```python
import torch

def _softmax(x, axis=-1):
    return torch.softmax(x, dim=axis)

def _gelu(x):
    return torch.nn.functional.gelu(x, approximate='tanh')

def _silu(x):
    return torch.nn.functional.silu(x)

def _sigmoid(x):
    return torch.sigmoid(x)

def _layernorm(x, axis=-1, eps=1e-05):
    m = x.mean(dim=axis, keepdim=True)
    v = x.var(dim=axis, keepdim=True, unbiased=False)
    return (x - m) / torch.sqrt(v + eps)

def _scatter_add(tgt, idx, src, axis=0):
    return tgt.clone().index_add_(axis, idx, src)

def _segment_sum(src, seg, n):
    out = torch.zeros((n,) + src.shape[1:], dtype=src.dtype)
    return out.index_add_(0, seg, src)

def _pad(x, pw):
    flat = tuple((v for pair in reversed(pw) for v in pair))
    return torch.nn.functional.pad(x, flat)
kernel_name = 'adaLN_cond__gqa_block_cached__glu_gated_swiglu__prompt'

def setup_inputs():

    _w = lambda a: (lambda t: t.to(torch.bfloat16) if t.is_floating_point() else t)(torch.as_tensor(a))

    def _A_setup():
        B, Sq, D = (1, 2048, 576)
        Hq, Hkv, Sk, Dh = (32, 16, 2048, 128)
        assert Hq % Hkv == 0, (Hq, Hkv)
        return {'x': _w((lambda *s: torch.randn(*s, dtype=torch.bfloat16) * 0.05)(B, Sq, D)), 'k_cache': _w((lambda *s: torch.randn(*s, dtype=torch.bfloat16) * 3.2)(B, Hkv, Sk, Dh)), 'v_cache': _w((lambda *s: torch.randn(*s, dtype=torch.bfloat16) * 1.6)(B, Hkv, Sk, Dh)), 'wq': _w((lambda *s: torch.randn(*s, dtype=torch.bfloat16) * 3.2)(D, Hq * Dh) * D ** (-0.5)), 'wo': _w((lambda *s: torch.randn(*s, dtype=torch.bfloat16) * 1.6)(Hq * Dh, D) * (Hq * Dh) ** (-0.5))}
    _A_in = _A_setup()

    def _B_setup():
        B, S, D, F = (1, 2048, 576, 4608)
        return {'x': _w((lambda *s: torch.randn(*s, dtype=torch.bfloat16) * 0.05)(B, S, D)), 'w1': _w((lambda *s: torch.randn(*s, dtype=torch.bfloat16) * 0.8)(D, F) * (2.0 / D) ** 0.5), 'w3': _w((lambda *s: torch.randn(*s, dtype=torch.bfloat16) * 0.8)(D, F) * (2.0 / D) ** 0.5), 'w2': _w((lambda *s: torch.randn(*s, dtype=torch.bfloat16) * 0.8)(F, D) * (2.0 / F) ** 0.5)}
    _B_in = _B_setup()
    return {'A_x': _A_in['x'], 'A_k_cache': _A_in['k_cache'], 'A_v_cache': _A_in['v_cache'], 'A_wq': _A_in['wq'], 'A_wo': _A_in['wo'], 'B_x': _B_in['x'], 'B_w1': _B_in['w1'], 'B_w3': _B_in['w3'], 'B_w2': _B_in['w2'], 'c': _w((lambda *s: torch.randn(*s, dtype=torch.bfloat16) * 0.2)(1, 576) * 8.0), 'w_mod': _w((lambda *s: torch.randn(*s, dtype=torch.bfloat16) * 0.2)(576, 6 * 576) * 576 ** (-0.5) * 8.0)}

def reference(A_x, A_k_cache, A_v_cache, A_wq, A_wo, B_x, B_w1, B_w3, B_w2, c, w_mod):

    def _A_ref(x, k_cache, v_cache, wq, wo):
        B, Sq, D = x.shape
        Hq, Dh = (32, 128)
        Hkv = k_cache.shape[1]
        rep = Hq // Hkv
        q = (lambda x, *d: x.permute(*d))((x @ wq).reshape(B, Sq, Hq, Dh), 0, 2, 1, 3)
        k = (lambda x, n, axis: torch.repeat_interleave(x, n, dim=axis))(k_cache, rep, axis=1)
        v = (lambda x, n, axis: torch.repeat_interleave(x, n, dim=axis))(v_cache, rep, axis=1)
        scores = torch.einsum('bhqd,bhkd->bhqk', q, k) * Dh ** (-0.5)
        p = _softmax(scores, axis=-1)
        o = torch.einsum('bhqk,bhkd->bhqd', p, v)
        return (lambda x, *d: x.permute(*d))(o, 0, 2, 1, 3).reshape(B, Sq, Hq * Dh) @ wo

    def _B_ref(x, w1, w3, w2):
        gate = torch.einsum('bsd,df->bsf', x, w1)
        up = torch.einsum('bsd,df->bsf', x, w3)
        h = _silu(gate) * up
        out = torch.einsum('bsf,fd->bsd', h, w2)
        return out
    x = A_x
    mod = (_silu(c) @ w_mod).reshape(c.shape[0], 6, 1, -1)
    sa, ca, ga, sb, cb, gb = (mod[:, 0].clone(), mod[:, 1].clone(), mod[:, 2].clone(), mod[:, 3].clone(), mod[:, 4].clone(), mod[:, 5].clone())
    h = _layernorm(x, axis=-1) * (1 + ca) + sa
    x = x + ga * _A_ref(h, A_k_cache, A_v_cache, A_wq, A_wo)
    h = _layernorm(x, axis=-1) * (1 + cb) + sb
    x = x + gb * _B_ref(h, B_w1, B_w3, B_w2)
    return x
```

```asm
; @launch kernel=k1_kernel grid=(364,1,1) block=(576,1,1) lds=8192
; @launch kernel=k4_kernel grid=(256,1,1) block=(256,1,1) lds=147968
.amdgcn_target "amdgcn-amd-amdhsa--gfx950"
.text
.globl k1_kernel
.p2align 8
.type k1_kernel,@function
k1_kernel:
    s_getpc_b64 s[64:65]
    v_lshlrev_b32 v62, 6, v0
    v_min_u32 v62, 2752, v62
    global_load_dword v63, v62, s[64:65]
    s_cmp_ge_u32 s2, 364
    s_cbranch_scc1 k1_kernel_end
    s_load_dwordx2 s[4:5], s[0:1], 0
    s_load_dwordx4 s[8:11], s[0:1], 72
    s_load_dwordx2 s[6:7], s[0:1], 104
    s_mov_b32 s30, 0xffff0000
    s_mov_b32 s68, s2
    s_add_u32 s2, s2, 256
    s_cmp_lt_u32 s2, 364
    s_cbranch_scc1 k1_kernel_mod
    s_sub_u32 s2, s2, 364
    v_lshrrev_b32 v7, 6, v0
    v_and_b32 v2, 7, v0
    v_bfe_u32 v6, v0, 3, 2
    v_lshrrev_b32 v5, 5, v0
    v_lshlrev_b32 v1, 6, v5
    v_lshl_add_u32 v1, v6, 3, v1
    v_mul_u32_u24 v4, 48, v2
    v_lshl_add_u32 v3, v7, 2, v4
    v_lshlrev_b32 v5, 10, v5
    v_lshl_add_u32 v5, v6, 8, v5
    v_lshl_add_u32 v5, v2, 4, v5
    s_mul_i32 s42, s2, 9216
    v_mul_u32_u24 v8, 1152, v2
    v_add3_u32 v8, v8, v1, s42
    s_lshr_b32 s40, s2, 1
    s_mul_i32 s40, s40, 18432
    s_and_b32 s41, s2, 1
    s_lshl_b32 s41, s41, 7
    s_add_u32 s40, s40, s41
    v_add_u32 v9, s40, v5
    s_waitcnt lgkmcnt(0)
    s_mov_b32 s12, s4
    s_mov_b32 s13, s5
    s_mov_b32 s14, 0x240000
    s_mov_b32 s15, 0x20000
    buffer_load_dwordx2 v[12:13], v8, s[12:15], 0 offen
    buffer_load_dwordx2 v[14:15], v8, s[12:15], 0 offen offset:32
    s_mov_b32 s16, s6
    s_mov_b32 s17, s7
    s_mov_b32 s18, 0x240000
    s_mov_b32 s19, 0x20000
    s_waitcnt vmcnt(0)
    v_lshlrev_b32 v16, 16, v12
    v_and_b32 v17, s30, v12
    v_lshlrev_b32 v18, 16, v13
    v_and_b32 v19, s30, v13
    v_lshlrev_b32 v20, 16, v14
    v_and_b32 v21, s30, v14
    v_lshlrev_b32 v22, 16, v15
    v_and_b32 v23, s30, v15
    v_add_f32 v24, v16, v17
    v_add_f32 v24, v24, v18
    v_add_f32 v24, v24, v19
    v_add_f32 v24, v24, v20
    v_add_f32 v24, v24, v21
    v_add_f32 v24, v24, v22
    v_add_f32 v24, v24, v23
    s_nop 1
    v_add_f32_dpp v24, v24, v24 row_ror:8 row_mask:0xf bank_mask:0xf
    v_mov_b32 v25, v24
    s_nop 1
    v_permlane16_swap_b32 v24, v25
    s_nop 1
    v_add_f32 v24, v24, v25
    v_mov_b32 v25, v24
    s_nop 1
    v_permlane32_swap_b32 v24, v25
    s_nop 1
    v_add_f32 v24, v24, v25
    ds_write_b32 v3, v24 offset:0
    s_waitcnt lgkmcnt(0)
    s_barrier
    ds_read_b128 v[28:31], v4 offset:0
    ds_read_b128 v[32:35], v4 offset:16
    ds_read_b32 v36, v4 offset:32
    s_waitcnt lgkmcnt(0)
    v_add_f32 v24, v28, v29
    v_add_f32 v24, v24, v30
    v_add_f32 v24, v24, v31
    v_add_f32 v24, v24, v32
    v_add_f32 v24, v24, v33
    v_add_f32 v24, v24, v34
    v_add_f32 v24, v24, v35
    v_add_f32 v24, v24, v36
    v_mul_f32 v24, 0x3ae38e39, v24
    v_sub_f32 v40, v16, v24
    v_sub_f32 v41, v17, v24
    v_sub_f32 v42, v18, v24
    v_sub_f32 v43, v19, v24
    v_sub_f32 v44, v20, v24
    v_sub_f32 v45, v21, v24
    v_sub_f32 v46, v22, v24
    v_sub_f32 v47, v23, v24
    v_mul_f32 v26, v40, v40
    v_fmac_f32 v26, v41, v41
    v_fmac_f32 v26, v42, v42
    v_fmac_f32 v26, v43, v43
    v_fmac_f32 v26, v44, v44
    v_fmac_f32 v26, v45, v45
    v_fmac_f32 v26, v46, v46
    v_fmac_f32 v26, v47, v47
    s_nop 1
    v_add_f32_dpp v26, v26, v26 row_ror:8 row_mask:0xf bank_mask:0xf
    v_mov_b32 v25, v26
    s_nop 1
    v_permlane16_swap_b32 v26, v25
    s_nop 1
    v_add_f32 v26, v26, v25
    v_mov_b32 v25, v26
    s_nop 1
    v_permlane32_swap_b32 v26, v25
    s_nop 1
    v_add_f32 v26, v26, v25
    ds_write_b32 v3, v26 offset:512
    s_waitcnt lgkmcnt(0)
    s_barrier
    ds_read_b128 v[28:31], v4 offset:512
    ds_read_b128 v[32:35], v4 offset:528
    ds_read_b32 v36, v4 offset:544
    s_waitcnt lgkmcnt(0)
    v_add_f32 v26, v28, v29
    v_add_f32 v26, v26, v30
    v_add_f32 v26, v26, v31
    v_add_f32 v26, v26, v32
    v_add_f32 v26, v26, v33
    v_add_f32 v26, v26, v34
    v_add_f32 v26, v26, v35
    v_add_f32 v26, v26, v36
    v_mul_f32 v26, 0x3ae38e39, v26
    v_cvt_pk_bf16_f32 v24, v24, v24
    v_lshlrev_b32 v24, 16, v24
    v_cvt_pk_bf16_f32 v26, v26, v26
    v_lshlrev_b32 v26, 16, v26
    v_add_f32 v26, 0x3727c5ac, v26
    v_cvt_pk_bf16_f32 v26, v26, v26
    v_lshlrev_b32 v26, 16, v26
    v_sqrt_f32 v26, v26
    s_nop 0
    v_cvt_pk_bf16_f32 v26, v26, v26
    v_lshlrev_b32 v26, 16, v26
    v_rcp_f32 v25, v26
    v_sub_f32 v16, v16, v24
    v_sub_f32 v17, v17, v24
    v_sub_f32 v18, v18, v24
    v_sub_f32 v19, v19, v24
    v_sub_f32 v20, v20, v24
    v_sub_f32 v21, v21, v24
    v_sub_f32 v22, v22, v24
    v_sub_f32 v23, v23, v24
    v_cvt_pk_bf16_f32 v28, v16, v17
    v_cvt_pk_bf16_f32 v29, v18, v19
    v_cvt_pk_bf16_f32 v30, v20, v21
    v_cvt_pk_bf16_f32 v31, v22, v23
    v_lshlrev_b32 v16, 16, v28
    v_and_b32 v17, s30, v28
    v_lshlrev_b32 v18, 16, v29
    v_and_b32 v19, s30, v29
    v_lshlrev_b32 v20, 16, v30
    v_and_b32 v21, s30, v30
    v_lshlrev_b32 v22, 16, v31
    v_and_b32 v23, s30, v31
    v_mul_f32 v40, v16, v25
    v_mul_f32 v41, v17, v25
    v_mul_f32 v42, v18, v25
    v_mul_f32 v43, v19, v25
    v_mul_f32 v44, v20, v25
    v_mul_f32 v45, v21, v25
    v_mul_f32 v46, v22, v25
    v_mul_f32 v47, v23, v25
    v_fma_f32 v16, -v40, v26, v16
    v_fma_f32 v17, -v41, v26, v17
    v_fma_f32 v18, -v42, v26, v18
    v_fma_f32 v19, -v43, v26, v19
    v_fma_f32 v20, -v44, v26, v20
    v_fma_f32 v21, -v45, v26, v21
    v_fma_f32 v22, -v46, v26, v22
    v_fma_f32 v23, -v47, v26, v23
    v_fmac_f32 v40, v16, v25
    v_fmac_f32 v41, v17, v25
    v_fmac_f32 v42, v18, v25
    v_fmac_f32 v43, v19, v25
    v_fmac_f32 v44, v20, v25
    v_fmac_f32 v45, v21, v25
    v_fmac_f32 v46, v22, v25
    v_fmac_f32 v47, v23, v25
    v_cvt_pk_bf16_f32 v28, v40, v41
    v_cvt_pk_bf16_f32 v29, v42, v43
    v_cvt_pk_bf16_f32 v30, v44, v45
    v_cvt_pk_bf16_f32 v31, v46, v47
    buffer_store_dwordx4 v[28:31], v9, s[16:19], 0 offen
    s_endpgm
k1_kernel_mod:
    s_sub_u32 s20, s2, 256
    v_lshrrev_b32 v1, 2, v0
    v_and_b32 v2, 3, v0
    s_movk_i32 s21, 6912
    v_mul_lo_u32 v3, v1, s21
    v_lshl_add_u32 v3, v2, 4, v3
    s_lshl_b32 s22, s20, 6
    v_add_u32 v3, s22, v3
    v_lshlrev_b32 v4, 1, v1
    s_waitcnt lgkmcnt(0)
    s_mov_b32 s12, s8
    s_mov_b32 s13, s9
    s_mov_b32 s14, 0x480
    s_mov_b32 s15, 0x20000
    s_mov_b32 s16, s10
    s_mov_b32 s17, s11
    s_mov_b32 s18, 0x3cc000
    s_mov_b32 s19, 0x20000
    buffer_load_ushort v8, v4, s[12:15], 0 offen offset:0
    buffer_load_ushort v9, v4, s[12:15], 0 offen offset:288
    buffer_load_ushort v10, v4, s[12:15], 0 offen offset:576
    buffer_load_ushort v11, v4, s[12:15], 0 offen offset:864
    s_mov_b32 s23, 0
    buffer_load_dwordx4 v[16:19], v3, s[16:19], s23 offen
    s_mov_b32 s23, 995328
    buffer_load_dwordx4 v[20:23], v3, s[16:19], s23 offen
    s_mov_b32 s23, 1990656
    buffer_load_dwordx4 v[24:27], v3, s[16:19], s23 offen
    s_mov_b32 s23, 2985984
    buffer_load_dwordx4 v[28:31], v3, s[16:19], s23 offen
    s_add_u32 s24, s6, 0x6c0000
    s_addc_u32 s25, s7, 0
    s_mov_b32 s26, 0xd000
    s_mov_b32 s27, 0x20000
    v_lshrrev_b32 v5, 6, v0
    v_lshlrev_b32 v6, 7, v5
    v_lshl_add_u32 v6, v2, 5, v6
    v_readfirstlane_b32 s31, v5
    s_mul_i32 s32, s20, 57
    s_lshr_b32 s32, s32, 10
    s_mul_i32 s33, s32, 18
    s_sub_u32 s33, s20, s33
    s_lshl_b32 s33, s33, 5
    v_and_b32 v7, 31, v0
    v_lshlrev_b32 v40, 2, v7
    v_add_u32 v7, s33, v7
    s_waitcnt vmcnt(4)
    v_lshlrev_b32 v8, 16, v8
    v_lshlrev_b32 v9, 16, v9
    v_lshlrev_b32 v10, 16, v10
    v_lshlrev_b32 v11, 16, v11
    v_mul_f32 v48, 0xbfb8aa3b, v8
    v_mul_f32 v49, 0xbfb8aa3b, v9
    v_mul_f32 v50, 0xbfb8aa3b, v10
    v_mul_f32 v51, 0xbfb8aa3b, v11
    v_exp_f32 v48, v48
    v_exp_f32 v49, v49
    v_exp_f32 v50, v50
    v_exp_f32 v51, v51
    v_add_f32 v48, 1.0, v48
    v_add_f32 v49, 1.0, v49
    v_add_f32 v50, 1.0, v50
    v_add_f32 v51, 1.0, v51
    v_rcp_f32 v48, v48
    v_rcp_f32 v49, v49
    v_rcp_f32 v50, v50
    v_rcp_f32 v51, v51
    v_mul_f32 v8, v8, v48
    v_mul_f32 v9, v9, v49
    v_mul_f32 v10, v10, v50
    v_mul_f32 v11, v11, v51
    v_cvt_pk_bf16_f32 v48, v8, v9
    v_cvt_pk_bf16_f32 v49, v10, v11
    v_lshlrev_b32 v8, 16, v48
    v_and_b32 v9, s30, v48
    v_lshlrev_b32 v10, 16, v49
    v_and_b32 v11, s30, v49
    s_waitcnt vmcnt(3)
    v_lshlrev_b32 v48, 16, v16
    v_and_b32 v49, s30, v16
    v_lshlrev_b32 v50, 16, v17
    v_and_b32 v51, s30, v17
    v_lshlrev_b32 v52, 16, v18
    v_and_b32 v53, s30, v18
    v_lshlrev_b32 v54, 16, v19
    v_and_b32 v55, s30, v19
    v_mul_f32 v56, v8, v48
    v_mul_f32 v57, v8, v49
    v_mul_f32 v58, v8, v50
    v_mul_f32 v59, v8, v51
    v_mul_f32 v60, v8, v52
    v_mul_f32 v61, v8, v53
    v_mul_f32 v62, v8, v54
    v_mul_f32 v63, v8, v55
    s_waitcnt vmcnt(2)
    v_lshlrev_b32 v48, 16, v20
    v_and_b32 v49, s30, v20
    v_lshlrev_b32 v50, 16, v21
    v_and_b32 v51, s30, v21
    v_lshlrev_b32 v52, 16, v22
    v_and_b32 v53, s30, v22
    v_lshlrev_b32 v54, 16, v23
    v_and_b32 v55, s30, v23
    v_fmac_f32 v56, v9, v48
    v_fmac_f32 v57, v9, v49
    v_fmac_f32 v58, v9, v50
    v_fmac_f32 v59, v9, v51
    v_fmac_f32 v60, v9, v52
    v_fmac_f32 v61, v9, v53
    v_fmac_f32 v62, v9, v54
    v_fmac_f32 v63, v9, v55
    s_waitcnt vmcnt(1)
    v_lshlrev_b32 v48, 16, v24
    v_and_b32 v49, s30, v24
    v_lshlrev_b32 v50, 16, v25
    v_and_b32 v51, s30, v25
    v_lshlrev_b32 v52, 16, v26
    v_and_b32 v53, s30, v26
    v_lshlrev_b32 v54, 16, v27
    v_and_b32 v55, s30, v27
    v_fmac_f32 v56, v10, v48
    v_fmac_f32 v57, v10, v49
    v_fmac_f32 v58, v10, v50
    v_fmac_f32 v59, v10, v51
    v_fmac_f32 v60, v10, v52
    v_fmac_f32 v61, v10, v53
    v_fmac_f32 v62, v10, v54
    v_fmac_f32 v63, v10, v55
    s_waitcnt vmcnt(0)
    v_lshlrev_b32 v48, 16, v28
    v_and_b32 v49, s30, v28
    v_lshlrev_b32 v50, 16, v29
    v_and_b32 v51, s30, v29
    v_lshlrev_b32 v52, 16, v30
    v_and_b32 v53, s30, v30
    v_lshlrev_b32 v54, 16, v31
    v_and_b32 v55, s30, v31
    v_fmac_f32 v56, v11, v48
    v_fmac_f32 v57, v11, v49
    v_fmac_f32 v58, v11, v50
    v_fmac_f32 v59, v11, v51
    v_fmac_f32 v60, v11, v52
    v_fmac_f32 v61, v11, v53
    v_fmac_f32 v62, v11, v54
    v_fmac_f32 v63, v11, v55
    v_add_f32_dpp v56, v56, v56 row_ror:4 row_mask:0xf bank_mask:0xf
    v_add_f32_dpp v57, v57, v57 row_ror:4 row_mask:0xf bank_mask:0xf
    v_add_f32_dpp v58, v58, v58 row_ror:4 row_mask:0xf bank_mask:0xf
    v_add_f32_dpp v59, v59, v59 row_ror:4 row_mask:0xf bank_mask:0xf
    v_add_f32_dpp v60, v60, v60 row_ror:4 row_mask:0xf bank_mask:0xf
    v_add_f32_dpp v61, v61, v61 row_ror:4 row_mask:0xf bank_mask:0xf
    v_add_f32_dpp v62, v62, v62 row_ror:4 row_mask:0xf bank_mask:0xf
    v_add_f32_dpp v63, v63, v63 row_ror:4 row_mask:0xf bank_mask:0xf
    s_nop 1
    v_add_f32_dpp v56, v56, v56 row_ror:8 row_mask:0xf bank_mask:0xf
    v_add_f32_dpp v57, v57, v57 row_ror:8 row_mask:0xf bank_mask:0xf
    v_add_f32_dpp v58, v58, v58 row_ror:8 row_mask:0xf bank_mask:0xf
    v_add_f32_dpp v59, v59, v59 row_ror:8 row_mask:0xf bank_mask:0xf
    v_add_f32_dpp v60, v60, v60 row_ror:8 row_mask:0xf bank_mask:0xf
    v_add_f32_dpp v61, v61, v61 row_ror:8 row_mask:0xf bank_mask:0xf
    v_add_f32_dpp v62, v62, v62 row_ror:8 row_mask:0xf bank_mask:0xf
    v_add_f32_dpp v63, v63, v63 row_ror:8 row_mask:0xf bank_mask:0xf
    v_mov_b32 v48, v56
    v_mov_b32 v49, v57
    v_mov_b32 v50, v58
    v_mov_b32 v51, v59
    v_mov_b32 v52, v60
    v_mov_b32 v53, v61
    v_mov_b32 v54, v62
    v_mov_b32 v55, v63
    s_nop 1
    v_permlane16_swap_b32 v56, v48
    v_permlane16_swap_b32 v57, v49
    v_permlane16_swap_b32 v58, v50
    v_permlane16_swap_b32 v59, v51
    v_permlane16_swap_b32 v60, v52
    v_permlane16_swap_b32 v61, v53
    v_permlane16_swap_b32 v62, v54
    v_permlane16_swap_b32 v63, v55
    s_nop 1
    v_add_f32 v56, v56, v48
    v_add_f32 v57, v57, v49
    v_add_f32 v58, v58, v50
    v_add_f32 v59, v59, v51
    v_add_f32 v60, v60, v52
    v_add_f32 v61, v61, v53
    v_add_f32 v62, v62, v54
    v_add_f32 v63, v63, v55
    v_mov_b32 v48, v56
    v_mov_b32 v49, v57
    v_mov_b32 v50, v58
    v_mov_b32 v51, v59
    v_mov_b32 v52, v60
    v_mov_b32 v53, v61
    v_mov_b32 v54, v62
    v_mov_b32 v55, v63
    s_nop 1
    v_permlane32_swap_b32 v56, v48
    v_permlane32_swap_b32 v57, v49
    v_permlane32_swap_b32 v58, v50
    v_permlane32_swap_b32 v59, v51
    v_permlane32_swap_b32 v60, v52
    v_permlane32_swap_b32 v61, v53
    v_permlane32_swap_b32 v62, v54
    v_permlane32_swap_b32 v63, v55
    s_nop 1
    v_add_f32 v56, v56, v48
    v_add_f32 v57, v57, v49
    v_add_f32 v58, v58, v50
    v_add_f32 v59, v59, v51
    v_add_f32 v60, v60, v52
    v_add_f32 v61, v61, v53
    v_add_f32 v62, v62, v54
    v_add_f32 v63, v63, v55
    ds_write_b128 v6, v[56:59]
    ds_write_b128 v6, v[60:63] offset:16
    s_waitcnt lgkmcnt(0)
    s_barrier
    s_cmp_lg_u32 s31, 0
    s_cbranch_scc1 k1_kernel_end
    ds_read_b32 v16, v40 offset:0
    ds_read_b32 v17, v40 offset:128
    ds_read_b32 v18, v40 offset:256
    ds_read_b32 v19, v40 offset:384
    ds_read_b32 v20, v40 offset:512
    ds_read_b32 v21, v40 offset:640
    ds_read_b32 v22, v40 offset:768
    ds_read_b32 v23, v40 offset:896
    ds_read_b32 v24, v40 offset:1024
    v_lshlrev_b32 v6, 2, v0
    s_waitcnt lgkmcnt(0)
    v_add_f32 v16, v16, v17
    v_add_f32 v16, v16, v18
    v_add_f32 v16, v16, v19
    v_add_f32 v16, v16, v20
    v_add_f32 v16, v16, v21
    v_add_f32 v16, v16, v22
    v_add_f32 v16, v16, v23
    v_add_f32 v16, v16, v24
    v_cvt_pk_bf16_f32 v16, v16, v16
    v_lshlrev_b32 v16, 16, v16
    s_cmp_eq_u32 s32, 1
    s_cbranch_scc1 k1_kernel_plus1
    s_cmp_eq_u32 s32, 4
    s_cbranch_scc0 k1_kernel_addr
k1_kernel_plus1:
    v_add_f32 v16, 1.0, v16
    v_cvt_pk_bf16_f32 v16, v16, v16
    v_lshlrev_b32 v16, 16, v16
k1_kernel_addr:
    s_cmp_ge_u32 s32, 2
    s_cbranch_scc1 k1_kernel_lin
    v_mul_f32 v16, 0x3e0293ee, v16
    v_lshrrev_b32 v8, 5, v7
    v_lshlrev_b32 v8, 8, v8
    v_bfe_u32 v9, v7, 2, 2
    v_lshl_add_u32 v8, v9, 6, v8
    v_bfe_u32 v9, v7, 4, 1
    v_lshl_add_u32 v8, v9, 4, v8
    v_and_b32 v9, 3, v7
    v_lshl_add_u32 v8, v9, 2, v8
    s_cmp_eq_u32 s32, 0
    s_cselect_b32 s34, 32, 0
    v_add_u32 v8, s34, v8
    s_branch k1_kernel_st
k1_kernel_lin:
    s_mov_b32 s34, 8192
    s_cmp_eq_u32 s32, 3
    s_cselect_b32 s34, 12800, s34
    s_cmp_eq_u32 s32, 4
    s_cselect_b32 s34, 10496, s34
    s_cmp_eq_u32 s32, 5
    s_cselect_b32 s34, 15104, s34
    v_lshlrev_b32 v8, 2, v7
    v_add_u32 v8, s34, v8
k1_kernel_st:
    buffer_store_dword v16, v8, s[24:27], 0 offen
    s_lshl_b32 s34, s20, 8
    s_add_u32 s34, s34, 24576
    v_mov_b32 v9, 0
    buffer_store_dword v9, v6, s[24:27], s34 offen
k1_kernel_end:
    s_endpgm
.globl k4_kernel
.p2align 8
.type k4_kernel,@function
k4_kernel:
    s_cmp_ge_u32 s2, 256
    s_cbranch_scc1 k4_kernel_end
    s_load_dwordx4 s[36:39], s[0:1], 24
    s_load_dwordx2 s[40:41], s[0:1], 104
    s_getpc_b64 s[60:61]
    v_lshlrev_b32 v255, 6, v0
    global_load_dword v47, v255, s[60:61]
    s_load_dwordx4 s[4:7], s[0:1], 8
    s_load_dwordx4 s[96:99], s[0:1], 48
    s_load_dwordx2 s[100:101], s[0:1], 64
    v_lshrrev_b32 v1, 6, v0
    v_and_b32 v2, 63, v0
    s_and_b32 s44, s2, 7
    s_lshl_b32 s44, s44, 1
    v_readfirstlane_b32 s46, v1
    s_bfe_u32 s45, s2, 0x10003
    s_add_u32 s44, s44, s45
    s_lshr_b32 s45, s2, 4
    s_mov_b32 s53, 0xffff0000
    s_and_b32 s44, s2, 3
    s_lshl_b32 s44, s44, 2
    s_bfe_u32 s45, s2, 0x20003
    s_add_u32 s44, s44, s45
    s_bfe_u32 s45, s2, 0x10002
    s_lshl_b32 s45, s45, 3
    s_lshr_b32 s58, s2, 5
    s_add_u32 s45, s45, s58
    v_lshrrev_b32 v3, 4, v2
    v_and_b32 v4, 15, v2
    s_lshl_b32 s47, s46, 12
    s_lshl_b32 s57, s46, 17
    v_add_u32 v5, 0, v3
    v_lshlrev_b32 v5, 1, v5
    v_xor_b32 v5, v5, v4
    v_lshlrev_b32 v5, 4, v5
    v_lshl_add_u32 v5, v3, 13, v5
    v_add_u32 v5, 0, v5
    v_add_u32 v240, s57, v5
    v_add_u32 v5, 4, v3
    v_lshlrev_b32 v5, 1, v5
    v_xor_b32 v5, v5, v4
    v_lshlrev_b32 v5, 4, v5
    v_lshl_add_u32 v5, v3, 13, v5
    v_add_u32 v5, 31744, v5
    v_add_u32 v241, s57, v5
    v_add_u32 v5, 0, v3
    v_lshlrev_b32 v5, 1, v5
    v_xor_b32 v5, v5, v4
    v_lshlrev_b32 v5, 4, v5
    v_lshl_add_u32 v5, v3, 13, v5
    v_add_u32 v5, 63488, v5
    v_add_u32 v242, s57, v5
    v_add_u32 v5, 4, v3
    v_lshlrev_b32 v5, 1, v5
    v_xor_b32 v5, v5, v4
    v_lshlrev_b32 v5, 4, v5
    v_lshl_add_u32 v5, v3, 13, v5
    v_add_u32 v5, 95232, v5
    v_add_u32 v243, s57, v5
    v_lshlrev_b32 v252, 4, v2
    s_lshl_b32 s59, s45, 2
    s_add_u32 s59, s59, s46
    s_mul_i32 s59, s59, 36864
    s_lshl_b32 s58, s44, 9
    s_waitcnt lgkmcnt(0)
    s_add_u32 s16, s36, s58
    s_addc_u32 s17, s37, 0
    s_mov_b32 s18, 0x47e200
    s_mov_b32 s19, 0x20000
    s_add_u32 s24, s40, s59
    s_addc_u32 s25, s41, 0
    s_mov_b32 s26, 0x9000
    s_mov_b32 s27, 0x20000
    s_add_u32 s28, s40, 0x6c0000
    s_addc_u32 s29, s41, 0
    s_mov_b32 s30, 0x1400
    s_mov_b32 s31, 0x20000
    s_lshl_b32 s58, s46, 10
    s_add_u32 m0, s58, 131072
    s_movk_i32 s59, 0x1000
    buffer_load_dwordx4 v252, s[28:31], s58 offen lds
    s_mov_b32 m0, 135168
    s_nop 0
    buffer_load_dwordx4 v252, s[28:31], s59 offen lds
    s_mov_b32 s59, 0
    buffer_load_dwordx4 v[48:51], v252, s[24:27], s59 offen offset:0
    s_mov_b32 s59, 16384
    buffer_load_dwordx4 v[52:55], v252, s[24:27], s59 offen offset:2048
    s_mov_b32 s59, 0
    buffer_load_dwordx4 v[56:59], v252, s[24:27], s59 offen offset:1024
    s_mov_b32 s59, 16384
    buffer_load_dwordx4 v[60:63], v252, s[24:27], s59 offen offset:3072
    s_mov_b32 s59, 0
    buffer_load_dwordx4 v[64:67], v252, s[24:27], s59 offen offset:2048
    s_mov_b32 s59, 20480
    buffer_load_dwordx4 v[68:71], v252, s[24:27], s59 offen offset:0
    s_mov_b32 s59, 0
    buffer_load_dwordx4 v[72:75], v252, s[24:27], s59 offen offset:3072
    s_mov_b32 s59, 20480
    buffer_load_dwordx4 v[76:79], v252, s[24:27], s59 offen offset:1024
    s_mov_b32 s59, 4096
    buffer_load_dwordx4 v[80:83], v252, s[24:27], s59 offen offset:0
    s_mov_b32 s59, 20480
    buffer_load_dwordx4 v[84:87], v252, s[24:27], s59 offen offset:2048
    s_mov_b32 s59, 4096
    buffer_load_dwordx4 v[88:91], v252, s[24:27], s59 offen offset:1024
    s_mov_b32 s59, 20480
    buffer_load_dwordx4 v[92:95], v252, s[24:27], s59 offen offset:3072
    s_mov_b32 s59, 4096
    buffer_load_dwordx4 v[96:99], v252, s[24:27], s59 offen offset:2048
    s_mov_b32 s59, 24576
    buffer_load_dwordx4 v[100:103], v252, s[24:27], s59 offen offset:0
    s_mov_b32 s59, 4096
    buffer_load_dwordx4 v[104:107], v252, s[24:27], s59 offen offset:3072
    s_mov_b32 s59, 24576
    buffer_load_dwordx4 v[108:111], v252, s[24:27], s59 offen offset:1024
    s_mov_b32 s59, 8192
    buffer_load_dwordx4 v[112:115], v252, s[24:27], s59 offen offset:0
    s_mov_b32 s59, 24576
    buffer_load_dwordx4 v[116:119], v252, s[24:27], s59 offen offset:2048
    s_mov_b32 s59, 8192
    buffer_load_dwordx4 v[120:123], v252, s[24:27], s59 offen offset:1024
    s_mov_b32 s59, 24576
    buffer_load_dwordx4 v[124:127], v252, s[24:27], s59 offen offset:3072
    s_lshl_b32 s58, s44, 19
    s_add_u32 s8, s4, s58
    s_addc_u32 s9, s5, 0
    s_mov_b32 s10, 0x80000
    s_mov_b32 s11, 0x20000
    s_add_u32 s12, s6, s58
    s_addc_u32 s13, s7, 0
    s_mov_b32 s14, 0x80000
    s_mov_b32 s15, 0x20000
    s_mul_i32 s58, s44, 294912
    s_add_u32 s20, s38, s58
    s_addc_u32 s21, s39, 0
    s_mov_b32 s22, 0x48000
    s_mov_b32 s23, 0x20000
    s_mul_i32 s58, s44, 2359296
    s_mul_i32 s59, s45, 147456
    s_add_u32 s58, s58, s59
    s_add_u32 s58, s58, 7340032
    s_add_u32 s32, s40, s58
    s_addc_u32 s33, s41, 0
    s_mov_b32 s34, 0x24000
    s_mov_b32 s35, 0x20000
    s_mov_b32 s48, 0
    s_mov_b32 s49, 0
    s_mov_b32 s51, 6
    s_mov_b32 s54, 0x5d800000
    s_mov_b32 s55, 0x3e0293ee
    v_lshrrev_b32 v1, 5, v2
    v_bfe_u32 v6, v2, 2, 2
    v_and_b32 v7, 3, v2
    v_bfe_u32 v46, v2, 4, 1
    v_lshlrev_b32 v46, 5, v46
    v_lshrrev_b32 v40, 1, v7
    v_and_b32 v41, 1, v7
    v_lshl_add_u32 v40, v41, 1, v40
    v_lshl_add_u32 v46, v40, 3, v46
    v_lshl_add_u32 v43, v1, 3, v6
    v_xor_b32 v41, 0, v6
    v_lshlrev_b32 v41, 6, v41
    v_lshl_add_u32 v44, v43, 8, v41
    v_add_u32 v244, v44, v46
    v_add_u32 v248, 0x10000, v244
    v_xor_b32 v41, 1, v6
    v_lshlrev_b32 v41, 6, v41
    v_lshl_add_u32 v44, v43, 8, v41
    v_add_u32 v245, v44, v46
    v_add_u32 v249, 0x10000, v245
    v_xor_b32 v41, 2, v6
    v_lshlrev_b32 v41, 6, v41
    v_lshl_add_u32 v44, v43, 8, v41
    v_add_u32 v246, v44, v46
    v_add_u32 v250, 0x10000, v246
    v_xor_b32 v41, 3, v6
    v_lshlrev_b32 v41, 6, v41
    v_lshl_add_u32 v44, v43, 8, v41
    v_add_u32 v247, v44, v46
    v_add_u32 v251, 0x10000, v247
    v_lshlrev_b32 v253, 6, v1
    v_add_u32 v253, 131072, v253
    v_add_u32 v41, 0, v3
    v_xor_b32 v41, v41, v4
    v_lshlrev_b32 v41, 4, v41
    v_lshl_add_u32 v8, v4, 8, v41
    v_lshl_add_u32 v41, v3, 8, v41
    v_add_u32 v20, s47, v41
    v_add_u32 v41, 4, v3
    v_xor_b32 v41, v41, v4
    v_lshlrev_b32 v41, 4, v41
    v_lshl_add_u32 v9, v4, 8, v41
    v_lshl_add_u32 v41, v3, 8, v41
    v_add_u32 v21, s47, v41
    v_add_u32 v41, 8, v3
    v_xor_b32 v41, v41, v4
    v_lshlrev_b32 v41, 4, v41
    v_lshl_add_u32 v10, v4, 8, v41
    v_lshl_add_u32 v41, v3, 8, v41
    v_add_u32 v22, s47, v41
    v_add_u32 v41, 12, v3
    v_xor_b32 v41, v41, v4
    v_lshlrev_b32 v41, 4, v41
    v_lshl_add_u32 v11, v4, 8, v41
    v_lshl_add_u32 v41, v3, 8, v41
    v_add_u32 v23, s47, v41
    v_lshrrev_b32 v42, 2, v2
    v_lshlrev_b32 v7, 3, v7
    v_lshl_add_u32 v43, v42, 8, v7
    v_add_u32 v43, 0x10000, v43
    v_and_b32 v44, 7, v42
    v_xor_b32 v41, 0, v44
    v_lshl_add_u32 v12, v41, 5, v43
    v_xor_b32 v41, 1, v44
    v_lshl_add_u32 v13, v41, 5, v43
    v_xor_b32 v41, 2, v44
    v_lshl_add_u32 v14, v41, 5, v43
    v_xor_b32 v41, 3, v44
    v_lshl_add_u32 v15, v41, 5, v43
    v_xor_b32 v41, 4, v44
    v_lshl_add_u32 v16, v41, 5, v43
    v_xor_b32 v41, 5, v44
    v_lshl_add_u32 v17, v41, 5, v43
    v_xor_b32 v41, 6, v44
    v_lshl_add_u32 v18, v41, 5, v43
    v_xor_b32 v41, 7, v44
    v_lshl_add_u32 v19, v41, 5, v43
    v_add_u32 v41, 0, v3
    v_lshlrev_b32 v41, 1, v41
    v_xor_b32 v41, v41, v4
    v_lshlrev_b32 v41, 4, v41
    v_lshl_add_u32 v41, v3, 8, v41
    v_add_u32 v24, s47, v41
    v_add_u32 v41, 4, v3
    v_lshlrev_b32 v41, 1, v41
    v_xor_b32 v41, v41, v4
    v_lshlrev_b32 v41, 4, v41
    v_lshl_add_u32 v41, v3, 8, v41
    v_add_u32 v25, s47, v41
    v_lshl_add_u32 v43, v42, 7, v7
    v_bfe_u32 v44, v42, 1, 2
    v_xor_b32 v41, 0, v44
    v_lshl_add_u32 v30, v41, 5, v43
    v_add_u32 v34, 0x10000, v30
    v_xor_b32 v41, 1, v44
    v_lshl_add_u32 v31, v41, 5, v43
    v_add_u32 v35, 0x10000, v31
    v_xor_b32 v41, 2, v44
    v_lshl_add_u32 v32, v41, 5, v43
    v_add_u32 v36, 0x10000, v32
    v_xor_b32 v41, 3, v44
    v_lshl_add_u32 v33, v41, 5, v43
    v_add_u32 v37, 0x10000, v33
    v_lshrrev_b32 v41, 3, v2
    s_lshl_b32 s58, s46, 5
    v_add_u32 v41, s58, v41
    v_mul_u32_u24 v41, 1152, v41
    v_and_b32 v44, 7, v2
    v_lshlrev_b32 v45, 1, v3
    v_xor_b32 v45, v45, v44
    v_lshl_add_u32 v26, v45, 4, v41
    v_add_u32 v27, 8192, v26
    v_add_u32 v28, 16384, v26
    v_add_u32 v29, 24576, v26
    v_bfe_u32 v41, v2, 3, 1
    s_lshl_b32 s58, s46, 2
    v_add_u32 v41, s58, v41
    v_mul_u32_u24 v41, 9216, v41
    v_lshl_add_u32 v41, v3, 7, v41
    v_lshl_add_u32 v38, v44, 4, v41
    v_subrev_u32 v244, 0x10000, v12
    v_subrev_u32 v245, 0x10000, v13
    v_subrev_u32 v246, 0x10000, v14
    v_subrev_u32 v247, 0x10000, v15
    v_subrev_u32 v248, 0x10000, v16
    v_subrev_u32 v249, 0x10000, v17
    v_subrev_u32 v250, 0x10000, v18
    v_subrev_u32 v251, 0x10000, v19
    v_lshlrev_b32 v253, 6, v3
    v_add_u32 v253, 131072, v253
    s_waitcnt vmcnt(20)
    s_barrier
    ds_read_b128 v[192:195], v253 offset:0
    ds_read_b128 v[196:199], v253 offset:16
    ds_read_b128 v[200:203], v253 offset:32
    ds_read_b128 v[204:207], v253 offset:48
    s_mov_b32 s59, 8192
    buffer_load_dwordx4 v[128:131], v252, s[24:27], s59 offen offset:2048
    s_mov_b32 s59, 28672
    buffer_load_dwordx4 v[132:135], v252, s[24:27], s59 offen offset:0
    ds_read_b128 v[208:211], v253 offset:256
    ds_read_b128 v[212:215], v253 offset:272
    ds_read_b128 v[216:219], v253 offset:288
    ds_read_b128 v[220:223], v253 offset:304
    s_waitcnt vmcnt(20) lgkmcnt(4)
    v_lshlrev_b32 v224, 16, v48
    v_and_b32 v225, s53, v48
    v_lshlrev_b32 v226, 16, v49
    v_and_b32 v227, s53, v49
    v_lshlrev_b32 v228, 16, v50
    v_and_b32 v229, s53, v50
    v_lshlrev_b32 v230, 16, v51
    v_and_b32 v231, s53, v51
    v_lshlrev_b32 v232, 16, v52
    v_and_b32 v233, s53, v52
    v_lshlrev_b32 v234, 16, v53
    v_and_b32 v235, s53, v53
    v_lshlrev_b32 v236, 16, v54
    v_and_b32 v237, s53, v54
    v_lshlrev_b32 v238, 16, v55
    v_and_b32 v239, s53, v55
    v_pk_fma_f32 v[224:225], v[224:225], v[192:193], v[200:201]
    v_pk_fma_f32 v[226:227], v[226:227], v[194:195], v[202:203]
    v_pk_fma_f32 v[228:229], v[228:229], v[196:197], v[204:205]
    v_pk_fma_f32 v[230:231], v[230:231], v[198:199], v[206:207]
    v_pk_fma_f32 v[232:233], v[232:233], v[192:193], v[200:201]
    v_pk_fma_f32 v[234:235], v[234:235], v[194:195], v[202:203]
    v_pk_fma_f32 v[236:237], v[236:237], v[196:197], v[204:205]
    v_pk_fma_f32 v[238:239], v[238:239], v[198:199], v[206:207]
    v_cvt_pk_bf16_f32 v48, v224, v225
    v_cvt_pk_bf16_f32 v49, v226, v227
    v_cvt_pk_bf16_f32 v50, v228, v229
    v_cvt_pk_bf16_f32 v51, v230, v231
    v_cvt_pk_bf16_f32 v52, v232, v233
    v_cvt_pk_bf16_f32 v53, v234, v235
    v_cvt_pk_bf16_f32 v54, v236, v237
    v_cvt_pk_bf16_f32 v55, v238, v239
    v_accvgpr_write_b32 a0, v48
    v_accvgpr_write_b32 a1, v49
    v_accvgpr_write_b32 a2, v50
    v_accvgpr_write_b32 a3, v51
    v_accvgpr_write_b32 a72, v52
    v_accvgpr_write_b32 a73, v53
    v_accvgpr_write_b32 a74, v54
    v_accvgpr_write_b32 a75, v55
    s_mov_b32 s59, 8192
    buffer_load_dwordx4 v[136:139], v252, s[24:27], s59 offen offset:3072
    s_mov_b32 s59, 28672
    buffer_load_dwordx4 v[140:143], v252, s[24:27], s59 offen offset:1024
    ds_read_b128 v[192:195], v253 offset:512
    ds_read_b128 v[196:199], v253 offset:528
    ds_read_b128 v[200:203], v253 offset:544
    ds_read_b128 v[204:207], v253 offset:560
    s_waitcnt vmcnt(20) lgkmcnt(4)
    v_lshlrev_b32 v224, 16, v56
    v_and_b32 v225, s53, v56
    v_lshlrev_b32 v226, 16, v57
    v_and_b32 v227, s53, v57
    v_lshlrev_b32 v228, 16, v58
    v_and_b32 v229, s53, v58
    v_lshlrev_b32 v230, 16, v59
    v_and_b32 v231, s53, v59
    v_lshlrev_b32 v232, 16, v60
    v_and_b32 v233, s53, v60
    v_lshlrev_b32 v234, 16, v61
    v_and_b32 v235, s53, v61
    v_lshlrev_b32 v236, 16, v62
    v_and_b32 v237, s53, v62
    v_lshlrev_b32 v238, 16, v63
    v_and_b32 v239, s53, v63
    v_pk_fma_f32 v[224:225], v[224:225], v[208:209], v[216:217]
    v_pk_fma_f32 v[226:227], v[226:227], v[210:211], v[218:219]
    v_pk_fma_f32 v[228:229], v[228:229], v[212:213], v[220:221]
    v_pk_fma_f32 v[230:231], v[230:231], v[214:215], v[222:223]
    v_pk_fma_f32 v[232:233], v[232:233], v[208:209], v[216:217]
    v_pk_fma_f32 v[234:235], v[234:235], v[210:211], v[218:219]
    v_pk_fma_f32 v[236:237], v[236:237], v[212:213], v[220:221]
    v_pk_fma_f32 v[238:239], v[238:239], v[214:215], v[222:223]
    v_cvt_pk_bf16_f32 v56, v224, v225
    v_cvt_pk_bf16_f32 v57, v226, v227
    v_cvt_pk_bf16_f32 v58, v228, v229
    v_cvt_pk_bf16_f32 v59, v230, v231
    v_cvt_pk_bf16_f32 v60, v232, v233
    v_cvt_pk_bf16_f32 v61, v234, v235
    v_cvt_pk_bf16_f32 v62, v236, v237
    v_cvt_pk_bf16_f32 v63, v238, v239
    v_accvgpr_write_b32 a4, v56
    v_accvgpr_write_b32 a5, v57
    v_accvgpr_write_b32 a6, v58
    v_accvgpr_write_b32 a7, v59
    v_accvgpr_write_b32 a76, v60
    v_accvgpr_write_b32 a77, v61
    v_accvgpr_write_b32 a78, v62
    v_accvgpr_write_b32 a79, v63
    s_mov_b32 s59, 12288
    buffer_load_dwordx4 v[144:147], v252, s[24:27], s59 offen offset:0
    s_mov_b32 s59, 28672
    buffer_load_dwordx4 v[148:151], v252, s[24:27], s59 offen offset:2048
    ds_read_b128 v[208:211], v253 offset:768
    ds_read_b128 v[212:215], v253 offset:784
    ds_read_b128 v[216:219], v253 offset:800
    ds_read_b128 v[220:223], v253 offset:816
    s_waitcnt vmcnt(20) lgkmcnt(4)
    v_lshlrev_b32 v224, 16, v64
    v_and_b32 v225, s53, v64
    v_lshlrev_b32 v226, 16, v65
    v_and_b32 v227, s53, v65
    v_lshlrev_b32 v228, 16, v66
    v_and_b32 v229, s53, v66
    v_lshlrev_b32 v230, 16, v67
    v_and_b32 v231, s53, v67
    v_lshlrev_b32 v232, 16, v68
    v_and_b32 v233, s53, v68
    v_lshlrev_b32 v234, 16, v69
    v_and_b32 v235, s53, v69
    v_lshlrev_b32 v236, 16, v70
    v_and_b32 v237, s53, v70
    v_lshlrev_b32 v238, 16, v71
    v_and_b32 v239, s53, v71
    v_pk_fma_f32 v[224:225], v[224:225], v[192:193], v[200:201]
    v_pk_fma_f32 v[226:227], v[226:227], v[194:195], v[202:203]
    v_pk_fma_f32 v[228:229], v[228:229], v[196:197], v[204:205]
    v_pk_fma_f32 v[230:231], v[230:231], v[198:199], v[206:207]
    v_pk_fma_f32 v[232:233], v[232:233], v[192:193], v[200:201]
    v_pk_fma_f32 v[234:235], v[234:235], v[194:195], v[202:203]
    v_pk_fma_f32 v[236:237], v[236:237], v[196:197], v[204:205]
    v_pk_fma_f32 v[238:239], v[238:239], v[198:199], v[206:207]
    v_cvt_pk_bf16_f32 v64, v224, v225
    v_cvt_pk_bf16_f32 v65, v226, v227
    v_cvt_pk_bf16_f32 v66, v228, v229
    v_cvt_pk_bf16_f32 v67, v230, v231
    v_cvt_pk_bf16_f32 v68, v232, v233
    v_cvt_pk_bf16_f32 v69, v234, v235
    v_cvt_pk_bf16_f32 v70, v236, v237
    v_cvt_pk_bf16_f32 v71, v238, v239
    v_accvgpr_write_b32 a8, v64
    v_accvgpr_write_b32 a9, v65
    v_accvgpr_write_b32 a10, v66
    v_accvgpr_write_b32 a11, v67
    v_accvgpr_write_b32 a80, v68
    v_accvgpr_write_b32 a81, v69
    v_accvgpr_write_b32 a82, v70
    v_accvgpr_write_b32 a83, v71
    s_mov_b32 s59, 12288
    buffer_load_dwordx4 v[152:155], v252, s[24:27], s59 offen offset:1024
    s_mov_b32 s59, 28672
    buffer_load_dwordx4 v[156:159], v252, s[24:27], s59 offen offset:3072
    ds_read_b128 v[192:195], v253 offset:1024
    ds_read_b128 v[196:199], v253 offset:1040
    ds_read_b128 v[200:203], v253 offset:1056
    ds_read_b128 v[204:207], v253 offset:1072
    s_waitcnt vmcnt(20) lgkmcnt(4)
    v_lshlrev_b32 v224, 16, v72
    v_and_b32 v225, s53, v72
    v_lshlrev_b32 v226, 16, v73
    v_and_b32 v227, s53, v73
    v_lshlrev_b32 v228, 16, v74
    v_and_b32 v229, s53, v74
    v_lshlrev_b32 v230, 16, v75
    v_and_b32 v231, s53, v75
    v_lshlrev_b32 v232, 16, v76
    v_and_b32 v233, s53, v76
    v_lshlrev_b32 v234, 16, v77
    v_and_b32 v235, s53, v77
    v_lshlrev_b32 v236, 16, v78
    v_and_b32 v237, s53, v78
    v_lshlrev_b32 v238, 16, v79
    v_and_b32 v239, s53, v79
    v_pk_fma_f32 v[224:225], v[224:225], v[208:209], v[216:217]
    v_pk_fma_f32 v[226:227], v[226:227], v[210:211], v[218:219]
    v_pk_fma_f32 v[228:229], v[228:229], v[212:213], v[220:221]
    v_pk_fma_f32 v[230:231], v[230:231], v[214:215], v[222:223]
    v_pk_fma_f32 v[232:233], v[232:233], v[208:209], v[216:217]
    v_pk_fma_f32 v[234:235], v[234:235], v[210:211], v[218:219]
    v_pk_fma_f32 v[236:237], v[236:237], v[212:213], v[220:221]
    v_pk_fma_f32 v[238:239], v[238:239], v[214:215], v[222:223]
    v_cvt_pk_bf16_f32 v72, v224, v225
    v_cvt_pk_bf16_f32 v73, v226, v227
    v_cvt_pk_bf16_f32 v74, v228, v229
    v_cvt_pk_bf16_f32 v75, v230, v231
    v_cvt_pk_bf16_f32 v76, v232, v233
    v_cvt_pk_bf16_f32 v77, v234, v235
    v_cvt_pk_bf16_f32 v78, v236, v237
    v_cvt_pk_bf16_f32 v79, v238, v239
    v_accvgpr_write_b32 a12, v72
    v_accvgpr_write_b32 a13, v73
    v_accvgpr_write_b32 a14, v74
    v_accvgpr_write_b32 a15, v75
    v_accvgpr_write_b32 a84, v76
    v_accvgpr_write_b32 a85, v77
    v_accvgpr_write_b32 a86, v78
    v_accvgpr_write_b32 a87, v79
    s_mov_b32 s59, 12288
    buffer_load_dwordx4 v[160:163], v252, s[24:27], s59 offen offset:2048
    s_mov_b32 s59, 32768
    buffer_load_dwordx4 v[164:167], v252, s[24:27], s59 offen offset:0
    ds_read_b128 v[208:211], v253 offset:1280
    ds_read_b128 v[212:215], v253 offset:1296
    ds_read_b128 v[216:219], v253 offset:1312
    ds_read_b128 v[220:223], v253 offset:1328
    s_waitcnt vmcnt(20) lgkmcnt(4)
    v_lshlrev_b32 v224, 16, v80
    v_and_b32 v225, s53, v80
    v_lshlrev_b32 v226, 16, v81
    v_and_b32 v227, s53, v81
    v_lshlrev_b32 v228, 16, v82
    v_and_b32 v229, s53, v82
    v_lshlrev_b32 v230, 16, v83
    v_and_b32 v231, s53, v83
    v_lshlrev_b32 v232, 16, v84
    v_and_b32 v233, s53, v84
    v_lshlrev_b32 v234, 16, v85
    v_and_b32 v235, s53, v85
    v_lshlrev_b32 v236, 16, v86
    v_and_b32 v237, s53, v86
    v_lshlrev_b32 v238, 16, v87
    v_and_b32 v239, s53, v87
    v_pk_fma_f32 v[224:225], v[224:225], v[192:193], v[200:201]
    v_pk_fma_f32 v[226:227], v[226:227], v[194:195], v[202:203]
    v_pk_fma_f32 v[228:229], v[228:229], v[196:197], v[204:205]
    v_pk_fma_f32 v[230:231], v[230:231], v[198:199], v[206:207]
    v_pk_fma_f32 v[232:233], v[232:233], v[192:193], v[200:201]
    v_pk_fma_f32 v[234:235], v[234:235], v[194:195], v[202:203]
    v_pk_fma_f32 v[236:237], v[236:237], v[196:197], v[204:205]
    v_pk_fma_f32 v[238:239], v[238:239], v[198:199], v[206:207]
    v_cvt_pk_bf16_f32 v80, v224, v225
    v_cvt_pk_bf16_f32 v81, v226, v227
    v_cvt_pk_bf16_f32 v82, v228, v229
    v_cvt_pk_bf16_f32 v83, v230, v231
    v_cvt_pk_bf16_f32 v84, v232, v233
    v_cvt_pk_bf16_f32 v85, v234, v235
    v_cvt_pk_bf16_f32 v86, v236, v237
    v_cvt_pk_bf16_f32 v87, v238, v239
    v_accvgpr_write_b32 a16, v80
    v_accvgpr_write_b32 a17, v81
    v_accvgpr_write_b32 a18, v82
    v_accvgpr_write_b32 a19, v83
    v_accvgpr_write_b32 a88, v84
    v_accvgpr_write_b32 a89, v85
    v_accvgpr_write_b32 a90, v86
    v_accvgpr_write_b32 a91, v87
    s_mov_b32 s59, 12288
    buffer_load_dwordx4 v[168:171], v252, s[24:27], s59 offen offset:3072
    s_mov_b32 s59, 32768
    buffer_load_dwordx4 v[172:175], v252, s[24:27], s59 offen offset:1024
    ds_read_b128 v[192:195], v253 offset:1536
    ds_read_b128 v[196:199], v253 offset:1552
    ds_read_b128 v[200:203], v253 offset:1568
    ds_read_b128 v[204:207], v253 offset:1584
    s_waitcnt vmcnt(20) lgkmcnt(4)
    v_lshlrev_b32 v224, 16, v88
    v_and_b32 v225, s53, v88
    v_lshlrev_b32 v226, 16, v89
    v_and_b32 v227, s53, v89
    v_lshlrev_b32 v228, 16, v90
    v_and_b32 v229, s53, v90
    v_lshlrev_b32 v230, 16, v91
    v_and_b32 v231, s53, v91
    v_lshlrev_b32 v232, 16, v92
    v_and_b32 v233, s53, v92
    v_lshlrev_b32 v234, 16, v93
    v_and_b32 v235, s53, v93
    v_lshlrev_b32 v236, 16, v94
    v_and_b32 v237, s53, v94
    v_lshlrev_b32 v238, 16, v95
    v_and_b32 v239, s53, v95
    v_pk_fma_f32 v[224:225], v[224:225], v[208:209], v[216:217]
    v_pk_fma_f32 v[226:227], v[226:227], v[210:211], v[218:219]
    v_pk_fma_f32 v[228:229], v[228:229], v[212:213], v[220:221]
    v_pk_fma_f32 v[230:231], v[230:231], v[214:215], v[222:223]
    v_pk_fma_f32 v[232:233], v[232:233], v[208:209], v[216:217]
    v_pk_fma_f32 v[234:235], v[234:235], v[210:211], v[218:219]
    v_pk_fma_f32 v[236:237], v[236:237], v[212:213], v[220:221]
    v_pk_fma_f32 v[238:239], v[238:239], v[214:215], v[222:223]
    v_cvt_pk_bf16_f32 v88, v224, v225
    v_cvt_pk_bf16_f32 v89, v226, v227
    v_cvt_pk_bf16_f32 v90, v228, v229
    v_cvt_pk_bf16_f32 v91, v230, v231
    v_cvt_pk_bf16_f32 v92, v232, v233
    v_cvt_pk_bf16_f32 v93, v234, v235
    v_cvt_pk_bf16_f32 v94, v236, v237
    v_cvt_pk_bf16_f32 v95, v238, v239
    v_accvgpr_write_b32 a20, v88
    v_accvgpr_write_b32 a21, v89
    v_accvgpr_write_b32 a22, v90
    v_accvgpr_write_b32 a23, v91
    v_accvgpr_write_b32 a92, v92
    v_accvgpr_write_b32 a93, v93
    v_accvgpr_write_b32 a94, v94
    v_accvgpr_write_b32 a95, v95
    s_mov_b32 s59, 16384
    buffer_load_dwordx4 v[176:179], v252, s[24:27], s59 offen offset:0
    s_mov_b32 s59, 32768
    buffer_load_dwordx4 v[180:183], v252, s[24:27], s59 offen offset:2048
    ds_read_b128 v[208:211], v253 offset:1792
    ds_read_b128 v[212:215], v253 offset:1808
    ds_read_b128 v[216:219], v253 offset:1824
    ds_read_b128 v[220:223], v253 offset:1840
    s_waitcnt vmcnt(20) lgkmcnt(4)
    v_lshlrev_b32 v224, 16, v96
    v_and_b32 v225, s53, v96
    v_lshlrev_b32 v226, 16, v97
    v_and_b32 v227, s53, v97
    v_lshlrev_b32 v228, 16, v98
    v_and_b32 v229, s53, v98
    v_lshlrev_b32 v230, 16, v99
    v_and_b32 v231, s53, v99
    v_lshlrev_b32 v232, 16, v100
    v_and_b32 v233, s53, v100
    v_lshlrev_b32 v234, 16, v101
    v_and_b32 v235, s53, v101
    v_lshlrev_b32 v236, 16, v102
    v_and_b32 v237, s53, v102
    v_lshlrev_b32 v238, 16, v103
    v_and_b32 v239, s53, v103
    v_pk_fma_f32 v[224:225], v[224:225], v[192:193], v[200:201]
    v_pk_fma_f32 v[226:227], v[226:227], v[194:195], v[202:203]
    v_pk_fma_f32 v[228:229], v[228:229], v[196:197], v[204:205]
    v_pk_fma_f32 v[230:231], v[230:231], v[198:199], v[206:207]
    v_pk_fma_f32 v[232:233], v[232:233], v[192:193], v[200:201]
    v_pk_fma_f32 v[234:235], v[234:235], v[194:195], v[202:203]
    v_pk_fma_f32 v[236:237], v[236:237], v[196:197], v[204:205]
    v_pk_fma_f32 v[238:239], v[238:239], v[198:199], v[206:207]
    v_cvt_pk_bf16_f32 v96, v224, v225
    v_cvt_pk_bf16_f32 v97, v226, v227
    v_cvt_pk_bf16_f32 v98, v228, v229
    v_cvt_pk_bf16_f32 v99, v230, v231
    v_cvt_pk_bf16_f32 v100, v232, v233
    v_cvt_pk_bf16_f32 v101, v234, v235
    v_cvt_pk_bf16_f32 v102, v236, v237
    v_cvt_pk_bf16_f32 v103, v238, v239
    v_accvgpr_write_b32 a24, v96
    v_accvgpr_write_b32 a25, v97
    v_accvgpr_write_b32 a26, v98
    v_accvgpr_write_b32 a27, v99
    v_accvgpr_write_b32 a96, v100
    v_accvgpr_write_b32 a97, v101
    v_accvgpr_write_b32 a98, v102
    v_accvgpr_write_b32 a99, v103
    s_mov_b32 s59, 16384
    buffer_load_dwordx4 v[184:187], v252, s[24:27], s59 offen offset:1024
    s_mov_b32 s59, 32768
    buffer_load_dwordx4 v[188:191], v252, s[24:27], s59 offen offset:3072
    ds_read_b128 v[192:195], v253 offset:2048
    ds_read_b128 v[196:199], v253 offset:2064
    ds_read_b128 v[200:203], v253 offset:2080
    ds_read_b128 v[204:207], v253 offset:2096
    s_waitcnt vmcnt(20) lgkmcnt(4)
    v_lshlrev_b32 v224, 16, v104
    v_and_b32 v225, s53, v104
    v_lshlrev_b32 v226, 16, v105
    v_and_b32 v227, s53, v105
    v_lshlrev_b32 v228, 16, v106
    v_and_b32 v229, s53, v106
    v_lshlrev_b32 v230, 16, v107
    v_and_b32 v231, s53, v107
    v_lshlrev_b32 v232, 16, v108
    v_and_b32 v233, s53, v108
    v_lshlrev_b32 v234, 16, v109
    v_and_b32 v235, s53, v109
    v_lshlrev_b32 v236, 16, v110
    v_and_b32 v237, s53, v110
    v_lshlrev_b32 v238, 16, v111
    v_and_b32 v239, s53, v111
    v_pk_fma_f32 v[224:225], v[224:225], v[208:209], v[216:217]
    v_pk_fma_f32 v[226:227], v[226:227], v[210:211], v[218:219]
    v_pk_fma_f32 v[228:229], v[228:229], v[212:213], v[220:221]
    v_pk_fma_f32 v[230:231], v[230:231], v[214:215], v[222:223]
    v_pk_fma_f32 v[232:233], v[232:233], v[208:209], v[216:217]
    v_pk_fma_f32 v[234:235], v[234:235], v[210:211], v[218:219]
    v_pk_fma_f32 v[236:237], v[236:237], v[212:213], v[220:221]
    v_pk_fma_f32 v[238:239], v[238:239], v[214:215], v[222:223]
    v_cvt_pk_bf16_f32 v104, v224, v225
    v_cvt_pk_bf16_f32 v105, v226, v227
    v_cvt_pk_bf16_f32 v106, v228, v229
    v_cvt_pk_bf16_f32 v107, v230, v231
    v_cvt_pk_bf16_f32 v108, v232, v233
    v_cvt_pk_bf16_f32 v109, v234, v235
    v_cvt_pk_bf16_f32 v110, v236, v237
    v_cvt_pk_bf16_f32 v111, v238, v239
    v_accvgpr_write_b32 a28, v104
    v_accvgpr_write_b32 a29, v105
    v_accvgpr_write_b32 a30, v106
    v_accvgpr_write_b32 a31, v107
    v_accvgpr_write_b32 a100, v108
    v_accvgpr_write_b32 a101, v109
    v_accvgpr_write_b32 a102, v110
    v_accvgpr_write_b32 a103, v111
    s_add_u32 m0, s47, 0
    s_mov_b32 s50, 0
    buffer_load_dwordx4 v240, s[16:19], s50 offen offset:0 lds
    buffer_load_dwordx4 v241, s[16:19], s50 offen offset:1024 lds
    buffer_load_dwordx4 v242, s[16:19], s50 offen offset:2048 lds
    buffer_load_dwordx4 v243, s[16:19], s50 offen offset:3072 lds
    ds_read_b128 v[208:211], v253 offset:2304
    ds_read_b128 v[212:215], v253 offset:2320
    ds_read_b128 v[216:219], v253 offset:2336
    ds_read_b128 v[220:223], v253 offset:2352
    s_waitcnt vmcnt(22) lgkmcnt(4)
    v_lshlrev_b32 v224, 16, v112
    v_and_b32 v225, s53, v112
    v_lshlrev_b32 v226, 16, v113
    v_and_b32 v227, s53, v113
    v_lshlrev_b32 v228, 16, v114
    v_and_b32 v229, s53, v114
    v_lshlrev_b32 v230, 16, v115
    v_and_b32 v231, s53, v115
    v_lshlrev_b32 v232, 16, v116
    v_and_b32 v233, s53, v116
    v_lshlrev_b32 v234, 16, v117
    v_and_b32 v235, s53, v117
    v_lshlrev_b32 v236, 16, v118
    v_and_b32 v237, s53, v118
    v_lshlrev_b32 v238, 16, v119
    v_and_b32 v239, s53, v119
    v_pk_fma_f32 v[224:225], v[224:225], v[192:193], v[200:201]
    v_pk_fma_f32 v[226:227], v[226:227], v[194:195], v[202:203]
    v_pk_fma_f32 v[228:229], v[228:229], v[196:197], v[204:205]
    v_pk_fma_f32 v[230:231], v[230:231], v[198:199], v[206:207]
    v_pk_fma_f32 v[232:233], v[232:233], v[192:193], v[200:201]
    v_pk_fma_f32 v[234:235], v[234:235], v[194:195], v[202:203]
    v_pk_fma_f32 v[236:237], v[236:237], v[196:197], v[204:205]
    v_pk_fma_f32 v[238:239], v[238:239], v[198:199], v[206:207]
    v_cvt_pk_bf16_f32 v112, v224, v225
    v_cvt_pk_bf16_f32 v113, v226, v227
    v_cvt_pk_bf16_f32 v114, v228, v229
    v_cvt_pk_bf16_f32 v115, v230, v231
    v_cvt_pk_bf16_f32 v116, v232, v233
    v_cvt_pk_bf16_f32 v117, v234, v235
    v_cvt_pk_bf16_f32 v118, v236, v237
    v_cvt_pk_bf16_f32 v119, v238, v239
    v_accvgpr_write_b32 a32, v112
    v_accvgpr_write_b32 a33, v113
    v_accvgpr_write_b32 a34, v114
    v_accvgpr_write_b32 a35, v115
    v_accvgpr_write_b32 a104, v116
    v_accvgpr_write_b32 a105, v117
    v_accvgpr_write_b32 a106, v118
    v_accvgpr_write_b32 a107, v119
    s_add_u32 m0, s47, 65536
    s_mov_b32 s50, 256
    buffer_load_dwordx4 v240, s[16:19], s50 offen offset:0 lds
    buffer_load_dwordx4 v241, s[16:19], s50 offen offset:1024 lds
    buffer_load_dwordx4 v242, s[16:19], s50 offen offset:2048 lds
    buffer_load_dwordx4 v243, s[16:19], s50 offen offset:3072 lds
    ds_read_b128 v[192:195], v253 offset:2560
    ds_read_b128 v[196:199], v253 offset:2576
    ds_read_b128 v[200:203], v253 offset:2592
    ds_read_b128 v[204:207], v253 offset:2608
    s_waitcnt vmcnt(24) lgkmcnt(4)
    v_lshlrev_b32 v224, 16, v120
    v_and_b32 v225, s53, v120
    v_lshlrev_b32 v226, 16, v121
    v_and_b32 v227, s53, v121
    v_lshlrev_b32 v228, 16, v122
    v_and_b32 v229, s53, v122
    v_lshlrev_b32 v230, 16, v123
    v_and_b32 v231, s53, v123
    v_lshlrev_b32 v232, 16, v124
    v_and_b32 v233, s53, v124
    v_lshlrev_b32 v234, 16, v125
    v_and_b32 v235, s53, v125
    v_lshlrev_b32 v236, 16, v126
    v_and_b32 v237, s53, v126
    v_lshlrev_b32 v238, 16, v127
    v_and_b32 v239, s53, v127
    v_pk_fma_f32 v[224:225], v[224:225], v[208:209], v[216:217]
    v_pk_fma_f32 v[226:227], v[226:227], v[210:211], v[218:219]
    v_pk_fma_f32 v[228:229], v[228:229], v[212:213], v[220:221]
    v_pk_fma_f32 v[230:231], v[230:231], v[214:215], v[222:223]
    v_pk_fma_f32 v[232:233], v[232:233], v[208:209], v[216:217]
    v_pk_fma_f32 v[234:235], v[234:235], v[210:211], v[218:219]
    v_pk_fma_f32 v[236:237], v[236:237], v[212:213], v[220:221]
    v_pk_fma_f32 v[238:239], v[238:239], v[214:215], v[222:223]
    v_cvt_pk_bf16_f32 v120, v224, v225
    v_cvt_pk_bf16_f32 v121, v226, v227
    v_cvt_pk_bf16_f32 v122, v228, v229
    v_cvt_pk_bf16_f32 v123, v230, v231
    v_cvt_pk_bf16_f32 v124, v232, v233
    v_cvt_pk_bf16_f32 v125, v234, v235
    v_cvt_pk_bf16_f32 v126, v236, v237
    v_cvt_pk_bf16_f32 v127, v238, v239
    v_accvgpr_write_b32 a36, v120
    v_accvgpr_write_b32 a37, v121
    v_accvgpr_write_b32 a38, v122
    v_accvgpr_write_b32 a39, v123
    v_accvgpr_write_b32 a108, v124
    v_accvgpr_write_b32 a109, v125
    v_accvgpr_write_b32 a110, v126
    v_accvgpr_write_b32 a111, v127
    s_add_u32 m0, s47, 16384
    s_mov_b32 s50, 524288
    buffer_load_dwordx4 v240, s[16:19], s50 offen offset:0 lds
    buffer_load_dwordx4 v241, s[16:19], s50 offen offset:1024 lds
    buffer_load_dwordx4 v242, s[16:19], s50 offen offset:2048 lds
    buffer_load_dwordx4 v243, s[16:19], s50 offen offset:3072 lds
    ds_read_b128 v[208:211], v253 offset:2816
    ds_read_b128 v[212:215], v253 offset:2832
    ds_read_b128 v[216:219], v253 offset:2848
    ds_read_b128 v[220:223], v253 offset:2864
    s_waitcnt vmcnt(26) lgkmcnt(4)
    v_lshlrev_b32 v224, 16, v128
    v_and_b32 v225, s53, v128
    v_lshlrev_b32 v226, 16, v129
    v_and_b32 v227, s53, v129
    v_lshlrev_b32 v228, 16, v130
    v_and_b32 v229, s53, v130
    v_lshlrev_b32 v230, 16, v131
    v_and_b32 v231, s53, v131
    v_lshlrev_b32 v232, 16, v132
    v_and_b32 v233, s53, v132
    v_lshlrev_b32 v234, 16, v133
    v_and_b32 v235, s53, v133
    v_lshlrev_b32 v236, 16, v134
    v_and_b32 v237, s53, v134
    v_lshlrev_b32 v238, 16, v135
    v_and_b32 v239, s53, v135
    v_pk_fma_f32 v[224:225], v[224:225], v[192:193], v[200:201]
    v_pk_fma_f32 v[226:227], v[226:227], v[194:195], v[202:203]
    v_pk_fma_f32 v[228:229], v[228:229], v[196:197], v[204:205]
    v_pk_fma_f32 v[230:231], v[230:231], v[198:199], v[206:207]
    v_pk_fma_f32 v[232:233], v[232:233], v[192:193], v[200:201]
    v_pk_fma_f32 v[234:235], v[234:235], v[194:195], v[202:203]
    v_pk_fma_f32 v[236:237], v[236:237], v[196:197], v[204:205]
    v_pk_fma_f32 v[238:239], v[238:239], v[198:199], v[206:207]
    v_cvt_pk_bf16_f32 v128, v224, v225
    v_cvt_pk_bf16_f32 v129, v226, v227
    v_cvt_pk_bf16_f32 v130, v228, v229
    v_cvt_pk_bf16_f32 v131, v230, v231
    v_cvt_pk_bf16_f32 v132, v232, v233
    v_cvt_pk_bf16_f32 v133, v234, v235
    v_cvt_pk_bf16_f32 v134, v236, v237
    v_cvt_pk_bf16_f32 v135, v238, v239
    v_accvgpr_write_b32 a40, v128
    v_accvgpr_write_b32 a41, v129
    v_accvgpr_write_b32 a42, v130
    v_accvgpr_write_b32 a43, v131
    v_accvgpr_write_b32 a112, v132
    v_accvgpr_write_b32 a113, v133
    v_accvgpr_write_b32 a114, v134
    v_accvgpr_write_b32 a115, v135
    s_add_u32 m0, s47, 81920
    s_mov_b32 s50, 524544
    buffer_load_dwordx4 v240, s[16:19], s50 offen offset:0 lds
    buffer_load_dwordx4 v241, s[16:19], s50 offen offset:1024 lds
    buffer_load_dwordx4 v242, s[16:19], s50 offen offset:2048 lds
    buffer_load_dwordx4 v243, s[16:19], s50 offen offset:3072 lds
    ds_read_b128 v[192:195], v253 offset:3072
    ds_read_b128 v[196:199], v253 offset:3088
    ds_read_b128 v[200:203], v253 offset:3104
    ds_read_b128 v[204:207], v253 offset:3120
    s_waitcnt vmcnt(28) lgkmcnt(4)
    v_lshlrev_b32 v224, 16, v136
    v_and_b32 v225, s53, v136
    v_lshlrev_b32 v226, 16, v137
    v_and_b32 v227, s53, v137
    v_lshlrev_b32 v228, 16, v138
    v_and_b32 v229, s53, v138
    v_lshlrev_b32 v230, 16, v139
    v_and_b32 v231, s53, v139
    v_lshlrev_b32 v232, 16, v140
    v_and_b32 v233, s53, v140
    v_lshlrev_b32 v234, 16, v141
    v_and_b32 v235, s53, v141
    v_lshlrev_b32 v236, 16, v142
    v_and_b32 v237, s53, v142
    v_lshlrev_b32 v238, 16, v143
    v_and_b32 v239, s53, v143
    v_pk_fma_f32 v[224:225], v[224:225], v[208:209], v[216:217]
    v_pk_fma_f32 v[226:227], v[226:227], v[210:211], v[218:219]
    v_pk_fma_f32 v[228:229], v[228:229], v[212:213], v[220:221]
    v_pk_fma_f32 v[230:231], v[230:231], v[214:215], v[222:223]
    v_pk_fma_f32 v[232:233], v[232:233], v[208:209], v[216:217]
    v_pk_fma_f32 v[234:235], v[234:235], v[210:211], v[218:219]
    v_pk_fma_f32 v[236:237], v[236:237], v[212:213], v[220:221]
    v_pk_fma_f32 v[238:239], v[238:239], v[214:215], v[222:223]
    v_cvt_pk_bf16_f32 v136, v224, v225
    v_cvt_pk_bf16_f32 v137, v226, v227
    v_cvt_pk_bf16_f32 v138, v228, v229
    v_cvt_pk_bf16_f32 v139, v230, v231
    v_cvt_pk_bf16_f32 v140, v232, v233
    v_cvt_pk_bf16_f32 v141, v234, v235
    v_cvt_pk_bf16_f32 v142, v236, v237
    v_cvt_pk_bf16_f32 v143, v238, v239
    v_accvgpr_write_b32 a44, v136
    v_accvgpr_write_b32 a45, v137
    v_accvgpr_write_b32 a46, v138
    v_accvgpr_write_b32 a47, v139
    v_accvgpr_write_b32 a116, v140
    v_accvgpr_write_b32 a117, v141
    v_accvgpr_write_b32 a118, v142
    v_accvgpr_write_b32 a119, v143
    s_add_u32 m0, s47, 32768
    s_mov_b32 s50, 1048576
    buffer_load_dwordx4 v240, s[16:19], s50 offen offset:0 lds
    buffer_load_dwordx4 v241, s[16:19], s50 offen offset:1024 lds
    buffer_load_dwordx4 v242, s[16:19], s50 offen offset:2048 lds
    buffer_load_dwordx4 v243, s[16:19], s50 offen offset:3072 lds
    ds_read_b128 v[208:211], v253 offset:3328
    ds_read_b128 v[212:215], v253 offset:3344
    ds_read_b128 v[216:219], v253 offset:3360
    ds_read_b128 v[220:223], v253 offset:3376
    s_waitcnt vmcnt(30) lgkmcnt(4)
    v_lshlrev_b32 v224, 16, v144
    v_and_b32 v225, s53, v144
    v_lshlrev_b32 v226, 16, v145
    v_and_b32 v227, s53, v145
    v_lshlrev_b32 v228, 16, v146
    v_and_b32 v229, s53, v146
    v_lshlrev_b32 v230, 16, v147
    v_and_b32 v231, s53, v147
    v_lshlrev_b32 v232, 16, v148
    v_and_b32 v233, s53, v148
    v_lshlrev_b32 v234, 16, v149
    v_and_b32 v235, s53, v149
    v_lshlrev_b32 v236, 16, v150
    v_and_b32 v237, s53, v150
    v_lshlrev_b32 v238, 16, v151
    v_and_b32 v239, s53, v151
    v_pk_fma_f32 v[224:225], v[224:225], v[192:193], v[200:201]
    v_pk_fma_f32 v[226:227], v[226:227], v[194:195], v[202:203]
    v_pk_fma_f32 v[228:229], v[228:229], v[196:197], v[204:205]
    v_pk_fma_f32 v[230:231], v[230:231], v[198:199], v[206:207]
    v_pk_fma_f32 v[232:233], v[232:233], v[192:193], v[200:201]
    v_pk_fma_f32 v[234:235], v[234:235], v[194:195], v[202:203]
    v_pk_fma_f32 v[236:237], v[236:237], v[196:197], v[204:205]
    v_pk_fma_f32 v[238:239], v[238:239], v[198:199], v[206:207]
    v_cvt_pk_bf16_f32 v144, v224, v225
    v_cvt_pk_bf16_f32 v145, v226, v227
    v_cvt_pk_bf16_f32 v146, v228, v229
    v_cvt_pk_bf16_f32 v147, v230, v231
    v_cvt_pk_bf16_f32 v148, v232, v233
    v_cvt_pk_bf16_f32 v149, v234, v235
    v_cvt_pk_bf16_f32 v150, v236, v237
    v_cvt_pk_bf16_f32 v151, v238, v239
    v_accvgpr_write_b32 a48, v144
    v_accvgpr_write_b32 a49, v145
    v_accvgpr_write_b32 a50, v146
    v_accvgpr_write_b32 a51, v147
    v_accvgpr_write_b32 a120, v148
    v_accvgpr_write_b32 a121, v149
    v_accvgpr_write_b32 a122, v150
    v_accvgpr_write_b32 a123, v151
    s_add_u32 m0, s47, 98304
    s_mov_b32 s50, 1048832
    buffer_load_dwordx4 v240, s[16:19], s50 offen offset:0 lds
    buffer_load_dwordx4 v241, s[16:19], s50 offen offset:1024 lds
    buffer_load_dwordx4 v242, s[16:19], s50 offen offset:2048 lds
    buffer_load_dwordx4 v243, s[16:19], s50 offen offset:3072 lds
    ds_read_b128 v[192:195], v253 offset:3584
    ds_read_b128 v[196:199], v253 offset:3600
    ds_read_b128 v[200:203], v253 offset:3616
    ds_read_b128 v[204:207], v253 offset:3632
    s_waitcnt vmcnt(32) lgkmcnt(4)
    v_lshlrev_b32 v224, 16, v152
    v_and_b32 v225, s53, v152
    v_lshlrev_b32 v226, 16, v153
    v_and_b32 v227, s53, v153
    v_lshlrev_b32 v228, 16, v154
    v_and_b32 v229, s53, v154
    v_lshlrev_b32 v230, 16, v155
    v_and_b32 v231, s53, v155
    v_lshlrev_b32 v232, 16, v156
    v_and_b32 v233, s53, v156
    v_lshlrev_b32 v234, 16, v157
    v_and_b32 v235, s53, v157
    v_lshlrev_b32 v236, 16, v158
    v_and_b32 v237, s53, v158
    v_lshlrev_b32 v238, 16, v159
    v_and_b32 v239, s53, v159
    v_pk_fma_f32 v[224:225], v[224:225], v[208:209], v[216:217]
    v_pk_fma_f32 v[226:227], v[226:227], v[210:211], v[218:219]
    v_pk_fma_f32 v[228:229], v[228:229], v[212:213], v[220:221]
    v_pk_fma_f32 v[230:231], v[230:231], v[214:215], v[222:223]
    v_pk_fma_f32 v[232:233], v[232:233], v[208:209], v[216:217]
    v_pk_fma_f32 v[234:235], v[234:235], v[210:211], v[218:219]
    v_pk_fma_f32 v[236:237], v[236:237], v[212:213], v[220:221]
    v_pk_fma_f32 v[238:239], v[238:239], v[214:215], v[222:223]
    v_cvt_pk_bf16_f32 v152, v224, v225
    v_cvt_pk_bf16_f32 v153, v226, v227
    v_cvt_pk_bf16_f32 v154, v228, v229
    v_cvt_pk_bf16_f32 v155, v230, v231
    v_cvt_pk_bf16_f32 v156, v232, v233
    v_cvt_pk_bf16_f32 v157, v234, v235
    v_cvt_pk_bf16_f32 v158, v236, v237
    v_cvt_pk_bf16_f32 v159, v238, v239
    v_accvgpr_write_b32 a52, v152
    v_accvgpr_write_b32 a53, v153
    v_accvgpr_write_b32 a54, v154
    v_accvgpr_write_b32 a55, v155
    v_accvgpr_write_b32 a124, v156
    v_accvgpr_write_b32 a125, v157
    v_accvgpr_write_b32 a126, v158
    v_accvgpr_write_b32 a127, v159
    ds_read_b128 v[208:211], v253 offset:3840
    ds_read_b128 v[212:215], v253 offset:3856
    ds_read_b128 v[216:219], v253 offset:3872
    ds_read_b128 v[220:223], v253 offset:3888
    s_waitcnt vmcnt(30) lgkmcnt(4)
    v_lshlrev_b32 v224, 16, v160
    v_and_b32 v225, s53, v160
    v_lshlrev_b32 v226, 16, v161
    v_and_b32 v227, s53, v161
    v_lshlrev_b32 v228, 16, v162
    v_and_b32 v229, s53, v162
    v_lshlrev_b32 v230, 16, v163
    v_and_b32 v231, s53, v163
    v_lshlrev_b32 v232, 16, v164
    v_and_b32 v233, s53, v164
    v_lshlrev_b32 v234, 16, v165
    v_and_b32 v235, s53, v165
    v_lshlrev_b32 v236, 16, v166
    v_and_b32 v237, s53, v166
    v_lshlrev_b32 v238, 16, v167
    v_and_b32 v239, s53, v167
    v_pk_fma_f32 v[224:225], v[224:225], v[192:193], v[200:201]
    v_pk_fma_f32 v[226:227], v[226:227], v[194:195], v[202:203]
    v_pk_fma_f32 v[228:229], v[228:229], v[196:197], v[204:205]
    v_pk_fma_f32 v[230:231], v[230:231], v[198:199], v[206:207]
    v_pk_fma_f32 v[232:233], v[232:233], v[192:193], v[200:201]
    v_pk_fma_f32 v[234:235], v[234:235], v[194:195], v[202:203]
    v_pk_fma_f32 v[236:237], v[236:237], v[196:197], v[204:205]
    v_pk_fma_f32 v[238:239], v[238:239], v[198:199], v[206:207]
    v_cvt_pk_bf16_f32 v160, v224, v225
    v_cvt_pk_bf16_f32 v161, v226, v227
    v_cvt_pk_bf16_f32 v162, v228, v229
    v_cvt_pk_bf16_f32 v163, v230, v231
    v_cvt_pk_bf16_f32 v164, v232, v233
    v_cvt_pk_bf16_f32 v165, v234, v235
    v_cvt_pk_bf16_f32 v166, v236, v237
    v_cvt_pk_bf16_f32 v167, v238, v239
    v_accvgpr_write_b32 a56, v160
    v_accvgpr_write_b32 a57, v161
    v_accvgpr_write_b32 a58, v162
    v_accvgpr_write_b32 a59, v163
    v_accvgpr_write_b32 a192, v164
    v_accvgpr_write_b32 a193, v165
    v_accvgpr_write_b32 a194, v166
    v_accvgpr_write_b32 a195, v167
    ds_read_b128 v[192:195], v253 offset:4096
    ds_read_b128 v[196:199], v253 offset:4112
    ds_read_b128 v[200:203], v253 offset:4128
    ds_read_b128 v[204:207], v253 offset:4144
    s_waitcnt vmcnt(28) lgkmcnt(4)
    v_lshlrev_b32 v224, 16, v168
    v_and_b32 v225, s53, v168
    v_lshlrev_b32 v226, 16, v169
    v_and_b32 v227, s53, v169
    v_lshlrev_b32 v228, 16, v170
    v_and_b32 v229, s53, v170
    v_lshlrev_b32 v230, 16, v171
    v_and_b32 v231, s53, v171
    v_lshlrev_b32 v232, 16, v172
    v_and_b32 v233, s53, v172
    v_lshlrev_b32 v234, 16, v173
    v_and_b32 v235, s53, v173
    v_lshlrev_b32 v236, 16, v174
    v_and_b32 v237, s53, v174
    v_lshlrev_b32 v238, 16, v175
    v_and_b32 v239, s53, v175
    v_pk_fma_f32 v[224:225], v[224:225], v[208:209], v[216:217]
    v_pk_fma_f32 v[226:227], v[226:227], v[210:211], v[218:219]
    v_pk_fma_f32 v[228:229], v[228:229], v[212:213], v[220:221]
    v_pk_fma_f32 v[230:231], v[230:231], v[214:215], v[222:223]
    v_pk_fma_f32 v[232:233], v[232:233], v[208:209], v[216:217]
    v_pk_fma_f32 v[234:235], v[234:235], v[210:211], v[218:219]
    v_pk_fma_f32 v[236:237], v[236:237], v[212:213], v[220:221]
    v_pk_fma_f32 v[238:239], v[238:239], v[214:215], v[222:223]
    v_cvt_pk_bf16_f32 v168, v224, v225
    v_cvt_pk_bf16_f32 v169, v226, v227
    v_cvt_pk_bf16_f32 v170, v228, v229
    v_cvt_pk_bf16_f32 v171, v230, v231
    v_cvt_pk_bf16_f32 v172, v232, v233
    v_cvt_pk_bf16_f32 v173, v234, v235
    v_cvt_pk_bf16_f32 v174, v236, v237
    v_cvt_pk_bf16_f32 v175, v238, v239
    v_accvgpr_write_b32 a60, v168
    v_accvgpr_write_b32 a61, v169
    v_accvgpr_write_b32 a62, v170
    v_accvgpr_write_b32 a63, v171
    v_accvgpr_write_b32 a196, v172
    v_accvgpr_write_b32 a197, v173
    v_accvgpr_write_b32 a198, v174
    v_accvgpr_write_b32 a199, v175
    ds_read_b128 v[208:211], v253 offset:4352
    ds_read_b128 v[212:215], v253 offset:4368
    ds_read_b128 v[216:219], v253 offset:4384
    ds_read_b128 v[220:223], v253 offset:4400
    s_waitcnt vmcnt(26) lgkmcnt(4)
    v_lshlrev_b32 v224, 16, v176
    v_and_b32 v225, s53, v176
    v_lshlrev_b32 v226, 16, v177
    v_and_b32 v227, s53, v177
    v_lshlrev_b32 v228, 16, v178
    v_and_b32 v229, s53, v178
    v_lshlrev_b32 v230, 16, v179
    v_and_b32 v231, s53, v179
    v_lshlrev_b32 v232, 16, v180
    v_and_b32 v233, s53, v180
    v_lshlrev_b32 v234, 16, v181
    v_and_b32 v235, s53, v181
    v_lshlrev_b32 v236, 16, v182
    v_and_b32 v237, s53, v182
    v_lshlrev_b32 v238, 16, v183
    v_and_b32 v239, s53, v183
    v_pk_fma_f32 v[224:225], v[224:225], v[192:193], v[200:201]
    v_pk_fma_f32 v[226:227], v[226:227], v[194:195], v[202:203]
    v_pk_fma_f32 v[228:229], v[228:229], v[196:197], v[204:205]
    v_pk_fma_f32 v[230:231], v[230:231], v[198:199], v[206:207]
    v_pk_fma_f32 v[232:233], v[232:233], v[192:193], v[200:201]
    v_pk_fma_f32 v[234:235], v[234:235], v[194:195], v[202:203]
    v_pk_fma_f32 v[236:237], v[236:237], v[196:197], v[204:205]
    v_pk_fma_f32 v[238:239], v[238:239], v[198:199], v[206:207]
    v_cvt_pk_bf16_f32 v176, v224, v225
    v_cvt_pk_bf16_f32 v177, v226, v227
    v_cvt_pk_bf16_f32 v178, v228, v229
    v_cvt_pk_bf16_f32 v179, v230, v231
    v_cvt_pk_bf16_f32 v180, v232, v233
    v_cvt_pk_bf16_f32 v181, v234, v235
    v_cvt_pk_bf16_f32 v182, v236, v237
    v_cvt_pk_bf16_f32 v183, v238, v239
    v_accvgpr_write_b32 a64, v176
    v_accvgpr_write_b32 a65, v177
    v_accvgpr_write_b32 a66, v178
    v_accvgpr_write_b32 a67, v179
    v_accvgpr_write_b32 a200, v180
    v_accvgpr_write_b32 a201, v181
    v_accvgpr_write_b32 a202, v182
    v_accvgpr_write_b32 a203, v183
    s_waitcnt vmcnt(24) lgkmcnt(0)
    v_lshlrev_b32 v224, 16, v184
    v_and_b32 v225, s53, v184
    v_lshlrev_b32 v226, 16, v185
    v_and_b32 v227, s53, v185
    v_lshlrev_b32 v228, 16, v186
    v_and_b32 v229, s53, v186
    v_lshlrev_b32 v230, 16, v187
    v_and_b32 v231, s53, v187
    v_lshlrev_b32 v232, 16, v188
    v_and_b32 v233, s53, v188
    v_lshlrev_b32 v234, 16, v189
    v_and_b32 v235, s53, v189
    v_lshlrev_b32 v236, 16, v190
    v_and_b32 v237, s53, v190
    v_lshlrev_b32 v238, 16, v191
    v_and_b32 v239, s53, v191
    v_pk_fma_f32 v[224:225], v[224:225], v[208:209], v[216:217]
    v_pk_fma_f32 v[226:227], v[226:227], v[210:211], v[218:219]
    v_pk_fma_f32 v[228:229], v[228:229], v[212:213], v[220:221]
    v_pk_fma_f32 v[230:231], v[230:231], v[214:215], v[222:223]
    v_pk_fma_f32 v[232:233], v[232:233], v[208:209], v[216:217]
    v_pk_fma_f32 v[234:235], v[234:235], v[210:211], v[218:219]
    v_pk_fma_f32 v[236:237], v[236:237], v[212:213], v[220:221]
    v_pk_fma_f32 v[238:239], v[238:239], v[214:215], v[222:223]
    v_cvt_pk_bf16_f32 v184, v224, v225
    v_cvt_pk_bf16_f32 v185, v226, v227
    v_cvt_pk_bf16_f32 v186, v228, v229
    v_cvt_pk_bf16_f32 v187, v230, v231
    v_cvt_pk_bf16_f32 v188, v232, v233
    v_cvt_pk_bf16_f32 v189, v234, v235
    v_cvt_pk_bf16_f32 v190, v236, v237
    v_cvt_pk_bf16_f32 v191, v238, v239
    v_accvgpr_write_b32 a68, v184
    v_accvgpr_write_b32 a69, v185
    v_accvgpr_write_b32 a70, v186
    v_accvgpr_write_b32 a71, v187
    v_accvgpr_write_b32 a204, v188
    v_accvgpr_write_b32 a205, v189
    v_accvgpr_write_b32 a206, v190
    v_accvgpr_write_b32 a207, v191
    s_getpc_b64 s[60:61]
    s_lshr_b32 s62, s2, 3
    s_lshl_b32 s62, s62, 2
    s_add_u32 s62, s62, s46
    s_mul_i32 s63, s62, 13108
    s_lshr_b32 s63, s63, 16
    s_mul_i32 s63, s63, 5
    s_sub_u32 s62, s62, s63
    s_lshl_b32 s62, s62, 13
    v_lshlrev_b32 v255, 7, v2
    v_add_u32 v255, s62, v255
    s_waitcnt vmcnt(16)
    s_barrier
    ds_read_b64_tr_b16 a[128:129], v244 offset:0
    ds_read_b64_tr_b16 a[130:131], v244 offset:4096
    ds_read_b64_tr_b16 a[132:133], v245 offset:0
    ds_read_b64_tr_b16 a[134:135], v245 offset:4096
    ds_read_b64_tr_b16 a[136:137], v246 offset:0
    ds_read_b64_tr_b16 a[138:139], v246 offset:4096
    ds_read_b64_tr_b16 a[140:141], v247 offset:0
    ds_read_b64_tr_b16 a[142:143], v247 offset:4096
    ds_read_b64_tr_b16 a[144:145], v248 offset:0
    ds_read_b64_tr_b16 a[146:147], v248 offset:4096
    ds_read_b64_tr_b16 a[148:149], v249 offset:0
    ds_read_b64_tr_b16 a[150:151], v249 offset:4096
    ds_read_b64_tr_b16 a[152:153], v250 offset:0
    ds_read_b64_tr_b16 a[154:155], v250 offset:4096
    ds_read_b64_tr_b16 a[156:157], v251 offset:0
    ds_read_b64_tr_b16 a[158:159], v251 offset:4096
    ds_read_b64_tr_b16 a[160:161], v12 offset:0
    ds_read_b64_tr_b16 a[162:163], v12 offset:4096
    ds_read_b64_tr_b16 a[164:165], v13 offset:0
    ds_read_b64_tr_b16 a[166:167], v13 offset:4096
    ds_read_b64_tr_b16 a[168:169], v14 offset:0
    ds_read_b64_tr_b16 a[170:171], v14 offset:4096
    ds_read_b64_tr_b16 a[172:173], v15 offset:0
    ds_read_b64_tr_b16 a[174:175], v15 offset:4096
    s_nop 1
    s_waitcnt lgkmcnt(15)
    v_mfma_f32_16x16x32_bf16 v[48:51], a[128:131], a[0:3], 0
    ds_read_b64_tr_b16 a[176:177], v16 offset:0
    v_mfma_f32_16x16x32_bf16 v[52:55], a[128:131], a[72:75], 0
    s_add_u32 m0, s47, 49152
    ds_read_b64_tr_b16 a[178:179], v16 offset:4096
    v_mfma_f32_16x16x32_bf16 v[56:59], a[132:135], a[0:3], 0
    ds_read_b64_tr_b16 a[180:181], v17 offset:0
    s_mov_b32 s50, 1572864
    v_mfma_f32_16x16x32_bf16 v[60:63], a[132:135], a[72:75], 0
    buffer_load_dwordx4 v240, s[16:19], s50 offen offset:0 lds
    ds_read_b64_tr_b16 a[182:183], v17 offset:4096
    v_mfma_f32_16x16x32_bf16 v[64:67], a[136:139], a[0:3], 0
    ds_read_b64_tr_b16 a[184:185], v18 offset:0
    ds_read_b64_tr_b16 a[186:187], v18 offset:4096
    v_mfma_f32_16x16x32_bf16 v[68:71], a[136:139], a[72:75], 0
    buffer_load_dwordx4 v241, s[16:19], s50 offen offset:1024 lds
    v_mfma_f32_16x16x32_bf16 v[72:75], a[140:143], a[0:3], 0
    ds_read_b64_tr_b16 a[188:189], v19 offset:0
    ds_read_b64_tr_b16 a[190:191], v19 offset:4096
    v_mfma_f32_16x16x32_bf16 v[76:79], a[140:143], a[72:75], 0
    buffer_load_dwordx4 v242, s[16:19], s50 offen offset:2048 lds
    s_waitcnt lgkmcnt(15)
    v_mfma_f32_16x16x32_bf16 v[80:83], a[144:147], a[0:3], 0
    ds_read_b64_tr_b16 a[128:129], v244 offset:8192
    ds_read_b64_tr_b16 a[130:131], v244 offset:12288
    v_mfma_f32_16x16x32_bf16 v[84:87], a[144:147], a[72:75], 0
    buffer_load_dwordx4 v243, s[16:19], s50 offen offset:3072 lds
    s_add_u32 m0, s47, 114688
    v_mfma_f32_16x16x32_bf16 v[88:91], a[148:151], a[0:3], 0
    ds_read_b64_tr_b16 a[132:133], v245 offset:8192
    s_mov_b32 s50, 1573120
    v_mfma_f32_16x16x32_bf16 v[92:95], a[148:151], a[72:75], 0
    buffer_load_dwordx4 v240, s[16:19], s50 offen offset:0 lds
    ds_read_b64_tr_b16 a[134:135], v245 offset:12288
    v_mfma_f32_16x16x32_bf16 v[96:99], a[152:155], a[0:3], 0
    ds_read_b64_tr_b16 a[136:137], v246 offset:8192
    ds_read_b64_tr_b16 a[138:139], v246 offset:12288
    v_mfma_f32_16x16x32_bf16 v[100:103], a[152:155], a[72:75], 0
    buffer_load_dwordx4 v241, s[16:19], s50 offen offset:1024 lds
    v_mfma_f32_16x16x32_bf16 v[104:107], a[156:159], a[0:3], 0
    ds_read_b64_tr_b16 a[140:141], v247 offset:8192
    ds_read_b64_tr_b16 a[142:143], v247 offset:12288
    v_mfma_f32_16x16x32_bf16 v[108:111], a[156:159], a[72:75], 0
    buffer_load_dwordx4 v242, s[16:19], s50 offen offset:2048 lds
    s_waitcnt lgkmcnt(15)
    v_mfma_f32_16x16x32_bf16 v[112:115], a[160:163], a[0:3], 0
    ds_read_b64_tr_b16 a[144:145], v248 offset:8192
    ds_read_b64_tr_b16 a[146:147], v248 offset:12288
    v_mfma_f32_16x16x32_bf16 v[116:119], a[160:163], a[72:75], 0
    buffer_load_dwordx4 v243, s[16:19], s50 offen offset:3072 lds
    v_mfma_f32_16x16x32_bf16 v[120:123], a[164:167], a[0:3], 0
    ds_read_b64_tr_b16 a[148:149], v249 offset:8192
    v_mfma_f32_16x16x32_bf16 v[124:127], a[164:167], a[72:75], 0
    ds_read_b64_tr_b16 a[150:151], v249 offset:12288
    v_mfma_f32_16x16x32_bf16 v[128:131], a[168:171], a[0:3], 0
    ds_read_b64_tr_b16 a[152:153], v250 offset:8192
    v_mfma_f32_16x16x32_bf16 v[132:135], a[168:171], a[72:75], 0
    ds_read_b64_tr_b16 a[154:155], v250 offset:12288
    v_mfma_f32_16x16x32_bf16 v[136:139], a[172:175], a[0:3], 0
    ds_read_b64_tr_b16 a[156:157], v251 offset:8192
    v_mfma_f32_16x16x32_bf16 v[140:143], a[172:175], a[72:75], 0
    ds_read_b64_tr_b16 a[158:159], v251 offset:12288
    s_waitcnt lgkmcnt(15)
    v_mfma_f32_16x16x32_bf16 v[144:147], a[176:179], a[0:3], 0
    ds_read_b64_tr_b16 a[160:161], v12 offset:8192
    v_mfma_f32_16x16x32_bf16 v[148:151], a[176:179], a[72:75], 0
    ds_read_b64_tr_b16 a[162:163], v12 offset:12288
    v_mfma_f32_16x16x32_bf16 v[152:155], a[180:183], a[0:3], 0
    ds_read_b64_tr_b16 a[164:165], v13 offset:8192
    v_mfma_f32_16x16x32_bf16 v[156:159], a[180:183], a[72:75], 0
    ds_read_b64_tr_b16 a[166:167], v13 offset:12288
    v_mfma_f32_16x16x32_bf16 v[160:163], a[184:187], a[0:3], 0
    ds_read_b64_tr_b16 a[168:169], v14 offset:8192
    v_mfma_f32_16x16x32_bf16 v[164:167], a[184:187], a[72:75], 0
    ds_read_b64_tr_b16 a[170:171], v14 offset:12288
    v_mfma_f32_16x16x32_bf16 v[168:171], a[188:191], a[0:3], 0
    ds_read_b64_tr_b16 a[172:173], v15 offset:8192
    ds_read_b64_tr_b16 a[174:175], v15 offset:12288
    v_mfma_f32_16x16x32_bf16 v[172:175], a[188:191], a[72:75], 0
    global_load_dword v254, v255, s[60:61]
    s_waitcnt lgkmcnt(15)
    v_mfma_f32_16x16x32_bf16 v[48:51], a[128:131], a[4:7], v[48:51]
    ds_read_b64_tr_b16 a[176:177], v16 offset:8192
    v_mfma_f32_16x16x32_bf16 v[52:55], a[128:131], a[76:79], v[52:55]
    ds_read_b64_tr_b16 a[178:179], v16 offset:12288
    v_mfma_f32_16x16x32_bf16 v[56:59], a[132:135], a[4:7], v[56:59]
    ds_read_b64_tr_b16 a[180:181], v17 offset:8192
    v_mfma_f32_16x16x32_bf16 v[60:63], a[132:135], a[76:79], v[60:63]
    ds_read_b64_tr_b16 a[182:183], v17 offset:12288
    v_mfma_f32_16x16x32_bf16 v[64:67], a[136:139], a[4:7], v[64:67]
    ds_read_b64_tr_b16 a[184:185], v18 offset:8192
    v_mfma_f32_16x16x32_bf16 v[68:71], a[136:139], a[76:79], v[68:71]
    ds_read_b64_tr_b16 a[186:187], v18 offset:12288
    v_mfma_f32_16x16x32_bf16 v[72:75], a[140:143], a[4:7], v[72:75]
    ds_read_b64_tr_b16 a[188:189], v19 offset:8192
    v_mfma_f32_16x16x32_bf16 v[76:79], a[140:143], a[76:79], v[76:79]
    ds_read_b64_tr_b16 a[190:191], v19 offset:12288
    s_waitcnt vmcnt(17)
    s_barrier
    s_waitcnt lgkmcnt(15)
    v_mfma_f32_16x16x32_bf16 v[80:83], a[144:147], a[4:7], v[80:83]
    ds_read_b64_tr_b16 a[128:129], v244 offset:16384
    v_mfma_f32_16x16x32_bf16 v[84:87], a[144:147], a[76:79], v[84:87]
    ds_read_b64_tr_b16 a[130:131], v244 offset:20480
    v_mfma_f32_16x16x32_bf16 v[88:91], a[148:151], a[4:7], v[88:91]
    ds_read_b64_tr_b16 a[132:133], v245 offset:16384
    v_mfma_f32_16x16x32_bf16 v[92:95], a[148:151], a[76:79], v[92:95]
    ds_read_b64_tr_b16 a[134:135], v245 offset:20480
    v_mfma_f32_16x16x32_bf16 v[96:99], a[152:155], a[4:7], v[96:99]
    ds_read_b64_tr_b16 a[136:137], v246 offset:16384
    v_mfma_f32_16x16x32_bf16 v[100:103], a[152:155], a[76:79], v[100:103]
    ds_read_b64_tr_b16 a[138:139], v246 offset:20480
    v_mfma_f32_16x16x32_bf16 v[104:107], a[156:159], a[4:7], v[104:107]
    ds_read_b64_tr_b16 a[140:141], v247 offset:16384
    v_mfma_f32_16x16x32_bf16 v[108:111], a[156:159], a[76:79], v[108:111]
    ds_read_b64_tr_b16 a[142:143], v247 offset:20480
    s_waitcnt lgkmcnt(15)
    v_mfma_f32_16x16x32_bf16 v[112:115], a[160:163], a[4:7], v[112:115]
    ds_read_b64_tr_b16 a[144:145], v248 offset:16384
    v_mfma_f32_16x16x32_bf16 v[116:119], a[160:163], a[76:79], v[116:119]
    ds_read_b64_tr_b16 a[146:147], v248 offset:20480
    v_mfma_f32_16x16x32_bf16 v[120:123], a[164:167], a[4:7], v[120:123]
    ds_read_b64_tr_b16 a[148:149], v249 offset:16384
    v_mfma_f32_16x16x32_bf16 v[124:127], a[164:167], a[76:79], v[124:127]
    ds_read_b64_tr_b16 a[150:151], v249 offset:20480
    v_mfma_f32_16x16x32_bf16 v[128:131], a[168:171], a[4:7], v[128:131]
    ds_read_b64_tr_b16 a[152:153], v250 offset:16384
    v_mfma_f32_16x16x32_bf16 v[132:135], a[168:171], a[76:79], v[132:135]
    ds_read_b64_tr_b16 a[154:155], v250 offset:20480
    v_mfma_f32_16x16x32_bf16 v[136:139], a[172:175], a[4:7], v[136:139]
    ds_read_b64_tr_b16 a[156:157], v251 offset:16384
    v_mfma_f32_16x16x32_bf16 v[140:143], a[172:175], a[76:79], v[140:143]
    ds_read_b64_tr_b16 a[158:159], v251 offset:20480
    s_waitcnt lgkmcnt(15)
    v_mfma_f32_16x16x32_bf16 v[144:147], a[176:179], a[4:7], v[144:147]
    ds_read_b64_tr_b16 a[160:161], v12 offset:16384
    v_mfma_f32_16x16x32_bf16 v[148:151], a[176:179], a[76:79], v[148:151]
    ds_read_b64_tr_b16 a[162:163], v12 offset:20480
    v_mfma_f32_16x16x32_bf16 v[152:155], a[180:183], a[4:7], v[152:155]
    ds_read_b64_tr_b16 a[164:165], v13 offset:16384
    v_mfma_f32_16x16x32_bf16 v[156:159], a[180:183], a[76:79], v[156:159]
    ds_read_b64_tr_b16 a[166:167], v13 offset:20480
    v_mfma_f32_16x16x32_bf16 v[160:163], a[184:187], a[4:7], v[160:163]
    ds_read_b64_tr_b16 a[168:169], v14 offset:16384
    v_mfma_f32_16x16x32_bf16 v[164:167], a[184:187], a[76:79], v[164:167]
    ds_read_b64_tr_b16 a[170:171], v14 offset:20480
    v_mfma_f32_16x16x32_bf16 v[168:171], a[188:191], a[4:7], v[168:171]
    ds_read_b64_tr_b16 a[172:173], v15 offset:16384
    v_mfma_f32_16x16x32_bf16 v[172:175], a[188:191], a[76:79], v[172:175]
    ds_read_b64_tr_b16 a[174:175], v15 offset:20480
    s_waitcnt lgkmcnt(15)
    v_mfma_f32_16x16x32_bf16 v[48:51], a[128:131], a[8:11], v[48:51]
    ds_read_b64_tr_b16 a[176:177], v16 offset:16384
    v_mfma_f32_16x16x32_bf16 v[52:55], a[128:131], a[80:83], v[52:55]
    ds_read_b64_tr_b16 a[178:179], v16 offset:20480
    v_mfma_f32_16x16x32_bf16 v[56:59], a[132:135], a[8:11], v[56:59]
    ds_read_b64_tr_b16 a[180:181], v17 offset:16384
    v_mfma_f32_16x16x32_bf16 v[60:63], a[132:135], a[80:83], v[60:63]
    ds_read_b64_tr_b16 a[182:183], v17 offset:20480
    v_mfma_f32_16x16x32_bf16 v[64:67], a[136:139], a[8:11], v[64:67]
    ds_read_b64_tr_b16 a[184:185], v18 offset:16384
    v_mfma_f32_16x16x32_bf16 v[68:71], a[136:139], a[80:83], v[68:71]
    ds_read_b64_tr_b16 a[186:187], v18 offset:20480
    v_mfma_f32_16x16x32_bf16 v[72:75], a[140:143], a[8:11], v[72:75]
    ds_read_b64_tr_b16 a[188:189], v19 offset:16384
    v_mfma_f32_16x16x32_bf16 v[76:79], a[140:143], a[80:83], v[76:79]
    ds_read_b64_tr_b16 a[190:191], v19 offset:20480
    s_waitcnt lgkmcnt(15)
    v_mfma_f32_16x16x32_bf16 v[80:83], a[144:147], a[8:11], v[80:83]
    ds_read_b64_tr_b16 a[128:129], v244 offset:24576
    v_mfma_f32_16x16x32_bf16 v[84:87], a[144:147], a[80:83], v[84:87]
    ds_read_b64_tr_b16 a[130:131], v244 offset:28672
    v_mfma_f32_16x16x32_bf16 v[88:91], a[148:151], a[8:11], v[88:91]
    ds_read_b64_tr_b16 a[132:133], v245 offset:24576
    v_mfma_f32_16x16x32_bf16 v[92:95], a[148:151], a[80:83], v[92:95]
    ds_read_b64_tr_b16 a[134:135], v245 offset:28672
    v_mfma_f32_16x16x32_bf16 v[96:99], a[152:155], a[8:11], v[96:99]
    ds_read_b64_tr_b16 a[136:137], v246 offset:24576
    v_mfma_f32_16x16x32_bf16 v[100:103], a[152:155], a[80:83], v[100:103]
    ds_read_b64_tr_b16 a[138:139], v246 offset:28672
    v_mfma_f32_16x16x32_bf16 v[104:107], a[156:159], a[8:11], v[104:107]
    ds_read_b64_tr_b16 a[140:141], v247 offset:24576
    v_mfma_f32_16x16x32_bf16 v[108:111], a[156:159], a[80:83], v[108:111]
    ds_read_b64_tr_b16 a[142:143], v247 offset:28672
    s_waitcnt lgkmcnt(15)
    v_mfma_f32_16x16x32_bf16 v[112:115], a[160:163], a[8:11], v[112:115]
    ds_read_b64_tr_b16 a[144:145], v248 offset:24576
    v_mfma_f32_16x16x32_bf16 v[116:119], a[160:163], a[80:83], v[116:119]
    ds_read_b64_tr_b16 a[146:147], v248 offset:28672
    v_mfma_f32_16x16x32_bf16 v[120:123], a[164:167], a[8:11], v[120:123]
    ds_read_b64_tr_b16 a[148:149], v249 offset:24576
    v_mfma_f32_16x16x32_bf16 v[124:127], a[164:167], a[80:83], v[124:127]
    ds_read_b64_tr_b16 a[150:151], v249 offset:28672
    v_mfma_f32_16x16x32_bf16 v[128:131], a[168:171], a[8:11], v[128:131]
    ds_read_b64_tr_b16 a[152:153], v250 offset:24576
    v_mfma_f32_16x16x32_bf16 v[132:135], a[168:171], a[80:83], v[132:135]
    ds_read_b64_tr_b16 a[154:155], v250 offset:28672
    v_mfma_f32_16x16x32_bf16 v[136:139], a[172:175], a[8:11], v[136:139]
    ds_read_b64_tr_b16 a[156:157], v251 offset:24576
    v_mfma_f32_16x16x32_bf16 v[140:143], a[172:175], a[80:83], v[140:143]
    ds_read_b64_tr_b16 a[158:159], v251 offset:28672
    s_waitcnt lgkmcnt(15)
    v_mfma_f32_16x16x32_bf16 v[144:147], a[176:179], a[8:11], v[144:147]
    ds_read_b64_tr_b16 a[160:161], v12 offset:24576
    v_mfma_f32_16x16x32_bf16 v[148:151], a[176:179], a[80:83], v[148:151]
    ds_read_b64_tr_b16 a[162:163], v12 offset:28672
    v_mfma_f32_16x16x32_bf16 v[152:155], a[180:183], a[8:11], v[152:155]
    ds_read_b64_tr_b16 a[164:165], v13 offset:24576
    v_mfma_f32_16x16x32_bf16 v[156:159], a[180:183], a[80:83], v[156:159]
    ds_read_b64_tr_b16 a[166:167], v13 offset:28672
    v_mfma_f32_16x16x32_bf16 v[160:163], a[184:187], a[8:11], v[160:163]
    ds_read_b64_tr_b16 a[168:169], v14 offset:24576
    v_mfma_f32_16x16x32_bf16 v[164:167], a[184:187], a[80:83], v[164:167]
    ds_read_b64_tr_b16 a[170:171], v14 offset:28672
    v_mfma_f32_16x16x32_bf16 v[168:171], a[188:191], a[8:11], v[168:171]
    ds_read_b64_tr_b16 a[172:173], v15 offset:24576
    v_mfma_f32_16x16x32_bf16 v[172:175], a[188:191], a[80:83], v[172:175]
    ds_read_b64_tr_b16 a[174:175], v15 offset:28672
    s_waitcnt lgkmcnt(15)
    v_mfma_f32_16x16x32_bf16 v[48:51], a[128:131], a[12:15], v[48:51]
    ds_read_b64_tr_b16 a[176:177], v16 offset:24576
    v_mfma_f32_16x16x32_bf16 v[52:55], a[128:131], a[84:87], v[52:55]
    ds_read_b64_tr_b16 a[178:179], v16 offset:28672
    v_mfma_f32_16x16x32_bf16 v[56:59], a[132:135], a[12:15], v[56:59]
    ds_read_b64_tr_b16 a[180:181], v17 offset:24576
    v_mfma_f32_16x16x32_bf16 v[60:63], a[132:135], a[84:87], v[60:63]
    ds_read_b64_tr_b16 a[182:183], v17 offset:28672
    v_mfma_f32_16x16x32_bf16 v[64:67], a[136:139], a[12:15], v[64:67]
    ds_read_b64_tr_b16 a[184:185], v18 offset:24576
    v_mfma_f32_16x16x32_bf16 v[68:71], a[136:139], a[84:87], v[68:71]
    ds_read_b64_tr_b16 a[186:187], v18 offset:28672
    v_mfma_f32_16x16x32_bf16 v[72:75], a[140:143], a[12:15], v[72:75]
    ds_read_b64_tr_b16 a[188:189], v19 offset:24576
    v_mfma_f32_16x16x32_bf16 v[76:79], a[140:143], a[84:87], v[76:79]
    ds_read_b64_tr_b16 a[190:191], v19 offset:28672
    s_waitcnt vmcnt(9)
    s_barrier
    s_waitcnt lgkmcnt(15)
    v_mfma_f32_16x16x32_bf16 v[80:83], a[144:147], a[12:15], v[80:83]
    ds_read_b64_tr_b16 a[128:129], v244 offset:32768
    v_mfma_f32_16x16x32_bf16 v[84:87], a[144:147], a[84:87], v[84:87]
    s_add_u32 m0, s47, 0
    ds_read_b64_tr_b16 a[130:131], v244 offset:36864
    v_mfma_f32_16x16x32_bf16 v[88:91], a[148:151], a[12:15], v[88:91]
    ds_read_b64_tr_b16 a[132:133], v245 offset:32768
    s_mov_b32 s50, 2097152
    v_mfma_f32_16x16x32_bf16 v[92:95], a[148:151], a[84:87], v[92:95]
    buffer_load_dwordx4 v240, s[16:19], s50 offen offset:0 lds
    ds_read_b64_tr_b16 a[134:135], v245 offset:36864
    v_mfma_f32_16x16x32_bf16 v[96:99], a[152:155], a[12:15], v[96:99]
    ds_read_b64_tr_b16 a[136:137], v246 offset:32768
    v_mfma_f32_16x16x32_bf16 v[100:103], a[152:155], a[84:87], v[100:103]
    ds_read_b64_tr_b16 a[138:139], v246 offset:36864
    v_mfma_f32_16x16x32_bf16 v[104:107], a[156:159], a[12:15], v[104:107]
    ds_read_b64_tr_b16 a[140:141], v247 offset:32768
    ds_read_b64_tr_b16 a[142:143], v247 offset:36864
    v_mfma_f32_16x16x32_bf16 v[108:111], a[156:159], a[84:87], v[108:111]
    buffer_load_dwordx4 v241, s[16:19], s50 offen offset:1024 lds
    s_waitcnt lgkmcnt(15)
    v_mfma_f32_16x16x32_bf16 v[112:115], a[160:163], a[12:15], v[112:115]
    ds_read_b64_tr_b16 a[144:145], v248 offset:32768
    v_mfma_f32_16x16x32_bf16 v[116:119], a[160:163], a[84:87], v[116:119]
    ds_read_b64_tr_b16 a[146:147], v248 offset:36864
    v_mfma_f32_16x16x32_bf16 v[120:123], a[164:167], a[12:15], v[120:123]
    ds_read_b64_tr_b16 a[148:149], v249 offset:32768
    ds_read_b64_tr_b16 a[150:151], v249 offset:36864
    v_mfma_f32_16x16x32_bf16 v[124:127], a[164:167], a[84:87], v[124:127]
    buffer_load_dwordx4 v242, s[16:19], s50 offen offset:2048 lds
    v_mfma_f32_16x16x32_bf16 v[128:131], a[168:171], a[12:15], v[128:131]
    ds_read_b64_tr_b16 a[152:153], v250 offset:32768
    v_mfma_f32_16x16x32_bf16 v[132:135], a[168:171], a[84:87], v[132:135]
    ds_read_b64_tr_b16 a[154:155], v250 offset:36864
    v_mfma_f32_16x16x32_bf16 v[136:139], a[172:175], a[12:15], v[136:139]
    ds_read_b64_tr_b16 a[156:157], v251 offset:32768
    ds_read_b64_tr_b16 a[158:159], v251 offset:36864
    v_mfma_f32_16x16x32_bf16 v[140:143], a[172:175], a[84:87], v[140:143]
    buffer_load_dwordx4 v243, s[16:19], s50 offen offset:3072 lds
    s_waitcnt lgkmcnt(15)
    v_mfma_f32_16x16x32_bf16 v[144:147], a[176:179], a[12:15], v[144:147]
    ds_read_b64_tr_b16 a[160:161], v12 offset:32768
    v_mfma_f32_16x16x32_bf16 v[148:151], a[176:179], a[84:87], v[148:151]
    s_add_u32 m0, s47, 65536
    ds_read_b64_tr_b16 a[162:163], v12 offset:36864
    v_mfma_f32_16x16x32_bf16 v[152:155], a[180:183], a[12:15], v[152:155]
    ds_read_b64_tr_b16 a[164:165], v13 offset:32768
    s_mov_b32 s50, 2097408
    v_mfma_f32_16x16x32_bf16 v[156:159], a[180:183], a[84:87], v[156:159]
    buffer_load_dwordx4 v240, s[16:19], s50 offen offset:0 lds
    ds_read_b64_tr_b16 a[166:167], v13 offset:36864
    v_mfma_f32_16x16x32_bf16 v[160:163], a[184:187], a[12:15], v[160:163]
    ds_read_b64_tr_b16 a[168:169], v14 offset:32768
    v_mfma_f32_16x16x32_bf16 v[164:167], a[184:187], a[84:87], v[164:167]
    ds_read_b64_tr_b16 a[170:171], v14 offset:36864
    v_mfma_f32_16x16x32_bf16 v[168:171], a[188:191], a[12:15], v[168:171]
    ds_read_b64_tr_b16 a[172:173], v15 offset:32768
    ds_read_b64_tr_b16 a[174:175], v15 offset:36864
    v_mfma_f32_16x16x32_bf16 v[172:175], a[188:191], a[84:87], v[172:175]
    buffer_load_dwordx4 v241, s[16:19], s50 offen offset:1024 lds
    s_waitcnt lgkmcnt(15)
    v_mfma_f32_16x16x32_bf16 v[48:51], a[128:131], a[16:19], v[48:51]
    ds_read_b64_tr_b16 a[176:177], v16 offset:32768
    v_mfma_f32_16x16x32_bf16 v[52:55], a[128:131], a[88:91], v[52:55]
    ds_read_b64_tr_b16 a[178:179], v16 offset:36864
    v_mfma_f32_16x16x32_bf16 v[56:59], a[132:135], a[16:19], v[56:59]
    ds_read_b64_tr_b16 a[180:181], v17 offset:32768
    ds_read_b64_tr_b16 a[182:183], v17 offset:36864
    v_mfma_f32_16x16x32_bf16 v[60:63], a[132:135], a[88:91], v[60:63]
    buffer_load_dwordx4 v242, s[16:19], s50 offen offset:2048 lds
    v_mfma_f32_16x16x32_bf16 v[64:67], a[136:139], a[16:19], v[64:67]
    ds_read_b64_tr_b16 a[184:185], v18 offset:32768
    v_mfma_f32_16x16x32_bf16 v[68:71], a[136:139], a[88:91], v[68:71]
    ds_read_b64_tr_b16 a[186:187], v18 offset:36864
    v_mfma_f32_16x16x32_bf16 v[72:75], a[140:143], a[16:19], v[72:75]
    ds_read_b64_tr_b16 a[188:189], v19 offset:32768
    ds_read_b64_tr_b16 a[190:191], v19 offset:36864
    v_mfma_f32_16x16x32_bf16 v[76:79], a[140:143], a[88:91], v[76:79]
    buffer_load_dwordx4 v243, s[16:19], s50 offen offset:3072 lds
    s_waitcnt lgkmcnt(15)
    v_mfma_f32_16x16x32_bf16 v[80:83], a[144:147], a[16:19], v[80:83]
    ds_read_b64_tr_b16 a[128:129], v244 offset:40960
    v_mfma_f32_16x16x32_bf16 v[84:87], a[144:147], a[88:91], v[84:87]
    ds_read_b64_tr_b16 a[130:131], v244 offset:45056
    v_mfma_f32_16x16x32_bf16 v[88:91], a[148:151], a[16:19], v[88:91]
    ds_read_b64_tr_b16 a[132:133], v245 offset:40960
    v_mfma_f32_16x16x32_bf16 v[92:95], a[148:151], a[88:91], v[92:95]
    ds_read_b64_tr_b16 a[134:135], v245 offset:45056
    v_mfma_f32_16x16x32_bf16 v[96:99], a[152:155], a[16:19], v[96:99]
    ds_read_b64_tr_b16 a[136:137], v246 offset:40960
    v_mfma_f32_16x16x32_bf16 v[100:103], a[152:155], a[88:91], v[100:103]
    ds_read_b64_tr_b16 a[138:139], v246 offset:45056
    v_mfma_f32_16x16x32_bf16 v[104:107], a[156:159], a[16:19], v[104:107]
    ds_read_b64_tr_b16 a[140:141], v247 offset:40960
    v_mfma_f32_16x16x32_bf16 v[108:111], a[156:159], a[88:91], v[108:111]
    ds_read_b64_tr_b16 a[142:143], v247 offset:45056
    s_waitcnt lgkmcnt(15)
    v_mfma_f32_16x16x32_bf16 v[112:115], a[160:163], a[16:19], v[112:115]
    ds_read_b64_tr_b16 a[144:145], v248 offset:40960
    v_mfma_f32_16x16x32_bf16 v[116:119], a[160:163], a[88:91], v[116:119]
    ds_read_b64_tr_b16 a[146:147], v248 offset:45056
    v_mfma_f32_16x16x32_bf16 v[120:123], a[164:167], a[16:19], v[120:123]
    ds_read_b64_tr_b16 a[148:149], v249 offset:40960
    v_mfma_f32_16x16x32_bf16 v[124:127], a[164:167], a[88:91], v[124:127]
    ds_read_b64_tr_b16 a[150:151], v249 offset:45056
    v_mfma_f32_16x16x32_bf16 v[128:131], a[168:171], a[16:19], v[128:131]
    ds_read_b64_tr_b16 a[152:153], v250 offset:40960
    v_mfma_f32_16x16x32_bf16 v[132:135], a[168:171], a[88:91], v[132:135]
    ds_read_b64_tr_b16 a[154:155], v250 offset:45056
    v_mfma_f32_16x16x32_bf16 v[136:139], a[172:175], a[16:19], v[136:139]
    ds_read_b64_tr_b16 a[156:157], v251 offset:40960
    v_mfma_f32_16x16x32_bf16 v[140:143], a[172:175], a[88:91], v[140:143]
    ds_read_b64_tr_b16 a[158:159], v251 offset:45056
    s_waitcnt lgkmcnt(15)
    v_mfma_f32_16x16x32_bf16 v[144:147], a[176:179], a[16:19], v[144:147]
    ds_read_b64_tr_b16 a[160:161], v12 offset:40960
    v_mfma_f32_16x16x32_bf16 v[148:151], a[176:179], a[88:91], v[148:151]
    ds_read_b64_tr_b16 a[162:163], v12 offset:45056
    v_mfma_f32_16x16x32_bf16 v[152:155], a[180:183], a[16:19], v[152:155]
    ds_read_b64_tr_b16 a[164:165], v13 offset:40960
    v_mfma_f32_16x16x32_bf16 v[156:159], a[180:183], a[88:91], v[156:159]
    ds_read_b64_tr_b16 a[166:167], v13 offset:45056
    v_mfma_f32_16x16x32_bf16 v[160:163], a[184:187], a[16:19], v[160:163]
    ds_read_b64_tr_b16 a[168:169], v14 offset:40960
    v_mfma_f32_16x16x32_bf16 v[164:167], a[184:187], a[88:91], v[164:167]
    ds_read_b64_tr_b16 a[170:171], v14 offset:45056
    v_mfma_f32_16x16x32_bf16 v[168:171], a[188:191], a[16:19], v[168:171]
    ds_read_b64_tr_b16 a[172:173], v15 offset:40960
    v_mfma_f32_16x16x32_bf16 v[172:175], a[188:191], a[88:91], v[172:175]
    ds_read_b64_tr_b16 a[174:175], v15 offset:45056
    s_waitcnt lgkmcnt(15)
    v_mfma_f32_16x16x32_bf16 v[48:51], a[128:131], a[20:23], v[48:51]
    ds_read_b64_tr_b16 a[176:177], v16 offset:40960
    v_mfma_f32_16x16x32_bf16 v[52:55], a[128:131], a[92:95], v[52:55]
    ds_read_b64_tr_b16 a[178:179], v16 offset:45056
    v_mfma_f32_16x16x32_bf16 v[56:59], a[132:135], a[20:23], v[56:59]
    ds_read_b64_tr_b16 a[180:181], v17 offset:40960
    v_mfma_f32_16x16x32_bf16 v[60:63], a[132:135], a[92:95], v[60:63]
    ds_read_b64_tr_b16 a[182:183], v17 offset:45056
    v_mfma_f32_16x16x32_bf16 v[64:67], a[136:139], a[20:23], v[64:67]
    ds_read_b64_tr_b16 a[184:185], v18 offset:40960
    v_mfma_f32_16x16x32_bf16 v[68:71], a[136:139], a[92:95], v[68:71]
    ds_read_b64_tr_b16 a[186:187], v18 offset:45056
    v_mfma_f32_16x16x32_bf16 v[72:75], a[140:143], a[20:23], v[72:75]
    ds_read_b64_tr_b16 a[188:189], v19 offset:40960
    v_mfma_f32_16x16x32_bf16 v[76:79], a[140:143], a[92:95], v[76:79]
    ds_read_b64_tr_b16 a[190:191], v19 offset:45056
    s_waitcnt vmcnt(9)
    s_barrier
    s_waitcnt lgkmcnt(15)
    v_mfma_f32_16x16x32_bf16 v[80:83], a[144:147], a[20:23], v[80:83]
    ds_read_b64_tr_b16 a[128:129], v244 offset:49152
    v_mfma_f32_16x16x32_bf16 v[84:87], a[144:147], a[92:95], v[84:87]
    s_add_u32 m0, s47, 16384
    ds_read_b64_tr_b16 a[130:131], v244 offset:53248
    v_mfma_f32_16x16x32_bf16 v[88:91], a[148:151], a[20:23], v[88:91]
    ds_read_b64_tr_b16 a[132:133], v245 offset:49152
    s_mov_b32 s50, 2621440
    v_mfma_f32_16x16x32_bf16 v[92:95], a[148:151], a[92:95], v[92:95]
    buffer_load_dwordx4 v240, s[16:19], s50 offen offset:0 lds
    ds_read_b64_tr_b16 a[134:135], v245 offset:53248
    v_mfma_f32_16x16x32_bf16 v[96:99], a[152:155], a[20:23], v[96:99]
    ds_read_b64_tr_b16 a[136:137], v246 offset:49152
    v_mfma_f32_16x16x32_bf16 v[100:103], a[152:155], a[92:95], v[100:103]
    ds_read_b64_tr_b16 a[138:139], v246 offset:53248
    v_mfma_f32_16x16x32_bf16 v[104:107], a[156:159], a[20:23], v[104:107]
    ds_read_b64_tr_b16 a[140:141], v247 offset:49152
    ds_read_b64_tr_b16 a[142:143], v247 offset:53248
    v_mfma_f32_16x16x32_bf16 v[108:111], a[156:159], a[92:95], v[108:111]
    buffer_load_dwordx4 v241, s[16:19], s50 offen offset:1024 lds
    s_waitcnt lgkmcnt(15)
    v_mfma_f32_16x16x32_bf16 v[112:115], a[160:163], a[20:23], v[112:115]
    ds_read_b64_tr_b16 a[144:145], v248 offset:49152
    v_mfma_f32_16x16x32_bf16 v[116:119], a[160:163], a[92:95], v[116:119]
    ds_read_b64_tr_b16 a[146:147], v248 offset:53248
    v_mfma_f32_16x16x32_bf16 v[120:123], a[164:167], a[20:23], v[120:123]
    ds_read_b64_tr_b16 a[148:149], v249 offset:49152
    ds_read_b64_tr_b16 a[150:151], v249 offset:53248
    v_mfma_f32_16x16x32_bf16 v[124:127], a[164:167], a[92:95], v[124:127]
    buffer_load_dwordx4 v242, s[16:19], s50 offen offset:2048 lds
    v_mfma_f32_16x16x32_bf16 v[128:131], a[168:171], a[20:23], v[128:131]
    ds_read_b64_tr_b16 a[152:153], v250 offset:49152
    v_mfma_f32_16x16x32_bf16 v[132:135], a[168:171], a[92:95], v[132:135]
    ds_read_b64_tr_b16 a[154:155], v250 offset:53248
    v_mfma_f32_16x16x32_bf16 v[136:139], a[172:175], a[20:23], v[136:139]
    ds_read_b64_tr_b16 a[156:157], v251 offset:49152
    ds_read_b64_tr_b16 a[158:159], v251 offset:53248
    v_mfma_f32_16x16x32_bf16 v[140:143], a[172:175], a[92:95], v[140:143]
    buffer_load_dwordx4 v243, s[16:19], s50 offen offset:3072 lds
    s_waitcnt lgkmcnt(15)
    v_mfma_f32_16x16x32_bf16 v[144:147], a[176:179], a[20:23], v[144:147]
    ds_read_b64_tr_b16 a[160:161], v12 offset:49152
    v_mfma_f32_16x16x32_bf16 v[148:151], a[176:179], a[92:95], v[148:151]
    s_add_u32 m0, s47, 81920
    ds_read_b64_tr_b16 a[162:163], v12 offset:53248
    v_mfma_f32_16x16x32_bf16 v[152:155], a[180:183], a[20:23], v[152:155]
    ds_read_b64_tr_b16 a[164:165], v13 offset:49152
    s_mov_b32 s50, 2621696
    v_mfma_f32_16x16x32_bf16 v[156:159], a[180:183], a[92:95], v[156:159]
    buffer_load_dwordx4 v240, s[16:19], s50 offen offset:0 lds
    ds_read_b64_tr_b16 a[166:167], v13 offset:53248
    v_mfma_f32_16x16x32_bf16 v[160:163], a[184:187], a[20:23], v[160:163]
    ds_read_b64_tr_b16 a[168:169], v14 offset:49152
    v_mfma_f32_16x16x32_bf16 v[164:167], a[184:187], a[92:95], v[164:167]
    ds_read_b64_tr_b16 a[170:171], v14 offset:53248
    v_mfma_f32_16x16x32_bf16 v[168:171], a[188:191], a[20:23], v[168:171]
    ds_read_b64_tr_b16 a[172:173], v15 offset:49152
    ds_read_b64_tr_b16 a[174:175], v15 offset:53248
    v_mfma_f32_16x16x32_bf16 v[172:175], a[188:191], a[92:95], v[172:175]
    buffer_load_dwordx4 v241, s[16:19], s50 offen offset:1024 lds
    s_waitcnt lgkmcnt(15)
    v_mfma_f32_16x16x32_bf16 v[48:51], a[128:131], a[24:27], v[48:51]
    ds_read_b64_tr_b16 a[176:177], v16 offset:49152
    v_mfma_f32_16x16x32_bf16 v[52:55], a[128:131], a[96:99], v[52:55]
    ds_read_b64_tr_b16 a[178:179], v16 offset:53248
    v_mfma_f32_16x16x32_bf16 v[56:59], a[132:135], a[24:27], v[56:59]
    ds_read_b64_tr_b16 a[180:181], v17 offset:49152
    ds_read_b64_tr_b16 a[182:183], v17 offset:53248
    v_mfma_f32_16x16x32_bf16 v[60:63], a[132:135], a[96:99], v[60:63]
    buffer_load_dwordx4 v242, s[16:19], s50 offen offset:2048 lds
    v_mfma_f32_16x16x32_bf16 v[64:67], a[136:139], a[24:27], v[64:67]
    ds_read_b64_tr_b16 a[184:185], v18 offset:49152
    v_mfma_f32_16x16x32_bf16 v[68:71], a[136:139], a[96:99], v[68:71]
    ds_read_b64_tr_b16 a[186:187], v18 offset:53248
    v_mfma_f32_16x16x32_bf16 v[72:75], a[140:143], a[24:27], v[72:75]
    ds_read_b64_tr_b16 a[188:189], v19 offset:49152
    ds_read_b64_tr_b16 a[190:191], v19 offset:53248
    v_mfma_f32_16x16x32_bf16 v[76:79], a[140:143], a[96:99], v[76:79]
    buffer_load_dwordx4 v243, s[16:19], s50 offen offset:3072 lds
    s_waitcnt lgkmcnt(15)
    v_mfma_f32_16x16x32_bf16 v[80:83], a[144:147], a[24:27], v[80:83]
    ds_read_b64_tr_b16 a[128:129], v244 offset:57344
    v_mfma_f32_16x16x32_bf16 v[84:87], a[144:147], a[96:99], v[84:87]
    ds_read_b64_tr_b16 a[130:131], v244 offset:61440
    v_mfma_f32_16x16x32_bf16 v[88:91], a[148:151], a[24:27], v[88:91]
    ds_read_b64_tr_b16 a[132:133], v245 offset:57344
    v_mfma_f32_16x16x32_bf16 v[92:95], a[148:151], a[96:99], v[92:95]
    ds_read_b64_tr_b16 a[134:135], v245 offset:61440
    v_mfma_f32_16x16x32_bf16 v[96:99], a[152:155], a[24:27], v[96:99]
    ds_read_b64_tr_b16 a[136:137], v246 offset:57344
    v_mfma_f32_16x16x32_bf16 v[100:103], a[152:155], a[96:99], v[100:103]
    ds_read_b64_tr_b16 a[138:139], v246 offset:61440
    v_mfma_f32_16x16x32_bf16 v[104:107], a[156:159], a[24:27], v[104:107]
    ds_read_b64_tr_b16 a[140:141], v247 offset:57344
    v_mfma_f32_16x16x32_bf16 v[108:111], a[156:159], a[96:99], v[108:111]
    ds_read_b64_tr_b16 a[142:143], v247 offset:61440
    s_waitcnt lgkmcnt(15)
    v_mfma_f32_16x16x32_bf16 v[112:115], a[160:163], a[24:27], v[112:115]
    ds_read_b64_tr_b16 a[144:145], v248 offset:57344
    v_mfma_f32_16x16x32_bf16 v[116:119], a[160:163], a[96:99], v[116:119]
    ds_read_b64_tr_b16 a[146:147], v248 offset:61440
    v_mfma_f32_16x16x32_bf16 v[120:123], a[164:167], a[24:27], v[120:123]
    ds_read_b64_tr_b16 a[148:149], v249 offset:57344
    v_mfma_f32_16x16x32_bf16 v[124:127], a[164:167], a[96:99], v[124:127]
    ds_read_b64_tr_b16 a[150:151], v249 offset:61440
    v_mfma_f32_16x16x32_bf16 v[128:131], a[168:171], a[24:27], v[128:131]
    ds_read_b64_tr_b16 a[152:153], v250 offset:57344
    v_mfma_f32_16x16x32_bf16 v[132:135], a[168:171], a[96:99], v[132:135]
    ds_read_b64_tr_b16 a[154:155], v250 offset:61440
    v_mfma_f32_16x16x32_bf16 v[136:139], a[172:175], a[24:27], v[136:139]
    ds_read_b64_tr_b16 a[156:157], v251 offset:57344
    v_mfma_f32_16x16x32_bf16 v[140:143], a[172:175], a[96:99], v[140:143]
    ds_read_b64_tr_b16 a[158:159], v251 offset:61440
    s_waitcnt lgkmcnt(15)
    v_mfma_f32_16x16x32_bf16 v[144:147], a[176:179], a[24:27], v[144:147]
    ds_read_b64_tr_b16 a[160:161], v12 offset:57344
    v_mfma_f32_16x16x32_bf16 v[148:151], a[176:179], a[96:99], v[148:151]
    ds_read_b64_tr_b16 a[162:163], v12 offset:61440
    v_mfma_f32_16x16x32_bf16 v[152:155], a[180:183], a[24:27], v[152:155]
    ds_read_b64_tr_b16 a[164:165], v13 offset:57344
    v_mfma_f32_16x16x32_bf16 v[156:159], a[180:183], a[96:99], v[156:159]
    ds_read_b64_tr_b16 a[166:167], v13 offset:61440
    v_mfma_f32_16x16x32_bf16 v[160:163], a[184:187], a[24:27], v[160:163]
    ds_read_b64_tr_b16 a[168:169], v14 offset:57344
    v_mfma_f32_16x16x32_bf16 v[164:167], a[184:187], a[96:99], v[164:167]
    ds_read_b64_tr_b16 a[170:171], v14 offset:61440
    v_mfma_f32_16x16x32_bf16 v[168:171], a[188:191], a[24:27], v[168:171]
    ds_read_b64_tr_b16 a[172:173], v15 offset:57344
    v_mfma_f32_16x16x32_bf16 v[172:175], a[188:191], a[96:99], v[172:175]
    ds_read_b64_tr_b16 a[174:175], v15 offset:61440
    s_waitcnt lgkmcnt(15)
    v_mfma_f32_16x16x32_bf16 v[48:51], a[128:131], a[28:31], v[48:51]
    ds_read_b64_tr_b16 a[176:177], v16 offset:57344
    v_mfma_f32_16x16x32_bf16 v[52:55], a[128:131], a[100:103], v[52:55]
    ds_read_b64_tr_b16 a[178:179], v16 offset:61440
    v_mfma_f32_16x16x32_bf16 v[56:59], a[132:135], a[28:31], v[56:59]
    ds_read_b64_tr_b16 a[180:181], v17 offset:57344
    v_mfma_f32_16x16x32_bf16 v[60:63], a[132:135], a[100:103], v[60:63]
    ds_read_b64_tr_b16 a[182:183], v17 offset:61440
    v_mfma_f32_16x16x32_bf16 v[64:67], a[136:139], a[28:31], v[64:67]
    ds_read_b64_tr_b16 a[184:185], v18 offset:57344
    v_mfma_f32_16x16x32_bf16 v[68:71], a[136:139], a[100:103], v[68:71]
    ds_read_b64_tr_b16 a[186:187], v18 offset:61440
    v_mfma_f32_16x16x32_bf16 v[72:75], a[140:143], a[28:31], v[72:75]
    ds_read_b64_tr_b16 a[188:189], v19 offset:57344
    v_mfma_f32_16x16x32_bf16 v[76:79], a[140:143], a[100:103], v[76:79]
    ds_read_b64_tr_b16 a[190:191], v19 offset:61440
    s_waitcnt vmcnt(8)
    s_barrier
    s_waitcnt lgkmcnt(15)
    v_mfma_f32_16x16x32_bf16 v[80:83], a[144:147], a[28:31], v[80:83]
    ds_read_b64_tr_b16 a[128:129], v244 offset:0
    v_mfma_f32_16x16x32_bf16 v[84:87], a[144:147], a[100:103], v[84:87]
    s_add_u32 m0, s47, 32768
    ds_read_b64_tr_b16 a[130:131], v244 offset:4096
    v_mfma_f32_16x16x32_bf16 v[88:91], a[148:151], a[28:31], v[88:91]
    ds_read_b64_tr_b16 a[132:133], v245 offset:0
    s_mov_b32 s50, 3145728
    v_mfma_f32_16x16x32_bf16 v[92:95], a[148:151], a[100:103], v[92:95]
    buffer_load_dwordx4 v240, s[16:19], s50 offen offset:0 lds
    ds_read_b64_tr_b16 a[134:135], v245 offset:4096
    v_mfma_f32_16x16x32_bf16 v[96:99], a[152:155], a[28:31], v[96:99]
    ds_read_b64_tr_b16 a[136:137], v246 offset:0
    v_mfma_f32_16x16x32_bf16 v[100:103], a[152:155], a[100:103], v[100:103]
    ds_read_b64_tr_b16 a[138:139], v246 offset:4096
    v_mfma_f32_16x16x32_bf16 v[104:107], a[156:159], a[28:31], v[104:107]
    ds_read_b64_tr_b16 a[140:141], v247 offset:0
    ds_read_b64_tr_b16 a[142:143], v247 offset:4096
    v_mfma_f32_16x16x32_bf16 v[108:111], a[156:159], a[100:103], v[108:111]
    buffer_load_dwordx4 v241, s[16:19], s50 offen offset:1024 lds
    s_waitcnt lgkmcnt(15)
    v_mfma_f32_16x16x32_bf16 v[112:115], a[160:163], a[28:31], v[112:115]
    ds_read_b64_tr_b16 a[144:145], v248 offset:0
    v_mfma_f32_16x16x32_bf16 v[116:119], a[160:163], a[100:103], v[116:119]
    ds_read_b64_tr_b16 a[146:147], v248 offset:4096
    v_mfma_f32_16x16x32_bf16 v[120:123], a[164:167], a[28:31], v[120:123]
    ds_read_b64_tr_b16 a[148:149], v249 offset:0
    ds_read_b64_tr_b16 a[150:151], v249 offset:4096
    v_mfma_f32_16x16x32_bf16 v[124:127], a[164:167], a[100:103], v[124:127]
    buffer_load_dwordx4 v242, s[16:19], s50 offen offset:2048 lds
    v_mfma_f32_16x16x32_bf16 v[128:131], a[168:171], a[28:31], v[128:131]
    ds_read_b64_tr_b16 a[152:153], v250 offset:0
    v_mfma_f32_16x16x32_bf16 v[132:135], a[168:171], a[100:103], v[132:135]
    ds_read_b64_tr_b16 a[154:155], v250 offset:4096
    v_mfma_f32_16x16x32_bf16 v[136:139], a[172:175], a[28:31], v[136:139]
    ds_read_b64_tr_b16 a[156:157], v251 offset:0
    ds_read_b64_tr_b16 a[158:159], v251 offset:4096
    v_mfma_f32_16x16x32_bf16 v[140:143], a[172:175], a[100:103], v[140:143]
    buffer_load_dwordx4 v243, s[16:19], s50 offen offset:3072 lds
    s_waitcnt lgkmcnt(15)
    v_mfma_f32_16x16x32_bf16 v[144:147], a[176:179], a[28:31], v[144:147]
    ds_read_b64_tr_b16 a[160:161], v12 offset:0
    v_mfma_f32_16x16x32_bf16 v[148:151], a[176:179], a[100:103], v[148:151]
    s_add_u32 m0, s47, 98304
    ds_read_b64_tr_b16 a[162:163], v12 offset:4096
    v_mfma_f32_16x16x32_bf16 v[152:155], a[180:183], a[28:31], v[152:155]
    ds_read_b64_tr_b16 a[164:165], v13 offset:0
    s_mov_b32 s50, 3145984
    v_mfma_f32_16x16x32_bf16 v[156:159], a[180:183], a[100:103], v[156:159]
    buffer_load_dwordx4 v240, s[16:19], s50 offen offset:0 lds
    ds_read_b64_tr_b16 a[166:167], v13 offset:4096
    v_mfma_f32_16x16x32_bf16 v[160:163], a[184:187], a[28:31], v[160:163]
    ds_read_b64_tr_b16 a[168:169], v14 offset:0
    v_mfma_f32_16x16x32_bf16 v[164:167], a[184:187], a[100:103], v[164:167]
    ds_read_b64_tr_b16 a[170:171], v14 offset:4096
    v_mfma_f32_16x16x32_bf16 v[168:171], a[188:191], a[28:31], v[168:171]
    ds_read_b64_tr_b16 a[172:173], v15 offset:0
    ds_read_b64_tr_b16 a[174:175], v15 offset:4096
    v_mfma_f32_16x16x32_bf16 v[172:175], a[188:191], a[100:103], v[172:175]
    buffer_load_dwordx4 v241, s[16:19], s50 offen offset:1024 lds
    s_waitcnt lgkmcnt(15)
    v_mfma_f32_16x16x32_bf16 v[48:51], a[128:131], a[32:35], v[48:51]
    ds_read_b64_tr_b16 a[176:177], v16 offset:0
    v_mfma_f32_16x16x32_bf16 v[52:55], a[128:131], a[104:107], v[52:55]
    ds_read_b64_tr_b16 a[178:179], v16 offset:4096
    v_mfma_f32_16x16x32_bf16 v[56:59], a[132:135], a[32:35], v[56:59]
    ds_read_b64_tr_b16 a[180:181], v17 offset:0
    ds_read_b64_tr_b16 a[182:183], v17 offset:4096
    v_mfma_f32_16x16x32_bf16 v[60:63], a[132:135], a[104:107], v[60:63]
    buffer_load_dwordx4 v242, s[16:19], s50 offen offset:2048 lds
    v_mfma_f32_16x16x32_bf16 v[64:67], a[136:139], a[32:35], v[64:67]
    ds_read_b64_tr_b16 a[184:185], v18 offset:0
    v_mfma_f32_16x16x32_bf16 v[68:71], a[136:139], a[104:107], v[68:71]
    ds_read_b64_tr_b16 a[186:187], v18 offset:4096
    v_mfma_f32_16x16x32_bf16 v[72:75], a[140:143], a[32:35], v[72:75]
    ds_read_b64_tr_b16 a[188:189], v19 offset:0
    ds_read_b64_tr_b16 a[190:191], v19 offset:4096
    v_mfma_f32_16x16x32_bf16 v[76:79], a[140:143], a[104:107], v[76:79]
    buffer_load_dwordx4 v243, s[16:19], s50 offen offset:3072 lds
    s_waitcnt lgkmcnt(15)
    v_mfma_f32_16x16x32_bf16 v[80:83], a[144:147], a[32:35], v[80:83]
    ds_read_b64_tr_b16 a[128:129], v244 offset:8192
    v_mfma_f32_16x16x32_bf16 v[84:87], a[144:147], a[104:107], v[84:87]
    ds_read_b64_tr_b16 a[130:131], v244 offset:12288
    v_mfma_f32_16x16x32_bf16 v[88:91], a[148:151], a[32:35], v[88:91]
    ds_read_b64_tr_b16 a[132:133], v245 offset:8192
    v_mfma_f32_16x16x32_bf16 v[92:95], a[148:151], a[104:107], v[92:95]
    ds_read_b64_tr_b16 a[134:135], v245 offset:12288
    v_mfma_f32_16x16x32_bf16 v[96:99], a[152:155], a[32:35], v[96:99]
    ds_read_b64_tr_b16 a[136:137], v246 offset:8192
    v_mfma_f32_16x16x32_bf16 v[100:103], a[152:155], a[104:107], v[100:103]
    ds_read_b64_tr_b16 a[138:139], v246 offset:12288
    v_mfma_f32_16x16x32_bf16 v[104:107], a[156:159], a[32:35], v[104:107]
    ds_read_b64_tr_b16 a[140:141], v247 offset:8192
    v_mfma_f32_16x16x32_bf16 v[108:111], a[156:159], a[104:107], v[108:111]
    ds_read_b64_tr_b16 a[142:143], v247 offset:12288
    s_waitcnt lgkmcnt(15)
    v_mfma_f32_16x16x32_bf16 v[112:115], a[160:163], a[32:35], v[112:115]
    ds_read_b64_tr_b16 a[144:145], v248 offset:8192
    v_mfma_f32_16x16x32_bf16 v[116:119], a[160:163], a[104:107], v[116:119]
    ds_read_b64_tr_b16 a[146:147], v248 offset:12288
    v_mfma_f32_16x16x32_bf16 v[120:123], a[164:167], a[32:35], v[120:123]
    ds_read_b64_tr_b16 a[148:149], v249 offset:8192
    v_mfma_f32_16x16x32_bf16 v[124:127], a[164:167], a[104:107], v[124:127]
    ds_read_b64_tr_b16 a[150:151], v249 offset:12288
    v_mfma_f32_16x16x32_bf16 v[128:131], a[168:171], a[32:35], v[128:131]
    ds_read_b64_tr_b16 a[152:153], v250 offset:8192
    v_mfma_f32_16x16x32_bf16 v[132:135], a[168:171], a[104:107], v[132:135]
    ds_read_b64_tr_b16 a[154:155], v250 offset:12288
    v_mfma_f32_16x16x32_bf16 v[136:139], a[172:175], a[32:35], v[136:139]
    ds_read_b64_tr_b16 a[156:157], v251 offset:8192
    v_mfma_f32_16x16x32_bf16 v[140:143], a[172:175], a[104:107], v[140:143]
    ds_read_b64_tr_b16 a[158:159], v251 offset:12288
    s_waitcnt lgkmcnt(15)
    v_mfma_f32_16x16x32_bf16 v[144:147], a[176:179], a[32:35], v[144:147]
    ds_read_b64_tr_b16 a[160:161], v12 offset:8192
    v_mfma_f32_16x16x32_bf16 v[148:151], a[176:179], a[104:107], v[148:151]
    ds_read_b64_tr_b16 a[162:163], v12 offset:12288
    v_mfma_f32_16x16x32_bf16 v[152:155], a[180:183], a[32:35], v[152:155]
    ds_read_b64_tr_b16 a[164:165], v13 offset:8192
    v_mfma_f32_16x16x32_bf16 v[156:159], a[180:183], a[104:107], v[156:159]
    ds_read_b64_tr_b16 a[166:167], v13 offset:12288
    v_mfma_f32_16x16x32_bf16 v[160:163], a[184:187], a[32:35], v[160:163]
    ds_read_b64_tr_b16 a[168:169], v14 offset:8192
    v_mfma_f32_16x16x32_bf16 v[164:167], a[184:187], a[104:107], v[164:167]
    ds_read_b64_tr_b16 a[170:171], v14 offset:12288
    v_mfma_f32_16x16x32_bf16 v[168:171], a[188:191], a[32:35], v[168:171]
    ds_read_b64_tr_b16 a[172:173], v15 offset:8192
    v_mfma_f32_16x16x32_bf16 v[172:175], a[188:191], a[104:107], v[172:175]
    ds_read_b64_tr_b16 a[174:175], v15 offset:12288
    s_waitcnt lgkmcnt(15)
    v_mfma_f32_16x16x32_bf16 v[48:51], a[128:131], a[36:39], v[48:51]
    ds_read_b64_tr_b16 a[176:177], v16 offset:8192
    v_mfma_f32_16x16x32_bf16 v[52:55], a[128:131], a[108:111], v[52:55]
    ds_read_b64_tr_b16 a[178:179], v16 offset:12288
    v_mfma_f32_16x16x32_bf16 v[56:59], a[132:135], a[36:39], v[56:59]
    ds_read_b64_tr_b16 a[180:181], v17 offset:8192
    v_mfma_f32_16x16x32_bf16 v[60:63], a[132:135], a[108:111], v[60:63]
    ds_read_b64_tr_b16 a[182:183], v17 offset:12288
    v_mfma_f32_16x16x32_bf16 v[64:67], a[136:139], a[36:39], v[64:67]
    ds_read_b64_tr_b16 a[184:185], v18 offset:8192
    v_mfma_f32_16x16x32_bf16 v[68:71], a[136:139], a[108:111], v[68:71]
    ds_read_b64_tr_b16 a[186:187], v18 offset:12288
    v_mfma_f32_16x16x32_bf16 v[72:75], a[140:143], a[36:39], v[72:75]
    ds_read_b64_tr_b16 a[188:189], v19 offset:8192
    v_mfma_f32_16x16x32_bf16 v[76:79], a[140:143], a[108:111], v[76:79]
    ds_read_b64_tr_b16 a[190:191], v19 offset:12288
    s_waitcnt vmcnt(8)
    s_barrier
    s_waitcnt lgkmcnt(15)
    v_mfma_f32_16x16x32_bf16 v[80:83], a[144:147], a[36:39], v[80:83]
    ds_read_b64_tr_b16 a[128:129], v244 offset:16384
    v_mfma_f32_16x16x32_bf16 v[84:87], a[144:147], a[108:111], v[84:87]
    s_add_u32 m0, s47, 49152
    ds_read_b64_tr_b16 a[130:131], v244 offset:20480
    v_mfma_f32_16x16x32_bf16 v[88:91], a[148:151], a[36:39], v[88:91]
    ds_read_b64_tr_b16 a[132:133], v245 offset:16384
    s_mov_b32 s50, 3670016
    v_mfma_f32_16x16x32_bf16 v[92:95], a[148:151], a[108:111], v[92:95]
    buffer_load_dwordx4 v240, s[16:19], s50 offen offset:0 lds
    ds_read_b64_tr_b16 a[134:135], v245 offset:20480
    v_mfma_f32_16x16x32_bf16 v[96:99], a[152:155], a[36:39], v[96:99]
    ds_read_b64_tr_b16 a[136:137], v246 offset:16384
    v_mfma_f32_16x16x32_bf16 v[100:103], a[152:155], a[108:111], v[100:103]
    ds_read_b64_tr_b16 a[138:139], v246 offset:20480
    v_mfma_f32_16x16x32_bf16 v[104:107], a[156:159], a[36:39], v[104:107]
    ds_read_b64_tr_b16 a[140:141], v247 offset:16384
    ds_read_b64_tr_b16 a[142:143], v247 offset:20480
    v_mfma_f32_16x16x32_bf16 v[108:111], a[156:159], a[108:111], v[108:111]
    buffer_load_dwordx4 v241, s[16:19], s50 offen offset:1024 lds
    s_waitcnt lgkmcnt(15)
    v_mfma_f32_16x16x32_bf16 v[112:115], a[160:163], a[36:39], v[112:115]
    ds_read_b64_tr_b16 a[144:145], v248 offset:16384
    v_mfma_f32_16x16x32_bf16 v[116:119], a[160:163], a[108:111], v[116:119]
    ds_read_b64_tr_b16 a[146:147], v248 offset:20480
    v_mfma_f32_16x16x32_bf16 v[120:123], a[164:167], a[36:39], v[120:123]
    ds_read_b64_tr_b16 a[148:149], v249 offset:16384
    ds_read_b64_tr_b16 a[150:151], v249 offset:20480
    v_mfma_f32_16x16x32_bf16 v[124:127], a[164:167], a[108:111], v[124:127]
    buffer_load_dwordx4 v242, s[16:19], s50 offen offset:2048 lds
    v_mfma_f32_16x16x32_bf16 v[128:131], a[168:171], a[36:39], v[128:131]
    ds_read_b64_tr_b16 a[152:153], v250 offset:16384
    v_mfma_f32_16x16x32_bf16 v[132:135], a[168:171], a[108:111], v[132:135]
    ds_read_b64_tr_b16 a[154:155], v250 offset:20480
    v_mfma_f32_16x16x32_bf16 v[136:139], a[172:175], a[36:39], v[136:139]
    ds_read_b64_tr_b16 a[156:157], v251 offset:16384
    ds_read_b64_tr_b16 a[158:159], v251 offset:20480
    v_mfma_f32_16x16x32_bf16 v[140:143], a[172:175], a[108:111], v[140:143]
    buffer_load_dwordx4 v243, s[16:19], s50 offen offset:3072 lds
    s_waitcnt lgkmcnt(15)
    v_mfma_f32_16x16x32_bf16 v[144:147], a[176:179], a[36:39], v[144:147]
    ds_read_b64_tr_b16 a[160:161], v12 offset:16384
    v_mfma_f32_16x16x32_bf16 v[148:151], a[176:179], a[108:111], v[148:151]
    s_add_u32 m0, s47, 114688
    ds_read_b64_tr_b16 a[162:163], v12 offset:20480
    v_mfma_f32_16x16x32_bf16 v[152:155], a[180:183], a[36:39], v[152:155]
    ds_read_b64_tr_b16 a[164:165], v13 offset:16384
    s_mov_b32 s50, 3670272
    v_mfma_f32_16x16x32_bf16 v[156:159], a[180:183], a[108:111], v[156:159]
    buffer_load_dwordx4 v240, s[16:19], s50 offen offset:0 lds
    ds_read_b64_tr_b16 a[166:167], v13 offset:20480
    v_mfma_f32_16x16x32_bf16 v[160:163], a[184:187], a[36:39], v[160:163]
    ds_read_b64_tr_b16 a[168:169], v14 offset:16384
    v_mfma_f32_16x16x32_bf16 v[164:167], a[184:187], a[108:111], v[164:167]
    ds_read_b64_tr_b16 a[170:171], v14 offset:20480
    v_mfma_f32_16x16x32_bf16 v[168:171], a[188:191], a[36:39], v[168:171]
    ds_read_b64_tr_b16 a[172:173], v15 offset:16384
    ds_read_b64_tr_b16 a[174:175], v15 offset:20480
    v_mfma_f32_16x16x32_bf16 v[172:175], a[188:191], a[108:111], v[172:175]
    buffer_load_dwordx4 v241, s[16:19], s50 offen offset:1024 lds
    s_waitcnt lgkmcnt(15)
    v_mfma_f32_16x16x32_bf16 v[48:51], a[128:131], a[40:43], v[48:51]
    ds_read_b64_tr_b16 a[176:177], v16 offset:16384
    v_mfma_f32_16x16x32_bf16 v[52:55], a[128:131], a[112:115], v[52:55]
    ds_read_b64_tr_b16 a[178:179], v16 offset:20480
    v_mfma_f32_16x16x32_bf16 v[56:59], a[132:135], a[40:43], v[56:59]
    ds_read_b64_tr_b16 a[180:181], v17 offset:16384
    ds_read_b64_tr_b16 a[182:183], v17 offset:20480
    v_mfma_f32_16x16x32_bf16 v[60:63], a[132:135], a[112:115], v[60:63]
    buffer_load_dwordx4 v242, s[16:19], s50 offen offset:2048 lds
    v_mfma_f32_16x16x32_bf16 v[64:67], a[136:139], a[40:43], v[64:67]
    ds_read_b64_tr_b16 a[184:185], v18 offset:16384
    v_mfma_f32_16x16x32_bf16 v[68:71], a[136:139], a[112:115], v[68:71]
    ds_read_b64_tr_b16 a[186:187], v18 offset:20480
    v_mfma_f32_16x16x32_bf16 v[72:75], a[140:143], a[40:43], v[72:75]
    ds_read_b64_tr_b16 a[188:189], v19 offset:16384
    ds_read_b64_tr_b16 a[190:191], v19 offset:20480
    v_mfma_f32_16x16x32_bf16 v[76:79], a[140:143], a[112:115], v[76:79]
    buffer_load_dwordx4 v243, s[16:19], s50 offen offset:3072 lds
    s_waitcnt lgkmcnt(15)
    v_mfma_f32_16x16x32_bf16 v[80:83], a[144:147], a[40:43], v[80:83]
    ds_read_b64_tr_b16 a[128:129], v244 offset:24576
    v_mfma_f32_16x16x32_bf16 v[84:87], a[144:147], a[112:115], v[84:87]
    ds_read_b64_tr_b16 a[130:131], v244 offset:28672
    v_mfma_f32_16x16x32_bf16 v[88:91], a[148:151], a[40:43], v[88:91]
    ds_read_b64_tr_b16 a[132:133], v245 offset:24576
    v_mfma_f32_16x16x32_bf16 v[92:95], a[148:151], a[112:115], v[92:95]
    ds_read_b64_tr_b16 a[134:135], v245 offset:28672
    v_mfma_f32_16x16x32_bf16 v[96:99], a[152:155], a[40:43], v[96:99]
    ds_read_b64_tr_b16 a[136:137], v246 offset:24576
    v_mfma_f32_16x16x32_bf16 v[100:103], a[152:155], a[112:115], v[100:103]
    ds_read_b64_tr_b16 a[138:139], v246 offset:28672
    v_mfma_f32_16x16x32_bf16 v[104:107], a[156:159], a[40:43], v[104:107]
    ds_read_b64_tr_b16 a[140:141], v247 offset:24576
    v_mfma_f32_16x16x32_bf16 v[108:111], a[156:159], a[112:115], v[108:111]
    ds_read_b64_tr_b16 a[142:143], v247 offset:28672
    s_waitcnt lgkmcnt(15)
    v_mfma_f32_16x16x32_bf16 v[112:115], a[160:163], a[40:43], v[112:115]
    ds_read_b64_tr_b16 a[144:145], v248 offset:24576
    v_mfma_f32_16x16x32_bf16 v[116:119], a[160:163], a[112:115], v[116:119]
    ds_read_b64_tr_b16 a[146:147], v248 offset:28672
    v_mfma_f32_16x16x32_bf16 v[120:123], a[164:167], a[40:43], v[120:123]
    ds_read_b64_tr_b16 a[148:149], v249 offset:24576
    v_mfma_f32_16x16x32_bf16 v[124:127], a[164:167], a[112:115], v[124:127]
    ds_read_b64_tr_b16 a[150:151], v249 offset:28672
    v_mfma_f32_16x16x32_bf16 v[128:131], a[168:171], a[40:43], v[128:131]
    ds_read_b64_tr_b16 a[152:153], v250 offset:24576
    v_mfma_f32_16x16x32_bf16 v[132:135], a[168:171], a[112:115], v[132:135]
    ds_read_b64_tr_b16 a[154:155], v250 offset:28672
    v_mfma_f32_16x16x32_bf16 v[136:139], a[172:175], a[40:43], v[136:139]
    ds_read_b64_tr_b16 a[156:157], v251 offset:24576
    v_mfma_f32_16x16x32_bf16 v[140:143], a[172:175], a[112:115], v[140:143]
    ds_read_b64_tr_b16 a[158:159], v251 offset:28672
    s_waitcnt lgkmcnt(15)
    v_mfma_f32_16x16x32_bf16 v[144:147], a[176:179], a[40:43], v[144:147]
    ds_read_b64_tr_b16 a[160:161], v12 offset:24576
    v_mfma_f32_16x16x32_bf16 v[148:151], a[176:179], a[112:115], v[148:151]
    ds_read_b64_tr_b16 a[162:163], v12 offset:28672
    v_mfma_f32_16x16x32_bf16 v[152:155], a[180:183], a[40:43], v[152:155]
    ds_read_b64_tr_b16 a[164:165], v13 offset:24576
    v_mfma_f32_16x16x32_bf16 v[156:159], a[180:183], a[112:115], v[156:159]
    ds_read_b64_tr_b16 a[166:167], v13 offset:28672
    v_mfma_f32_16x16x32_bf16 v[160:163], a[184:187], a[40:43], v[160:163]
    ds_read_b64_tr_b16 a[168:169], v14 offset:24576
    v_mfma_f32_16x16x32_bf16 v[164:167], a[184:187], a[112:115], v[164:167]
    ds_read_b64_tr_b16 a[170:171], v14 offset:28672
    v_mfma_f32_16x16x32_bf16 v[168:171], a[188:191], a[40:43], v[168:171]
    ds_read_b64_tr_b16 a[172:173], v15 offset:24576
    v_mfma_f32_16x16x32_bf16 v[172:175], a[188:191], a[112:115], v[172:175]
    ds_read_b64_tr_b16 a[174:175], v15 offset:28672
    s_waitcnt lgkmcnt(15)
    v_mfma_f32_16x16x32_bf16 v[48:51], a[128:131], a[44:47], v[48:51]
    ds_read_b64_tr_b16 a[176:177], v16 offset:24576
    v_mfma_f32_16x16x32_bf16 v[52:55], a[128:131], a[116:119], v[52:55]
    ds_read_b64_tr_b16 a[178:179], v16 offset:28672
    v_mfma_f32_16x16x32_bf16 v[56:59], a[132:135], a[44:47], v[56:59]
    ds_read_b64_tr_b16 a[180:181], v17 offset:24576
    v_mfma_f32_16x16x32_bf16 v[60:63], a[132:135], a[116:119], v[60:63]
    ds_read_b64_tr_b16 a[182:183], v17 offset:28672
    v_mfma_f32_16x16x32_bf16 v[64:67], a[136:139], a[44:47], v[64:67]
    ds_read_b64_tr_b16 a[184:185], v18 offset:24576
    v_mfma_f32_16x16x32_bf16 v[68:71], a[136:139], a[116:119], v[68:71]
    ds_read_b64_tr_b16 a[186:187], v18 offset:28672
    v_mfma_f32_16x16x32_bf16 v[72:75], a[140:143], a[44:47], v[72:75]
    ds_read_b64_tr_b16 a[188:189], v19 offset:24576
    v_mfma_f32_16x16x32_bf16 v[76:79], a[140:143], a[116:119], v[76:79]
    ds_read_b64_tr_b16 a[190:191], v19 offset:28672
    s_waitcnt vmcnt(8)
    s_barrier
    s_waitcnt lgkmcnt(15)
    v_mfma_f32_16x16x32_bf16 v[80:83], a[144:147], a[44:47], v[80:83]
    ds_read_b64_tr_b16 a[128:129], v244 offset:32768
    v_mfma_f32_16x16x32_bf16 v[84:87], a[144:147], a[116:119], v[84:87]
    s_add_u32 m0, s47, 0
    ds_read_b64_tr_b16 a[130:131], v244 offset:36864
    v_mfma_f32_16x16x32_bf16 v[88:91], a[148:151], a[44:47], v[88:91]
    ds_read_b64_tr_b16 a[132:133], v245 offset:32768
    s_mov_b32 s50, 4194304
    v_mfma_f32_16x16x32_bf16 v[92:95], a[148:151], a[116:119], v[92:95]
    buffer_load_dwordx4 v240, s[16:19], s50 offen offset:0 lds
    ds_read_b64_tr_b16 a[134:135], v245 offset:36864
    v_mfma_f32_16x16x32_bf16 v[96:99], a[152:155], a[44:47], v[96:99]
    ds_read_b64_tr_b16 a[136:137], v246 offset:32768
    v_mfma_f32_16x16x32_bf16 v[100:103], a[152:155], a[116:119], v[100:103]
    ds_read_b64_tr_b16 a[138:139], v246 offset:36864
    v_mfma_f32_16x16x32_bf16 v[104:107], a[156:159], a[44:47], v[104:107]
    ds_read_b64_tr_b16 a[140:141], v247 offset:32768
    ds_read_b64_tr_b16 a[142:143], v247 offset:36864
    v_mfma_f32_16x16x32_bf16 v[108:111], a[156:159], a[116:119], v[108:111]
    buffer_load_dwordx4 v241, s[16:19], s50 offen offset:1024 lds
    s_waitcnt lgkmcnt(15)
    v_mfma_f32_16x16x32_bf16 v[112:115], a[160:163], a[44:47], v[112:115]
    ds_read_b64_tr_b16 a[144:145], v248 offset:32768
    v_mfma_f32_16x16x32_bf16 v[116:119], a[160:163], a[116:119], v[116:119]
    ds_read_b64_tr_b16 a[146:147], v248 offset:36864
    v_mfma_f32_16x16x32_bf16 v[120:123], a[164:167], a[44:47], v[120:123]
    ds_read_b64_tr_b16 a[148:149], v249 offset:32768
    ds_read_b64_tr_b16 a[150:151], v249 offset:36864
    v_mfma_f32_16x16x32_bf16 v[124:127], a[164:167], a[116:119], v[124:127]
    buffer_load_dwordx4 v242, s[16:19], s50 offen offset:2048 lds
    v_mfma_f32_16x16x32_bf16 v[128:131], a[168:171], a[44:47], v[128:131]
    ds_read_b64_tr_b16 a[152:153], v250 offset:32768
    v_mfma_f32_16x16x32_bf16 v[132:135], a[168:171], a[116:119], v[132:135]
    ds_read_b64_tr_b16 a[154:155], v250 offset:36864
    v_mfma_f32_16x16x32_bf16 v[136:139], a[172:175], a[44:47], v[136:139]
    ds_read_b64_tr_b16 a[156:157], v251 offset:32768
    ds_read_b64_tr_b16 a[158:159], v251 offset:36864
    v_mfma_f32_16x16x32_bf16 v[140:143], a[172:175], a[116:119], v[140:143]
    buffer_load_dwordx4 v243, s[16:19], s50 offen offset:3072 lds
    s_waitcnt lgkmcnt(15)
    v_mfma_f32_16x16x32_bf16 v[144:147], a[176:179], a[44:47], v[144:147]
    ds_read_b64_tr_b16 a[160:161], v12 offset:32768
    v_mfma_f32_16x16x32_bf16 v[148:151], a[176:179], a[116:119], v[148:151]
    s_add_u32 m0, s47, 65536
    ds_read_b64_tr_b16 a[162:163], v12 offset:36864
    v_mfma_f32_16x16x32_bf16 v[152:155], a[180:183], a[44:47], v[152:155]
    ds_read_b64_tr_b16 a[164:165], v13 offset:32768
    s_mov_b32 s50, 4194560
    v_mfma_f32_16x16x32_bf16 v[156:159], a[180:183], a[116:119], v[156:159]
    buffer_load_dwordx4 v240, s[16:19], s50 offen offset:0 lds
    ds_read_b64_tr_b16 a[166:167], v13 offset:36864
    v_mfma_f32_16x16x32_bf16 v[160:163], a[184:187], a[44:47], v[160:163]
    ds_read_b64_tr_b16 a[168:169], v14 offset:32768
    v_mfma_f32_16x16x32_bf16 v[164:167], a[184:187], a[116:119], v[164:167]
    ds_read_b64_tr_b16 a[170:171], v14 offset:36864
    v_mfma_f32_16x16x32_bf16 v[168:171], a[188:191], a[44:47], v[168:171]
    ds_read_b64_tr_b16 a[172:173], v15 offset:32768
    ds_read_b64_tr_b16 a[174:175], v15 offset:36864
    v_mfma_f32_16x16x32_bf16 v[172:175], a[188:191], a[116:119], v[172:175]
    buffer_load_dwordx4 v241, s[16:19], s50 offen offset:1024 lds
    s_waitcnt lgkmcnt(15)
    v_mfma_f32_16x16x32_bf16 v[48:51], a[128:131], a[48:51], v[48:51]
    ds_read_b64_tr_b16 a[176:177], v16 offset:32768
    v_mfma_f32_16x16x32_bf16 v[52:55], a[128:131], a[120:123], v[52:55]
    ds_read_b64_tr_b16 a[178:179], v16 offset:36864
    v_mfma_f32_16x16x32_bf16 v[56:59], a[132:135], a[48:51], v[56:59]
    ds_read_b64_tr_b16 a[180:181], v17 offset:32768
    ds_read_b64_tr_b16 a[182:183], v17 offset:36864
    v_mfma_f32_16x16x32_bf16 v[60:63], a[132:135], a[120:123], v[60:63]
    buffer_load_dwordx4 v242, s[16:19], s50 offen offset:2048 lds
    v_mfma_f32_16x16x32_bf16 v[64:67], a[136:139], a[48:51], v[64:67]
    ds_read_b64_tr_b16 a[184:185], v18 offset:32768
    v_mfma_f32_16x16x32_bf16 v[68:71], a[136:139], a[120:123], v[68:71]
    ds_read_b64_tr_b16 a[186:187], v18 offset:36864
    v_mfma_f32_16x16x32_bf16 v[72:75], a[140:143], a[48:51], v[72:75]
    ds_read_b64_tr_b16 a[188:189], v19 offset:32768
    ds_read_b64_tr_b16 a[190:191], v19 offset:36864
    v_mfma_f32_16x16x32_bf16 v[76:79], a[140:143], a[120:123], v[76:79]
    buffer_load_dwordx4 v243, s[16:19], s50 offen offset:3072 lds
    s_waitcnt lgkmcnt(15)
    v_mfma_f32_16x16x32_bf16 v[80:83], a[144:147], a[48:51], v[80:83]
    ds_read_b64_tr_b16 a[128:129], v244 offset:40960
    v_mfma_f32_16x16x32_bf16 v[84:87], a[144:147], a[120:123], v[84:87]
    ds_read_b64_tr_b16 a[130:131], v244 offset:45056
    v_mfma_f32_16x16x32_bf16 v[88:91], a[148:151], a[48:51], v[88:91]
    ds_read_b64_tr_b16 a[132:133], v245 offset:40960
    v_mfma_f32_16x16x32_bf16 v[92:95], a[148:151], a[120:123], v[92:95]
    ds_read_b64_tr_b16 a[134:135], v245 offset:45056
    v_mfma_f32_16x16x32_bf16 v[96:99], a[152:155], a[48:51], v[96:99]
    ds_read_b64_tr_b16 a[136:137], v246 offset:40960
    v_mfma_f32_16x16x32_bf16 v[100:103], a[152:155], a[120:123], v[100:103]
    ds_read_b64_tr_b16 a[138:139], v246 offset:45056
    v_mfma_f32_16x16x32_bf16 v[104:107], a[156:159], a[48:51], v[104:107]
    ds_read_b64_tr_b16 a[140:141], v247 offset:40960
    v_mfma_f32_16x16x32_bf16 v[108:111], a[156:159], a[120:123], v[108:111]
    ds_read_b64_tr_b16 a[142:143], v247 offset:45056
    s_waitcnt lgkmcnt(15)
    v_mfma_f32_16x16x32_bf16 v[112:115], a[160:163], a[48:51], v[112:115]
    ds_read_b64_tr_b16 a[144:145], v248 offset:40960
    v_mfma_f32_16x16x32_bf16 v[116:119], a[160:163], a[120:123], v[116:119]
    ds_read_b64_tr_b16 a[146:147], v248 offset:45056
    v_mfma_f32_16x16x32_bf16 v[120:123], a[164:167], a[48:51], v[120:123]
    ds_read_b64_tr_b16 a[148:149], v249 offset:40960
    v_mfma_f32_16x16x32_bf16 v[124:127], a[164:167], a[120:123], v[124:127]
    ds_read_b64_tr_b16 a[150:151], v249 offset:45056
    v_mfma_f32_16x16x32_bf16 v[128:131], a[168:171], a[48:51], v[128:131]
    ds_read_b64_tr_b16 a[152:153], v250 offset:40960
    v_mfma_f32_16x16x32_bf16 v[132:135], a[168:171], a[120:123], v[132:135]
    ds_read_b64_tr_b16 a[154:155], v250 offset:45056
    v_mfma_f32_16x16x32_bf16 v[136:139], a[172:175], a[48:51], v[136:139]
    ds_read_b64_tr_b16 a[156:157], v251 offset:40960
    v_mfma_f32_16x16x32_bf16 v[140:143], a[172:175], a[120:123], v[140:143]
    ds_read_b64_tr_b16 a[158:159], v251 offset:45056
    s_waitcnt lgkmcnt(15)
    v_mfma_f32_16x16x32_bf16 v[144:147], a[176:179], a[48:51], v[144:147]
    ds_read_b64_tr_b16 a[160:161], v12 offset:40960
    v_mfma_f32_16x16x32_bf16 v[148:151], a[176:179], a[120:123], v[148:151]
    ds_read_b64_tr_b16 a[162:163], v12 offset:45056
    v_mfma_f32_16x16x32_bf16 v[152:155], a[180:183], a[48:51], v[152:155]
    ds_read_b64_tr_b16 a[164:165], v13 offset:40960
    v_mfma_f32_16x16x32_bf16 v[156:159], a[180:183], a[120:123], v[156:159]
    ds_read_b64_tr_b16 a[166:167], v13 offset:45056
    v_mfma_f32_16x16x32_bf16 v[160:163], a[184:187], a[48:51], v[160:163]
    ds_read_b64_tr_b16 a[168:169], v14 offset:40960
    v_mfma_f32_16x16x32_bf16 v[164:167], a[184:187], a[120:123], v[164:167]
    ds_read_b64_tr_b16 a[170:171], v14 offset:45056
    v_mfma_f32_16x16x32_bf16 v[168:171], a[188:191], a[48:51], v[168:171]
    ds_read_b64_tr_b16 a[172:173], v15 offset:40960
    v_mfma_f32_16x16x32_bf16 v[172:175], a[188:191], a[120:123], v[172:175]
    ds_read_b64_tr_b16 a[174:175], v15 offset:45056
    s_waitcnt lgkmcnt(15)
    v_mfma_f32_16x16x32_bf16 v[48:51], a[128:131], a[52:55], v[48:51]
    ds_read_b64_tr_b16 a[176:177], v16 offset:40960
    v_mfma_f32_16x16x32_bf16 v[52:55], a[128:131], a[124:127], v[52:55]
    ds_read_b64_tr_b16 a[178:179], v16 offset:45056
    v_mfma_f32_16x16x32_bf16 v[56:59], a[132:135], a[52:55], v[56:59]
    ds_read_b64_tr_b16 a[180:181], v17 offset:40960
    v_mfma_f32_16x16x32_bf16 v[60:63], a[132:135], a[124:127], v[60:63]
    ds_read_b64_tr_b16 a[182:183], v17 offset:45056
    v_mfma_f32_16x16x32_bf16 v[64:67], a[136:139], a[52:55], v[64:67]
    ds_read_b64_tr_b16 a[184:185], v18 offset:40960
    v_mfma_f32_16x16x32_bf16 v[68:71], a[136:139], a[124:127], v[68:71]
    ds_read_b64_tr_b16 a[186:187], v18 offset:45056
    v_mfma_f32_16x16x32_bf16 v[72:75], a[140:143], a[52:55], v[72:75]
    ds_read_b64_tr_b16 a[188:189], v19 offset:40960
    v_mfma_f32_16x16x32_bf16 v[76:79], a[140:143], a[124:127], v[76:79]
    ds_read_b64_tr_b16 a[190:191], v19 offset:45056
    s_waitcnt vmcnt(8)
    s_barrier
    s_waitcnt lgkmcnt(15)
    v_mfma_f32_16x16x32_bf16 v[80:83], a[144:147], a[52:55], v[80:83]
    ds_read_b64_tr_b16 a[128:129], v244 offset:49152
    v_mfma_f32_16x16x32_bf16 v[84:87], a[144:147], a[124:127], v[84:87]
    ds_read_b64_tr_b16 a[130:131], v244 offset:53248
    v_mfma_f32_16x16x32_bf16 v[88:91], a[148:151], a[52:55], v[88:91]
    ds_read_b64_tr_b16 a[132:133], v245 offset:49152
    s_add_u32 m0, s47, 16384
    v_mfma_f32_16x16x32_bf16 v[92:95], a[148:151], a[124:127], v[92:95]
    buffer_load_dwordx4 v20, s[8:11], s48 offen offset:0 lds
    ds_read_b64_tr_b16 a[134:135], v245 offset:53248
    v_mfma_f32_16x16x32_bf16 v[96:99], a[152:155], a[52:55], v[96:99]
    ds_read_b64_tr_b16 a[136:137], v246 offset:49152
    v_mfma_f32_16x16x32_bf16 v[100:103], a[152:155], a[124:127], v[100:103]
    ds_read_b64_tr_b16 a[138:139], v246 offset:53248
    v_mfma_f32_16x16x32_bf16 v[104:107], a[156:159], a[52:55], v[104:107]
    ds_read_b64_tr_b16 a[140:141], v247 offset:49152
    ds_read_b64_tr_b16 a[142:143], v247 offset:53248
    v_mfma_f32_16x16x32_bf16 v[108:111], a[156:159], a[124:127], v[108:111]
    buffer_load_dwordx4 v21, s[8:11], s48 offen offset:1024 lds
    s_waitcnt lgkmcnt(15)
    v_mfma_f32_16x16x32_bf16 v[112:115], a[160:163], a[52:55], v[112:115]
    ds_read_b64_tr_b16 a[144:145], v248 offset:49152
    v_mfma_f32_16x16x32_bf16 v[116:119], a[160:163], a[124:127], v[116:119]
    ds_read_b64_tr_b16 a[146:147], v248 offset:53248
    v_mfma_f32_16x16x32_bf16 v[120:123], a[164:167], a[52:55], v[120:123]
    ds_read_b64_tr_b16 a[148:149], v249 offset:49152
    ds_read_b64_tr_b16 a[150:151], v249 offset:53248
    v_mfma_f32_16x16x32_bf16 v[124:127], a[164:167], a[124:127], v[124:127]
    buffer_load_dwordx4 v22, s[8:11], s48 offen offset:2048 lds
    v_mfma_f32_16x16x32_bf16 v[128:131], a[168:171], a[52:55], v[128:131]
    ds_read_b64_tr_b16 a[152:153], v250 offset:49152
    v_mfma_f32_16x16x32_bf16 v[132:135], a[168:171], a[124:127], v[132:135]
    ds_read_b64_tr_b16 a[154:155], v250 offset:53248
    v_mfma_f32_16x16x32_bf16 v[136:139], a[172:175], a[52:55], v[136:139]
    ds_read_b64_tr_b16 a[156:157], v251 offset:49152
    ds_read_b64_tr_b16 a[158:159], v251 offset:53248
    v_mfma_f32_16x16x32_bf16 v[140:143], a[172:175], a[124:127], v[140:143]
    buffer_load_dwordx4 v23, s[8:11], s48 offen offset:3072 lds
    s_waitcnt lgkmcnt(15)
    v_mfma_f32_16x16x32_bf16 v[144:147], a[176:179], a[52:55], v[144:147]
    ds_read_b64_tr_b16 a[160:161], v12 offset:49152
    s_add_u32 s48, s48, 0x4000
    v_mfma_f32_16x16x32_bf16 v[148:151], a[176:179], a[124:127], v[148:151]
    ds_read_b64_tr_b16 a[162:163], v12 offset:53248
    v_mfma_f32_16x16x32_bf16 v[152:155], a[180:183], a[52:55], v[152:155]
    ds_read_b64_tr_b16 a[164:165], v13 offset:49152
    v_mfma_f32_16x16x32_bf16 v[156:159], a[180:183], a[124:127], v[156:159]
    ds_read_b64_tr_b16 a[166:167], v13 offset:53248
    v_mfma_f32_16x16x32_bf16 v[160:163], a[184:187], a[52:55], v[160:163]
    ds_read_b64_tr_b16 a[168:169], v14 offset:49152
    v_mfma_f32_16x16x32_bf16 v[164:167], a[184:187], a[124:127], v[164:167]
    ds_read_b64_tr_b16 a[170:171], v14 offset:53248
    v_mfma_f32_16x16x32_bf16 v[168:171], a[188:191], a[52:55], v[168:171]
    ds_read_b64_tr_b16 a[172:173], v15 offset:49152
    v_mfma_f32_16x16x32_bf16 v[172:175], a[188:191], a[124:127], v[172:175]
    ds_read_b64_tr_b16 a[174:175], v15 offset:53248
    s_waitcnt lgkmcnt(15)
    v_mfma_f32_16x16x32_bf16 v[48:51], a[128:131], a[56:59], v[48:51]
    ds_read_b64_tr_b16 a[176:177], v16 offset:49152
    v_mfma_f32_16x16x32_bf16 v[52:55], a[128:131], a[192:195], v[52:55]
    ds_read_b64_tr_b16 a[178:179], v16 offset:53248
    v_mfma_f32_16x16x32_bf16 v[56:59], a[132:135], a[56:59], v[56:59]
    ds_read_b64_tr_b16 a[180:181], v17 offset:49152
    v_mfma_f32_16x16x32_bf16 v[60:63], a[132:135], a[192:195], v[60:63]
    ds_read_b64_tr_b16 a[182:183], v17 offset:53248
    v_mfma_f32_16x16x32_bf16 v[64:67], a[136:139], a[56:59], v[64:67]
    ds_read_b64_tr_b16 a[184:185], v18 offset:49152
    v_mfma_f32_16x16x32_bf16 v[68:71], a[136:139], a[192:195], v[68:71]
    ds_read_b64_tr_b16 a[186:187], v18 offset:53248
    v_mfma_f32_16x16x32_bf16 v[72:75], a[140:143], a[56:59], v[72:75]
    ds_read_b64_tr_b16 a[188:189], v19 offset:49152
    v_mfma_f32_16x16x32_bf16 v[76:79], a[140:143], a[192:195], v[76:79]
    ds_read_b64_tr_b16 a[190:191], v19 offset:53248
    s_waitcnt lgkmcnt(15)
    v_mfma_f32_16x16x32_bf16 v[80:83], a[144:147], a[56:59], v[80:83]
    ds_read_b64_tr_b16 a[128:129], v244 offset:57344
    v_mfma_f32_16x16x32_bf16 v[84:87], a[144:147], a[192:195], v[84:87]
    ds_read_b64_tr_b16 a[130:131], v244 offset:61440
    v_mfma_f32_16x16x32_bf16 v[88:91], a[148:151], a[56:59], v[88:91]
    ds_read_b64_tr_b16 a[132:133], v245 offset:57344
    v_mfma_f32_16x16x32_bf16 v[92:95], a[148:151], a[192:195], v[92:95]
    ds_read_b64_tr_b16 a[134:135], v245 offset:61440
    v_mfma_f32_16x16x32_bf16 v[96:99], a[152:155], a[56:59], v[96:99]
    ds_read_b64_tr_b16 a[136:137], v246 offset:57344
    v_mfma_f32_16x16x32_bf16 v[100:103], a[152:155], a[192:195], v[100:103]
    ds_read_b64_tr_b16 a[138:139], v246 offset:61440
    v_mfma_f32_16x16x32_bf16 v[104:107], a[156:159], a[56:59], v[104:107]
    ds_read_b64_tr_b16 a[140:141], v247 offset:57344
    v_mfma_f32_16x16x32_bf16 v[108:111], a[156:159], a[192:195], v[108:111]
    ds_read_b64_tr_b16 a[142:143], v247 offset:61440
    s_waitcnt lgkmcnt(15)
    v_mfma_f32_16x16x32_bf16 v[112:115], a[160:163], a[56:59], v[112:115]
    ds_read_b64_tr_b16 a[144:145], v248 offset:57344
    v_mfma_f32_16x16x32_bf16 v[116:119], a[160:163], a[192:195], v[116:119]
    ds_read_b64_tr_b16 a[146:147], v248 offset:61440
    v_mfma_f32_16x16x32_bf16 v[120:123], a[164:167], a[56:59], v[120:123]
    ds_read_b64_tr_b16 a[148:149], v249 offset:57344
    v_mfma_f32_16x16x32_bf16 v[124:127], a[164:167], a[192:195], v[124:127]
    ds_read_b64_tr_b16 a[150:151], v249 offset:61440
    v_mfma_f32_16x16x32_bf16 v[128:131], a[168:171], a[56:59], v[128:131]
    ds_read_b64_tr_b16 a[152:153], v250 offset:57344
    v_mfma_f32_16x16x32_bf16 v[132:135], a[168:171], a[192:195], v[132:135]
    ds_read_b64_tr_b16 a[154:155], v250 offset:61440
    v_mfma_f32_16x16x32_bf16 v[136:139], a[172:175], a[56:59], v[136:139]
    ds_read_b64_tr_b16 a[156:157], v251 offset:57344
    v_mfma_f32_16x16x32_bf16 v[140:143], a[172:175], a[192:195], v[140:143]
    ds_read_b64_tr_b16 a[158:159], v251 offset:61440
    s_waitcnt lgkmcnt(15)
    v_mfma_f32_16x16x32_bf16 v[144:147], a[176:179], a[56:59], v[144:147]
    ds_read_b64_tr_b16 a[160:161], v12 offset:57344
    v_mfma_f32_16x16x32_bf16 v[148:151], a[176:179], a[192:195], v[148:151]
    ds_read_b64_tr_b16 a[162:163], v12 offset:61440
    v_mfma_f32_16x16x32_bf16 v[152:155], a[180:183], a[56:59], v[152:155]
    ds_read_b64_tr_b16 a[164:165], v13 offset:57344
    v_mfma_f32_16x16x32_bf16 v[156:159], a[180:183], a[192:195], v[156:159]
    ds_read_b64_tr_b16 a[166:167], v13 offset:61440
    v_mfma_f32_16x16x32_bf16 v[160:163], a[184:187], a[56:59], v[160:163]
    ds_read_b64_tr_b16 a[168:169], v14 offset:57344
    v_mfma_f32_16x16x32_bf16 v[164:167], a[184:187], a[192:195], v[164:167]
    ds_read_b64_tr_b16 a[170:171], v14 offset:61440
    v_mfma_f32_16x16x32_bf16 v[168:171], a[188:191], a[56:59], v[168:171]
    ds_read_b64_tr_b16 a[172:173], v15 offset:57344
    v_mfma_f32_16x16x32_bf16 v[172:175], a[188:191], a[192:195], v[172:175]
    ds_read_b64_tr_b16 a[174:175], v15 offset:61440
    s_waitcnt lgkmcnt(15)
    v_mfma_f32_16x16x32_bf16 v[48:51], a[128:131], a[60:63], v[48:51]
    ds_read_b64_tr_b16 a[176:177], v16 offset:57344
    v_mfma_f32_16x16x32_bf16 v[52:55], a[128:131], a[196:199], v[52:55]
    ds_read_b64_tr_b16 a[178:179], v16 offset:61440
    v_mfma_f32_16x16x32_bf16 v[56:59], a[132:135], a[60:63], v[56:59]
    ds_read_b64_tr_b16 a[180:181], v17 offset:57344
    v_mfma_f32_16x16x32_bf16 v[60:63], a[132:135], a[196:199], v[60:63]
    ds_read_b64_tr_b16 a[182:183], v17 offset:61440
    v_mfma_f32_16x16x32_bf16 v[64:67], a[136:139], a[60:63], v[64:67]
    ds_read_b64_tr_b16 a[184:185], v18 offset:57344
    v_mfma_f32_16x16x32_bf16 v[68:71], a[136:139], a[196:199], v[68:71]
    ds_read_b64_tr_b16 a[186:187], v18 offset:61440
    v_mfma_f32_16x16x32_bf16 v[72:75], a[140:143], a[60:63], v[72:75]
    ds_read_b64_tr_b16 a[188:189], v19 offset:57344
    v_mfma_f32_16x16x32_bf16 v[76:79], a[140:143], a[196:199], v[76:79]
    ds_read_b64_tr_b16 a[190:191], v19 offset:61440
    s_waitcnt vmcnt(4)
    s_barrier
    s_waitcnt lgkmcnt(15)
    v_mfma_f32_16x16x32_bf16 v[80:83], a[144:147], a[60:63], v[80:83]
    ds_read_b64_tr_b16 a[128:129], v244 offset:0
    v_mfma_f32_16x16x32_bf16 v[84:87], a[144:147], a[196:199], v[84:87]
    ds_read_b64_tr_b16 a[130:131], v244 offset:4096
    v_mfma_f32_16x16x32_bf16 v[88:91], a[148:151], a[60:63], v[88:91]
    ds_read_b64_tr_b16 a[132:133], v245 offset:0
    s_add_u32 m0, s47, 98304
    v_mfma_f32_16x16x32_bf16 v[92:95], a[148:151], a[196:199], v[92:95]
    buffer_load_dwordx4 v24, s[12:15], s49 offen offset:0 lds
    ds_read_b64_tr_b16 a[134:135], v245 offset:4096
    v_mfma_f32_16x16x32_bf16 v[96:99], a[152:155], a[60:63], v[96:99]
    ds_read_b64_tr_b16 a[136:137], v246 offset:0
    v_mfma_f32_16x16x32_bf16 v[100:103], a[152:155], a[196:199], v[100:103]
    ds_read_b64_tr_b16 a[138:139], v246 offset:4096
    v_mfma_f32_16x16x32_bf16 v[104:107], a[156:159], a[60:63], v[104:107]
    ds_read_b64_tr_b16 a[140:141], v247 offset:0
    ds_read_b64_tr_b16 a[142:143], v247 offset:4096
    v_mfma_f32_16x16x32_bf16 v[108:111], a[156:159], a[196:199], v[108:111]
    buffer_load_dwordx4 v25, s[12:15], s49 offen offset:1024 lds
    s_waitcnt lgkmcnt(15)
    v_mfma_f32_16x16x32_bf16 v[112:115], a[160:163], a[60:63], v[112:115]
    ds_read_b64_tr_b16 a[144:145], v248 offset:0
    v_mfma_f32_16x16x32_bf16 v[116:119], a[160:163], a[196:199], v[116:119]
    ds_read_b64_tr_b16 a[146:147], v248 offset:4096
    v_mfma_f32_16x16x32_bf16 v[120:123], a[164:167], a[60:63], v[120:123]
    ds_read_b64_tr_b16 a[148:149], v249 offset:0
    ds_read_b64_tr_b16 a[150:151], v249 offset:4096
    v_mfma_f32_16x16x32_bf16 v[124:127], a[164:167], a[196:199], v[124:127]
    buffer_load_dwordx4 v24, s[12:15], s49 offen offset:2048 lds
    v_mfma_f32_16x16x32_bf16 v[128:131], a[168:171], a[60:63], v[128:131]
    ds_read_b64_tr_b16 a[152:153], v250 offset:0
    v_mfma_f32_16x16x32_bf16 v[132:135], a[168:171], a[196:199], v[132:135]
    ds_read_b64_tr_b16 a[154:155], v250 offset:4096
    v_mfma_f32_16x16x32_bf16 v[136:139], a[172:175], a[60:63], v[136:139]
    ds_read_b64_tr_b16 a[156:157], v251 offset:0
    ds_read_b64_tr_b16 a[158:159], v251 offset:4096
    v_mfma_f32_16x16x32_bf16 v[140:143], a[172:175], a[196:199], v[140:143]
    buffer_load_dwordx4 v25, s[12:15], s49 offen offset:3072 lds
    s_waitcnt lgkmcnt(15)
    v_mfma_f32_16x16x32_bf16 v[144:147], a[176:179], a[60:63], v[144:147]
    ds_read_b64_tr_b16 a[160:161], v12 offset:0
    s_add_u32 s49, s49, 0x4000
    v_mfma_f32_16x16x32_bf16 v[148:151], a[176:179], a[196:199], v[148:151]
    ds_read_b64_tr_b16 a[162:163], v12 offset:4096
    v_mfma_f32_16x16x32_bf16 v[152:155], a[180:183], a[60:63], v[152:155]
    ds_read_b64_tr_b16 a[164:165], v13 offset:0
    s_add_u32 m0, s47, 32768
    v_mfma_f32_16x16x32_bf16 v[156:159], a[180:183], a[196:199], v[156:159]
    buffer_load_dwordx4 v20, s[8:11], s48 offen offset:0 lds
    ds_read_b64_tr_b16 a[166:167], v13 offset:4096
    v_mfma_f32_16x16x32_bf16 v[160:163], a[184:187], a[60:63], v[160:163]
    ds_read_b64_tr_b16 a[168:169], v14 offset:0
    v_mfma_f32_16x16x32_bf16 v[164:167], a[184:187], a[196:199], v[164:167]
    ds_read_b64_tr_b16 a[170:171], v14 offset:4096
    v_mfma_f32_16x16x32_bf16 v[168:171], a[188:191], a[60:63], v[168:171]
    ds_read_b64_tr_b16 a[172:173], v15 offset:0
    ds_read_b64_tr_b16 a[174:175], v15 offset:4096
    v_mfma_f32_16x16x32_bf16 v[172:175], a[188:191], a[196:199], v[172:175]
    buffer_load_dwordx4 v21, s[8:11], s48 offen offset:1024 lds
    s_waitcnt lgkmcnt(15)
    v_mfma_f32_16x16x32_bf16 v[48:51], a[128:131], a[64:67], v[48:51]
    ds_read_b64_tr_b16 a[176:177], v16 offset:0
    v_mfma_f32_16x16x32_bf16 v[52:55], a[128:131], a[200:203], v[52:55]
    ds_read_b64_tr_b16 a[178:179], v16 offset:4096
    v_mfma_f32_16x16x32_bf16 v[56:59], a[132:135], a[64:67], v[56:59]
    ds_read_b64_tr_b16 a[180:181], v17 offset:0
    ds_read_b64_tr_b16 a[182:183], v17 offset:4096
    v_mfma_f32_16x16x32_bf16 v[60:63], a[132:135], a[200:203], v[60:63]
    buffer_load_dwordx4 v22, s[8:11], s48 offen offset:2048 lds
    v_mfma_f32_16x16x32_bf16 v[64:67], a[136:139], a[64:67], v[64:67]
    ds_read_b64_tr_b16 a[184:185], v18 offset:0
    v_mfma_f32_16x16x32_bf16 v[68:71], a[136:139], a[200:203], v[68:71]
    ds_read_b64_tr_b16 a[186:187], v18 offset:4096
    v_mfma_f32_16x16x32_bf16 v[72:75], a[140:143], a[64:67], v[72:75]
    ds_read_b64_tr_b16 a[188:189], v19 offset:0
    ds_read_b64_tr_b16 a[190:191], v19 offset:4096
    v_mfma_f32_16x16x32_bf16 v[76:79], a[140:143], a[200:203], v[76:79]
    buffer_load_dwordx4 v23, s[8:11], s48 offen offset:3072 lds
    s_waitcnt lgkmcnt(15)
    v_mfma_f32_16x16x32_bf16 v[80:83], a[144:147], a[64:67], v[80:83]
    ds_read_b64_tr_b16 a[128:129], v244 offset:8192
    s_add_u32 s48, s48, 0x4000
    v_mfma_f32_16x16x32_bf16 v[84:87], a[144:147], a[200:203], v[84:87]
    ds_read_b64_tr_b16 a[130:131], v244 offset:12288
    v_mfma_f32_16x16x32_bf16 v[88:91], a[148:151], a[64:67], v[88:91]
    ds_read_b64_tr_b16 a[132:133], v245 offset:8192
    v_mfma_f32_16x16x32_bf16 v[92:95], a[148:151], a[200:203], v[92:95]
    ds_read_b64_tr_b16 a[134:135], v245 offset:12288
    v_mfma_f32_16x16x32_bf16 v[96:99], a[152:155], a[64:67], v[96:99]
    ds_read_b64_tr_b16 a[136:137], v246 offset:8192
    v_mfma_f32_16x16x32_bf16 v[100:103], a[152:155], a[200:203], v[100:103]
    ds_read_b64_tr_b16 a[138:139], v246 offset:12288
    v_mfma_f32_16x16x32_bf16 v[104:107], a[156:159], a[64:67], v[104:107]
    ds_read_b64_tr_b16 a[140:141], v247 offset:8192
    v_mfma_f32_16x16x32_bf16 v[108:111], a[156:159], a[200:203], v[108:111]
    ds_read_b64_tr_b16 a[142:143], v247 offset:12288
    s_waitcnt lgkmcnt(15)
    v_mfma_f32_16x16x32_bf16 v[112:115], a[160:163], a[64:67], v[112:115]
    ds_read_b64_tr_b16 a[144:145], v248 offset:8192
    v_mfma_f32_16x16x32_bf16 v[116:119], a[160:163], a[200:203], v[116:119]
    ds_read_b64_tr_b16 a[146:147], v248 offset:12288
    v_mfma_f32_16x16x32_bf16 v[120:123], a[164:167], a[64:67], v[120:123]
    ds_read_b64_tr_b16 a[148:149], v249 offset:8192
    v_mfma_f32_16x16x32_bf16 v[124:127], a[164:167], a[200:203], v[124:127]
    ds_read_b64_tr_b16 a[150:151], v249 offset:12288
    v_mfma_f32_16x16x32_bf16 v[128:131], a[168:171], a[64:67], v[128:131]
    ds_read_b64_tr_b16 a[152:153], v250 offset:8192
    v_mfma_f32_16x16x32_bf16 v[132:135], a[168:171], a[200:203], v[132:135]
    ds_read_b64_tr_b16 a[154:155], v250 offset:12288
    v_mfma_f32_16x16x32_bf16 v[136:139], a[172:175], a[64:67], v[136:139]
    ds_read_b64_tr_b16 a[156:157], v251 offset:8192
    v_mfma_f32_16x16x32_bf16 v[140:143], a[172:175], a[200:203], v[140:143]
    ds_read_b64_tr_b16 a[158:159], v251 offset:12288
    s_waitcnt lgkmcnt(15)
    v_mfma_f32_16x16x32_bf16 v[144:147], a[176:179], a[64:67], v[144:147]
    ds_read_b64_tr_b16 a[160:161], v12 offset:8192
    v_mfma_f32_16x16x32_bf16 v[148:151], a[176:179], a[200:203], v[148:151]
    ds_read_b64_tr_b16 a[162:163], v12 offset:12288
    v_mfma_f32_16x16x32_bf16 v[152:155], a[180:183], a[64:67], v[152:155]
    ds_read_b64_tr_b16 a[164:165], v13 offset:8192
    v_mfma_f32_16x16x32_bf16 v[156:159], a[180:183], a[200:203], v[156:159]
    ds_read_b64_tr_b16 a[166:167], v13 offset:12288
    v_mfma_f32_16x16x32_bf16 v[160:163], a[184:187], a[64:67], v[160:163]
    ds_read_b64_tr_b16 a[168:169], v14 offset:8192
    v_mfma_f32_16x16x32_bf16 v[164:167], a[184:187], a[200:203], v[164:167]
    ds_read_b64_tr_b16 a[170:171], v14 offset:12288
    v_mfma_f32_16x16x32_bf16 v[168:171], a[188:191], a[64:67], v[168:171]
    ds_read_b64_tr_b16 a[172:173], v15 offset:8192
    v_mfma_f32_16x16x32_bf16 v[172:175], a[188:191], a[200:203], v[172:175]
    ds_read_b64_tr_b16 a[174:175], v15 offset:12288
    s_waitcnt lgkmcnt(15)
    v_mfma_f32_16x16x32_bf16 v[48:51], a[128:131], a[68:71], v[48:51]
    ds_read_b64_tr_b16 a[176:177], v16 offset:8192
    v_mfma_f32_16x16x32_bf16 v[52:55], a[128:131], a[204:207], v[52:55]
    ds_read_b64_tr_b16 a[178:179], v16 offset:12288
    v_mfma_f32_16x16x32_bf16 v[56:59], a[132:135], a[68:71], v[56:59]
    ds_read_b64_tr_b16 a[180:181], v17 offset:8192
    v_mfma_f32_16x16x32_bf16 v[60:63], a[132:135], a[204:207], v[60:63]
    ds_read_b64_tr_b16 a[182:183], v17 offset:12288
    v_mfma_f32_16x16x32_bf16 v[64:67], a[136:139], a[68:71], v[64:67]
    ds_read_b64_tr_b16 a[184:185], v18 offset:8192
    v_mfma_f32_16x16x32_bf16 v[68:71], a[136:139], a[204:207], v[68:71]
    ds_read_b64_tr_b16 a[186:187], v18 offset:12288
    v_cvt_pk_bf16_f32 v176, v48, v49
    v_mfma_f32_16x16x32_bf16 v[72:75], a[140:143], a[68:71], v[72:75]
    ds_read_b64_tr_b16 a[188:189], v19 offset:8192
    v_cvt_pk_bf16_f32 v178, v56, v57
    v_mfma_f32_16x16x32_bf16 v[76:79], a[140:143], a[204:207], v[76:79]
    ds_read_b64_tr_b16 a[190:191], v19 offset:12288
    s_waitcnt lgkmcnt(15)
    v_mfma_f32_16x16x32_bf16 v[80:83], a[144:147], a[68:71], v[80:83]
    v_cvt_pk_bf16_f32 v177, v50, v51
    v_cvt_pk_bf16_f32 v179, v58, v59
    v_mfma_f32_16x16x32_bf16 v[84:87], a[144:147], a[204:207], v[84:87]
    v_permlane32_swap_b32 v176, v178
    v_permlane32_swap_b32 v177, v179
    v_mfma_f32_16x16x32_bf16 v[88:91], a[148:151], a[68:71], v[88:91]
    v_permlane16_swap_b32 v176, v178
    v_permlane16_swap_b32 v177, v179
    v_mfma_f32_16x16x32_bf16 v[92:95], a[148:151], a[204:207], v[92:95]
    v_cvt_pk_bf16_f32 v192, v52, v53
    v_cvt_pk_bf16_f32 v194, v60, v61
    v_mfma_f32_16x16x32_bf16 v[96:99], a[152:155], a[68:71], v[96:99]
    v_cvt_pk_bf16_f32 v193, v54, v55
    v_cvt_pk_bf16_f32 v195, v62, v63
    v_mfma_f32_16x16x32_bf16 v[100:103], a[152:155], a[204:207], v[100:103]
    v_permlane32_swap_b32 v192, v194
    v_permlane32_swap_b32 v193, v195
    v_mfma_f32_16x16x32_bf16 v[104:107], a[156:159], a[68:71], v[104:107]
    v_permlane16_swap_b32 v192, v194
    v_permlane16_swap_b32 v193, v195
    v_mfma_f32_16x16x32_bf16 v[108:111], a[156:159], a[204:207], v[108:111]
    v_cvt_pk_bf16_f32 v180, v64, v65
    s_waitcnt lgkmcnt(8)
    v_mfma_f32_16x16x32_bf16 v[112:115], a[160:163], a[68:71], v[112:115]
    v_cvt_pk_bf16_f32 v182, v72, v73
    v_cvt_pk_bf16_f32 v181, v66, v67
    v_mfma_f32_16x16x32_bf16 v[116:119], a[160:163], a[204:207], v[116:119]
    s_waitcnt vmcnt(8)
    s_barrier
    v_mfma_f32_16x16x32_bf16 v[120:123], a[164:167], a[68:71], v[120:123]
    ds_read_b128 a[128:131], v8 offset:16384
    v_cvt_pk_bf16_f32 v183, v74, v75
    v_mfma_f32_16x16x32_bf16 v[124:127], a[164:167], a[204:207], v[124:127]
    v_permlane32_swap_b32 v180, v182
    v_permlane32_swap_b32 v181, v183
    v_mfma_f32_16x16x32_bf16 v[128:131], a[168:171], a[68:71], v[128:131]
    ds_read_b128 a[132:135], v8 offset:20480
    s_add_u32 m0, s47, 114688
    v_mfma_f32_16x16x32_bf16 v[132:135], a[168:171], a[204:207], v[132:135]
    buffer_load_dwordx4 v24, s[12:15], s49 offen offset:0 lds
    v_mfma_f32_16x16x32_bf16 v[136:139], a[172:175], a[68:71], v[136:139]
    ds_read_b128 a[136:139], v9 offset:16384
    v_permlane16_swap_b32 v180, v182
    v_mfma_f32_16x16x32_bf16 v[140:143], a[172:175], a[204:207], v[140:143]
    v_permlane16_swap_b32 v181, v183
    s_waitcnt lgkmcnt(3)
    v_mfma_f32_16x16x32_bf16 v[144:147], a[176:179], a[68:71], v[144:147]
    ds_read_b128 a[140:143], v9 offset:20480
    v_cvt_pk_bf16_f32 v196, v68, v69
    v_mfma_f32_16x16x32_bf16 v[148:151], a[176:179], a[204:207], v[148:151]
    buffer_load_dwordx4 v25, s[12:15], s49 offen offset:1024 lds
    v_mfma_f32_16x16x32_bf16 v[152:155], a[180:183], a[68:71], v[152:155]
    ds_read_b128 a[144:147], v10 offset:16384
    v_cvt_pk_bf16_f32 v198, v76, v77
    v_mfma_f32_16x16x32_bf16 v[156:159], a[180:183], a[204:207], v[156:159]
    v_cvt_pk_bf16_f32 v197, v70, v71
    v_cvt_pk_bf16_f32 v199, v78, v79
    v_mfma_f32_16x16x32_bf16 v[160:163], a[184:187], a[68:71], v[160:163]
    ds_read_b128 a[148:151], v10 offset:20480
    v_permlane32_swap_b32 v196, v198
    v_mfma_f32_16x16x32_bf16 v[164:167], a[184:187], a[204:207], v[164:167]
    buffer_load_dwordx4 v24, s[12:15], s49 offen offset:2048 lds
    v_mfma_f32_16x16x32_bf16 v[168:171], a[188:191], a[68:71], v[168:171]
    ds_read_b128 a[152:155], v11 offset:16384
    v_permlane32_swap_b32 v197, v199
    v_permlane16_swap_b32 v196, v198
    s_nop 0
    v_permlane16_swap_b32 v197, v199
    v_cvt_pk_bf16_f32 v184, v80, v81
    v_cvt_pk_bf16_f32 v186, v88, v89
    v_cvt_pk_bf16_f32 v185, v82, v83
    v_cvt_pk_bf16_f32 v187, v90, v91
    v_permlane32_swap_b32 v184, v186
    s_nop 0
    v_permlane32_swap_b32 v185, v187
    v_permlane16_swap_b32 v184, v186
    s_nop 0
    v_permlane16_swap_b32 v185, v187
    v_cvt_pk_bf16_f32 v200, v84, v85
    v_cvt_pk_bf16_f32 v202, v92, v93
    v_cvt_pk_bf16_f32 v201, v86, v87
    v_cvt_pk_bf16_f32 v203, v94, v95
    v_permlane32_swap_b32 v200, v202
    s_nop 0
    v_permlane32_swap_b32 v201, v203
    v_permlane16_swap_b32 v200, v202
    s_nop 0
    v_permlane16_swap_b32 v201, v203
    v_cvt_pk_bf16_f32 v188, v96, v97
    v_cvt_pk_bf16_f32 v190, v104, v105
    v_cvt_pk_bf16_f32 v189, v98, v99
    v_cvt_pk_bf16_f32 v191, v106, v107
    v_permlane32_swap_b32 v188, v190
    s_nop 0
    v_permlane32_swap_b32 v189, v191
    v_permlane16_swap_b32 v188, v190
    s_nop 0
    v_permlane16_swap_b32 v189, v191
    v_cvt_pk_bf16_f32 v204, v100, v101
    v_cvt_pk_bf16_f32 v206, v108, v109
    v_cvt_pk_bf16_f32 v205, v102, v103
    v_cvt_pk_bf16_f32 v207, v110, v111
    v_permlane32_swap_b32 v204, v206
    s_nop 0
    v_permlane32_swap_b32 v205, v207
    v_permlane16_swap_b32 v204, v206
    s_nop 0
    v_permlane16_swap_b32 v205, v207
    v_mfma_f32_16x16x32_bf16 v[172:175], a[188:191], a[204:207], v[172:175]
    v_cvt_pk_bf16_f32 v208, v112, v113
    s_waitcnt lgkmcnt(5)
    v_mfma_f32_16x16x32_bf16 v[48:51], a[128:131], v[176:179], 0
    ds_read_b128 a[156:159], v11 offset:20480
    v_cvt_pk_bf16_f32 v210, v120, v121
    v_mfma_f32_16x16x32_bf16 v[56:59], a[128:131], v[192:195], 0
    buffer_load_dwordx4 v25, s[12:15], s49 offen offset:3072 lds
    v_mfma_f32_16x16x32_bf16 v[52:55], a[132:135], v[176:179], 0
    s_add_u32 s49, s49, 0x4000
    v_cvt_pk_bf16_f32 v209, v114, v115
    v_mfma_f32_16x16x32_bf16 v[60:63], a[132:135], v[192:195], 0
    v_cvt_pk_bf16_f32 v211, v122, v123
    s_waitcnt lgkmcnt(4)
    v_mfma_f32_16x16x32_bf16 v[48:51], a[136:139], v[180:183], v[48:51]
    s_add_u32 m0, s47, 49152
    v_permlane32_swap_b32 v208, v210
    v_mfma_f32_16x16x32_bf16 v[56:59], a[136:139], v[196:199], v[56:59]
    buffer_load_dwordx4 v20, s[8:11], s48 offen offset:0 lds
    v_mfma_f32_16x16x32_bf16 v[52:55], a[140:143], v[180:183], v[52:55]
    v_permlane32_swap_b32 v209, v211
    v_permlane16_swap_b32 v208, v210
    v_mfma_f32_16x16x32_bf16 v[60:63], a[140:143], v[196:199], v[60:63]
    v_permlane16_swap_b32 v209, v211
    s_waitcnt lgkmcnt(2)
    v_mfma_f32_16x16x32_bf16 v[48:51], a[144:147], v[184:187], v[48:51]
    v_cvt_pk_bf16_f32 v224, v116, v117
    v_cvt_pk_bf16_f32 v226, v124, v125
    v_mfma_f32_16x16x32_bf16 v[56:59], a[144:147], v[200:203], v[56:59]
    buffer_load_dwordx4 v21, s[8:11], s48 offen offset:1024 lds
    v_mfma_f32_16x16x32_bf16 v[52:55], a[148:151], v[184:187], v[52:55]
    v_cvt_pk_bf16_f32 v225, v118, v119
    v_cvt_pk_bf16_f32 v227, v126, v127
    v_mfma_f32_16x16x32_bf16 v[60:63], a[148:151], v[200:203], v[60:63]
    v_permlane32_swap_b32 v224, v226
    s_waitcnt lgkmcnt(0)
    v_mfma_f32_16x16x32_bf16 v[48:51], a[152:155], v[188:191], v[48:51]
    v_permlane32_swap_b32 v225, v227
    v_permlane16_swap_b32 v224, v226
    v_mfma_f32_16x16x32_bf16 v[56:59], a[152:155], v[204:207], v[56:59]
    buffer_load_dwordx4 v22, s[8:11], s48 offen offset:2048 lds
    v_mfma_f32_16x16x32_bf16 v[52:55], a[156:159], v[188:191], v[52:55]
    v_permlane16_swap_b32 v225, v227
    v_cvt_pk_bf16_f32 v212, v128, v129
    v_mfma_f32_16x16x32_bf16 v[60:63], a[156:159], v[204:207], v[60:63]
    v_cvt_pk_bf16_f32 v214, v136, v137
    v_cvt_pk_bf16_f32 v213, v130, v131
    v_mfma_f32_16x16x32_bf16 v[64:67], a[128:131], v[208:211], 0
    v_cvt_pk_bf16_f32 v215, v138, v139
    v_permlane32_swap_b32 v212, v214
    s_nop 0
    v_permlane32_swap_b32 v213, v215
    v_permlane16_swap_b32 v212, v214
    s_nop 0
    v_permlane16_swap_b32 v213, v215
    v_cvt_pk_bf16_f32 v228, v132, v133
    v_cvt_pk_bf16_f32 v230, v140, v141
    v_cvt_pk_bf16_f32 v229, v134, v135
    v_cvt_pk_bf16_f32 v231, v142, v143
    v_permlane32_swap_b32 v228, v230
    s_nop 0
    v_permlane32_swap_b32 v229, v231
    v_permlane16_swap_b32 v228, v230
    s_nop 0
    v_permlane16_swap_b32 v229, v231
    v_mfma_f32_16x16x32_bf16 v[72:75], a[128:131], v[224:227], 0
    buffer_load_dwordx4 v23, s[8:11], s48 offen offset:3072 lds
    v_mfma_f32_16x16x32_bf16 v[68:71], a[132:135], v[208:211], 0
    ds_read_b128 a[160:163], v8 offset:24576
    s_add_u32 s48, s48, 0x4000
    v_cvt_pk_bf16_f32 v216, v144, v145
    v_cvt_pk_bf16_f32 v218, v152, v153
    v_cvt_pk_bf16_f32 v217, v146, v147
    v_cvt_pk_bf16_f32 v219, v154, v155
    v_permlane32_swap_b32 v216, v218
    s_nop 0
    v_permlane32_swap_b32 v217, v219
    v_permlane16_swap_b32 v216, v218
    s_nop 0
    v_permlane16_swap_b32 v217, v219
    v_cvt_pk_bf16_f32 v232, v148, v149
    v_cvt_pk_bf16_f32 v234, v156, v157
    v_cvt_pk_bf16_f32 v233, v150, v151
    v_cvt_pk_bf16_f32 v235, v158, v159
    v_permlane32_swap_b32 v232, v234
    s_nop 0
    v_permlane32_swap_b32 v233, v235
    v_permlane16_swap_b32 v232, v234
    s_nop 0
    v_permlane16_swap_b32 v233, v235
    v_mfma_f32_16x16x32_bf16 v[76:79], a[132:135], v[224:227], 0
    v_cvt_pk_bf16_f32 v220, v160, v161
    v_cvt_pk_bf16_f32 v222, v168, v169
    v_mfma_f32_16x16x32_bf16 v[64:67], a[136:139], v[212:215], v[64:67]
    ds_read_b128 a[164:167], v9 offset:24576
    v_cvt_pk_bf16_f32 v221, v162, v163
    v_cvt_pk_bf16_f32 v223, v170, v171
    v_permlane32_swap_b32 v220, v222
    s_nop 0
    v_permlane32_swap_b32 v221, v223
    v_permlane16_swap_b32 v220, v222
    s_nop 0
    v_permlane16_swap_b32 v221, v223
    v_cvt_pk_bf16_f32 v236, v164, v165
    v_cvt_pk_bf16_f32 v238, v172, v173
    v_cvt_pk_bf16_f32 v237, v166, v167
    v_cvt_pk_bf16_f32 v239, v174, v175
    v_permlane32_swap_b32 v236, v238
    s_nop 0
    v_permlane32_swap_b32 v237, v239
    v_permlane16_swap_b32 v236, v238
    s_nop 0
    v_permlane16_swap_b32 v237, v239
    v_mfma_f32_16x16x32_bf16 v[72:75], a[136:139], v[228:231], v[72:75]
    v_mov_b32 v40, 0
    v_mov_b32 v41, 0
    v_mfma_f32_16x16x32_bf16 v[68:71], a[140:143], v[212:215], v[68:71]
    ds_read_b128 a[168:171], v10 offset:24576
    v_mov_b32 v42, 0
    v_mfma_f32_16x16x32_bf16 v[76:79], a[140:143], v[228:231], v[76:79]
    v_mov_b32 v43, 0
    v_mov_b32 v44, 0
    v_mfma_f32_16x16x32_bf16 v[64:67], a[144:147], v[216:219], v[64:67]
    ds_read_b128 a[172:175], v11 offset:24576
    v_mov_b32 v45, 0
    v_mfma_f32_16x16x32_bf16 v[72:75], a[144:147], v[232:235], v[72:75]
    v_mov_b32 v46, 0
    s_mov_b32 s24, s96
    v_mfma_f32_16x16x32_bf16 v[68:71], a[148:151], v[216:219], v[68:71]
    ds_read_b128 a[176:179], v8 offset:28672
    s_mov_b32 s25, s97
    v_mfma_f32_16x16x32_bf16 v[76:79], a[148:151], v[232:235], v[76:79]
    v_mov_b32 v47, 0
    s_mov_b32 s26, 5308416
    v_mfma_f32_16x16x32_bf16 v[64:67], a[152:155], v[220:223], v[64:67]
    ds_read_b128 a[180:183], v9 offset:28672
    s_mov_b32 s27, 0x20000
    v_mfma_f32_16x16x32_bf16 v[72:75], a[152:155], v[236:239], v[72:75]
    v_mov_b32 v240, 0
    s_mov_b32 s28, s98
    v_mfma_f32_16x16x32_bf16 v[68:71], a[156:159], v[220:223], v[68:71]
    ds_read_b128 a[184:187], v10 offset:28672
    v_mov_b32 v241, 0
    v_mov_b32 v242, 0
    v_mov_b32 v243, 0
    v_mov_b32 v244, 0
    v_mov_b32 v245, 0
    v_mov_b32 v246, 0
    v_mov_b32 v247, 0
    v_mov_b32 v172, 0x3f803f80
    v_mov_b32 v173, 0x3f803f80
    v_mov_b32 v174, 0x3f803f80
    v_mov_b32 v175, 0x3f803f80
    v_max3_f32 v160, v48, v49, v50
    v_max3_f32 v160, v160, v51, v52
    v_max3_f32 v160, v160, v53, v54
    v_max_f32 v160, v160, v55
    v_mov_b32 v161, v160
    s_nop 1
    v_permlane16_swap_b32 v160, v161
    v_max_f32 v160, v160, v161
    v_mov_b32 v161, v160
    s_nop 1
    v_permlane32_swap_b32 v160, v161
    v_max_f32 v160, v160, v161
    v_add_f32 v160, 0x42b40000, v160
    v_ceil_f32 v160, v160
    v_sub_f32 v144, 0, v160
    v_sub_f32 v145, 0, v160
    v_sub_f32 v146, 0, v160
    v_sub_f32 v147, 0, v160
    v_max3_f32 v162, v56, v57, v58
    v_max3_f32 v162, v162, v59, v60
    v_max3_f32 v162, v162, v61, v62
    v_max_f32 v162, v162, v63
    v_mov_b32 v163, v162
    s_nop 1
    v_permlane16_swap_b32 v162, v163
    v_max_f32 v162, v162, v163
    v_mov_b32 v163, v162
    s_nop 1
    v_permlane32_swap_b32 v162, v163
    v_max_f32 v162, v162, v163
    v_add_f32 v162, 0x42b40000, v162
    v_ceil_f32 v162, v162
    v_sub_f32 v148, 0, v162
    v_sub_f32 v149, 0, v162
    v_sub_f32 v150, 0, v162
    v_sub_f32 v151, 0, v162
    s_mov_b32 s29, s99
    v_mfma_f32_16x16x32_bf16 v[76:79], a[156:159], v[236:239], v[76:79]
    s_mov_b32 s30, 5308416
    s_waitcnt lgkmcnt(5)
    v_mfma_f32_16x16x32_bf16 v[80:83], a[160:163], v[176:179], v[144:147]
    ds_read_b128 a[188:191], v11 offset:28672
    s_mov_b32 s31, 0x20000
    v_mfma_f32_16x16x32_bf16 v[88:91], a[160:163], v[192:195], v[148:151]
    s_mov_b32 s36, s100
    v_mfma_f32_16x16x32_bf16 v[80:83], a[164:167], v[180:183], v[80:83]
    v_max3_f32 v164, v64, v65, v66
    s_mov_b32 s37, s101
    v_mfma_f32_16x16x32_bf16 v[88:91], a[164:167], v[196:199], v[88:91]
    s_mov_b32 s38, 5308416
    s_waitcnt lgkmcnt(4)
    v_mfma_f32_16x16x32_bf16 v[80:83], a[168:171], v[184:187], v[80:83]
    v_max3_f32 v164, v164, v67, v68
    s_mov_b32 s39, 0x20000
    v_mfma_f32_16x16x32_bf16 v[88:91], a[168:171], v[200:203], v[88:91]
    v_max3_f32 v164, v164, v69, v70
    s_lshl_b32 s58, s2, 15
    v_mfma_f32_16x16x32_bf16 v[80:83], a[172:175], v[188:191], v[80:83]
    v_max_f32 v164, v164, v71
    s_lshl_b32 s59, s46, 13
    v_mfma_f32_16x16x32_bf16 v[88:91], a[172:175], v[204:207], v[88:91]
    s_add_u32 s58, s58, s59
    s_waitcnt lgkmcnt(2)
    v_mfma_f32_16x16x32_bf16 v[84:87], a[176:179], v[176:179], v[144:147]
    v_mov_b32 v165, v164
    s_lshl_b32 s59, s45, 2
    v_mfma_f32_16x16x32_bf16 v[92:95], a[176:179], v[192:195], v[148:151]
    v_permlane16_swap_b32 v164, v165
    s_add_u32 s59, s59, s46
    v_mfma_f32_16x16x32_bf16 v[84:87], a[180:183], v[180:183], v[84:87]
    v_max_f32 v164, v164, v165
    s_mul_i32 s59, s59, 4608
    v_mfma_f32_16x16x32_bf16 v[92:95], a[180:183], v[196:199], v[92:95]
    s_waitcnt vmcnt(8)
    s_barrier
    v_lshlrev_b32 v254, 3, v252
    s_waitcnt lgkmcnt(0)
    v_mfma_f32_16x16x32_bf16 v[84:87], a[184:187], v[184:187], v[84:87]
    ds_read_b128 a[128:131], v8 offset:32768
    s_getpc_b64 s[60:61]
k4_kernel_pc:
    v_mfma_f32_16x16x32_bf16 v[92:95], a[184:187], v[200:203], v[92:95]
    s_add_u32 s60, s60, k4_kernel_ffn-k4_kernel_pc
    s_addc_u32 s61, s61, 0
    v_mfma_f32_16x16x32_bf16 v[84:87], a[188:191], v[188:191], v[84:87]
    ds_read_b64_tr_b16 a[132:133], v12 offset:32768
    ds_read_b64_tr_b16 a[134:135], v12 offset:36864
    v_mov_b32 v165, v164
    s_nop 1
    v_permlane32_swap_b32 v164, v165
    v_max_f32 v164, v164, v165
    v_add_f32 v164, 0x42b40000, v164
    v_ceil_f32 v164, v164
    v_sub_f32 v152, 0, v164
    v_sub_f32 v153, 0, v164
    v_sub_f32 v154, 0, v164
    v_sub_f32 v155, 0, v164
    v_max3_f32 v166, v72, v73, v74
    v_max3_f32 v166, v166, v75, v76
    v_max3_f32 v166, v166, v77, v78
    v_max_f32 v166, v166, v79
    v_mov_b32 v167, v166
    s_nop 1
    v_permlane16_swap_b32 v166, v167
    v_max_f32 v166, v166, v167
    v_mov_b32 v167, v166
    s_nop 1
    v_permlane32_swap_b32 v166, v167
    v_max_f32 v166, v166, v167
    v_add_f32 v166, 0x42b40000, v166
    v_ceil_f32 v166, v166
    v_sub_f32 v156, 0, v166
    v_sub_f32 v157, 0, v166
    v_sub_f32 v158, 0, v166
    v_sub_f32 v159, 0, v166
    s_min_u32 s62, s2, 4
    v_mfma_f32_16x16x32_bf16 v[92:95], a[188:191], v[204:207], v[92:95]
    v_add_f32 v48, v48, v144
    s_lshl_b32 s62, s62, 13
    v_mfma_f32_16x16x32_bf16 v[96:99], a[160:163], v[208:211], v[152:155]
    v_add_f32 v49, v49, v144
    v_add_u32 v253, s62, v254
    v_mfma_f32_16x16x32_bf16 v[104:107], a[160:163], v[224:227], v[156:159]
    v_add_f32 v50, v50, v144
    v_add_f32 v51, v51, v144
    v_mfma_f32_16x16x32_bf16 v[96:99], a[164:167], v[212:215], v[96:99]
    v_add_f32 v52, v52, v144
    v_add_f32 v53, v53, v144
    v_mfma_f32_16x16x32_bf16 v[104:107], a[164:167], v[228:231], v[104:107]
    buffer_load_dword v255, v254, s[20:23], s59 offen
    v_mfma_f32_16x16x32_bf16 v[96:99], a[168:171], v[216:219], v[96:99]
    ds_read_b128 a[136:139], v9 offset:32768
    v_add_f32 v54, v54, v144
    v_mfma_f32_16x16x32_bf16 v[104:107], a[168:171], v[232:235], v[104:107]
    v_add_f32 v55, v55, v144
    v_add_f32 v56, v56, v148
    v_mfma_f32_16x16x32_bf16 v[96:99], a[172:175], v[220:223], v[96:99]
    ds_read_b64_tr_b16 a[140:141], v13 offset:32768
    ds_read_b64_tr_b16 a[142:143], v13 offset:36864
    v_mfma_f32_16x16x32_bf16 v[104:107], a[172:175], v[236:239], v[104:107]
    global_load_dword v255, v253, s[60:61]
    v_mfma_f32_16x16x32_bf16 v[100:103], a[176:179], v[208:211], v[152:155]
    v_add_f32 v57, v57, v148
    v_add_f32 v58, v58, v148
    v_mfma_f32_16x16x32_bf16 v[108:111], a[176:179], v[224:227], v[156:159]
    v_add_f32 v59, v59, v148
    v_add_f32 v60, v60, v148
    v_mfma_f32_16x16x32_bf16 v[100:103], a[180:183], v[212:215], v[100:103]
    v_add_f32 v61, v61, v148
    v_add_f32 v62, v62, v148
    v_mfma_f32_16x16x32_bf16 v[108:111], a[180:183], v[228:231], v[108:111]
    v_add_f32 v63, v63, v148
    v_add_f32 v64, v64, v152
    v_mfma_f32_16x16x32_bf16 v[100:103], a[184:187], v[216:219], v[100:103]
    ds_read_b128 a[144:147], v10 offset:32768
    v_add_f32 v65, v65, v152
    v_mfma_f32_16x16x32_bf16 v[108:111], a[184:187], v[232:235], v[108:111]
    v_add_f32 v66, v66, v152
    v_add_f32 v67, v67, v152
    v_add_f32 v68, v68, v152
    v_add_f32 v69, v69, v152
    v_add_f32 v70, v70, v152
    v_add_f32 v71, v71, v152
    v_add_f32 v72, v72, v156
    v_add_f32 v73, v73, v156
    v_add_f32 v74, v74, v156
    v_add_f32 v75, v75, v156
    v_add_f32 v76, v76, v156
    v_add_f32 v77, v77, v156
    v_add_f32 v78, v78, v156
    v_add_f32 v79, v79, v156
    v_mfma_f32_16x16x32_bf16 v[100:103], a[188:191], v[220:223], v[100:103]
    ds_read_b64_tr_b16 a[148:149], v14 offset:32768
    ds_read_b64_tr_b16 a[150:151], v14 offset:36864
    v_mov_b32 v248, v40
    v_mov_b32 v249, v44
    v_mov_b32 v250, v240
    v_mov_b32 v251, v244
    v_exp_f32 v160, v48
    v_exp_f32 v161, v49
    s_nop 0
    v_cvt_pk_bf16_f32 v112, v160, v161
    v_exp_f32 v162, v50
    v_exp_f32 v163, v51
    s_nop 0
    v_cvt_pk_bf16_f32 v113, v162, v163
    v_exp_f32 v164, v56
    v_exp_f32 v165, v57
    s_nop 0
    v_cvt_pk_bf16_f32 v116, v164, v165
    v_exp_f32 v166, v58
    v_exp_f32 v167, v59
    s_nop 0
    v_cvt_pk_bf16_f32 v117, v166, v167
    v_exp_f32 v168, v52
    v_exp_f32 v169, v53
    s_nop 0
    v_cvt_pk_bf16_f32 v114, v168, v169
    v_exp_f32 v170, v54
    v_exp_f32 v171, v55
    s_nop 0
    v_cvt_pk_bf16_f32 v115, v170, v171
    v_mfma_f32_16x16x32_bf16 v[108:111], a[188:191], v[236:239], v[108:111]
    v_exp_f32 v160, v64
    v_exp_f32 v161, v65
    s_nop 0
    v_cvt_pk_bf16_f32 v120, v160, v161
    v_exp_f32 v162, v66
    v_exp_f32 v163, v67
    s_nop 0
    v_cvt_pk_bf16_f32 v121, v162, v163
    v_exp_f32 v164, v60
    v_exp_f32 v165, v61
    s_nop 0
    v_cvt_pk_bf16_f32 v118, v164, v165
    v_exp_f32 v166, v62
    v_exp_f32 v167, v63
    s_nop 0
    v_cvt_pk_bf16_f32 v119, v166, v167
    v_mfma_f32_16x16x32_bf16 v[40:43], v[172:175], v[112:115], v[40:43]
    v_exp_f32 v168, v72
    v_exp_f32 v169, v73
    s_nop 0
    v_cvt_pk_bf16_f32 v124, v168, v169
    v_exp_f32 v170, v74
    v_exp_f32 v171, v75
    s_nop 0
    v_cvt_pk_bf16_f32 v125, v170, v171
    v_exp_f32 v160, v68
    v_exp_f32 v161, v69
    s_nop 0
    v_cvt_pk_bf16_f32 v122, v160, v161
    v_exp_f32 v162, v70
    v_exp_f32 v163, v71
    s_nop 0
    v_cvt_pk_bf16_f32 v123, v162, v163
    v_mfma_f32_16x16x32_bf16 v[44:47], v[172:175], v[116:119], v[44:47]
    v_exp_f32 v164, v76
    v_exp_f32 v165, v77
    s_nop 0
    v_cvt_pk_bf16_f32 v126, v164, v165
    v_exp_f32 v166, v78
    v_exp_f32 v167, v79
    s_nop 0
    v_cvt_pk_bf16_f32 v127, v166, v167
    v_mfma_f32_16x16x32_bf16 v[240:243], v[172:175], v[120:123], v[240:243]
    s_nop 0
    v_mfma_f32_16x16x32_bf16 v[244:247], v[172:175], v[124:127], v[244:247]
    s_nop 5
    v_max3_f32 v39, v40, v44, v240
    s_nop 0
    v_max_f32 v39, v39, v244
    v_cmp_lt_f32 vcc, s54, v39
    s_cbranch_vccnz k4_kernel_stub100
k4_kernel_ret100:
    s_waitcnt lgkmcnt(3)
    v_mfma_f32_16x16x32_bf16 v[48:51], a[128:131], v[176:179], v[144:147]
    ds_read_b128 a[152:155], v11 offset:32768
    s_add_u32 m0, s47, 65536
    v_mfma_f32_16x16x32_bf16 v[56:59], a[128:131], v[192:195], v[148:151]
    v_exp_f32 v160, v80
    v_mfma_f32_16x16x32_bf16 v[64:67], a[128:131], v[208:211], v[152:155]
    ds_read_b64_tr_b16 a[156:157], v15 offset:32768
    ds_read_b64_tr_b16 a[158:159], v15 offset:36864
    v_mfma_f32_16x16x32_bf16 v[72:75], a[128:131], v[224:227], v[156:159]
    v_exp_f32 v161, v81
    v_mfma_f32_16x16x32_bf16 a[0:3], a[132:135], v[112:115], 0
    v_exp_f32 v162, v82
    v_mfma_f32_16x16x32_bf16 a[32:35], a[132:135], v[116:119], 0
    v_exp_f32 v163, v83
    v_mfma_f32_16x16x32_bf16 a[64:67], a[132:135], v[120:123], 0
    v_exp_f32 v164, v88
    v_mfma_f32_16x16x32_bf16 a[96:99], a[132:135], v[124:127], 0
    buffer_load_dwordx4 v24, s[12:15], s49 offen offset:0 lds
    v_mfma_f32_16x16x32_bf16 v[48:51], a[136:139], v[180:183], v[48:51]
    ds_read_b128 a[160:163], v8 offset:36864
    v_mov_b32 v248, v40
    v_mfma_f32_16x16x32_bf16 v[56:59], a[136:139], v[196:199], v[56:59]
    v_exp_f32 v165, v89
    v_mfma_f32_16x16x32_bf16 v[64:67], a[136:139], v[212:215], v[64:67]
    ds_read_b64_tr_b16 a[164:165], v16 offset:32768
    ds_read_b64_tr_b16 a[166:167], v16 offset:36864
    v_mfma_f32_16x16x32_bf16 v[72:75], a[136:139], v[228:231], v[72:75]
    v_exp_f32 v166, v90
    v_mfma_f32_16x16x32_bf16 a[4:7], a[140:143], v[112:115], 0
    v_exp_f32 v167, v91
    v_mfma_f32_16x16x32_bf16 a[36:39], a[140:143], v[116:119], 0
    v_exp_f32 v168, v84
    v_mfma_f32_16x16x32_bf16 a[68:71], a[140:143], v[120:123], 0
    v_exp_f32 v169, v85
    v_mfma_f32_16x16x32_bf16 a[100:103], a[140:143], v[124:127], 0
    v_mov_b32 v249, v44
    s_waitcnt lgkmcnt(3)
    v_mfma_f32_16x16x32_bf16 v[48:51], a[144:147], v[184:187], v[48:51]
    ds_read_b128 a[168:171], v9 offset:36864
    v_mov_b32 v250, v240
    v_mfma_f32_16x16x32_bf16 v[56:59], a[144:147], v[200:203], v[56:59]
    v_exp_f32 v170, v86
    v_mfma_f32_16x16x32_bf16 v[64:67], a[144:147], v[216:219], v[64:67]
    ds_read_b64_tr_b16 a[172:173], v17 offset:32768
    ds_read_b64_tr_b16 a[174:175], v17 offset:36864
    v_mfma_f32_16x16x32_bf16 v[72:75], a[144:147], v[232:235], v[72:75]
    v_exp_f32 v171, v87
    v_mfma_f32_16x16x32_bf16 a[8:11], a[148:151], v[112:115], 0
    v_mov_b32 v251, v244
    v_cvt_pk_bf16_f32 v128, v160, v161
    v_mfma_f32_16x16x32_bf16 a[40:43], a[148:151], v[116:119], 0
    v_exp_f32 v160, v96
    v_mfma_f32_16x16x32_bf16 a[72:75], a[148:151], v[120:123], 0
    v_exp_f32 v161, v97
    v_mfma_f32_16x16x32_bf16 a[104:107], a[148:151], v[124:127], 0
    buffer_load_dwordx4 v25, s[12:15], s49 offen offset:1024 lds
    v_mfma_f32_16x16x32_bf16 v[48:51], a[152:155], v[188:191], v[48:51]
    ds_read_b128 a[176:179], v10 offset:36864
    v_cvt_pk_bf16_f32 v129, v162, v163
    v_mfma_f32_16x16x32_bf16 v[56:59], a[152:155], v[204:207], v[56:59]
    v_exp_f32 v162, v98
    v_mfma_f32_16x16x32_bf16 v[64:67], a[152:155], v[220:223], v[64:67]
    ds_read_b64_tr_b16 a[180:181], v18 offset:32768
    ds_read_b64_tr_b16 a[182:183], v18 offset:36864
    v_mfma_f32_16x16x32_bf16 v[72:75], a[152:155], v[236:239], v[72:75]
    v_exp_f32 v163, v99
    v_mfma_f32_16x16x32_bf16 a[12:15], a[156:159], v[112:115], 0
    v_cvt_pk_bf16_f32 v132, v164, v165
    v_cvt_pk_bf16_f32 v133, v166, v167
    v_mfma_f32_16x16x32_bf16 a[44:47], a[156:159], v[116:119], 0
    v_exp_f32 v164, v92
    v_mfma_f32_16x16x32_bf16 a[76:79], a[156:159], v[120:123], 0
    v_cvt_pk_bf16_f32 v130, v168, v169
    v_cvt_pk_bf16_f32 v131, v170, v171
    v_mfma_f32_16x16x32_bf16 a[108:111], a[156:159], v[124:127], 0
    v_exp_f32 v165, v93
    v_mfma_f32_16x16x32_bf16 v[40:43], v[172:175], v[128:131], v[40:43]
    v_cvt_pk_bf16_f32 v136, v160, v161
    s_waitcnt lgkmcnt(3)
    v_mfma_f32_16x16x32_bf16 v[52:55], a[160:163], v[176:179], v[144:147]
    ds_read_b128 a[184:187], v11 offset:36864
    v_cvt_pk_bf16_f32 v137, v162, v163
    v_mfma_f32_16x16x32_bf16 v[60:63], a[160:163], v[192:195], v[148:151]
    v_exp_f32 v166, v94
    v_mfma_f32_16x16x32_bf16 v[68:71], a[160:163], v[208:211], v[152:155]
    ds_read_b64_tr_b16 a[188:189], v19 offset:32768
    ds_read_b64_tr_b16 a[190:191], v19 offset:36864
    v_mfma_f32_16x16x32_bf16 v[76:79], a[160:163], v[224:227], v[156:159]
    v_exp_f32 v167, v95
    v_mfma_f32_16x16x32_bf16 a[16:19], a[164:167], v[112:115], 0
    v_exp_f32 v168, v104
    v_mfma_f32_16x16x32_bf16 a[48:51], a[164:167], v[116:119], 0
    v_exp_f32 v169, v105
    v_mfma_f32_16x16x32_bf16 a[80:83], a[164:167], v[120:123], 0
    v_cvt_pk_bf16_f32 v134, v164, v165
    v_cvt_pk_bf16_f32 v135, v166, v167
    v_mfma_f32_16x16x32_bf16 a[112:115], a[164:167], v[124:127], 0
    v_exp_f32 v170, v106
    v_mfma_f32_16x16x32_bf16 v[44:47], v[172:175], v[132:135], v[44:47]
    buffer_load_dwordx4 v24, s[12:15], s49 offen offset:2048 lds
    v_mfma_f32_16x16x32_bf16 v[52:55], a[168:171], v[180:183], v[52:55]
    ds_read_b128 a[128:131], v8 offset:40960
    v_cvt_pk_bf16_f32 v140, v168, v169
    v_mfma_f32_16x16x32_bf16 v[60:63], a[168:171], v[196:199], v[60:63]
    v_exp_f32 v171, v107
    v_mfma_f32_16x16x32_bf16 v[68:71], a[168:171], v[212:215], v[68:71]
    ds_read_b64_tr_b16 a[132:133], v12 offset:40960
    ds_read_b64_tr_b16 a[134:135], v12 offset:45056
    v_mfma_f32_16x16x32_bf16 v[76:79], a[168:171], v[228:231], v[76:79]
    v_exp_f32 v160, v100
    v_mfma_f32_16x16x32_bf16 a[20:23], a[172:175], v[112:115], 0
    v_exp_f32 v161, v101
    v_mfma_f32_16x16x32_bf16 a[52:55], a[172:175], v[116:119], 0
    v_exp_f32 v162, v102
    v_mfma_f32_16x16x32_bf16 a[84:87], a[172:175], v[120:123], 0
    v_cvt_pk_bf16_f32 v141, v170, v171
    v_cvt_pk_bf16_f32 v138, v160, v161
    v_exp_f32 v163, v103
    s_nop 0
    v_cvt_pk_bf16_f32 v139, v162, v163
    v_mfma_f32_16x16x32_bf16 a[116:119], a[172:175], v[124:127], 0
    v_exp_f32 v164, v108
    v_mfma_f32_16x16x32_bf16 v[240:243], v[172:175], v[136:139], v[240:243]
    s_waitcnt lgkmcnt(3)
    v_mfma_f32_16x16x32_bf16 v[52:55], a[176:179], v[184:187], v[52:55]
    ds_read_b128 a[136:139], v9 offset:40960
    v_mfma_f32_16x16x32_bf16 v[60:63], a[176:179], v[200:203], v[60:63]
    v_exp_f32 v165, v109
    v_mfma_f32_16x16x32_bf16 v[68:71], a[176:179], v[216:219], v[68:71]
    ds_read_b64_tr_b16 a[140:141], v13 offset:40960
    ds_read_b64_tr_b16 a[142:143], v13 offset:45056
    v_mfma_f32_16x16x32_bf16 v[76:79], a[176:179], v[232:235], v[76:79]
    v_exp_f32 v166, v110
    v_mfma_f32_16x16x32_bf16 a[24:27], a[180:183], v[112:115], 0
    v_exp_f32 v167, v111
    v_mfma_f32_16x16x32_bf16 a[56:59], a[180:183], v[116:119], 0
    v_cvt_pk_bf16_f32 v142, v164, v165
    v_cvt_pk_bf16_f32 v143, v166, v167
    v_mfma_f32_16x16x32_bf16 a[88:91], a[180:183], v[120:123], 0
    v_max3_f32 v39, v40, v44, v240
    v_mfma_f32_16x16x32_bf16 a[120:123], a[180:183], v[124:127], 0
    v_mfma_f32_16x16x32_bf16 v[244:247], v[172:175], v[140:143], v[244:247]
    buffer_load_dwordx4 v25, s[12:15], s49 offen offset:3072 lds
    v_mfma_f32_16x16x32_bf16 v[52:55], a[184:187], v[188:191], v[52:55]
    ds_read_b128 a[144:147], v10 offset:40960
    s_add_u32 s49, s49, 0x4000
    s_add_u32 m0, s47, 0
    v_mfma_f32_16x16x32_bf16 v[60:63], a[184:187], v[204:207], v[60:63]
    v_mfma_f32_16x16x32_bf16 v[68:71], a[184:187], v[220:223], v[68:71]
    ds_read_b64_tr_b16 a[148:149], v14 offset:40960
    ds_read_b64_tr_b16 a[150:151], v14 offset:45056
    v_mfma_f32_16x16x32_bf16 v[76:79], a[184:187], v[236:239], v[76:79]
    buffer_load_dwordx4 v20, s[8:11], s48 offen offset:0 lds
    v_mfma_f32_16x16x32_bf16 a[28:31], a[188:191], v[112:115], 0
    v_max_f32 v39, v39, v244
    v_cmp_lt_f32 vcc, s54, v39
    v_mfma_f32_16x16x32_bf16 a[60:63], a[188:191], v[116:119], 0
    buffer_load_dwordx4 v21, s[8:11], s48 offen offset:1024 lds
    v_mfma_f32_16x16x32_bf16 a[92:95], a[188:191], v[120:123], 0
    v_mfma_f32_16x16x32_bf16 a[124:127], a[188:191], v[124:127], 0
    s_cbranch_vccnz k4_kernel_stub101
k4_kernel_ret101:
    s_waitcnt lgkmcnt(3)
    v_mfma_f32_16x16x32_bf16 v[80:83], a[128:131], v[176:179], v[144:147]
    ds_read_b128 a[152:155], v11 offset:40960
    v_mov_b32 v248, v40
    v_mfma_f32_16x16x32_bf16 v[88:91], a[128:131], v[192:195], v[148:151]
    v_exp_f32 v160, v48
    v_mfma_f32_16x16x32_bf16 v[96:99], a[128:131], v[208:211], v[152:155]
    ds_read_b64_tr_b16 a[156:157], v15 offset:40960
    ds_read_b64_tr_b16 a[158:159], v15 offset:45056
    v_mfma_f32_16x16x32_bf16 v[104:107], a[128:131], v[224:227], v[156:159]
    v_exp_f32 v161, v49
    v_mfma_f32_16x16x32_bf16 a[0:3], a[132:135], v[128:131], a[0:3]
    v_exp_f32 v162, v50
    v_mfma_f32_16x16x32_bf16 a[32:35], a[132:135], v[132:135], a[32:35]
    v_exp_f32 v163, v51
    v_mfma_f32_16x16x32_bf16 a[64:67], a[132:135], v[136:139], a[64:67]
    v_exp_f32 v164, v56
    v_mfma_f32_16x16x32_bf16 a[96:99], a[132:135], v[140:143], a[96:99]
    buffer_load_dwordx4 v22, s[8:11], s48 offen offset:2048 lds
    v_mfma_f32_16x16x32_bf16 v[80:83], a[136:139], v[180:183], v[80:83]
    ds_read_b128 a[160:163], v8 offset:45056
    v_mov_b32 v249, v44
    v_mfma_f32_16x16x32_bf16 v[88:91], a[136:139], v[196:199], v[88:91]
    v_exp_f32 v165, v57
    v_mfma_f32_16x16x32_bf16 v[96:99], a[136:139], v[212:215], v[96:99]
    ds_read_b64_tr_b16 a[164:165], v16 offset:40960
    ds_read_b64_tr_b16 a[166:167], v16 offset:45056
    v_mfma_f32_16x16x32_bf16 v[104:107], a[136:139], v[228:231], v[104:107]
    v_exp_f32 v166, v58
    v_mfma_f32_16x16x32_bf16 a[4:7], a[140:143], v[128:131], a[4:7]
    v_exp_f32 v167, v59
    v_mfma_f32_16x16x32_bf16 a[36:39], a[140:143], v[132:135], a[36:39]
    v_exp_f32 v168, v52
    v_mfma_f32_16x16x32_bf16 a[68:71], a[140:143], v[136:139], a[68:71]
    v_exp_f32 v169, v53
    v_mfma_f32_16x16x32_bf16 a[100:103], a[140:143], v[140:143], a[100:103]
    v_mov_b32 v250, v240
    s_waitcnt lgkmcnt(3)
    v_mfma_f32_16x16x32_bf16 v[80:83], a[144:147], v[184:187], v[80:83]
    ds_read_b128 a[168:171], v9 offset:45056
    v_mov_b32 v251, v244
    v_mfma_f32_16x16x32_bf16 v[88:91], a[144:147], v[200:203], v[88:91]
    v_exp_f32 v170, v54
    v_mfma_f32_16x16x32_bf16 v[96:99], a[144:147], v[216:219], v[96:99]
    ds_read_b64_tr_b16 a[172:173], v17 offset:40960
    ds_read_b64_tr_b16 a[174:175], v17 offset:45056
    v_mfma_f32_16x16x32_bf16 v[104:107], a[144:147], v[232:235], v[104:107]
    v_exp_f32 v171, v55
    v_mfma_f32_16x16x32_bf16 a[8:11], a[148:151], v[128:131], a[8:11]
    v_cvt_pk_bf16_f32 v112, v160, v161
    v_cvt_pk_bf16_f32 v113, v162, v163
    v_mfma_f32_16x16x32_bf16 a[40:43], a[148:151], v[132:135], a[40:43]
    v_exp_f32 v160, v64
    v_mfma_f32_16x16x32_bf16 a[72:75], a[148:151], v[136:139], a[72:75]
    v_exp_f32 v161, v65
    v_mfma_f32_16x16x32_bf16 a[104:107], a[148:151], v[140:143], a[104:107]
    buffer_load_dwordx4 v23, s[8:11], s48 offen offset:3072 lds
    v_mfma_f32_16x16x32_bf16 v[80:83], a[152:155], v[188:191], v[80:83]
    ds_read_b128 a[176:179], v10 offset:45056
    s_add_u32 s48, s48, 0x4000
    v_mfma_f32_16x16x32_bf16 v[88:91], a[152:155], v[204:207], v[88:91]
    v_exp_f32 v162, v66
    v_mfma_f32_16x16x32_bf16 v[96:99], a[152:155], v[220:223], v[96:99]
    ds_read_b64_tr_b16 a[180:181], v18 offset:40960
    ds_read_b64_tr_b16 a[182:183], v18 offset:45056
    v_mfma_f32_16x16x32_bf16 v[104:107], a[152:155], v[236:239], v[104:107]
    v_exp_f32 v163, v67
    v_mfma_f32_16x16x32_bf16 a[12:15], a[156:159], v[128:131], a[12:15]
    v_cvt_pk_bf16_f32 v116, v164, v165
    v_cvt_pk_bf16_f32 v117, v166, v167
    v_mfma_f32_16x16x32_bf16 a[44:47], a[156:159], v[132:135], a[44:47]
    v_exp_f32 v164, v60
    v_mfma_f32_16x16x32_bf16 a[76:79], a[156:159], v[136:139], a[76:79]
    v_cvt_pk_bf16_f32 v114, v168, v169
    v_cvt_pk_bf16_f32 v115, v170, v171
    v_mfma_f32_16x16x32_bf16 a[108:111], a[156:159], v[140:143], a[108:111]
    v_exp_f32 v165, v61
    v_mfma_f32_16x16x32_bf16 v[40:43], v[172:175], v[112:115], v[40:43]
    v_cvt_pk_bf16_f32 v120, v160, v161
    s_waitcnt lgkmcnt(3)
    v_mfma_f32_16x16x32_bf16 v[84:87], a[160:163], v[176:179], v[144:147]
    ds_read_b128 a[184:187], v11 offset:45056
    v_cvt_pk_bf16_f32 v121, v162, v163
    v_mfma_f32_16x16x32_bf16 v[92:95], a[160:163], v[192:195], v[148:151]
    v_exp_f32 v166, v62
    v_mfma_f32_16x16x32_bf16 v[100:103], a[160:163], v[208:211], v[152:155]
    ds_read_b64_tr_b16 a[188:189], v19 offset:40960
    ds_read_b64_tr_b16 a[190:191], v19 offset:45056
    v_mfma_f32_16x16x32_bf16 v[108:111], a[160:163], v[224:227], v[156:159]
    v_exp_f32 v167, v63
    v_mfma_f32_16x16x32_bf16 a[16:19], a[164:167], v[128:131], a[16:19]
    v_exp_f32 v168, v72
    v_mfma_f32_16x16x32_bf16 a[48:51], a[164:167], v[132:135], a[48:51]
    v_exp_f32 v169, v73
    v_mfma_f32_16x16x32_bf16 a[80:83], a[164:167], v[136:139], a[80:83]
    v_cvt_pk_bf16_f32 v118, v164, v165
    v_cvt_pk_bf16_f32 v119, v166, v167
    v_mfma_f32_16x16x32_bf16 a[112:115], a[164:167], v[140:143], a[112:115]
    v_exp_f32 v170, v74
    v_mfma_f32_16x16x32_bf16 v[44:47], v[172:175], v[116:119], v[44:47]
    s_waitcnt vmcnt(10)
    s_barrier
    v_mfma_f32_16x16x32_bf16 v[84:87], a[168:171], v[180:183], v[84:87]
    ds_read_b128 a[128:131], v8 offset:49152
    v_cvt_pk_bf16_f32 v124, v168, v169
    v_mfma_f32_16x16x32_bf16 v[92:95], a[168:171], v[196:199], v[92:95]
    v_exp_f32 v171, v75
    v_mfma_f32_16x16x32_bf16 v[100:103], a[168:171], v[212:215], v[100:103]
    ds_read_b64_tr_b16 a[132:133], v12 offset:49152
    ds_read_b64_tr_b16 a[134:135], v12 offset:53248
    v_mfma_f32_16x16x32_bf16 v[108:111], a[168:171], v[228:231], v[108:111]
    v_exp_f32 v160, v68
    v_mfma_f32_16x16x32_bf16 a[20:23], a[172:175], v[128:131], a[20:23]
    v_exp_f32 v161, v69
    v_mfma_f32_16x16x32_bf16 a[52:55], a[172:175], v[132:135], a[52:55]
    v_exp_f32 v162, v70
    v_mfma_f32_16x16x32_bf16 a[84:87], a[172:175], v[136:139], a[84:87]
    v_cvt_pk_bf16_f32 v125, v170, v171
    v_cvt_pk_bf16_f32 v122, v160, v161
    v_exp_f32 v163, v71
    s_nop 0
    v_cvt_pk_bf16_f32 v123, v162, v163
    v_mfma_f32_16x16x32_bf16 a[116:119], a[172:175], v[140:143], a[116:119]
    v_exp_f32 v164, v76
    v_mfma_f32_16x16x32_bf16 v[240:243], v[172:175], v[120:123], v[240:243]
    s_waitcnt lgkmcnt(3)
    v_mfma_f32_16x16x32_bf16 v[84:87], a[176:179], v[184:187], v[84:87]
    ds_read_b128 a[136:139], v9 offset:49152
    s_add_u32 m0, s47, 81920
    v_mfma_f32_16x16x32_bf16 v[92:95], a[176:179], v[200:203], v[92:95]
    v_exp_f32 v165, v77
    v_mfma_f32_16x16x32_bf16 v[100:103], a[176:179], v[216:219], v[100:103]
    ds_read_b64_tr_b16 a[140:141], v13 offset:49152
    ds_read_b64_tr_b16 a[142:143], v13 offset:53248
    v_mfma_f32_16x16x32_bf16 v[108:111], a[176:179], v[232:235], v[108:111]
    v_exp_f32 v166, v78
    v_mfma_f32_16x16x32_bf16 a[24:27], a[180:183], v[128:131], a[24:27]
    v_exp_f32 v167, v79
    v_mfma_f32_16x16x32_bf16 a[56:59], a[180:183], v[132:135], a[56:59]
    v_cvt_pk_bf16_f32 v126, v164, v165
    v_cvt_pk_bf16_f32 v127, v166, v167
    v_mfma_f32_16x16x32_bf16 a[88:91], a[180:183], v[136:139], a[88:91]
    v_max3_f32 v39, v40, v44, v240
    v_mfma_f32_16x16x32_bf16 a[120:123], a[180:183], v[140:143], a[120:123]
    v_mfma_f32_16x16x32_bf16 v[244:247], v[172:175], v[124:127], v[244:247]
    buffer_load_dwordx4 v24, s[12:15], s49 offen offset:0 lds
    v_mfma_f32_16x16x32_bf16 v[84:87], a[184:187], v[188:191], v[84:87]
    ds_read_b128 a[144:147], v10 offset:49152
    v_mfma_f32_16x16x32_bf16 v[92:95], a[184:187], v[204:207], v[92:95]
    v_mfma_f32_16x16x32_bf16 v[100:103], a[184:187], v[220:223], v[100:103]
    ds_read_b64_tr_b16 a[148:149], v14 offset:49152
    ds_read_b64_tr_b16 a[150:151], v14 offset:53248
    v_mfma_f32_16x16x32_bf16 v[108:111], a[184:187], v[236:239], v[108:111]
    buffer_load_dwordx4 v25, s[12:15], s49 offen offset:1024 lds
    v_mfma_f32_16x16x32_bf16 a[28:31], a[188:191], v[128:131], a[28:31]
    v_max_f32 v39, v39, v244
    v_cmp_lt_f32 vcc, s54, v39
    v_mfma_f32_16x16x32_bf16 a[60:63], a[188:191], v[132:135], a[60:63]
    buffer_load_dwordx4 v24, s[12:15], s49 offen offset:2048 lds
    v_mfma_f32_16x16x32_bf16 a[92:95], a[188:191], v[136:139], a[92:95]
    v_mfma_f32_16x16x32_bf16 a[124:127], a[188:191], v[140:143], a[124:127]
    s_cbranch_vccnz k4_kernel_stub102
k4_kernel_ret102:
.p2align 4
k4_kernel_loop:
    s_waitcnt lgkmcnt(3)
    v_mfma_f32_16x16x32_bf16 v[48:51], a[128:131], v[176:179], v[144:147]
    ds_read_b128 a[152:155], v11 offset:49152
    v_mov_b32 v248, v40
    v_mfma_f32_16x16x32_bf16 v[56:59], a[128:131], v[192:195], v[148:151]
    v_exp_f32 v160, v80
    v_mfma_f32_16x16x32_bf16 v[64:67], a[128:131], v[208:211], v[152:155]
    ds_read_b64_tr_b16 a[156:157], v15 offset:49152
    ds_read_b64_tr_b16 a[158:159], v15 offset:53248
    v_mfma_f32_16x16x32_bf16 v[72:75], a[128:131], v[224:227], v[156:159]
    v_exp_f32 v161, v81
    v_mfma_f32_16x16x32_bf16 a[0:3], a[132:135], v[112:115], a[0:3]
    v_exp_f32 v162, v82
    v_mfma_f32_16x16x32_bf16 a[32:35], a[132:135], v[116:119], a[32:35]
    v_exp_f32 v163, v83
    v_mfma_f32_16x16x32_bf16 a[64:67], a[132:135], v[120:123], a[64:67]
    v_exp_f32 v164, v88
    v_mfma_f32_16x16x32_bf16 a[96:99], a[132:135], v[124:127], a[96:99]
    buffer_load_dwordx4 v25, s[12:15], s49 offen offset:3072 lds
    v_mfma_f32_16x16x32_bf16 v[48:51], a[136:139], v[180:183], v[48:51]
    ds_read_b128 a[160:163], v8 offset:53248
    s_add_u32 s49, s49, 0x4000
    v_mfma_f32_16x16x32_bf16 v[56:59], a[136:139], v[196:199], v[56:59]
    v_exp_f32 v165, v89
    v_mfma_f32_16x16x32_bf16 v[64:67], a[136:139], v[212:215], v[64:67]
    ds_read_b64_tr_b16 a[164:165], v16 offset:49152
    ds_read_b64_tr_b16 a[166:167], v16 offset:53248
    v_mfma_f32_16x16x32_bf16 v[72:75], a[136:139], v[228:231], v[72:75]
    v_exp_f32 v166, v90
    v_mfma_f32_16x16x32_bf16 a[4:7], a[140:143], v[112:115], a[4:7]
    v_exp_f32 v167, v91
    v_mfma_f32_16x16x32_bf16 a[36:39], a[140:143], v[116:119], a[36:39]
    v_exp_f32 v168, v84
    v_mfma_f32_16x16x32_bf16 a[68:71], a[140:143], v[120:123], a[68:71]
    v_exp_f32 v169, v85
    v_mfma_f32_16x16x32_bf16 a[100:103], a[140:143], v[124:127], a[100:103]
    v_mov_b32 v249, v44
    s_waitcnt lgkmcnt(3)
    v_mfma_f32_16x16x32_bf16 v[48:51], a[144:147], v[184:187], v[48:51]
    ds_read_b128 a[168:171], v9 offset:53248
    s_add_u32 m0, s47, 16384
    v_mfma_f32_16x16x32_bf16 v[56:59], a[144:147], v[200:203], v[56:59]
    v_exp_f32 v170, v86
    v_mfma_f32_16x16x32_bf16 v[64:67], a[144:147], v[216:219], v[64:67]
    ds_read_b64_tr_b16 a[172:173], v17 offset:49152
    ds_read_b64_tr_b16 a[174:175], v17 offset:53248
    v_mfma_f32_16x16x32_bf16 v[72:75], a[144:147], v[232:235], v[72:75]
    v_exp_f32 v171, v87
    v_mfma_f32_16x16x32_bf16 a[8:11], a[148:151], v[112:115], a[8:11]
    v_mov_b32 v250, v240
    v_mov_b32 v251, v244
    v_mfma_f32_16x16x32_bf16 a[40:43], a[148:151], v[116:119], a[40:43]
    v_cvt_pk_bf16_f32 v128, v160, v161
    v_cvt_pk_bf16_f32 v129, v162, v163
    v_mfma_f32_16x16x32_bf16 a[72:75], a[148:151], v[120:123], a[72:75]
    v_exp_f32 v160, v96
    v_mfma_f32_16x16x32_bf16 a[104:107], a[148:151], v[124:127], a[104:107]
    buffer_load_dwordx4 v20, s[8:11], s48 offen offset:0 lds
    v_mfma_f32_16x16x32_bf16 v[48:51], a[152:155], v[188:191], v[48:51]
    ds_read_b128 a[176:179], v10 offset:53248
    v_cvt_pk_bf16_f32 v132, v164, v165
    v_mfma_f32_16x16x32_bf16 v[56:59], a[152:155], v[204:207], v[56:59]
    v_exp_f32 v161, v97
    v_mfma_f32_16x16x32_bf16 v[64:67], a[152:155], v[220:223], v[64:67]
    ds_read_b64_tr_b16 a[180:181], v18 offset:49152
    ds_read_b64_tr_b16 a[182:183], v18 offset:53248
    v_mfma_f32_16x16x32_bf16 v[72:75], a[152:155], v[236:239], v[72:75]
    v_exp_f32 v162, v98
    v_mfma_f32_16x16x32_bf16 a[12:15], a[156:159], v[112:115], a[12:15]
    v_exp_f32 v163, v99
    v_mfma_f32_16x16x32_bf16 a[44:47], a[156:159], v[116:119], a[44:47]
    v_exp_f32 v164, v92
    v_mfma_f32_16x16x32_bf16 a[76:79], a[156:159], v[120:123], a[76:79]
    v_cvt_pk_bf16_f32 v133, v166, v167
    v_cvt_pk_bf16_f32 v130, v168, v169
    v_cvt_pk_bf16_f32 v131, v170, v171
    v_mfma_f32_16x16x32_bf16 a[108:111], a[156:159], v[124:127], a[108:111]
    v_exp_f32 v165, v93
    v_mfma_f32_16x16x32_bf16 v[40:43], v[172:175], v[128:131], v[40:43]
    v_cvt_pk_bf16_f32 v136, v160, v161
    s_waitcnt lgkmcnt(3)
    v_mfma_f32_16x16x32_bf16 v[52:55], a[160:163], v[176:179], v[144:147]
    ds_read_b128 a[184:187], v11 offset:53248
    v_cvt_pk_bf16_f32 v137, v162, v163
    v_mfma_f32_16x16x32_bf16 v[60:63], a[160:163], v[192:195], v[148:151]
    v_exp_f32 v166, v94
    v_mfma_f32_16x16x32_bf16 v[68:71], a[160:163], v[208:211], v[152:155]
    ds_read_b64_tr_b16 a[188:189], v19 offset:49152
    ds_read_b64_tr_b16 a[190:191], v19 offset:53248
    v_mfma_f32_16x16x32_bf16 v[76:79], a[160:163], v[224:227], v[156:159]
    v_exp_f32 v167, v95
    v_mfma_f32_16x16x32_bf16 a[16:19], a[164:167], v[112:115], a[16:19]
    v_exp_f32 v168, v104
    v_mfma_f32_16x16x32_bf16 a[48:51], a[164:167], v[116:119], a[48:51]
    v_exp_f32 v169, v105
    v_mfma_f32_16x16x32_bf16 a[80:83], a[164:167], v[120:123], a[80:83]
    v_cvt_pk_bf16_f32 v134, v164, v165
    v_cvt_pk_bf16_f32 v135, v166, v167
    v_mfma_f32_16x16x32_bf16 a[112:115], a[164:167], v[124:127], a[112:115]
    v_exp_f32 v170, v106
    v_mfma_f32_16x16x32_bf16 v[44:47], v[172:175], v[132:135], v[44:47]
    buffer_load_dwordx4 v21, s[8:11], s48 offen offset:1024 lds
    v_mfma_f32_16x16x32_bf16 v[52:55], a[168:171], v[180:183], v[52:55]
    ds_read_b128 a[128:131], v8 offset:57344
    v_cvt_pk_bf16_f32 v140, v168, v169
    v_mfma_f32_16x16x32_bf16 v[60:63], a[168:171], v[196:199], v[60:63]
    v_exp_f32 v171, v107
    v_mfma_f32_16x16x32_bf16 v[68:71], a[168:171], v[212:215], v[68:71]
    ds_read_b64_tr_b16 a[132:133], v12 offset:57344
    ds_read_b64_tr_b16 a[134:135], v12 offset:61440
    v_mfma_f32_16x16x32_bf16 v[76:79], a[168:171], v[228:231], v[76:79]
    v_exp_f32 v160, v100
    v_mfma_f32_16x16x32_bf16 a[20:23], a[172:175], v[112:115], a[20:23]
    v_exp_f32 v161, v101
    v_mfma_f32_16x16x32_bf16 a[52:55], a[172:175], v[116:119], a[52:55]
    v_exp_f32 v162, v102
    v_mfma_f32_16x16x32_bf16 a[84:87], a[172:175], v[120:123], a[84:87]
    v_cvt_pk_bf16_f32 v141, v170, v171
    v_cvt_pk_bf16_f32 v138, v160, v161
    v_exp_f32 v163, v103
    s_nop 0
    v_cvt_pk_bf16_f32 v139, v162, v163
    v_mfma_f32_16x16x32_bf16 a[116:119], a[172:175], v[124:127], a[116:119]
    v_exp_f32 v164, v108
    v_mfma_f32_16x16x32_bf16 v[240:243], v[172:175], v[136:139], v[240:243]
    s_waitcnt lgkmcnt(3)
    v_mfma_f32_16x16x32_bf16 v[52:55], a[176:179], v[184:187], v[52:55]
    ds_read_b128 a[136:139], v9 offset:57344
    v_mfma_f32_16x16x32_bf16 v[60:63], a[176:179], v[200:203], v[60:63]
    v_exp_f32 v165, v109
    v_mfma_f32_16x16x32_bf16 v[68:71], a[176:179], v[216:219], v[68:71]
    ds_read_b64_tr_b16 a[140:141], v13 offset:57344
    ds_read_b64_tr_b16 a[142:143], v13 offset:61440
    v_mfma_f32_16x16x32_bf16 v[76:79], a[176:179], v[232:235], v[76:79]
    v_exp_f32 v166, v110
    v_mfma_f32_16x16x32_bf16 a[24:27], a[180:183], v[112:115], a[24:27]
    v_exp_f32 v167, v111
    v_mfma_f32_16x16x32_bf16 a[56:59], a[180:183], v[116:119], a[56:59]
    v_cvt_pk_bf16_f32 v142, v164, v165
    v_cvt_pk_bf16_f32 v143, v166, v167
    v_mfma_f32_16x16x32_bf16 a[88:91], a[180:183], v[120:123], a[88:91]
    v_max3_f32 v39, v40, v44, v240
    v_mfma_f32_16x16x32_bf16 a[120:123], a[180:183], v[124:127], a[120:123]
    v_mfma_f32_16x16x32_bf16 v[244:247], v[172:175], v[140:143], v[244:247]
    buffer_load_dwordx4 v22, s[8:11], s48 offen offset:2048 lds
    v_mfma_f32_16x16x32_bf16 v[52:55], a[184:187], v[188:191], v[52:55]
    ds_read_b128 a[144:147], v10 offset:57344
    v_mfma_f32_16x16x32_bf16 v[60:63], a[184:187], v[204:207], v[60:63]
    v_mfma_f32_16x16x32_bf16 v[68:71], a[184:187], v[220:223], v[68:71]
    ds_read_b64_tr_b16 a[148:149], v14 offset:57344
    ds_read_b64_tr_b16 a[150:151], v14 offset:61440
    v_mfma_f32_16x16x32_bf16 v[76:79], a[184:187], v[236:239], v[76:79]
    buffer_load_dwordx4 v23, s[8:11], s48 offen offset:3072 lds
    v_mfma_f32_16x16x32_bf16 a[28:31], a[188:191], v[112:115], a[28:31]
    v_max_f32 v39, v39, v244
    v_cmp_lt_f32 vcc, s54, v39
    v_mfma_f32_16x16x32_bf16 a[60:63], a[188:191], v[116:119], a[60:63]
    v_mfma_f32_16x16x32_bf16 a[92:95], a[188:191], v[120:123], a[92:95]
    v_mfma_f32_16x16x32_bf16 a[124:127], a[188:191], v[124:127], a[124:127]
    s_cbranch_vccnz k4_kernel_stub0
k4_kernel_ret0:
    s_waitcnt lgkmcnt(3)
    v_mfma_f32_16x16x32_bf16 v[80:83], a[128:131], v[176:179], v[144:147]
    ds_read_b128 a[152:155], v11 offset:57344
    s_add_u32 s48, s48, 0x4000
    v_mfma_f32_16x16x32_bf16 v[88:91], a[128:131], v[192:195], v[148:151]
    v_exp_f32 v160, v48
    v_mfma_f32_16x16x32_bf16 v[96:99], a[128:131], v[208:211], v[152:155]
    ds_read_b64_tr_b16 a[156:157], v15 offset:57344
    ds_read_b64_tr_b16 a[158:159], v15 offset:61440
    v_mfma_f32_16x16x32_bf16 v[104:107], a[128:131], v[224:227], v[156:159]
    v_exp_f32 v161, v49
    v_mfma_f32_16x16x32_bf16 a[0:3], a[132:135], v[128:131], a[0:3]
    v_exp_f32 v162, v50
    v_mfma_f32_16x16x32_bf16 a[32:35], a[132:135], v[132:135], a[32:35]
    v_exp_f32 v163, v51
    v_mfma_f32_16x16x32_bf16 a[64:67], a[132:135], v[136:139], a[64:67]
    v_exp_f32 v164, v56
    v_mfma_f32_16x16x32_bf16 a[96:99], a[132:135], v[140:143], a[96:99]
    v_exp_f32 v165, v57
    v_mfma_f32_16x16x32_bf16 v[80:83], a[136:139], v[180:183], v[80:83]
    ds_read_b128 a[160:163], v8 offset:61440
    buffer_load_dword v255, v254, s[24:27], s58 offen
    v_mfma_f32_16x16x32_bf16 v[88:91], a[136:139], v[196:199], v[88:91]
    v_exp_f32 v166, v58
    v_mfma_f32_16x16x32_bf16 v[96:99], a[136:139], v[212:215], v[96:99]
    ds_read_b64_tr_b16 a[164:165], v16 offset:57344
    ds_read_b64_tr_b16 a[166:167], v16 offset:61440
    s_mov_b32 s24, s28
    v_mfma_f32_16x16x32_bf16 v[104:107], a[136:139], v[228:231], v[104:107]
    v_exp_f32 v167, v59
    v_mfma_f32_16x16x32_bf16 a[4:7], a[140:143], v[128:131], a[4:7]
    v_mov_b32 v248, v40
    s_mov_b32 s25, s29
    v_mfma_f32_16x16x32_bf16 a[36:39], a[140:143], v[132:135], a[36:39]
    v_exp_f32 v168, v52
    v_mfma_f32_16x16x32_bf16 a[68:71], a[140:143], v[136:139], a[68:71]
    v_mov_b32 v249, v44
    s_mov_b32 s28, s36
    v_mfma_f32_16x16x32_bf16 a[100:103], a[140:143], v[140:143], a[100:103]
    v_mov_b32 v250, v240
    s_waitcnt lgkmcnt(3)
    v_mfma_f32_16x16x32_bf16 v[80:83], a[144:147], v[184:187], v[80:83]
    ds_read_b128 a[168:171], v9 offset:61440
    s_mov_b32 s29, s37
    v_mfma_f32_16x16x32_bf16 v[88:91], a[144:147], v[200:203], v[88:91]
    v_exp_f32 v169, v53
    v_mfma_f32_16x16x32_bf16 v[96:99], a[144:147], v[216:219], v[96:99]
    ds_read_b64_tr_b16 a[172:173], v17 offset:57344
    ds_read_b64_tr_b16 a[174:175], v17 offset:61440
    s_mov_b32 s26, s30
    v_mfma_f32_16x16x32_bf16 v[104:107], a[144:147], v[232:235], v[104:107]
    v_exp_f32 v170, v54
    v_mfma_f32_16x16x32_bf16 a[8:11], a[148:151], v[128:131], a[8:11]
    v_mov_b32 v251, v244
    s_mov_b32 s30, s38
    v_mfma_f32_16x16x32_bf16 a[40:43], a[148:151], v[132:135], a[40:43]
    v_exp_f32 v171, v55
    v_mfma_f32_16x16x32_bf16 a[72:75], a[148:151], v[136:139], a[72:75]
    v_cvt_pk_bf16_f32 v112, v160, v161
    s_mov_b32 s38, 0
    v_mfma_f32_16x16x32_bf16 a[104:107], a[148:151], v[140:143], a[104:107]
    v_exp_f32 v160, v64
    v_mfma_f32_16x16x32_bf16 v[80:83], a[152:155], v[188:191], v[80:83]
    ds_read_b128 a[176:179], v10 offset:61440
    v_cvt_pk_bf16_f32 v113, v162, v163
    v_mfma_f32_16x16x32_bf16 v[88:91], a[152:155], v[204:207], v[88:91]
    v_exp_f32 v161, v65
    v_mfma_f32_16x16x32_bf16 v[96:99], a[152:155], v[220:223], v[96:99]
    ds_read_b64_tr_b16 a[180:181], v18 offset:57344
    ds_read_b64_tr_b16 a[182:183], v18 offset:61440
    v_mfma_f32_16x16x32_bf16 v[104:107], a[152:155], v[236:239], v[104:107]
    v_exp_f32 v162, v66
    v_mfma_f32_16x16x32_bf16 a[12:15], a[156:159], v[128:131], a[12:15]
    v_exp_f32 v163, v67
    v_mfma_f32_16x16x32_bf16 a[44:47], a[156:159], v[132:135], a[44:47]
    v_cvt_pk_bf16_f32 v116, v164, v165
    v_cvt_pk_bf16_f32 v117, v166, v167
    v_mfma_f32_16x16x32_bf16 a[76:79], a[156:159], v[136:139], a[76:79]
    v_cvt_pk_bf16_f32 v114, v168, v169
    v_cvt_pk_bf16_f32 v115, v170, v171
    v_mfma_f32_16x16x32_bf16 a[108:111], a[156:159], v[140:143], a[108:111]
    v_exp_f32 v164, v60
    v_mfma_f32_16x16x32_bf16 v[40:43], v[172:175], v[112:115], v[40:43]
    v_cvt_pk_bf16_f32 v120, v160, v161
    s_waitcnt lgkmcnt(3)
    v_mfma_f32_16x16x32_bf16 v[84:87], a[160:163], v[176:179], v[144:147]
    ds_read_b128 a[184:187], v11 offset:61440
    v_cvt_pk_bf16_f32 v121, v162, v163
    v_mfma_f32_16x16x32_bf16 v[92:95], a[160:163], v[192:195], v[148:151]
    v_exp_f32 v165, v61
    v_mfma_f32_16x16x32_bf16 v[100:103], a[160:163], v[208:211], v[152:155]
    ds_read_b64_tr_b16 a[188:189], v19 offset:57344
    ds_read_b64_tr_b16 a[190:191], v19 offset:61440
    v_mfma_f32_16x16x32_bf16 v[108:111], a[160:163], v[224:227], v[156:159]
    v_exp_f32 v166, v62
    v_mfma_f32_16x16x32_bf16 a[16:19], a[164:167], v[128:131], a[16:19]
    v_exp_f32 v167, v63
    v_mfma_f32_16x16x32_bf16 a[48:51], a[164:167], v[132:135], a[48:51]
    v_exp_f32 v168, v72
    v_mfma_f32_16x16x32_bf16 a[80:83], a[164:167], v[136:139], a[80:83]
    v_cvt_pk_bf16_f32 v118, v164, v165
    v_cvt_pk_bf16_f32 v119, v166, v167
    v_mfma_f32_16x16x32_bf16 a[112:115], a[164:167], v[140:143], a[112:115]
    v_exp_f32 v169, v73
    v_mfma_f32_16x16x32_bf16 v[44:47], v[172:175], v[116:119], v[44:47]
    s_waitcnt vmcnt(9)
    s_barrier
    v_mfma_f32_16x16x32_bf16 v[84:87], a[168:171], v[180:183], v[84:87]
    ds_read_b128 a[128:131], v8 offset:0
    v_cvt_pk_bf16_f32 v124, v168, v169
    v_mfma_f32_16x16x32_bf16 v[92:95], a[168:171], v[196:199], v[92:95]
    v_exp_f32 v170, v74
    v_mfma_f32_16x16x32_bf16 v[100:103], a[168:171], v[212:215], v[100:103]
    ds_read_b64_tr_b16 a[132:133], v12 offset:0
    ds_read_b64_tr_b16 a[134:135], v12 offset:4096
    v_mfma_f32_16x16x32_bf16 v[108:111], a[168:171], v[228:231], v[108:111]
    v_exp_f32 v171, v75
    v_mfma_f32_16x16x32_bf16 a[20:23], a[172:175], v[128:131], a[20:23]
    v_exp_f32 v160, v68
    v_mfma_f32_16x16x32_bf16 a[52:55], a[172:175], v[132:135], a[52:55]
    v_exp_f32 v161, v69
    v_mfma_f32_16x16x32_bf16 a[84:87], a[172:175], v[136:139], a[84:87]
    v_cvt_pk_bf16_f32 v125, v170, v171
    v_cvt_pk_bf16_f32 v122, v160, v161
    v_exp_f32 v162, v70
    v_exp_f32 v163, v71
    s_nop 0
    v_cvt_pk_bf16_f32 v123, v162, v163
    v_mfma_f32_16x16x32_bf16 a[116:119], a[172:175], v[140:143], a[116:119]
    v_exp_f32 v164, v76
    v_mfma_f32_16x16x32_bf16 v[240:243], v[172:175], v[120:123], v[240:243]
    s_waitcnt lgkmcnt(3)
    v_mfma_f32_16x16x32_bf16 v[84:87], a[176:179], v[184:187], v[84:87]
    ds_read_b128 a[136:139], v9 offset:0
    s_add_u32 m0, s47, 98304
    v_mfma_f32_16x16x32_bf16 v[92:95], a[176:179], v[200:203], v[92:95]
    v_exp_f32 v165, v77
    v_mfma_f32_16x16x32_bf16 v[100:103], a[176:179], v[216:219], v[100:103]
    ds_read_b64_tr_b16 a[140:141], v13 offset:0
    ds_read_b64_tr_b16 a[142:143], v13 offset:4096
    v_mfma_f32_16x16x32_bf16 v[108:111], a[176:179], v[232:235], v[108:111]
    v_exp_f32 v166, v78
    v_mfma_f32_16x16x32_bf16 a[24:27], a[180:183], v[128:131], a[24:27]
    v_exp_f32 v167, v79
    v_mfma_f32_16x16x32_bf16 a[56:59], a[180:183], v[132:135], a[56:59]
    v_cvt_pk_bf16_f32 v126, v164, v165
    v_cvt_pk_bf16_f32 v127, v166, v167
    v_mfma_f32_16x16x32_bf16 a[88:91], a[180:183], v[136:139], a[88:91]
    v_max3_f32 v39, v40, v44, v240
    v_mfma_f32_16x16x32_bf16 a[120:123], a[180:183], v[140:143], a[120:123]
    v_mfma_f32_16x16x32_bf16 v[244:247], v[172:175], v[124:127], v[244:247]
    buffer_load_dwordx4 v24, s[12:15], s49 offen offset:0 lds
    v_mfma_f32_16x16x32_bf16 v[84:87], a[184:187], v[188:191], v[84:87]
    ds_read_b128 a[144:147], v10 offset:0
    v_mfma_f32_16x16x32_bf16 v[92:95], a[184:187], v[204:207], v[92:95]
    v_mfma_f32_16x16x32_bf16 v[100:103], a[184:187], v[220:223], v[100:103]
    ds_read_b64_tr_b16 a[148:149], v14 offset:0
    ds_read_b64_tr_b16 a[150:151], v14 offset:4096
    v_mfma_f32_16x16x32_bf16 v[108:111], a[184:187], v[236:239], v[108:111]
    buffer_load_dwordx4 v25, s[12:15], s49 offen offset:1024 lds
    v_mfma_f32_16x16x32_bf16 a[28:31], a[188:191], v[128:131], a[28:31]
    v_max_f32 v39, v39, v244
    v_cmp_lt_f32 vcc, s54, v39
    v_mfma_f32_16x16x32_bf16 a[60:63], a[188:191], v[132:135], a[60:63]
    buffer_load_dwordx4 v24, s[12:15], s49 offen offset:2048 lds
    v_mfma_f32_16x16x32_bf16 a[92:95], a[188:191], v[136:139], a[92:95]
    v_mfma_f32_16x16x32_bf16 a[124:127], a[188:191], v[140:143], a[124:127]
    s_cbranch_vccnz k4_kernel_stub1
k4_kernel_ret1:
    s_waitcnt lgkmcnt(3)
    v_mfma_f32_16x16x32_bf16 v[48:51], a[128:131], v[176:179], v[144:147]
    ds_read_b128 a[152:155], v11 offset:0
    v_mov_b32 v248, v40
    v_mfma_f32_16x16x32_bf16 v[56:59], a[128:131], v[192:195], v[148:151]
    v_exp_f32 v160, v80
    v_mfma_f32_16x16x32_bf16 v[64:67], a[128:131], v[208:211], v[152:155]
    ds_read_b64_tr_b16 a[156:157], v15 offset:0
    ds_read_b64_tr_b16 a[158:159], v15 offset:4096
    v_mfma_f32_16x16x32_bf16 v[72:75], a[128:131], v[224:227], v[156:159]
    v_exp_f32 v161, v81
    v_mfma_f32_16x16x32_bf16 a[0:3], a[132:135], v[112:115], a[0:3]
    v_exp_f32 v162, v82
    v_mfma_f32_16x16x32_bf16 a[32:35], a[132:135], v[116:119], a[32:35]
    v_exp_f32 v163, v83
    v_mfma_f32_16x16x32_bf16 a[64:67], a[132:135], v[120:123], a[64:67]
    v_exp_f32 v164, v88
    v_mfma_f32_16x16x32_bf16 a[96:99], a[132:135], v[124:127], a[96:99]
    buffer_load_dwordx4 v25, s[12:15], s49 offen offset:3072 lds
    v_mfma_f32_16x16x32_bf16 v[48:51], a[136:139], v[180:183], v[48:51]
    ds_read_b128 a[160:163], v8 offset:4096
    s_add_u32 s49, s49, 0x4000
    v_mfma_f32_16x16x32_bf16 v[56:59], a[136:139], v[196:199], v[56:59]
    v_exp_f32 v165, v89
    v_mfma_f32_16x16x32_bf16 v[64:67], a[136:139], v[212:215], v[64:67]
    ds_read_b64_tr_b16 a[164:165], v16 offset:0
    ds_read_b64_tr_b16 a[166:167], v16 offset:4096
    v_mfma_f32_16x16x32_bf16 v[72:75], a[136:139], v[228:231], v[72:75]
    v_exp_f32 v166, v90
    v_mfma_f32_16x16x32_bf16 a[4:7], a[140:143], v[112:115], a[4:7]
    v_exp_f32 v167, v91
    v_mfma_f32_16x16x32_bf16 a[36:39], a[140:143], v[116:119], a[36:39]
    v_exp_f32 v168, v84
    v_mfma_f32_16x16x32_bf16 a[68:71], a[140:143], v[120:123], a[68:71]
    v_exp_f32 v169, v85
    v_mfma_f32_16x16x32_bf16 a[100:103], a[140:143], v[124:127], a[100:103]
    v_mov_b32 v249, v44
    s_waitcnt lgkmcnt(3)
    v_mfma_f32_16x16x32_bf16 v[48:51], a[144:147], v[184:187], v[48:51]
    ds_read_b128 a[168:171], v9 offset:4096
    s_add_u32 m0, s47, 32768
    v_mfma_f32_16x16x32_bf16 v[56:59], a[144:147], v[200:203], v[56:59]
    v_exp_f32 v170, v86
    v_mfma_f32_16x16x32_bf16 v[64:67], a[144:147], v[216:219], v[64:67]
    ds_read_b64_tr_b16 a[172:173], v17 offset:0
    ds_read_b64_tr_b16 a[174:175], v17 offset:4096
    v_mfma_f32_16x16x32_bf16 v[72:75], a[144:147], v[232:235], v[72:75]
    v_exp_f32 v171, v87
    v_mfma_f32_16x16x32_bf16 a[8:11], a[148:151], v[112:115], a[8:11]
    v_mov_b32 v250, v240
    v_mov_b32 v251, v244
    v_mfma_f32_16x16x32_bf16 a[40:43], a[148:151], v[116:119], a[40:43]
    v_cvt_pk_bf16_f32 v128, v160, v161
    v_cvt_pk_bf16_f32 v129, v162, v163
    v_mfma_f32_16x16x32_bf16 a[72:75], a[148:151], v[120:123], a[72:75]
    v_exp_f32 v160, v96
    v_mfma_f32_16x16x32_bf16 a[104:107], a[148:151], v[124:127], a[104:107]
    buffer_load_dwordx4 v20, s[8:11], s48 offen offset:0 lds
    v_mfma_f32_16x16x32_bf16 v[48:51], a[152:155], v[188:191], v[48:51]
    ds_read_b128 a[176:179], v10 offset:4096
    v_cvt_pk_bf16_f32 v132, v164, v165
    v_mfma_f32_16x16x32_bf16 v[56:59], a[152:155], v[204:207], v[56:59]
    v_exp_f32 v161, v97
    v_mfma_f32_16x16x32_bf16 v[64:67], a[152:155], v[220:223], v[64:67]
    ds_read_b64_tr_b16 a[180:181], v18 offset:0
    ds_read_b64_tr_b16 a[182:183], v18 offset:4096
    v_mfma_f32_16x16x32_bf16 v[72:75], a[152:155], v[236:239], v[72:75]
    v_exp_f32 v162, v98
    v_mfma_f32_16x16x32_bf16 a[12:15], a[156:159], v[112:115], a[12:15]
    v_exp_f32 v163, v99
    v_mfma_f32_16x16x32_bf16 a[44:47], a[156:159], v[116:119], a[44:47]
    v_exp_f32 v164, v92
    v_mfma_f32_16x16x32_bf16 a[76:79], a[156:159], v[120:123], a[76:79]
    v_cvt_pk_bf16_f32 v133, v166, v167
    v_cvt_pk_bf16_f32 v130, v168, v169
    v_cvt_pk_bf16_f32 v131, v170, v171
    v_mfma_f32_16x16x32_bf16 a[108:111], a[156:159], v[124:127], a[108:111]
    v_exp_f32 v165, v93
    v_mfma_f32_16x16x32_bf16 v[40:43], v[172:175], v[128:131], v[40:43]
    v_cvt_pk_bf16_f32 v136, v160, v161
    s_waitcnt lgkmcnt(3)
    v_mfma_f32_16x16x32_bf16 v[52:55], a[160:163], v[176:179], v[144:147]
    ds_read_b128 a[184:187], v11 offset:4096
    v_cvt_pk_bf16_f32 v137, v162, v163
    v_mfma_f32_16x16x32_bf16 v[60:63], a[160:163], v[192:195], v[148:151]
    v_exp_f32 v166, v94
    v_mfma_f32_16x16x32_bf16 v[68:71], a[160:163], v[208:211], v[152:155]
    ds_read_b64_tr_b16 a[188:189], v19 offset:0
    ds_read_b64_tr_b16 a[190:191], v19 offset:4096
    v_mfma_f32_16x16x32_bf16 v[76:79], a[160:163], v[224:227], v[156:159]
    v_exp_f32 v167, v95
    v_mfma_f32_16x16x32_bf16 a[16:19], a[164:167], v[112:115], a[16:19]
    v_exp_f32 v168, v104
    v_mfma_f32_16x16x32_bf16 a[48:51], a[164:167], v[116:119], a[48:51]
    v_exp_f32 v169, v105
    v_mfma_f32_16x16x32_bf16 a[80:83], a[164:167], v[120:123], a[80:83]
    v_cvt_pk_bf16_f32 v134, v164, v165
    v_cvt_pk_bf16_f32 v135, v166, v167
    v_mfma_f32_16x16x32_bf16 a[112:115], a[164:167], v[124:127], a[112:115]
    v_exp_f32 v170, v106
    v_mfma_f32_16x16x32_bf16 v[44:47], v[172:175], v[132:135], v[44:47]
    buffer_load_dwordx4 v21, s[8:11], s48 offen offset:1024 lds
    v_mfma_f32_16x16x32_bf16 v[52:55], a[168:171], v[180:183], v[52:55]
    ds_read_b128 a[128:131], v8 offset:8192
    v_cvt_pk_bf16_f32 v140, v168, v169
    v_mfma_f32_16x16x32_bf16 v[60:63], a[168:171], v[196:199], v[60:63]
    v_exp_f32 v171, v107
    v_mfma_f32_16x16x32_bf16 v[68:71], a[168:171], v[212:215], v[68:71]
    ds_read_b64_tr_b16 a[132:133], v12 offset:8192
    ds_read_b64_tr_b16 a[134:135], v12 offset:12288
    v_mfma_f32_16x16x32_bf16 v[76:79], a[168:171], v[228:231], v[76:79]
    v_exp_f32 v160, v100
    v_mfma_f32_16x16x32_bf16 a[20:23], a[172:175], v[112:115], a[20:23]
    v_exp_f32 v161, v101
    v_mfma_f32_16x16x32_bf16 a[52:55], a[172:175], v[116:119], a[52:55]
    v_exp_f32 v162, v102
    v_mfma_f32_16x16x32_bf16 a[84:87], a[172:175], v[120:123], a[84:87]
    v_cvt_pk_bf16_f32 v141, v170, v171
    v_cvt_pk_bf16_f32 v138, v160, v161
    v_exp_f32 v163, v103
    s_nop 0
    v_cvt_pk_bf16_f32 v139, v162, v163
    v_mfma_f32_16x16x32_bf16 a[116:119], a[172:175], v[124:127], a[116:119]
    v_exp_f32 v164, v108
    v_mfma_f32_16x16x32_bf16 v[240:243], v[172:175], v[136:139], v[240:243]
    s_waitcnt lgkmcnt(3)
    v_mfma_f32_16x16x32_bf16 v[52:55], a[176:179], v[184:187], v[52:55]
    ds_read_b128 a[136:139], v9 offset:8192
    v_mfma_f32_16x16x32_bf16 v[60:63], a[176:179], v[200:203], v[60:63]
    v_exp_f32 v165, v109
    v_mfma_f32_16x16x32_bf16 v[68:71], a[176:179], v[216:219], v[68:71]
    ds_read_b64_tr_b16 a[140:141], v13 offset:8192
    ds_read_b64_tr_b16 a[142:143], v13 offset:12288
    v_mfma_f32_16x16x32_bf16 v[76:79], a[176:179], v[232:235], v[76:79]
    v_exp_f32 v166, v110
    v_mfma_f32_16x16x32_bf16 a[24:27], a[180:183], v[112:115], a[24:27]
    v_exp_f32 v167, v111
    v_mfma_f32_16x16x32_bf16 a[56:59], a[180:183], v[116:119], a[56:59]
    v_cvt_pk_bf16_f32 v142, v164, v165
    v_cvt_pk_bf16_f32 v143, v166, v167
    v_mfma_f32_16x16x32_bf16 a[88:91], a[180:183], v[120:123], a[88:91]
    v_max3_f32 v39, v40, v44, v240
    v_mfma_f32_16x16x32_bf16 a[120:123], a[180:183], v[124:127], a[120:123]
    v_mfma_f32_16x16x32_bf16 v[244:247], v[172:175], v[140:143], v[244:247]
    buffer_load_dwordx4 v22, s[8:11], s48 offen offset:2048 lds
    v_mfma_f32_16x16x32_bf16 v[52:55], a[184:187], v[188:191], v[52:55]
    ds_read_b128 a[144:147], v10 offset:8192
    v_mfma_f32_16x16x32_bf16 v[60:63], a[184:187], v[204:207], v[60:63]
    v_mfma_f32_16x16x32_bf16 v[68:71], a[184:187], v[220:223], v[68:71]
    ds_read_b64_tr_b16 a[148:149], v14 offset:8192
    ds_read_b64_tr_b16 a[150:151], v14 offset:12288
    v_mfma_f32_16x16x32_bf16 v[76:79], a[184:187], v[236:239], v[76:79]
    buffer_load_dwordx4 v23, s[8:11], s48 offen offset:3072 lds
    v_mfma_f32_16x16x32_bf16 a[28:31], a[188:191], v[112:115], a[28:31]
    v_max_f32 v39, v39, v244
    v_cmp_lt_f32 vcc, s54, v39
    v_mfma_f32_16x16x32_bf16 a[60:63], a[188:191], v[116:119], a[60:63]
    v_mfma_f32_16x16x32_bf16 a[92:95], a[188:191], v[120:123], a[92:95]
    v_mfma_f32_16x16x32_bf16 a[124:127], a[188:191], v[124:127], a[124:127]
    s_cbranch_vccnz k4_kernel_stub2
k4_kernel_ret2:
    s_waitcnt lgkmcnt(3)
    v_mfma_f32_16x16x32_bf16 v[80:83], a[128:131], v[176:179], v[144:147]
    ds_read_b128 a[152:155], v11 offset:8192
    s_add_u32 s48, s48, 0x4000
    v_mfma_f32_16x16x32_bf16 v[88:91], a[128:131], v[192:195], v[148:151]
    v_exp_f32 v160, v48
    v_mfma_f32_16x16x32_bf16 v[96:99], a[128:131], v[208:211], v[152:155]
    ds_read_b64_tr_b16 a[156:157], v15 offset:8192
    ds_read_b64_tr_b16 a[158:159], v15 offset:12288
    v_mfma_f32_16x16x32_bf16 v[104:107], a[128:131], v[224:227], v[156:159]
    v_exp_f32 v161, v49
    v_mfma_f32_16x16x32_bf16 a[0:3], a[132:135], v[128:131], a[0:3]
    v_exp_f32 v162, v50
    v_mfma_f32_16x16x32_bf16 a[32:35], a[132:135], v[132:135], a[32:35]
    v_exp_f32 v163, v51
    v_mfma_f32_16x16x32_bf16 a[64:67], a[132:135], v[136:139], a[64:67]
    v_exp_f32 v164, v56
    v_mfma_f32_16x16x32_bf16 a[96:99], a[132:135], v[140:143], a[96:99]
    v_exp_f32 v165, v57
    v_mfma_f32_16x16x32_bf16 v[80:83], a[136:139], v[180:183], v[80:83]
    ds_read_b128 a[160:163], v8 offset:12288
    v_mov_b32 v248, v40
    v_mfma_f32_16x16x32_bf16 v[88:91], a[136:139], v[196:199], v[88:91]
    v_exp_f32 v166, v58
    v_mfma_f32_16x16x32_bf16 v[96:99], a[136:139], v[212:215], v[96:99]
    ds_read_b64_tr_b16 a[164:165], v16 offset:8192
    ds_read_b64_tr_b16 a[166:167], v16 offset:12288
    v_mfma_f32_16x16x32_bf16 v[104:107], a[136:139], v[228:231], v[104:107]
    v_exp_f32 v167, v59
    v_mfma_f32_16x16x32_bf16 a[4:7], a[140:143], v[128:131], a[4:7]
    v_exp_f32 v168, v52
    v_mfma_f32_16x16x32_bf16 a[36:39], a[140:143], v[132:135], a[36:39]
    v_exp_f32 v169, v53
    v_mfma_f32_16x16x32_bf16 a[68:71], a[140:143], v[136:139], a[68:71]
    v_exp_f32 v170, v54
    v_mfma_f32_16x16x32_bf16 a[100:103], a[140:143], v[140:143], a[100:103]
    v_mov_b32 v249, v44
    s_waitcnt lgkmcnt(3)
    v_mfma_f32_16x16x32_bf16 v[80:83], a[144:147], v[184:187], v[80:83]
    ds_read_b128 a[168:171], v9 offset:12288
    v_mov_b32 v250, v240
    v_mfma_f32_16x16x32_bf16 v[88:91], a[144:147], v[200:203], v[88:91]
    v_exp_f32 v171, v55
    v_mfma_f32_16x16x32_bf16 v[96:99], a[144:147], v[216:219], v[96:99]
    ds_read_b64_tr_b16 a[172:173], v17 offset:8192
    ds_read_b64_tr_b16 a[174:175], v17 offset:12288
    v_mfma_f32_16x16x32_bf16 v[104:107], a[144:147], v[232:235], v[104:107]
    v_mov_b32 v251, v244
    v_cvt_pk_bf16_f32 v112, v160, v161
    v_mfma_f32_16x16x32_bf16 a[8:11], a[148:151], v[128:131], a[8:11]
    v_exp_f32 v160, v64
    v_mfma_f32_16x16x32_bf16 a[40:43], a[148:151], v[132:135], a[40:43]
    v_exp_f32 v161, v65
    v_mfma_f32_16x16x32_bf16 a[72:75], a[148:151], v[136:139], a[72:75]
    v_cvt_pk_bf16_f32 v113, v162, v163
    v_cvt_pk_bf16_f32 v116, v164, v165
    v_mfma_f32_16x16x32_bf16 a[104:107], a[148:151], v[140:143], a[104:107]
    v_exp_f32 v162, v66
    v_mfma_f32_16x16x32_bf16 v[80:83], a[152:155], v[188:191], v[80:83]
    ds_read_b128 a[176:179], v10 offset:12288
    v_cvt_pk_bf16_f32 v117, v166, v167
    v_mfma_f32_16x16x32_bf16 v[88:91], a[152:155], v[204:207], v[88:91]
    v_exp_f32 v163, v67
    v_mfma_f32_16x16x32_bf16 v[96:99], a[152:155], v[220:223], v[96:99]
    ds_read_b64_tr_b16 a[180:181], v18 offset:8192
    ds_read_b64_tr_b16 a[182:183], v18 offset:12288
    v_mfma_f32_16x16x32_bf16 v[104:107], a[152:155], v[236:239], v[104:107]
    v_exp_f32 v164, v60
    v_mfma_f32_16x16x32_bf16 a[12:15], a[156:159], v[128:131], a[12:15]
    v_exp_f32 v165, v61
    v_mfma_f32_16x16x32_bf16 a[44:47], a[156:159], v[132:135], a[44:47]
    v_exp_f32 v166, v62
    v_mfma_f32_16x16x32_bf16 a[76:79], a[156:159], v[136:139], a[76:79]
    v_cvt_pk_bf16_f32 v114, v168, v169
    v_cvt_pk_bf16_f32 v115, v170, v171
    v_mfma_f32_16x16x32_bf16 a[108:111], a[156:159], v[140:143], a[108:111]
    v_exp_f32 v167, v63
    v_mfma_f32_16x16x32_bf16 v[40:43], v[172:175], v[112:115], v[40:43]
    v_cvt_pk_bf16_f32 v120, v160, v161
    s_waitcnt lgkmcnt(3)
    v_mfma_f32_16x16x32_bf16 v[84:87], a[160:163], v[176:179], v[144:147]
    ds_read_b128 a[184:187], v11 offset:12288
    v_cvt_pk_bf16_f32 v121, v162, v163
    v_mfma_f32_16x16x32_bf16 v[92:95], a[160:163], v[192:195], v[148:151]
    v_exp_f32 v168, v72
    v_mfma_f32_16x16x32_bf16 v[100:103], a[160:163], v[208:211], v[152:155]
    ds_read_b64_tr_b16 a[188:189], v19 offset:8192
    ds_read_b64_tr_b16 a[190:191], v19 offset:12288
    v_mfma_f32_16x16x32_bf16 v[108:111], a[160:163], v[224:227], v[156:159]
    v_exp_f32 v169, v73
    v_mfma_f32_16x16x32_bf16 a[16:19], a[164:167], v[128:131], a[16:19]
    v_exp_f32 v170, v74
    v_mfma_f32_16x16x32_bf16 a[48:51], a[164:167], v[132:135], a[48:51]
    v_exp_f32 v171, v75
    v_mfma_f32_16x16x32_bf16 a[80:83], a[164:167], v[136:139], a[80:83]
    v_cvt_pk_bf16_f32 v118, v164, v165
    v_cvt_pk_bf16_f32 v119, v166, v167
    v_mfma_f32_16x16x32_bf16 a[112:115], a[164:167], v[140:143], a[112:115]
    v_exp_f32 v160, v68
    v_mfma_f32_16x16x32_bf16 v[44:47], v[172:175], v[116:119], v[44:47]
    s_waitcnt vmcnt(9)
    s_barrier
    v_mfma_f32_16x16x32_bf16 v[84:87], a[168:171], v[180:183], v[84:87]
    ds_read_b128 a[128:131], v8 offset:16384
    v_cvt_pk_bf16_f32 v124, v168, v169
    v_mfma_f32_16x16x32_bf16 v[92:95], a[168:171], v[196:199], v[92:95]
    v_exp_f32 v161, v69
    v_mfma_f32_16x16x32_bf16 v[100:103], a[168:171], v[212:215], v[100:103]
    ds_read_b64_tr_b16 a[132:133], v12 offset:16384
    ds_read_b64_tr_b16 a[134:135], v12 offset:20480
    v_mfma_f32_16x16x32_bf16 v[108:111], a[168:171], v[228:231], v[108:111]
    v_exp_f32 v162, v70
    v_mfma_f32_16x16x32_bf16 a[20:23], a[172:175], v[128:131], a[20:23]
    v_exp_f32 v163, v71
    v_mfma_f32_16x16x32_bf16 a[52:55], a[172:175], v[132:135], a[52:55]
    v_exp_f32 v164, v76
    v_mfma_f32_16x16x32_bf16 a[84:87], a[172:175], v[136:139], a[84:87]
    v_cvt_pk_bf16_f32 v125, v170, v171
    v_cvt_pk_bf16_f32 v122, v160, v161
    v_cvt_pk_bf16_f32 v123, v162, v163
    v_mfma_f32_16x16x32_bf16 a[116:119], a[172:175], v[140:143], a[116:119]
    v_exp_f32 v165, v77
    v_mfma_f32_16x16x32_bf16 v[240:243], v[172:175], v[120:123], v[240:243]
    v_cvt_pk_bf16_f32 v126, v164, v165
    s_waitcnt lgkmcnt(3)
    v_mfma_f32_16x16x32_bf16 v[84:87], a[176:179], v[184:187], v[84:87]
    ds_read_b128 a[136:139], v9 offset:16384
    s_add_u32 m0, s47, 114688
    v_mfma_f32_16x16x32_bf16 v[92:95], a[176:179], v[200:203], v[92:95]
    v_exp_f32 v166, v78
    v_mfma_f32_16x16x32_bf16 v[100:103], a[176:179], v[216:219], v[100:103]
    ds_read_b64_tr_b16 a[140:141], v13 offset:16384
    ds_read_b64_tr_b16 a[142:143], v13 offset:20480
    v_mfma_f32_16x16x32_bf16 v[108:111], a[176:179], v[232:235], v[108:111]
    v_exp_f32 v167, v79
    v_mfma_f32_16x16x32_bf16 a[24:27], a[180:183], v[128:131], a[24:27]
    v_cvt_pk_bf16_f32 v127, v166, v167
    v_max3_f32 v39, v40, v44, v240
    v_mfma_f32_16x16x32_bf16 a[56:59], a[180:183], v[132:135], a[56:59]
    v_mfma_f32_16x16x32_bf16 a[88:91], a[180:183], v[136:139], a[88:91]
    v_mfma_f32_16x16x32_bf16 a[120:123], a[180:183], v[140:143], a[120:123]
    v_mfma_f32_16x16x32_bf16 v[244:247], v[172:175], v[124:127], v[244:247]
    buffer_load_dwordx4 v24, s[12:15], s49 offen offset:0 lds
    v_mfma_f32_16x16x32_bf16 v[84:87], a[184:187], v[188:191], v[84:87]
    ds_read_b128 a[144:147], v10 offset:16384
    v_mfma_f32_16x16x32_bf16 v[92:95], a[184:187], v[204:207], v[92:95]
    v_mfma_f32_16x16x32_bf16 v[100:103], a[184:187], v[220:223], v[100:103]
    ds_read_b64_tr_b16 a[148:149], v14 offset:16384
    ds_read_b64_tr_b16 a[150:151], v14 offset:20480
    v_mfma_f32_16x16x32_bf16 v[108:111], a[184:187], v[236:239], v[108:111]
    buffer_load_dwordx4 v25, s[12:15], s49 offen offset:1024 lds
    v_mfma_f32_16x16x32_bf16 a[28:31], a[188:191], v[128:131], a[28:31]
    v_max_f32 v39, v39, v244
    v_cmp_lt_f32 vcc, s54, v39
    v_mfma_f32_16x16x32_bf16 a[60:63], a[188:191], v[132:135], a[60:63]
    buffer_load_dwordx4 v24, s[12:15], s49 offen offset:2048 lds
    v_mfma_f32_16x16x32_bf16 a[92:95], a[188:191], v[136:139], a[92:95]
    v_mfma_f32_16x16x32_bf16 a[124:127], a[188:191], v[140:143], a[124:127]
    s_cbranch_vccnz k4_kernel_stub3
k4_kernel_ret3:
    s_waitcnt lgkmcnt(3)
    v_mfma_f32_16x16x32_bf16 v[48:51], a[128:131], v[176:179], v[144:147]
    ds_read_b128 a[152:155], v11 offset:16384
    v_mov_b32 v248, v40
    v_mfma_f32_16x16x32_bf16 v[56:59], a[128:131], v[192:195], v[148:151]
    v_exp_f32 v160, v80
    v_mfma_f32_16x16x32_bf16 v[64:67], a[128:131], v[208:211], v[152:155]
    ds_read_b64_tr_b16 a[156:157], v15 offset:16384
    ds_read_b64_tr_b16 a[158:159], v15 offset:20480
    v_mfma_f32_16x16x32_bf16 v[72:75], a[128:131], v[224:227], v[156:159]
    v_exp_f32 v161, v81
    v_mfma_f32_16x16x32_bf16 a[0:3], a[132:135], v[112:115], a[0:3]
    v_exp_f32 v162, v82
    v_mfma_f32_16x16x32_bf16 a[32:35], a[132:135], v[116:119], a[32:35]
    v_exp_f32 v163, v83
    v_mfma_f32_16x16x32_bf16 a[64:67], a[132:135], v[120:123], a[64:67]
    v_exp_f32 v164, v88
    v_mfma_f32_16x16x32_bf16 a[96:99], a[132:135], v[124:127], a[96:99]
    buffer_load_dwordx4 v25, s[12:15], s49 offen offset:3072 lds
    v_mfma_f32_16x16x32_bf16 v[48:51], a[136:139], v[180:183], v[48:51]
    ds_read_b128 a[160:163], v8 offset:20480
    s_add_u32 s49, s49, 0x4000
    v_mfma_f32_16x16x32_bf16 v[56:59], a[136:139], v[196:199], v[56:59]
    v_exp_f32 v165, v89
    v_mfma_f32_16x16x32_bf16 v[64:67], a[136:139], v[212:215], v[64:67]
    ds_read_b64_tr_b16 a[164:165], v16 offset:16384
    ds_read_b64_tr_b16 a[166:167], v16 offset:20480
    v_mfma_f32_16x16x32_bf16 v[72:75], a[136:139], v[228:231], v[72:75]
    v_exp_f32 v166, v90
    v_mfma_f32_16x16x32_bf16 a[4:7], a[140:143], v[112:115], a[4:7]
    v_exp_f32 v167, v91
    v_mfma_f32_16x16x32_bf16 a[36:39], a[140:143], v[116:119], a[36:39]
    v_exp_f32 v168, v84
    v_mfma_f32_16x16x32_bf16 a[68:71], a[140:143], v[120:123], a[68:71]
    v_exp_f32 v169, v85
    v_mfma_f32_16x16x32_bf16 a[100:103], a[140:143], v[124:127], a[100:103]
    v_mov_b32 v249, v44
    s_waitcnt lgkmcnt(3)
    v_mfma_f32_16x16x32_bf16 v[48:51], a[144:147], v[184:187], v[48:51]
    ds_read_b128 a[168:171], v9 offset:20480
    s_add_u32 m0, s47, 49152
    v_mfma_f32_16x16x32_bf16 v[56:59], a[144:147], v[200:203], v[56:59]
    v_exp_f32 v170, v86
    v_mfma_f32_16x16x32_bf16 v[64:67], a[144:147], v[216:219], v[64:67]
    ds_read_b64_tr_b16 a[172:173], v17 offset:16384
    ds_read_b64_tr_b16 a[174:175], v17 offset:20480
    v_mfma_f32_16x16x32_bf16 v[72:75], a[144:147], v[232:235], v[72:75]
    v_exp_f32 v171, v87
    v_mfma_f32_16x16x32_bf16 a[8:11], a[148:151], v[112:115], a[8:11]
    v_mov_b32 v250, v240
    v_mov_b32 v251, v244
    v_mfma_f32_16x16x32_bf16 a[40:43], a[148:151], v[116:119], a[40:43]
    v_cvt_pk_bf16_f32 v128, v160, v161
    v_cvt_pk_bf16_f32 v129, v162, v163
    v_mfma_f32_16x16x32_bf16 a[72:75], a[148:151], v[120:123], a[72:75]
    v_exp_f32 v160, v96
    v_mfma_f32_16x16x32_bf16 a[104:107], a[148:151], v[124:127], a[104:107]
    buffer_load_dwordx4 v20, s[8:11], s48 offen offset:0 lds
    v_mfma_f32_16x16x32_bf16 v[48:51], a[152:155], v[188:191], v[48:51]
    ds_read_b128 a[176:179], v10 offset:20480
    v_cvt_pk_bf16_f32 v132, v164, v165
    v_mfma_f32_16x16x32_bf16 v[56:59], a[152:155], v[204:207], v[56:59]
    v_exp_f32 v161, v97
    v_mfma_f32_16x16x32_bf16 v[64:67], a[152:155], v[220:223], v[64:67]
    ds_read_b64_tr_b16 a[180:181], v18 offset:16384
    ds_read_b64_tr_b16 a[182:183], v18 offset:20480
    v_mfma_f32_16x16x32_bf16 v[72:75], a[152:155], v[236:239], v[72:75]
    v_exp_f32 v162, v98
    v_mfma_f32_16x16x32_bf16 a[12:15], a[156:159], v[112:115], a[12:15]
    v_exp_f32 v163, v99
    v_mfma_f32_16x16x32_bf16 a[44:47], a[156:159], v[116:119], a[44:47]
    v_exp_f32 v164, v92
    v_mfma_f32_16x16x32_bf16 a[76:79], a[156:159], v[120:123], a[76:79]
    v_cvt_pk_bf16_f32 v133, v166, v167
    v_cvt_pk_bf16_f32 v130, v168, v169
    v_cvt_pk_bf16_f32 v131, v170, v171
    v_mfma_f32_16x16x32_bf16 a[108:111], a[156:159], v[124:127], a[108:111]
    v_exp_f32 v165, v93
    v_mfma_f32_16x16x32_bf16 v[40:43], v[172:175], v[128:131], v[40:43]
    v_cvt_pk_bf16_f32 v136, v160, v161
    s_waitcnt lgkmcnt(3)
    v_mfma_f32_16x16x32_bf16 v[52:55], a[160:163], v[176:179], v[144:147]
    ds_read_b128 a[184:187], v11 offset:20480
    v_cvt_pk_bf16_f32 v137, v162, v163
    v_mfma_f32_16x16x32_bf16 v[60:63], a[160:163], v[192:195], v[148:151]
    v_exp_f32 v166, v94
    v_mfma_f32_16x16x32_bf16 v[68:71], a[160:163], v[208:211], v[152:155]
    ds_read_b64_tr_b16 a[188:189], v19 offset:16384
    ds_read_b64_tr_b16 a[190:191], v19 offset:20480
    v_mfma_f32_16x16x32_bf16 v[76:79], a[160:163], v[224:227], v[156:159]
    v_exp_f32 v167, v95
    v_mfma_f32_16x16x32_bf16 a[16:19], a[164:167], v[112:115], a[16:19]
    v_exp_f32 v168, v104
    v_mfma_f32_16x16x32_bf16 a[48:51], a[164:167], v[116:119], a[48:51]
    v_exp_f32 v169, v105
    v_mfma_f32_16x16x32_bf16 a[80:83], a[164:167], v[120:123], a[80:83]
    v_cvt_pk_bf16_f32 v134, v164, v165
    v_cvt_pk_bf16_f32 v135, v166, v167
    v_mfma_f32_16x16x32_bf16 a[112:115], a[164:167], v[124:127], a[112:115]
    v_exp_f32 v170, v106
    v_mfma_f32_16x16x32_bf16 v[44:47], v[172:175], v[132:135], v[44:47]
    buffer_load_dwordx4 v21, s[8:11], s48 offen offset:1024 lds
    v_mfma_f32_16x16x32_bf16 v[52:55], a[168:171], v[180:183], v[52:55]
    ds_read_b128 a[128:131], v8 offset:24576
    v_cvt_pk_bf16_f32 v140, v168, v169
    v_mfma_f32_16x16x32_bf16 v[60:63], a[168:171], v[196:199], v[60:63]
    v_exp_f32 v171, v107
    v_mfma_f32_16x16x32_bf16 v[68:71], a[168:171], v[212:215], v[68:71]
    ds_read_b64_tr_b16 a[132:133], v12 offset:24576
    ds_read_b64_tr_b16 a[134:135], v12 offset:28672
    v_mfma_f32_16x16x32_bf16 v[76:79], a[168:171], v[228:231], v[76:79]
    v_exp_f32 v160, v100
    v_mfma_f32_16x16x32_bf16 a[20:23], a[172:175], v[112:115], a[20:23]
    v_exp_f32 v161, v101
    v_mfma_f32_16x16x32_bf16 a[52:55], a[172:175], v[116:119], a[52:55]
    v_exp_f32 v162, v102
    v_mfma_f32_16x16x32_bf16 a[84:87], a[172:175], v[120:123], a[84:87]
    v_cvt_pk_bf16_f32 v141, v170, v171
    v_cvt_pk_bf16_f32 v138, v160, v161
    v_exp_f32 v163, v103
    s_nop 0
    v_cvt_pk_bf16_f32 v139, v162, v163
    v_mfma_f32_16x16x32_bf16 a[116:119], a[172:175], v[124:127], a[116:119]
    v_exp_f32 v164, v108
    v_mfma_f32_16x16x32_bf16 v[240:243], v[172:175], v[136:139], v[240:243]
    s_waitcnt lgkmcnt(3)
    v_mfma_f32_16x16x32_bf16 v[52:55], a[176:179], v[184:187], v[52:55]
    ds_read_b128 a[136:139], v9 offset:24576
    v_mfma_f32_16x16x32_bf16 v[60:63], a[176:179], v[200:203], v[60:63]
    v_exp_f32 v165, v109
    v_mfma_f32_16x16x32_bf16 v[68:71], a[176:179], v[216:219], v[68:71]
    ds_read_b64_tr_b16 a[140:141], v13 offset:24576
    ds_read_b64_tr_b16 a[142:143], v13 offset:28672
    v_mfma_f32_16x16x32_bf16 v[76:79], a[176:179], v[232:235], v[76:79]
    v_exp_f32 v166, v110
    v_mfma_f32_16x16x32_bf16 a[24:27], a[180:183], v[112:115], a[24:27]
    v_exp_f32 v167, v111
    v_mfma_f32_16x16x32_bf16 a[56:59], a[180:183], v[116:119], a[56:59]
    v_cvt_pk_bf16_f32 v142, v164, v165
    v_cvt_pk_bf16_f32 v143, v166, v167
    v_mfma_f32_16x16x32_bf16 a[88:91], a[180:183], v[120:123], a[88:91]
    v_max3_f32 v39, v40, v44, v240
    v_mfma_f32_16x16x32_bf16 a[120:123], a[180:183], v[124:127], a[120:123]
    v_mfma_f32_16x16x32_bf16 v[244:247], v[172:175], v[140:143], v[244:247]
    buffer_load_dwordx4 v22, s[8:11], s48 offen offset:2048 lds
    v_mfma_f32_16x16x32_bf16 v[52:55], a[184:187], v[188:191], v[52:55]
    ds_read_b128 a[144:147], v10 offset:24576
    v_mfma_f32_16x16x32_bf16 v[60:63], a[184:187], v[204:207], v[60:63]
    v_mfma_f32_16x16x32_bf16 v[68:71], a[184:187], v[220:223], v[68:71]
    ds_read_b64_tr_b16 a[148:149], v14 offset:24576
    ds_read_b64_tr_b16 a[150:151], v14 offset:28672
    v_mfma_f32_16x16x32_bf16 v[76:79], a[184:187], v[236:239], v[76:79]
    buffer_load_dwordx4 v23, s[8:11], s48 offen offset:3072 lds
    v_mfma_f32_16x16x32_bf16 a[28:31], a[188:191], v[112:115], a[28:31]
    v_max_f32 v39, v39, v244
    v_cmp_lt_f32 vcc, s54, v39
    v_mfma_f32_16x16x32_bf16 a[60:63], a[188:191], v[116:119], a[60:63]
    v_mfma_f32_16x16x32_bf16 a[92:95], a[188:191], v[120:123], a[92:95]
    v_mfma_f32_16x16x32_bf16 a[124:127], a[188:191], v[124:127], a[124:127]
    s_cbranch_vccnz k4_kernel_stub4
k4_kernel_ret4:
    s_waitcnt lgkmcnt(3)
    v_mfma_f32_16x16x32_bf16 v[80:83], a[128:131], v[176:179], v[144:147]
    ds_read_b128 a[152:155], v11 offset:24576
    s_add_u32 s48, s48, 0x4000
    v_mfma_f32_16x16x32_bf16 v[88:91], a[128:131], v[192:195], v[148:151]
    v_exp_f32 v160, v48
    v_mfma_f32_16x16x32_bf16 v[96:99], a[128:131], v[208:211], v[152:155]
    ds_read_b64_tr_b16 a[156:157], v15 offset:24576
    ds_read_b64_tr_b16 a[158:159], v15 offset:28672
    v_mfma_f32_16x16x32_bf16 v[104:107], a[128:131], v[224:227], v[156:159]
    v_exp_f32 v161, v49
    v_mfma_f32_16x16x32_bf16 a[0:3], a[132:135], v[128:131], a[0:3]
    v_exp_f32 v162, v50
    v_mfma_f32_16x16x32_bf16 a[32:35], a[132:135], v[132:135], a[32:35]
    v_exp_f32 v163, v51
    v_mfma_f32_16x16x32_bf16 a[64:67], a[132:135], v[136:139], a[64:67]
    v_exp_f32 v164, v56
    v_mfma_f32_16x16x32_bf16 a[96:99], a[132:135], v[140:143], a[96:99]
    v_exp_f32 v165, v57
    v_mfma_f32_16x16x32_bf16 v[80:83], a[136:139], v[180:183], v[80:83]
    ds_read_b128 a[160:163], v8 offset:28672
    v_mov_b32 v248, v40
    v_mfma_f32_16x16x32_bf16 v[88:91], a[136:139], v[196:199], v[88:91]
    v_exp_f32 v166, v58
    v_mfma_f32_16x16x32_bf16 v[96:99], a[136:139], v[212:215], v[96:99]
    ds_read_b64_tr_b16 a[164:165], v16 offset:24576
    ds_read_b64_tr_b16 a[166:167], v16 offset:28672
    v_mfma_f32_16x16x32_bf16 v[104:107], a[136:139], v[228:231], v[104:107]
    v_exp_f32 v167, v59
    v_mfma_f32_16x16x32_bf16 a[4:7], a[140:143], v[128:131], a[4:7]
    v_exp_f32 v168, v52
    v_mfma_f32_16x16x32_bf16 a[36:39], a[140:143], v[132:135], a[36:39]
    v_exp_f32 v169, v53
    v_mfma_f32_16x16x32_bf16 a[68:71], a[140:143], v[136:139], a[68:71]
    v_exp_f32 v170, v54
    v_mfma_f32_16x16x32_bf16 a[100:103], a[140:143], v[140:143], a[100:103]
    v_mov_b32 v249, v44
    s_waitcnt lgkmcnt(3)
    v_mfma_f32_16x16x32_bf16 v[80:83], a[144:147], v[184:187], v[80:83]
    ds_read_b128 a[168:171], v9 offset:28672
    v_mov_b32 v250, v240
    v_mfma_f32_16x16x32_bf16 v[88:91], a[144:147], v[200:203], v[88:91]
    v_exp_f32 v171, v55
    v_mfma_f32_16x16x32_bf16 v[96:99], a[144:147], v[216:219], v[96:99]
    ds_read_b64_tr_b16 a[172:173], v17 offset:24576
    ds_read_b64_tr_b16 a[174:175], v17 offset:28672
    v_mfma_f32_16x16x32_bf16 v[104:107], a[144:147], v[232:235], v[104:107]
    v_mov_b32 v251, v244
    v_cvt_pk_bf16_f32 v112, v160, v161
    v_mfma_f32_16x16x32_bf16 a[8:11], a[148:151], v[128:131], a[8:11]
    v_exp_f32 v160, v64
    v_mfma_f32_16x16x32_bf16 a[40:43], a[148:151], v[132:135], a[40:43]
    v_exp_f32 v161, v65
    v_mfma_f32_16x16x32_bf16 a[72:75], a[148:151], v[136:139], a[72:75]
    v_cvt_pk_bf16_f32 v113, v162, v163
    v_cvt_pk_bf16_f32 v116, v164, v165
    v_mfma_f32_16x16x32_bf16 a[104:107], a[148:151], v[140:143], a[104:107]
    v_exp_f32 v162, v66
    v_mfma_f32_16x16x32_bf16 v[80:83], a[152:155], v[188:191], v[80:83]
    ds_read_b128 a[176:179], v10 offset:28672
    v_cvt_pk_bf16_f32 v117, v166, v167
    v_mfma_f32_16x16x32_bf16 v[88:91], a[152:155], v[204:207], v[88:91]
    v_exp_f32 v163, v67
    v_mfma_f32_16x16x32_bf16 v[96:99], a[152:155], v[220:223], v[96:99]
    ds_read_b64_tr_b16 a[180:181], v18 offset:24576
    ds_read_b64_tr_b16 a[182:183], v18 offset:28672
    v_mfma_f32_16x16x32_bf16 v[104:107], a[152:155], v[236:239], v[104:107]
    v_exp_f32 v164, v60
    v_mfma_f32_16x16x32_bf16 a[12:15], a[156:159], v[128:131], a[12:15]
    v_exp_f32 v165, v61
    v_mfma_f32_16x16x32_bf16 a[44:47], a[156:159], v[132:135], a[44:47]
    v_exp_f32 v166, v62
    v_mfma_f32_16x16x32_bf16 a[76:79], a[156:159], v[136:139], a[76:79]
    v_cvt_pk_bf16_f32 v114, v168, v169
    v_cvt_pk_bf16_f32 v115, v170, v171
    v_mfma_f32_16x16x32_bf16 a[108:111], a[156:159], v[140:143], a[108:111]
    v_exp_f32 v167, v63
    v_mfma_f32_16x16x32_bf16 v[40:43], v[172:175], v[112:115], v[40:43]
    v_cvt_pk_bf16_f32 v120, v160, v161
    s_waitcnt lgkmcnt(3)
    v_mfma_f32_16x16x32_bf16 v[84:87], a[160:163], v[176:179], v[144:147]
    ds_read_b128 a[184:187], v11 offset:28672
    v_cvt_pk_bf16_f32 v121, v162, v163
    v_mfma_f32_16x16x32_bf16 v[92:95], a[160:163], v[192:195], v[148:151]
    v_exp_f32 v168, v72
    v_mfma_f32_16x16x32_bf16 v[100:103], a[160:163], v[208:211], v[152:155]
    ds_read_b64_tr_b16 a[188:189], v19 offset:24576
    ds_read_b64_tr_b16 a[190:191], v19 offset:28672
    v_mfma_f32_16x16x32_bf16 v[108:111], a[160:163], v[224:227], v[156:159]
    v_exp_f32 v169, v73
    v_mfma_f32_16x16x32_bf16 a[16:19], a[164:167], v[128:131], a[16:19]
    v_exp_f32 v170, v74
    v_mfma_f32_16x16x32_bf16 a[48:51], a[164:167], v[132:135], a[48:51]
    v_exp_f32 v171, v75
    v_mfma_f32_16x16x32_bf16 a[80:83], a[164:167], v[136:139], a[80:83]
    v_cvt_pk_bf16_f32 v118, v164, v165
    v_cvt_pk_bf16_f32 v119, v166, v167
    v_mfma_f32_16x16x32_bf16 a[112:115], a[164:167], v[140:143], a[112:115]
    v_exp_f32 v160, v68
    v_mfma_f32_16x16x32_bf16 v[44:47], v[172:175], v[116:119], v[44:47]
    s_waitcnt vmcnt(8)
    s_barrier
    v_mfma_f32_16x16x32_bf16 v[84:87], a[168:171], v[180:183], v[84:87]
    ds_read_b128 a[128:131], v8 offset:32768
    v_cvt_pk_bf16_f32 v124, v168, v169
    v_mfma_f32_16x16x32_bf16 v[92:95], a[168:171], v[196:199], v[92:95]
    v_exp_f32 v161, v69
    v_mfma_f32_16x16x32_bf16 v[100:103], a[168:171], v[212:215], v[100:103]
    ds_read_b64_tr_b16 a[132:133], v12 offset:32768
    ds_read_b64_tr_b16 a[134:135], v12 offset:36864
    v_mfma_f32_16x16x32_bf16 v[108:111], a[168:171], v[228:231], v[108:111]
    v_exp_f32 v162, v70
    v_mfma_f32_16x16x32_bf16 a[20:23], a[172:175], v[128:131], a[20:23]
    v_exp_f32 v163, v71
    v_mfma_f32_16x16x32_bf16 a[52:55], a[172:175], v[132:135], a[52:55]
    v_exp_f32 v164, v76
    v_mfma_f32_16x16x32_bf16 a[84:87], a[172:175], v[136:139], a[84:87]
    v_cvt_pk_bf16_f32 v125, v170, v171
    v_cvt_pk_bf16_f32 v122, v160, v161
    v_cvt_pk_bf16_f32 v123, v162, v163
    v_mfma_f32_16x16x32_bf16 a[116:119], a[172:175], v[140:143], a[116:119]
    v_exp_f32 v165, v77
    v_mfma_f32_16x16x32_bf16 v[240:243], v[172:175], v[120:123], v[240:243]
    v_cvt_pk_bf16_f32 v126, v164, v165
    s_waitcnt lgkmcnt(3)
    v_mfma_f32_16x16x32_bf16 v[84:87], a[176:179], v[184:187], v[84:87]
    ds_read_b128 a[136:139], v9 offset:32768
    s_add_u32 m0, s47, 65536
    v_mfma_f32_16x16x32_bf16 v[92:95], a[176:179], v[200:203], v[92:95]
    v_exp_f32 v166, v78
    v_mfma_f32_16x16x32_bf16 v[100:103], a[176:179], v[216:219], v[100:103]
    ds_read_b64_tr_b16 a[140:141], v13 offset:32768
    ds_read_b64_tr_b16 a[142:143], v13 offset:36864
    v_mfma_f32_16x16x32_bf16 v[108:111], a[176:179], v[232:235], v[108:111]
    v_exp_f32 v167, v79
    v_mfma_f32_16x16x32_bf16 a[24:27], a[180:183], v[128:131], a[24:27]
    v_cvt_pk_bf16_f32 v127, v166, v167
    v_max3_f32 v39, v40, v44, v240
    v_mfma_f32_16x16x32_bf16 a[56:59], a[180:183], v[132:135], a[56:59]
    v_mfma_f32_16x16x32_bf16 a[88:91], a[180:183], v[136:139], a[88:91]
    v_mfma_f32_16x16x32_bf16 a[120:123], a[180:183], v[140:143], a[120:123]
    v_mfma_f32_16x16x32_bf16 v[244:247], v[172:175], v[124:127], v[244:247]
    buffer_load_dwordx4 v24, s[12:15], s49 offen offset:0 lds
    v_mfma_f32_16x16x32_bf16 v[84:87], a[184:187], v[188:191], v[84:87]
    ds_read_b128 a[144:147], v10 offset:32768
    v_mfma_f32_16x16x32_bf16 v[92:95], a[184:187], v[204:207], v[92:95]
    v_mfma_f32_16x16x32_bf16 v[100:103], a[184:187], v[220:223], v[100:103]
    ds_read_b64_tr_b16 a[148:149], v14 offset:32768
    ds_read_b64_tr_b16 a[150:151], v14 offset:36864
    v_mfma_f32_16x16x32_bf16 v[108:111], a[184:187], v[236:239], v[108:111]
    buffer_load_dwordx4 v25, s[12:15], s49 offen offset:1024 lds
    v_mfma_f32_16x16x32_bf16 a[28:31], a[188:191], v[128:131], a[28:31]
    v_max_f32 v39, v39, v244
    v_cmp_lt_f32 vcc, s54, v39
    v_mfma_f32_16x16x32_bf16 a[60:63], a[188:191], v[132:135], a[60:63]
    buffer_load_dwordx4 v24, s[12:15], s49 offen offset:2048 lds
    v_mfma_f32_16x16x32_bf16 a[92:95], a[188:191], v[136:139], a[92:95]
    v_mfma_f32_16x16x32_bf16 a[124:127], a[188:191], v[140:143], a[124:127]
    s_cbranch_vccnz k4_kernel_stub5
k4_kernel_ret5:
    s_waitcnt lgkmcnt(3)
    v_mfma_f32_16x16x32_bf16 v[48:51], a[128:131], v[176:179], v[144:147]
    ds_read_b128 a[152:155], v11 offset:32768
    v_mov_b32 v248, v40
    v_mfma_f32_16x16x32_bf16 v[56:59], a[128:131], v[192:195], v[148:151]
    v_exp_f32 v160, v80
    v_mfma_f32_16x16x32_bf16 v[64:67], a[128:131], v[208:211], v[152:155]
    ds_read_b64_tr_b16 a[156:157], v15 offset:32768
    ds_read_b64_tr_b16 a[158:159], v15 offset:36864
    v_mfma_f32_16x16x32_bf16 v[72:75], a[128:131], v[224:227], v[156:159]
    v_exp_f32 v161, v81
    v_mfma_f32_16x16x32_bf16 a[0:3], a[132:135], v[112:115], a[0:3]
    v_exp_f32 v162, v82
    v_mfma_f32_16x16x32_bf16 a[32:35], a[132:135], v[116:119], a[32:35]
    v_exp_f32 v163, v83
    v_mfma_f32_16x16x32_bf16 a[64:67], a[132:135], v[120:123], a[64:67]
    v_exp_f32 v164, v88
    v_mfma_f32_16x16x32_bf16 a[96:99], a[132:135], v[124:127], a[96:99]
    buffer_load_dwordx4 v25, s[12:15], s49 offen offset:3072 lds
    v_mfma_f32_16x16x32_bf16 v[48:51], a[136:139], v[180:183], v[48:51]
    ds_read_b128 a[160:163], v8 offset:36864
    s_add_u32 s49, s49, 0x4000
    v_mfma_f32_16x16x32_bf16 v[56:59], a[136:139], v[196:199], v[56:59]
    v_exp_f32 v165, v89
    v_mfma_f32_16x16x32_bf16 v[64:67], a[136:139], v[212:215], v[64:67]
    ds_read_b64_tr_b16 a[164:165], v16 offset:32768
    ds_read_b64_tr_b16 a[166:167], v16 offset:36864
    v_mfma_f32_16x16x32_bf16 v[72:75], a[136:139], v[228:231], v[72:75]
    v_exp_f32 v166, v90
    v_mfma_f32_16x16x32_bf16 a[4:7], a[140:143], v[112:115], a[4:7]
    v_exp_f32 v167, v91
    v_mfma_f32_16x16x32_bf16 a[36:39], a[140:143], v[116:119], a[36:39]
    v_exp_f32 v168, v84
    v_mfma_f32_16x16x32_bf16 a[68:71], a[140:143], v[120:123], a[68:71]
    v_exp_f32 v169, v85
    v_mfma_f32_16x16x32_bf16 a[100:103], a[140:143], v[124:127], a[100:103]
    v_mov_b32 v249, v44
    s_waitcnt lgkmcnt(3)
    v_mfma_f32_16x16x32_bf16 v[48:51], a[144:147], v[184:187], v[48:51]
    ds_read_b128 a[168:171], v9 offset:36864
    s_add_u32 m0, s47, 0
    v_mfma_f32_16x16x32_bf16 v[56:59], a[144:147], v[200:203], v[56:59]
    v_exp_f32 v170, v86
    v_mfma_f32_16x16x32_bf16 v[64:67], a[144:147], v[216:219], v[64:67]
    ds_read_b64_tr_b16 a[172:173], v17 offset:32768
    ds_read_b64_tr_b16 a[174:175], v17 offset:36864
    v_mfma_f32_16x16x32_bf16 v[72:75], a[144:147], v[232:235], v[72:75]
    v_exp_f32 v171, v87
    v_mfma_f32_16x16x32_bf16 a[8:11], a[148:151], v[112:115], a[8:11]
    v_mov_b32 v250, v240
    v_mov_b32 v251, v244
    v_mfma_f32_16x16x32_bf16 a[40:43], a[148:151], v[116:119], a[40:43]
    v_cvt_pk_bf16_f32 v128, v160, v161
    v_cvt_pk_bf16_f32 v129, v162, v163
    v_mfma_f32_16x16x32_bf16 a[72:75], a[148:151], v[120:123], a[72:75]
    v_exp_f32 v160, v96
    v_mfma_f32_16x16x32_bf16 a[104:107], a[148:151], v[124:127], a[104:107]
    buffer_load_dwordx4 v20, s[8:11], s48 offen offset:0 lds
    v_mfma_f32_16x16x32_bf16 v[48:51], a[152:155], v[188:191], v[48:51]
    ds_read_b128 a[176:179], v10 offset:36864
    v_cvt_pk_bf16_f32 v132, v164, v165
    v_mfma_f32_16x16x32_bf16 v[56:59], a[152:155], v[204:207], v[56:59]
    v_exp_f32 v161, v97
    v_mfma_f32_16x16x32_bf16 v[64:67], a[152:155], v[220:223], v[64:67]
    ds_read_b64_tr_b16 a[180:181], v18 offset:32768
    ds_read_b64_tr_b16 a[182:183], v18 offset:36864
    v_mfma_f32_16x16x32_bf16 v[72:75], a[152:155], v[236:239], v[72:75]
    v_exp_f32 v162, v98
    v_mfma_f32_16x16x32_bf16 a[12:15], a[156:159], v[112:115], a[12:15]
    v_exp_f32 v163, v99
    v_mfma_f32_16x16x32_bf16 a[44:47], a[156:159], v[116:119], a[44:47]
    v_exp_f32 v164, v92
    v_mfma_f32_16x16x32_bf16 a[76:79], a[156:159], v[120:123], a[76:79]
    v_cvt_pk_bf16_f32 v133, v166, v167
    v_cvt_pk_bf16_f32 v130, v168, v169
    v_cvt_pk_bf16_f32 v131, v170, v171
    v_mfma_f32_16x16x32_bf16 a[108:111], a[156:159], v[124:127], a[108:111]
    v_exp_f32 v165, v93
    v_mfma_f32_16x16x32_bf16 v[40:43], v[172:175], v[128:131], v[40:43]
    v_cvt_pk_bf16_f32 v136, v160, v161
    s_waitcnt lgkmcnt(3)
    v_mfma_f32_16x16x32_bf16 v[52:55], a[160:163], v[176:179], v[144:147]
    ds_read_b128 a[184:187], v11 offset:36864
    v_cvt_pk_bf16_f32 v137, v162, v163
    v_mfma_f32_16x16x32_bf16 v[60:63], a[160:163], v[192:195], v[148:151]
    v_exp_f32 v166, v94
    v_mfma_f32_16x16x32_bf16 v[68:71], a[160:163], v[208:211], v[152:155]
    ds_read_b64_tr_b16 a[188:189], v19 offset:32768
    ds_read_b64_tr_b16 a[190:191], v19 offset:36864
    v_mfma_f32_16x16x32_bf16 v[76:79], a[160:163], v[224:227], v[156:159]
    v_exp_f32 v167, v95
    v_mfma_f32_16x16x32_bf16 a[16:19], a[164:167], v[112:115], a[16:19]
    v_exp_f32 v168, v104
    v_mfma_f32_16x16x32_bf16 a[48:51], a[164:167], v[116:119], a[48:51]
    v_exp_f32 v169, v105
    v_mfma_f32_16x16x32_bf16 a[80:83], a[164:167], v[120:123], a[80:83]
    v_cvt_pk_bf16_f32 v134, v164, v165
    v_cvt_pk_bf16_f32 v135, v166, v167
    v_mfma_f32_16x16x32_bf16 a[112:115], a[164:167], v[124:127], a[112:115]
    v_exp_f32 v170, v106
    v_mfma_f32_16x16x32_bf16 v[44:47], v[172:175], v[132:135], v[44:47]
    buffer_load_dwordx4 v21, s[8:11], s48 offen offset:1024 lds
    v_mfma_f32_16x16x32_bf16 v[52:55], a[168:171], v[180:183], v[52:55]
    ds_read_b128 a[128:131], v8 offset:40960
    v_cvt_pk_bf16_f32 v140, v168, v169
    v_mfma_f32_16x16x32_bf16 v[60:63], a[168:171], v[196:199], v[60:63]
    v_exp_f32 v171, v107
    v_mfma_f32_16x16x32_bf16 v[68:71], a[168:171], v[212:215], v[68:71]
    ds_read_b64_tr_b16 a[132:133], v12 offset:40960
    ds_read_b64_tr_b16 a[134:135], v12 offset:45056
    v_mfma_f32_16x16x32_bf16 v[76:79], a[168:171], v[228:231], v[76:79]
    v_exp_f32 v160, v100
    v_mfma_f32_16x16x32_bf16 a[20:23], a[172:175], v[112:115], a[20:23]
    v_exp_f32 v161, v101
    v_mfma_f32_16x16x32_bf16 a[52:55], a[172:175], v[116:119], a[52:55]
    v_exp_f32 v162, v102
    v_mfma_f32_16x16x32_bf16 a[84:87], a[172:175], v[120:123], a[84:87]
    v_cvt_pk_bf16_f32 v141, v170, v171
    v_cvt_pk_bf16_f32 v138, v160, v161
    v_exp_f32 v163, v103
    s_nop 0
    v_cvt_pk_bf16_f32 v139, v162, v163
    v_mfma_f32_16x16x32_bf16 a[116:119], a[172:175], v[124:127], a[116:119]
    v_exp_f32 v164, v108
    v_mfma_f32_16x16x32_bf16 v[240:243], v[172:175], v[136:139], v[240:243]
    s_waitcnt lgkmcnt(3)
    v_mfma_f32_16x16x32_bf16 v[52:55], a[176:179], v[184:187], v[52:55]
    ds_read_b128 a[136:139], v9 offset:40960
    v_mfma_f32_16x16x32_bf16 v[60:63], a[176:179], v[200:203], v[60:63]
    v_exp_f32 v165, v109
    v_mfma_f32_16x16x32_bf16 v[68:71], a[176:179], v[216:219], v[68:71]
    ds_read_b64_tr_b16 a[140:141], v13 offset:40960
    ds_read_b64_tr_b16 a[142:143], v13 offset:45056
    v_mfma_f32_16x16x32_bf16 v[76:79], a[176:179], v[232:235], v[76:79]
    v_exp_f32 v166, v110
    v_mfma_f32_16x16x32_bf16 a[24:27], a[180:183], v[112:115], a[24:27]
    v_exp_f32 v167, v111
    v_mfma_f32_16x16x32_bf16 a[56:59], a[180:183], v[116:119], a[56:59]
    v_cvt_pk_bf16_f32 v142, v164, v165
    v_cvt_pk_bf16_f32 v143, v166, v167
    v_mfma_f32_16x16x32_bf16 a[88:91], a[180:183], v[120:123], a[88:91]
    v_max3_f32 v39, v40, v44, v240
    v_mfma_f32_16x16x32_bf16 a[120:123], a[180:183], v[124:127], a[120:123]
    v_mfma_f32_16x16x32_bf16 v[244:247], v[172:175], v[140:143], v[244:247]
    buffer_load_dwordx4 v22, s[8:11], s48 offen offset:2048 lds
    v_mfma_f32_16x16x32_bf16 v[52:55], a[184:187], v[188:191], v[52:55]
    ds_read_b128 a[144:147], v10 offset:40960
    v_mfma_f32_16x16x32_bf16 v[60:63], a[184:187], v[204:207], v[60:63]
    v_mfma_f32_16x16x32_bf16 v[68:71], a[184:187], v[220:223], v[68:71]
    ds_read_b64_tr_b16 a[148:149], v14 offset:40960
    ds_read_b64_tr_b16 a[150:151], v14 offset:45056
    v_mfma_f32_16x16x32_bf16 v[76:79], a[184:187], v[236:239], v[76:79]
    buffer_load_dwordx4 v23, s[8:11], s48 offen offset:3072 lds
    v_mfma_f32_16x16x32_bf16 a[28:31], a[188:191], v[112:115], a[28:31]
    v_max_f32 v39, v39, v244
    v_cmp_lt_f32 vcc, s54, v39
    v_mfma_f32_16x16x32_bf16 a[60:63], a[188:191], v[116:119], a[60:63]
    v_mfma_f32_16x16x32_bf16 a[92:95], a[188:191], v[120:123], a[92:95]
    v_mfma_f32_16x16x32_bf16 a[124:127], a[188:191], v[124:127], a[124:127]
    s_cbranch_vccnz k4_kernel_stub6
k4_kernel_ret6:
    s_waitcnt lgkmcnt(3)
    v_mfma_f32_16x16x32_bf16 v[80:83], a[128:131], v[176:179], v[144:147]
    ds_read_b128 a[152:155], v11 offset:40960
    s_add_u32 s48, s48, 0x4000
    v_mfma_f32_16x16x32_bf16 v[88:91], a[128:131], v[192:195], v[148:151]
    v_exp_f32 v160, v48
    v_mfma_f32_16x16x32_bf16 v[96:99], a[128:131], v[208:211], v[152:155]
    ds_read_b64_tr_b16 a[156:157], v15 offset:40960
    ds_read_b64_tr_b16 a[158:159], v15 offset:45056
    v_mfma_f32_16x16x32_bf16 v[104:107], a[128:131], v[224:227], v[156:159]
    v_exp_f32 v161, v49
    v_mfma_f32_16x16x32_bf16 a[0:3], a[132:135], v[128:131], a[0:3]
    v_exp_f32 v162, v50
    v_mfma_f32_16x16x32_bf16 a[32:35], a[132:135], v[132:135], a[32:35]
    v_exp_f32 v163, v51
    v_mfma_f32_16x16x32_bf16 a[64:67], a[132:135], v[136:139], a[64:67]
    v_exp_f32 v164, v56
    v_mfma_f32_16x16x32_bf16 a[96:99], a[132:135], v[140:143], a[96:99]
    v_exp_f32 v165, v57
    v_mfma_f32_16x16x32_bf16 v[80:83], a[136:139], v[180:183], v[80:83]
    ds_read_b128 a[160:163], v8 offset:45056
    v_mov_b32 v248, v40
    v_mfma_f32_16x16x32_bf16 v[88:91], a[136:139], v[196:199], v[88:91]
    v_exp_f32 v166, v58
    v_mfma_f32_16x16x32_bf16 v[96:99], a[136:139], v[212:215], v[96:99]
    ds_read_b64_tr_b16 a[164:165], v16 offset:40960
    ds_read_b64_tr_b16 a[166:167], v16 offset:45056
    v_mfma_f32_16x16x32_bf16 v[104:107], a[136:139], v[228:231], v[104:107]
    v_exp_f32 v167, v59
    v_mfma_f32_16x16x32_bf16 a[4:7], a[140:143], v[128:131], a[4:7]
    v_exp_f32 v168, v52
    v_mfma_f32_16x16x32_bf16 a[36:39], a[140:143], v[132:135], a[36:39]
    v_exp_f32 v169, v53
    v_mfma_f32_16x16x32_bf16 a[68:71], a[140:143], v[136:139], a[68:71]
    v_exp_f32 v170, v54
    v_mfma_f32_16x16x32_bf16 a[100:103], a[140:143], v[140:143], a[100:103]
    v_mov_b32 v249, v44
    s_waitcnt lgkmcnt(3)
    v_mfma_f32_16x16x32_bf16 v[80:83], a[144:147], v[184:187], v[80:83]
    ds_read_b128 a[168:171], v9 offset:45056
    v_mov_b32 v250, v240
    v_mfma_f32_16x16x32_bf16 v[88:91], a[144:147], v[200:203], v[88:91]
    v_exp_f32 v171, v55
    v_mfma_f32_16x16x32_bf16 v[96:99], a[144:147], v[216:219], v[96:99]
    ds_read_b64_tr_b16 a[172:173], v17 offset:40960
    ds_read_b64_tr_b16 a[174:175], v17 offset:45056
    v_mfma_f32_16x16x32_bf16 v[104:107], a[144:147], v[232:235], v[104:107]
    v_mov_b32 v251, v244
    v_cvt_pk_bf16_f32 v112, v160, v161
    v_mfma_f32_16x16x32_bf16 a[8:11], a[148:151], v[128:131], a[8:11]
    v_exp_f32 v160, v64
    v_mfma_f32_16x16x32_bf16 a[40:43], a[148:151], v[132:135], a[40:43]
    v_exp_f32 v161, v65
    v_mfma_f32_16x16x32_bf16 a[72:75], a[148:151], v[136:139], a[72:75]
    v_cvt_pk_bf16_f32 v113, v162, v163
    v_cvt_pk_bf16_f32 v116, v164, v165
    v_mfma_f32_16x16x32_bf16 a[104:107], a[148:151], v[140:143], a[104:107]
    v_exp_f32 v162, v66
    v_mfma_f32_16x16x32_bf16 v[80:83], a[152:155], v[188:191], v[80:83]
    ds_read_b128 a[176:179], v10 offset:45056
    v_cvt_pk_bf16_f32 v117, v166, v167
    v_mfma_f32_16x16x32_bf16 v[88:91], a[152:155], v[204:207], v[88:91]
    v_exp_f32 v163, v67
    v_mfma_f32_16x16x32_bf16 v[96:99], a[152:155], v[220:223], v[96:99]
    ds_read_b64_tr_b16 a[180:181], v18 offset:40960
    ds_read_b64_tr_b16 a[182:183], v18 offset:45056
    v_mfma_f32_16x16x32_bf16 v[104:107], a[152:155], v[236:239], v[104:107]
    v_exp_f32 v164, v60
    v_mfma_f32_16x16x32_bf16 a[12:15], a[156:159], v[128:131], a[12:15]
    v_exp_f32 v165, v61
    v_mfma_f32_16x16x32_bf16 a[44:47], a[156:159], v[132:135], a[44:47]
    v_exp_f32 v166, v62
    v_mfma_f32_16x16x32_bf16 a[76:79], a[156:159], v[136:139], a[76:79]
    v_cvt_pk_bf16_f32 v114, v168, v169
    v_cvt_pk_bf16_f32 v115, v170, v171
    v_mfma_f32_16x16x32_bf16 a[108:111], a[156:159], v[140:143], a[108:111]
    v_exp_f32 v167, v63
    v_mfma_f32_16x16x32_bf16 v[40:43], v[172:175], v[112:115], v[40:43]
    v_cvt_pk_bf16_f32 v120, v160, v161
    s_waitcnt lgkmcnt(3)
    v_mfma_f32_16x16x32_bf16 v[84:87], a[160:163], v[176:179], v[144:147]
    ds_read_b128 a[184:187], v11 offset:45056
    v_cvt_pk_bf16_f32 v121, v162, v163
    v_mfma_f32_16x16x32_bf16 v[92:95], a[160:163], v[192:195], v[148:151]
    v_exp_f32 v168, v72
    v_mfma_f32_16x16x32_bf16 v[100:103], a[160:163], v[208:211], v[152:155]
    ds_read_b64_tr_b16 a[188:189], v19 offset:40960
    ds_read_b64_tr_b16 a[190:191], v19 offset:45056
    v_mfma_f32_16x16x32_bf16 v[108:111], a[160:163], v[224:227], v[156:159]
    v_exp_f32 v169, v73
    v_mfma_f32_16x16x32_bf16 a[16:19], a[164:167], v[128:131], a[16:19]
    v_exp_f32 v170, v74
    v_mfma_f32_16x16x32_bf16 a[48:51], a[164:167], v[132:135], a[48:51]
    v_exp_f32 v171, v75
    v_mfma_f32_16x16x32_bf16 a[80:83], a[164:167], v[136:139], a[80:83]
    v_cvt_pk_bf16_f32 v118, v164, v165
    v_cvt_pk_bf16_f32 v119, v166, v167
    v_mfma_f32_16x16x32_bf16 a[112:115], a[164:167], v[140:143], a[112:115]
    v_exp_f32 v160, v68
    v_mfma_f32_16x16x32_bf16 v[44:47], v[172:175], v[116:119], v[44:47]
    s_waitcnt vmcnt(8)
    s_barrier
    v_mfma_f32_16x16x32_bf16 v[84:87], a[168:171], v[180:183], v[84:87]
    ds_read_b128 a[128:131], v8 offset:49152
    v_cvt_pk_bf16_f32 v124, v168, v169
    v_mfma_f32_16x16x32_bf16 v[92:95], a[168:171], v[196:199], v[92:95]
    v_exp_f32 v161, v69
    v_mfma_f32_16x16x32_bf16 v[100:103], a[168:171], v[212:215], v[100:103]
    ds_read_b64_tr_b16 a[132:133], v12 offset:49152
    ds_read_b64_tr_b16 a[134:135], v12 offset:53248
    v_mfma_f32_16x16x32_bf16 v[108:111], a[168:171], v[228:231], v[108:111]
    v_exp_f32 v162, v70
    v_mfma_f32_16x16x32_bf16 a[20:23], a[172:175], v[128:131], a[20:23]
    v_exp_f32 v163, v71
    v_mfma_f32_16x16x32_bf16 a[52:55], a[172:175], v[132:135], a[52:55]
    v_exp_f32 v164, v76
    v_mfma_f32_16x16x32_bf16 a[84:87], a[172:175], v[136:139], a[84:87]
    v_cvt_pk_bf16_f32 v125, v170, v171
    v_cvt_pk_bf16_f32 v122, v160, v161
    v_cvt_pk_bf16_f32 v123, v162, v163
    v_mfma_f32_16x16x32_bf16 a[116:119], a[172:175], v[140:143], a[116:119]
    v_exp_f32 v165, v77
    v_mfma_f32_16x16x32_bf16 v[240:243], v[172:175], v[120:123], v[240:243]
    v_cvt_pk_bf16_f32 v126, v164, v165
    s_waitcnt lgkmcnt(3)
    v_mfma_f32_16x16x32_bf16 v[84:87], a[176:179], v[184:187], v[84:87]
    ds_read_b128 a[136:139], v9 offset:49152
    s_add_u32 m0, s47, 81920
    v_mfma_f32_16x16x32_bf16 v[92:95], a[176:179], v[200:203], v[92:95]
    v_exp_f32 v166, v78
    v_mfma_f32_16x16x32_bf16 v[100:103], a[176:179], v[216:219], v[100:103]
    ds_read_b64_tr_b16 a[140:141], v13 offset:49152
    ds_read_b64_tr_b16 a[142:143], v13 offset:53248
    v_mfma_f32_16x16x32_bf16 v[108:111], a[176:179], v[232:235], v[108:111]
    v_exp_f32 v167, v79
    v_mfma_f32_16x16x32_bf16 a[24:27], a[180:183], v[128:131], a[24:27]
    v_cvt_pk_bf16_f32 v127, v166, v167
    v_max3_f32 v39, v40, v44, v240
    v_mfma_f32_16x16x32_bf16 a[56:59], a[180:183], v[132:135], a[56:59]
    v_mfma_f32_16x16x32_bf16 a[88:91], a[180:183], v[136:139], a[88:91]
    v_mfma_f32_16x16x32_bf16 a[120:123], a[180:183], v[140:143], a[120:123]
    v_mfma_f32_16x16x32_bf16 v[244:247], v[172:175], v[124:127], v[244:247]
    buffer_load_dwordx4 v24, s[12:15], s49 offen offset:0 lds
    v_mfma_f32_16x16x32_bf16 v[84:87], a[184:187], v[188:191], v[84:87]
    ds_read_b128 a[144:147], v10 offset:49152
    v_mfma_f32_16x16x32_bf16 v[92:95], a[184:187], v[204:207], v[92:95]
    v_mfma_f32_16x16x32_bf16 v[100:103], a[184:187], v[220:223], v[100:103]
    ds_read_b64_tr_b16 a[148:149], v14 offset:49152
    ds_read_b64_tr_b16 a[150:151], v14 offset:53248
    v_mfma_f32_16x16x32_bf16 v[108:111], a[184:187], v[236:239], v[108:111]
    buffer_load_dwordx4 v25, s[12:15], s49 offen offset:1024 lds
    v_mfma_f32_16x16x32_bf16 a[28:31], a[188:191], v[128:131], a[28:31]
    v_max_f32 v39, v39, v244
    v_cmp_lt_f32 vcc, s54, v39
    v_mfma_f32_16x16x32_bf16 a[60:63], a[188:191], v[132:135], a[60:63]
    buffer_load_dwordx4 v24, s[12:15], s49 offen offset:2048 lds
    v_mfma_f32_16x16x32_bf16 a[92:95], a[188:191], v[136:139], a[92:95]
    v_mfma_f32_16x16x32_bf16 a[124:127], a[188:191], v[140:143], a[124:127]
    s_cbranch_vccnz k4_kernel_stub7
k4_kernel_ret7:
    s_sub_u32 s51, s51, 1
    s_cbranch_scc0 k4_kernel_loop
    s_waitcnt lgkmcnt(3)
    v_mfma_f32_16x16x32_bf16 v[48:51], a[128:131], v[176:179], v[144:147]
    ds_read_b128 a[152:155], v11 offset:49152
    v_mov_b32 v248, v40
    v_mfma_f32_16x16x32_bf16 v[56:59], a[128:131], v[192:195], v[148:151]
    v_exp_f32 v160, v80
    v_mfma_f32_16x16x32_bf16 v[64:67], a[128:131], v[208:211], v[152:155]
    ds_read_b64_tr_b16 a[156:157], v15 offset:49152
    ds_read_b64_tr_b16 a[158:159], v15 offset:53248
    v_mfma_f32_16x16x32_bf16 v[72:75], a[128:131], v[224:227], v[156:159]
    v_exp_f32 v161, v81
    v_mfma_f32_16x16x32_bf16 a[0:3], a[132:135], v[112:115], a[0:3]
    v_exp_f32 v162, v82
    v_mfma_f32_16x16x32_bf16 a[32:35], a[132:135], v[116:119], a[32:35]
    v_exp_f32 v163, v83
    v_mfma_f32_16x16x32_bf16 a[64:67], a[132:135], v[120:123], a[64:67]
    v_exp_f32 v164, v88
    v_mfma_f32_16x16x32_bf16 a[96:99], a[132:135], v[124:127], a[96:99]
    buffer_load_dwordx4 v25, s[12:15], s49 offen offset:3072 lds
    v_mfma_f32_16x16x32_bf16 v[48:51], a[136:139], v[180:183], v[48:51]
    ds_read_b128 a[160:163], v8 offset:53248
    s_add_u32 s49, s49, 0x4000
    v_mfma_f32_16x16x32_bf16 v[56:59], a[136:139], v[196:199], v[56:59]
    v_exp_f32 v165, v89
    v_mfma_f32_16x16x32_bf16 v[64:67], a[136:139], v[212:215], v[64:67]
    ds_read_b64_tr_b16 a[164:165], v16 offset:49152
    ds_read_b64_tr_b16 a[166:167], v16 offset:53248
    v_mfma_f32_16x16x32_bf16 v[72:75], a[136:139], v[228:231], v[72:75]
    v_exp_f32 v166, v90
    v_mfma_f32_16x16x32_bf16 a[4:7], a[140:143], v[112:115], a[4:7]
    v_exp_f32 v167, v91
    v_mfma_f32_16x16x32_bf16 a[36:39], a[140:143], v[116:119], a[36:39]
    v_exp_f32 v168, v84
    v_mfma_f32_16x16x32_bf16 a[68:71], a[140:143], v[120:123], a[68:71]
    v_exp_f32 v169, v85
    v_mfma_f32_16x16x32_bf16 a[100:103], a[140:143], v[124:127], a[100:103]
    v_mov_b32 v249, v44
    s_waitcnt lgkmcnt(3)
    v_mfma_f32_16x16x32_bf16 v[48:51], a[144:147], v[184:187], v[48:51]
    ds_read_b128 a[168:171], v9 offset:53248
    v_mov_b32 v250, v240
    v_mfma_f32_16x16x32_bf16 v[56:59], a[144:147], v[200:203], v[56:59]
    v_exp_f32 v170, v86
    v_mfma_f32_16x16x32_bf16 v[64:67], a[144:147], v[216:219], v[64:67]
    ds_read_b64_tr_b16 a[172:173], v17 offset:49152
    ds_read_b64_tr_b16 a[174:175], v17 offset:53248
    v_mfma_f32_16x16x32_bf16 v[72:75], a[144:147], v[232:235], v[72:75]
    v_exp_f32 v171, v87
    v_mfma_f32_16x16x32_bf16 a[8:11], a[148:151], v[112:115], a[8:11]
    v_mov_b32 v251, v244
    v_cvt_pk_bf16_f32 v128, v160, v161
    v_mfma_f32_16x16x32_bf16 a[40:43], a[148:151], v[116:119], a[40:43]
    v_exp_f32 v160, v96
    v_mfma_f32_16x16x32_bf16 a[72:75], a[148:151], v[120:123], a[72:75]
    v_exp_f32 v161, v97
    v_mfma_f32_16x16x32_bf16 a[104:107], a[148:151], v[124:127], a[104:107]
    v_cvt_pk_bf16_f32 v129, v162, v163
    v_cvt_pk_bf16_f32 v132, v164, v165
    v_mfma_f32_16x16x32_bf16 v[48:51], a[152:155], v[188:191], v[48:51]
    ds_read_b128 a[176:179], v10 offset:53248
    v_cvt_pk_bf16_f32 v133, v166, v167
    v_mfma_f32_16x16x32_bf16 v[56:59], a[152:155], v[204:207], v[56:59]
    v_exp_f32 v162, v98
    v_mfma_f32_16x16x32_bf16 v[64:67], a[152:155], v[220:223], v[64:67]
    ds_read_b64_tr_b16 a[180:181], v18 offset:49152
    ds_read_b64_tr_b16 a[182:183], v18 offset:53248
    v_mfma_f32_16x16x32_bf16 v[72:75], a[152:155], v[236:239], v[72:75]
    v_exp_f32 v163, v99
    v_mfma_f32_16x16x32_bf16 a[12:15], a[156:159], v[112:115], a[12:15]
    v_exp_f32 v164, v92
    v_mfma_f32_16x16x32_bf16 a[44:47], a[156:159], v[116:119], a[44:47]
    v_exp_f32 v165, v93
    v_mfma_f32_16x16x32_bf16 a[76:79], a[156:159], v[120:123], a[76:79]
    v_cvt_pk_bf16_f32 v130, v168, v169
    v_cvt_pk_bf16_f32 v131, v170, v171
    v_mfma_f32_16x16x32_bf16 a[108:111], a[156:159], v[124:127], a[108:111]
    v_exp_f32 v166, v94
    v_mfma_f32_16x16x32_bf16 v[40:43], v[172:175], v[128:131], v[40:43]
    v_cvt_pk_bf16_f32 v136, v160, v161
    s_waitcnt lgkmcnt(3)
    v_mfma_f32_16x16x32_bf16 v[52:55], a[160:163], v[176:179], v[144:147]
    ds_read_b128 a[184:187], v11 offset:53248
    v_cvt_pk_bf16_f32 v137, v162, v163
    v_mfma_f32_16x16x32_bf16 v[60:63], a[160:163], v[192:195], v[148:151]
    v_exp_f32 v167, v95
    v_mfma_f32_16x16x32_bf16 v[68:71], a[160:163], v[208:211], v[152:155]
    ds_read_b64_tr_b16 a[188:189], v19 offset:49152
    ds_read_b64_tr_b16 a[190:191], v19 offset:53248
    v_mfma_f32_16x16x32_bf16 v[76:79], a[160:163], v[224:227], v[156:159]
    v_exp_f32 v168, v104
    v_mfma_f32_16x16x32_bf16 a[16:19], a[164:167], v[112:115], a[16:19]
    v_exp_f32 v169, v105
    v_mfma_f32_16x16x32_bf16 a[48:51], a[164:167], v[116:119], a[48:51]
    v_exp_f32 v170, v106
    v_mfma_f32_16x16x32_bf16 a[80:83], a[164:167], v[120:123], a[80:83]
    v_cvt_pk_bf16_f32 v134, v164, v165
    v_cvt_pk_bf16_f32 v135, v166, v167
    v_mfma_f32_16x16x32_bf16 a[112:115], a[164:167], v[124:127], a[112:115]
    v_exp_f32 v171, v107
    v_mfma_f32_16x16x32_bf16 v[44:47], v[172:175], v[132:135], v[44:47]
    v_exp_f32 v160, v100
    v_mfma_f32_16x16x32_bf16 v[52:55], a[168:171], v[180:183], v[52:55]
    ds_read_b128 a[128:131], v8 offset:57344
    v_cvt_pk_bf16_f32 v140, v168, v169
    v_mfma_f32_16x16x32_bf16 v[60:63], a[168:171], v[196:199], v[60:63]
    v_exp_f32 v161, v101
    v_mfma_f32_16x16x32_bf16 v[68:71], a[168:171], v[212:215], v[68:71]
    ds_read_b64_tr_b16 a[132:133], v12 offset:57344
    ds_read_b64_tr_b16 a[134:135], v12 offset:61440
    v_mfma_f32_16x16x32_bf16 v[76:79], a[168:171], v[228:231], v[76:79]
    v_exp_f32 v162, v102
    v_mfma_f32_16x16x32_bf16 a[20:23], a[172:175], v[112:115], a[20:23]
    v_exp_f32 v163, v103
    v_mfma_f32_16x16x32_bf16 a[52:55], a[172:175], v[116:119], a[52:55]
    v_exp_f32 v164, v108
    v_mfma_f32_16x16x32_bf16 a[84:87], a[172:175], v[120:123], a[84:87]
    v_cvt_pk_bf16_f32 v141, v170, v171
    v_cvt_pk_bf16_f32 v138, v160, v161
    v_cvt_pk_bf16_f32 v139, v162, v163
    v_mfma_f32_16x16x32_bf16 a[116:119], a[172:175], v[124:127], a[116:119]
    v_exp_f32 v165, v109
    v_mfma_f32_16x16x32_bf16 v[240:243], v[172:175], v[136:139], v[240:243]
    v_cvt_pk_bf16_f32 v142, v164, v165
    s_waitcnt lgkmcnt(3)
    v_mfma_f32_16x16x32_bf16 v[52:55], a[176:179], v[184:187], v[52:55]
    ds_read_b128 a[136:139], v9 offset:57344
    v_mfma_f32_16x16x32_bf16 v[60:63], a[176:179], v[200:203], v[60:63]
    v_exp_f32 v166, v110
    v_mfma_f32_16x16x32_bf16 v[68:71], a[176:179], v[216:219], v[68:71]
    ds_read_b64_tr_b16 a[140:141], v13 offset:57344
    ds_read_b64_tr_b16 a[142:143], v13 offset:61440
    v_mfma_f32_16x16x32_bf16 v[76:79], a[176:179], v[232:235], v[76:79]
    v_exp_f32 v167, v111
    v_mfma_f32_16x16x32_bf16 a[24:27], a[180:183], v[112:115], a[24:27]
    v_cvt_pk_bf16_f32 v143, v166, v167
    v_max3_f32 v39, v40, v44, v240
    v_mfma_f32_16x16x32_bf16 a[56:59], a[180:183], v[116:119], a[56:59]
    v_mfma_f32_16x16x32_bf16 a[88:91], a[180:183], v[120:123], a[88:91]
    v_mfma_f32_16x16x32_bf16 a[120:123], a[180:183], v[124:127], a[120:123]
    v_mfma_f32_16x16x32_bf16 v[244:247], v[172:175], v[140:143], v[244:247]
    v_mfma_f32_16x16x32_bf16 v[52:55], a[184:187], v[188:191], v[52:55]
    ds_read_b128 a[144:147], v10 offset:57344
    v_mfma_f32_16x16x32_bf16 v[60:63], a[184:187], v[204:207], v[60:63]
    v_mfma_f32_16x16x32_bf16 v[68:71], a[184:187], v[220:223], v[68:71]
    ds_read_b64_tr_b16 a[148:149], v14 offset:57344
    ds_read_b64_tr_b16 a[150:151], v14 offset:61440
    v_mfma_f32_16x16x32_bf16 v[76:79], a[184:187], v[236:239], v[76:79]
    v_mfma_f32_16x16x32_bf16 a[28:31], a[188:191], v[112:115], a[28:31]
    v_max_f32 v39, v39, v244
    v_cmp_lt_f32 vcc, s54, v39
    v_mfma_f32_16x16x32_bf16 a[60:63], a[188:191], v[116:119], a[60:63]
    v_mfma_f32_16x16x32_bf16 a[92:95], a[188:191], v[120:123], a[92:95]
    v_mfma_f32_16x16x32_bf16 a[124:127], a[188:191], v[124:127], a[124:127]
    s_cbranch_vccnz k4_kernel_stub159
k4_kernel_ret159:
    s_waitcnt lgkmcnt(3)
    v_mfma_f32_16x16x32_bf16 v[80:83], a[128:131], v[176:179], v[144:147]
    ds_read_b128 a[152:155], v11 offset:57344
    v_mov_b32 v248, v40
    v_mfma_f32_16x16x32_bf16 v[88:91], a[128:131], v[192:195], v[148:151]
    v_exp_f32 v160, v48
    v_mfma_f32_16x16x32_bf16 v[96:99], a[128:131], v[208:211], v[152:155]
    ds_read_b64_tr_b16 a[156:157], v15 offset:57344
    ds_read_b64_tr_b16 a[158:159], v15 offset:61440
    v_mfma_f32_16x16x32_bf16 v[104:107], a[128:131], v[224:227], v[156:159]
    v_exp_f32 v161, v49
    v_mfma_f32_16x16x32_bf16 a[0:3], a[132:135], v[128:131], a[0:3]
    v_exp_f32 v162, v50
    v_mfma_f32_16x16x32_bf16 a[32:35], a[132:135], v[132:135], a[32:35]
    v_exp_f32 v163, v51
    v_mfma_f32_16x16x32_bf16 a[64:67], a[132:135], v[136:139], a[64:67]
    v_exp_f32 v164, v56
    v_mfma_f32_16x16x32_bf16 a[96:99], a[132:135], v[140:143], a[96:99]
    v_exp_f32 v165, v57
    v_mfma_f32_16x16x32_bf16 v[80:83], a[136:139], v[180:183], v[80:83]
    ds_read_b128 a[160:163], v8 offset:61440
    v_mov_b32 v249, v44
    v_mfma_f32_16x16x32_bf16 v[88:91], a[136:139], v[196:199], v[88:91]
    v_exp_f32 v166, v58
    v_mfma_f32_16x16x32_bf16 v[96:99], a[136:139], v[212:215], v[96:99]
    ds_read_b64_tr_b16 a[164:165], v16 offset:57344
    ds_read_b64_tr_b16 a[166:167], v16 offset:61440
    v_mfma_f32_16x16x32_bf16 v[104:107], a[136:139], v[228:231], v[104:107]
    v_exp_f32 v167, v59
    v_mfma_f32_16x16x32_bf16 a[4:7], a[140:143], v[128:131], a[4:7]
    v_exp_f32 v168, v52
    v_mfma_f32_16x16x32_bf16 a[36:39], a[140:143], v[132:135], a[36:39]
    v_exp_f32 v169, v53
    v_mfma_f32_16x16x32_bf16 a[68:71], a[140:143], v[136:139], a[68:71]
    v_exp_f32 v170, v54
    v_mfma_f32_16x16x32_bf16 a[100:103], a[140:143], v[140:143], a[100:103]
    v_mov_b32 v250, v240
    s_waitcnt lgkmcnt(3)
    v_mfma_f32_16x16x32_bf16 v[80:83], a[144:147], v[184:187], v[80:83]
    ds_read_b128 a[168:171], v9 offset:61440
    v_mov_b32 v251, v244
    v_mfma_f32_16x16x32_bf16 v[88:91], a[144:147], v[200:203], v[88:91]
    v_exp_f32 v171, v55
    v_mfma_f32_16x16x32_bf16 v[96:99], a[144:147], v[216:219], v[96:99]
    ds_read_b64_tr_b16 a[172:173], v17 offset:57344
    ds_read_b64_tr_b16 a[174:175], v17 offset:61440
    v_mfma_f32_16x16x32_bf16 v[104:107], a[144:147], v[232:235], v[104:107]
    v_cvt_pk_bf16_f32 v112, v160, v161
    v_cvt_pk_bf16_f32 v113, v162, v163
    v_mfma_f32_16x16x32_bf16 a[8:11], a[148:151], v[128:131], a[8:11]
    v_exp_f32 v160, v64
    v_mfma_f32_16x16x32_bf16 a[40:43], a[148:151], v[132:135], a[40:43]
    v_exp_f32 v161, v65
    v_mfma_f32_16x16x32_bf16 a[72:75], a[148:151], v[136:139], a[72:75]
    v_exp_f32 v162, v66
    v_mfma_f32_16x16x32_bf16 a[104:107], a[148:151], v[140:143], a[104:107]
    v_exp_f32 v163, v67
    v_mfma_f32_16x16x32_bf16 v[80:83], a[152:155], v[188:191], v[80:83]
    ds_read_b128 a[176:179], v10 offset:61440
    v_cvt_pk_bf16_f32 v116, v164, v165
    v_mfma_f32_16x16x32_bf16 v[88:91], a[152:155], v[204:207], v[88:91]
    v_exp_f32 v164, v60
    v_mfma_f32_16x16x32_bf16 v[96:99], a[152:155], v[220:223], v[96:99]
    ds_read_b64_tr_b16 a[180:181], v18 offset:57344
    ds_read_b64_tr_b16 a[182:183], v18 offset:61440
    v_mfma_f32_16x16x32_bf16 v[104:107], a[152:155], v[236:239], v[104:107]
    v_exp_f32 v165, v61
    v_mfma_f32_16x16x32_bf16 a[12:15], a[156:159], v[128:131], a[12:15]
    v_cvt_pk_bf16_f32 v117, v166, v167
    v_cvt_pk_bf16_f32 v114, v168, v169
    v_mfma_f32_16x16x32_bf16 a[44:47], a[156:159], v[132:135], a[44:47]
    v_exp_f32 v166, v62
    v_mfma_f32_16x16x32_bf16 a[76:79], a[156:159], v[136:139], a[76:79]
    v_cvt_pk_bf16_f32 v115, v170, v171
    v_cvt_pk_bf16_f32 v120, v160, v161
    v_mfma_f32_16x16x32_bf16 a[108:111], a[156:159], v[140:143], a[108:111]
    v_exp_f32 v167, v63
    v_mfma_f32_16x16x32_bf16 v[40:43], v[172:175], v[112:115], v[40:43]
    v_cvt_pk_bf16_f32 v121, v162, v163
    s_waitcnt lgkmcnt(3)
    v_mfma_f32_16x16x32_bf16 v[84:87], a[160:163], v[176:179], v[144:147]
    ds_read_b128 a[184:187], v11 offset:61440
    v_cvt_pk_bf16_f32 v118, v164, v165
    v_mfma_f32_16x16x32_bf16 v[92:95], a[160:163], v[192:195], v[148:151]
    v_exp_f32 v168, v72
    v_mfma_f32_16x16x32_bf16 v[100:103], a[160:163], v[208:211], v[152:155]
    ds_read_b64_tr_b16 a[188:189], v19 offset:57344
    ds_read_b64_tr_b16 a[190:191], v19 offset:61440
    v_mfma_f32_16x16x32_bf16 v[108:111], a[160:163], v[224:227], v[156:159]
    v_exp_f32 v169, v73
    v_mfma_f32_16x16x32_bf16 a[16:19], a[164:167], v[128:131], a[16:19]
    v_exp_f32 v170, v74
    v_mfma_f32_16x16x32_bf16 a[48:51], a[164:167], v[132:135], a[48:51]
    v_exp_f32 v171, v75
    v_mfma_f32_16x16x32_bf16 a[80:83], a[164:167], v[136:139], a[80:83]
    v_cvt_pk_bf16_f32 v119, v166, v167
    v_cvt_pk_bf16_f32 v124, v168, v169
    v_mfma_f32_16x16x32_bf16 a[112:115], a[164:167], v[140:143], a[112:115]
    v_exp_f32 v160, v68
    v_mfma_f32_16x16x32_bf16 v[44:47], v[172:175], v[116:119], v[44:47]
    s_waitcnt vmcnt(4)
    s_barrier
    v_mfma_f32_16x16x32_bf16 v[84:87], a[168:171], v[180:183], v[84:87]
    ds_read_b128 a[128:131], v8 offset:0
    v_cvt_pk_bf16_f32 v125, v170, v171
    v_mfma_f32_16x16x32_bf16 v[92:95], a[168:171], v[196:199], v[92:95]
    v_exp_f32 v161, v69
    v_mfma_f32_16x16x32_bf16 v[100:103], a[168:171], v[212:215], v[100:103]
    ds_read_b64_tr_b16 a[132:133], v12 offset:0
    ds_read_b64_tr_b16 a[134:135], v12 offset:4096
    v_mfma_f32_16x16x32_bf16 v[108:111], a[168:171], v[228:231], v[108:111]
    v_exp_f32 v162, v70
    v_mfma_f32_16x16x32_bf16 a[20:23], a[172:175], v[128:131], a[20:23]
    v_exp_f32 v163, v71
    v_mfma_f32_16x16x32_bf16 a[52:55], a[172:175], v[132:135], a[52:55]
    v_exp_f32 v164, v76
    v_mfma_f32_16x16x32_bf16 a[84:87], a[172:175], v[136:139], a[84:87]
    v_cvt_pk_bf16_f32 v122, v160, v161
    v_cvt_pk_bf16_f32 v123, v162, v163
    v_mfma_f32_16x16x32_bf16 a[116:119], a[172:175], v[140:143], a[116:119]
    v_exp_f32 v165, v77
    v_mfma_f32_16x16x32_bf16 v[240:243], v[172:175], v[120:123], v[240:243]
    v_cvt_pk_bf16_f32 v126, v164, v165
    s_waitcnt lgkmcnt(3)
    v_mfma_f32_16x16x32_bf16 v[84:87], a[176:179], v[184:187], v[84:87]
    ds_read_b128 a[136:139], v9 offset:0
    s_add_u32 m0, s47, 32768
    s_mov_b32 s50, 0
    v_mfma_f32_16x16x32_bf16 v[92:95], a[176:179], v[200:203], v[92:95]
    v_exp_f32 v166, v78
    v_mfma_f32_16x16x32_bf16 v[100:103], a[176:179], v[216:219], v[100:103]
    ds_read_b64_tr_b16 a[140:141], v13 offset:0
    ds_read_b64_tr_b16 a[142:143], v13 offset:4096
    v_mfma_f32_16x16x32_bf16 v[108:111], a[176:179], v[232:235], v[108:111]
    v_exp_f32 v167, v79
    v_mfma_f32_16x16x32_bf16 a[24:27], a[180:183], v[128:131], a[24:27]
    v_cvt_pk_bf16_f32 v127, v166, v167
    v_max3_f32 v39, v40, v44, v240
    v_mfma_f32_16x16x32_bf16 a[56:59], a[180:183], v[132:135], a[56:59]
    v_mfma_f32_16x16x32_bf16 a[88:91], a[180:183], v[136:139], a[88:91]
    v_mfma_f32_16x16x32_bf16 a[120:123], a[180:183], v[140:143], a[120:123]
    v_mfma_f32_16x16x32_bf16 v[244:247], v[172:175], v[124:127], v[244:247]
    buffer_load_dwordx4 v26, s[20:23], s50 offen offset:0 lds
    v_mfma_f32_16x16x32_bf16 v[84:87], a[184:187], v[188:191], v[84:87]
    ds_read_b128 a[144:147], v10 offset:0
    v_mfma_f32_16x16x32_bf16 v[92:95], a[184:187], v[204:207], v[92:95]
    v_mfma_f32_16x16x32_bf16 v[100:103], a[184:187], v[220:223], v[100:103]
    ds_read_b64_tr_b16 a[148:149], v14 offset:0
    ds_read_b64_tr_b16 a[150:151], v14 offset:4096
    v_mfma_f32_16x16x32_bf16 v[108:111], a[184:187], v[236:239], v[108:111]
    buffer_load_dwordx4 v27, s[20:23], s50 offen offset:1024 lds
    v_mfma_f32_16x16x32_bf16 a[28:31], a[188:191], v[128:131], a[28:31]
    v_max_f32 v39, v39, v244
    v_cmp_lt_f32 vcc, s54, v39
    v_mfma_f32_16x16x32_bf16 a[60:63], a[188:191], v[132:135], a[60:63]
    buffer_load_dwordx4 v28, s[20:23], s50 offen offset:2048 lds
    v_mfma_f32_16x16x32_bf16 a[92:95], a[188:191], v[136:139], a[92:95]
    v_mfma_f32_16x16x32_bf16 a[124:127], a[188:191], v[140:143], a[124:127]
    s_cbranch_vccnz k4_kernel_stub160
k4_kernel_ret160:
    s_waitcnt lgkmcnt(3)
    v_mfma_f32_16x16x32_bf16 v[48:51], a[128:131], v[176:179], v[144:147]
    ds_read_b128 a[152:155], v11 offset:0
    v_mov_b32 v248, v40
    v_mfma_f32_16x16x32_bf16 v[56:59], a[128:131], v[192:195], v[148:151]
    v_exp_f32 v160, v80
    v_mfma_f32_16x16x32_bf16 v[64:67], a[128:131], v[208:211], v[152:155]
    ds_read_b64_tr_b16 a[156:157], v15 offset:0
    ds_read_b64_tr_b16 a[158:159], v15 offset:4096
    v_mfma_f32_16x16x32_bf16 v[72:75], a[128:131], v[224:227], v[156:159]
    v_exp_f32 v161, v81
    v_mfma_f32_16x16x32_bf16 a[0:3], a[132:135], v[112:115], a[0:3]
    v_exp_f32 v162, v82
    v_mfma_f32_16x16x32_bf16 a[32:35], a[132:135], v[116:119], a[32:35]
    v_exp_f32 v163, v83
    v_mfma_f32_16x16x32_bf16 a[64:67], a[132:135], v[120:123], a[64:67]
    v_exp_f32 v164, v88
    v_mfma_f32_16x16x32_bf16 a[96:99], a[132:135], v[124:127], a[96:99]
    buffer_load_dwordx4 v29, s[20:23], s50 offen offset:3072 lds
    v_mfma_f32_16x16x32_bf16 v[48:51], a[136:139], v[180:183], v[48:51]
    ds_read_b128 a[160:163], v8 offset:4096
    v_mov_b32 v249, v44
    v_mfma_f32_16x16x32_bf16 v[56:59], a[136:139], v[196:199], v[56:59]
    v_exp_f32 v165, v89
    v_mfma_f32_16x16x32_bf16 v[64:67], a[136:139], v[212:215], v[64:67]
    ds_read_b64_tr_b16 a[164:165], v16 offset:0
    ds_read_b64_tr_b16 a[166:167], v16 offset:4096
    v_mfma_f32_16x16x32_bf16 v[72:75], a[136:139], v[228:231], v[72:75]
    v_exp_f32 v166, v90
    v_mfma_f32_16x16x32_bf16 a[4:7], a[140:143], v[112:115], a[4:7]
    v_exp_f32 v167, v91
    v_mfma_f32_16x16x32_bf16 a[36:39], a[140:143], v[116:119], a[36:39]
    v_exp_f32 v168, v84
    v_mfma_f32_16x16x32_bf16 a[68:71], a[140:143], v[120:123], a[68:71]
    v_exp_f32 v169, v85
    v_mfma_f32_16x16x32_bf16 a[100:103], a[140:143], v[124:127], a[100:103]
    v_mov_b32 v250, v240
    s_waitcnt lgkmcnt(3)
    v_mfma_f32_16x16x32_bf16 v[48:51], a[144:147], v[184:187], v[48:51]
    ds_read_b128 a[168:171], v9 offset:4096
    s_add_u32 m0, s47, 98304
    s_mov_b32 s50, 147456
    v_mfma_f32_16x16x32_bf16 v[56:59], a[144:147], v[200:203], v[56:59]
    v_exp_f32 v170, v86
    v_mfma_f32_16x16x32_bf16 v[64:67], a[144:147], v[216:219], v[64:67]
    ds_read_b64_tr_b16 a[172:173], v17 offset:0
    ds_read_b64_tr_b16 a[174:175], v17 offset:4096
    v_mfma_f32_16x16x32_bf16 v[72:75], a[144:147], v[232:235], v[72:75]
    v_exp_f32 v171, v87
    v_mfma_f32_16x16x32_bf16 a[8:11], a[148:151], v[112:115], a[8:11]
    v_mov_b32 v251, v244
    v_cvt_pk_bf16_f32 v128, v160, v161
    v_mfma_f32_16x16x32_bf16 a[40:43], a[148:151], v[116:119], a[40:43]
    v_exp_f32 v160, v96
    v_mfma_f32_16x16x32_bf16 a[72:75], a[148:151], v[120:123], a[72:75]
    v_exp_f32 v161, v97
    v_mfma_f32_16x16x32_bf16 a[104:107], a[148:151], v[124:127], a[104:107]
    buffer_load_dwordx4 v26, s[20:23], s50 offen offset:0 lds
    v_mfma_f32_16x16x32_bf16 v[48:51], a[152:155], v[188:191], v[48:51]
    ds_read_b128 a[176:179], v10 offset:4096
    v_cvt_pk_bf16_f32 v129, v162, v163
    v_mfma_f32_16x16x32_bf16 v[56:59], a[152:155], v[204:207], v[56:59]
    v_exp_f32 v162, v98
    v_mfma_f32_16x16x32_bf16 v[64:67], a[152:155], v[220:223], v[64:67]
    ds_read_b64_tr_b16 a[180:181], v18 offset:0
    ds_read_b64_tr_b16 a[182:183], v18 offset:4096
    v_mfma_f32_16x16x32_bf16 v[72:75], a[152:155], v[236:239], v[72:75]
    v_exp_f32 v163, v99
    v_mfma_f32_16x16x32_bf16 a[12:15], a[156:159], v[112:115], a[12:15]
    v_cvt_pk_bf16_f32 v132, v164, v165
    v_cvt_pk_bf16_f32 v133, v166, v167
    v_mfma_f32_16x16x32_bf16 a[44:47], a[156:159], v[116:119], a[44:47]
    v_exp_f32 v164, v92
    v_mfma_f32_16x16x32_bf16 a[76:79], a[156:159], v[120:123], a[76:79]
    v_cvt_pk_bf16_f32 v130, v168, v169
    v_cvt_pk_bf16_f32 v131, v170, v171
    v_mfma_f32_16x16x32_bf16 a[108:111], a[156:159], v[124:127], a[108:111]
    v_exp_f32 v165, v93
    v_mfma_f32_16x16x32_bf16 v[40:43], v[172:175], v[128:131], v[40:43]
    v_cvt_pk_bf16_f32 v136, v160, v161
    s_waitcnt lgkmcnt(3)
    v_mfma_f32_16x16x32_bf16 v[52:55], a[160:163], v[176:179], v[144:147]
    ds_read_b128 a[184:187], v11 offset:4096
    v_cvt_pk_bf16_f32 v137, v162, v163
    v_mfma_f32_16x16x32_bf16 v[60:63], a[160:163], v[192:195], v[148:151]
    v_exp_f32 v166, v94
    v_mfma_f32_16x16x32_bf16 v[68:71], a[160:163], v[208:211], v[152:155]
    ds_read_b64_tr_b16 a[188:189], v19 offset:0
    ds_read_b64_tr_b16 a[190:191], v19 offset:4096
    v_mfma_f32_16x16x32_bf16 v[76:79], a[160:163], v[224:227], v[156:159]
    v_exp_f32 v167, v95
    v_mfma_f32_16x16x32_bf16 a[16:19], a[164:167], v[112:115], a[16:19]
    v_exp_f32 v168, v104
    v_mfma_f32_16x16x32_bf16 a[48:51], a[164:167], v[116:119], a[48:51]
    v_exp_f32 v169, v105
    v_mfma_f32_16x16x32_bf16 a[80:83], a[164:167], v[120:123], a[80:83]
    v_cvt_pk_bf16_f32 v134, v164, v165
    v_cvt_pk_bf16_f32 v135, v166, v167
    v_mfma_f32_16x16x32_bf16 a[112:115], a[164:167], v[124:127], a[112:115]
    v_exp_f32 v170, v106
    v_mfma_f32_16x16x32_bf16 v[44:47], v[172:175], v[132:135], v[44:47]
    buffer_load_dwordx4 v27, s[20:23], s50 offen offset:1024 lds
    v_mfma_f32_16x16x32_bf16 v[52:55], a[168:171], v[180:183], v[52:55]
    ds_read_b128 a[128:131], v8 offset:8192
    v_cvt_pk_bf16_f32 v140, v168, v169
    v_mfma_f32_16x16x32_bf16 v[60:63], a[168:171], v[196:199], v[60:63]
    v_exp_f32 v171, v107
    v_mfma_f32_16x16x32_bf16 v[68:71], a[168:171], v[212:215], v[68:71]
    ds_read_b64_tr_b16 a[132:133], v12 offset:8192
    ds_read_b64_tr_b16 a[134:135], v12 offset:12288
    v_mfma_f32_16x16x32_bf16 v[76:79], a[168:171], v[228:231], v[76:79]
    v_exp_f32 v160, v100
    v_mfma_f32_16x16x32_bf16 a[20:23], a[172:175], v[112:115], a[20:23]
    v_exp_f32 v161, v101
    v_mfma_f32_16x16x32_bf16 a[52:55], a[172:175], v[116:119], a[52:55]
    v_exp_f32 v162, v102
    v_mfma_f32_16x16x32_bf16 a[84:87], a[172:175], v[120:123], a[84:87]
    v_cvt_pk_bf16_f32 v141, v170, v171
    v_cvt_pk_bf16_f32 v138, v160, v161
    v_exp_f32 v163, v103
    s_nop 0
    v_cvt_pk_bf16_f32 v139, v162, v163
    v_mfma_f32_16x16x32_bf16 a[116:119], a[172:175], v[124:127], a[116:119]
    v_exp_f32 v164, v108
    v_mfma_f32_16x16x32_bf16 v[240:243], v[172:175], v[136:139], v[240:243]
    s_waitcnt lgkmcnt(3)
    v_mfma_f32_16x16x32_bf16 v[52:55], a[176:179], v[184:187], v[52:55]
    ds_read_b128 a[136:139], v9 offset:8192
    v_mfma_f32_16x16x32_bf16 v[60:63], a[176:179], v[200:203], v[60:63]
    v_exp_f32 v165, v109
    v_mfma_f32_16x16x32_bf16 v[68:71], a[176:179], v[216:219], v[68:71]
    ds_read_b64_tr_b16 a[140:141], v13 offset:8192
    ds_read_b64_tr_b16 a[142:143], v13 offset:12288
    v_mfma_f32_16x16x32_bf16 v[76:79], a[176:179], v[232:235], v[76:79]
    v_exp_f32 v166, v110
    v_mfma_f32_16x16x32_bf16 a[24:27], a[180:183], v[112:115], a[24:27]
    v_exp_f32 v167, v111
    v_mfma_f32_16x16x32_bf16 a[56:59], a[180:183], v[116:119], a[56:59]
    v_cvt_pk_bf16_f32 v142, v164, v165
    v_cvt_pk_bf16_f32 v143, v166, v167
    v_mfma_f32_16x16x32_bf16 a[88:91], a[180:183], v[120:123], a[88:91]
    v_max3_f32 v39, v40, v44, v240
    v_mfma_f32_16x16x32_bf16 a[120:123], a[180:183], v[124:127], a[120:123]
    v_mfma_f32_16x16x32_bf16 v[244:247], v[172:175], v[140:143], v[244:247]
    buffer_load_dwordx4 v28, s[20:23], s50 offen offset:2048 lds
    v_mfma_f32_16x16x32_bf16 v[52:55], a[184:187], v[188:191], v[52:55]
    ds_read_b128 a[144:147], v10 offset:8192
    v_mfma_f32_16x16x32_bf16 v[60:63], a[184:187], v[204:207], v[60:63]
    v_mfma_f32_16x16x32_bf16 v[68:71], a[184:187], v[220:223], v[68:71]
    ds_read_b64_tr_b16 a[148:149], v14 offset:8192
    ds_read_b64_tr_b16 a[150:151], v14 offset:12288
    v_mfma_f32_16x16x32_bf16 v[76:79], a[184:187], v[236:239], v[76:79]
    buffer_load_dwordx4 v29, s[20:23], s50 offen offset:3072 lds
    v_mfma_f32_16x16x32_bf16 a[28:31], a[188:191], v[112:115], a[28:31]
    v_max_f32 v39, v39, v244
    v_cmp_lt_f32 vcc, s54, v39
    v_mfma_f32_16x16x32_bf16 a[60:63], a[188:191], v[116:119], a[60:63]
    v_mfma_f32_16x16x32_bf16 a[92:95], a[188:191], v[120:123], a[92:95]
    v_mfma_f32_16x16x32_bf16 a[124:127], a[188:191], v[124:127], a[124:127]
    s_cbranch_vccnz k4_kernel_stub161
k4_kernel_ret161:
    s_waitcnt lgkmcnt(3)
    v_mfma_f32_16x16x32_bf16 v[80:83], a[128:131], v[176:179], v[144:147]
    ds_read_b128 a[152:155], v11 offset:8192
    v_mov_b32 v248, v40
    v_mfma_f32_16x16x32_bf16 v[88:91], a[128:131], v[192:195], v[148:151]
    v_exp_f32 v160, v48
    v_mfma_f32_16x16x32_bf16 v[96:99], a[128:131], v[208:211], v[152:155]
    ds_read_b64_tr_b16 a[156:157], v15 offset:8192
    ds_read_b64_tr_b16 a[158:159], v15 offset:12288
    v_mfma_f32_16x16x32_bf16 v[104:107], a[128:131], v[224:227], v[156:159]
    v_exp_f32 v161, v49
    v_mfma_f32_16x16x32_bf16 a[0:3], a[132:135], v[128:131], a[0:3]
    v_exp_f32 v162, v50
    v_mfma_f32_16x16x32_bf16 a[32:35], a[132:135], v[132:135], a[32:35]
    v_exp_f32 v163, v51
    v_mfma_f32_16x16x32_bf16 a[64:67], a[132:135], v[136:139], a[64:67]
    v_exp_f32 v164, v56
    v_mfma_f32_16x16x32_bf16 a[96:99], a[132:135], v[140:143], a[96:99]
    v_exp_f32 v165, v57
    v_mfma_f32_16x16x32_bf16 v[80:83], a[136:139], v[180:183], v[80:83]
    ds_read_b128 a[160:163], v8 offset:12288
    v_mov_b32 v249, v44
    v_mfma_f32_16x16x32_bf16 v[88:91], a[136:139], v[196:199], v[88:91]
    v_exp_f32 v166, v58
    v_mfma_f32_16x16x32_bf16 v[96:99], a[136:139], v[212:215], v[96:99]
    ds_read_b64_tr_b16 a[164:165], v16 offset:8192
    ds_read_b64_tr_b16 a[166:167], v16 offset:12288
    v_mfma_f32_16x16x32_bf16 v[104:107], a[136:139], v[228:231], v[104:107]
    v_exp_f32 v167, v59
    v_mfma_f32_16x16x32_bf16 a[4:7], a[140:143], v[128:131], a[4:7]
    v_exp_f32 v168, v52
    v_mfma_f32_16x16x32_bf16 a[36:39], a[140:143], v[132:135], a[36:39]
    v_exp_f32 v169, v53
    v_mfma_f32_16x16x32_bf16 a[68:71], a[140:143], v[136:139], a[68:71]
    v_exp_f32 v170, v54
    v_mfma_f32_16x16x32_bf16 a[100:103], a[140:143], v[140:143], a[100:103]
    v_mov_b32 v250, v240
    s_waitcnt lgkmcnt(3)
    v_mfma_f32_16x16x32_bf16 v[80:83], a[144:147], v[184:187], v[80:83]
    ds_read_b128 a[168:171], v9 offset:12288
    v_mov_b32 v251, v244
    v_mfma_f32_16x16x32_bf16 v[88:91], a[144:147], v[200:203], v[88:91]
    v_exp_f32 v171, v55
    v_mfma_f32_16x16x32_bf16 v[96:99], a[144:147], v[216:219], v[96:99]
    ds_read_b64_tr_b16 a[172:173], v17 offset:8192
    ds_read_b64_tr_b16 a[174:175], v17 offset:12288
    v_mfma_f32_16x16x32_bf16 v[104:107], a[144:147], v[232:235], v[104:107]
    v_cvt_pk_bf16_f32 v112, v160, v161
    v_cvt_pk_bf16_f32 v113, v162, v163
    v_mfma_f32_16x16x32_bf16 a[8:11], a[148:151], v[128:131], a[8:11]
    v_exp_f32 v160, v64
    v_mfma_f32_16x16x32_bf16 a[40:43], a[148:151], v[132:135], a[40:43]
    v_exp_f32 v161, v65
    v_mfma_f32_16x16x32_bf16 a[72:75], a[148:151], v[136:139], a[72:75]
    v_exp_f32 v162, v66
    v_mfma_f32_16x16x32_bf16 a[104:107], a[148:151], v[140:143], a[104:107]
    v_exp_f32 v163, v67
    v_mfma_f32_16x16x32_bf16 v[80:83], a[152:155], v[188:191], v[80:83]
    ds_read_b128 a[176:179], v10 offset:12288
    v_cvt_pk_bf16_f32 v116, v164, v165
    v_mfma_f32_16x16x32_bf16 v[88:91], a[152:155], v[204:207], v[88:91]
    v_exp_f32 v164, v60
    v_mfma_f32_16x16x32_bf16 v[96:99], a[152:155], v[220:223], v[96:99]
    ds_read_b64_tr_b16 a[180:181], v18 offset:8192
    ds_read_b64_tr_b16 a[182:183], v18 offset:12288
    v_mfma_f32_16x16x32_bf16 v[104:107], a[152:155], v[236:239], v[104:107]
    v_exp_f32 v165, v61
    v_mfma_f32_16x16x32_bf16 a[12:15], a[156:159], v[128:131], a[12:15]
    v_cvt_pk_bf16_f32 v117, v166, v167
    v_cvt_pk_bf16_f32 v114, v168, v169
    v_mfma_f32_16x16x32_bf16 a[44:47], a[156:159], v[132:135], a[44:47]
    v_exp_f32 v166, v62
    v_mfma_f32_16x16x32_bf16 a[76:79], a[156:159], v[136:139], a[76:79]
    v_cvt_pk_bf16_f32 v115, v170, v171
    v_cvt_pk_bf16_f32 v120, v160, v161
    v_mfma_f32_16x16x32_bf16 a[108:111], a[156:159], v[140:143], a[108:111]
    v_exp_f32 v167, v63
    v_mfma_f32_16x16x32_bf16 v[40:43], v[172:175], v[112:115], v[40:43]
    v_cvt_pk_bf16_f32 v121, v162, v163
    s_waitcnt lgkmcnt(3)
    v_mfma_f32_16x16x32_bf16 v[84:87], a[160:163], v[176:179], v[144:147]
    ds_read_b128 a[184:187], v11 offset:12288
    v_cvt_pk_bf16_f32 v118, v164, v165
    v_mfma_f32_16x16x32_bf16 v[92:95], a[160:163], v[192:195], v[148:151]
    v_exp_f32 v168, v72
    v_mfma_f32_16x16x32_bf16 v[100:103], a[160:163], v[208:211], v[152:155]
    ds_read_b64_tr_b16 a[188:189], v19 offset:8192
    ds_read_b64_tr_b16 a[190:191], v19 offset:12288
    v_mfma_f32_16x16x32_bf16 v[108:111], a[160:163], v[224:227], v[156:159]
    v_exp_f32 v169, v73
    v_mfma_f32_16x16x32_bf16 a[16:19], a[164:167], v[128:131], a[16:19]
    v_exp_f32 v170, v74
    v_mfma_f32_16x16x32_bf16 a[48:51], a[164:167], v[132:135], a[48:51]
    v_exp_f32 v171, v75
    v_mfma_f32_16x16x32_bf16 a[80:83], a[164:167], v[136:139], a[80:83]
    v_cvt_pk_bf16_f32 v119, v166, v167
    v_cvt_pk_bf16_f32 v124, v168, v169
    v_mfma_f32_16x16x32_bf16 a[112:115], a[164:167], v[140:143], a[112:115]
    v_exp_f32 v160, v68
    v_mfma_f32_16x16x32_bf16 v[44:47], v[172:175], v[116:119], v[44:47]
    v_exp_f32 v161, v69
    v_mfma_f32_16x16x32_bf16 v[84:87], a[168:171], v[180:183], v[84:87]
    v_exp_f32 v162, v70
    v_mfma_f32_16x16x32_bf16 v[92:95], a[168:171], v[196:199], v[92:95]
    v_exp_f32 v163, v71
    v_mfma_f32_16x16x32_bf16 v[100:103], a[168:171], v[212:215], v[100:103]
    v_exp_f32 v164, v76
    v_mfma_f32_16x16x32_bf16 v[108:111], a[168:171], v[228:231], v[108:111]
    v_exp_f32 v165, v77
    v_mfma_f32_16x16x32_bf16 a[20:23], a[172:175], v[128:131], a[20:23]
    v_exp_f32 v166, v78
    v_mfma_f32_16x16x32_bf16 a[52:55], a[172:175], v[132:135], a[52:55]
    v_exp_f32 v167, v79
    v_mfma_f32_16x16x32_bf16 a[84:87], a[172:175], v[136:139], a[84:87]
    v_cvt_pk_bf16_f32 v125, v170, v171
    v_cvt_pk_bf16_f32 v122, v160, v161
    v_cvt_pk_bf16_f32 v123, v162, v163
    v_mfma_f32_16x16x32_bf16 a[116:119], a[172:175], v[140:143], a[116:119]
    v_cvt_pk_bf16_f32 v126, v164, v165
    v_cvt_pk_bf16_f32 v127, v166, v167
    v_mfma_f32_16x16x32_bf16 v[240:243], v[172:175], v[120:123], v[240:243]
    s_waitcnt lgkmcnt(0)
    v_mfma_f32_16x16x32_bf16 v[84:87], a[176:179], v[184:187], v[84:87]
    v_mfma_f32_16x16x32_bf16 v[92:95], a[176:179], v[200:203], v[92:95]
    v_mfma_f32_16x16x32_bf16 v[100:103], a[176:179], v[216:219], v[100:103]
    s_waitcnt vmcnt(8)
    s_barrier
    v_mfma_f32_16x16x32_bf16 v[108:111], a[176:179], v[232:235], v[108:111]
    ds_read_b64_tr_b16 a[128:129], v12 offset:16384
    v_max3_f32 v39, v40, v44, v240
    v_mfma_f32_16x16x32_bf16 a[24:27], a[180:183], v[128:131], a[24:27]
    s_add_u32 m0, s47, 49152
    v_mfma_f32_16x16x32_bf16 a[56:59], a[180:183], v[132:135], a[56:59]
    ds_read_b64_tr_b16 a[130:131], v12 offset:20480
    s_mov_b32 s50, 128
    v_mfma_f32_16x16x32_bf16 a[88:91], a[180:183], v[136:139], a[88:91]
    buffer_load_dwordx4 v26, s[20:23], s50 offen offset:0 lds
    v_mfma_f32_16x16x32_bf16 a[120:123], a[180:183], v[140:143], a[120:123]
    ds_read_b64_tr_b16 a[132:133], v13 offset:16384
    v_mfma_f32_16x16x32_bf16 v[244:247], v[172:175], v[124:127], v[244:247]
    v_mfma_f32_16x16x32_bf16 v[84:87], a[184:187], v[188:191], v[84:87]
    ds_read_b64_tr_b16 a[134:135], v13 offset:20480
    v_mfma_f32_16x16x32_bf16 v[92:95], a[184:187], v[204:207], v[92:95]
    buffer_load_dwordx4 v27, s[20:23], s50 offen offset:1024 lds
    v_mfma_f32_16x16x32_bf16 v[100:103], a[184:187], v[220:223], v[100:103]
    ds_read_b64_tr_b16 a[136:137], v14 offset:16384
    v_mfma_f32_16x16x32_bf16 v[108:111], a[184:187], v[236:239], v[108:111]
    v_mfma_f32_16x16x32_bf16 a[28:31], a[188:191], v[128:131], a[28:31]
    ds_read_b64_tr_b16 a[138:139], v14 offset:20480
    v_max_f32 v39, v39, v244
    v_mfma_f32_16x16x32_bf16 a[60:63], a[188:191], v[132:135], a[60:63]
    buffer_load_dwordx4 v28, s[20:23], s50 offen offset:2048 lds
    v_mfma_f32_16x16x32_bf16 a[92:95], a[188:191], v[136:139], a[92:95]
    ds_read_b64_tr_b16 a[140:141], v15 offset:16384
    v_cmp_lt_f32 vcc, s54, v39
    v_mfma_f32_16x16x32_bf16 a[124:127], a[188:191], v[140:143], a[124:127]
    s_cbranch_vccnz k4_kernel_stub162
k4_kernel_ret162:
    s_waitcnt lgkmcnt(5)
    v_mfma_f32_16x16x32_bf16 a[0:3], a[128:131], v[112:115], a[0:3]
    ds_read_b64_tr_b16 a[142:143], v15 offset:20480
    v_mov_b32 v248, v40
    v_mfma_f32_16x16x32_bf16 a[32:35], a[128:131], v[116:119], a[32:35]
    buffer_load_dwordx4 v29, s[20:23], s50 offen offset:3072 lds
    v_mfma_f32_16x16x32_bf16 a[64:67], a[128:131], v[120:123], a[64:67]
    ds_read_b64_tr_b16 a[144:145], v16 offset:16384
    v_mov_b32 v249, v44
    v_mfma_f32_16x16x32_bf16 a[96:99], a[128:131], v[124:127], a[96:99]
    s_add_u32 m0, s47, 114688
    s_waitcnt lgkmcnt(5)
    v_mfma_f32_16x16x32_bf16 a[4:7], a[132:135], v[112:115], a[4:7]
    ds_read_b64_tr_b16 a[146:147], v16 offset:20480
    s_mov_b32 s50, 147584
    v_mfma_f32_16x16x32_bf16 a[36:39], a[132:135], v[116:119], a[36:39]
    buffer_load_dwordx4 v26, s[20:23], s50 offen offset:0 lds
    v_mfma_f32_16x16x32_bf16 a[68:71], a[132:135], v[120:123], a[68:71]
    ds_read_b64_tr_b16 a[148:149], v17 offset:16384
    v_mov_b32 v250, v240
    v_mfma_f32_16x16x32_bf16 a[100:103], a[132:135], v[124:127], a[100:103]
    v_mov_b32 v251, v244
    s_waitcnt lgkmcnt(5)
    v_mfma_f32_16x16x32_bf16 a[8:11], a[136:139], v[112:115], a[8:11]
    ds_read_b64_tr_b16 a[150:151], v17 offset:20480
    v_mfma_f32_16x16x32_bf16 a[40:43], a[136:139], v[116:119], a[40:43]
    buffer_load_dwordx4 v27, s[20:23], s50 offen offset:1024 lds
    v_mfma_f32_16x16x32_bf16 a[72:75], a[136:139], v[120:123], a[72:75]
    ds_read_b64_tr_b16 a[152:153], v18 offset:16384
    v_mfma_f32_16x16x32_bf16 a[104:107], a[136:139], v[124:127], a[104:107]
    s_waitcnt lgkmcnt(5)
    v_mfma_f32_16x16x32_bf16 a[12:15], a[140:143], v[112:115], a[12:15]
    ds_read_b64_tr_b16 a[154:155], v18 offset:20480
    v_mfma_f32_16x16x32_bf16 a[44:47], a[140:143], v[116:119], a[44:47]
    buffer_load_dwordx4 v28, s[20:23], s50 offen offset:2048 lds
    v_mfma_f32_16x16x32_bf16 a[76:79], a[140:143], v[120:123], a[76:79]
    ds_read_b64_tr_b16 a[156:157], v19 offset:16384
    v_mfma_f32_16x16x32_bf16 a[108:111], a[140:143], v[124:127], a[108:111]
    s_waitcnt lgkmcnt(5)
    v_mfma_f32_16x16x32_bf16 a[16:19], a[144:147], v[112:115], a[16:19]
    ds_read_b64_tr_b16 a[158:159], v19 offset:20480
    v_mfma_f32_16x16x32_bf16 a[48:51], a[144:147], v[116:119], a[48:51]
    buffer_load_dwordx4 v29, s[20:23], s50 offen offset:3072 lds
    v_mfma_f32_16x16x32_bf16 a[80:83], a[144:147], v[120:123], a[80:83]
    v_exp_f32 v160, v80
    v_mfma_f32_16x16x32_bf16 a[112:115], a[144:147], v[124:127], a[112:115]
    s_waitcnt lgkmcnt(4)
    v_mfma_f32_16x16x32_bf16 a[20:23], a[148:151], v[112:115], a[20:23]
    v_exp_f32 v161, v81
    v_mfma_f32_16x16x32_bf16 a[52:55], a[148:151], v[116:119], a[52:55]
    v_exp_f32 v162, v82
    v_mfma_f32_16x16x32_bf16 a[84:87], a[148:151], v[120:123], a[84:87]
    ds_read_b64_tr_b16 a[160:161], v12 offset:24576
    v_cvt_pk_bf16_f32 v128, v160, v161
    v_mfma_f32_16x16x32_bf16 a[116:119], a[148:151], v[124:127], a[116:119]
    ds_read_b64_tr_b16 a[162:163], v12 offset:28672
    s_waitcnt lgkmcnt(4)
    v_mfma_f32_16x16x32_bf16 a[24:27], a[152:155], v[112:115], a[24:27]
    ds_read_b64_tr_b16 a[164:165], v13 offset:24576
    v_mfma_f32_16x16x32_bf16 a[56:59], a[152:155], v[116:119], a[56:59]
    ds_read_b64_tr_b16 a[166:167], v13 offset:28672
    v_mfma_f32_16x16x32_bf16 a[88:91], a[152:155], v[120:123], a[88:91]
    ds_read_b64_tr_b16 a[168:169], v14 offset:24576
    v_mfma_f32_16x16x32_bf16 a[120:123], a[152:155], v[124:127], a[120:123]
    ds_read_b64_tr_b16 a[170:171], v14 offset:28672
    s_waitcnt lgkmcnt(6)
    v_mfma_f32_16x16x32_bf16 a[28:31], a[156:159], v[112:115], a[28:31]
    ds_read_b64_tr_b16 a[172:173], v15 offset:24576
    v_mfma_f32_16x16x32_bf16 a[60:63], a[156:159], v[116:119], a[60:63]
    ds_read_b64_tr_b16 a[174:175], v15 offset:28672
    v_mfma_f32_16x16x32_bf16 a[92:95], a[156:159], v[120:123], a[92:95]
    ds_read_b64_tr_b16 a[176:177], v16 offset:24576
    v_exp_f32 v163, v83
    s_nop 0
    v_cvt_pk_bf16_f32 v129, v162, v163
    v_exp_f32 v164, v88
    v_exp_f32 v165, v89
    s_nop 0
    v_cvt_pk_bf16_f32 v132, v164, v165
    v_exp_f32 v166, v90
    v_exp_f32 v167, v91
    s_nop 0
    v_cvt_pk_bf16_f32 v133, v166, v167
    v_exp_f32 v168, v84
    v_exp_f32 v169, v85
    s_nop 0
    v_cvt_pk_bf16_f32 v130, v168, v169
    v_exp_f32 v170, v86
    v_exp_f32 v171, v87
    s_nop 0
    v_cvt_pk_bf16_f32 v131, v170, v171
    v_mfma_f32_16x16x32_bf16 a[124:127], a[156:159], v[124:127], a[124:127]
    ds_read_b64_tr_b16 a[178:179], v16 offset:28672
    v_exp_f32 v160, v96
    v_exp_f32 v161, v97
    s_nop 0
    v_cvt_pk_bf16_f32 v136, v160, v161
    v_exp_f32 v162, v98
    v_exp_f32 v163, v99
    s_nop 0
    v_cvt_pk_bf16_f32 v137, v162, v163
    v_exp_f32 v164, v92
    v_exp_f32 v165, v93
    s_nop 0
    v_cvt_pk_bf16_f32 v134, v164, v165
    v_exp_f32 v166, v94
    v_exp_f32 v167, v95
    s_nop 0
    v_cvt_pk_bf16_f32 v135, v166, v167
    v_mfma_f32_16x16x32_bf16 v[40:43], v[172:175], v[128:131], v[40:43]
    ds_read_b64_tr_b16 a[180:181], v17 offset:24576
    v_exp_f32 v168, v104
    v_exp_f32 v169, v105
    s_nop 0
    v_cvt_pk_bf16_f32 v140, v168, v169
    v_exp_f32 v170, v106
    v_exp_f32 v171, v107
    s_nop 0
    v_cvt_pk_bf16_f32 v141, v170, v171
    v_exp_f32 v160, v100
    v_exp_f32 v161, v101
    s_nop 0
    v_cvt_pk_bf16_f32 v138, v160, v161
    v_exp_f32 v162, v102
    v_exp_f32 v163, v103
    s_nop 0
    v_cvt_pk_bf16_f32 v139, v162, v163
    v_mfma_f32_16x16x32_bf16 v[44:47], v[172:175], v[132:135], v[44:47]
    ds_read_b64_tr_b16 a[182:183], v17 offset:28672
    v_exp_f32 v164, v108
    v_exp_f32 v165, v109
    s_nop 0
    v_cvt_pk_bf16_f32 v142, v164, v165
    v_exp_f32 v166, v110
    v_exp_f32 v167, v111
    s_nop 0
    v_cvt_pk_bf16_f32 v143, v166, v167
    v_mfma_f32_16x16x32_bf16 v[240:243], v[172:175], v[136:139], v[240:243]
    ds_read_b64_tr_b16 a[184:185], v18 offset:24576
    v_mfma_f32_16x16x32_bf16 v[244:247], v[172:175], v[140:143], v[244:247]
    ds_read_b64_tr_b16 a[186:187], v18 offset:28672
    s_nop 4
    v_max3_f32 v39, v40, v44, v240
    s_nop 0
    v_max_f32 v39, v39, v244
    v_cmp_lt_f32 vcc, s54, v39
    s_cbranch_vccnz k4_kernel_stub163
k4_kernel_ret163:
    s_waitcnt lgkmcnt(10)
    v_mfma_f32_16x16x32_bf16 a[0:3], a[160:163], v[128:131], a[0:3]
    ds_read_b64_tr_b16 a[188:189], v19 offset:24576
    v_mov_b32 v144, v40
    v_mfma_f32_16x16x32_bf16 a[32:35], a[160:163], v[132:135], a[32:35]
    ds_read_b64_tr_b16 a[190:191], v19 offset:28672
    v_mov_b32 v145, v44
    v_mfma_f32_16x16x32_bf16 a[4:7], a[164:167], v[128:131], a[4:7]
    v_rcp_f32 v144, v144
    v_mfma_f32_16x16x32_bf16 a[36:39], a[164:167], v[132:135], a[36:39]
    v_mov_b32 v146, v240
    s_waitcnt lgkmcnt(8)
    v_mfma_f32_16x16x32_bf16 a[8:11], a[168:171], v[128:131], a[8:11]
    v_rcp_f32 v145, v145
    v_mfma_f32_16x16x32_bf16 a[40:43], a[168:171], v[132:135], a[40:43]
    v_rcp_f32 v146, v146
    v_mfma_f32_16x16x32_bf16 a[12:15], a[172:175], v[128:131], a[12:15]
    v_mov_b32 v147, v244
    v_accvgpr_read_b32 v160, a0
    v_mfma_f32_16x16x32_bf16 a[44:47], a[172:175], v[132:135], a[44:47]
    v_accvgpr_read_b32 v161, a1
    s_waitcnt lgkmcnt(4)
    v_mfma_f32_16x16x32_bf16 a[16:19], a[176:179], v[128:131], a[16:19]
    v_rcp_f32 v147, v147
    v_mfma_f32_16x16x32_bf16 a[48:51], a[176:179], v[132:135], a[48:51]
    v_accvgpr_read_b32 v162, a2
    v_accvgpr_read_b32 v163, a3
    v_mfma_f32_16x16x32_bf16 a[20:23], a[180:183], v[128:131], a[20:23]
    v_accvgpr_read_b32 v164, a4
    v_accvgpr_read_b32 v165, a5
    v_mfma_f32_16x16x32_bf16 a[52:55], a[180:183], v[132:135], a[52:55]
    v_accvgpr_read_b32 v166, a6
    s_waitcnt lgkmcnt(0)
    v_mfma_f32_16x16x32_bf16 a[24:27], a[184:187], v[128:131], a[24:27]
    v_accvgpr_read_b32 v167, a7
    v_mul_f32 v160, v160, v144
    v_mfma_f32_16x16x32_bf16 a[56:59], a[184:187], v[132:135], a[56:59]
    v_mul_f32 v161, v161, v144
    v_mul_f32 v162, v162, v144
    v_mfma_f32_16x16x32_bf16 a[28:31], a[188:191], v[128:131], a[28:31]
    v_mul_f32 v163, v163, v144
    v_mul_f32 v164, v164, v144
    v_mfma_f32_16x16x32_bf16 a[60:63], a[188:191], v[132:135], a[60:63]
    v_mul_f32 v165, v165, v144
    v_mul_f32 v166, v166, v144
    v_mfma_f32_16x16x32_bf16 a[64:67], a[160:163], v[136:139], a[64:67]
    v_mul_f32 v167, v167, v144
    v_cvt_pk_bf16_f32 v176, v160, v161
    v_mfma_f32_16x16x32_bf16 a[96:99], a[160:163], v[140:143], a[96:99]
    s_waitcnt vmcnt(8)
    s_barrier
    v_mfma_f32_16x16x32_bf16 a[68:71], a[164:167], v[136:139], a[68:71]
    ds_read_b64_tr_b16 a[128:129], v30 offset:32768
    v_cvt_pk_bf16_f32 v177, v162, v163
    v_mfma_f32_16x16x32_bf16 a[100:103], a[164:167], v[140:143], a[100:103]
    s_add_u32 m0, s47, 0
    ds_read_b64_tr_b16 a[130:131], v30 offset:34816
    v_mfma_f32_16x16x32_bf16 a[72:75], a[168:171], v[136:139], a[72:75]
    ds_read_b64_tr_b16 a[132:133], v31 offset:32768
    s_mov_b32 s50, 256
    v_mfma_f32_16x16x32_bf16 a[104:107], a[168:171], v[140:143], a[104:107]
    buffer_load_dwordx4 v26, s[20:23], s50 offen offset:0 lds
    ds_read_b64_tr_b16 a[134:135], v31 offset:34816
    v_mfma_f32_16x16x32_bf16 a[76:79], a[172:175], v[136:139], a[76:79]
    ds_read_b64_tr_b16 a[136:137], v32 offset:32768
    v_cvt_pk_bf16_f32 v178, v164, v165
    v_mfma_f32_16x16x32_bf16 a[108:111], a[172:175], v[140:143], a[108:111]
    ds_read_b64_tr_b16 a[138:139], v32 offset:34816
    v_cvt_pk_bf16_f32 v179, v166, v167
    v_mfma_f32_16x16x32_bf16 a[80:83], a[176:179], v[136:139], a[80:83]
    ds_read_b64_tr_b16 a[140:141], v33 offset:32768
    ds_read_b64_tr_b16 a[160:161], v30 offset:40960
    v_mfma_f32_16x16x32_bf16 a[112:115], a[176:179], v[140:143], a[112:115]
    buffer_load_dwordx4 v27, s[20:23], s50 offen offset:1024 lds
    ds_read_b64_tr_b16 a[142:143], v33 offset:34816
    ds_read_b64_tr_b16 a[162:163], v30 offset:43008
    v_mfma_f32_16x16x32_bf16 a[84:87], a[180:183], v[136:139], a[84:87]
    ds_read_b64_tr_b16 a[144:145], v30 offset:36864
    ds_read_b64_tr_b16 a[164:165], v31 offset:40960
    v_mfma_f32_16x16x32_bf16 a[116:119], a[180:183], v[140:143], a[116:119]
    ds_read_b64_tr_b16 a[146:147], v30 offset:38912
    ds_read_b64_tr_b16 a[166:167], v31 offset:43008
    v_mfma_f32_16x16x32_bf16 a[88:91], a[184:187], v[136:139], a[88:91]
    ds_read_b64_tr_b16 a[148:149], v31 offset:36864
    ds_read_b64_tr_b16 a[168:169], v32 offset:40960
    v_mfma_f32_16x16x32_bf16 a[120:123], a[184:187], v[140:143], a[120:123]
    buffer_load_dwordx4 v28, s[20:23], s50 offen offset:2048 lds
    ds_read_b64_tr_b16 a[150:151], v31 offset:38912
    ds_read_b64_tr_b16 a[170:171], v32 offset:43008
    v_mfma_f32_16x16x32_bf16 a[92:95], a[188:191], v[136:139], a[92:95]
    ds_read_b64_tr_b16 a[152:153], v32 offset:36864
    ds_read_b64_tr_b16 a[172:173], v33 offset:40960
    v_accvgpr_read_b32 v152, a32
    v_accvgpr_read_b32 v153, a33
    v_accvgpr_read_b32 v154, a34
    v_accvgpr_read_b32 v155, a35
    v_accvgpr_read_b32 v156, a36
    v_accvgpr_read_b32 v157, a37
    v_accvgpr_read_b32 v158, a38
    v_accvgpr_read_b32 v159, a39
    v_mul_f32 v152, v152, v145
    v_mul_f32 v153, v153, v145
    v_mul_f32 v154, v154, v145
    v_mul_f32 v155, v155, v145
    v_mul_f32 v156, v156, v145
    v_mul_f32 v157, v157, v145
    v_mul_f32 v158, v158, v145
    v_mul_f32 v159, v159, v145
    v_cvt_pk_bf16_f32 v192, v152, v153
    v_cvt_pk_bf16_f32 v193, v154, v155
    v_cvt_pk_bf16_f32 v194, v156, v157
    v_cvt_pk_bf16_f32 v195, v158, v159
    v_mfma_f32_16x16x32_bf16 a[124:127], a[188:191], v[140:143], a[124:127]
    ds_read_b64_tr_b16 a[154:155], v32 offset:38912
    ds_read_b64_tr_b16 a[174:175], v33 offset:43008
    s_waitcnt lgkmcnt(13)
    v_mfma_f32_16x16x32_bf16 v[48:51], a[128:131], v[176:179], 0
    ds_read_b64_tr_b16 a[156:157], v33 offset:36864
    ds_read_b64_tr_b16 a[176:177], v30 offset:45056
    v_mfma_f32_16x16x32_bf16 v[64:67], a[128:131], v[192:195], 0
    buffer_load_dwordx4 v29, s[20:23], s50 offen offset:3072 lds
    ds_read_b64_tr_b16 a[158:159], v33 offset:38912
    ds_read_b64_tr_b16 a[178:179], v30 offset:47104
    v_mfma_f32_16x16x32_bf16 v[52:55], a[132:135], v[176:179], 0
    ds_read_b64_tr_b16 a[180:181], v31 offset:45056
    v_accvgpr_read_b32 v160, a8
    v_mfma_f32_16x16x32_bf16 v[68:71], a[132:135], v[192:195], 0
    s_add_u32 m0, s47, 65536
    ds_read_b64_tr_b16 a[182:183], v31 offset:47104
    v_mfma_f32_16x16x32_bf16 v[56:59], a[136:139], v[176:179], 0
    ds_read_b64_tr_b16 a[184:185], v32 offset:45056
    s_mov_b32 s50, 147712
    v_mfma_f32_16x16x32_bf16 v[72:75], a[136:139], v[192:195], 0
    buffer_load_dwordx4 v26, s[20:23], s50 offen offset:0 lds
    ds_read_b64_tr_b16 a[186:187], v32 offset:47104
    v_mfma_f32_16x16x32_bf16 v[60:63], a[140:143], v[176:179], 0
    ds_read_b64_tr_b16 a[188:189], v33 offset:45056
    v_accvgpr_read_b32 v161, a9
    v_accvgpr_read_b32 v162, a10
    v_accvgpr_read_b32 v163, a11
    v_accvgpr_read_b32 v164, a12
    v_accvgpr_read_b32 v165, a13
    v_accvgpr_read_b32 v166, a14
    v_accvgpr_read_b32 v167, a15
    v_mul_f32 v160, v160, v144
    v_mul_f32 v161, v161, v144
    v_mul_f32 v162, v162, v144
    v_mul_f32 v163, v163, v144
    v_mul_f32 v164, v164, v144
    v_mul_f32 v165, v165, v144
    v_mul_f32 v166, v166, v144
    v_mul_f32 v167, v167, v144
    v_cvt_pk_bf16_f32 v180, v160, v161
    v_cvt_pk_bf16_f32 v181, v162, v163
    v_cvt_pk_bf16_f32 v182, v164, v165
    v_cvt_pk_bf16_f32 v183, v166, v167
    v_accvgpr_read_b32 v152, a40
    v_accvgpr_read_b32 v153, a41
    v_accvgpr_read_b32 v154, a42
    v_accvgpr_read_b32 v155, a43
    v_accvgpr_read_b32 v156, a44
    v_accvgpr_read_b32 v157, a45
    v_accvgpr_read_b32 v158, a46
    v_accvgpr_read_b32 v159, a47
    v_mul_f32 v152, v152, v145
    v_mul_f32 v153, v153, v145
    v_mul_f32 v154, v154, v145
    v_mul_f32 v155, v155, v145
    v_mul_f32 v156, v156, v145
    v_mul_f32 v157, v157, v145
    v_mul_f32 v158, v158, v145
    v_mul_f32 v159, v159, v145
    v_cvt_pk_bf16_f32 v196, v152, v153
    v_cvt_pk_bf16_f32 v197, v154, v155
    v_cvt_pk_bf16_f32 v198, v156, v157
    v_cvt_pk_bf16_f32 v199, v158, v159
    v_mfma_f32_16x16x32_bf16 v[76:79], a[140:143], v[192:195], 0
    ds_read_b64_tr_b16 a[190:191], v33 offset:47104
    s_waitcnt lgkmcnt(7)
    v_mfma_f32_16x16x32_bf16 v[48:51], a[144:147], v[180:183], v[48:51]
    ds_read_b64_tr_b16 a[128:129], v34 offset:32768
    ds_read_b64_tr_b16 a[130:131], v34 offset:34816
    v_mfma_f32_16x16x32_bf16 v[64:67], a[144:147], v[196:199], v[64:67]
    buffer_load_dwordx4 v27, s[20:23], s50 offen offset:1024 lds
    v_mfma_f32_16x16x32_bf16 v[52:55], a[148:151], v[180:183], v[52:55]
    ds_read_b64_tr_b16 a[132:133], v35 offset:32768
    v_accvgpr_read_b32 v160, a16
    v_mfma_f32_16x16x32_bf16 v[68:71], a[148:151], v[196:199], v[68:71]
    ds_read_b64_tr_b16 a[134:135], v35 offset:34816
    v_accvgpr_read_b32 v161, a17
    v_mfma_f32_16x16x32_bf16 v[56:59], a[152:155], v[180:183], v[56:59]
    ds_read_b64_tr_b16 a[136:137], v36 offset:32768
    ds_read_b64_tr_b16 a[138:139], v36 offset:34816
    v_mfma_f32_16x16x32_bf16 v[72:75], a[152:155], v[196:199], v[72:75]
    buffer_load_dwordx4 v28, s[20:23], s50 offen offset:2048 lds
    v_mfma_f32_16x16x32_bf16 v[60:63], a[156:159], v[180:183], v[60:63]
    ds_read_b64_tr_b16 a[140:141], v37 offset:32768
    v_accvgpr_read_b32 v162, a18
    v_accvgpr_read_b32 v163, a19
    v_accvgpr_read_b32 v164, a20
    v_accvgpr_read_b32 v165, a21
    v_accvgpr_read_b32 v166, a22
    v_accvgpr_read_b32 v167, a23
    v_mul_f32 v160, v160, v144
    v_mul_f32 v161, v161, v144
    v_mul_f32 v162, v162, v144
    v_mul_f32 v163, v163, v144
    v_mul_f32 v164, v164, v144
    v_mul_f32 v165, v165, v144
    v_mul_f32 v166, v166, v144
    v_mul_f32 v167, v167, v144
    v_cvt_pk_bf16_f32 v184, v160, v161
    v_cvt_pk_bf16_f32 v185, v162, v163
    v_cvt_pk_bf16_f32 v186, v164, v165
    v_cvt_pk_bf16_f32 v187, v166, v167
    v_accvgpr_read_b32 v152, a48
    v_accvgpr_read_b32 v153, a49
    v_accvgpr_read_b32 v154, a50
    v_accvgpr_read_b32 v155, a51
    v_accvgpr_read_b32 v156, a52
    v_accvgpr_read_b32 v157, a53
    v_accvgpr_read_b32 v158, a54
    v_accvgpr_read_b32 v159, a55
    v_mul_f32 v152, v152, v145
    v_mul_f32 v153, v153, v145
    v_mul_f32 v154, v154, v145
    v_mul_f32 v155, v155, v145
    v_mul_f32 v156, v156, v145
    v_mul_f32 v157, v157, v145
    v_mul_f32 v158, v158, v145
    v_mul_f32 v159, v159, v145
    v_cvt_pk_bf16_f32 v200, v152, v153
    v_cvt_pk_bf16_f32 v201, v154, v155
    v_cvt_pk_bf16_f32 v202, v156, v157
    v_cvt_pk_bf16_f32 v203, v158, v159
    v_mfma_f32_16x16x32_bf16 v[76:79], a[156:159], v[196:199], v[76:79]
    ds_read_b64_tr_b16 a[142:143], v37 offset:34816
    v_accvgpr_read_b32 v160, a24
    v_mfma_f32_16x16x32_bf16 v[48:51], a[160:163], v[184:187], v[48:51]
    ds_read_b64_tr_b16 a[144:145], v34 offset:36864
    ds_read_b64_tr_b16 a[146:147], v34 offset:38912
    v_mfma_f32_16x16x32_bf16 v[64:67], a[160:163], v[200:203], v[64:67]
    buffer_load_dwordx4 v29, s[20:23], s50 offen offset:3072 lds
    v_mfma_f32_16x16x32_bf16 v[52:55], a[164:167], v[184:187], v[52:55]
    ds_read_b64_tr_b16 a[148:149], v35 offset:36864
    v_accvgpr_read_b32 v161, a25
    v_mfma_f32_16x16x32_bf16 v[68:71], a[164:167], v[200:203], v[68:71]
    ds_read_b64_tr_b16 a[150:151], v35 offset:38912
    v_accvgpr_read_b32 v162, a26
    v_mfma_f32_16x16x32_bf16 v[56:59], a[168:171], v[184:187], v[56:59]
    ds_read_b64_tr_b16 a[152:153], v36 offset:36864
    v_accvgpr_read_b32 v163, a27
    v_mfma_f32_16x16x32_bf16 v[72:75], a[168:171], v[200:203], v[72:75]
    ds_read_b64_tr_b16 a[154:155], v36 offset:38912
    v_accvgpr_read_b32 v164, a28
    v_mfma_f32_16x16x32_bf16 v[60:63], a[172:175], v[184:187], v[60:63]
    ds_read_b64_tr_b16 a[156:157], v37 offset:36864
    v_accvgpr_read_b32 v165, a29
    v_accvgpr_read_b32 v166, a30
    v_accvgpr_read_b32 v167, a31
    v_mul_f32 v160, v160, v144
    v_mul_f32 v161, v161, v144
    v_mul_f32 v162, v162, v144
    v_mul_f32 v163, v163, v144
    v_mul_f32 v164, v164, v144
    v_mul_f32 v165, v165, v144
    v_mul_f32 v166, v166, v144
    v_mul_f32 v167, v167, v144
    v_cvt_pk_bf16_f32 v188, v160, v161
    v_cvt_pk_bf16_f32 v189, v162, v163
    v_cvt_pk_bf16_f32 v190, v164, v165
    v_cvt_pk_bf16_f32 v191, v166, v167
    v_accvgpr_read_b32 v152, a56
    v_accvgpr_read_b32 v153, a57
    v_accvgpr_read_b32 v154, a58
    v_accvgpr_read_b32 v155, a59
    v_accvgpr_read_b32 v156, a60
    v_accvgpr_read_b32 v157, a61
    v_accvgpr_read_b32 v158, a62
    v_accvgpr_read_b32 v159, a63
    v_mul_f32 v152, v152, v145
    v_mul_f32 v153, v153, v145
    v_mul_f32 v154, v154, v145
    v_mul_f32 v155, v155, v145
    v_mul_f32 v156, v156, v145
    v_mul_f32 v157, v157, v145
    v_mul_f32 v158, v158, v145
    v_mul_f32 v159, v159, v145
    v_cvt_pk_bf16_f32 v204, v152, v153
    v_cvt_pk_bf16_f32 v205, v154, v155
    v_cvt_pk_bf16_f32 v206, v156, v157
    v_cvt_pk_bf16_f32 v207, v158, v159
    v_mfma_f32_16x16x32_bf16 v[76:79], a[172:175], v[200:203], v[76:79]
    ds_read_b64_tr_b16 a[158:159], v37 offset:38912
    s_waitcnt lgkmcnt(15)
    v_mfma_f32_16x16x32_bf16 v[48:51], a[176:179], v[188:191], v[48:51]
    ds_read_b64_tr_b16 a[160:161], v34 offset:40960
    v_accvgpr_read_b32 v160, a64
    v_mfma_f32_16x16x32_bf16 v[64:67], a[176:179], v[204:207], v[64:67]
    ds_read_b64_tr_b16 a[162:163], v34 offset:43008
    v_accvgpr_read_b32 v161, a65
    v_mfma_f32_16x16x32_bf16 v[52:55], a[180:183], v[188:191], v[52:55]
    ds_read_b64_tr_b16 a[164:165], v35 offset:40960
    v_accvgpr_read_b32 v162, a66
    v_mfma_f32_16x16x32_bf16 v[68:71], a[180:183], v[204:207], v[68:71]
    ds_read_b64_tr_b16 a[166:167], v35 offset:43008
    v_accvgpr_read_b32 v163, a67
    v_mfma_f32_16x16x32_bf16 v[56:59], a[184:187], v[188:191], v[56:59]
    ds_read_b64_tr_b16 a[168:169], v36 offset:40960
    v_accvgpr_read_b32 v164, a68
    v_mfma_f32_16x16x32_bf16 v[72:75], a[184:187], v[204:207], v[72:75]
    ds_read_b64_tr_b16 a[170:171], v36 offset:43008
    v_accvgpr_read_b32 v165, a69
    v_mfma_f32_16x16x32_bf16 v[60:63], a[188:191], v[188:191], v[60:63]
    ds_read_b64_tr_b16 a[172:173], v37 offset:40960
    v_accvgpr_read_b32 v166, a70
    v_accvgpr_read_b32 v167, a71
    v_mul_f32 v160, v160, v146
    v_mul_f32 v161, v161, v146
    v_mul_f32 v162, v162, v146
    v_mul_f32 v163, v163, v146
    v_mul_f32 v164, v164, v146
    v_mul_f32 v165, v165, v146
    v_mul_f32 v166, v166, v146
    v_mul_f32 v167, v167, v146
    v_cvt_pk_bf16_f32 v208, v160, v161
    v_cvt_pk_bf16_f32 v209, v162, v163
    v_cvt_pk_bf16_f32 v210, v164, v165
    v_cvt_pk_bf16_f32 v211, v166, v167
    v_accvgpr_read_b32 v152, a96
    v_accvgpr_read_b32 v153, a97
    v_accvgpr_read_b32 v154, a98
    v_accvgpr_read_b32 v155, a99
    v_accvgpr_read_b32 v156, a100
    v_accvgpr_read_b32 v157, a101
    v_accvgpr_read_b32 v158, a102
    v_accvgpr_read_b32 v159, a103
    v_mul_f32 v152, v152, v147
    v_mul_f32 v153, v153, v147
    v_mul_f32 v154, v154, v147
    v_mul_f32 v155, v155, v147
    v_mul_f32 v156, v156, v147
    v_mul_f32 v157, v157, v147
    v_mul_f32 v158, v158, v147
    v_mul_f32 v159, v159, v147
    v_cvt_pk_bf16_f32 v224, v152, v153
    v_cvt_pk_bf16_f32 v225, v154, v155
    v_cvt_pk_bf16_f32 v226, v156, v157
    v_cvt_pk_bf16_f32 v227, v158, v159
    v_mfma_f32_16x16x32_bf16 v[76:79], a[188:191], v[204:207], v[76:79]
    ds_read_b64_tr_b16 a[174:175], v37 offset:43008
    s_waitcnt lgkmcnt(15)
    v_mfma_f32_16x16x32_bf16 v[48:51], a[128:131], v[208:211], v[48:51]
    ds_read_b64_tr_b16 a[176:177], v34 offset:45056
    v_accvgpr_read_b32 v160, a72
    v_mfma_f32_16x16x32_bf16 v[64:67], a[128:131], v[224:227], v[64:67]
    ds_read_b64_tr_b16 a[178:179], v34 offset:47104
    v_accvgpr_read_b32 v161, a73
    v_mfma_f32_16x16x32_bf16 v[52:55], a[132:135], v[208:211], v[52:55]
    ds_read_b64_tr_b16 a[180:181], v35 offset:45056
    v_accvgpr_read_b32 v162, a74
    v_mfma_f32_16x16x32_bf16 v[68:71], a[132:135], v[224:227], v[68:71]
    ds_read_b64_tr_b16 a[182:183], v35 offset:47104
    v_accvgpr_read_b32 v163, a75
    v_mfma_f32_16x16x32_bf16 v[56:59], a[136:139], v[208:211], v[56:59]
    ds_read_b64_tr_b16 a[184:185], v36 offset:45056
    v_accvgpr_read_b32 v164, a76
    v_mfma_f32_16x16x32_bf16 v[72:75], a[136:139], v[224:227], v[72:75]
    ds_read_b64_tr_b16 a[186:187], v36 offset:47104
    v_accvgpr_read_b32 v165, a77
    v_mfma_f32_16x16x32_bf16 v[60:63], a[140:143], v[208:211], v[60:63]
    ds_read_b64_tr_b16 a[188:189], v37 offset:45056
    v_accvgpr_read_b32 v166, a78
    v_accvgpr_read_b32 v167, a79
    v_mul_f32 v160, v160, v146
    v_mul_f32 v161, v161, v146
    v_mul_f32 v162, v162, v146
    v_mul_f32 v163, v163, v146
    v_mul_f32 v164, v164, v146
    v_mul_f32 v165, v165, v146
    v_mul_f32 v166, v166, v146
    v_mul_f32 v167, v167, v146
    v_cvt_pk_bf16_f32 v212, v160, v161
    v_cvt_pk_bf16_f32 v213, v162, v163
    v_cvt_pk_bf16_f32 v214, v164, v165
    v_cvt_pk_bf16_f32 v215, v166, v167
    v_accvgpr_read_b32 v152, a104
    v_accvgpr_read_b32 v153, a105
    v_accvgpr_read_b32 v154, a106
    v_accvgpr_read_b32 v155, a107
    v_accvgpr_read_b32 v156, a108
    v_accvgpr_read_b32 v157, a109
    v_accvgpr_read_b32 v158, a110
    v_accvgpr_read_b32 v159, a111
    v_mul_f32 v152, v152, v147
    v_mul_f32 v153, v153, v147
    v_mul_f32 v154, v154, v147
    v_mul_f32 v155, v155, v147
    v_mul_f32 v156, v156, v147
    v_mul_f32 v157, v157, v147
    v_mul_f32 v158, v158, v147
    v_mul_f32 v159, v159, v147
    v_cvt_pk_bf16_f32 v228, v152, v153
    v_cvt_pk_bf16_f32 v229, v154, v155
    v_cvt_pk_bf16_f32 v230, v156, v157
    v_cvt_pk_bf16_f32 v231, v158, v159
    v_mfma_f32_16x16x32_bf16 v[76:79], a[140:143], v[224:227], v[76:79]
    ds_read_b64_tr_b16 a[190:191], v37 offset:47104
    s_waitcnt vmcnt(8)
    s_barrier
    s_waitcnt lgkmcnt(15)
    v_mfma_f32_16x16x32_bf16 v[48:51], a[144:147], v[212:215], v[48:51]
    ds_read_b64_tr_b16 a[128:129], v30 offset:49152
    v_accvgpr_read_b32 v160, a80
    v_mfma_f32_16x16x32_bf16 v[64:67], a[144:147], v[228:231], v[64:67]
    s_add_u32 m0, s47, 16384
    ds_read_b64_tr_b16 a[130:131], v30 offset:51200
    v_mfma_f32_16x16x32_bf16 v[52:55], a[148:151], v[212:215], v[52:55]
    ds_read_b64_tr_b16 a[132:133], v31 offset:49152
    s_mov_b32 s50, 384
    v_mfma_f32_16x16x32_bf16 v[68:71], a[148:151], v[228:231], v[68:71]
    buffer_load_dwordx4 v26, s[20:23], s50 offen offset:0 lds
    ds_read_b64_tr_b16 a[134:135], v31 offset:51200
    v_mfma_f32_16x16x32_bf16 v[56:59], a[152:155], v[212:215], v[56:59]
    ds_read_b64_tr_b16 a[136:137], v32 offset:49152
    v_accvgpr_read_b32 v161, a81
    v_mfma_f32_16x16x32_bf16 v[72:75], a[152:155], v[228:231], v[72:75]
    ds_read_b64_tr_b16 a[138:139], v32 offset:51200
    v_accvgpr_read_b32 v162, a82
    v_mfma_f32_16x16x32_bf16 v[60:63], a[156:159], v[212:215], v[60:63]
    ds_read_b64_tr_b16 a[140:141], v33 offset:49152
    ds_read_b64_tr_b16 a[142:143], v33 offset:51200
    v_accvgpr_read_b32 v163, a83
    v_accvgpr_read_b32 v164, a84
    v_accvgpr_read_b32 v165, a85
    v_accvgpr_read_b32 v166, a86
    v_accvgpr_read_b32 v167, a87
    v_mul_f32 v160, v160, v146
    v_mul_f32 v161, v161, v146
    v_mul_f32 v162, v162, v146
    v_mul_f32 v163, v163, v146
    v_mul_f32 v164, v164, v146
    v_mul_f32 v165, v165, v146
    v_mul_f32 v166, v166, v146
    v_mul_f32 v167, v167, v146
    v_cvt_pk_bf16_f32 v216, v160, v161
    v_cvt_pk_bf16_f32 v217, v162, v163
    v_cvt_pk_bf16_f32 v218, v164, v165
    v_cvt_pk_bf16_f32 v219, v166, v167
    v_accvgpr_read_b32 v152, a112
    v_accvgpr_read_b32 v153, a113
    v_accvgpr_read_b32 v154, a114
    v_accvgpr_read_b32 v155, a115
    v_accvgpr_read_b32 v156, a116
    v_accvgpr_read_b32 v157, a117
    v_accvgpr_read_b32 v158, a118
    v_accvgpr_read_b32 v159, a119
    v_mul_f32 v152, v152, v147
    v_mul_f32 v153, v153, v147
    v_mul_f32 v154, v154, v147
    v_mul_f32 v155, v155, v147
    v_mul_f32 v156, v156, v147
    v_mul_f32 v157, v157, v147
    v_mul_f32 v158, v158, v147
    v_mul_f32 v159, v159, v147
    v_cvt_pk_bf16_f32 v232, v152, v153
    v_cvt_pk_bf16_f32 v233, v154, v155
    v_cvt_pk_bf16_f32 v234, v156, v157
    v_cvt_pk_bf16_f32 v235, v158, v159
    v_mfma_f32_16x16x32_bf16 v[76:79], a[156:159], v[228:231], v[76:79]
    buffer_load_dwordx4 v27, s[20:23], s50 offen offset:1024 lds
    s_waitcnt lgkmcnt(15)
    v_mfma_f32_16x16x32_bf16 v[48:51], a[160:163], v[216:219], v[48:51]
    ds_read_b64_tr_b16 a[144:145], v30 offset:53248
    v_accvgpr_read_b32 v160, a88
    v_mfma_f32_16x16x32_bf16 v[64:67], a[160:163], v[232:235], v[64:67]
    ds_read_b64_tr_b16 a[146:147], v30 offset:55296
    v_accvgpr_read_b32 v161, a89
    v_mfma_f32_16x16x32_bf16 v[52:55], a[164:167], v[216:219], v[52:55]
    ds_read_b64_tr_b16 a[148:149], v31 offset:53248
    ds_read_b64_tr_b16 a[150:151], v31 offset:55296
    v_mfma_f32_16x16x32_bf16 v[68:71], a[164:167], v[232:235], v[68:71]
    buffer_load_dwordx4 v28, s[20:23], s50 offen offset:2048 lds
    v_mfma_f32_16x16x32_bf16 v[56:59], a[168:171], v[216:219], v[56:59]
    ds_read_b64_tr_b16 a[152:153], v32 offset:53248
    v_accvgpr_read_b32 v162, a90
    v_mfma_f32_16x16x32_bf16 v[72:75], a[168:171], v[232:235], v[72:75]
    ds_read_b64_tr_b16 a[154:155], v32 offset:55296
    v_accvgpr_read_b32 v163, a91
    v_mfma_f32_16x16x32_bf16 v[60:63], a[172:175], v[216:219], v[60:63]
    ds_read_b64_tr_b16 a[156:157], v33 offset:53248
    ds_read_b64_tr_b16 a[158:159], v33 offset:55296
    v_accvgpr_read_b32 v164, a92
    v_accvgpr_read_b32 v165, a93
    v_accvgpr_read_b32 v166, a94
    v_accvgpr_read_b32 v167, a95
    v_mul_f32 v160, v160, v146
    v_mul_f32 v161, v161, v146
    v_mul_f32 v162, v162, v146
    v_mul_f32 v163, v163, v146
    v_mul_f32 v164, v164, v146
    v_mul_f32 v165, v165, v146
    v_mul_f32 v166, v166, v146
    v_mul_f32 v167, v167, v146
    v_cvt_pk_bf16_f32 v220, v160, v161
    v_cvt_pk_bf16_f32 v221, v162, v163
    v_cvt_pk_bf16_f32 v222, v164, v165
    v_cvt_pk_bf16_f32 v223, v166, v167
    v_accvgpr_read_b32 v152, a120
    v_accvgpr_read_b32 v153, a121
    v_accvgpr_read_b32 v154, a122
    v_accvgpr_read_b32 v155, a123
    v_accvgpr_read_b32 v156, a124
    v_accvgpr_read_b32 v157, a125
    v_accvgpr_read_b32 v158, a126
    v_accvgpr_read_b32 v159, a127
    v_mul_f32 v152, v152, v147
    v_mul_f32 v153, v153, v147
    v_mul_f32 v154, v154, v147
    v_mul_f32 v155, v155, v147
    v_mul_f32 v156, v156, v147
    v_mul_f32 v157, v157, v147
    v_mul_f32 v158, v158, v147
    v_mul_f32 v159, v159, v147
    v_cvt_pk_bf16_f32 v236, v152, v153
    v_cvt_pk_bf16_f32 v237, v154, v155
    v_cvt_pk_bf16_f32 v238, v156, v157
    v_cvt_pk_bf16_f32 v239, v158, v159
    v_mfma_f32_16x16x32_bf16 v[76:79], a[172:175], v[232:235], v[76:79]
    buffer_load_dwordx4 v29, s[20:23], s50 offen offset:3072 lds
    s_waitcnt lgkmcnt(15)
    v_mfma_f32_16x16x32_bf16 v[48:51], a[176:179], v[220:223], v[48:51]
    ds_read_b64_tr_b16 a[160:161], v30 offset:57344
    v_mfma_f32_16x16x32_bf16 v[64:67], a[176:179], v[236:239], v[64:67]
    s_add_u32 m0, s47, 81920
    ds_read_b64_tr_b16 a[162:163], v30 offset:59392
    v_mfma_f32_16x16x32_bf16 v[52:55], a[180:183], v[220:223], v[52:55]
    ds_read_b64_tr_b16 a[164:165], v31 offset:57344
    s_mov_b32 s50, 147840
    v_mfma_f32_16x16x32_bf16 v[68:71], a[180:183], v[236:239], v[68:71]
    buffer_load_dwordx4 v26, s[20:23], s50 offen offset:0 lds
    ds_read_b64_tr_b16 a[166:167], v31 offset:59392
    v_mfma_f32_16x16x32_bf16 v[56:59], a[184:187], v[220:223], v[56:59]
    ds_read_b64_tr_b16 a[168:169], v32 offset:57344
    v_mfma_f32_16x16x32_bf16 v[72:75], a[184:187], v[236:239], v[72:75]
    ds_read_b64_tr_b16 a[170:171], v32 offset:59392
    v_mfma_f32_16x16x32_bf16 v[60:63], a[188:191], v[220:223], v[60:63]
    ds_read_b64_tr_b16 a[172:173], v33 offset:57344
    ds_read_b64_tr_b16 a[174:175], v33 offset:59392
    v_mfma_f32_16x16x32_bf16 v[76:79], a[188:191], v[236:239], v[76:79]
    buffer_load_dwordx4 v27, s[20:23], s50 offen offset:1024 lds
    s_waitcnt lgkmcnt(15)
    v_mfma_f32_16x16x32_bf16 v[80:83], a[128:131], v[176:179], 0
    ds_read_b64_tr_b16 a[176:177], v30 offset:61440
    v_mfma_f32_16x16x32_bf16 v[96:99], a[128:131], v[192:195], 0
    ds_read_b64_tr_b16 a[178:179], v30 offset:63488
    v_mfma_f32_16x16x32_bf16 v[84:87], a[132:135], v[176:179], 0
    ds_read_b64_tr_b16 a[180:181], v31 offset:61440
    ds_read_b64_tr_b16 a[182:183], v31 offset:63488
    v_mfma_f32_16x16x32_bf16 v[100:103], a[132:135], v[192:195], 0
    buffer_load_dwordx4 v28, s[20:23], s50 offen offset:2048 lds
    v_mfma_f32_16x16x32_bf16 v[88:91], a[136:139], v[176:179], 0
    ds_read_b64_tr_b16 a[184:185], v32 offset:61440
    v_cvt_pk_bf16_f32 v112, v48, v49
    v_mfma_f32_16x16x32_bf16 v[104:107], a[136:139], v[192:195], 0
    ds_read_b64_tr_b16 a[186:187], v32 offset:63488
    v_cvt_pk_bf16_f32 v113, v50, v51
    v_mfma_f32_16x16x32_bf16 v[92:95], a[140:143], v[176:179], 0
    ds_read_b64_tr_b16 a[188:189], v33 offset:61440
    ds_read_b64_tr_b16 a[190:191], v33 offset:63488
    v_mfma_f32_16x16x32_bf16 v[108:111], a[140:143], v[192:195], 0
    buffer_load_dwordx4 v29, s[20:23], s50 offen offset:3072 lds
    s_waitcnt lgkmcnt(15)
    v_mfma_f32_16x16x32_bf16 v[80:83], a[144:147], v[180:183], v[80:83]
    ds_read_b64_tr_b16 a[128:129], v34 offset:49152
    v_cvt_pk_bf16_f32 v114, v52, v53
    v_mfma_f32_16x16x32_bf16 v[96:99], a[144:147], v[196:199], v[96:99]
    ds_read_b64_tr_b16 a[130:131], v34 offset:51200
    v_cvt_pk_bf16_f32 v115, v54, v55
    v_mfma_f32_16x16x32_bf16 v[84:87], a[148:151], v[180:183], v[84:87]
    ds_read_b64_tr_b16 a[132:133], v35 offset:49152
    v_cvt_pk_bf16_f32 v116, v56, v57
    v_mfma_f32_16x16x32_bf16 v[100:103], a[148:151], v[196:199], v[100:103]
    ds_read_b64_tr_b16 a[134:135], v35 offset:51200
    v_cvt_pk_bf16_f32 v117, v58, v59
    v_mfma_f32_16x16x32_bf16 v[88:91], a[152:155], v[180:183], v[88:91]
    ds_read_b64_tr_b16 a[136:137], v36 offset:49152
    v_cvt_pk_bf16_f32 v118, v60, v61
    v_mfma_f32_16x16x32_bf16 v[104:107], a[152:155], v[196:199], v[104:107]
    ds_read_b64_tr_b16 a[138:139], v36 offset:51200
    v_cvt_pk_bf16_f32 v119, v62, v63
    v_mfma_f32_16x16x32_bf16 v[92:95], a[156:159], v[180:183], v[92:95]
    ds_read_b64_tr_b16 a[140:141], v37 offset:49152
    v_cvt_pk_bf16_f32 v120, v64, v65
    v_mfma_f32_16x16x32_bf16 v[108:111], a[156:159], v[196:199], v[108:111]
    ds_read_b64_tr_b16 a[142:143], v37 offset:51200
    s_waitcnt lgkmcnt(15)
    v_mfma_f32_16x16x32_bf16 v[80:83], a[160:163], v[184:187], v[80:83]
    ds_read_b64_tr_b16 a[144:145], v34 offset:53248
    v_cvt_pk_bf16_f32 v121, v66, v67
    v_mfma_f32_16x16x32_bf16 v[96:99], a[160:163], v[200:203], v[96:99]
    ds_read_b64_tr_b16 a[146:147], v34 offset:55296
    v_cvt_pk_bf16_f32 v122, v68, v69
    v_mfma_f32_16x16x32_bf16 v[84:87], a[164:167], v[184:187], v[84:87]
    ds_read_b64_tr_b16 a[148:149], v35 offset:53248
    v_cvt_pk_bf16_f32 v123, v70, v71
    v_mfma_f32_16x16x32_bf16 v[100:103], a[164:167], v[200:203], v[100:103]
    ds_read_b64_tr_b16 a[150:151], v35 offset:55296
    v_cvt_pk_bf16_f32 v124, v72, v73
    v_mfma_f32_16x16x32_bf16 v[88:91], a[168:171], v[184:187], v[88:91]
    ds_read_b64_tr_b16 a[152:153], v36 offset:53248
    v_cvt_pk_bf16_f32 v125, v74, v75
    v_mfma_f32_16x16x32_bf16 v[104:107], a[168:171], v[200:203], v[104:107]
    ds_read_b64_tr_b16 a[154:155], v36 offset:55296
    v_cvt_pk_bf16_f32 v126, v76, v77
    v_mfma_f32_16x16x32_bf16 v[92:95], a[172:175], v[184:187], v[92:95]
    ds_read_b64_tr_b16 a[156:157], v37 offset:53248
    v_cvt_pk_bf16_f32 v127, v78, v79
    v_mfma_f32_16x16x32_bf16 v[108:111], a[172:175], v[200:203], v[108:111]
    s_mov_b32 s56, 0
    ds_read_b64_tr_b16 a[158:159], v37 offset:55296
    s_waitcnt lgkmcnt(15)
    v_mfma_f32_16x16x32_bf16 v[80:83], a[176:179], v[188:191], v[80:83]
    ds_read_b64_tr_b16 a[160:161], v34 offset:57344
    ds_read_b64_tr_b16 a[162:163], v34 offset:59392
    v_mfma_f32_16x16x32_bf16 v[96:99], a[176:179], v[204:207], v[96:99]
    buffer_store_dwordx4 v[112:115], v38, s[32:35], s56 offen offset:0 sc1
    v_mfma_f32_16x16x32_bf16 v[84:87], a[180:183], v[188:191], v[84:87]
    ds_read_b64_tr_b16 a[164:165], v35 offset:57344
    v_mfma_f32_16x16x32_bf16 v[100:103], a[180:183], v[204:207], v[100:103]
    ds_read_b64_tr_b16 a[166:167], v35 offset:59392
    v_mfma_f32_16x16x32_bf16 v[88:91], a[184:187], v[188:191], v[88:91]
    ds_read_b64_tr_b16 a[168:169], v36 offset:57344
    ds_read_b64_tr_b16 a[170:171], v36 offset:59392
    v_mfma_f32_16x16x32_bf16 v[104:107], a[184:187], v[204:207], v[104:107]
    buffer_store_dwordx4 v[116:119], v38, s[32:35], s56 offen offset:512 sc1
    v_mfma_f32_16x16x32_bf16 v[92:95], a[188:191], v[188:191], v[92:95]
    ds_read_b64_tr_b16 a[172:173], v37 offset:57344
    v_mfma_f32_16x16x32_bf16 v[108:111], a[188:191], v[204:207], v[108:111]
    s_mov_b32 s56, 18432
    ds_read_b64_tr_b16 a[174:175], v37 offset:59392
    s_waitcnt lgkmcnt(15)
    v_mfma_f32_16x16x32_bf16 v[80:83], a[128:131], v[208:211], v[80:83]
    ds_read_b64_tr_b16 a[176:177], v34 offset:61440
    ds_read_b64_tr_b16 a[178:179], v34 offset:63488
    v_mfma_f32_16x16x32_bf16 v[96:99], a[128:131], v[224:227], v[96:99]
    buffer_store_dwordx4 v[120:123], v38, s[32:35], s56 offen offset:0 sc1
    v_mfma_f32_16x16x32_bf16 v[84:87], a[132:135], v[208:211], v[84:87]
    ds_read_b64_tr_b16 a[180:181], v35 offset:61440
    v_mfma_f32_16x16x32_bf16 v[100:103], a[132:135], v[224:227], v[100:103]
    ds_read_b64_tr_b16 a[182:183], v35 offset:63488
    v_mfma_f32_16x16x32_bf16 v[88:91], a[136:139], v[208:211], v[88:91]
    ds_read_b64_tr_b16 a[184:185], v36 offset:61440
    ds_read_b64_tr_b16 a[186:187], v36 offset:63488
    v_mfma_f32_16x16x32_bf16 v[104:107], a[136:139], v[224:227], v[104:107]
    buffer_store_dwordx4 v[124:127], v38, s[32:35], s56 offen offset:512 sc1
    v_mfma_f32_16x16x32_bf16 v[92:95], a[140:143], v[208:211], v[92:95]
    ds_read_b64_tr_b16 a[188:189], v37 offset:61440
    v_mfma_f32_16x16x32_bf16 v[108:111], a[140:143], v[224:227], v[108:111]
    ds_read_b64_tr_b16 a[190:191], v37 offset:63488
    s_waitcnt vmcnt(12)
    s_barrier
    s_waitcnt lgkmcnt(15)
    v_mfma_f32_16x16x32_bf16 v[80:83], a[144:147], v[212:215], v[80:83]
    ds_read_b64_tr_b16 a[128:129], v30 offset:0
    v_mfma_f32_16x16x32_bf16 v[96:99], a[144:147], v[228:231], v[96:99]
    s_add_u32 m0, s47, 32768
    ds_read_b64_tr_b16 a[130:131], v30 offset:2048
    v_mfma_f32_16x16x32_bf16 v[84:87], a[148:151], v[212:215], v[84:87]
    ds_read_b64_tr_b16 a[132:133], v31 offset:0
    s_mov_b32 s50, 512
    v_mfma_f32_16x16x32_bf16 v[100:103], a[148:151], v[228:231], v[100:103]
    buffer_load_dwordx4 v26, s[20:23], s50 offen offset:0 lds
    ds_read_b64_tr_b16 a[134:135], v31 offset:2048
    v_mfma_f32_16x16x32_bf16 v[88:91], a[152:155], v[212:215], v[88:91]
    ds_read_b64_tr_b16 a[136:137], v32 offset:0
    v_mfma_f32_16x16x32_bf16 v[104:107], a[152:155], v[228:231], v[104:107]
    ds_read_b64_tr_b16 a[138:139], v32 offset:2048
    v_mfma_f32_16x16x32_bf16 v[92:95], a[156:159], v[212:215], v[92:95]
    ds_read_b64_tr_b16 a[140:141], v33 offset:0
    ds_read_b64_tr_b16 a[142:143], v33 offset:2048
    v_mfma_f32_16x16x32_bf16 v[108:111], a[156:159], v[228:231], v[108:111]
    buffer_load_dwordx4 v27, s[20:23], s50 offen offset:1024 lds
    s_waitcnt lgkmcnt(15)
    v_mfma_f32_16x16x32_bf16 v[80:83], a[160:163], v[216:219], v[80:83]
    ds_read_b64_tr_b16 a[144:145], v30 offset:4096
    v_mfma_f32_16x16x32_bf16 v[96:99], a[160:163], v[232:235], v[96:99]
    ds_read_b64_tr_b16 a[146:147], v30 offset:6144
    v_mfma_f32_16x16x32_bf16 v[84:87], a[164:167], v[216:219], v[84:87]
    ds_read_b64_tr_b16 a[148:149], v31 offset:4096
    ds_read_b64_tr_b16 a[150:151], v31 offset:6144
    v_mfma_f32_16x16x32_bf16 v[100:103], a[164:167], v[232:235], v[100:103]
    buffer_load_dwordx4 v28, s[20:23], s50 offen offset:2048 lds
    v_mfma_f32_16x16x32_bf16 v[88:91], a[168:171], v[216:219], v[88:91]
    ds_read_b64_tr_b16 a[152:153], v32 offset:4096
    v_mfma_f32_16x16x32_bf16 v[104:107], a[168:171], v[232:235], v[104:107]
    ds_read_b64_tr_b16 a[154:155], v32 offset:6144
    v_mfma_f32_16x16x32_bf16 v[92:95], a[172:175], v[216:219], v[92:95]
    ds_read_b64_tr_b16 a[156:157], v33 offset:4096
    ds_read_b64_tr_b16 a[158:159], v33 offset:6144
    v_mfma_f32_16x16x32_bf16 v[108:111], a[172:175], v[232:235], v[108:111]
    buffer_load_dwordx4 v29, s[20:23], s50 offen offset:3072 lds
    s_waitcnt lgkmcnt(15)
    v_mfma_f32_16x16x32_bf16 v[80:83], a[176:179], v[220:223], v[80:83]
    ds_read_b64_tr_b16 a[160:161], v30 offset:8192
    v_mfma_f32_16x16x32_bf16 v[96:99], a[176:179], v[236:239], v[96:99]
    s_add_u32 m0, s47, 98304
    ds_read_b64_tr_b16 a[162:163], v30 offset:10240
    v_mfma_f32_16x16x32_bf16 v[84:87], a[180:183], v[220:223], v[84:87]
    ds_read_b64_tr_b16 a[164:165], v31 offset:8192
    s_mov_b32 s50, 147968
    v_mfma_f32_16x16x32_bf16 v[100:103], a[180:183], v[236:239], v[100:103]
    buffer_load_dwordx4 v26, s[20:23], s50 offen offset:0 lds
    ds_read_b64_tr_b16 a[166:167], v31 offset:10240
    v_mfma_f32_16x16x32_bf16 v[88:91], a[184:187], v[220:223], v[88:91]
    ds_read_b64_tr_b16 a[168:169], v32 offset:8192
    v_mfma_f32_16x16x32_bf16 v[104:107], a[184:187], v[236:239], v[104:107]
    ds_read_b64_tr_b16 a[170:171], v32 offset:10240
    v_mfma_f32_16x16x32_bf16 v[92:95], a[188:191], v[220:223], v[92:95]
    ds_read_b64_tr_b16 a[172:173], v33 offset:8192
    ds_read_b64_tr_b16 a[174:175], v33 offset:10240
    v_mfma_f32_16x16x32_bf16 v[108:111], a[188:191], v[236:239], v[108:111]
    buffer_load_dwordx4 v27, s[20:23], s50 offen offset:1024 lds
    s_waitcnt lgkmcnt(15)
    v_mfma_f32_16x16x32_bf16 v[48:51], a[128:131], v[176:179], 0
    ds_read_b64_tr_b16 a[176:177], v30 offset:12288
    v_mfma_f32_16x16x32_bf16 v[64:67], a[128:131], v[192:195], 0
    ds_read_b64_tr_b16 a[178:179], v30 offset:14336
    v_mfma_f32_16x16x32_bf16 v[52:55], a[132:135], v[176:179], 0
    ds_read_b64_tr_b16 a[180:181], v31 offset:12288
    ds_read_b64_tr_b16 a[182:183], v31 offset:14336
    v_mfma_f32_16x16x32_bf16 v[68:71], a[132:135], v[192:195], 0
    buffer_load_dwordx4 v28, s[20:23], s50 offen offset:2048 lds
    v_mfma_f32_16x16x32_bf16 v[56:59], a[136:139], v[176:179], 0
    ds_read_b64_tr_b16 a[184:185], v32 offset:12288
    v_cvt_pk_bf16_f32 v128, v80, v81
    v_mfma_f32_16x16x32_bf16 v[72:75], a[136:139], v[192:195], 0
    ds_read_b64_tr_b16 a[186:187], v32 offset:14336
    v_cvt_pk_bf16_f32 v129, v82, v83
    v_mfma_f32_16x16x32_bf16 v[60:63], a[140:143], v[176:179], 0
    ds_read_b64_tr_b16 a[188:189], v33 offset:12288
    ds_read_b64_tr_b16 a[190:191], v33 offset:14336
    v_mfma_f32_16x16x32_bf16 v[76:79], a[140:143], v[192:195], 0
    buffer_load_dwordx4 v29, s[20:23], s50 offen offset:3072 lds
    s_waitcnt lgkmcnt(15)
    v_mfma_f32_16x16x32_bf16 v[48:51], a[144:147], v[180:183], v[48:51]
    ds_read_b64_tr_b16 a[128:129], v34 offset:0
    v_cvt_pk_bf16_f32 v130, v84, v85
    v_mfma_f32_16x16x32_bf16 v[64:67], a[144:147], v[196:199], v[64:67]
    ds_read_b64_tr_b16 a[130:131], v34 offset:2048
    v_cvt_pk_bf16_f32 v131, v86, v87
    v_mfma_f32_16x16x32_bf16 v[52:55], a[148:151], v[180:183], v[52:55]
    ds_read_b64_tr_b16 a[132:133], v35 offset:0
    v_cvt_pk_bf16_f32 v132, v88, v89
    v_mfma_f32_16x16x32_bf16 v[68:71], a[148:151], v[196:199], v[68:71]
    ds_read_b64_tr_b16 a[134:135], v35 offset:2048
    v_cvt_pk_bf16_f32 v133, v90, v91
    v_mfma_f32_16x16x32_bf16 v[56:59], a[152:155], v[180:183], v[56:59]
    ds_read_b64_tr_b16 a[136:137], v36 offset:0
    v_cvt_pk_bf16_f32 v134, v92, v93
    v_mfma_f32_16x16x32_bf16 v[72:75], a[152:155], v[196:199], v[72:75]
    ds_read_b64_tr_b16 a[138:139], v36 offset:2048
    v_cvt_pk_bf16_f32 v135, v94, v95
    v_mfma_f32_16x16x32_bf16 v[60:63], a[156:159], v[180:183], v[60:63]
    ds_read_b64_tr_b16 a[140:141], v37 offset:0
    v_cvt_pk_bf16_f32 v136, v96, v97
    v_mfma_f32_16x16x32_bf16 v[76:79], a[156:159], v[196:199], v[76:79]
    ds_read_b64_tr_b16 a[142:143], v37 offset:2048
    s_waitcnt lgkmcnt(15)
    v_mfma_f32_16x16x32_bf16 v[48:51], a[160:163], v[184:187], v[48:51]
    ds_read_b64_tr_b16 a[144:145], v34 offset:4096
    v_cvt_pk_bf16_f32 v137, v98, v99
    v_mfma_f32_16x16x32_bf16 v[64:67], a[160:163], v[200:203], v[64:67]
    ds_read_b64_tr_b16 a[146:147], v34 offset:6144
    v_cvt_pk_bf16_f32 v138, v100, v101
    v_mfma_f32_16x16x32_bf16 v[52:55], a[164:167], v[184:187], v[52:55]
    ds_read_b64_tr_b16 a[148:149], v35 offset:4096
    v_cvt_pk_bf16_f32 v139, v102, v103
    v_mfma_f32_16x16x32_bf16 v[68:71], a[164:167], v[200:203], v[68:71]
    ds_read_b64_tr_b16 a[150:151], v35 offset:6144
    v_cvt_pk_bf16_f32 v140, v104, v105
    v_mfma_f32_16x16x32_bf16 v[56:59], a[168:171], v[184:187], v[56:59]
    ds_read_b64_tr_b16 a[152:153], v36 offset:4096
    v_cvt_pk_bf16_f32 v141, v106, v107
    v_mfma_f32_16x16x32_bf16 v[72:75], a[168:171], v[200:203], v[72:75]
    ds_read_b64_tr_b16 a[154:155], v36 offset:6144
    v_cvt_pk_bf16_f32 v142, v108, v109
    v_mfma_f32_16x16x32_bf16 v[60:63], a[172:175], v[184:187], v[60:63]
    ds_read_b64_tr_b16 a[156:157], v37 offset:4096
    v_cvt_pk_bf16_f32 v143, v110, v111
    v_mfma_f32_16x16x32_bf16 v[76:79], a[172:175], v[200:203], v[76:79]
    s_mov_b32 s56, 1024
    ds_read_b64_tr_b16 a[158:159], v37 offset:6144
    s_waitcnt lgkmcnt(15)
    v_mfma_f32_16x16x32_bf16 v[48:51], a[176:179], v[188:191], v[48:51]
    ds_read_b64_tr_b16 a[160:161], v34 offset:8192
    ds_read_b64_tr_b16 a[162:163], v34 offset:10240
    v_mfma_f32_16x16x32_bf16 v[64:67], a[176:179], v[204:207], v[64:67]
    buffer_store_dwordx4 v[128:131], v38, s[32:35], s56 offen offset:0 sc1
    v_mfma_f32_16x16x32_bf16 v[52:55], a[180:183], v[188:191], v[52:55]
    ds_read_b64_tr_b16 a[164:165], v35 offset:8192
    v_mfma_f32_16x16x32_bf16 v[68:71], a[180:183], v[204:207], v[68:71]
    ds_read_b64_tr_b16 a[166:167], v35 offset:10240
    v_mfma_f32_16x16x32_bf16 v[56:59], a[184:187], v[188:191], v[56:59]
    ds_read_b64_tr_b16 a[168:169], v36 offset:8192
    ds_read_b64_tr_b16 a[170:171], v36 offset:10240
    v_mfma_f32_16x16x32_bf16 v[72:75], a[184:187], v[204:207], v[72:75]
    buffer_store_dwordx4 v[132:135], v38, s[32:35], s56 offen offset:512 sc1
    v_mfma_f32_16x16x32_bf16 v[60:63], a[188:191], v[188:191], v[60:63]
    ds_read_b64_tr_b16 a[172:173], v37 offset:8192
    v_mfma_f32_16x16x32_bf16 v[76:79], a[188:191], v[204:207], v[76:79]
    s_mov_b32 s56, 19456
    ds_read_b64_tr_b16 a[174:175], v37 offset:10240
    s_waitcnt lgkmcnt(15)
    v_mfma_f32_16x16x32_bf16 v[48:51], a[128:131], v[208:211], v[48:51]
    ds_read_b64_tr_b16 a[176:177], v34 offset:12288
    ds_read_b64_tr_b16 a[178:179], v34 offset:14336
    v_mfma_f32_16x16x32_bf16 v[64:67], a[128:131], v[224:227], v[64:67]
    buffer_store_dwordx4 v[136:139], v38, s[32:35], s56 offen offset:0 sc1
    v_mfma_f32_16x16x32_bf16 v[52:55], a[132:135], v[208:211], v[52:55]
    ds_read_b64_tr_b16 a[180:181], v35 offset:12288
    v_mfma_f32_16x16x32_bf16 v[68:71], a[132:135], v[224:227], v[68:71]
    ds_read_b64_tr_b16 a[182:183], v35 offset:14336
    v_mfma_f32_16x16x32_bf16 v[56:59], a[136:139], v[208:211], v[56:59]
    ds_read_b64_tr_b16 a[184:185], v36 offset:12288
    ds_read_b64_tr_b16 a[186:187], v36 offset:14336
    v_mfma_f32_16x16x32_bf16 v[72:75], a[136:139], v[224:227], v[72:75]
    buffer_store_dwordx4 v[140:143], v38, s[32:35], s56 offen offset:512 sc1
    v_mfma_f32_16x16x32_bf16 v[60:63], a[140:143], v[208:211], v[60:63]
    ds_read_b64_tr_b16 a[188:189], v37 offset:12288
    v_mfma_f32_16x16x32_bf16 v[76:79], a[140:143], v[224:227], v[76:79]
    ds_read_b64_tr_b16 a[190:191], v37 offset:14336
    s_waitcnt vmcnt(16)
    s_barrier
    s_waitcnt lgkmcnt(15)
    v_mfma_f32_16x16x32_bf16 v[48:51], a[144:147], v[212:215], v[48:51]
    ds_read_b64_tr_b16 a[128:129], v30 offset:16384
    v_mfma_f32_16x16x32_bf16 v[64:67], a[144:147], v[228:231], v[64:67]
    s_add_u32 m0, s47, 49152
    ds_read_b64_tr_b16 a[130:131], v30 offset:18432
    v_mfma_f32_16x16x32_bf16 v[52:55], a[148:151], v[212:215], v[52:55]
    ds_read_b64_tr_b16 a[132:133], v31 offset:16384
    s_mov_b32 s50, 640
    v_mfma_f32_16x16x32_bf16 v[68:71], a[148:151], v[228:231], v[68:71]
    buffer_load_dwordx4 v26, s[20:23], s50 offen offset:0 lds
    ds_read_b64_tr_b16 a[134:135], v31 offset:18432
    v_mfma_f32_16x16x32_bf16 v[56:59], a[152:155], v[212:215], v[56:59]
    ds_read_b64_tr_b16 a[136:137], v32 offset:16384
    v_mfma_f32_16x16x32_bf16 v[72:75], a[152:155], v[228:231], v[72:75]
    ds_read_b64_tr_b16 a[138:139], v32 offset:18432
    v_mfma_f32_16x16x32_bf16 v[60:63], a[156:159], v[212:215], v[60:63]
    ds_read_b64_tr_b16 a[140:141], v33 offset:16384
    ds_read_b64_tr_b16 a[142:143], v33 offset:18432
    v_mfma_f32_16x16x32_bf16 v[76:79], a[156:159], v[228:231], v[76:79]
    buffer_load_dwordx4 v27, s[20:23], s50 offen offset:1024 lds
    s_waitcnt lgkmcnt(15)
    v_mfma_f32_16x16x32_bf16 v[48:51], a[160:163], v[216:219], v[48:51]
    ds_read_b64_tr_b16 a[144:145], v30 offset:20480
    v_mfma_f32_16x16x32_bf16 v[64:67], a[160:163], v[232:235], v[64:67]
    ds_read_b64_tr_b16 a[146:147], v30 offset:22528
    v_mfma_f32_16x16x32_bf16 v[52:55], a[164:167], v[216:219], v[52:55]
    ds_read_b64_tr_b16 a[148:149], v31 offset:20480
    ds_read_b64_tr_b16 a[150:151], v31 offset:22528
    v_mfma_f32_16x16x32_bf16 v[68:71], a[164:167], v[232:235], v[68:71]
    buffer_load_dwordx4 v28, s[20:23], s50 offen offset:2048 lds
    v_mfma_f32_16x16x32_bf16 v[56:59], a[168:171], v[216:219], v[56:59]
    ds_read_b64_tr_b16 a[152:153], v32 offset:20480
    v_mfma_f32_16x16x32_bf16 v[72:75], a[168:171], v[232:235], v[72:75]
    ds_read_b64_tr_b16 a[154:155], v32 offset:22528
    v_mfma_f32_16x16x32_bf16 v[60:63], a[172:175], v[216:219], v[60:63]
    ds_read_b64_tr_b16 a[156:157], v33 offset:20480
    ds_read_b64_tr_b16 a[158:159], v33 offset:22528
    v_mfma_f32_16x16x32_bf16 v[76:79], a[172:175], v[232:235], v[76:79]
    buffer_load_dwordx4 v29, s[20:23], s50 offen offset:3072 lds
    s_waitcnt lgkmcnt(15)
    v_mfma_f32_16x16x32_bf16 v[48:51], a[176:179], v[220:223], v[48:51]
    ds_read_b64_tr_b16 a[160:161], v30 offset:24576
    v_mfma_f32_16x16x32_bf16 v[64:67], a[176:179], v[236:239], v[64:67]
    s_add_u32 m0, s47, 114688
    ds_read_b64_tr_b16 a[162:163], v30 offset:26624
    v_mfma_f32_16x16x32_bf16 v[52:55], a[180:183], v[220:223], v[52:55]
    ds_read_b64_tr_b16 a[164:165], v31 offset:24576
    s_mov_b32 s50, 148096
    v_mfma_f32_16x16x32_bf16 v[68:71], a[180:183], v[236:239], v[68:71]
    buffer_load_dwordx4 v26, s[20:23], s50 offen offset:0 lds
    ds_read_b64_tr_b16 a[166:167], v31 offset:26624
    v_mfma_f32_16x16x32_bf16 v[56:59], a[184:187], v[220:223], v[56:59]
    ds_read_b64_tr_b16 a[168:169], v32 offset:24576
    v_mfma_f32_16x16x32_bf16 v[72:75], a[184:187], v[236:239], v[72:75]
    ds_read_b64_tr_b16 a[170:171], v32 offset:26624
    v_mfma_f32_16x16x32_bf16 v[60:63], a[188:191], v[220:223], v[60:63]
    ds_read_b64_tr_b16 a[172:173], v33 offset:24576
    ds_read_b64_tr_b16 a[174:175], v33 offset:26624
    v_mfma_f32_16x16x32_bf16 v[76:79], a[188:191], v[236:239], v[76:79]
    buffer_load_dwordx4 v27, s[20:23], s50 offen offset:1024 lds
    s_waitcnt lgkmcnt(15)
    v_mfma_f32_16x16x32_bf16 v[80:83], a[128:131], v[176:179], 0
    ds_read_b64_tr_b16 a[176:177], v30 offset:28672
    v_mfma_f32_16x16x32_bf16 v[96:99], a[128:131], v[192:195], 0
    ds_read_b64_tr_b16 a[178:179], v30 offset:30720
    v_mfma_f32_16x16x32_bf16 v[84:87], a[132:135], v[176:179], 0
    ds_read_b64_tr_b16 a[180:181], v31 offset:28672
    ds_read_b64_tr_b16 a[182:183], v31 offset:30720
    v_mfma_f32_16x16x32_bf16 v[100:103], a[132:135], v[192:195], 0
    buffer_load_dwordx4 v28, s[20:23], s50 offen offset:2048 lds
    v_mfma_f32_16x16x32_bf16 v[88:91], a[136:139], v[176:179], 0
    ds_read_b64_tr_b16 a[184:185], v32 offset:28672
    v_cvt_pk_bf16_f32 v112, v48, v49
    v_mfma_f32_16x16x32_bf16 v[104:107], a[136:139], v[192:195], 0
    ds_read_b64_tr_b16 a[186:187], v32 offset:30720
    v_cvt_pk_bf16_f32 v113, v50, v51
    v_mfma_f32_16x16x32_bf16 v[92:95], a[140:143], v[176:179], 0
    ds_read_b64_tr_b16 a[188:189], v33 offset:28672
    ds_read_b64_tr_b16 a[190:191], v33 offset:30720
    v_mfma_f32_16x16x32_bf16 v[108:111], a[140:143], v[192:195], 0
    buffer_load_dwordx4 v29, s[20:23], s50 offen offset:3072 lds
    s_waitcnt lgkmcnt(15)
    v_mfma_f32_16x16x32_bf16 v[80:83], a[144:147], v[180:183], v[80:83]
    ds_read_b64_tr_b16 a[128:129], v34 offset:16384
    v_cvt_pk_bf16_f32 v114, v52, v53
    v_mfma_f32_16x16x32_bf16 v[96:99], a[144:147], v[196:199], v[96:99]
    ds_read_b64_tr_b16 a[130:131], v34 offset:18432
    v_cvt_pk_bf16_f32 v115, v54, v55
    v_mfma_f32_16x16x32_bf16 v[84:87], a[148:151], v[180:183], v[84:87]
    ds_read_b64_tr_b16 a[132:133], v35 offset:16384
    v_cvt_pk_bf16_f32 v116, v56, v57
    v_mfma_f32_16x16x32_bf16 v[100:103], a[148:151], v[196:199], v[100:103]
    ds_read_b64_tr_b16 a[134:135], v35 offset:18432
    v_cvt_pk_bf16_f32 v117, v58, v59
    v_mfma_f32_16x16x32_bf16 v[88:91], a[152:155], v[180:183], v[88:91]
    ds_read_b64_tr_b16 a[136:137], v36 offset:16384
    v_cvt_pk_bf16_f32 v118, v60, v61
    v_mfma_f32_16x16x32_bf16 v[104:107], a[152:155], v[196:199], v[104:107]
    ds_read_b64_tr_b16 a[138:139], v36 offset:18432
    v_cvt_pk_bf16_f32 v119, v62, v63
    v_mfma_f32_16x16x32_bf16 v[92:95], a[156:159], v[180:183], v[92:95]
    ds_read_b64_tr_b16 a[140:141], v37 offset:16384
    v_cvt_pk_bf16_f32 v120, v64, v65
    v_mfma_f32_16x16x32_bf16 v[108:111], a[156:159], v[196:199], v[108:111]
    ds_read_b64_tr_b16 a[142:143], v37 offset:18432
    s_waitcnt lgkmcnt(15)
    v_mfma_f32_16x16x32_bf16 v[80:83], a[160:163], v[184:187], v[80:83]
    ds_read_b64_tr_b16 a[144:145], v34 offset:20480
    v_cvt_pk_bf16_f32 v121, v66, v67
    v_mfma_f32_16x16x32_bf16 v[96:99], a[160:163], v[200:203], v[96:99]
    ds_read_b64_tr_b16 a[146:147], v34 offset:22528
    v_cvt_pk_bf16_f32 v122, v68, v69
    v_mfma_f32_16x16x32_bf16 v[84:87], a[164:167], v[184:187], v[84:87]
    ds_read_b64_tr_b16 a[148:149], v35 offset:20480
    v_cvt_pk_bf16_f32 v123, v70, v71
    v_mfma_f32_16x16x32_bf16 v[100:103], a[164:167], v[200:203], v[100:103]
    ds_read_b64_tr_b16 a[150:151], v35 offset:22528
    v_cvt_pk_bf16_f32 v124, v72, v73
    v_mfma_f32_16x16x32_bf16 v[88:91], a[168:171], v[184:187], v[88:91]
    ds_read_b64_tr_b16 a[152:153], v36 offset:20480
    v_cvt_pk_bf16_f32 v125, v74, v75
    v_mfma_f32_16x16x32_bf16 v[104:107], a[168:171], v[200:203], v[104:107]
    ds_read_b64_tr_b16 a[154:155], v36 offset:22528
    v_cvt_pk_bf16_f32 v126, v76, v77
    v_mfma_f32_16x16x32_bf16 v[92:95], a[172:175], v[184:187], v[92:95]
    ds_read_b64_tr_b16 a[156:157], v37 offset:20480
    v_cvt_pk_bf16_f32 v127, v78, v79
    v_mfma_f32_16x16x32_bf16 v[108:111], a[172:175], v[200:203], v[108:111]
    s_mov_b32 s56, 2048
    ds_read_b64_tr_b16 a[158:159], v37 offset:22528
    s_waitcnt lgkmcnt(15)
    v_mfma_f32_16x16x32_bf16 v[80:83], a[176:179], v[188:191], v[80:83]
    ds_read_b64_tr_b16 a[160:161], v34 offset:24576
    ds_read_b64_tr_b16 a[162:163], v34 offset:26624
    v_mfma_f32_16x16x32_bf16 v[96:99], a[176:179], v[204:207], v[96:99]
    buffer_store_dwordx4 v[112:115], v38, s[32:35], s56 offen offset:0 sc1
    v_mfma_f32_16x16x32_bf16 v[84:87], a[180:183], v[188:191], v[84:87]
    ds_read_b64_tr_b16 a[164:165], v35 offset:24576
    v_mfma_f32_16x16x32_bf16 v[100:103], a[180:183], v[204:207], v[100:103]
    ds_read_b64_tr_b16 a[166:167], v35 offset:26624
    v_mfma_f32_16x16x32_bf16 v[88:91], a[184:187], v[188:191], v[88:91]
    ds_read_b64_tr_b16 a[168:169], v36 offset:24576
    ds_read_b64_tr_b16 a[170:171], v36 offset:26624
    v_mfma_f32_16x16x32_bf16 v[104:107], a[184:187], v[204:207], v[104:107]
    buffer_store_dwordx4 v[116:119], v38, s[32:35], s56 offen offset:512 sc1
    v_mfma_f32_16x16x32_bf16 v[92:95], a[188:191], v[188:191], v[92:95]
    ds_read_b64_tr_b16 a[172:173], v37 offset:24576
    v_mfma_f32_16x16x32_bf16 v[108:111], a[188:191], v[204:207], v[108:111]
    s_mov_b32 s56, 20480
    ds_read_b64_tr_b16 a[174:175], v37 offset:26624
    s_waitcnt lgkmcnt(15)
    v_mfma_f32_16x16x32_bf16 v[80:83], a[128:131], v[208:211], v[80:83]
    ds_read_b64_tr_b16 a[176:177], v34 offset:28672
    ds_read_b64_tr_b16 a[178:179], v34 offset:30720
    v_mfma_f32_16x16x32_bf16 v[96:99], a[128:131], v[224:227], v[96:99]
    buffer_store_dwordx4 v[120:123], v38, s[32:35], s56 offen offset:0 sc1
    v_mfma_f32_16x16x32_bf16 v[84:87], a[132:135], v[208:211], v[84:87]
    ds_read_b64_tr_b16 a[180:181], v35 offset:28672
    v_mfma_f32_16x16x32_bf16 v[100:103], a[132:135], v[224:227], v[100:103]
    ds_read_b64_tr_b16 a[182:183], v35 offset:30720
    v_mfma_f32_16x16x32_bf16 v[88:91], a[136:139], v[208:211], v[88:91]
    ds_read_b64_tr_b16 a[184:185], v36 offset:28672
    ds_read_b64_tr_b16 a[186:187], v36 offset:30720
    v_mfma_f32_16x16x32_bf16 v[104:107], a[136:139], v[224:227], v[104:107]
    buffer_store_dwordx4 v[124:127], v38, s[32:35], s56 offen offset:512 sc1
    v_mfma_f32_16x16x32_bf16 v[92:95], a[140:143], v[208:211], v[92:95]
    ds_read_b64_tr_b16 a[188:189], v37 offset:28672
    v_mfma_f32_16x16x32_bf16 v[108:111], a[140:143], v[224:227], v[108:111]
    ds_read_b64_tr_b16 a[190:191], v37 offset:30720
    s_waitcnt vmcnt(16)
    s_barrier
    s_waitcnt lgkmcnt(15)
    v_mfma_f32_16x16x32_bf16 v[80:83], a[144:147], v[212:215], v[80:83]
    ds_read_b64_tr_b16 a[128:129], v30 offset:32768
    v_mfma_f32_16x16x32_bf16 v[96:99], a[144:147], v[228:231], v[96:99]
    s_add_u32 m0, s47, 0
    ds_read_b64_tr_b16 a[130:131], v30 offset:34816
    v_mfma_f32_16x16x32_bf16 v[84:87], a[148:151], v[212:215], v[84:87]
    ds_read_b64_tr_b16 a[132:133], v31 offset:32768
    s_mov_b32 s50, 768
    v_mfma_f32_16x16x32_bf16 v[100:103], a[148:151], v[228:231], v[100:103]
    buffer_load_dwordx4 v26, s[20:23], s50 offen offset:0 lds
    ds_read_b64_tr_b16 a[134:135], v31 offset:34816
    v_mfma_f32_16x16x32_bf16 v[88:91], a[152:155], v[212:215], v[88:91]
    ds_read_b64_tr_b16 a[136:137], v32 offset:32768
    v_mfma_f32_16x16x32_bf16 v[104:107], a[152:155], v[228:231], v[104:107]
    ds_read_b64_tr_b16 a[138:139], v32 offset:34816
    v_mfma_f32_16x16x32_bf16 v[92:95], a[156:159], v[212:215], v[92:95]
    ds_read_b64_tr_b16 a[140:141], v33 offset:32768
    ds_read_b64_tr_b16 a[142:143], v33 offset:34816
    v_mfma_f32_16x16x32_bf16 v[108:111], a[156:159], v[228:231], v[108:111]
    buffer_load_dwordx4 v27, s[20:23], s50 offen offset:1024 lds
    s_waitcnt lgkmcnt(15)
    v_mfma_f32_16x16x32_bf16 v[80:83], a[160:163], v[216:219], v[80:83]
    ds_read_b64_tr_b16 a[144:145], v30 offset:36864
    v_mfma_f32_16x16x32_bf16 v[96:99], a[160:163], v[232:235], v[96:99]
    ds_read_b64_tr_b16 a[146:147], v30 offset:38912
    v_mfma_f32_16x16x32_bf16 v[84:87], a[164:167], v[216:219], v[84:87]
    ds_read_b64_tr_b16 a[148:149], v31 offset:36864
    ds_read_b64_tr_b16 a[150:151], v31 offset:38912
    v_mfma_f32_16x16x32_bf16 v[100:103], a[164:167], v[232:235], v[100:103]
    buffer_load_dwordx4 v28, s[20:23], s50 offen offset:2048 lds
    v_mfma_f32_16x16x32_bf16 v[88:91], a[168:171], v[216:219], v[88:91]
    ds_read_b64_tr_b16 a[152:153], v32 offset:36864
    v_mfma_f32_16x16x32_bf16 v[104:107], a[168:171], v[232:235], v[104:107]
    ds_read_b64_tr_b16 a[154:155], v32 offset:38912
    v_mfma_f32_16x16x32_bf16 v[92:95], a[172:175], v[216:219], v[92:95]
    ds_read_b64_tr_b16 a[156:157], v33 offset:36864
    ds_read_b64_tr_b16 a[158:159], v33 offset:38912
    v_mfma_f32_16x16x32_bf16 v[108:111], a[172:175], v[232:235], v[108:111]
    buffer_load_dwordx4 v29, s[20:23], s50 offen offset:3072 lds
    s_waitcnt lgkmcnt(15)
    v_mfma_f32_16x16x32_bf16 v[80:83], a[176:179], v[220:223], v[80:83]
    ds_read_b64_tr_b16 a[160:161], v30 offset:40960
    v_mfma_f32_16x16x32_bf16 v[96:99], a[176:179], v[236:239], v[96:99]
    s_add_u32 m0, s47, 65536
    ds_read_b64_tr_b16 a[162:163], v30 offset:43008
    v_mfma_f32_16x16x32_bf16 v[84:87], a[180:183], v[220:223], v[84:87]
    ds_read_b64_tr_b16 a[164:165], v31 offset:40960
    s_mov_b32 s50, 148224
    v_mfma_f32_16x16x32_bf16 v[100:103], a[180:183], v[236:239], v[100:103]
    buffer_load_dwordx4 v26, s[20:23], s50 offen offset:0 lds
    ds_read_b64_tr_b16 a[166:167], v31 offset:43008
    v_mfma_f32_16x16x32_bf16 v[88:91], a[184:187], v[220:223], v[88:91]
    ds_read_b64_tr_b16 a[168:169], v32 offset:40960
    v_mfma_f32_16x16x32_bf16 v[104:107], a[184:187], v[236:239], v[104:107]
    ds_read_b64_tr_b16 a[170:171], v32 offset:43008
    v_mfma_f32_16x16x32_bf16 v[92:95], a[188:191], v[220:223], v[92:95]
    ds_read_b64_tr_b16 a[172:173], v33 offset:40960
    ds_read_b64_tr_b16 a[174:175], v33 offset:43008
    v_mfma_f32_16x16x32_bf16 v[108:111], a[188:191], v[236:239], v[108:111]
    buffer_load_dwordx4 v27, s[20:23], s50 offen offset:1024 lds
    s_waitcnt lgkmcnt(15)
    v_mfma_f32_16x16x32_bf16 v[48:51], a[128:131], v[176:179], 0
    ds_read_b64_tr_b16 a[176:177], v30 offset:45056
    v_mfma_f32_16x16x32_bf16 v[64:67], a[128:131], v[192:195], 0
    ds_read_b64_tr_b16 a[178:179], v30 offset:47104
    v_mfma_f32_16x16x32_bf16 v[52:55], a[132:135], v[176:179], 0
    ds_read_b64_tr_b16 a[180:181], v31 offset:45056
    ds_read_b64_tr_b16 a[182:183], v31 offset:47104
    v_mfma_f32_16x16x32_bf16 v[68:71], a[132:135], v[192:195], 0
    buffer_load_dwordx4 v28, s[20:23], s50 offen offset:2048 lds
    v_mfma_f32_16x16x32_bf16 v[56:59], a[136:139], v[176:179], 0
    ds_read_b64_tr_b16 a[184:185], v32 offset:45056
    v_cvt_pk_bf16_f32 v128, v80, v81
    v_mfma_f32_16x16x32_bf16 v[72:75], a[136:139], v[192:195], 0
    ds_read_b64_tr_b16 a[186:187], v32 offset:47104
    v_cvt_pk_bf16_f32 v129, v82, v83
    v_mfma_f32_16x16x32_bf16 v[60:63], a[140:143], v[176:179], 0
    ds_read_b64_tr_b16 a[188:189], v33 offset:45056
    ds_read_b64_tr_b16 a[190:191], v33 offset:47104
    v_mfma_f32_16x16x32_bf16 v[76:79], a[140:143], v[192:195], 0
    buffer_load_dwordx4 v29, s[20:23], s50 offen offset:3072 lds
    s_waitcnt lgkmcnt(15)
    v_mfma_f32_16x16x32_bf16 v[48:51], a[144:147], v[180:183], v[48:51]
    ds_read_b64_tr_b16 a[128:129], v34 offset:32768
    v_cvt_pk_bf16_f32 v130, v84, v85
    v_mfma_f32_16x16x32_bf16 v[64:67], a[144:147], v[196:199], v[64:67]
    ds_read_b64_tr_b16 a[130:131], v34 offset:34816
    v_cvt_pk_bf16_f32 v131, v86, v87
    v_mfma_f32_16x16x32_bf16 v[52:55], a[148:151], v[180:183], v[52:55]
    ds_read_b64_tr_b16 a[132:133], v35 offset:32768
    v_cvt_pk_bf16_f32 v132, v88, v89
    v_mfma_f32_16x16x32_bf16 v[68:71], a[148:151], v[196:199], v[68:71]
    ds_read_b64_tr_b16 a[134:135], v35 offset:34816
    v_cvt_pk_bf16_f32 v133, v90, v91
    v_mfma_f32_16x16x32_bf16 v[56:59], a[152:155], v[180:183], v[56:59]
    ds_read_b64_tr_b16 a[136:137], v36 offset:32768
    v_cvt_pk_bf16_f32 v134, v92, v93
    v_mfma_f32_16x16x32_bf16 v[72:75], a[152:155], v[196:199], v[72:75]
    ds_read_b64_tr_b16 a[138:139], v36 offset:34816
    v_cvt_pk_bf16_f32 v135, v94, v95
    v_mfma_f32_16x16x32_bf16 v[60:63], a[156:159], v[180:183], v[60:63]
    ds_read_b64_tr_b16 a[140:141], v37 offset:32768
    v_cvt_pk_bf16_f32 v136, v96, v97
    v_mfma_f32_16x16x32_bf16 v[76:79], a[156:159], v[196:199], v[76:79]
    ds_read_b64_tr_b16 a[142:143], v37 offset:34816
    s_waitcnt lgkmcnt(15)
    v_mfma_f32_16x16x32_bf16 v[48:51], a[160:163], v[184:187], v[48:51]
    ds_read_b64_tr_b16 a[144:145], v34 offset:36864
    v_cvt_pk_bf16_f32 v137, v98, v99
    v_mfma_f32_16x16x32_bf16 v[64:67], a[160:163], v[200:203], v[64:67]
    ds_read_b64_tr_b16 a[146:147], v34 offset:38912
    v_cvt_pk_bf16_f32 v138, v100, v101
    v_mfma_f32_16x16x32_bf16 v[52:55], a[164:167], v[184:187], v[52:55]
    ds_read_b64_tr_b16 a[148:149], v35 offset:36864
    v_cvt_pk_bf16_f32 v139, v102, v103
    v_mfma_f32_16x16x32_bf16 v[68:71], a[164:167], v[200:203], v[68:71]
    ds_read_b64_tr_b16 a[150:151], v35 offset:38912
    v_cvt_pk_bf16_f32 v140, v104, v105
    v_mfma_f32_16x16x32_bf16 v[56:59], a[168:171], v[184:187], v[56:59]
    ds_read_b64_tr_b16 a[152:153], v36 offset:36864
    v_cvt_pk_bf16_f32 v141, v106, v107
    v_mfma_f32_16x16x32_bf16 v[72:75], a[168:171], v[200:203], v[72:75]
    ds_read_b64_tr_b16 a[154:155], v36 offset:38912
    v_cvt_pk_bf16_f32 v142, v108, v109
    v_mfma_f32_16x16x32_bf16 v[60:63], a[172:175], v[184:187], v[60:63]
    ds_read_b64_tr_b16 a[156:157], v37 offset:36864
    v_cvt_pk_bf16_f32 v143, v110, v111
    v_mfma_f32_16x16x32_bf16 v[76:79], a[172:175], v[200:203], v[76:79]
    s_mov_b32 s56, 3072
    ds_read_b64_tr_b16 a[158:159], v37 offset:38912
    s_waitcnt lgkmcnt(15)
    v_mfma_f32_16x16x32_bf16 v[48:51], a[176:179], v[188:191], v[48:51]
    ds_read_b64_tr_b16 a[160:161], v34 offset:40960
    ds_read_b64_tr_b16 a[162:163], v34 offset:43008
    v_mfma_f32_16x16x32_bf16 v[64:67], a[176:179], v[204:207], v[64:67]
    buffer_store_dwordx4 v[128:131], v38, s[32:35], s56 offen offset:0 sc1
    v_mfma_f32_16x16x32_bf16 v[52:55], a[180:183], v[188:191], v[52:55]
    ds_read_b64_tr_b16 a[164:165], v35 offset:40960
    v_mfma_f32_16x16x32_bf16 v[68:71], a[180:183], v[204:207], v[68:71]
    ds_read_b64_tr_b16 a[166:167], v35 offset:43008
    v_mfma_f32_16x16x32_bf16 v[56:59], a[184:187], v[188:191], v[56:59]
    ds_read_b64_tr_b16 a[168:169], v36 offset:40960
    ds_read_b64_tr_b16 a[170:171], v36 offset:43008
    v_mfma_f32_16x16x32_bf16 v[72:75], a[184:187], v[204:207], v[72:75]
    buffer_store_dwordx4 v[132:135], v38, s[32:35], s56 offen offset:512 sc1
    v_mfma_f32_16x16x32_bf16 v[60:63], a[188:191], v[188:191], v[60:63]
    ds_read_b64_tr_b16 a[172:173], v37 offset:40960
    v_mfma_f32_16x16x32_bf16 v[76:79], a[188:191], v[204:207], v[76:79]
    s_mov_b32 s56, 21504
    ds_read_b64_tr_b16 a[174:175], v37 offset:43008
    s_waitcnt lgkmcnt(15)
    v_mfma_f32_16x16x32_bf16 v[48:51], a[128:131], v[208:211], v[48:51]
    ds_read_b64_tr_b16 a[176:177], v34 offset:45056
    ds_read_b64_tr_b16 a[178:179], v34 offset:47104
    v_mfma_f32_16x16x32_bf16 v[64:67], a[128:131], v[224:227], v[64:67]
    buffer_store_dwordx4 v[136:139], v38, s[32:35], s56 offen offset:0 sc1
    v_mfma_f32_16x16x32_bf16 v[52:55], a[132:135], v[208:211], v[52:55]
    ds_read_b64_tr_b16 a[180:181], v35 offset:45056
    v_mfma_f32_16x16x32_bf16 v[68:71], a[132:135], v[224:227], v[68:71]
    ds_read_b64_tr_b16 a[182:183], v35 offset:47104
    v_mfma_f32_16x16x32_bf16 v[56:59], a[136:139], v[208:211], v[56:59]
    ds_read_b64_tr_b16 a[184:185], v36 offset:45056
    ds_read_b64_tr_b16 a[186:187], v36 offset:47104
    v_mfma_f32_16x16x32_bf16 v[72:75], a[136:139], v[224:227], v[72:75]
    buffer_store_dwordx4 v[140:143], v38, s[32:35], s56 offen offset:512 sc1
    v_mfma_f32_16x16x32_bf16 v[60:63], a[140:143], v[208:211], v[60:63]
    ds_read_b64_tr_b16 a[188:189], v37 offset:45056
    v_mfma_f32_16x16x32_bf16 v[76:79], a[140:143], v[224:227], v[76:79]
    ds_read_b64_tr_b16 a[190:191], v37 offset:47104
    s_waitcnt vmcnt(16)
    s_barrier
    s_waitcnt lgkmcnt(15)
    v_mfma_f32_16x16x32_bf16 v[48:51], a[144:147], v[212:215], v[48:51]
    ds_read_b64_tr_b16 a[128:129], v30 offset:49152
    v_mfma_f32_16x16x32_bf16 v[64:67], a[144:147], v[228:231], v[64:67]
    s_add_u32 m0, s47, 16384
    ds_read_b64_tr_b16 a[130:131], v30 offset:51200
    v_mfma_f32_16x16x32_bf16 v[52:55], a[148:151], v[212:215], v[52:55]
    ds_read_b64_tr_b16 a[132:133], v31 offset:49152
    s_mov_b32 s50, 896
    v_mfma_f32_16x16x32_bf16 v[68:71], a[148:151], v[228:231], v[68:71]
    buffer_load_dwordx4 v26, s[20:23], s50 offen offset:0 lds
    ds_read_b64_tr_b16 a[134:135], v31 offset:51200
    v_mfma_f32_16x16x32_bf16 v[56:59], a[152:155], v[212:215], v[56:59]
    ds_read_b64_tr_b16 a[136:137], v32 offset:49152
    v_mfma_f32_16x16x32_bf16 v[72:75], a[152:155], v[228:231], v[72:75]
    ds_read_b64_tr_b16 a[138:139], v32 offset:51200
    v_mfma_f32_16x16x32_bf16 v[60:63], a[156:159], v[212:215], v[60:63]
    ds_read_b64_tr_b16 a[140:141], v33 offset:49152
    ds_read_b64_tr_b16 a[142:143], v33 offset:51200
    v_mfma_f32_16x16x32_bf16 v[76:79], a[156:159], v[228:231], v[76:79]
    buffer_load_dwordx4 v27, s[20:23], s50 offen offset:1024 lds
    s_waitcnt lgkmcnt(15)
    v_mfma_f32_16x16x32_bf16 v[48:51], a[160:163], v[216:219], v[48:51]
    ds_read_b64_tr_b16 a[144:145], v30 offset:53248
    v_mfma_f32_16x16x32_bf16 v[64:67], a[160:163], v[232:235], v[64:67]
    ds_read_b64_tr_b16 a[146:147], v30 offset:55296
    v_mfma_f32_16x16x32_bf16 v[52:55], a[164:167], v[216:219], v[52:55]
    ds_read_b64_tr_b16 a[148:149], v31 offset:53248
    ds_read_b64_tr_b16 a[150:151], v31 offset:55296
    v_mfma_f32_16x16x32_bf16 v[68:71], a[164:167], v[232:235], v[68:71]
    buffer_load_dwordx4 v28, s[20:23], s50 offen offset:2048 lds
    v_mfma_f32_16x16x32_bf16 v[56:59], a[168:171], v[216:219], v[56:59]
    ds_read_b64_tr_b16 a[152:153], v32 offset:53248
    v_mfma_f32_16x16x32_bf16 v[72:75], a[168:171], v[232:235], v[72:75]
    ds_read_b64_tr_b16 a[154:155], v32 offset:55296
    v_mfma_f32_16x16x32_bf16 v[60:63], a[172:175], v[216:219], v[60:63]
    ds_read_b64_tr_b16 a[156:157], v33 offset:53248
    ds_read_b64_tr_b16 a[158:159], v33 offset:55296
    v_mfma_f32_16x16x32_bf16 v[76:79], a[172:175], v[232:235], v[76:79]
    buffer_load_dwordx4 v29, s[20:23], s50 offen offset:3072 lds
    s_waitcnt lgkmcnt(15)
    v_mfma_f32_16x16x32_bf16 v[48:51], a[176:179], v[220:223], v[48:51]
    ds_read_b64_tr_b16 a[160:161], v30 offset:57344
    v_mfma_f32_16x16x32_bf16 v[64:67], a[176:179], v[236:239], v[64:67]
    s_add_u32 m0, s47, 81920
    ds_read_b64_tr_b16 a[162:163], v30 offset:59392
    v_mfma_f32_16x16x32_bf16 v[52:55], a[180:183], v[220:223], v[52:55]
    ds_read_b64_tr_b16 a[164:165], v31 offset:57344
    s_mov_b32 s50, 148352
    v_mfma_f32_16x16x32_bf16 v[68:71], a[180:183], v[236:239], v[68:71]
    buffer_load_dwordx4 v26, s[20:23], s50 offen offset:0 lds
    ds_read_b64_tr_b16 a[166:167], v31 offset:59392
    v_mfma_f32_16x16x32_bf16 v[56:59], a[184:187], v[220:223], v[56:59]
    ds_read_b64_tr_b16 a[168:169], v32 offset:57344
    v_mfma_f32_16x16x32_bf16 v[72:75], a[184:187], v[236:239], v[72:75]
    ds_read_b64_tr_b16 a[170:171], v32 offset:59392
    v_mfma_f32_16x16x32_bf16 v[60:63], a[188:191], v[220:223], v[60:63]
    ds_read_b64_tr_b16 a[172:173], v33 offset:57344
    ds_read_b64_tr_b16 a[174:175], v33 offset:59392
    v_mfma_f32_16x16x32_bf16 v[76:79], a[188:191], v[236:239], v[76:79]
    buffer_load_dwordx4 v27, s[20:23], s50 offen offset:1024 lds
    s_waitcnt lgkmcnt(15)
    v_mfma_f32_16x16x32_bf16 v[80:83], a[128:131], v[176:179], 0
    ds_read_b64_tr_b16 a[176:177], v30 offset:61440
    v_mfma_f32_16x16x32_bf16 v[96:99], a[128:131], v[192:195], 0
    ds_read_b64_tr_b16 a[178:179], v30 offset:63488
    v_mfma_f32_16x16x32_bf16 v[84:87], a[132:135], v[176:179], 0
    ds_read_b64_tr_b16 a[180:181], v31 offset:61440
    ds_read_b64_tr_b16 a[182:183], v31 offset:63488
    v_mfma_f32_16x16x32_bf16 v[100:103], a[132:135], v[192:195], 0
    buffer_load_dwordx4 v28, s[20:23], s50 offen offset:2048 lds
    v_mfma_f32_16x16x32_bf16 v[88:91], a[136:139], v[176:179], 0
    ds_read_b64_tr_b16 a[184:185], v32 offset:61440
    v_cvt_pk_bf16_f32 v112, v48, v49
    v_mfma_f32_16x16x32_bf16 v[104:107], a[136:139], v[192:195], 0
    ds_read_b64_tr_b16 a[186:187], v32 offset:63488
    v_cvt_pk_bf16_f32 v113, v50, v51
    v_mfma_f32_16x16x32_bf16 v[92:95], a[140:143], v[176:179], 0
    ds_read_b64_tr_b16 a[188:189], v33 offset:61440
    ds_read_b64_tr_b16 a[190:191], v33 offset:63488
    v_mfma_f32_16x16x32_bf16 v[108:111], a[140:143], v[192:195], 0
    buffer_load_dwordx4 v29, s[20:23], s50 offen offset:3072 lds
    s_waitcnt lgkmcnt(15)
    v_mfma_f32_16x16x32_bf16 v[80:83], a[144:147], v[180:183], v[80:83]
    ds_read_b64_tr_b16 a[128:129], v34 offset:49152
    v_cvt_pk_bf16_f32 v114, v52, v53
    v_mfma_f32_16x16x32_bf16 v[96:99], a[144:147], v[196:199], v[96:99]
    ds_read_b64_tr_b16 a[130:131], v34 offset:51200
    v_cvt_pk_bf16_f32 v115, v54, v55
    v_mfma_f32_16x16x32_bf16 v[84:87], a[148:151], v[180:183], v[84:87]
    ds_read_b64_tr_b16 a[132:133], v35 offset:49152
    v_cvt_pk_bf16_f32 v116, v56, v57
    v_mfma_f32_16x16x32_bf16 v[100:103], a[148:151], v[196:199], v[100:103]
    ds_read_b64_tr_b16 a[134:135], v35 offset:51200
    v_cvt_pk_bf16_f32 v117, v58, v59
    v_mfma_f32_16x16x32_bf16 v[88:91], a[152:155], v[180:183], v[88:91]
    ds_read_b64_tr_b16 a[136:137], v36 offset:49152
    v_cvt_pk_bf16_f32 v118, v60, v61
    v_mfma_f32_16x16x32_bf16 v[104:107], a[152:155], v[196:199], v[104:107]
    ds_read_b64_tr_b16 a[138:139], v36 offset:51200
    v_cvt_pk_bf16_f32 v119, v62, v63
    v_mfma_f32_16x16x32_bf16 v[92:95], a[156:159], v[180:183], v[92:95]
    ds_read_b64_tr_b16 a[140:141], v37 offset:49152
    v_cvt_pk_bf16_f32 v120, v64, v65
    v_mfma_f32_16x16x32_bf16 v[108:111], a[156:159], v[196:199], v[108:111]
    ds_read_b64_tr_b16 a[142:143], v37 offset:51200
    s_waitcnt lgkmcnt(15)
    v_mfma_f32_16x16x32_bf16 v[80:83], a[160:163], v[184:187], v[80:83]
    ds_read_b64_tr_b16 a[144:145], v34 offset:53248
    v_cvt_pk_bf16_f32 v121, v66, v67
    v_mfma_f32_16x16x32_bf16 v[96:99], a[160:163], v[200:203], v[96:99]
    ds_read_b64_tr_b16 a[146:147], v34 offset:55296
    v_cvt_pk_bf16_f32 v122, v68, v69
    v_mfma_f32_16x16x32_bf16 v[84:87], a[164:167], v[184:187], v[84:87]
    ds_read_b64_tr_b16 a[148:149], v35 offset:53248
    v_cvt_pk_bf16_f32 v123, v70, v71
    v_mfma_f32_16x16x32_bf16 v[100:103], a[164:167], v[200:203], v[100:103]
    ds_read_b64_tr_b16 a[150:151], v35 offset:55296
    v_cvt_pk_bf16_f32 v124, v72, v73
    v_mfma_f32_16x16x32_bf16 v[88:91], a[168:171], v[184:187], v[88:91]
    ds_read_b64_tr_b16 a[152:153], v36 offset:53248
    v_cvt_pk_bf16_f32 v125, v74, v75
    v_mfma_f32_16x16x32_bf16 v[104:107], a[168:171], v[200:203], v[104:107]
    ds_read_b64_tr_b16 a[154:155], v36 offset:55296
    v_cvt_pk_bf16_f32 v126, v76, v77
    v_mfma_f32_16x16x32_bf16 v[92:95], a[172:175], v[184:187], v[92:95]
    ds_read_b64_tr_b16 a[156:157], v37 offset:53248
    v_cvt_pk_bf16_f32 v127, v78, v79
    v_mfma_f32_16x16x32_bf16 v[108:111], a[172:175], v[200:203], v[108:111]
    s_mov_b32 s56, 4096
    ds_read_b64_tr_b16 a[158:159], v37 offset:55296
    s_waitcnt lgkmcnt(15)
    v_mfma_f32_16x16x32_bf16 v[80:83], a[176:179], v[188:191], v[80:83]
    ds_read_b64_tr_b16 a[160:161], v34 offset:57344
    ds_read_b64_tr_b16 a[162:163], v34 offset:59392
    v_mfma_f32_16x16x32_bf16 v[96:99], a[176:179], v[204:207], v[96:99]
    buffer_store_dwordx4 v[112:115], v38, s[32:35], s56 offen offset:0 sc1
    v_mfma_f32_16x16x32_bf16 v[84:87], a[180:183], v[188:191], v[84:87]
    ds_read_b64_tr_b16 a[164:165], v35 offset:57344
    v_mfma_f32_16x16x32_bf16 v[100:103], a[180:183], v[204:207], v[100:103]
    ds_read_b64_tr_b16 a[166:167], v35 offset:59392
    v_mfma_f32_16x16x32_bf16 v[88:91], a[184:187], v[188:191], v[88:91]
    ds_read_b64_tr_b16 a[168:169], v36 offset:57344
    ds_read_b64_tr_b16 a[170:171], v36 offset:59392
    v_mfma_f32_16x16x32_bf16 v[104:107], a[184:187], v[204:207], v[104:107]
    buffer_store_dwordx4 v[116:119], v38, s[32:35], s56 offen offset:512 sc1
    v_mfma_f32_16x16x32_bf16 v[92:95], a[188:191], v[188:191], v[92:95]
    ds_read_b64_tr_b16 a[172:173], v37 offset:57344
    v_mfma_f32_16x16x32_bf16 v[108:111], a[188:191], v[204:207], v[108:111]
    s_mov_b32 s56, 22528
    ds_read_b64_tr_b16 a[174:175], v37 offset:59392
    s_waitcnt lgkmcnt(15)
    v_mfma_f32_16x16x32_bf16 v[80:83], a[128:131], v[208:211], v[80:83]
    ds_read_b64_tr_b16 a[176:177], v34 offset:61440
    ds_read_b64_tr_b16 a[178:179], v34 offset:63488
    v_mfma_f32_16x16x32_bf16 v[96:99], a[128:131], v[224:227], v[96:99]
    buffer_store_dwordx4 v[120:123], v38, s[32:35], s56 offen offset:0 sc1
    v_mfma_f32_16x16x32_bf16 v[84:87], a[132:135], v[208:211], v[84:87]
    ds_read_b64_tr_b16 a[180:181], v35 offset:61440
    v_mfma_f32_16x16x32_bf16 v[100:103], a[132:135], v[224:227], v[100:103]
    ds_read_b64_tr_b16 a[182:183], v35 offset:63488
    v_mfma_f32_16x16x32_bf16 v[88:91], a[136:139], v[208:211], v[88:91]
    ds_read_b64_tr_b16 a[184:185], v36 offset:61440
    ds_read_b64_tr_b16 a[186:187], v36 offset:63488
    v_mfma_f32_16x16x32_bf16 v[104:107], a[136:139], v[224:227], v[104:107]
    buffer_store_dwordx4 v[124:127], v38, s[32:35], s56 offen offset:512 sc1
    v_mfma_f32_16x16x32_bf16 v[92:95], a[140:143], v[208:211], v[92:95]
    ds_read_b64_tr_b16 a[188:189], v37 offset:61440
    v_mfma_f32_16x16x32_bf16 v[108:111], a[140:143], v[224:227], v[108:111]
    ds_read_b64_tr_b16 a[190:191], v37 offset:63488
    s_waitcnt vmcnt(16)
    s_barrier
    s_waitcnt lgkmcnt(15)
    v_mfma_f32_16x16x32_bf16 v[80:83], a[144:147], v[212:215], v[80:83]
    ds_read_b64_tr_b16 a[128:129], v30 offset:0
    v_mfma_f32_16x16x32_bf16 v[96:99], a[144:147], v[228:231], v[96:99]
    s_add_u32 m0, s47, 32768
    ds_read_b64_tr_b16 a[130:131], v30 offset:2048
    v_mfma_f32_16x16x32_bf16 v[84:87], a[148:151], v[212:215], v[84:87]
    ds_read_b64_tr_b16 a[132:133], v31 offset:0
    s_mov_b32 s50, 1024
    v_mfma_f32_16x16x32_bf16 v[100:103], a[148:151], v[228:231], v[100:103]
    buffer_load_dwordx4 v26, s[20:23], s50 offen offset:0 lds
    ds_read_b64_tr_b16 a[134:135], v31 offset:2048
    v_mfma_f32_16x16x32_bf16 v[88:91], a[152:155], v[212:215], v[88:91]
    ds_read_b64_tr_b16 a[136:137], v32 offset:0
    v_mfma_f32_16x16x32_bf16 v[104:107], a[152:155], v[228:231], v[104:107]
    ds_read_b64_tr_b16 a[138:139], v32 offset:2048
    v_mfma_f32_16x16x32_bf16 v[92:95], a[156:159], v[212:215], v[92:95]
    ds_read_b64_tr_b16 a[140:141], v33 offset:0
    ds_read_b64_tr_b16 a[142:143], v33 offset:2048
    v_mfma_f32_16x16x32_bf16 v[108:111], a[156:159], v[228:231], v[108:111]
    buffer_load_dwordx4 v27, s[20:23], s50 offen offset:1024 lds
    s_waitcnt lgkmcnt(15)
    v_mfma_f32_16x16x32_bf16 v[80:83], a[160:163], v[216:219], v[80:83]
    ds_read_b64_tr_b16 a[144:145], v30 offset:4096
    v_mfma_f32_16x16x32_bf16 v[96:99], a[160:163], v[232:235], v[96:99]
    ds_read_b64_tr_b16 a[146:147], v30 offset:6144
    v_mfma_f32_16x16x32_bf16 v[84:87], a[164:167], v[216:219], v[84:87]
    ds_read_b64_tr_b16 a[148:149], v31 offset:4096
    ds_read_b64_tr_b16 a[150:151], v31 offset:6144
    v_mfma_f32_16x16x32_bf16 v[100:103], a[164:167], v[232:235], v[100:103]
    buffer_load_dwordx4 v28, s[20:23], s50 offen offset:2048 lds
    v_mfma_f32_16x16x32_bf16 v[88:91], a[168:171], v[216:219], v[88:91]
    ds_read_b64_tr_b16 a[152:153], v32 offset:4096
    v_mfma_f32_16x16x32_bf16 v[104:107], a[168:171], v[232:235], v[104:107]
    ds_read_b64_tr_b16 a[154:155], v32 offset:6144
    v_mfma_f32_16x16x32_bf16 v[92:95], a[172:175], v[216:219], v[92:95]
    ds_read_b64_tr_b16 a[156:157], v33 offset:4096
    ds_read_b64_tr_b16 a[158:159], v33 offset:6144
    v_mfma_f32_16x16x32_bf16 v[108:111], a[172:175], v[232:235], v[108:111]
    buffer_load_dwordx4 v29, s[20:23], s50 offen offset:3072 lds
    s_waitcnt lgkmcnt(15)
    v_mfma_f32_16x16x32_bf16 v[80:83], a[176:179], v[220:223], v[80:83]
    ds_read_b64_tr_b16 a[160:161], v30 offset:8192
    v_mfma_f32_16x16x32_bf16 v[96:99], a[176:179], v[236:239], v[96:99]
    s_add_u32 m0, s47, 98304
    ds_read_b64_tr_b16 a[162:163], v30 offset:10240
    v_mfma_f32_16x16x32_bf16 v[84:87], a[180:183], v[220:223], v[84:87]
    ds_read_b64_tr_b16 a[164:165], v31 offset:8192
    s_mov_b32 s50, 148480
    v_mfma_f32_16x16x32_bf16 v[100:103], a[180:183], v[236:239], v[100:103]
    buffer_load_dwordx4 v26, s[20:23], s50 offen offset:0 lds
    ds_read_b64_tr_b16 a[166:167], v31 offset:10240
    v_mfma_f32_16x16x32_bf16 v[88:91], a[184:187], v[220:223], v[88:91]
    ds_read_b64_tr_b16 a[168:169], v32 offset:8192
    v_mfma_f32_16x16x32_bf16 v[104:107], a[184:187], v[236:239], v[104:107]
    ds_read_b64_tr_b16 a[170:171], v32 offset:10240
    v_mfma_f32_16x16x32_bf16 v[92:95], a[188:191], v[220:223], v[92:95]
    ds_read_b64_tr_b16 a[172:173], v33 offset:8192
    ds_read_b64_tr_b16 a[174:175], v33 offset:10240
    v_mfma_f32_16x16x32_bf16 v[108:111], a[188:191], v[236:239], v[108:111]
    buffer_load_dwordx4 v27, s[20:23], s50 offen offset:1024 lds
    s_waitcnt lgkmcnt(15)
    v_mfma_f32_16x16x32_bf16 v[48:51], a[128:131], v[176:179], 0
    ds_read_b64_tr_b16 a[176:177], v30 offset:12288
    v_mfma_f32_16x16x32_bf16 v[64:67], a[128:131], v[192:195], 0
    ds_read_b64_tr_b16 a[178:179], v30 offset:14336
    v_mfma_f32_16x16x32_bf16 v[52:55], a[132:135], v[176:179], 0
    ds_read_b64_tr_b16 a[180:181], v31 offset:12288
    ds_read_b64_tr_b16 a[182:183], v31 offset:14336
    v_mfma_f32_16x16x32_bf16 v[68:71], a[132:135], v[192:195], 0
    buffer_load_dwordx4 v28, s[20:23], s50 offen offset:2048 lds
    v_mfma_f32_16x16x32_bf16 v[56:59], a[136:139], v[176:179], 0
    ds_read_b64_tr_b16 a[184:185], v32 offset:12288
    v_cvt_pk_bf16_f32 v128, v80, v81
    v_mfma_f32_16x16x32_bf16 v[72:75], a[136:139], v[192:195], 0
    ds_read_b64_tr_b16 a[186:187], v32 offset:14336
    v_cvt_pk_bf16_f32 v129, v82, v83
    v_mfma_f32_16x16x32_bf16 v[60:63], a[140:143], v[176:179], 0
    ds_read_b64_tr_b16 a[188:189], v33 offset:12288
    ds_read_b64_tr_b16 a[190:191], v33 offset:14336
    v_mfma_f32_16x16x32_bf16 v[76:79], a[140:143], v[192:195], 0
    buffer_load_dwordx4 v29, s[20:23], s50 offen offset:3072 lds
    s_waitcnt lgkmcnt(15)
    v_mfma_f32_16x16x32_bf16 v[48:51], a[144:147], v[180:183], v[48:51]
    ds_read_b64_tr_b16 a[128:129], v34 offset:0
    v_cvt_pk_bf16_f32 v130, v84, v85
    v_mfma_f32_16x16x32_bf16 v[64:67], a[144:147], v[196:199], v[64:67]
    ds_read_b64_tr_b16 a[130:131], v34 offset:2048
    v_cvt_pk_bf16_f32 v131, v86, v87
    v_mfma_f32_16x16x32_bf16 v[52:55], a[148:151], v[180:183], v[52:55]
    ds_read_b64_tr_b16 a[132:133], v35 offset:0
    v_cvt_pk_bf16_f32 v132, v88, v89
    v_mfma_f32_16x16x32_bf16 v[68:71], a[148:151], v[196:199], v[68:71]
    ds_read_b64_tr_b16 a[134:135], v35 offset:2048
    v_cvt_pk_bf16_f32 v133, v90, v91
    v_mfma_f32_16x16x32_bf16 v[56:59], a[152:155], v[180:183], v[56:59]
    ds_read_b64_tr_b16 a[136:137], v36 offset:0
    v_cvt_pk_bf16_f32 v134, v92, v93
    v_mfma_f32_16x16x32_bf16 v[72:75], a[152:155], v[196:199], v[72:75]
    ds_read_b64_tr_b16 a[138:139], v36 offset:2048
    v_cvt_pk_bf16_f32 v135, v94, v95
    v_mfma_f32_16x16x32_bf16 v[60:63], a[156:159], v[180:183], v[60:63]
    ds_read_b64_tr_b16 a[140:141], v37 offset:0
    v_cvt_pk_bf16_f32 v136, v96, v97
    v_mfma_f32_16x16x32_bf16 v[76:79], a[156:159], v[196:199], v[76:79]
    ds_read_b64_tr_b16 a[142:143], v37 offset:2048
    s_waitcnt lgkmcnt(15)
    v_mfma_f32_16x16x32_bf16 v[48:51], a[160:163], v[184:187], v[48:51]
    ds_read_b64_tr_b16 a[144:145], v34 offset:4096
    v_cvt_pk_bf16_f32 v137, v98, v99
    v_mfma_f32_16x16x32_bf16 v[64:67], a[160:163], v[200:203], v[64:67]
    ds_read_b64_tr_b16 a[146:147], v34 offset:6144
    v_cvt_pk_bf16_f32 v138, v100, v101
    v_mfma_f32_16x16x32_bf16 v[52:55], a[164:167], v[184:187], v[52:55]
    ds_read_b64_tr_b16 a[148:149], v35 offset:4096
    v_cvt_pk_bf16_f32 v139, v102, v103
    v_mfma_f32_16x16x32_bf16 v[68:71], a[164:167], v[200:203], v[68:71]
    ds_read_b64_tr_b16 a[150:151], v35 offset:6144
    v_cvt_pk_bf16_f32 v140, v104, v105
    v_mfma_f32_16x16x32_bf16 v[56:59], a[168:171], v[184:187], v[56:59]
    ds_read_b64_tr_b16 a[152:153], v36 offset:4096
    v_cvt_pk_bf16_f32 v141, v106, v107
    v_mfma_f32_16x16x32_bf16 v[72:75], a[168:171], v[200:203], v[72:75]
    ds_read_b64_tr_b16 a[154:155], v36 offset:6144
    v_cvt_pk_bf16_f32 v142, v108, v109
    v_mfma_f32_16x16x32_bf16 v[60:63], a[172:175], v[184:187], v[60:63]
    ds_read_b64_tr_b16 a[156:157], v37 offset:4096
    v_cvt_pk_bf16_f32 v143, v110, v111
    v_mfma_f32_16x16x32_bf16 v[76:79], a[172:175], v[200:203], v[76:79]
    s_mov_b32 s56, 5120
    ds_read_b64_tr_b16 a[158:159], v37 offset:6144
    s_waitcnt lgkmcnt(15)
    v_mfma_f32_16x16x32_bf16 v[48:51], a[176:179], v[188:191], v[48:51]
    ds_read_b64_tr_b16 a[160:161], v34 offset:8192
    ds_read_b64_tr_b16 a[162:163], v34 offset:10240
    v_mfma_f32_16x16x32_bf16 v[64:67], a[176:179], v[204:207], v[64:67]
    buffer_store_dwordx4 v[128:131], v38, s[32:35], s56 offen offset:0 sc1
    v_mfma_f32_16x16x32_bf16 v[52:55], a[180:183], v[188:191], v[52:55]
    ds_read_b64_tr_b16 a[164:165], v35 offset:8192
    v_mfma_f32_16x16x32_bf16 v[68:71], a[180:183], v[204:207], v[68:71]
    ds_read_b64_tr_b16 a[166:167], v35 offset:10240
    v_mfma_f32_16x16x32_bf16 v[56:59], a[184:187], v[188:191], v[56:59]
    ds_read_b64_tr_b16 a[168:169], v36 offset:8192
    ds_read_b64_tr_b16 a[170:171], v36 offset:10240
    v_mfma_f32_16x16x32_bf16 v[72:75], a[184:187], v[204:207], v[72:75]
    buffer_store_dwordx4 v[132:135], v38, s[32:35], s56 offen offset:512 sc1
    v_mfma_f32_16x16x32_bf16 v[60:63], a[188:191], v[188:191], v[60:63]
    ds_read_b64_tr_b16 a[172:173], v37 offset:8192
    v_mfma_f32_16x16x32_bf16 v[76:79], a[188:191], v[204:207], v[76:79]
    s_mov_b32 s56, 23552
    ds_read_b64_tr_b16 a[174:175], v37 offset:10240
    s_waitcnt lgkmcnt(15)
    v_mfma_f32_16x16x32_bf16 v[48:51], a[128:131], v[208:211], v[48:51]
    ds_read_b64_tr_b16 a[176:177], v34 offset:12288
    ds_read_b64_tr_b16 a[178:179], v34 offset:14336
    v_mfma_f32_16x16x32_bf16 v[64:67], a[128:131], v[224:227], v[64:67]
    buffer_store_dwordx4 v[136:139], v38, s[32:35], s56 offen offset:0 sc1
    v_mfma_f32_16x16x32_bf16 v[52:55], a[132:135], v[208:211], v[52:55]
    ds_read_b64_tr_b16 a[180:181], v35 offset:12288
    v_mfma_f32_16x16x32_bf16 v[68:71], a[132:135], v[224:227], v[68:71]
    ds_read_b64_tr_b16 a[182:183], v35 offset:14336
    v_mfma_f32_16x16x32_bf16 v[56:59], a[136:139], v[208:211], v[56:59]
    ds_read_b64_tr_b16 a[184:185], v36 offset:12288
    ds_read_b64_tr_b16 a[186:187], v36 offset:14336
    v_mfma_f32_16x16x32_bf16 v[72:75], a[136:139], v[224:227], v[72:75]
    buffer_store_dwordx4 v[140:143], v38, s[32:35], s56 offen offset:512 sc1
    v_mfma_f32_16x16x32_bf16 v[60:63], a[140:143], v[208:211], v[60:63]
    ds_read_b64_tr_b16 a[188:189], v37 offset:12288
    v_mfma_f32_16x16x32_bf16 v[76:79], a[140:143], v[224:227], v[76:79]
    ds_read_b64_tr_b16 a[190:191], v37 offset:14336
    s_waitcnt vmcnt(16)
    s_barrier
    s_waitcnt lgkmcnt(15)
    v_mfma_f32_16x16x32_bf16 v[48:51], a[144:147], v[212:215], v[48:51]
    ds_read_b64_tr_b16 a[128:129], v30 offset:16384
    v_mfma_f32_16x16x32_bf16 v[64:67], a[144:147], v[228:231], v[64:67]
    ds_read_b64_tr_b16 a[130:131], v30 offset:18432
    v_mfma_f32_16x16x32_bf16 v[52:55], a[148:151], v[212:215], v[52:55]
    ds_read_b64_tr_b16 a[132:133], v31 offset:16384
    v_mfma_f32_16x16x32_bf16 v[68:71], a[148:151], v[228:231], v[68:71]
    ds_read_b64_tr_b16 a[134:135], v31 offset:18432
    v_mfma_f32_16x16x32_bf16 v[56:59], a[152:155], v[212:215], v[56:59]
    ds_read_b64_tr_b16 a[136:137], v32 offset:16384
    v_mfma_f32_16x16x32_bf16 v[72:75], a[152:155], v[228:231], v[72:75]
    ds_read_b64_tr_b16 a[138:139], v32 offset:18432
    v_mfma_f32_16x16x32_bf16 v[60:63], a[156:159], v[212:215], v[60:63]
    ds_read_b64_tr_b16 a[140:141], v33 offset:16384
    v_mfma_f32_16x16x32_bf16 v[76:79], a[156:159], v[228:231], v[76:79]
    ds_read_b64_tr_b16 a[142:143], v33 offset:18432
    s_waitcnt lgkmcnt(15)
    v_mfma_f32_16x16x32_bf16 v[48:51], a[160:163], v[216:219], v[48:51]
    ds_read_b64_tr_b16 a[144:145], v30 offset:20480
    v_mfma_f32_16x16x32_bf16 v[64:67], a[160:163], v[232:235], v[64:67]
    ds_read_b64_tr_b16 a[146:147], v30 offset:22528
    v_mfma_f32_16x16x32_bf16 v[52:55], a[164:167], v[216:219], v[52:55]
    ds_read_b64_tr_b16 a[148:149], v31 offset:20480
    v_mfma_f32_16x16x32_bf16 v[68:71], a[164:167], v[232:235], v[68:71]
    ds_read_b64_tr_b16 a[150:151], v31 offset:22528
    v_mfma_f32_16x16x32_bf16 v[56:59], a[168:171], v[216:219], v[56:59]
    ds_read_b64_tr_b16 a[152:153], v32 offset:20480
    v_mfma_f32_16x16x32_bf16 v[72:75], a[168:171], v[232:235], v[72:75]
    ds_read_b64_tr_b16 a[154:155], v32 offset:22528
    v_mfma_f32_16x16x32_bf16 v[60:63], a[172:175], v[216:219], v[60:63]
    ds_read_b64_tr_b16 a[156:157], v33 offset:20480
    v_mfma_f32_16x16x32_bf16 v[76:79], a[172:175], v[232:235], v[76:79]
    ds_read_b64_tr_b16 a[158:159], v33 offset:22528
    s_waitcnt lgkmcnt(15)
    v_mfma_f32_16x16x32_bf16 v[48:51], a[176:179], v[220:223], v[48:51]
    ds_read_b64_tr_b16 a[160:161], v30 offset:24576
    v_mfma_f32_16x16x32_bf16 v[64:67], a[176:179], v[236:239], v[64:67]
    ds_read_b64_tr_b16 a[162:163], v30 offset:26624
    v_mfma_f32_16x16x32_bf16 v[52:55], a[180:183], v[220:223], v[52:55]
    ds_read_b64_tr_b16 a[164:165], v31 offset:24576
    v_mfma_f32_16x16x32_bf16 v[68:71], a[180:183], v[236:239], v[68:71]
    ds_read_b64_tr_b16 a[166:167], v31 offset:26624
    v_mfma_f32_16x16x32_bf16 v[56:59], a[184:187], v[220:223], v[56:59]
    ds_read_b64_tr_b16 a[168:169], v32 offset:24576
    v_mfma_f32_16x16x32_bf16 v[72:75], a[184:187], v[236:239], v[72:75]
    ds_read_b64_tr_b16 a[170:171], v32 offset:26624
    v_mfma_f32_16x16x32_bf16 v[60:63], a[188:191], v[220:223], v[60:63]
    ds_read_b64_tr_b16 a[172:173], v33 offset:24576
    v_mfma_f32_16x16x32_bf16 v[76:79], a[188:191], v[236:239], v[76:79]
    ds_read_b64_tr_b16 a[174:175], v33 offset:26624
    s_waitcnt lgkmcnt(15)
    v_mfma_f32_16x16x32_bf16 v[80:83], a[128:131], v[176:179], 0
    ds_read_b64_tr_b16 a[176:177], v30 offset:28672
    v_mfma_f32_16x16x32_bf16 v[96:99], a[128:131], v[192:195], 0
    ds_read_b64_tr_b16 a[178:179], v30 offset:30720
    v_mfma_f32_16x16x32_bf16 v[84:87], a[132:135], v[176:179], 0
    ds_read_b64_tr_b16 a[180:181], v31 offset:28672
    v_mfma_f32_16x16x32_bf16 v[100:103], a[132:135], v[192:195], 0
    ds_read_b64_tr_b16 a[182:183], v31 offset:30720
    v_cvt_pk_bf16_f32 v112, v48, v49
    v_mfma_f32_16x16x32_bf16 v[88:91], a[136:139], v[176:179], 0
    ds_read_b64_tr_b16 a[184:185], v32 offset:28672
    v_cvt_pk_bf16_f32 v113, v50, v51
    v_mfma_f32_16x16x32_bf16 v[104:107], a[136:139], v[192:195], 0
    ds_read_b64_tr_b16 a[186:187], v32 offset:30720
    v_cvt_pk_bf16_f32 v114, v52, v53
    v_mfma_f32_16x16x32_bf16 v[92:95], a[140:143], v[176:179], 0
    ds_read_b64_tr_b16 a[188:189], v33 offset:28672
    v_cvt_pk_bf16_f32 v115, v54, v55
    v_mfma_f32_16x16x32_bf16 v[108:111], a[140:143], v[192:195], 0
    ds_read_b64_tr_b16 a[190:191], v33 offset:30720
    s_waitcnt lgkmcnt(15)
    v_mfma_f32_16x16x32_bf16 v[80:83], a[144:147], v[180:183], v[80:83]
    ds_read_b64_tr_b16 a[128:129], v34 offset:16384
    v_cvt_pk_bf16_f32 v116, v56, v57
    v_mfma_f32_16x16x32_bf16 v[96:99], a[144:147], v[196:199], v[96:99]
    ds_read_b64_tr_b16 a[130:131], v34 offset:18432
    v_cvt_pk_bf16_f32 v117, v58, v59
    v_mfma_f32_16x16x32_bf16 v[84:87], a[148:151], v[180:183], v[84:87]
    ds_read_b64_tr_b16 a[132:133], v35 offset:16384
    v_cvt_pk_bf16_f32 v118, v60, v61
    v_mfma_f32_16x16x32_bf16 v[100:103], a[148:151], v[196:199], v[100:103]
    ds_read_b64_tr_b16 a[134:135], v35 offset:18432
    v_cvt_pk_bf16_f32 v119, v62, v63
    v_mfma_f32_16x16x32_bf16 v[88:91], a[152:155], v[180:183], v[88:91]
    ds_read_b64_tr_b16 a[136:137], v36 offset:16384
    v_cvt_pk_bf16_f32 v120, v64, v65
    v_mfma_f32_16x16x32_bf16 v[104:107], a[152:155], v[196:199], v[104:107]
    ds_read_b64_tr_b16 a[138:139], v36 offset:18432
    v_cvt_pk_bf16_f32 v121, v66, v67
    v_mfma_f32_16x16x32_bf16 v[92:95], a[156:159], v[180:183], v[92:95]
    ds_read_b64_tr_b16 a[140:141], v37 offset:16384
    v_cvt_pk_bf16_f32 v122, v68, v69
    v_mfma_f32_16x16x32_bf16 v[108:111], a[156:159], v[196:199], v[108:111]
    ds_read_b64_tr_b16 a[142:143], v37 offset:18432
    s_waitcnt lgkmcnt(15)
    v_mfma_f32_16x16x32_bf16 v[80:83], a[160:163], v[184:187], v[80:83]
    ds_read_b64_tr_b16 a[144:145], v34 offset:20480
    v_cvt_pk_bf16_f32 v123, v70, v71
    v_mfma_f32_16x16x32_bf16 v[96:99], a[160:163], v[200:203], v[96:99]
    ds_read_b64_tr_b16 a[146:147], v34 offset:22528
    v_cvt_pk_bf16_f32 v124, v72, v73
    v_mfma_f32_16x16x32_bf16 v[84:87], a[164:167], v[184:187], v[84:87]
    ds_read_b64_tr_b16 a[148:149], v35 offset:20480
    v_cvt_pk_bf16_f32 v125, v74, v75
    v_mfma_f32_16x16x32_bf16 v[100:103], a[164:167], v[200:203], v[100:103]
    ds_read_b64_tr_b16 a[150:151], v35 offset:22528
    v_cvt_pk_bf16_f32 v126, v76, v77
    v_mfma_f32_16x16x32_bf16 v[88:91], a[168:171], v[184:187], v[88:91]
    ds_read_b64_tr_b16 a[152:153], v36 offset:20480
    v_cvt_pk_bf16_f32 v127, v78, v79
    v_mfma_f32_16x16x32_bf16 v[104:107], a[168:171], v[200:203], v[104:107]
    ds_read_b64_tr_b16 a[154:155], v36 offset:22528
    v_mfma_f32_16x16x32_bf16 v[92:95], a[172:175], v[184:187], v[92:95]
    ds_read_b64_tr_b16 a[156:157], v37 offset:20480
    v_mfma_f32_16x16x32_bf16 v[108:111], a[172:175], v[200:203], v[108:111]
    s_mov_b32 s56, 6144
    ds_read_b64_tr_b16 a[158:159], v37 offset:22528
    s_waitcnt lgkmcnt(15)
    v_mfma_f32_16x16x32_bf16 v[80:83], a[176:179], v[188:191], v[80:83]
    ds_read_b64_tr_b16 a[160:161], v34 offset:24576
    ds_read_b64_tr_b16 a[162:163], v34 offset:26624
    v_mfma_f32_16x16x32_bf16 v[96:99], a[176:179], v[204:207], v[96:99]
    buffer_store_dwordx4 v[112:115], v38, s[32:35], s56 offen offset:0 sc1
    v_mfma_f32_16x16x32_bf16 v[84:87], a[180:183], v[188:191], v[84:87]
    ds_read_b64_tr_b16 a[164:165], v35 offset:24576
    v_mfma_f32_16x16x32_bf16 v[100:103], a[180:183], v[204:207], v[100:103]
    ds_read_b64_tr_b16 a[166:167], v35 offset:26624
    v_mfma_f32_16x16x32_bf16 v[88:91], a[184:187], v[188:191], v[88:91]
    ds_read_b64_tr_b16 a[168:169], v36 offset:24576
    ds_read_b64_tr_b16 a[170:171], v36 offset:26624
    v_mfma_f32_16x16x32_bf16 v[104:107], a[184:187], v[204:207], v[104:107]
    buffer_store_dwordx4 v[116:119], v38, s[32:35], s56 offen offset:512 sc1
    v_mfma_f32_16x16x32_bf16 v[92:95], a[188:191], v[188:191], v[92:95]
    ds_read_b64_tr_b16 a[172:173], v37 offset:24576
    v_mfma_f32_16x16x32_bf16 v[108:111], a[188:191], v[204:207], v[108:111]
    s_mov_b32 s56, 24576
    ds_read_b64_tr_b16 a[174:175], v37 offset:26624
    s_waitcnt lgkmcnt(15)
    v_mfma_f32_16x16x32_bf16 v[80:83], a[128:131], v[208:211], v[80:83]
    ds_read_b64_tr_b16 a[176:177], v34 offset:28672
    ds_read_b64_tr_b16 a[178:179], v34 offset:30720
    v_mfma_f32_16x16x32_bf16 v[96:99], a[128:131], v[224:227], v[96:99]
    buffer_store_dwordx4 v[120:123], v38, s[32:35], s56 offen offset:0 sc1
    v_mfma_f32_16x16x32_bf16 v[84:87], a[132:135], v[208:211], v[84:87]
    ds_read_b64_tr_b16 a[180:181], v35 offset:28672
    v_mfma_f32_16x16x32_bf16 v[100:103], a[132:135], v[224:227], v[100:103]
    ds_read_b64_tr_b16 a[182:183], v35 offset:30720
    v_mfma_f32_16x16x32_bf16 v[88:91], a[136:139], v[208:211], v[88:91]
    ds_read_b64_tr_b16 a[184:185], v36 offset:28672
    ds_read_b64_tr_b16 a[186:187], v36 offset:30720
    v_mfma_f32_16x16x32_bf16 v[104:107], a[136:139], v[224:227], v[104:107]
    buffer_store_dwordx4 v[124:127], v38, s[32:35], s56 offen offset:512 sc1
    v_mfma_f32_16x16x32_bf16 v[92:95], a[140:143], v[208:211], v[92:95]
    ds_read_b64_tr_b16 a[188:189], v37 offset:28672
    v_mfma_f32_16x16x32_bf16 v[108:111], a[140:143], v[224:227], v[108:111]
    ds_read_b64_tr_b16 a[190:191], v37 offset:30720
    s_waitcnt vmcnt(8)
    s_barrier
    s_waitcnt lgkmcnt(15)
    v_mfma_f32_16x16x32_bf16 v[80:83], a[144:147], v[212:215], v[80:83]
    ds_read_b64_tr_b16 a[128:129], v30 offset:32768
    v_mfma_f32_16x16x32_bf16 v[96:99], a[144:147], v[228:231], v[96:99]
    ds_read_b64_tr_b16 a[130:131], v30 offset:34816
    v_mfma_f32_16x16x32_bf16 v[84:87], a[148:151], v[212:215], v[84:87]
    ds_read_b64_tr_b16 a[132:133], v31 offset:32768
    v_mfma_f32_16x16x32_bf16 v[100:103], a[148:151], v[228:231], v[100:103]
    ds_read_b64_tr_b16 a[134:135], v31 offset:34816
    v_mfma_f32_16x16x32_bf16 v[88:91], a[152:155], v[212:215], v[88:91]
    ds_read_b64_tr_b16 a[136:137], v32 offset:32768
    v_mfma_f32_16x16x32_bf16 v[104:107], a[152:155], v[228:231], v[104:107]
    ds_read_b64_tr_b16 a[138:139], v32 offset:34816
    v_mfma_f32_16x16x32_bf16 v[92:95], a[156:159], v[212:215], v[92:95]
    ds_read_b64_tr_b16 a[140:141], v33 offset:32768
    v_mfma_f32_16x16x32_bf16 v[108:111], a[156:159], v[228:231], v[108:111]
    ds_read_b64_tr_b16 a[142:143], v33 offset:34816
    s_waitcnt lgkmcnt(15)
    v_mfma_f32_16x16x32_bf16 v[80:83], a[160:163], v[216:219], v[80:83]
    ds_read_b64_tr_b16 a[144:145], v30 offset:36864
    v_mfma_f32_16x16x32_bf16 v[96:99], a[160:163], v[232:235], v[96:99]
    ds_read_b64_tr_b16 a[146:147], v30 offset:38912
    v_mfma_f32_16x16x32_bf16 v[84:87], a[164:167], v[216:219], v[84:87]
    ds_read_b64_tr_b16 a[148:149], v31 offset:36864
    v_mfma_f32_16x16x32_bf16 v[100:103], a[164:167], v[232:235], v[100:103]
    ds_read_b64_tr_b16 a[150:151], v31 offset:38912
    v_mfma_f32_16x16x32_bf16 v[88:91], a[168:171], v[216:219], v[88:91]
    ds_read_b64_tr_b16 a[152:153], v32 offset:36864
    v_mfma_f32_16x16x32_bf16 v[104:107], a[168:171], v[232:235], v[104:107]
    ds_read_b64_tr_b16 a[154:155], v32 offset:38912
    v_mfma_f32_16x16x32_bf16 v[92:95], a[172:175], v[216:219], v[92:95]
    ds_read_b64_tr_b16 a[156:157], v33 offset:36864
    v_mfma_f32_16x16x32_bf16 v[108:111], a[172:175], v[232:235], v[108:111]
    ds_read_b64_tr_b16 a[158:159], v33 offset:38912
    s_waitcnt lgkmcnt(15)
    v_mfma_f32_16x16x32_bf16 v[80:83], a[176:179], v[220:223], v[80:83]
    ds_read_b64_tr_b16 a[160:161], v30 offset:40960
    v_mfma_f32_16x16x32_bf16 v[96:99], a[176:179], v[236:239], v[96:99]
    ds_read_b64_tr_b16 a[162:163], v30 offset:43008
    v_mfma_f32_16x16x32_bf16 v[84:87], a[180:183], v[220:223], v[84:87]
    ds_read_b64_tr_b16 a[164:165], v31 offset:40960
    v_mfma_f32_16x16x32_bf16 v[100:103], a[180:183], v[236:239], v[100:103]
    ds_read_b64_tr_b16 a[166:167], v31 offset:43008
    v_mfma_f32_16x16x32_bf16 v[88:91], a[184:187], v[220:223], v[88:91]
    ds_read_b64_tr_b16 a[168:169], v32 offset:40960
    v_mfma_f32_16x16x32_bf16 v[104:107], a[184:187], v[236:239], v[104:107]
    ds_read_b64_tr_b16 a[170:171], v32 offset:43008
    v_mfma_f32_16x16x32_bf16 v[92:95], a[188:191], v[220:223], v[92:95]
    ds_read_b64_tr_b16 a[172:173], v33 offset:40960
    v_mfma_f32_16x16x32_bf16 v[108:111], a[188:191], v[236:239], v[108:111]
    ds_read_b64_tr_b16 a[174:175], v33 offset:43008
    s_waitcnt lgkmcnt(15)
    v_mfma_f32_16x16x32_bf16 v[48:51], a[128:131], v[176:179], 0
    ds_read_b64_tr_b16 a[176:177], v30 offset:45056
    v_mfma_f32_16x16x32_bf16 v[64:67], a[128:131], v[192:195], 0
    ds_read_b64_tr_b16 a[178:179], v30 offset:47104
    v_mfma_f32_16x16x32_bf16 v[52:55], a[132:135], v[176:179], 0
    ds_read_b64_tr_b16 a[180:181], v31 offset:45056
    v_mfma_f32_16x16x32_bf16 v[68:71], a[132:135], v[192:195], 0
    ds_read_b64_tr_b16 a[182:183], v31 offset:47104
    v_cvt_pk_bf16_f32 v128, v80, v81
    v_mfma_f32_16x16x32_bf16 v[56:59], a[136:139], v[176:179], 0
    ds_read_b64_tr_b16 a[184:185], v32 offset:45056
    v_cvt_pk_bf16_f32 v129, v82, v83
    v_mfma_f32_16x16x32_bf16 v[72:75], a[136:139], v[192:195], 0
    ds_read_b64_tr_b16 a[186:187], v32 offset:47104
    v_cvt_pk_bf16_f32 v130, v84, v85
    v_mfma_f32_16x16x32_bf16 v[60:63], a[140:143], v[176:179], 0
    ds_read_b64_tr_b16 a[188:189], v33 offset:45056
    v_cvt_pk_bf16_f32 v131, v86, v87
    v_mfma_f32_16x16x32_bf16 v[76:79], a[140:143], v[192:195], 0
    ds_read_b64_tr_b16 a[190:191], v33 offset:47104
    s_waitcnt lgkmcnt(15)
    v_mfma_f32_16x16x32_bf16 v[48:51], a[144:147], v[180:183], v[48:51]
    ds_read_b64_tr_b16 a[128:129], v34 offset:32768
    v_cvt_pk_bf16_f32 v132, v88, v89
    v_mfma_f32_16x16x32_bf16 v[64:67], a[144:147], v[196:199], v[64:67]
    ds_read_b64_tr_b16 a[130:131], v34 offset:34816
    v_cvt_pk_bf16_f32 v133, v90, v91
    v_mfma_f32_16x16x32_bf16 v[52:55], a[148:151], v[180:183], v[52:55]
    ds_read_b64_tr_b16 a[132:133], v35 offset:32768
    v_cvt_pk_bf16_f32 v134, v92, v93
    v_mfma_f32_16x16x32_bf16 v[68:71], a[148:151], v[196:199], v[68:71]
    ds_read_b64_tr_b16 a[134:135], v35 offset:34816
    v_cvt_pk_bf16_f32 v135, v94, v95
    v_mfma_f32_16x16x32_bf16 v[56:59], a[152:155], v[180:183], v[56:59]
    ds_read_b64_tr_b16 a[136:137], v36 offset:32768
    v_cvt_pk_bf16_f32 v136, v96, v97
    v_mfma_f32_16x16x32_bf16 v[72:75], a[152:155], v[196:199], v[72:75]
    ds_read_b64_tr_b16 a[138:139], v36 offset:34816
    v_cvt_pk_bf16_f32 v137, v98, v99
    v_mfma_f32_16x16x32_bf16 v[60:63], a[156:159], v[180:183], v[60:63]
    ds_read_b64_tr_b16 a[140:141], v37 offset:32768
    v_cvt_pk_bf16_f32 v138, v100, v101
    v_mfma_f32_16x16x32_bf16 v[76:79], a[156:159], v[196:199], v[76:79]
    ds_read_b64_tr_b16 a[142:143], v37 offset:34816
    s_waitcnt lgkmcnt(15)
    v_mfma_f32_16x16x32_bf16 v[48:51], a[160:163], v[184:187], v[48:51]
    ds_read_b64_tr_b16 a[144:145], v34 offset:36864
    v_cvt_pk_bf16_f32 v139, v102, v103
    v_mfma_f32_16x16x32_bf16 v[64:67], a[160:163], v[200:203], v[64:67]
    ds_read_b64_tr_b16 a[146:147], v34 offset:38912
    v_cvt_pk_bf16_f32 v140, v104, v105
    v_mfma_f32_16x16x32_bf16 v[52:55], a[164:167], v[184:187], v[52:55]
    ds_read_b64_tr_b16 a[148:149], v35 offset:36864
    v_cvt_pk_bf16_f32 v141, v106, v107
    v_mfma_f32_16x16x32_bf16 v[68:71], a[164:167], v[200:203], v[68:71]
    ds_read_b64_tr_b16 a[150:151], v35 offset:38912
    v_cvt_pk_bf16_f32 v142, v108, v109
    v_mfma_f32_16x16x32_bf16 v[56:59], a[168:171], v[184:187], v[56:59]
    ds_read_b64_tr_b16 a[152:153], v36 offset:36864
    v_cvt_pk_bf16_f32 v143, v110, v111
    v_mfma_f32_16x16x32_bf16 v[72:75], a[168:171], v[200:203], v[72:75]
    ds_read_b64_tr_b16 a[154:155], v36 offset:38912
    v_mfma_f32_16x16x32_bf16 v[60:63], a[172:175], v[184:187], v[60:63]
    ds_read_b64_tr_b16 a[156:157], v37 offset:36864
    v_mfma_f32_16x16x32_bf16 v[76:79], a[172:175], v[200:203], v[76:79]
    s_mov_b32 s56, 7168
    ds_read_b64_tr_b16 a[158:159], v37 offset:38912
    s_waitcnt lgkmcnt(15)
    v_mfma_f32_16x16x32_bf16 v[48:51], a[176:179], v[188:191], v[48:51]
    ds_read_b64_tr_b16 a[160:161], v34 offset:40960
    ds_read_b64_tr_b16 a[162:163], v34 offset:43008
    v_mfma_f32_16x16x32_bf16 v[64:67], a[176:179], v[204:207], v[64:67]
    buffer_store_dwordx4 v[128:131], v38, s[32:35], s56 offen offset:0 sc1
    v_mfma_f32_16x16x32_bf16 v[52:55], a[180:183], v[188:191], v[52:55]
    ds_read_b64_tr_b16 a[164:165], v35 offset:40960
    v_mfma_f32_16x16x32_bf16 v[68:71], a[180:183], v[204:207], v[68:71]
    ds_read_b64_tr_b16 a[166:167], v35 offset:43008
    v_mfma_f32_16x16x32_bf16 v[56:59], a[184:187], v[188:191], v[56:59]
    ds_read_b64_tr_b16 a[168:169], v36 offset:40960
    ds_read_b64_tr_b16 a[170:171], v36 offset:43008
    v_mfma_f32_16x16x32_bf16 v[72:75], a[184:187], v[204:207], v[72:75]
    buffer_store_dwordx4 v[132:135], v38, s[32:35], s56 offen offset:512 sc1
    v_mfma_f32_16x16x32_bf16 v[60:63], a[188:191], v[188:191], v[60:63]
    ds_read_b64_tr_b16 a[172:173], v37 offset:40960
    v_mfma_f32_16x16x32_bf16 v[76:79], a[188:191], v[204:207], v[76:79]
    s_mov_b32 s56, 25600
    ds_read_b64_tr_b16 a[174:175], v37 offset:43008
    s_waitcnt lgkmcnt(15)
    v_mfma_f32_16x16x32_bf16 v[48:51], a[128:131], v[208:211], v[48:51]
    ds_read_b64_tr_b16 a[176:177], v34 offset:45056
    ds_read_b64_tr_b16 a[178:179], v34 offset:47104
    v_mfma_f32_16x16x32_bf16 v[64:67], a[128:131], v[224:227], v[64:67]
    buffer_store_dwordx4 v[136:139], v38, s[32:35], s56 offen offset:0 sc1
    v_mfma_f32_16x16x32_bf16 v[52:55], a[132:135], v[208:211], v[52:55]
    ds_read_b64_tr_b16 a[180:181], v35 offset:45056
    v_mfma_f32_16x16x32_bf16 v[68:71], a[132:135], v[224:227], v[68:71]
    ds_read_b64_tr_b16 a[182:183], v35 offset:47104
    v_mfma_f32_16x16x32_bf16 v[56:59], a[136:139], v[208:211], v[56:59]
    ds_read_b64_tr_b16 a[184:185], v36 offset:45056
    ds_read_b64_tr_b16 a[186:187], v36 offset:47104
    v_mfma_f32_16x16x32_bf16 v[72:75], a[136:139], v[224:227], v[72:75]
    buffer_store_dwordx4 v[140:143], v38, s[32:35], s56 offen offset:512 sc1
    v_mfma_f32_16x16x32_bf16 v[60:63], a[140:143], v[208:211], v[60:63]
    ds_read_b64_tr_b16 a[188:189], v37 offset:45056
    v_mfma_f32_16x16x32_bf16 v[76:79], a[140:143], v[224:227], v[76:79]
    ds_read_b64_tr_b16 a[190:191], v37 offset:47104
    s_waitcnt lgkmcnt(15)
    v_mfma_f32_16x16x32_bf16 v[48:51], a[144:147], v[212:215], v[48:51]
    v_mfma_f32_16x16x32_bf16 v[64:67], a[144:147], v[228:231], v[64:67]
    v_mfma_f32_16x16x32_bf16 v[52:55], a[148:151], v[212:215], v[52:55]
    v_mfma_f32_16x16x32_bf16 v[68:71], a[148:151], v[228:231], v[68:71]
    v_mfma_f32_16x16x32_bf16 v[56:59], a[152:155], v[212:215], v[56:59]
    v_mfma_f32_16x16x32_bf16 v[72:75], a[152:155], v[228:231], v[72:75]
    v_mfma_f32_16x16x32_bf16 v[60:63], a[156:159], v[212:215], v[60:63]
    v_mfma_f32_16x16x32_bf16 v[76:79], a[156:159], v[228:231], v[76:79]
    s_waitcnt lgkmcnt(8)
    v_mfma_f32_16x16x32_bf16 v[48:51], a[160:163], v[216:219], v[48:51]
    v_mfma_f32_16x16x32_bf16 v[64:67], a[160:163], v[232:235], v[64:67]
    v_mfma_f32_16x16x32_bf16 v[52:55], a[164:167], v[216:219], v[52:55]
    v_mfma_f32_16x16x32_bf16 v[68:71], a[164:167], v[232:235], v[68:71]
    v_mfma_f32_16x16x32_bf16 v[56:59], a[168:171], v[216:219], v[56:59]
    v_mfma_f32_16x16x32_bf16 v[72:75], a[168:171], v[232:235], v[72:75]
    v_mfma_f32_16x16x32_bf16 v[60:63], a[172:175], v[216:219], v[60:63]
    v_mfma_f32_16x16x32_bf16 v[76:79], a[172:175], v[232:235], v[76:79]
    s_waitcnt lgkmcnt(0)
    v_mfma_f32_16x16x32_bf16 v[48:51], a[176:179], v[220:223], v[48:51]
    v_mfma_f32_16x16x32_bf16 v[64:67], a[176:179], v[236:239], v[64:67]
    v_mfma_f32_16x16x32_bf16 v[52:55], a[180:183], v[220:223], v[52:55]
    v_mfma_f32_16x16x32_bf16 v[68:71], a[180:183], v[236:239], v[68:71]
    v_mfma_f32_16x16x32_bf16 v[56:59], a[184:187], v[220:223], v[56:59]
    v_mfma_f32_16x16x32_bf16 v[72:75], a[184:187], v[236:239], v[72:75]
    v_mfma_f32_16x16x32_bf16 v[60:63], a[188:191], v[220:223], v[60:63]
    v_mfma_f32_16x16x32_bf16 v[76:79], a[188:191], v[236:239], v[76:79]
    s_nop 7
    v_cvt_pk_bf16_f32 v112, v48, v49
    v_cvt_pk_bf16_f32 v113, v50, v51
    v_cvt_pk_bf16_f32 v114, v52, v53
    v_cvt_pk_bf16_f32 v115, v54, v55
    s_mov_b32 s56, 8192
    buffer_store_dwordx4 v[112:115], v38, s[32:35], s56 offen offset:0 sc1
    v_cvt_pk_bf16_f32 v116, v56, v57
    v_cvt_pk_bf16_f32 v117, v58, v59
    v_cvt_pk_bf16_f32 v118, v60, v61
    v_cvt_pk_bf16_f32 v119, v62, v63
    s_mov_b32 s56, 8192
    buffer_store_dwordx4 v[116:119], v38, s[32:35], s56 offen offset:512 sc1
    v_cvt_pk_bf16_f32 v120, v64, v65
    v_cvt_pk_bf16_f32 v121, v66, v67
    v_cvt_pk_bf16_f32 v122, v68, v69
    v_cvt_pk_bf16_f32 v123, v70, v71
    s_mov_b32 s56, 26624
    buffer_store_dwordx4 v[120:123], v38, s[32:35], s56 offen offset:0 sc1
    v_cvt_pk_bf16_f32 v124, v72, v73
    v_cvt_pk_bf16_f32 v125, v74, v75
    v_cvt_pk_bf16_f32 v126, v76, v77
    v_cvt_pk_bf16_f32 v127, v78, v79
    s_mov_b32 s56, 26624
    buffer_store_dwordx4 v[124:127], v38, s[32:35], s56 offen offset:512 sc1
    s_waitcnt vmcnt(0)
    s_barrier
k4_kernel_ffn:
    s_lshl_b32 s58, s45, 7
    s_add_u32 s58, s58, 7104512
    s_add_u32 s28, s40, s58
    s_addc_u32 s29, s41, 0
    s_mov_b32 s30, 0x40
    s_mov_b32 s31, 0x20000
    s_lshl_b32 s58, s44, 2
    v_mov_b32 v49, s58
    v_mov_b32 v50, 1
    s_cmp_lg_u32 s46, 3
    s_cbranch_scc1 k4_kernel_nf1
    s_mov_b64 exec, 1
    buffer_store_dword v50, v49, s[28:31], 0 offen sc1
    s_mov_b64 exec, -1
k4_kernel_nf1:
    s_load_dwordx4 s[4:7], s[0:1], 48
    s_load_dwordx2 s[36:37], s[0:1], 64
    s_load_dwordx2 s[40:41], s[0:1], 104
    s_load_dwordx2 s[8:9], s[0:1], 0
    s_getpc_b64 s[60:61]
    v_lshlrev_b32 v62, 6, v0
    global_load_dword v63, v62, s[60:61]
    v_lshrrev_b32 v1, 6, v0
    v_and_b32 v2, 63, v0
    s_and_b32 s44, s2, 7
    s_lshl_b32 s44, s44, 1
    v_readfirstlane_b32 s46, v1
    s_bfe_u32 s45, s2, 0x10003
    s_add_u32 s44, s44, s45
    s_lshr_b32 s45, s2, 4
    s_and_b32 s44, s2, 3
    s_lshl_b32 s44, s44, 2
    s_bfe_u32 s45, s2, 0x20003
    s_add_u32 s44, s44, s45
    s_bfe_u32 s45, s2, 0x10002
    s_lshl_b32 s45, s45, 3
    s_lshr_b32 s58, s2, 5
    s_add_u32 s45, s45, s58
    s_mul_i32 s47, s46, 9216
    s_and_b32 s57, s46, 1
    s_mul_i32 s57, s57, 442368
    s_mov_b32 s58, 43691
    v_and_b32 v7, 3, v2
    v_lshrrev_b32 v3, 2, v2
    v_add_u32 v3, 0, v3
    v_mul_lo_u32 v4, v3, s58
    v_lshrrev_b32 v4, 17, v4
    v_mul_u32_u24 v5, 3, v4
    v_sub_u32 v5, v3, v5
    v_bfe_u32 v6, v4, 2, 1
    v_lshlrev_b32 v6, 1, v6
    v_xor_b32 v6, v6, v7
    v_lshlrev_b32 v6, 4, v6
    v_lshl_add_u32 v6, v5, 6, v6
    v_mul_u32_u24 v4, 9216, v4
    v_add3_u32 v32, v4, v6, s57
    v_lshrrev_b32 v3, 2, v2
    v_add_u32 v3, 16, v3
    v_mul_lo_u32 v4, v3, s58
    v_lshrrev_b32 v4, 17, v4
    v_mul_u32_u24 v5, 3, v4
    v_sub_u32 v5, v3, v5
    v_bfe_u32 v6, v4, 2, 1
    v_lshlrev_b32 v6, 1, v6
    v_xor_b32 v6, v6, v7
    v_lshlrev_b32 v6, 4, v6
    v_lshl_add_u32 v6, v5, 6, v6
    v_mul_u32_u24 v4, 9216, v4
    v_add3_u32 v33, v4, v6, s57
    v_subrev_u32 v33, 1024, v33
    v_lshrrev_b32 v3, 2, v2
    v_add_u32 v3, 32, v3
    v_mul_lo_u32 v4, v3, s58
    v_lshrrev_b32 v4, 17, v4
    v_mul_u32_u24 v5, 3, v4
    v_sub_u32 v5, v3, v5
    v_bfe_u32 v6, v4, 2, 1
    v_lshlrev_b32 v6, 1, v6
    v_xor_b32 v6, v6, v7
    v_lshlrev_b32 v6, 4, v6
    v_lshl_add_u32 v6, v5, 6, v6
    v_mul_u32_u24 v4, 9216, v4
    v_add3_u32 v34, v4, v6, s57
    v_subrev_u32 v34, 2048, v34
    v_lshlrev_b32 v39, 4, v2
    s_waitcnt lgkmcnt(0)
    s_cmp_ge_u32 s46, 2
    s_cselect_b32 s4, s6, s4
    s_cselect_b32 s5, s7, s5
    s_mul_i32 s58, s44, 576
    s_add_u32 s16, s4, s58
    s_addc_u32 s17, s5, 0
    s_mov_b32 s18, 0x50de40
    s_mov_b32 s19, 0x20000
    s_lshl_b32 s58, s45, 2
    s_add_u32 s58, s58, s46
    s_mul_i32 s58, s58, 36864
    s_add_u32 s58, s58, 2359296
    s_add_u32 s24, s40, s58
    s_addc_u32 s25, s41, 0
    s_mov_b32 s26, 0x9000
    s_mov_b32 s27, 0x20000
    s_mov_b32 s53, 0xffff0000
    s_lshl_b32 s56, s45, 4
    s_add_u32 s56, s56, s44
    s_mul_i32 s57, s56, 9216
    s_lshl_b32 s58, s45, 7
    s_add_u32 s58, s58, 7102464
    s_add_u32 s60, s40, s58
    s_addc_u32 s61, s41, 0
    s_mov_b32 s62, 0x40
    s_mov_b32 s63, 0x20000
    s_cmp_eq_u32 s46, 3
    s_cbranch_scc1 k4_kernel_w3
    s_add_u32 s12, s40, 0x700000
    s_addc_u32 s13, s41, 0
    s_mov_b32 s14, 0x2400000
    s_mov_b32 s15, 0x20000
    v_lshlrev_b32 v16, 4, v0
    v_add_u32 v16, s57, v16
    v_add_u32 v17, 6144, v16
    s_add_u32 m0, s47, 0
    s_mov_b32 s50, 0
    buffer_load_dwordx4 v32, s[16:19], s50 offen offset:0 lds
    buffer_load_dwordx4 v33, s[16:19], s50 offen offset:1024 lds
    buffer_load_dwordx4 v34, s[16:19], s50 offen offset:2048 lds
    s_add_u32 m0, s47, 3072
    s_mov_b32 s50, 147456
    buffer_load_dwordx4 v32, s[16:19], s50 offen offset:0 lds
    buffer_load_dwordx4 v33, s[16:19], s50 offen offset:1024 lds
    buffer_load_dwordx4 v34, s[16:19], s50 offen offset:2048 lds
    s_add_u32 m0, s47, 6144
    s_mov_b32 s50, 294912
    buffer_load_dwordx4 v32, s[16:19], s50 offen offset:0 lds
    buffer_load_dwordx4 v33, s[16:19], s50 offen offset:1024 lds
    buffer_load_dwordx4 v34, s[16:19], s50 offen offset:2048 lds
    s_add_u32 m0, s47, 36864
    s_mov_b32 s50, 884736
    buffer_load_dwordx4 v32, s[16:19], s50 offen offset:0 lds
    buffer_load_dwordx4 v33, s[16:19], s50 offen offset:1024 lds
    buffer_load_dwordx4 v34, s[16:19], s50 offen offset:2048 lds
    s_add_u32 m0, s47, 39936
    s_mov_b32 s50, 1032192
    buffer_load_dwordx4 v32, s[16:19], s50 offen offset:0 lds
    buffer_load_dwordx4 v33, s[16:19], s50 offen offset:1024 lds
    buffer_load_dwordx4 v34, s[16:19], s50 offen offset:2048 lds
    s_add_u32 m0, s47, 43008
    s_mov_b32 s50, 1179648
    buffer_load_dwordx4 v32, s[16:19], s50 offen offset:0 lds
    buffer_load_dwordx4 v33, s[16:19], s50 offen offset:1024 lds
    buffer_load_dwordx4 v34, s[16:19], s50 offen offset:2048 lds
    s_add_u32 m0, s47, 73728
    s_mov_b32 s50, 1769472
    buffer_load_dwordx4 v32, s[16:19], s50 offen offset:0 lds
    buffer_load_dwordx4 v33, s[16:19], s50 offen offset:1024 lds
    buffer_load_dwordx4 v34, s[16:19], s50 offen offset:2048 lds
    s_add_u32 m0, s47, 76800
    s_mov_b32 s50, 1916928
    buffer_load_dwordx4 v32, s[16:19], s50 offen offset:0 lds
    buffer_load_dwordx4 v33, s[16:19], s50 offen offset:1024 lds
    buffer_load_dwordx4 v34, s[16:19], s50 offen offset:2048 lds
    s_add_u32 m0, s47, 79872
    s_mov_b32 s50, 2064384
    buffer_load_dwordx4 v32, s[16:19], s50 offen offset:0 lds
    buffer_load_dwordx4 v33, s[16:19], s50 offen offset:1024 lds
    buffer_load_dwordx4 v34, s[16:19], s50 offen offset:2048 lds
    s_add_u32 m0, s47, 110592
    s_mov_b32 s50, 2654208
    buffer_load_dwordx4 v32, s[16:19], s50 offen offset:0 lds
    buffer_load_dwordx4 v33, s[16:19], s50 offen offset:1024 lds
    buffer_load_dwordx4 v34, s[16:19], s50 offen offset:2048 lds
    s_add_u32 m0, s47, 113664
    s_mov_b32 s50, 2801664
    buffer_load_dwordx4 v32, s[16:19], s50 offen offset:0 lds
    buffer_load_dwordx4 v33, s[16:19], s50 offen offset:1024 lds
    buffer_load_dwordx4 v34, s[16:19], s50 offen offset:2048 lds
    s_add_u32 m0, s47, 116736
    s_mov_b32 s50, 2949120
    buffer_load_dwordx4 v32, s[16:19], s50 offen offset:0 lds
    buffer_load_dwordx4 v33, s[16:19], s50 offen offset:1024 lds
    buffer_load_dwordx4 v34, s[16:19], s50 offen offset:2048 lds
    s_barrier
    s_mov_b32 s59, 0
    buffer_load_dwordx4 v[64:67], v16, s[12:15], s59 offen offset:0 sc1
    buffer_load_dwordx4 v[68:71], v16, s[12:15], s59 offen offset:3072 sc1
    buffer_load_dwordx4 v[72:75], v17, s[12:15], s59 offen offset:0 sc1
    s_mov_b32 s59, 2359296
    buffer_load_dwordx4 v[76:79], v16, s[12:15], s59 offen offset:0 sc1
    buffer_load_dwordx4 v[80:83], v16, s[12:15], s59 offen offset:3072 sc1
    buffer_load_dwordx4 v[84:87], v17, s[12:15], s59 offen offset:0 sc1
    s_mov_b32 s59, 4718592
    buffer_load_dwordx4 v[88:91], v16, s[12:15], s59 offen offset:0 sc1
    buffer_load_dwordx4 v[92:95], v16, s[12:15], s59 offen offset:3072 sc1
    buffer_load_dwordx4 v[96:99], v17, s[12:15], s59 offen offset:0 sc1
    s_mov_b32 s59, 7077888
    buffer_load_dwordx4 v[100:103], v16, s[12:15], s59 offen offset:0 sc1
    buffer_load_dwordx4 v[104:107], v16, s[12:15], s59 offen offset:3072 sc1
    buffer_load_dwordx4 v[108:111], v17, s[12:15], s59 offen offset:0 sc1
    s_mov_b32 s59, 9437184
    buffer_load_dwordx4 v[112:115], v16, s[12:15], s59 offen offset:0 sc1
    buffer_load_dwordx4 v[116:119], v16, s[12:15], s59 offen offset:3072 sc1
    buffer_load_dwordx4 v[120:123], v17, s[12:15], s59 offen offset:0 sc1
    s_mov_b32 s59, 11796480
    buffer_load_dwordx4 v[124:127], v16, s[12:15], s59 offen offset:0 sc1
    buffer_load_dwordx4 v[128:131], v16, s[12:15], s59 offen offset:3072 sc1
    buffer_load_dwordx4 v[132:135], v17, s[12:15], s59 offen offset:0 sc1
    s_mov_b32 s59, 14155776
    buffer_load_dwordx4 v[136:139], v16, s[12:15], s59 offen offset:0 sc1
    buffer_load_dwordx4 v[140:143], v16, s[12:15], s59 offen offset:3072 sc1
    buffer_load_dwordx4 v[144:147], v17, s[12:15], s59 offen offset:0 sc1
    s_mov_b32 s59, 16515072
    buffer_load_dwordx4 v[148:151], v16, s[12:15], s59 offen offset:0 sc1
    buffer_load_dwordx4 v[152:155], v16, s[12:15], s59 offen offset:3072 sc1
    buffer_load_dwordx4 v[156:159], v17, s[12:15], s59 offen offset:0 sc1
    s_mov_b32 s59, 18874368
    buffer_load_dwordx4 v[160:163], v16, s[12:15], s59 offen offset:0 sc1
    buffer_load_dwordx4 v[164:167], v16, s[12:15], s59 offen offset:3072 sc1
    buffer_load_dwordx4 v[168:171], v17, s[12:15], s59 offen offset:0 sc1
    s_mov_b32 s59, 21233664
    buffer_load_dwordx4 v[172:175], v16, s[12:15], s59 offen offset:0 sc1
    buffer_load_dwordx4 v[176:179], v16, s[12:15], s59 offen offset:3072 sc1
    buffer_load_dwordx4 v[180:183], v17, s[12:15], s59 offen offset:0 sc1
    s_mov_b32 s59, 23592960
    buffer_load_dwordx4 v[184:187], v16, s[12:15], s59 offen offset:0 sc1
    buffer_load_dwordx4 v[188:191], v16, s[12:15], s59 offen offset:3072 sc1
    buffer_load_dwordx4 v[192:195], v17, s[12:15], s59 offen offset:0 sc1
    s_mov_b32 s59, 25952256
    buffer_load_dwordx4 v[196:199], v16, s[12:15], s59 offen offset:0 sc1
    buffer_load_dwordx4 v[200:203], v16, s[12:15], s59 offen offset:3072 sc1
    buffer_load_dwordx4 v[204:207], v17, s[12:15], s59 offen offset:0 sc1
    s_mov_b32 s59, 28311552
    buffer_load_dwordx4 v[208:211], v16, s[12:15], s59 offen offset:0 sc1
    buffer_load_dwordx4 v[212:215], v16, s[12:15], s59 offen offset:3072 sc1
    buffer_load_dwordx4 v[216:219], v17, s[12:15], s59 offen offset:0 sc1
    v_and_b32 v18, 7, v0
    v_bfe_u32 v19, v0, 3, 2
    v_lshrrev_b32 v20, 5, v0
    v_lshlrev_b32 v21, 6, v20
    v_lshl_add_u32 v21, v19, 3, v21
    v_mul_u32_u24 v22, 1152, v18
    v_add3_u32 v22, v22, v21, s57
    v_lshlrev_b32 v23, 1, v21
    s_mov_b32 s10, 2359296
    s_mov_b32 s11, 0x20000
    s_add_u32 s28, s40, 0x6c2000
    s_addc_u32 s29, s41, 0
    s_mov_b32 s30, 0x2400
    s_mov_b32 s31, 0x20000
    buffer_load_dwordx2 v[244:245], v22, s[8:11], 0 offen offset:0
    buffer_load_dwordx2 v[246:247], v22, s[8:11], 0 offen offset:32
    buffer_load_dwordx2 v[248:249], v22, s[8:11], 0 offen offset:384
    buffer_load_dwordx2 v[250:251], v22, s[8:11], 0 offen offset:416
    buffer_load_dwordx2 v[252:253], v22, s[8:11], 0 offen offset:768
    buffer_load_dwordx2 v[254:255], v22, s[8:11], 0 offen offset:800
    s_movk_i32 s59, 0
    buffer_load_dwordx4 v[220:223], v23, s[28:31], s59 offen offset:0
    buffer_load_dwordx4 v[224:227], v23, s[28:31], s59 offen offset:64
    buffer_load_dwordx4 v[228:231], v23, s[28:31], s59 offen offset:768
    buffer_load_dwordx4 v[232:235], v23, s[28:31], s59 offen offset:832
    buffer_load_dwordx4 v[236:239], v23, s[28:31], s59 offen offset:1536
    buffer_load_dwordx4 v[240:243], v23, s[28:31], s59 offen offset:1600
    s_waitcnt vmcnt(48)
    v_lshlrev_b32 v40, 16, v64
    v_and_b32 v41, s53, v64
    v_lshlrev_b32 v42, 16, v65
    v_and_b32 v43, s53, v65
    v_lshlrev_b32 v44, 16, v66
    v_and_b32 v45, s53, v66
    v_lshlrev_b32 v46, 16, v67
    v_and_b32 v47, s53, v67
    v_lshlrev_b32 v48, 16, v68
    v_and_b32 v49, s53, v68
    v_lshlrev_b32 v50, 16, v69
    v_and_b32 v51, s53, v69
    v_lshlrev_b32 v52, 16, v70
    v_and_b32 v53, s53, v70
    v_lshlrev_b32 v54, 16, v71
    v_and_b32 v55, s53, v71
    v_lshlrev_b32 v56, 16, v72
    v_and_b32 v57, s53, v72
    v_lshlrev_b32 v58, 16, v73
    v_and_b32 v59, s53, v73
    v_lshlrev_b32 v60, 16, v74
    v_and_b32 v61, s53, v74
    v_lshlrev_b32 v62, 16, v75
    v_and_b32 v63, s53, v75
    s_mov_b32 s59, 30670848
    buffer_load_dwordx4 v[64:67], v16, s[12:15], s59 offen offset:0 sc1
    buffer_load_dwordx4 v[68:71], v16, s[12:15], s59 offen offset:3072 sc1
    buffer_load_dwordx4 v[72:75], v17, s[12:15], s59 offen offset:0 sc1
    s_waitcnt vmcnt(48)
    v_lshlrev_b32 v8, 16, v76
    v_and_b32 v9, s53, v76
    v_lshlrev_b32 v10, 16, v77
    v_and_b32 v11, s53, v77
    v_lshlrev_b32 v12, 16, v78
    v_and_b32 v13, s53, v78
    v_lshlrev_b32 v14, 16, v79
    v_and_b32 v15, s53, v79
    v_pk_add_f32 v[40:41], v[40:41], v[8:9]
    v_pk_add_f32 v[42:43], v[42:43], v[10:11]
    v_pk_add_f32 v[44:45], v[44:45], v[12:13]
    v_pk_add_f32 v[46:47], v[46:47], v[14:15]
    v_lshlrev_b32 v8, 16, v80
    v_and_b32 v9, s53, v80
    v_lshlrev_b32 v10, 16, v81
    v_and_b32 v11, s53, v81
    v_lshlrev_b32 v12, 16, v82
    v_and_b32 v13, s53, v82
    v_lshlrev_b32 v14, 16, v83
    v_and_b32 v15, s53, v83
    v_pk_add_f32 v[48:49], v[48:49], v[8:9]
    v_pk_add_f32 v[50:51], v[50:51], v[10:11]
    v_pk_add_f32 v[52:53], v[52:53], v[12:13]
    v_pk_add_f32 v[54:55], v[54:55], v[14:15]
    v_lshlrev_b32 v8, 16, v84
    v_and_b32 v9, s53, v84
    v_lshlrev_b32 v10, 16, v85
    v_and_b32 v11, s53, v85
    v_lshlrev_b32 v12, 16, v86
    v_and_b32 v13, s53, v86
    v_lshlrev_b32 v14, 16, v87
    v_and_b32 v15, s53, v87
    v_pk_add_f32 v[56:57], v[56:57], v[8:9]
    v_pk_add_f32 v[58:59], v[58:59], v[10:11]
    v_pk_add_f32 v[60:61], v[60:61], v[12:13]
    v_pk_add_f32 v[62:63], v[62:63], v[14:15]
    s_mov_b32 s59, 33030144
    buffer_load_dwordx4 v[76:79], v16, s[12:15], s59 offen offset:0 sc1
    buffer_load_dwordx4 v[80:83], v16, s[12:15], s59 offen offset:3072 sc1
    buffer_load_dwordx4 v[84:87], v17, s[12:15], s59 offen offset:0 sc1
    s_waitcnt vmcnt(48)
    v_lshlrev_b32 v8, 16, v88
    v_and_b32 v9, s53, v88
    v_lshlrev_b32 v10, 16, v89
    v_and_b32 v11, s53, v89
    v_lshlrev_b32 v12, 16, v90
    v_and_b32 v13, s53, v90
    v_lshlrev_b32 v14, 16, v91
    v_and_b32 v15, s53, v91
    v_pk_add_f32 v[40:41], v[40:41], v[8:9]
    v_pk_add_f32 v[42:43], v[42:43], v[10:11]
    v_pk_add_f32 v[44:45], v[44:45], v[12:13]
    v_pk_add_f32 v[46:47], v[46:47], v[14:15]
    v_lshlrev_b32 v8, 16, v92
    v_and_b32 v9, s53, v92
    v_lshlrev_b32 v10, 16, v93
    v_and_b32 v11, s53, v93
    v_lshlrev_b32 v12, 16, v94
    v_and_b32 v13, s53, v94
    v_lshlrev_b32 v14, 16, v95
    v_and_b32 v15, s53, v95
    v_pk_add_f32 v[48:49], v[48:49], v[8:9]
    v_pk_add_f32 v[50:51], v[50:51], v[10:11]
    v_pk_add_f32 v[52:53], v[52:53], v[12:13]
    v_pk_add_f32 v[54:55], v[54:55], v[14:15]
    v_lshlrev_b32 v8, 16, v96
    v_and_b32 v9, s53, v96
    v_lshlrev_b32 v10, 16, v97
    v_and_b32 v11, s53, v97
    v_lshlrev_b32 v12, 16, v98
    v_and_b32 v13, s53, v98
    v_lshlrev_b32 v14, 16, v99
    v_and_b32 v15, s53, v99
    v_pk_add_f32 v[56:57], v[56:57], v[8:9]
    v_pk_add_f32 v[58:59], v[58:59], v[10:11]
    v_pk_add_f32 v[60:61], v[60:61], v[12:13]
    v_pk_add_f32 v[62:63], v[62:63], v[14:15]
    s_mov_b32 s59, 35389440
    buffer_load_dwordx4 v[88:91], v16, s[12:15], s59 offen offset:0 sc1
    buffer_load_dwordx4 v[92:95], v16, s[12:15], s59 offen offset:3072 sc1
    buffer_load_dwordx4 v[96:99], v17, s[12:15], s59 offen offset:0 sc1
    s_waitcnt vmcnt(48)
    v_lshlrev_b32 v8, 16, v100
    v_and_b32 v9, s53, v100
    v_lshlrev_b32 v10, 16, v101
    v_and_b32 v11, s53, v101
    v_lshlrev_b32 v12, 16, v102
    v_and_b32 v13, s53, v102
    v_lshlrev_b32 v14, 16, v103
    v_and_b32 v15, s53, v103
    v_pk_add_f32 v[40:41], v[40:41], v[8:9]
    v_pk_add_f32 v[42:43], v[42:43], v[10:11]
    v_pk_add_f32 v[44:45], v[44:45], v[12:13]
    v_pk_add_f32 v[46:47], v[46:47], v[14:15]
    v_lshlrev_b32 v8, 16, v104
    v_and_b32 v9, s53, v104
    v_lshlrev_b32 v10, 16, v105
    v_and_b32 v11, s53, v105
    v_lshlrev_b32 v12, 16, v106
    v_and_b32 v13, s53, v106
    v_lshlrev_b32 v14, 16, v107
    v_and_b32 v15, s53, v107
    v_pk_add_f32 v[48:49], v[48:49], v[8:9]
    v_pk_add_f32 v[50:51], v[50:51], v[10:11]
    v_pk_add_f32 v[52:53], v[52:53], v[12:13]
    v_pk_add_f32 v[54:55], v[54:55], v[14:15]
    v_lshlrev_b32 v8, 16, v108
    v_and_b32 v9, s53, v108
    v_lshlrev_b32 v10, 16, v109
    v_and_b32 v11, s53, v109
    v_lshlrev_b32 v12, 16, v110
    v_and_b32 v13, s53, v110
    v_lshlrev_b32 v14, 16, v111
    v_and_b32 v15, s53, v111
    v_pk_add_f32 v[56:57], v[56:57], v[8:9]
    v_pk_add_f32 v[58:59], v[58:59], v[10:11]
    v_pk_add_f32 v[60:61], v[60:61], v[12:13]
    v_pk_add_f32 v[62:63], v[62:63], v[14:15]
    s_waitcnt vmcnt(45)
    v_lshlrev_b32 v8, 16, v112
    v_and_b32 v9, s53, v112
    v_lshlrev_b32 v10, 16, v113
    v_and_b32 v11, s53, v113
    v_lshlrev_b32 v12, 16, v114
    v_and_b32 v13, s53, v114
    v_lshlrev_b32 v14, 16, v115
    v_and_b32 v15, s53, v115
    v_pk_add_f32 v[40:41], v[40:41], v[8:9]
    v_pk_add_f32 v[42:43], v[42:43], v[10:11]
    v_pk_add_f32 v[44:45], v[44:45], v[12:13]
    v_pk_add_f32 v[46:47], v[46:47], v[14:15]
    v_lshlrev_b32 v8, 16, v116
    v_and_b32 v9, s53, v116
    v_lshlrev_b32 v10, 16, v117
    v_and_b32 v11, s53, v117
    v_lshlrev_b32 v12, 16, v118
    v_and_b32 v13, s53, v118
    v_lshlrev_b32 v14, 16, v119
    v_and_b32 v15, s53, v119
    v_pk_add_f32 v[48:49], v[48:49], v[8:9]
    v_pk_add_f32 v[50:51], v[50:51], v[10:11]
    v_pk_add_f32 v[52:53], v[52:53], v[12:13]
    v_pk_add_f32 v[54:55], v[54:55], v[14:15]
    v_lshlrev_b32 v8, 16, v120
    v_and_b32 v9, s53, v120
    v_lshlrev_b32 v10, 16, v121
    v_and_b32 v11, s53, v121
    v_lshlrev_b32 v12, 16, v122
    v_and_b32 v13, s53, v122
    v_lshlrev_b32 v14, 16, v123
    v_and_b32 v15, s53, v123
    v_pk_add_f32 v[56:57], v[56:57], v[8:9]
    v_pk_add_f32 v[58:59], v[58:59], v[10:11]
    v_pk_add_f32 v[60:61], v[60:61], v[12:13]
    v_pk_add_f32 v[62:63], v[62:63], v[14:15]
    s_movk_i32 s59, 2304
    buffer_load_dwordx4 v[100:103], v23, s[28:31], s59 offen offset:0
    buffer_load_dwordx4 v[104:107], v23, s[28:31], s59 offen offset:64
    buffer_load_dwordx4 v[108:111], v23, s[28:31], s59 offen offset:768
    buffer_load_dwordx4 v[112:115], v23, s[28:31], s59 offen offset:832
    buffer_load_dwordx4 v[116:119], v23, s[28:31], s59 offen offset:1536
    buffer_load_dwordx4 v[120:123], v23, s[28:31], s59 offen offset:1600
    s_waitcnt vmcnt(48)
    v_lshlrev_b32 v8, 16, v124
    v_and_b32 v9, s53, v124
    v_lshlrev_b32 v10, 16, v125
    v_and_b32 v11, s53, v125
    v_lshlrev_b32 v12, 16, v126
    v_and_b32 v13, s53, v126
    v_lshlrev_b32 v14, 16, v127
    v_and_b32 v15, s53, v127
    v_pk_add_f32 v[40:41], v[40:41], v[8:9]
    v_pk_add_f32 v[42:43], v[42:43], v[10:11]
    v_pk_add_f32 v[44:45], v[44:45], v[12:13]
    v_pk_add_f32 v[46:47], v[46:47], v[14:15]
    v_lshlrev_b32 v8, 16, v128
    v_and_b32 v9, s53, v128
    v_lshlrev_b32 v10, 16, v129
    v_and_b32 v11, s53, v129
    v_lshlrev_b32 v12, 16, v130
    v_and_b32 v13, s53, v130
    v_lshlrev_b32 v14, 16, v131
    v_and_b32 v15, s53, v131
    v_pk_add_f32 v[48:49], v[48:49], v[8:9]
    v_pk_add_f32 v[50:51], v[50:51], v[10:11]
    v_pk_add_f32 v[52:53], v[52:53], v[12:13]
    v_pk_add_f32 v[54:55], v[54:55], v[14:15]
    v_lshlrev_b32 v8, 16, v132
    v_and_b32 v9, s53, v132
    v_lshlrev_b32 v10, 16, v133
    v_and_b32 v11, s53, v133
    v_lshlrev_b32 v12, 16, v134
    v_and_b32 v13, s53, v134
    v_lshlrev_b32 v14, 16, v135
    v_and_b32 v15, s53, v135
    v_pk_add_f32 v[56:57], v[56:57], v[8:9]
    v_pk_add_f32 v[58:59], v[58:59], v[10:11]
    v_pk_add_f32 v[60:61], v[60:61], v[12:13]
    v_pk_add_f32 v[62:63], v[62:63], v[14:15]
    s_waitcnt vmcnt(45)
    v_lshlrev_b32 v8, 16, v136
    v_and_b32 v9, s53, v136
    v_lshlrev_b32 v10, 16, v137
    v_and_b32 v11, s53, v137
    v_lshlrev_b32 v12, 16, v138
    v_and_b32 v13, s53, v138
    v_lshlrev_b32 v14, 16, v139
    v_and_b32 v15, s53, v139
    v_pk_add_f32 v[40:41], v[40:41], v[8:9]
    v_pk_add_f32 v[42:43], v[42:43], v[10:11]
    v_pk_add_f32 v[44:45], v[44:45], v[12:13]
    v_pk_add_f32 v[46:47], v[46:47], v[14:15]
    v_lshlrev_b32 v8, 16, v140
    v_and_b32 v9, s53, v140
    v_lshlrev_b32 v10, 16, v141
    v_and_b32 v11, s53, v141
    v_lshlrev_b32 v12, 16, v142
    v_and_b32 v13, s53, v142
    v_lshlrev_b32 v14, 16, v143
    v_and_b32 v15, s53, v143
    v_pk_add_f32 v[48:49], v[48:49], v[8:9]
    v_pk_add_f32 v[50:51], v[50:51], v[10:11]
    v_pk_add_f32 v[52:53], v[52:53], v[12:13]
    v_pk_add_f32 v[54:55], v[54:55], v[14:15]
    v_lshlrev_b32 v8, 16, v144
    v_and_b32 v9, s53, v144
    v_lshlrev_b32 v10, 16, v145
    v_and_b32 v11, s53, v145
    v_lshlrev_b32 v12, 16, v146
    v_and_b32 v13, s53, v146
    v_lshlrev_b32 v14, 16, v147
    v_and_b32 v15, s53, v147
    v_pk_add_f32 v[56:57], v[56:57], v[8:9]
    v_pk_add_f32 v[58:59], v[58:59], v[10:11]
    v_pk_add_f32 v[60:61], v[60:61], v[12:13]
    v_pk_add_f32 v[62:63], v[62:63], v[14:15]
    s_movk_i32 s59, 4608
    buffer_load_dwordx4 v[124:127], v23, s[28:31], s59 offen offset:0
    buffer_load_dwordx4 v[128:131], v23, s[28:31], s59 offen offset:64
    buffer_load_dwordx4 v[132:135], v23, s[28:31], s59 offen offset:768
    buffer_load_dwordx4 v[136:139], v23, s[28:31], s59 offen offset:832
    buffer_load_dwordx4 v[140:143], v23, s[28:31], s59 offen offset:1536
    buffer_load_dwordx4 v[144:147], v23, s[28:31], s59 offen offset:1600
    s_waitcnt vmcnt(48)
    v_lshlrev_b32 v8, 16, v148
    v_and_b32 v9, s53, v148
    v_lshlrev_b32 v10, 16, v149
    v_and_b32 v11, s53, v149
    v_lshlrev_b32 v12, 16, v150
    v_and_b32 v13, s53, v150
    v_lshlrev_b32 v14, 16, v151
    v_and_b32 v15, s53, v151
    v_pk_add_f32 v[40:41], v[40:41], v[8:9]
    v_pk_add_f32 v[42:43], v[42:43], v[10:11]
    v_pk_add_f32 v[44:45], v[44:45], v[12:13]
    v_pk_add_f32 v[46:47], v[46:47], v[14:15]
    v_lshlrev_b32 v8, 16, v152
    v_and_b32 v9, s53, v152
    v_lshlrev_b32 v10, 16, v153
    v_and_b32 v11, s53, v153
    v_lshlrev_b32 v12, 16, v154
    v_and_b32 v13, s53, v154
    v_lshlrev_b32 v14, 16, v155
    v_and_b32 v15, s53, v155
    v_pk_add_f32 v[48:49], v[48:49], v[8:9]
    v_pk_add_f32 v[50:51], v[50:51], v[10:11]
    v_pk_add_f32 v[52:53], v[52:53], v[12:13]
    v_pk_add_f32 v[54:55], v[54:55], v[14:15]
    v_lshlrev_b32 v8, 16, v156
    v_and_b32 v9, s53, v156
    v_lshlrev_b32 v10, 16, v157
    v_and_b32 v11, s53, v157
    v_lshlrev_b32 v12, 16, v158
    v_and_b32 v13, s53, v158
    v_lshlrev_b32 v14, 16, v159
    v_and_b32 v15, s53, v159
    v_pk_add_f32 v[56:57], v[56:57], v[8:9]
    v_pk_add_f32 v[58:59], v[58:59], v[10:11]
    v_pk_add_f32 v[60:61], v[60:61], v[12:13]
    v_pk_add_f32 v[62:63], v[62:63], v[14:15]
    s_waitcnt vmcnt(45)
    v_lshlrev_b32 v8, 16, v160
    v_and_b32 v9, s53, v160
    v_lshlrev_b32 v10, 16, v161
    v_and_b32 v11, s53, v161
    v_lshlrev_b32 v12, 16, v162
    v_and_b32 v13, s53, v162
    v_lshlrev_b32 v14, 16, v163
    v_and_b32 v15, s53, v163
    v_pk_add_f32 v[40:41], v[40:41], v[8:9]
    v_pk_add_f32 v[42:43], v[42:43], v[10:11]
    v_pk_add_f32 v[44:45], v[44:45], v[12:13]
    v_pk_add_f32 v[46:47], v[46:47], v[14:15]
    v_lshlrev_b32 v8, 16, v164
    v_and_b32 v9, s53, v164
    v_lshlrev_b32 v10, 16, v165
    v_and_b32 v11, s53, v165
    v_lshlrev_b32 v12, 16, v166
    v_and_b32 v13, s53, v166
    v_lshlrev_b32 v14, 16, v167
    v_and_b32 v15, s53, v167
    v_pk_add_f32 v[48:49], v[48:49], v[8:9]
    v_pk_add_f32 v[50:51], v[50:51], v[10:11]
    v_pk_add_f32 v[52:53], v[52:53], v[12:13]
    v_pk_add_f32 v[54:55], v[54:55], v[14:15]
    v_lshlrev_b32 v8, 16, v168
    v_and_b32 v9, s53, v168
    v_lshlrev_b32 v10, 16, v169
    v_and_b32 v11, s53, v169
    v_lshlrev_b32 v12, 16, v170
    v_and_b32 v13, s53, v170
    v_lshlrev_b32 v14, 16, v171
    v_and_b32 v15, s53, v171
    v_pk_add_f32 v[56:57], v[56:57], v[8:9]
    v_pk_add_f32 v[58:59], v[58:59], v[10:11]
    v_pk_add_f32 v[60:61], v[60:61], v[12:13]
    v_pk_add_f32 v[62:63], v[62:63], v[14:15]
    s_waitcnt vmcnt(42)
    v_lshlrev_b32 v8, 16, v172
    v_and_b32 v9, s53, v172
    v_lshlrev_b32 v10, 16, v173
    v_and_b32 v11, s53, v173
    v_lshlrev_b32 v12, 16, v174
    v_and_b32 v13, s53, v174
    v_lshlrev_b32 v14, 16, v175
    v_and_b32 v15, s53, v175
    v_pk_add_f32 v[40:41], v[40:41], v[8:9]
    v_pk_add_f32 v[42:43], v[42:43], v[10:11]
    v_pk_add_f32 v[44:45], v[44:45], v[12:13]
    v_pk_add_f32 v[46:47], v[46:47], v[14:15]
    v_lshlrev_b32 v8, 16, v176
    v_and_b32 v9, s53, v176
    v_lshlrev_b32 v10, 16, v177
    v_and_b32 v11, s53, v177
    v_lshlrev_b32 v12, 16, v178
    v_and_b32 v13, s53, v178
    v_lshlrev_b32 v14, 16, v179
    v_and_b32 v15, s53, v179
    v_pk_add_f32 v[48:49], v[48:49], v[8:9]
    v_pk_add_f32 v[50:51], v[50:51], v[10:11]
    v_pk_add_f32 v[52:53], v[52:53], v[12:13]
    v_pk_add_f32 v[54:55], v[54:55], v[14:15]
    v_lshlrev_b32 v8, 16, v180
    v_and_b32 v9, s53, v180
    v_lshlrev_b32 v10, 16, v181
    v_and_b32 v11, s53, v181
    v_lshlrev_b32 v12, 16, v182
    v_and_b32 v13, s53, v182
    v_lshlrev_b32 v14, 16, v183
    v_and_b32 v15, s53, v183
    v_pk_add_f32 v[56:57], v[56:57], v[8:9]
    v_pk_add_f32 v[58:59], v[58:59], v[10:11]
    v_pk_add_f32 v[60:61], v[60:61], v[12:13]
    v_pk_add_f32 v[62:63], v[62:63], v[14:15]
    s_waitcnt vmcnt(39)
    v_lshlrev_b32 v8, 16, v184
    v_and_b32 v9, s53, v184
    v_lshlrev_b32 v10, 16, v185
    v_and_b32 v11, s53, v185
    v_lshlrev_b32 v12, 16, v186
    v_and_b32 v13, s53, v186
    v_lshlrev_b32 v14, 16, v187
    v_and_b32 v15, s53, v187
    v_pk_add_f32 v[40:41], v[40:41], v[8:9]
    v_pk_add_f32 v[42:43], v[42:43], v[10:11]
    v_pk_add_f32 v[44:45], v[44:45], v[12:13]
    v_pk_add_f32 v[46:47], v[46:47], v[14:15]
    v_lshlrev_b32 v8, 16, v188
    v_and_b32 v9, s53, v188
    v_lshlrev_b32 v10, 16, v189
    v_and_b32 v11, s53, v189
    v_lshlrev_b32 v12, 16, v190
    v_and_b32 v13, s53, v190
    v_lshlrev_b32 v14, 16, v191
    v_and_b32 v15, s53, v191
    v_pk_add_f32 v[48:49], v[48:49], v[8:9]
    v_pk_add_f32 v[50:51], v[50:51], v[10:11]
    v_pk_add_f32 v[52:53], v[52:53], v[12:13]
    v_pk_add_f32 v[54:55], v[54:55], v[14:15]
    v_lshlrev_b32 v8, 16, v192
    v_and_b32 v9, s53, v192
    v_lshlrev_b32 v10, 16, v193
    v_and_b32 v11, s53, v193
    v_lshlrev_b32 v12, 16, v194
    v_and_b32 v13, s53, v194
    v_lshlrev_b32 v14, 16, v195
    v_and_b32 v15, s53, v195
    v_pk_add_f32 v[56:57], v[56:57], v[8:9]
    v_pk_add_f32 v[58:59], v[58:59], v[10:11]
    v_pk_add_f32 v[60:61], v[60:61], v[12:13]
    v_pk_add_f32 v[62:63], v[62:63], v[14:15]
    s_waitcnt vmcnt(36)
    v_lshlrev_b32 v8, 16, v196
    v_and_b32 v9, s53, v196
    v_lshlrev_b32 v10, 16, v197
    v_and_b32 v11, s53, v197
    v_lshlrev_b32 v12, 16, v198
    v_and_b32 v13, s53, v198
    v_lshlrev_b32 v14, 16, v199
    v_and_b32 v15, s53, v199
    v_pk_add_f32 v[40:41], v[40:41], v[8:9]
    v_pk_add_f32 v[42:43], v[42:43], v[10:11]
    v_pk_add_f32 v[44:45], v[44:45], v[12:13]
    v_pk_add_f32 v[46:47], v[46:47], v[14:15]
    v_lshlrev_b32 v8, 16, v200
    v_and_b32 v9, s53, v200
    v_lshlrev_b32 v10, 16, v201
    v_and_b32 v11, s53, v201
    v_lshlrev_b32 v12, 16, v202
    v_and_b32 v13, s53, v202
    v_lshlrev_b32 v14, 16, v203
    v_and_b32 v15, s53, v203
    v_pk_add_f32 v[48:49], v[48:49], v[8:9]
    v_pk_add_f32 v[50:51], v[50:51], v[10:11]
    v_pk_add_f32 v[52:53], v[52:53], v[12:13]
    v_pk_add_f32 v[54:55], v[54:55], v[14:15]
    v_lshlrev_b32 v8, 16, v204
    v_and_b32 v9, s53, v204
    v_lshlrev_b32 v10, 16, v205
    v_and_b32 v11, s53, v205
    v_lshlrev_b32 v12, 16, v206
    v_and_b32 v13, s53, v206
    v_lshlrev_b32 v14, 16, v207
    v_and_b32 v15, s53, v207
    v_pk_add_f32 v[56:57], v[56:57], v[8:9]
    v_pk_add_f32 v[58:59], v[58:59], v[10:11]
    v_pk_add_f32 v[60:61], v[60:61], v[12:13]
    v_pk_add_f32 v[62:63], v[62:63], v[14:15]
    s_waitcnt vmcnt(33)
    v_lshlrev_b32 v8, 16, v208
    v_and_b32 v9, s53, v208
    v_lshlrev_b32 v10, 16, v209
    v_and_b32 v11, s53, v209
    v_lshlrev_b32 v12, 16, v210
    v_and_b32 v13, s53, v210
    v_lshlrev_b32 v14, 16, v211
    v_and_b32 v15, s53, v211
    v_pk_add_f32 v[40:41], v[40:41], v[8:9]
    v_pk_add_f32 v[42:43], v[42:43], v[10:11]
    v_pk_add_f32 v[44:45], v[44:45], v[12:13]
    v_pk_add_f32 v[46:47], v[46:47], v[14:15]
    v_lshlrev_b32 v8, 16, v212
    v_and_b32 v9, s53, v212
    v_lshlrev_b32 v10, 16, v213
    v_and_b32 v11, s53, v213
    v_lshlrev_b32 v12, 16, v214
    v_and_b32 v13, s53, v214
    v_lshlrev_b32 v14, 16, v215
    v_and_b32 v15, s53, v215
    v_pk_add_f32 v[48:49], v[48:49], v[8:9]
    v_pk_add_f32 v[50:51], v[50:51], v[10:11]
    v_pk_add_f32 v[52:53], v[52:53], v[12:13]
    v_pk_add_f32 v[54:55], v[54:55], v[14:15]
    v_lshlrev_b32 v8, 16, v216
    v_and_b32 v9, s53, v216
    v_lshlrev_b32 v10, 16, v217
    v_and_b32 v11, s53, v217
    v_lshlrev_b32 v12, 16, v218
    v_and_b32 v13, s53, v218
    v_lshlrev_b32 v14, 16, v219
    v_and_b32 v15, s53, v219
    v_pk_add_f32 v[56:57], v[56:57], v[8:9]
    v_pk_add_f32 v[58:59], v[58:59], v[10:11]
    v_pk_add_f32 v[60:61], v[60:61], v[12:13]
    v_pk_add_f32 v[62:63], v[62:63], v[14:15]
    s_waitcnt vmcnt(18)
    v_lshlrev_b32 v8, 16, v64
    v_and_b32 v9, s53, v64
    v_lshlrev_b32 v10, 16, v65
    v_and_b32 v11, s53, v65
    v_lshlrev_b32 v12, 16, v66
    v_and_b32 v13, s53, v66
    v_lshlrev_b32 v14, 16, v67
    v_and_b32 v15, s53, v67
    v_pk_add_f32 v[40:41], v[40:41], v[8:9]
    v_pk_add_f32 v[42:43], v[42:43], v[10:11]
    v_pk_add_f32 v[44:45], v[44:45], v[12:13]
    v_pk_add_f32 v[46:47], v[46:47], v[14:15]
    v_lshlrev_b32 v8, 16, v68
    v_and_b32 v9, s53, v68
    v_lshlrev_b32 v10, 16, v69
    v_and_b32 v11, s53, v69
    v_lshlrev_b32 v12, 16, v70
    v_and_b32 v13, s53, v70
    v_lshlrev_b32 v14, 16, v71
    v_and_b32 v15, s53, v71
    v_pk_add_f32 v[48:49], v[48:49], v[8:9]
    v_pk_add_f32 v[50:51], v[50:51], v[10:11]
    v_pk_add_f32 v[52:53], v[52:53], v[12:13]
    v_pk_add_f32 v[54:55], v[54:55], v[14:15]
    v_lshlrev_b32 v8, 16, v72
    v_and_b32 v9, s53, v72
    v_lshlrev_b32 v10, 16, v73
    v_and_b32 v11, s53, v73
    v_lshlrev_b32 v12, 16, v74
    v_and_b32 v13, s53, v74
    v_lshlrev_b32 v14, 16, v75
    v_and_b32 v15, s53, v75
    v_pk_add_f32 v[56:57], v[56:57], v[8:9]
    v_pk_add_f32 v[58:59], v[58:59], v[10:11]
    v_pk_add_f32 v[60:61], v[60:61], v[12:13]
    v_pk_add_f32 v[62:63], v[62:63], v[14:15]
    s_waitcnt vmcnt(15)
    v_lshlrev_b32 v8, 16, v76
    v_and_b32 v9, s53, v76
    v_lshlrev_b32 v10, 16, v77
    v_and_b32 v11, s53, v77
    v_lshlrev_b32 v12, 16, v78
    v_and_b32 v13, s53, v78
    v_lshlrev_b32 v14, 16, v79
    v_and_b32 v15, s53, v79
    v_pk_add_f32 v[40:41], v[40:41], v[8:9]
    v_pk_add_f32 v[42:43], v[42:43], v[10:11]
    v_pk_add_f32 v[44:45], v[44:45], v[12:13]
    v_pk_add_f32 v[46:47], v[46:47], v[14:15]
    v_lshlrev_b32 v8, 16, v80
    v_and_b32 v9, s53, v80
    v_lshlrev_b32 v10, 16, v81
    v_and_b32 v11, s53, v81
    v_lshlrev_b32 v12, 16, v82
    v_and_b32 v13, s53, v82
    v_lshlrev_b32 v14, 16, v83
    v_and_b32 v15, s53, v83
    v_pk_add_f32 v[48:49], v[48:49], v[8:9]
    v_pk_add_f32 v[50:51], v[50:51], v[10:11]
    v_pk_add_f32 v[52:53], v[52:53], v[12:13]
    v_pk_add_f32 v[54:55], v[54:55], v[14:15]
    v_lshlrev_b32 v8, 16, v84
    v_and_b32 v9, s53, v84
    v_lshlrev_b32 v10, 16, v85
    v_and_b32 v11, s53, v85
    v_lshlrev_b32 v12, 16, v86
    v_and_b32 v13, s53, v86
    v_lshlrev_b32 v14, 16, v87
    v_and_b32 v15, s53, v87
    v_pk_add_f32 v[56:57], v[56:57], v[8:9]
    v_pk_add_f32 v[58:59], v[58:59], v[10:11]
    v_pk_add_f32 v[60:61], v[60:61], v[12:13]
    v_pk_add_f32 v[62:63], v[62:63], v[14:15]
    s_waitcnt vmcnt(12)
    v_lshlrev_b32 v8, 16, v88
    v_and_b32 v9, s53, v88
    v_lshlrev_b32 v10, 16, v89
    v_and_b32 v11, s53, v89
    v_lshlrev_b32 v12, 16, v90
    v_and_b32 v13, s53, v90
    v_lshlrev_b32 v14, 16, v91
    v_and_b32 v15, s53, v91
    v_pk_add_f32 v[40:41], v[40:41], v[8:9]
    v_pk_add_f32 v[42:43], v[42:43], v[10:11]
    v_pk_add_f32 v[44:45], v[44:45], v[12:13]
    v_pk_add_f32 v[46:47], v[46:47], v[14:15]
    v_lshlrev_b32 v8, 16, v92
    v_and_b32 v9, s53, v92
    v_lshlrev_b32 v10, 16, v93
    v_and_b32 v11, s53, v93
    v_lshlrev_b32 v12, 16, v94
    v_and_b32 v13, s53, v94
    v_lshlrev_b32 v14, 16, v95
    v_and_b32 v15, s53, v95
    v_pk_add_f32 v[48:49], v[48:49], v[8:9]
    v_pk_add_f32 v[50:51], v[50:51], v[10:11]
    v_pk_add_f32 v[52:53], v[52:53], v[12:13]
    v_pk_add_f32 v[54:55], v[54:55], v[14:15]
    v_lshlrev_b32 v8, 16, v96
    v_and_b32 v9, s53, v96
    v_lshlrev_b32 v10, 16, v97
    v_and_b32 v11, s53, v97
    v_lshlrev_b32 v12, 16, v98
    v_and_b32 v13, s53, v98
    v_lshlrev_b32 v14, 16, v99
    v_and_b32 v15, s53, v99
    v_pk_add_f32 v[56:57], v[56:57], v[8:9]
    v_pk_add_f32 v[58:59], v[58:59], v[10:11]
    v_pk_add_f32 v[60:61], v[60:61], v[12:13]
    v_pk_add_f32 v[62:63], v[62:63], v[14:15]
    v_cvt_pk_bf16_f32 v8, v40, v41
    v_cvt_pk_bf16_f32 v9, v42, v43
    v_cvt_pk_bf16_f32 v10, v44, v45
    v_cvt_pk_bf16_f32 v11, v46, v47
    v_lshlrev_b32 v40, 16, v8
    v_and_b32 v41, s53, v8
    v_lshlrev_b32 v42, 16, v9
    v_and_b32 v43, s53, v9
    v_lshlrev_b32 v44, 16, v10
    v_and_b32 v45, s53, v10
    v_lshlrev_b32 v46, 16, v11
    v_and_b32 v47, s53, v11
    v_lshlrev_b32 v8, 16, v244
    v_and_b32 v9, s53, v244
    v_lshlrev_b32 v10, 16, v245
    v_and_b32 v11, s53, v245
    v_lshlrev_b32 v12, 16, v246
    v_and_b32 v13, s53, v246
    v_lshlrev_b32 v14, 16, v247
    v_and_b32 v15, s53, v247
    v_pk_fma_f32 v[40:41], v[40:41], v[220:221], v[8:9]
    v_pk_fma_f32 v[42:43], v[42:43], v[222:223], v[10:11]
    v_pk_fma_f32 v[44:45], v[44:45], v[224:225], v[12:13]
    v_pk_fma_f32 v[46:47], v[46:47], v[226:227], v[14:15]
    v_cvt_pk_bf16_f32 v244, v40, v41
    v_cvt_pk_bf16_f32 v245, v42, v43
    v_cvt_pk_bf16_f32 v246, v44, v45
    v_cvt_pk_bf16_f32 v247, v46, v47
    v_lshlrev_b32 v40, 16, v244
    v_and_b32 v41, s53, v244
    v_lshlrev_b32 v42, 16, v245
    v_and_b32 v43, s53, v245
    v_lshlrev_b32 v44, 16, v246
    v_and_b32 v45, s53, v246
    v_lshlrev_b32 v46, 16, v247
    v_and_b32 v47, s53, v247
    v_cvt_pk_bf16_f32 v8, v48, v49
    v_cvt_pk_bf16_f32 v9, v50, v51
    v_cvt_pk_bf16_f32 v10, v52, v53
    v_cvt_pk_bf16_f32 v11, v54, v55
    v_lshlrev_b32 v48, 16, v8
    v_and_b32 v49, s53, v8
    v_lshlrev_b32 v50, 16, v9
    v_and_b32 v51, s53, v9
    v_lshlrev_b32 v52, 16, v10
    v_and_b32 v53, s53, v10
    v_lshlrev_b32 v54, 16, v11
    v_and_b32 v55, s53, v11
    v_lshlrev_b32 v8, 16, v248
    v_and_b32 v9, s53, v248
    v_lshlrev_b32 v10, 16, v249
    v_and_b32 v11, s53, v249
    v_lshlrev_b32 v12, 16, v250
    v_and_b32 v13, s53, v250
    v_lshlrev_b32 v14, 16, v251
    v_and_b32 v15, s53, v251
    v_pk_fma_f32 v[48:49], v[48:49], v[228:229], v[8:9]
    v_pk_fma_f32 v[50:51], v[50:51], v[230:231], v[10:11]
    v_pk_fma_f32 v[52:53], v[52:53], v[232:233], v[12:13]
    v_pk_fma_f32 v[54:55], v[54:55], v[234:235], v[14:15]
    v_cvt_pk_bf16_f32 v248, v48, v49
    v_cvt_pk_bf16_f32 v249, v50, v51
    v_cvt_pk_bf16_f32 v250, v52, v53
    v_cvt_pk_bf16_f32 v251, v54, v55
    v_lshlrev_b32 v48, 16, v248
    v_and_b32 v49, s53, v248
    v_lshlrev_b32 v50, 16, v249
    v_and_b32 v51, s53, v249
    v_lshlrev_b32 v52, 16, v250
    v_and_b32 v53, s53, v250
    v_lshlrev_b32 v54, 16, v251
    v_and_b32 v55, s53, v251
    v_cvt_pk_bf16_f32 v8, v56, v57
    v_cvt_pk_bf16_f32 v9, v58, v59
    v_cvt_pk_bf16_f32 v10, v60, v61
    v_cvt_pk_bf16_f32 v11, v62, v63
    v_lshlrev_b32 v56, 16, v8
    v_and_b32 v57, s53, v8
    v_lshlrev_b32 v58, 16, v9
    v_and_b32 v59, s53, v9
    v_lshlrev_b32 v60, 16, v10
    v_and_b32 v61, s53, v10
    v_lshlrev_b32 v62, 16, v11
    v_and_b32 v63, s53, v11
    v_lshlrev_b32 v8, 16, v252
    v_and_b32 v9, s53, v252
    v_lshlrev_b32 v10, 16, v253
    v_and_b32 v11, s53, v253
    v_lshlrev_b32 v12, 16, v254
    v_and_b32 v13, s53, v254
    v_lshlrev_b32 v14, 16, v255
    v_and_b32 v15, s53, v255
    v_pk_fma_f32 v[56:57], v[56:57], v[236:237], v[8:9]
    v_pk_fma_f32 v[58:59], v[58:59], v[238:239], v[10:11]
    v_pk_fma_f32 v[60:61], v[60:61], v[240:241], v[12:13]
    v_pk_fma_f32 v[62:63], v[62:63], v[242:243], v[14:15]
    v_cvt_pk_bf16_f32 v252, v56, v57
    v_cvt_pk_bf16_f32 v253, v58, v59
    v_cvt_pk_bf16_f32 v254, v60, v61
    v_cvt_pk_bf16_f32 v255, v62, v63
    v_lshlrev_b32 v56, 16, v252
    v_and_b32 v57, s53, v252
    v_lshlrev_b32 v58, 16, v253
    v_and_b32 v59, s53, v253
    v_lshlrev_b32 v60, 16, v254
    v_and_b32 v61, s53, v254
    v_lshlrev_b32 v62, 16, v255
    v_and_b32 v63, s53, v255
    s_mov_b32 s54, 0xbfb8aa3b
    s_mov_b32 s55, 0xbfb8aa3b
    s_mov_b32 s58, 0x3f803f80
    v_mov_b32 v24, 0
    v_mov_b32 v25, 0
    v_mov_b32 v26, 0
    v_mov_b32 v27, 0
    v_dot2_f32_bf16 v24, v244, s58, v24
    v_dot2_f32_bf16 v25, v244, v244, v25
    v_dot2_f32_bf16 v26, v245, s58, v26
    v_dot2_f32_bf16 v27, v245, v245, v27
    v_dot2_f32_bf16 v24, v246, s58, v24
    v_dot2_f32_bf16 v25, v246, v246, v25
    v_dot2_f32_bf16 v26, v247, s58, v26
    v_dot2_f32_bf16 v27, v247, v247, v27
    v_dot2_f32_bf16 v24, v248, s58, v24
    v_dot2_f32_bf16 v25, v248, v248, v25
    v_dot2_f32_bf16 v26, v249, s58, v26
    v_dot2_f32_bf16 v27, v249, v249, v27
    v_dot2_f32_bf16 v24, v250, s58, v24
    v_dot2_f32_bf16 v25, v250, v250, v25
    v_dot2_f32_bf16 v26, v251, s58, v26
    v_dot2_f32_bf16 v27, v251, v251, v27
    v_dot2_f32_bf16 v24, v252, s58, v24
    v_dot2_f32_bf16 v25, v252, v252, v25
    v_dot2_f32_bf16 v26, v253, s58, v26
    v_dot2_f32_bf16 v27, v253, v253, v27
    v_dot2_f32_bf16 v24, v254, s58, v24
    v_dot2_f32_bf16 v25, v254, v254, v25
    v_dot2_f32_bf16 v26, v255, s58, v26
    v_dot2_f32_bf16 v27, v255, v255, v27
    s_nop 2
    v_add_f32 v24, v24, v26
    v_add_f32 v25, v25, v27
    s_nop 1
    v_add_f32_dpp v24, v24, v24 row_ror:8 row_mask:0xf bank_mask:0xf
    v_add_f32_dpp v25, v25, v25 row_ror:8 row_mask:0xf bank_mask:0xf
    v_mov_b32 v26, v24
    v_mov_b32 v27, v25
    s_nop 1
    v_permlane16_swap_b32 v24, v26
    v_permlane16_swap_b32 v25, v27
    s_nop 1
    v_add_f32 v24, v24, v26
    v_add_f32 v25, v25, v27
    v_mov_b32 v26, v24
    v_mov_b32 v27, v25
    s_nop 1
    v_permlane32_swap_b32 v24, v26
    v_permlane32_swap_b32 v25, v27
    s_nop 1
    v_add_f32 v24, v24, v26
    v_add_f32 v25, v25, v27
    v_lshlrev_b32 v28, 5, v18
    v_add_u32 v28, 147456, v28
    v_lshl_add_u32 v29, v1, 3, v28
    ds_write_b64 v29, v[24:25]
    s_add_u32 s12, s40, 0x480000
    s_addc_u32 s13, s41, 0
    s_mov_b32 s14, 0x240000
    s_mov_b32 s15, 0x20000
    buffer_store_dwordx2 v[244:245], v22, s[12:15], 0 offen offset:0
    buffer_store_dwordx2 v[246:247], v22, s[12:15], 0 offen offset:32
    buffer_store_dwordx2 v[248:249], v22, s[12:15], 0 offen offset:384
    buffer_store_dwordx2 v[250:251], v22, s[12:15], 0 offen offset:416
    buffer_store_dwordx2 v[252:253], v22, s[12:15], 0 offen offset:768
    buffer_store_dwordx2 v[254:255], v22, s[12:15], 0 offen offset:800
    v_lshlrev_b32 v30, 10, v20
    v_lshl_add_u32 v30, v19, 8, v30
    v_lshl_add_u32 v30, v18, 4, v30
    s_lshr_b32 s58, s56, 1
    s_mul_i32 s58, s58, 18432
    s_and_b32 s59, s56, 1
    s_lshl_b32 s59, s59, 7
    s_add_u32 s58, s58, s59
    v_add_u32 v30, s58, v30
    s_waitcnt lgkmcnt(0)
    s_barrier
    ds_read_b128 v[24:27], v28
    ds_read_b64 v[8:9], v28 offset:16
    s_add_u32 s12, s40, 0x240000
    s_addc_u32 s13, s41, 0
    s_mov_b32 s14, 0x240000
    s_mov_b32 s15, 0x20000
    s_waitcnt lgkmcnt(0)
    v_add_f32 v24, v24, v26
    v_add_f32 v25, v25, v27
    v_add_f32 v24, v24, v8
    v_add_f32 v25, v25, v9
    v_mul_f32 v24, 0x3ae38e39, v24
    v_mul_f32 v25, 0x3ae38e39, v25
    v_fma_f32 v25, -v24, v24, v25
    v_max_f32 v25, 0, v25
    v_cvt_pk_bf16_f32 v24, v24, v24
    v_lshlrev_b32 v24, 16, v24
    v_cvt_pk_bf16_f32 v25, v25, v25
    v_lshlrev_b32 v25, 16, v25
    v_add_f32 v25, 0x3727c5ac, v25
    v_cvt_pk_bf16_f32 v25, v25, v25
    v_lshlrev_b32 v25, 16, v25
    v_sqrt_f32 v25, v25
    s_waitcnt vmcnt(6)
    v_pk_mul_f32 v[100:101], v[100:101], s[54:55]
    v_pk_mul_f32 v[102:103], v[102:103], s[54:55]
    v_pk_mul_f32 v[104:105], v[104:105], s[54:55]
    v_pk_mul_f32 v[106:107], v[106:107], s[54:55]
    v_pk_mul_f32 v[108:109], v[108:109], s[54:55]
    v_pk_mul_f32 v[110:111], v[110:111], s[54:55]
    v_pk_mul_f32 v[112:113], v[112:113], s[54:55]
    v_pk_mul_f32 v[114:115], v[114:115], s[54:55]
    v_pk_mul_f32 v[116:117], v[116:117], s[54:55]
    v_pk_mul_f32 v[118:119], v[118:119], s[54:55]
    v_pk_mul_f32 v[120:121], v[120:121], s[54:55]
    v_pk_mul_f32 v[122:123], v[122:123], s[54:55]
    v_pk_mul_f32 v[124:125], v[124:125], s[54:55]
    v_pk_mul_f32 v[126:127], v[126:127], s[54:55]
    v_pk_mul_f32 v[128:129], v[128:129], s[54:55]
    v_pk_mul_f32 v[130:131], v[130:131], s[54:55]
    v_pk_mul_f32 v[132:133], v[132:133], s[54:55]
    v_pk_mul_f32 v[134:135], v[134:135], s[54:55]
    v_pk_mul_f32 v[136:137], v[136:137], s[54:55]
    v_pk_mul_f32 v[138:139], v[138:139], s[54:55]
    v_pk_mul_f32 v[140:141], v[140:141], s[54:55]
    v_pk_mul_f32 v[142:143], v[142:143], s[54:55]
    v_pk_mul_f32 v[144:145], v[144:145], s[54:55]
    v_pk_mul_f32 v[146:147], v[146:147], s[54:55]
    v_cvt_pk_bf16_f32 v25, v25, v25
    v_lshlrev_b32 v25, 16, v25
    v_rcp_f32 v26, v25
    s_nop 0
    v_mul_f32 v24, v24, v26
    v_sub_f32 v24, 0, v24
    v_pk_fma_f32 v[40:41], v[40:41], v[26:27], v[24:25] op_sel_hi:[1,0,0]
    v_pk_fma_f32 v[42:43], v[42:43], v[26:27], v[24:25] op_sel_hi:[1,0,0]
    v_pk_fma_f32 v[44:45], v[44:45], v[26:27], v[24:25] op_sel_hi:[1,0,0]
    v_pk_fma_f32 v[46:47], v[46:47], v[26:27], v[24:25] op_sel_hi:[1,0,0]
    v_pk_fma_f32 v[40:41], v[40:41], v[100:101], v[124:125]
    v_pk_fma_f32 v[42:43], v[42:43], v[102:103], v[126:127]
    v_pk_fma_f32 v[44:45], v[44:45], v[104:105], v[128:129]
    v_pk_fma_f32 v[46:47], v[46:47], v[106:107], v[130:131]
    v_cvt_pk_bf16_f32 v152, v40, v41
    v_cvt_pk_bf16_f32 v153, v42, v43
    v_cvt_pk_bf16_f32 v154, v44, v45
    v_cvt_pk_bf16_f32 v155, v46, v47
    s_movk_i32 s59, 0
    buffer_store_dwordx4 v[152:155], v30, s[12:15], s59 offen sc1
    v_pk_fma_f32 v[48:49], v[48:49], v[26:27], v[24:25] op_sel_hi:[1,0,0]
    v_pk_fma_f32 v[50:51], v[50:51], v[26:27], v[24:25] op_sel_hi:[1,0,0]
    v_pk_fma_f32 v[52:53], v[52:53], v[26:27], v[24:25] op_sel_hi:[1,0,0]
    v_pk_fma_f32 v[54:55], v[54:55], v[26:27], v[24:25] op_sel_hi:[1,0,0]
    v_pk_fma_f32 v[48:49], v[48:49], v[108:109], v[132:133]
    v_pk_fma_f32 v[50:51], v[50:51], v[110:111], v[134:135]
    v_pk_fma_f32 v[52:53], v[52:53], v[112:113], v[136:137]
    v_pk_fma_f32 v[54:55], v[54:55], v[114:115], v[138:139]
    v_cvt_pk_bf16_f32 v156, v48, v49
    v_cvt_pk_bf16_f32 v157, v50, v51
    v_cvt_pk_bf16_f32 v158, v52, v53
    v_cvt_pk_bf16_f32 v159, v54, v55
    s_movk_i32 s59, 6144
    buffer_store_dwordx4 v[156:159], v30, s[12:15], s59 offen sc1
    v_pk_fma_f32 v[56:57], v[56:57], v[26:27], v[24:25] op_sel_hi:[1,0,0]
    v_pk_fma_f32 v[58:59], v[58:59], v[26:27], v[24:25] op_sel_hi:[1,0,0]
    v_pk_fma_f32 v[60:61], v[60:61], v[26:27], v[24:25] op_sel_hi:[1,0,0]
    v_pk_fma_f32 v[62:63], v[62:63], v[26:27], v[24:25] op_sel_hi:[1,0,0]
    v_pk_fma_f32 v[56:57], v[56:57], v[116:117], v[140:141]
    v_pk_fma_f32 v[58:59], v[58:59], v[118:119], v[142:143]
    v_pk_fma_f32 v[60:61], v[60:61], v[120:121], v[144:145]
    v_pk_fma_f32 v[62:63], v[62:63], v[122:123], v[146:147]
    v_cvt_pk_bf16_f32 v160, v56, v57
    v_cvt_pk_bf16_f32 v161, v58, v59
    v_cvt_pk_bf16_f32 v162, v60, v61
    v_cvt_pk_bf16_f32 v163, v62, v63
    s_movk_i32 s59, 12288
    buffer_store_dwordx4 v[160:163], v30, s[12:15], s59 offen sc1
    v_and_b32 v7, 3, v2
    s_mul_i32 s58, s44, 331776
    s_add_u32 s20, s36, s58
    s_addc_u32 s21, s37, 0
    s_mov_b32 s22, 0x51000
    s_mov_b32 s23, 0x20000
    s_mul_i32 s58, s44, 2359296
    s_mul_i32 s59, s45, 147456
    s_add_u32 s58, s58, s59
    s_add_u32 s58, s58, 45088768
    s_add_u32 s32, s40, s58
    s_addc_u32 s33, s41, 0
    s_mov_b32 s34, 0x24000
    s_mov_b32 s35, 0x20000
    v_lshrrev_b32 v1, 4, v2
    v_bfe_u32 v6, v2, 2, 4
    v_lshlrev_b32 v7, 3, v7
    v_mul_u32_u24 v44, 192, v6
    v_add_u32 v44, v44, v7
    v_and_b32 v45, 1, v1
    v_lshl_add_u32 v8, v45, 5, v44
    v_xor_b32 v45, 1, v45
    v_lshl_add_u32 v9, v45, 5, v44
    v_add_u32 v10, 36864, v8
    v_add_u32 v11, 36864, v9
    v_add_u32 v12, 73728, v8
    v_add_u32 v13, 73728, v9
    v_add_u32 v14, 110592, v8
    v_add_u32 v15, 110592, v9
    v_lshl_add_u32 v44, v6, 7, v7
    v_bfe_u32 v45, v6, 1, 2
    v_xor_b32 v46, 0, v45
    v_lshl_add_u32 v16, v46, 5, v44
    v_add_u32 v20, 36864, v16
    v_add_u32 v24, 73728, v16
    v_add_u32 v28, 110592, v16
    v_xor_b32 v46, 1, v45
    v_lshl_add_u32 v17, v46, 5, v44
    v_add_u32 v21, 36864, v17
    v_add_u32 v25, 73728, v17
    v_add_u32 v29, 110592, v17
    v_xor_b32 v46, 2, v45
    v_lshl_add_u32 v18, v46, 5, v44
    v_add_u32 v22, 36864, v18
    v_add_u32 v26, 73728, v18
    v_add_u32 v30, 110592, v18
    v_xor_b32 v46, 3, v45
    v_lshl_add_u32 v19, v46, 5, v44
    v_add_u32 v23, 36864, v19
    v_add_u32 v27, 73728, v19
    v_add_u32 v31, 110592, v19
    v_lshrrev_b32 v41, 3, v2
    s_mul_i32 s58, s46, 72
    v_add_u32 v41, s58, v41
    v_mul_u32_u24 v41, 1152, v41
    v_and_b32 v44, 7, v2
    v_lshlrev_b32 v45, 1, v1
    v_xor_b32 v45, v45, v44
    v_lshl_add_u32 v35, v45, 4, v41
    v_add_u32 v36, 8192, v35
    v_add_u32 v37, 16384, v35
    v_bfe_u32 v41, v2, 3, 1
    s_lshl_b32 s58, s46, 2
    v_add_u32 v41, s58, v41
    v_mul_u32_u24 v41, 9216, v41
    v_lshl_add_u32 v41, v1, 7, v41
    v_lshl_add_u32 v38, v44, 4, v41
    s_waitcnt vmcnt(0)
    s_barrier
    s_branch k4_kernel_go
k4_kernel_w3:
    v_and_b32 v48, 15, v2
    v_lshlrev_b32 v48, 2, v48
    s_mov_b32 s56, 0x80000
k4_kernel_poll1:
    buffer_load_dword v51, v48, s[28:31], 0 offen sc1
    s_waitcnt vmcnt(0)
    v_cmp_ne_u32 vcc, 1, v51
    s_sub_u32 s56, s56, 1
    s_cbranch_scc1 k4_kernel_got1
    s_cbranch_vccz k4_kernel_got1
    s_sleep 2
    s_branch k4_kernel_poll1
k4_kernel_got1:
    s_barrier
    s_add_u32 m0, s47, 0
    s_mov_b32 s50, 0
    buffer_load_dwordx4 v32, s[16:19], s50 offen offset:0 lds
    buffer_load_dwordx4 v33, s[16:19], s50 offen offset:1024 lds
    buffer_load_dwordx4 v34, s[16:19], s50 offen offset:2048 lds
    s_add_u32 m0, s47, 3072
    s_mov_b32 s50, 147456
    buffer_load_dwordx4 v32, s[16:19], s50 offen offset:0 lds
    buffer_load_dwordx4 v33, s[16:19], s50 offen offset:1024 lds
    buffer_load_dwordx4 v34, s[16:19], s50 offen offset:2048 lds
    s_add_u32 m0, s47, 6144
    s_mov_b32 s50, 294912
    buffer_load_dwordx4 v32, s[16:19], s50 offen offset:0 lds
    buffer_load_dwordx4 v33, s[16:19], s50 offen offset:1024 lds
    buffer_load_dwordx4 v34, s[16:19], s50 offen offset:2048 lds
    s_add_u32 m0, s47, 36864
    s_mov_b32 s50, 884736
    buffer_load_dwordx4 v32, s[16:19], s50 offen offset:0 lds
    buffer_load_dwordx4 v33, s[16:19], s50 offen offset:1024 lds
    buffer_load_dwordx4 v34, s[16:19], s50 offen offset:2048 lds
    s_add_u32 m0, s47, 39936
    s_mov_b32 s50, 1032192
    buffer_load_dwordx4 v32, s[16:19], s50 offen offset:0 lds
    buffer_load_dwordx4 v33, s[16:19], s50 offen offset:1024 lds
    buffer_load_dwordx4 v34, s[16:19], s50 offen offset:2048 lds
    s_add_u32 m0, s47, 43008
    s_mov_b32 s50, 1179648
    buffer_load_dwordx4 v32, s[16:19], s50 offen offset:0 lds
    buffer_load_dwordx4 v33, s[16:19], s50 offen offset:1024 lds
    buffer_load_dwordx4 v34, s[16:19], s50 offen offset:2048 lds
    s_add_u32 m0, s47, 73728
    s_mov_b32 s50, 1769472
    buffer_load_dwordx4 v32, s[16:19], s50 offen offset:0 lds
    buffer_load_dwordx4 v33, s[16:19], s50 offen offset:1024 lds
    buffer_load_dwordx4 v34, s[16:19], s50 offen offset:2048 lds
    s_add_u32 m0, s47, 76800
    s_mov_b32 s50, 1916928
    buffer_load_dwordx4 v32, s[16:19], s50 offen offset:0 lds
    buffer_load_dwordx4 v33, s[16:19], s50 offen offset:1024 lds
    buffer_load_dwordx4 v34, s[16:19], s50 offen offset:2048 lds
    s_add_u32 m0, s47, 79872
    s_mov_b32 s50, 2064384
    buffer_load_dwordx4 v32, s[16:19], s50 offen offset:0 lds
    buffer_load_dwordx4 v33, s[16:19], s50 offen offset:1024 lds
    buffer_load_dwordx4 v34, s[16:19], s50 offen offset:2048 lds
    s_add_u32 m0, s47, 110592
    s_mov_b32 s50, 2654208
    buffer_load_dwordx4 v32, s[16:19], s50 offen offset:0 lds
    buffer_load_dwordx4 v33, s[16:19], s50 offen offset:1024 lds
    buffer_load_dwordx4 v34, s[16:19], s50 offen offset:2048 lds
    s_add_u32 m0, s47, 113664
    s_mov_b32 s50, 2801664
    buffer_load_dwordx4 v32, s[16:19], s50 offen offset:0 lds
    buffer_load_dwordx4 v33, s[16:19], s50 offen offset:1024 lds
    buffer_load_dwordx4 v34, s[16:19], s50 offen offset:2048 lds
    s_add_u32 m0, s47, 116736
    s_mov_b32 s50, 2949120
    buffer_load_dwordx4 v32, s[16:19], s50 offen offset:0 lds
    buffer_load_dwordx4 v33, s[16:19], s50 offen offset:1024 lds
    buffer_load_dwordx4 v34, s[16:19], s50 offen offset:2048 lds
    v_and_b32 v7, 3, v2
    s_mul_i32 s58, s44, 331776
    s_add_u32 s20, s36, s58
    s_addc_u32 s21, s37, 0
    s_mov_b32 s22, 0x51000
    s_mov_b32 s23, 0x20000
    s_mul_i32 s58, s44, 2359296
    s_mul_i32 s59, s45, 147456
    s_add_u32 s58, s58, s59
    s_add_u32 s58, s58, 45088768
    s_add_u32 s32, s40, s58
    s_addc_u32 s33, s41, 0
    s_mov_b32 s34, 0x24000
    s_mov_b32 s35, 0x20000
    v_lshrrev_b32 v1, 4, v2
    v_bfe_u32 v6, v2, 2, 4
    v_lshlrev_b32 v7, 3, v7
    v_mul_u32_u24 v44, 192, v6
    v_add_u32 v44, v44, v7
    v_and_b32 v45, 1, v1
    v_lshl_add_u32 v8, v45, 5, v44
    v_xor_b32 v45, 1, v45
    v_lshl_add_u32 v9, v45, 5, v44
    v_add_u32 v10, 36864, v8
    v_add_u32 v11, 36864, v9
    v_add_u32 v12, 73728, v8
    v_add_u32 v13, 73728, v9
    v_add_u32 v14, 110592, v8
    v_add_u32 v15, 110592, v9
    v_lshl_add_u32 v44, v6, 7, v7
    v_bfe_u32 v45, v6, 1, 2
    v_xor_b32 v46, 0, v45
    v_lshl_add_u32 v16, v46, 5, v44
    v_add_u32 v20, 36864, v16
    v_add_u32 v24, 73728, v16
    v_add_u32 v28, 110592, v16
    v_xor_b32 v46, 1, v45
    v_lshl_add_u32 v17, v46, 5, v44
    v_add_u32 v21, 36864, v17
    v_add_u32 v25, 73728, v17
    v_add_u32 v29, 110592, v17
    v_xor_b32 v46, 2, v45
    v_lshl_add_u32 v18, v46, 5, v44
    v_add_u32 v22, 36864, v18
    v_add_u32 v26, 73728, v18
    v_add_u32 v30, 110592, v18
    v_xor_b32 v46, 3, v45
    v_lshl_add_u32 v19, v46, 5, v44
    v_add_u32 v23, 36864, v19
    v_add_u32 v27, 73728, v19
    v_add_u32 v31, 110592, v19
    v_lshrrev_b32 v41, 3, v2
    s_mul_i32 s58, s46, 72
    v_add_u32 v41, s58, v41
    v_mul_u32_u24 v41, 1152, v41
    v_and_b32 v44, 7, v2
    v_lshlrev_b32 v45, 1, v1
    v_xor_b32 v45, v45, v44
    v_lshl_add_u32 v35, v45, 4, v41
    v_add_u32 v36, 8192, v35
    v_add_u32 v37, 16384, v35
    v_bfe_u32 v41, v2, 3, 1
    s_lshl_b32 s58, s46, 2
    v_add_u32 v41, s58, v41
    v_mul_u32_u24 v41, 9216, v41
    v_lshl_add_u32 v41, v1, 7, v41
    v_lshl_add_u32 v38, v44, 4, v41
    v_and_b32 v48, 15, v2
    v_lshlrev_b32 v48, 2, v48
    s_lshl_b32 s58, s44, 2
    v_mov_b32 v49, s58
    v_mov_b32 v50, 1
    s_mov_b32 s56, 0x80000
    s_waitcnt vmcnt(0)
    s_barrier
    s_barrier
    s_mov_b64 exec, 1
    buffer_store_dword v50, v49, s[60:63], 0 offen sc1
    s_mov_b64 exec, -1
k4_kernel_poll:
    buffer_load_dword v51, v48, s[60:63], 0 offen sc1
    s_waitcnt vmcnt(0)
    v_cmp_ne_u32 vcc, 1, v51
    s_sub_u32 s56, s56, 1
    s_cbranch_scc1 k4_kernel_go
    s_cbranch_vccz k4_kernel_go
    s_sleep 2
    s_branch k4_kernel_poll
k4_kernel_go:
    s_barrier
    s_mov_b32 s59, 0
    buffer_load_dwordx4 a[0:3], v39, s[24:27], s59 offen offset:0 sc1
    s_mov_b32 s59, 16384
    buffer_load_dwordx4 a[72:75], v39, s[24:27], s59 offen offset:2048 sc1
    s_mov_b32 s59, 0
    buffer_load_dwordx4 a[4:7], v39, s[24:27], s59 offen offset:1024 sc1
    s_mov_b32 s59, 16384
    buffer_load_dwordx4 a[76:79], v39, s[24:27], s59 offen offset:3072 sc1
    s_mov_b32 s59, 0
    buffer_load_dwordx4 a[8:11], v39, s[24:27], s59 offen offset:2048 sc1
    s_mov_b32 s59, 20480
    buffer_load_dwordx4 a[80:83], v39, s[24:27], s59 offen offset:0 sc1
    s_mov_b32 s59, 0
    buffer_load_dwordx4 a[12:15], v39, s[24:27], s59 offen offset:3072 sc1
    s_mov_b32 s59, 20480
    buffer_load_dwordx4 a[84:87], v39, s[24:27], s59 offen offset:1024 sc1
    s_getpc_b64 s[60:61]
    s_lshr_b32 s62, s2, 3
    s_lshl_b32 s62, s62, 2
    s_add_u32 s62, s62, s46
    s_mul_i32 s63, s62, 10923
    s_lshr_b32 s63, s63, 16
    s_mul_i32 s63, s63, 6
    s_sub_u32 s62, s62, s63
    s_lshl_b32 s62, s62, 13
    v_lshlrev_b32 v61, 7, v2
    v_add_u32 v61, s62, v61
    ds_read_b64_tr_b16 a[192:193], v8 offset:0
    ds_read_b64_tr_b16 a[194:195], v8 offset:3072
    ds_read_b64_tr_b16 a[196:197], v8 offset:18432
    ds_read_b64_tr_b16 a[198:199], v8 offset:21504
    ds_read_b64_tr_b16 a[200:201], v9 offset:0
    ds_read_b64_tr_b16 a[202:203], v9 offset:3072
    ds_read_b64_tr_b16 a[204:205], v9 offset:18432
    ds_read_b64_tr_b16 a[206:207], v9 offset:21504
    ds_read_b64_tr_b16 a[208:209], v8 offset:64
    ds_read_b64_tr_b16 a[210:211], v8 offset:3136
    ds_read_b64_tr_b16 a[212:213], v8 offset:18496
    ds_read_b64_tr_b16 a[214:215], v8 offset:21568
    ds_read_b64_tr_b16 a[216:217], v9 offset:64
    ds_read_b64_tr_b16 a[218:219], v9 offset:3136
    ds_read_b64_tr_b16 a[220:221], v9 offset:18496
    ds_read_b64_tr_b16 a[222:223], v9 offset:21568
    ds_read_b64_tr_b16 a[224:225], v8 offset:128
    ds_read_b64_tr_b16 a[226:227], v8 offset:3200
    ds_read_b64_tr_b16 a[228:229], v8 offset:18560
    ds_read_b64_tr_b16 a[230:231], v8 offset:21632
    ds_read_b64_tr_b16 a[232:233], v9 offset:128
    ds_read_b64_tr_b16 a[234:235], v9 offset:3200
    ds_read_b64_tr_b16 a[236:237], v9 offset:18560
    ds_read_b64_tr_b16 a[238:239], v9 offset:21632
    s_waitcnt vmcnt(6) lgkmcnt(15)
    v_mfma_f32_16x16x32_bf16 v[64:67], a[192:195], a[0:3], 0
    ds_read_b64_tr_b16 a[240:241], v8 offset:6144
    v_mfma_f32_16x16x32_bf16 v[68:71], a[192:195], a[72:75], 0
    ds_read_b64_tr_b16 a[242:243], v8 offset:9216
    v_mfma_f32_16x16x32_bf16 v[112:115], a[196:199], a[0:3], 0
    ds_read_b64_tr_b16 a[244:245], v8 offset:24576
    s_mov_b32 s59, 4096
    v_mfma_f32_16x16x32_bf16 v[116:119], a[196:199], a[72:75], 0
    buffer_load_dwordx4 a[16:19], v39, s[24:27], s59 offen offset:0 sc1
    ds_read_b64_tr_b16 a[246:247], v8 offset:27648
    v_mfma_f32_16x16x32_bf16 v[72:75], a[200:203], a[0:3], 0
    ds_read_b64_tr_b16 a[248:249], v9 offset:6144
    v_mfma_f32_16x16x32_bf16 v[76:79], a[200:203], a[72:75], 0
    s_mov_b32 s59, 20480
    ds_read_b64_tr_b16 a[250:251], v9 offset:9216
    v_mfma_f32_16x16x32_bf16 v[120:123], a[204:207], a[0:3], 0
    ds_read_b64_tr_b16 a[252:253], v9 offset:24576
    buffer_load_dwordx4 a[88:91], v39, s[24:27], s59 offen offset:2048 sc1
    v_mfma_f32_16x16x32_bf16 v[124:127], a[204:207], a[72:75], 0
    ds_read_b64_tr_b16 a[254:255], v9 offset:27648
    s_waitcnt lgkmcnt(15)
    v_mfma_f32_16x16x32_bf16 v[80:83], a[208:211], a[0:3], 0
    ds_read_b64_tr_b16 a[192:193], v8 offset:6208
    s_mov_b32 s59, 4096
    v_mfma_f32_16x16x32_bf16 v[84:87], a[208:211], a[72:75], 0
    buffer_load_dwordx4 a[20:23], v39, s[24:27], s59 offen offset:1024 sc1
    ds_read_b64_tr_b16 a[194:195], v8 offset:9280
    v_mfma_f32_16x16x32_bf16 v[128:131], a[212:215], a[0:3], 0
    ds_read_b64_tr_b16 a[196:197], v8 offset:24640
    v_mfma_f32_16x16x32_bf16 v[132:135], a[212:215], a[72:75], 0
    s_mov_b32 s59, 20480
    ds_read_b64_tr_b16 a[198:199], v8 offset:27712
    v_mfma_f32_16x16x32_bf16 v[88:91], a[216:219], a[0:3], 0
    ds_read_b64_tr_b16 a[200:201], v9 offset:6208
    buffer_load_dwordx4 a[92:95], v39, s[24:27], s59 offen offset:3072 sc1
    v_mfma_f32_16x16x32_bf16 v[92:95], a[216:219], a[72:75], 0
    ds_read_b64_tr_b16 a[202:203], v9 offset:9280
    v_mfma_f32_16x16x32_bf16 v[136:139], a[220:223], a[0:3], 0
    ds_read_b64_tr_b16 a[204:205], v9 offset:24640
    s_mov_b32 s59, 4096
    v_mfma_f32_16x16x32_bf16 v[140:143], a[220:223], a[72:75], 0
    buffer_load_dwordx4 a[24:27], v39, s[24:27], s59 offen offset:2048 sc1
    ds_read_b64_tr_b16 a[206:207], v9 offset:27712
    s_waitcnt lgkmcnt(15)
    v_mfma_f32_16x16x32_bf16 v[96:99], a[224:227], a[0:3], 0
    ds_read_b64_tr_b16 a[208:209], v8 offset:6272
    v_mfma_f32_16x16x32_bf16 v[100:103], a[224:227], a[72:75], 0
    s_mov_b32 s59, 24576
    ds_read_b64_tr_b16 a[210:211], v8 offset:9344
    v_mfma_f32_16x16x32_bf16 v[144:147], a[228:231], a[0:3], 0
    ds_read_b64_tr_b16 a[212:213], v8 offset:24704
    buffer_load_dwordx4 a[96:99], v39, s[24:27], s59 offen offset:0 sc1
    v_mfma_f32_16x16x32_bf16 v[148:151], a[228:231], a[72:75], 0
    ds_read_b64_tr_b16 a[214:215], v8 offset:27776
    v_mfma_f32_16x16x32_bf16 v[104:107], a[232:235], a[0:3], 0
    ds_read_b64_tr_b16 a[216:217], v9 offset:6272
    s_mov_b32 s59, 4096
    v_mfma_f32_16x16x32_bf16 v[108:111], a[232:235], a[72:75], 0
    buffer_load_dwordx4 a[28:31], v39, s[24:27], s59 offen offset:3072 sc1
    ds_read_b64_tr_b16 a[218:219], v9 offset:9344
    v_mfma_f32_16x16x32_bf16 v[152:155], a[236:239], a[0:3], 0
    ds_read_b64_tr_b16 a[220:221], v9 offset:24704
    v_mfma_f32_16x16x32_bf16 v[156:159], a[236:239], a[72:75], 0
    s_mov_b32 s59, 24576
    ds_read_b64_tr_b16 a[222:223], v9 offset:27776
    s_waitcnt vmcnt(11) lgkmcnt(15)
    v_mfma_f32_16x16x32_bf16 v[64:67], a[240:243], a[4:7], v[64:67]
    ds_read_b64_tr_b16 a[224:225], v8 offset:12288
    buffer_load_dwordx4 a[100:103], v39, s[24:27], s59 offen offset:1024 sc1
    v_mfma_f32_16x16x32_bf16 v[68:71], a[240:243], a[76:79], v[68:71]
    ds_read_b64_tr_b16 a[226:227], v8 offset:15360
    v_mfma_f32_16x16x32_bf16 v[112:115], a[244:247], a[4:7], v[112:115]
    ds_read_b64_tr_b16 a[228:229], v8 offset:30720
    s_mov_b32 s59, 8192
    v_mfma_f32_16x16x32_bf16 v[116:119], a[244:247], a[76:79], v[116:119]
    buffer_load_dwordx4 a[32:35], v39, s[24:27], s59 offen offset:0 sc1
    ds_read_b64_tr_b16 a[230:231], v8 offset:33792
    v_mfma_f32_16x16x32_bf16 v[72:75], a[248:251], a[4:7], v[72:75]
    ds_read_b64_tr_b16 a[232:233], v9 offset:12288
    v_mfma_f32_16x16x32_bf16 v[76:79], a[248:251], a[76:79], v[76:79]
    s_mov_b32 s59, 24576
    ds_read_b64_tr_b16 a[234:235], v9 offset:15360
    v_mfma_f32_16x16x32_bf16 v[120:123], a[252:255], a[4:7], v[120:123]
    ds_read_b64_tr_b16 a[236:237], v9 offset:30720
    buffer_load_dwordx4 a[104:107], v39, s[24:27], s59 offen offset:2048 sc1
    v_mfma_f32_16x16x32_bf16 v[124:127], a[252:255], a[76:79], v[124:127]
    ds_read_b64_tr_b16 a[238:239], v9 offset:33792
    s_waitcnt lgkmcnt(15)
    v_mfma_f32_16x16x32_bf16 v[80:83], a[192:195], a[4:7], v[80:83]
    ds_read_b64_tr_b16 a[240:241], v8 offset:12352
    v_mfma_f32_16x16x32_bf16 v[84:87], a[192:195], a[76:79], v[84:87]
    ds_read_b64_tr_b16 a[242:243], v8 offset:15424
    v_mfma_f32_16x16x32_bf16 v[128:131], a[196:199], a[4:7], v[128:131]
    ds_read_b64_tr_b16 a[244:245], v8 offset:30784
    v_mfma_f32_16x16x32_bf16 v[132:135], a[196:199], a[76:79], v[132:135]
    ds_read_b64_tr_b16 a[246:247], v8 offset:33856
    v_mfma_f32_16x16x32_bf16 v[88:91], a[200:203], a[4:7], v[88:91]
    ds_read_b64_tr_b16 a[248:249], v9 offset:12352
    v_mfma_f32_16x16x32_bf16 v[92:95], a[200:203], a[76:79], v[92:95]
    ds_read_b64_tr_b16 a[250:251], v9 offset:15424
    v_mfma_f32_16x16x32_bf16 v[136:139], a[204:207], a[4:7], v[136:139]
    ds_read_b64_tr_b16 a[252:253], v9 offset:30784
    v_mfma_f32_16x16x32_bf16 v[140:143], a[204:207], a[76:79], v[140:143]
    ds_read_b64_tr_b16 a[254:255], v9 offset:33856
    s_waitcnt lgkmcnt(15)
    v_mfma_f32_16x16x32_bf16 v[96:99], a[208:211], a[4:7], v[96:99]
    ds_read_b64_tr_b16 a[192:193], v8 offset:12416
    v_mfma_f32_16x16x32_bf16 v[100:103], a[208:211], a[76:79], v[100:103]
    ds_read_b64_tr_b16 a[194:195], v8 offset:15488
    v_mfma_f32_16x16x32_bf16 v[144:147], a[212:215], a[4:7], v[144:147]
    ds_read_b64_tr_b16 a[196:197], v8 offset:30848
    v_mfma_f32_16x16x32_bf16 v[148:151], a[212:215], a[76:79], v[148:151]
    ds_read_b64_tr_b16 a[198:199], v8 offset:33920
    v_mfma_f32_16x16x32_bf16 v[104:107], a[216:219], a[4:7], v[104:107]
    ds_read_b64_tr_b16 a[200:201], v9 offset:12416
    v_mfma_f32_16x16x32_bf16 v[108:111], a[216:219], a[76:79], v[108:111]
    ds_read_b64_tr_b16 a[202:203], v9 offset:15488
    v_mfma_f32_16x16x32_bf16 v[152:155], a[220:223], a[4:7], v[152:155]
    ds_read_b64_tr_b16 a[204:205], v9 offset:30848
    v_mfma_f32_16x16x32_bf16 v[156:159], a[220:223], a[76:79], v[156:159]
    ds_read_b64_tr_b16 a[206:207], v9 offset:33920
    s_barrier
    s_waitcnt vmcnt(12) lgkmcnt(15)
    v_mfma_f32_16x16x32_bf16 v[64:67], a[224:227], a[8:11], v[64:67]
    ds_read_b64_tr_b16 a[208:209], v10 offset:0
    v_mfma_f32_16x16x32_bf16 v[68:71], a[224:227], a[80:83], v[68:71]
    s_mov_b32 s59, 8192
    ds_read_b64_tr_b16 a[210:211], v10 offset:3072
    v_mfma_f32_16x16x32_bf16 v[112:115], a[228:231], a[8:11], v[112:115]
    ds_read_b64_tr_b16 a[212:213], v10 offset:18432
    ds_read_b64_tr_b16 a[214:215], v10 offset:21504
    v_mfma_f32_16x16x32_bf16 v[116:119], a[228:231], a[80:83], v[116:119]
    buffer_load_dwordx4 a[36:39], v39, s[24:27], s59 offen offset:1024 sc1
    global_load_dword v60, v61, s[60:61]
    v_mfma_f32_16x16x32_bf16 v[72:75], a[232:235], a[8:11], v[72:75]
    ds_read_b64_tr_b16 a[216:217], v11 offset:0
    v_mfma_f32_16x16x32_bf16 v[76:79], a[232:235], a[80:83], v[76:79]
    s_mov_b32 s59, 24576
    ds_read_b64_tr_b16 a[218:219], v11 offset:3072
    v_mfma_f32_16x16x32_bf16 v[120:123], a[236:239], a[8:11], v[120:123]
    ds_read_b64_tr_b16 a[220:221], v11 offset:18432
    ds_read_b64_tr_b16 a[222:223], v11 offset:21504
    v_mfma_f32_16x16x32_bf16 v[124:127], a[236:239], a[80:83], v[124:127]
    buffer_load_dwordx4 a[108:111], v39, s[24:27], s59 offen offset:3072 sc1
    s_waitcnt lgkmcnt(15)
    v_mfma_f32_16x16x32_bf16 v[80:83], a[240:243], a[8:11], v[80:83]
    ds_read_b64_tr_b16 a[224:225], v10 offset:64
    v_mfma_f32_16x16x32_bf16 v[84:87], a[240:243], a[80:83], v[84:87]
    s_mov_b32 s59, 8192
    ds_read_b64_tr_b16 a[226:227], v10 offset:3136
    v_mfma_f32_16x16x32_bf16 v[128:131], a[244:247], a[8:11], v[128:131]
    ds_read_b64_tr_b16 a[228:229], v10 offset:18496
    ds_read_b64_tr_b16 a[230:231], v10 offset:21568
    v_mfma_f32_16x16x32_bf16 v[132:135], a[244:247], a[80:83], v[132:135]
    buffer_load_dwordx4 a[40:43], v39, s[24:27], s59 offen offset:2048 sc1
    v_mfma_f32_16x16x32_bf16 v[88:91], a[248:251], a[8:11], v[88:91]
    ds_read_b64_tr_b16 a[232:233], v11 offset:64
    v_mfma_f32_16x16x32_bf16 v[92:95], a[248:251], a[80:83], v[92:95]
    s_mov_b32 s59, 28672
    ds_read_b64_tr_b16 a[234:235], v11 offset:3136
    v_mfma_f32_16x16x32_bf16 v[136:139], a[252:255], a[8:11], v[136:139]
    ds_read_b64_tr_b16 a[236:237], v11 offset:18496
    ds_read_b64_tr_b16 a[238:239], v11 offset:21568
    v_mfma_f32_16x16x32_bf16 v[140:143], a[252:255], a[80:83], v[140:143]
    buffer_load_dwordx4 a[112:115], v39, s[24:27], s59 offen offset:0 sc1
    s_waitcnt lgkmcnt(15)
    v_mfma_f32_16x16x32_bf16 v[96:99], a[192:195], a[8:11], v[96:99]
    ds_read_b64_tr_b16 a[240:241], v10 offset:128
    v_mfma_f32_16x16x32_bf16 v[100:103], a[192:195], a[80:83], v[100:103]
    s_mov_b32 s59, 8192
    ds_read_b64_tr_b16 a[242:243], v10 offset:3200
    v_mfma_f32_16x16x32_bf16 v[144:147], a[196:199], a[8:11], v[144:147]
    ds_read_b64_tr_b16 a[244:245], v10 offset:18560
    ds_read_b64_tr_b16 a[246:247], v10 offset:21632
    v_mfma_f32_16x16x32_bf16 v[148:151], a[196:199], a[80:83], v[148:151]
    buffer_load_dwordx4 a[44:47], v39, s[24:27], s59 offen offset:3072 sc1
    v_mfma_f32_16x16x32_bf16 v[104:107], a[200:203], a[8:11], v[104:107]
    ds_read_b64_tr_b16 a[248:249], v11 offset:128
    v_mfma_f32_16x16x32_bf16 v[108:111], a[200:203], a[80:83], v[108:111]
    s_mov_b32 s59, 28672
    ds_read_b64_tr_b16 a[250:251], v11 offset:3200
    v_mfma_f32_16x16x32_bf16 v[152:155], a[204:207], a[8:11], v[152:155]
    ds_read_b64_tr_b16 a[252:253], v11 offset:18560
    ds_read_b64_tr_b16 a[254:255], v11 offset:21632
    v_mfma_f32_16x16x32_bf16 v[156:159], a[204:207], a[80:83], v[156:159]
    buffer_load_dwordx4 a[116:119], v39, s[24:27], s59 offen offset:1024 sc1
    s_waitcnt vmcnt(17) lgkmcnt(15)
    v_mfma_f32_16x16x32_bf16 v[64:67], a[208:211], a[12:15], v[64:67]
    ds_read_b64_tr_b16 a[192:193], v10 offset:6144
    v_mfma_f32_16x16x32_bf16 v[68:71], a[208:211], a[84:87], v[68:71]
    s_mov_b32 s59, 12288
    ds_read_b64_tr_b16 a[194:195], v10 offset:9216
    v_mfma_f32_16x16x32_bf16 v[112:115], a[212:215], a[12:15], v[112:115]
    ds_read_b64_tr_b16 a[196:197], v10 offset:24576
    ds_read_b64_tr_b16 a[198:199], v10 offset:27648
    v_mfma_f32_16x16x32_bf16 v[116:119], a[212:215], a[84:87], v[116:119]
    buffer_load_dwordx4 a[48:51], v39, s[24:27], s59 offen offset:0 sc1
    v_mfma_f32_16x16x32_bf16 v[72:75], a[216:219], a[12:15], v[72:75]
    ds_read_b64_tr_b16 a[200:201], v11 offset:6144
    v_mfma_f32_16x16x32_bf16 v[76:79], a[216:219], a[84:87], v[76:79]
    s_mov_b32 s59, 28672
    ds_read_b64_tr_b16 a[202:203], v11 offset:9216
    v_mfma_f32_16x16x32_bf16 v[120:123], a[220:223], a[12:15], v[120:123]
    ds_read_b64_tr_b16 a[204:205], v11 offset:24576
    ds_read_b64_tr_b16 a[206:207], v11 offset:27648
    v_mfma_f32_16x16x32_bf16 v[124:127], a[220:223], a[84:87], v[124:127]
    buffer_load_dwordx4 a[120:123], v39, s[24:27], s59 offen offset:2048 sc1
    s_waitcnt lgkmcnt(15)
    v_mfma_f32_16x16x32_bf16 v[80:83], a[224:227], a[12:15], v[80:83]
    ds_read_b64_tr_b16 a[208:209], v10 offset:6208
    v_mfma_f32_16x16x32_bf16 v[84:87], a[224:227], a[84:87], v[84:87]
    s_mov_b32 s59, 12288
    ds_read_b64_tr_b16 a[210:211], v10 offset:9280
    v_mfma_f32_16x16x32_bf16 v[128:131], a[228:231], a[12:15], v[128:131]
    ds_read_b64_tr_b16 a[212:213], v10 offset:24640
    ds_read_b64_tr_b16 a[214:215], v10 offset:27712
    v_mfma_f32_16x16x32_bf16 v[132:135], a[228:231], a[84:87], v[132:135]
    buffer_load_dwordx4 a[52:55], v39, s[24:27], s59 offen offset:1024 sc1
    v_mfma_f32_16x16x32_bf16 v[88:91], a[232:235], a[12:15], v[88:91]
    ds_read_b64_tr_b16 a[216:217], v11 offset:6208
    v_mfma_f32_16x16x32_bf16 v[92:95], a[232:235], a[84:87], v[92:95]
    s_mov_b32 s59, 28672
    ds_read_b64_tr_b16 a[218:219], v11 offset:9280
    v_mfma_f32_16x16x32_bf16 v[136:139], a[236:239], a[12:15], v[136:139]
    ds_read_b64_tr_b16 a[220:221], v11 offset:24640
    ds_read_b64_tr_b16 a[222:223], v11 offset:27712
    v_mfma_f32_16x16x32_bf16 v[140:143], a[236:239], a[84:87], v[140:143]
    buffer_load_dwordx4 a[124:127], v39, s[24:27], s59 offen offset:3072 sc1
    s_waitcnt lgkmcnt(15)
    v_mfma_f32_16x16x32_bf16 v[96:99], a[240:243], a[12:15], v[96:99]
    ds_read_b64_tr_b16 a[224:225], v10 offset:6272
    v_mfma_f32_16x16x32_bf16 v[100:103], a[240:243], a[84:87], v[100:103]
    s_mov_b32 s59, 12288
    ds_read_b64_tr_b16 a[226:227], v10 offset:9344
    v_mfma_f32_16x16x32_bf16 v[144:147], a[244:247], a[12:15], v[144:147]
    ds_read_b64_tr_b16 a[228:229], v10 offset:24704
    ds_read_b64_tr_b16 a[230:231], v10 offset:27776
    v_mfma_f32_16x16x32_bf16 v[148:151], a[244:247], a[84:87], v[148:151]
    buffer_load_dwordx4 a[56:59], v39, s[24:27], s59 offen offset:2048 sc1
    v_mfma_f32_16x16x32_bf16 v[104:107], a[248:251], a[12:15], v[104:107]
    ds_read_b64_tr_b16 a[232:233], v11 offset:6272
    v_mfma_f32_16x16x32_bf16 v[108:111], a[248:251], a[84:87], v[108:111]
    s_mov_b32 s59, 32768
    ds_read_b64_tr_b16 a[234:235], v11 offset:9344
    v_mfma_f32_16x16x32_bf16 v[152:155], a[252:255], a[12:15], v[152:155]
    ds_read_b64_tr_b16 a[236:237], v11 offset:24704
    ds_read_b64_tr_b16 a[238:239], v11 offset:27776
    v_mfma_f32_16x16x32_bf16 v[156:159], a[252:255], a[84:87], v[156:159]
    buffer_load_dwordx4 a[128:131], v39, s[24:27], s59 offen offset:0 sc1
    s_waitcnt vmcnt(21) lgkmcnt(15)
    v_mfma_f32_16x16x32_bf16 v[64:67], a[192:195], a[16:19], v[64:67]
    ds_read_b64_tr_b16 a[240:241], v10 offset:12288
    v_mfma_f32_16x16x32_bf16 v[68:71], a[192:195], a[88:91], v[68:71]
    ds_read_b64_tr_b16 a[242:243], v10 offset:15360
    v_mfma_f32_16x16x32_bf16 v[112:115], a[196:199], a[16:19], v[112:115]
    ds_read_b64_tr_b16 a[244:245], v10 offset:30720
    v_mfma_f32_16x16x32_bf16 v[116:119], a[196:199], a[88:91], v[116:119]
    ds_read_b64_tr_b16 a[246:247], v10 offset:33792
    v_mfma_f32_16x16x32_bf16 v[72:75], a[200:203], a[16:19], v[72:75]
    ds_read_b64_tr_b16 a[248:249], v11 offset:12288
    v_mfma_f32_16x16x32_bf16 v[76:79], a[200:203], a[88:91], v[76:79]
    ds_read_b64_tr_b16 a[250:251], v11 offset:15360
    v_mfma_f32_16x16x32_bf16 v[120:123], a[204:207], a[16:19], v[120:123]
    ds_read_b64_tr_b16 a[252:253], v11 offset:30720
    v_mfma_f32_16x16x32_bf16 v[124:127], a[204:207], a[88:91], v[124:127]
    ds_read_b64_tr_b16 a[254:255], v11 offset:33792
    s_waitcnt lgkmcnt(15)
    v_mfma_f32_16x16x32_bf16 v[80:83], a[208:211], a[16:19], v[80:83]
    ds_read_b64_tr_b16 a[192:193], v10 offset:12352
    v_mfma_f32_16x16x32_bf16 v[84:87], a[208:211], a[88:91], v[84:87]
    ds_read_b64_tr_b16 a[194:195], v10 offset:15424
    v_mfma_f32_16x16x32_bf16 v[128:131], a[212:215], a[16:19], v[128:131]
    ds_read_b64_tr_b16 a[196:197], v10 offset:30784
    v_mfma_f32_16x16x32_bf16 v[132:135], a[212:215], a[88:91], v[132:135]
    ds_read_b64_tr_b16 a[198:199], v10 offset:33856
    v_mfma_f32_16x16x32_bf16 v[88:91], a[216:219], a[16:19], v[88:91]
    ds_read_b64_tr_b16 a[200:201], v11 offset:12352
    v_mfma_f32_16x16x32_bf16 v[92:95], a[216:219], a[88:91], v[92:95]
    ds_read_b64_tr_b16 a[202:203], v11 offset:15424
    v_mfma_f32_16x16x32_bf16 v[136:139], a[220:223], a[16:19], v[136:139]
    ds_read_b64_tr_b16 a[204:205], v11 offset:30784
    v_mfma_f32_16x16x32_bf16 v[140:143], a[220:223], a[88:91], v[140:143]
    ds_read_b64_tr_b16 a[206:207], v11 offset:33856
    s_waitcnt lgkmcnt(15)
    v_mfma_f32_16x16x32_bf16 v[96:99], a[224:227], a[16:19], v[96:99]
    ds_read_b64_tr_b16 a[208:209], v10 offset:12416
    v_mfma_f32_16x16x32_bf16 v[100:103], a[224:227], a[88:91], v[100:103]
    ds_read_b64_tr_b16 a[210:211], v10 offset:15488
    v_mfma_f32_16x16x32_bf16 v[144:147], a[228:231], a[16:19], v[144:147]
    ds_read_b64_tr_b16 a[212:213], v10 offset:30848
    v_mfma_f32_16x16x32_bf16 v[148:151], a[228:231], a[88:91], v[148:151]
    ds_read_b64_tr_b16 a[214:215], v10 offset:33920
    v_mfma_f32_16x16x32_bf16 v[104:107], a[232:235], a[16:19], v[104:107]
    ds_read_b64_tr_b16 a[216:217], v11 offset:12416
    v_mfma_f32_16x16x32_bf16 v[108:111], a[232:235], a[88:91], v[108:111]
    ds_read_b64_tr_b16 a[218:219], v11 offset:15488
    v_mfma_f32_16x16x32_bf16 v[152:155], a[236:239], a[16:19], v[152:155]
    ds_read_b64_tr_b16 a[220:221], v11 offset:30848
    v_mfma_f32_16x16x32_bf16 v[156:159], a[236:239], a[88:91], v[156:159]
    ds_read_b64_tr_b16 a[222:223], v11 offset:33920
    s_barrier
    s_waitcnt vmcnt(19) lgkmcnt(15)
    v_mfma_f32_16x16x32_bf16 v[64:67], a[240:243], a[20:23], v[64:67]
    ds_read_b64_tr_b16 a[224:225], v12 offset:0
    v_mfma_f32_16x16x32_bf16 v[68:71], a[240:243], a[92:95], v[68:71]
    s_mov_b32 s59, 12288
    ds_read_b64_tr_b16 a[226:227], v12 offset:3072
    v_mfma_f32_16x16x32_bf16 v[112:115], a[244:247], a[20:23], v[112:115]
    ds_read_b64_tr_b16 a[228:229], v12 offset:18432
    ds_read_b64_tr_b16 a[230:231], v12 offset:21504
    v_mfma_f32_16x16x32_bf16 v[116:119], a[244:247], a[92:95], v[116:119]
    buffer_load_dwordx4 a[60:63], v39, s[24:27], s59 offen offset:3072 sc1
    v_mfma_f32_16x16x32_bf16 v[72:75], a[248:251], a[20:23], v[72:75]
    ds_read_b64_tr_b16 a[232:233], v13 offset:0
    v_mfma_f32_16x16x32_bf16 v[76:79], a[248:251], a[92:95], v[76:79]
    s_mov_b32 s59, 32768
    ds_read_b64_tr_b16 a[234:235], v13 offset:3072
    v_mfma_f32_16x16x32_bf16 v[120:123], a[252:255], a[20:23], v[120:123]
    ds_read_b64_tr_b16 a[236:237], v13 offset:18432
    ds_read_b64_tr_b16 a[238:239], v13 offset:21504
    v_mfma_f32_16x16x32_bf16 v[124:127], a[252:255], a[92:95], v[124:127]
    buffer_load_dwordx4 a[132:135], v39, s[24:27], s59 offen offset:1024 sc1
    s_waitcnt lgkmcnt(15)
    v_mfma_f32_16x16x32_bf16 v[80:83], a[192:195], a[20:23], v[80:83]
    ds_read_b64_tr_b16 a[240:241], v12 offset:64
    v_mfma_f32_16x16x32_bf16 v[84:87], a[192:195], a[92:95], v[84:87]
    s_mov_b32 s59, 16384
    ds_read_b64_tr_b16 a[242:243], v12 offset:3136
    v_mfma_f32_16x16x32_bf16 v[128:131], a[196:199], a[20:23], v[128:131]
    ds_read_b64_tr_b16 a[244:245], v12 offset:18496
    ds_read_b64_tr_b16 a[246:247], v12 offset:21568
    v_mfma_f32_16x16x32_bf16 v[132:135], a[196:199], a[92:95], v[132:135]
    buffer_load_dwordx4 a[64:67], v39, s[24:27], s59 offen offset:0 sc1
    v_mfma_f32_16x16x32_bf16 v[88:91], a[200:203], a[20:23], v[88:91]
    ds_read_b64_tr_b16 a[248:249], v13 offset:64
    v_mfma_f32_16x16x32_bf16 v[92:95], a[200:203], a[92:95], v[92:95]
    s_mov_b32 s59, 32768
    ds_read_b64_tr_b16 a[250:251], v13 offset:3136
    v_mfma_f32_16x16x32_bf16 v[136:139], a[204:207], a[20:23], v[136:139]
    ds_read_b64_tr_b16 a[252:253], v13 offset:18496
    ds_read_b64_tr_b16 a[254:255], v13 offset:21568
    v_mfma_f32_16x16x32_bf16 v[140:143], a[204:207], a[92:95], v[140:143]
    buffer_load_dwordx4 a[136:139], v39, s[24:27], s59 offen offset:2048 sc1
    s_waitcnt lgkmcnt(15)
    v_mfma_f32_16x16x32_bf16 v[96:99], a[208:211], a[20:23], v[96:99]
    ds_read_b64_tr_b16 a[192:193], v12 offset:128
    v_mfma_f32_16x16x32_bf16 v[100:103], a[208:211], a[92:95], v[100:103]
    s_mov_b32 s59, 16384
    ds_read_b64_tr_b16 a[194:195], v12 offset:3200
    v_mfma_f32_16x16x32_bf16 v[144:147], a[212:215], a[20:23], v[144:147]
    ds_read_b64_tr_b16 a[196:197], v12 offset:18560
    ds_read_b64_tr_b16 a[198:199], v12 offset:21632
    v_mfma_f32_16x16x32_bf16 v[148:151], a[212:215], a[92:95], v[148:151]
    buffer_load_dwordx4 a[68:71], v39, s[24:27], s59 offen offset:1024 sc1
    v_mfma_f32_16x16x32_bf16 v[104:107], a[216:219], a[20:23], v[104:107]
    ds_read_b64_tr_b16 a[200:201], v13 offset:128
    v_mfma_f32_16x16x32_bf16 v[108:111], a[216:219], a[92:95], v[108:111]
    s_mov_b32 s59, 32768
    ds_read_b64_tr_b16 a[202:203], v13 offset:3200
    v_mfma_f32_16x16x32_bf16 v[152:155], a[220:223], a[20:23], v[152:155]
    ds_read_b64_tr_b16 a[204:205], v13 offset:18560
    ds_read_b64_tr_b16 a[206:207], v13 offset:21632
    v_mfma_f32_16x16x32_bf16 v[156:159], a[220:223], a[92:95], v[156:159]
    buffer_load_dwordx4 a[140:143], v39, s[24:27], s59 offen offset:3072 sc1
    s_add_u32 m0, s47, 0
    s_waitcnt vmcnt(23) lgkmcnt(15)
    v_mfma_f32_16x16x32_bf16 v[64:67], a[224:227], a[24:27], v[64:67]
    ds_read_b64_tr_b16 a[208:209], v12 offset:6144
    v_mfma_f32_16x16x32_bf16 v[68:71], a[224:227], a[96:99], v[68:71]
    s_mov_b32 s50, 3538944
    ds_read_b64_tr_b16 a[210:211], v12 offset:9216
    v_mfma_f32_16x16x32_bf16 v[112:115], a[228:231], a[24:27], v[112:115]
    ds_read_b64_tr_b16 a[212:213], v12 offset:24576
    ds_read_b64_tr_b16 a[214:215], v12 offset:27648
    v_mfma_f32_16x16x32_bf16 v[116:119], a[228:231], a[96:99], v[116:119]
    buffer_load_dwordx4 v32, s[16:19], s50 offen offset:0 lds
    v_mfma_f32_16x16x32_bf16 v[72:75], a[232:235], a[24:27], v[72:75]
    ds_read_b64_tr_b16 a[216:217], v13 offset:6144
    v_mfma_f32_16x16x32_bf16 v[76:79], a[232:235], a[96:99], v[76:79]
    ds_read_b64_tr_b16 a[218:219], v13 offset:9216
    v_mfma_f32_16x16x32_bf16 v[120:123], a[236:239], a[24:27], v[120:123]
    ds_read_b64_tr_b16 a[220:221], v13 offset:24576
    ds_read_b64_tr_b16 a[222:223], v13 offset:27648
    v_mfma_f32_16x16x32_bf16 v[124:127], a[236:239], a[96:99], v[124:127]
    buffer_load_dwordx4 v33, s[16:19], s50 offen offset:1024 lds
    s_waitcnt lgkmcnt(15)
    v_mfma_f32_16x16x32_bf16 v[80:83], a[240:243], a[24:27], v[80:83]
    ds_read_b64_tr_b16 a[224:225], v12 offset:6208
    v_mfma_f32_16x16x32_bf16 v[84:87], a[240:243], a[96:99], v[84:87]
    ds_read_b64_tr_b16 a[226:227], v12 offset:9280
    v_mfma_f32_16x16x32_bf16 v[128:131], a[244:247], a[24:27], v[128:131]
    ds_read_b64_tr_b16 a[228:229], v12 offset:24640
    ds_read_b64_tr_b16 a[230:231], v12 offset:27712
    v_mfma_f32_16x16x32_bf16 v[132:135], a[244:247], a[96:99], v[132:135]
    buffer_load_dwordx4 v34, s[16:19], s50 offen offset:2048 lds
    s_add_u32 m0, s47, 3072
    v_mfma_f32_16x16x32_bf16 v[88:91], a[248:251], a[24:27], v[88:91]
    ds_read_b64_tr_b16 a[232:233], v13 offset:6208
    v_mfma_f32_16x16x32_bf16 v[92:95], a[248:251], a[96:99], v[92:95]
    s_mov_b32 s50, 3686400
    ds_read_b64_tr_b16 a[234:235], v13 offset:9280
    v_mfma_f32_16x16x32_bf16 v[136:139], a[252:255], a[24:27], v[136:139]
    ds_read_b64_tr_b16 a[236:237], v13 offset:24640
    ds_read_b64_tr_b16 a[238:239], v13 offset:27712
    v_mfma_f32_16x16x32_bf16 v[140:143], a[252:255], a[96:99], v[140:143]
    buffer_load_dwordx4 v32, s[16:19], s50 offen offset:0 lds
    s_waitcnt lgkmcnt(15)
    v_mfma_f32_16x16x32_bf16 v[96:99], a[192:195], a[24:27], v[96:99]
    ds_read_b64_tr_b16 a[240:241], v12 offset:6272
    v_mfma_f32_16x16x32_bf16 v[100:103], a[192:195], a[96:99], v[100:103]
    ds_read_b64_tr_b16 a[242:243], v12 offset:9344
    v_mfma_f32_16x16x32_bf16 v[144:147], a[196:199], a[24:27], v[144:147]
    ds_read_b64_tr_b16 a[244:245], v12 offset:24704
    ds_read_b64_tr_b16 a[246:247], v12 offset:27776
    v_mfma_f32_16x16x32_bf16 v[148:151], a[196:199], a[96:99], v[148:151]
    buffer_load_dwordx4 v33, s[16:19], s50 offen offset:1024 lds
    v_mfma_f32_16x16x32_bf16 v[104:107], a[200:203], a[24:27], v[104:107]
    ds_read_b64_tr_b16 a[248:249], v13 offset:6272
    v_mfma_f32_16x16x32_bf16 v[108:111], a[200:203], a[96:99], v[108:111]
    ds_read_b64_tr_b16 a[250:251], v13 offset:9344
    v_mfma_f32_16x16x32_bf16 v[152:155], a[204:207], a[24:27], v[152:155]
    ds_read_b64_tr_b16 a[252:253], v13 offset:24704
    ds_read_b64_tr_b16 a[254:255], v13 offset:27776
    v_mfma_f32_16x16x32_bf16 v[156:159], a[204:207], a[96:99], v[156:159]
    buffer_load_dwordx4 v34, s[16:19], s50 offen offset:2048 lds
    s_add_u32 m0, s47, 6144
    s_waitcnt vmcnt(27) lgkmcnt(15)
    v_mfma_f32_16x16x32_bf16 v[64:67], a[208:211], a[28:31], v[64:67]
    ds_read_b64_tr_b16 a[192:193], v12 offset:12288
    v_mfma_f32_16x16x32_bf16 v[68:71], a[208:211], a[100:103], v[68:71]
    s_mov_b32 s50, 3833856
    ds_read_b64_tr_b16 a[194:195], v12 offset:15360
    v_mfma_f32_16x16x32_bf16 v[112:115], a[212:215], a[28:31], v[112:115]
    ds_read_b64_tr_b16 a[196:197], v12 offset:30720
    ds_read_b64_tr_b16 a[198:199], v12 offset:33792
    v_mfma_f32_16x16x32_bf16 v[116:119], a[212:215], a[100:103], v[116:119]
    buffer_load_dwordx4 v32, s[16:19], s50 offen offset:0 lds
    v_mfma_f32_16x16x32_bf16 v[72:75], a[216:219], a[28:31], v[72:75]
    ds_read_b64_tr_b16 a[200:201], v13 offset:12288
    v_mfma_f32_16x16x32_bf16 v[76:79], a[216:219], a[100:103], v[76:79]
    ds_read_b64_tr_b16 a[202:203], v13 offset:15360
    v_mfma_f32_16x16x32_bf16 v[120:123], a[220:223], a[28:31], v[120:123]
    ds_read_b64_tr_b16 a[204:205], v13 offset:30720
    ds_read_b64_tr_b16 a[206:207], v13 offset:33792
    v_mfma_f32_16x16x32_bf16 v[124:127], a[220:223], a[100:103], v[124:127]
    buffer_load_dwordx4 v33, s[16:19], s50 offen offset:1024 lds
    s_waitcnt lgkmcnt(15)
    v_mfma_f32_16x16x32_bf16 v[80:83], a[224:227], a[28:31], v[80:83]
    ds_read_b64_tr_b16 a[208:209], v12 offset:12352
    v_mfma_f32_16x16x32_bf16 v[84:87], a[224:227], a[100:103], v[84:87]
    ds_read_b64_tr_b16 a[210:211], v12 offset:15424
    v_mfma_f32_16x16x32_bf16 v[128:131], a[228:231], a[28:31], v[128:131]
    ds_read_b64_tr_b16 a[212:213], v12 offset:30784
    ds_read_b64_tr_b16 a[214:215], v12 offset:33856
    v_mfma_f32_16x16x32_bf16 v[132:135], a[228:231], a[100:103], v[132:135]
    buffer_load_dwordx4 v34, s[16:19], s50 offen offset:2048 lds
    v_mfma_f32_16x16x32_bf16 v[88:91], a[232:235], a[28:31], v[88:91]
    ds_read_b64_tr_b16 a[216:217], v13 offset:12352
    v_mfma_f32_16x16x32_bf16 v[92:95], a[232:235], a[100:103], v[92:95]
    ds_read_b64_tr_b16 a[218:219], v13 offset:15424
    v_mfma_f32_16x16x32_bf16 v[136:139], a[236:239], a[28:31], v[136:139]
    ds_read_b64_tr_b16 a[220:221], v13 offset:30784
    v_mfma_f32_16x16x32_bf16 v[140:143], a[236:239], a[100:103], v[140:143]
    ds_read_b64_tr_b16 a[222:223], v13 offset:33856
    s_waitcnt lgkmcnt(15)
    v_mfma_f32_16x16x32_bf16 v[96:99], a[240:243], a[28:31], v[96:99]
    ds_read_b64_tr_b16 a[224:225], v12 offset:12416
    v_mfma_f32_16x16x32_bf16 v[100:103], a[240:243], a[100:103], v[100:103]
    ds_read_b64_tr_b16 a[226:227], v12 offset:15488
    v_mfma_f32_16x16x32_bf16 v[144:147], a[244:247], a[28:31], v[144:147]
    ds_read_b64_tr_b16 a[228:229], v12 offset:30848
    v_mfma_f32_16x16x32_bf16 v[148:151], a[244:247], a[100:103], v[148:151]
    ds_read_b64_tr_b16 a[230:231], v12 offset:33920
    v_mfma_f32_16x16x32_bf16 v[104:107], a[248:251], a[28:31], v[104:107]
    ds_read_b64_tr_b16 a[232:233], v13 offset:12416
    v_mfma_f32_16x16x32_bf16 v[108:111], a[248:251], a[100:103], v[108:111]
    ds_read_b64_tr_b16 a[234:235], v13 offset:15488
    v_mfma_f32_16x16x32_bf16 v[152:155], a[252:255], a[28:31], v[152:155]
    ds_read_b64_tr_b16 a[236:237], v13 offset:30848
    v_mfma_f32_16x16x32_bf16 v[156:159], a[252:255], a[100:103], v[156:159]
    s_add_u32 m0, s47, 36864
    ds_read_b64_tr_b16 a[238:239], v13 offset:33920
    s_barrier
    s_waitcnt vmcnt(28) lgkmcnt(15)
    v_mfma_f32_16x16x32_bf16 v[64:67], a[192:195], a[32:35], v[64:67]
    ds_read_b64_tr_b16 a[240:241], v14 offset:0
    v_mfma_f32_16x16x32_bf16 v[68:71], a[192:195], a[104:107], v[68:71]
    s_mov_b32 s50, 4423680
    ds_read_b64_tr_b16 a[242:243], v14 offset:3072
    v_mfma_f32_16x16x32_bf16 v[112:115], a[196:199], a[32:35], v[112:115]
    ds_read_b64_tr_b16 a[244:245], v14 offset:18432
    ds_read_b64_tr_b16 a[246:247], v14 offset:21504
    v_mfma_f32_16x16x32_bf16 v[116:119], a[196:199], a[104:107], v[116:119]
    buffer_load_dwordx4 v32, s[16:19], s50 offen offset:0 lds
    v_mfma_f32_16x16x32_bf16 v[72:75], a[200:203], a[32:35], v[72:75]
    ds_read_b64_tr_b16 a[248:249], v15 offset:0
    v_mfma_f32_16x16x32_bf16 v[76:79], a[200:203], a[104:107], v[76:79]
    ds_read_b64_tr_b16 a[250:251], v15 offset:3072
    v_mfma_f32_16x16x32_bf16 v[120:123], a[204:207], a[32:35], v[120:123]
    ds_read_b64_tr_b16 a[252:253], v15 offset:18432
    ds_read_b64_tr_b16 a[254:255], v15 offset:21504
    v_mfma_f32_16x16x32_bf16 v[124:127], a[204:207], a[104:107], v[124:127]
    buffer_load_dwordx4 v33, s[16:19], s50 offen offset:1024 lds
    s_waitcnt lgkmcnt(15)
    v_mfma_f32_16x16x32_bf16 v[80:83], a[208:211], a[32:35], v[80:83]
    ds_read_b64_tr_b16 a[192:193], v14 offset:64
    v_mfma_f32_16x16x32_bf16 v[84:87], a[208:211], a[104:107], v[84:87]
    ds_read_b64_tr_b16 a[194:195], v14 offset:3136
    v_mfma_f32_16x16x32_bf16 v[128:131], a[212:215], a[32:35], v[128:131]
    ds_read_b64_tr_b16 a[196:197], v14 offset:18496
    ds_read_b64_tr_b16 a[198:199], v14 offset:21568
    v_mfma_f32_16x16x32_bf16 v[132:135], a[212:215], a[104:107], v[132:135]
    buffer_load_dwordx4 v34, s[16:19], s50 offen offset:2048 lds
    s_add_u32 m0, s47, 39936
    v_mfma_f32_16x16x32_bf16 v[88:91], a[216:219], a[32:35], v[88:91]
    ds_read_b64_tr_b16 a[200:201], v15 offset:64
    v_mfma_f32_16x16x32_bf16 v[92:95], a[216:219], a[104:107], v[92:95]
    s_mov_b32 s50, 4571136
    ds_read_b64_tr_b16 a[202:203], v15 offset:3136
    v_mfma_f32_16x16x32_bf16 v[136:139], a[220:223], a[32:35], v[136:139]
    ds_read_b64_tr_b16 a[204:205], v15 offset:18496
    ds_read_b64_tr_b16 a[206:207], v15 offset:21568
    v_mfma_f32_16x16x32_bf16 v[140:143], a[220:223], a[104:107], v[140:143]
    buffer_load_dwordx4 v32, s[16:19], s50 offen offset:0 lds
    s_waitcnt lgkmcnt(15)
    v_mfma_f32_16x16x32_bf16 v[96:99], a[224:227], a[32:35], v[96:99]
    ds_read_b64_tr_b16 a[208:209], v14 offset:128
    v_mfma_f32_16x16x32_bf16 v[100:103], a[224:227], a[104:107], v[100:103]
    ds_read_b64_tr_b16 a[210:211], v14 offset:3200
    v_mfma_f32_16x16x32_bf16 v[144:147], a[228:231], a[32:35], v[144:147]
    ds_read_b64_tr_b16 a[212:213], v14 offset:18560
    ds_read_b64_tr_b16 a[214:215], v14 offset:21632
    v_mfma_f32_16x16x32_bf16 v[148:151], a[228:231], a[104:107], v[148:151]
    buffer_load_dwordx4 v33, s[16:19], s50 offen offset:1024 lds
    v_mfma_f32_16x16x32_bf16 v[104:107], a[232:235], a[32:35], v[104:107]
    ds_read_b64_tr_b16 a[216:217], v15 offset:128
    v_mfma_f32_16x16x32_bf16 v[108:111], a[232:235], a[104:107], v[108:111]
    ds_read_b64_tr_b16 a[218:219], v15 offset:3200
    v_mfma_f32_16x16x32_bf16 v[152:155], a[236:239], a[32:35], v[152:155]
    ds_read_b64_tr_b16 a[220:221], v15 offset:18560
    ds_read_b64_tr_b16 a[222:223], v15 offset:21632
    v_mfma_f32_16x16x32_bf16 v[156:159], a[236:239], a[104:107], v[156:159]
    buffer_load_dwordx4 v34, s[16:19], s50 offen offset:2048 lds
    s_add_u32 m0, s47, 43008
    s_waitcnt vmcnt(31) lgkmcnt(15)
    v_mfma_f32_16x16x32_bf16 v[64:67], a[240:243], a[36:39], v[64:67]
    ds_read_b64_tr_b16 a[224:225], v14 offset:6144
    v_mfma_f32_16x16x32_bf16 v[68:71], a[240:243], a[108:111], v[68:71]
    s_mov_b32 s50, 4718592
    ds_read_b64_tr_b16 a[226:227], v14 offset:9216
    v_mfma_f32_16x16x32_bf16 v[112:115], a[244:247], a[36:39], v[112:115]
    ds_read_b64_tr_b16 a[228:229], v14 offset:24576
    ds_read_b64_tr_b16 a[230:231], v14 offset:27648
    v_mfma_f32_16x16x32_bf16 v[116:119], a[244:247], a[108:111], v[116:119]
    buffer_load_dwordx4 v32, s[16:19], s50 offen offset:0 lds
    v_mfma_f32_16x16x32_bf16 v[72:75], a[248:251], a[36:39], v[72:75]
    ds_read_b64_tr_b16 a[232:233], v15 offset:6144
    v_mfma_f32_16x16x32_bf16 v[76:79], a[248:251], a[108:111], v[76:79]
    ds_read_b64_tr_b16 a[234:235], v15 offset:9216
    v_mfma_f32_16x16x32_bf16 v[120:123], a[252:255], a[36:39], v[120:123]
    ds_read_b64_tr_b16 a[236:237], v15 offset:24576
    ds_read_b64_tr_b16 a[238:239], v15 offset:27648
    v_mfma_f32_16x16x32_bf16 v[124:127], a[252:255], a[108:111], v[124:127]
    buffer_load_dwordx4 v33, s[16:19], s50 offen offset:1024 lds
    s_waitcnt lgkmcnt(15)
    v_mfma_f32_16x16x32_bf16 v[80:83], a[192:195], a[36:39], v[80:83]
    ds_read_b64_tr_b16 a[240:241], v14 offset:6208
    v_mfma_f32_16x16x32_bf16 v[84:87], a[192:195], a[108:111], v[84:87]
    ds_read_b64_tr_b16 a[242:243], v14 offset:9280
    v_mfma_f32_16x16x32_bf16 v[128:131], a[196:199], a[36:39], v[128:131]
    ds_read_b64_tr_b16 a[244:245], v14 offset:24640
    ds_read_b64_tr_b16 a[246:247], v14 offset:27712
    v_mfma_f32_16x16x32_bf16 v[132:135], a[196:199], a[108:111], v[132:135]
    buffer_load_dwordx4 v34, s[16:19], s50 offen offset:2048 lds
    v_mfma_f32_16x16x32_bf16 v[88:91], a[200:203], a[36:39], v[88:91]
    ds_read_b64_tr_b16 a[248:249], v15 offset:6208
    v_mfma_f32_16x16x32_bf16 v[92:95], a[200:203], a[108:111], v[92:95]
    ds_read_b64_tr_b16 a[250:251], v15 offset:9280
    v_mfma_f32_16x16x32_bf16 v[136:139], a[204:207], a[36:39], v[136:139]
    ds_read_b64_tr_b16 a[252:253], v15 offset:24640
    v_mfma_f32_16x16x32_bf16 v[140:143], a[204:207], a[108:111], v[140:143]
    ds_read_b64_tr_b16 a[254:255], v15 offset:27712
    s_waitcnt lgkmcnt(15)
    v_mfma_f32_16x16x32_bf16 v[96:99], a[208:211], a[36:39], v[96:99]
    ds_read_b64_tr_b16 a[192:193], v14 offset:6272
    v_mfma_f32_16x16x32_bf16 v[100:103], a[208:211], a[108:111], v[100:103]
    ds_read_b64_tr_b16 a[194:195], v14 offset:9344
    v_mfma_f32_16x16x32_bf16 v[144:147], a[212:215], a[36:39], v[144:147]
    ds_read_b64_tr_b16 a[196:197], v14 offset:24704
    v_mfma_f32_16x16x32_bf16 v[148:151], a[212:215], a[108:111], v[148:151]
    ds_read_b64_tr_b16 a[198:199], v14 offset:27776
    v_mfma_f32_16x16x32_bf16 v[104:107], a[216:219], a[36:39], v[104:107]
    ds_read_b64_tr_b16 a[200:201], v15 offset:6272
    v_mfma_f32_16x16x32_bf16 v[108:111], a[216:219], a[108:111], v[108:111]
    ds_read_b64_tr_b16 a[202:203], v15 offset:9344
    v_mfma_f32_16x16x32_bf16 v[152:155], a[220:223], a[36:39], v[152:155]
    ds_read_b64_tr_b16 a[204:205], v15 offset:24704
    v_mfma_f32_16x16x32_bf16 v[156:159], a[220:223], a[108:111], v[156:159]
    ds_read_b64_tr_b16 a[206:207], v15 offset:27776
    s_waitcnt vmcnt(32) lgkmcnt(15)
    v_mfma_f32_16x16x32_bf16 v[64:67], a[224:227], a[40:43], v[64:67]
    ds_read_b64_tr_b16 a[208:209], v14 offset:12288
    v_mfma_f32_16x16x32_bf16 v[68:71], a[224:227], a[112:115], v[68:71]
    ds_read_b64_tr_b16 a[210:211], v14 offset:15360
    v_mfma_f32_16x16x32_bf16 v[112:115], a[228:231], a[40:43], v[112:115]
    ds_read_b64_tr_b16 a[212:213], v14 offset:30720
    v_mfma_f32_16x16x32_bf16 v[116:119], a[228:231], a[112:115], v[116:119]
    ds_read_b64_tr_b16 a[214:215], v14 offset:33792
    v_mfma_f32_16x16x32_bf16 v[72:75], a[232:235], a[40:43], v[72:75]
    ds_read_b64_tr_b16 a[216:217], v15 offset:12288
    v_mfma_f32_16x16x32_bf16 v[76:79], a[232:235], a[112:115], v[76:79]
    ds_read_b64_tr_b16 a[218:219], v15 offset:15360
    v_mfma_f32_16x16x32_bf16 v[120:123], a[236:239], a[40:43], v[120:123]
    ds_read_b64_tr_b16 a[220:221], v15 offset:30720
    v_mfma_f32_16x16x32_bf16 v[124:127], a[236:239], a[112:115], v[124:127]
    ds_read_b64_tr_b16 a[222:223], v15 offset:33792
    s_waitcnt lgkmcnt(15)
    v_mfma_f32_16x16x32_bf16 v[80:83], a[240:243], a[40:43], v[80:83]
    ds_read_b64_tr_b16 a[224:225], v14 offset:12352
    v_mfma_f32_16x16x32_bf16 v[84:87], a[240:243], a[112:115], v[84:87]
    ds_read_b64_tr_b16 a[226:227], v14 offset:15424
    v_mfma_f32_16x16x32_bf16 v[128:131], a[244:247], a[40:43], v[128:131]
    ds_read_b64_tr_b16 a[228:229], v14 offset:30784
    v_mfma_f32_16x16x32_bf16 v[132:135], a[244:247], a[112:115], v[132:135]
    ds_read_b64_tr_b16 a[230:231], v14 offset:33856
    v_mfma_f32_16x16x32_bf16 v[88:91], a[248:251], a[40:43], v[88:91]
    ds_read_b64_tr_b16 a[232:233], v15 offset:12352
    v_mfma_f32_16x16x32_bf16 v[92:95], a[248:251], a[112:115], v[92:95]
    ds_read_b64_tr_b16 a[234:235], v15 offset:15424
    v_mfma_f32_16x16x32_bf16 v[136:139], a[252:255], a[40:43], v[136:139]
    ds_read_b64_tr_b16 a[236:237], v15 offset:30784
    v_mfma_f32_16x16x32_bf16 v[140:143], a[252:255], a[112:115], v[140:143]
    ds_read_b64_tr_b16 a[238:239], v15 offset:33856
    s_waitcnt lgkmcnt(15)
    v_mfma_f32_16x16x32_bf16 v[96:99], a[192:195], a[40:43], v[96:99]
    ds_read_b64_tr_b16 a[240:241], v14 offset:12416
    v_mfma_f32_16x16x32_bf16 v[100:103], a[192:195], a[112:115], v[100:103]
    ds_read_b64_tr_b16 a[242:243], v14 offset:15488
    v_mfma_f32_16x16x32_bf16 v[144:147], a[196:199], a[40:43], v[144:147]
    ds_read_b64_tr_b16 a[244:245], v14 offset:30848
    v_mfma_f32_16x16x32_bf16 v[148:151], a[196:199], a[112:115], v[148:151]
    ds_read_b64_tr_b16 a[246:247], v14 offset:33920
    v_mfma_f32_16x16x32_bf16 v[104:107], a[200:203], a[40:43], v[104:107]
    ds_read_b64_tr_b16 a[248:249], v15 offset:12416
    v_mfma_f32_16x16x32_bf16 v[108:111], a[200:203], a[112:115], v[108:111]
    ds_read_b64_tr_b16 a[250:251], v15 offset:15488
    v_mfma_f32_16x16x32_bf16 v[152:155], a[204:207], a[40:43], v[152:155]
    ds_read_b64_tr_b16 a[252:253], v15 offset:30848
    v_mfma_f32_16x16x32_bf16 v[156:159], a[204:207], a[112:115], v[156:159]
    s_add_u32 m0, s47, 73728
    ds_read_b64_tr_b16 a[254:255], v15 offset:33920
    s_waitcnt vmcnt(9)
    s_barrier
    s_waitcnt lgkmcnt(15)
    v_mfma_f32_16x16x32_bf16 v[64:67], a[208:211], a[44:47], v[64:67]
    ds_read_b64_tr_b16 a[192:193], v8 offset:0
    v_mfma_f32_16x16x32_bf16 v[68:71], a[208:211], a[116:119], v[68:71]
    s_mov_b32 s50, 192
    ds_read_b64_tr_b16 a[194:195], v8 offset:3072
    v_mfma_f32_16x16x32_bf16 v[112:115], a[212:215], a[44:47], v[112:115]
    ds_read_b64_tr_b16 a[196:197], v8 offset:18432
    ds_read_b64_tr_b16 a[198:199], v8 offset:21504
    v_mfma_f32_16x16x32_bf16 v[116:119], a[212:215], a[116:119], v[116:119]
    buffer_load_dwordx4 v32, s[16:19], s50 offen offset:0 lds
    v_mfma_f32_16x16x32_bf16 v[72:75], a[216:219], a[44:47], v[72:75]
    ds_read_b64_tr_b16 a[200:201], v9 offset:0
    v_mfma_f32_16x16x32_bf16 v[76:79], a[216:219], a[116:119], v[76:79]
    ds_read_b64_tr_b16 a[202:203], v9 offset:3072
    v_mfma_f32_16x16x32_bf16 v[120:123], a[220:223], a[44:47], v[120:123]
    ds_read_b64_tr_b16 a[204:205], v9 offset:18432
    ds_read_b64_tr_b16 a[206:207], v9 offset:21504
    v_mfma_f32_16x16x32_bf16 v[124:127], a[220:223], a[116:119], v[124:127]
    buffer_load_dwordx4 v33, s[16:19], s50 offen offset:1024 lds
    s_waitcnt lgkmcnt(15)
    v_mfma_f32_16x16x32_bf16 v[80:83], a[224:227], a[44:47], v[80:83]
    ds_read_b64_tr_b16 a[208:209], v8 offset:64
    v_mfma_f32_16x16x32_bf16 v[84:87], a[224:227], a[116:119], v[84:87]
    ds_read_b64_tr_b16 a[210:211], v8 offset:3136
    v_mfma_f32_16x16x32_bf16 v[128:131], a[228:231], a[44:47], v[128:131]
    ds_read_b64_tr_b16 a[212:213], v8 offset:18496
    ds_read_b64_tr_b16 a[214:215], v8 offset:21568
    v_mfma_f32_16x16x32_bf16 v[132:135], a[228:231], a[116:119], v[132:135]
    buffer_load_dwordx4 v34, s[16:19], s50 offen offset:2048 lds
    s_add_u32 m0, s47, 76800
    v_mfma_f32_16x16x32_bf16 v[88:91], a[232:235], a[44:47], v[88:91]
    ds_read_b64_tr_b16 a[216:217], v9 offset:64
    v_mfma_f32_16x16x32_bf16 v[92:95], a[232:235], a[116:119], v[92:95]
    s_mov_b32 s50, 147648
    ds_read_b64_tr_b16 a[218:219], v9 offset:3136
    v_mfma_f32_16x16x32_bf16 v[136:139], a[236:239], a[44:47], v[136:139]
    ds_read_b64_tr_b16 a[220:221], v9 offset:18496
    ds_read_b64_tr_b16 a[222:223], v9 offset:21568
    v_mfma_f32_16x16x32_bf16 v[140:143], a[236:239], a[116:119], v[140:143]
    buffer_load_dwordx4 v32, s[16:19], s50 offen offset:0 lds
    s_waitcnt lgkmcnt(15)
    v_mfma_f32_16x16x32_bf16 v[96:99], a[240:243], a[44:47], v[96:99]
    ds_read_b64_tr_b16 a[224:225], v8 offset:128
    v_mfma_f32_16x16x32_bf16 v[100:103], a[240:243], a[116:119], v[100:103]
    ds_read_b64_tr_b16 a[226:227], v8 offset:3200
    v_mfma_f32_16x16x32_bf16 v[144:147], a[244:247], a[44:47], v[144:147]
    ds_read_b64_tr_b16 a[228:229], v8 offset:18560
    ds_read_b64_tr_b16 a[230:231], v8 offset:21632
    v_mfma_f32_16x16x32_bf16 v[148:151], a[244:247], a[116:119], v[148:151]
    buffer_load_dwordx4 v33, s[16:19], s50 offen offset:1024 lds
    v_mfma_f32_16x16x32_bf16 v[104:107], a[248:251], a[44:47], v[104:107]
    ds_read_b64_tr_b16 a[232:233], v9 offset:128
    v_mfma_f32_16x16x32_bf16 v[108:111], a[248:251], a[116:119], v[108:111]
    ds_read_b64_tr_b16 a[234:235], v9 offset:3200
    v_mfma_f32_16x16x32_bf16 v[152:155], a[252:255], a[44:47], v[152:155]
    ds_read_b64_tr_b16 a[236:237], v9 offset:18560
    ds_read_b64_tr_b16 a[238:239], v9 offset:21632
    v_mfma_f32_16x16x32_bf16 v[156:159], a[252:255], a[116:119], v[156:159]
    buffer_load_dwordx4 v34, s[16:19], s50 offen offset:2048 lds
    s_add_u32 m0, s47, 79872
    s_waitcnt lgkmcnt(15)
    v_mfma_f32_16x16x32_bf16 v[64:67], a[192:195], a[48:51], v[64:67]
    ds_read_b64_tr_b16 a[240:241], v8 offset:6144
    v_mfma_f32_16x16x32_bf16 v[68:71], a[192:195], a[120:123], v[68:71]
    s_mov_b32 s50, 295104
    ds_read_b64_tr_b16 a[242:243], v8 offset:9216
    v_mfma_f32_16x16x32_bf16 v[112:115], a[196:199], a[48:51], v[112:115]
    ds_read_b64_tr_b16 a[244:245], v8 offset:24576
    ds_read_b64_tr_b16 a[246:247], v8 offset:27648
    v_mfma_f32_16x16x32_bf16 v[116:119], a[196:199], a[120:123], v[116:119]
    buffer_load_dwordx4 v32, s[16:19], s50 offen offset:0 lds
    v_mfma_f32_16x16x32_bf16 v[72:75], a[200:203], a[48:51], v[72:75]
    ds_read_b64_tr_b16 a[248:249], v9 offset:6144
    v_mfma_f32_16x16x32_bf16 v[76:79], a[200:203], a[120:123], v[76:79]
    ds_read_b64_tr_b16 a[250:251], v9 offset:9216
    v_mfma_f32_16x16x32_bf16 v[120:123], a[204:207], a[48:51], v[120:123]
    ds_read_b64_tr_b16 a[252:253], v9 offset:24576
    ds_read_b64_tr_b16 a[254:255], v9 offset:27648
    v_mfma_f32_16x16x32_bf16 v[124:127], a[204:207], a[120:123], v[124:127]
    buffer_load_dwordx4 v33, s[16:19], s50 offen offset:1024 lds
    s_waitcnt lgkmcnt(15)
    v_mfma_f32_16x16x32_bf16 v[80:83], a[208:211], a[48:51], v[80:83]
    ds_read_b64_tr_b16 a[192:193], v8 offset:6208
    v_mfma_f32_16x16x32_bf16 v[84:87], a[208:211], a[120:123], v[84:87]
    ds_read_b64_tr_b16 a[194:195], v8 offset:9280
    v_mfma_f32_16x16x32_bf16 v[128:131], a[212:215], a[48:51], v[128:131]
    ds_read_b64_tr_b16 a[196:197], v8 offset:24640
    ds_read_b64_tr_b16 a[198:199], v8 offset:27712
    v_mfma_f32_16x16x32_bf16 v[132:135], a[212:215], a[120:123], v[132:135]
    buffer_load_dwordx4 v34, s[16:19], s50 offen offset:2048 lds
    v_mfma_f32_16x16x32_bf16 v[88:91], a[216:219], a[48:51], v[88:91]
    ds_read_b64_tr_b16 a[200:201], v9 offset:6208
    v_mfma_f32_16x16x32_bf16 v[92:95], a[216:219], a[120:123], v[92:95]
    ds_read_b64_tr_b16 a[202:203], v9 offset:9280
    v_mfma_f32_16x16x32_bf16 v[136:139], a[220:223], a[48:51], v[136:139]
    ds_read_b64_tr_b16 a[204:205], v9 offset:24640
    v_mfma_f32_16x16x32_bf16 v[140:143], a[220:223], a[120:123], v[140:143]
    ds_read_b64_tr_b16 a[206:207], v9 offset:27712
    s_waitcnt lgkmcnt(15)
    v_mfma_f32_16x16x32_bf16 v[96:99], a[224:227], a[48:51], v[96:99]
    ds_read_b64_tr_b16 a[208:209], v8 offset:6272
    v_mfma_f32_16x16x32_bf16 v[100:103], a[224:227], a[120:123], v[100:103]
    ds_read_b64_tr_b16 a[210:211], v8 offset:9344
    v_mfma_f32_16x16x32_bf16 v[144:147], a[228:231], a[48:51], v[144:147]
    ds_read_b64_tr_b16 a[212:213], v8 offset:24704
    v_mfma_f32_16x16x32_bf16 v[148:151], a[228:231], a[120:123], v[148:151]
    ds_read_b64_tr_b16 a[214:215], v8 offset:27776
    v_mfma_f32_16x16x32_bf16 v[104:107], a[232:235], a[48:51], v[104:107]
    ds_read_b64_tr_b16 a[216:217], v9 offset:6272
    v_mfma_f32_16x16x32_bf16 v[108:111], a[232:235], a[120:123], v[108:111]
    ds_read_b64_tr_b16 a[218:219], v9 offset:9344
    v_mfma_f32_16x16x32_bf16 v[152:155], a[236:239], a[48:51], v[152:155]
    ds_read_b64_tr_b16 a[220:221], v9 offset:24704
    v_mfma_f32_16x16x32_bf16 v[156:159], a[236:239], a[120:123], v[156:159]
    ds_read_b64_tr_b16 a[222:223], v9 offset:27776
    s_waitcnt lgkmcnt(15)
    v_mfma_f32_16x16x32_bf16 v[64:67], a[240:243], a[52:55], v[64:67]
    ds_read_b64_tr_b16 a[224:225], v8 offset:12288
    v_mfma_f32_16x16x32_bf16 v[68:71], a[240:243], a[124:127], v[68:71]
    ds_read_b64_tr_b16 a[226:227], v8 offset:15360
    v_mfma_f32_16x16x32_bf16 v[112:115], a[244:247], a[52:55], v[112:115]
    ds_read_b64_tr_b16 a[228:229], v8 offset:30720
    v_mfma_f32_16x16x32_bf16 v[116:119], a[244:247], a[124:127], v[116:119]
    ds_read_b64_tr_b16 a[230:231], v8 offset:33792
    v_mfma_f32_16x16x32_bf16 v[72:75], a[248:251], a[52:55], v[72:75]
    ds_read_b64_tr_b16 a[232:233], v9 offset:12288
    v_mfma_f32_16x16x32_bf16 v[76:79], a[248:251], a[124:127], v[76:79]
    ds_read_b64_tr_b16 a[234:235], v9 offset:15360
    v_mfma_f32_16x16x32_bf16 v[120:123], a[252:255], a[52:55], v[120:123]
    ds_read_b64_tr_b16 a[236:237], v9 offset:30720
    v_mfma_f32_16x16x32_bf16 v[124:127], a[252:255], a[124:127], v[124:127]
    ds_read_b64_tr_b16 a[238:239], v9 offset:33792
    s_waitcnt lgkmcnt(15)
    v_mfma_f32_16x16x32_bf16 v[80:83], a[192:195], a[52:55], v[80:83]
    ds_read_b64_tr_b16 a[240:241], v8 offset:12352
    v_mfma_f32_16x16x32_bf16 v[84:87], a[192:195], a[124:127], v[84:87]
    ds_read_b64_tr_b16 a[242:243], v8 offset:15424
    v_mfma_f32_16x16x32_bf16 v[128:131], a[196:199], a[52:55], v[128:131]
    ds_read_b64_tr_b16 a[244:245], v8 offset:30784
    v_mfma_f32_16x16x32_bf16 v[132:135], a[196:199], a[124:127], v[132:135]
    ds_read_b64_tr_b16 a[246:247], v8 offset:33856
    v_mfma_f32_16x16x32_bf16 v[88:91], a[200:203], a[52:55], v[88:91]
    ds_read_b64_tr_b16 a[248:249], v9 offset:12352
    v_mfma_f32_16x16x32_bf16 v[92:95], a[200:203], a[124:127], v[92:95]
    ds_read_b64_tr_b16 a[250:251], v9 offset:15424
    v_mfma_f32_16x16x32_bf16 v[136:139], a[204:207], a[52:55], v[136:139]
    ds_read_b64_tr_b16 a[252:253], v9 offset:30784
    v_mfma_f32_16x16x32_bf16 v[140:143], a[204:207], a[124:127], v[140:143]
    ds_read_b64_tr_b16 a[254:255], v9 offset:33856
    s_waitcnt lgkmcnt(15)
    v_mfma_f32_16x16x32_bf16 v[96:99], a[208:211], a[52:55], v[96:99]
    ds_read_b64_tr_b16 a[192:193], v8 offset:12416
    v_mfma_f32_16x16x32_bf16 v[100:103], a[208:211], a[124:127], v[100:103]
    ds_read_b64_tr_b16 a[194:195], v8 offset:15488
    v_mfma_f32_16x16x32_bf16 v[144:147], a[212:215], a[52:55], v[144:147]
    ds_read_b64_tr_b16 a[196:197], v8 offset:30848
    v_mfma_f32_16x16x32_bf16 v[148:151], a[212:215], a[124:127], v[148:151]
    ds_read_b64_tr_b16 a[198:199], v8 offset:33920
    v_mfma_f32_16x16x32_bf16 v[104:107], a[216:219], a[52:55], v[104:107]
    ds_read_b64_tr_b16 a[200:201], v9 offset:12416
    v_mfma_f32_16x16x32_bf16 v[108:111], a[216:219], a[124:127], v[108:111]
    ds_read_b64_tr_b16 a[202:203], v9 offset:15488
    v_mfma_f32_16x16x32_bf16 v[152:155], a[220:223], a[52:55], v[152:155]
    ds_read_b64_tr_b16 a[204:205], v9 offset:30848
    v_mfma_f32_16x16x32_bf16 v[156:159], a[220:223], a[124:127], v[156:159]
    s_add_u32 m0, s47, 110592
    ds_read_b64_tr_b16 a[206:207], v9 offset:33920
    s_waitcnt vmcnt(9)
    s_barrier
    s_waitcnt lgkmcnt(15)
    v_mfma_f32_16x16x32_bf16 v[64:67], a[224:227], a[56:59], v[64:67]
    ds_read_b64_tr_b16 a[208:209], v10 offset:0
    v_mfma_f32_16x16x32_bf16 v[68:71], a[224:227], a[128:131], v[68:71]
    s_mov_b32 s50, 884928
    ds_read_b64_tr_b16 a[210:211], v10 offset:3072
    v_mfma_f32_16x16x32_bf16 v[112:115], a[228:231], a[56:59], v[112:115]
    ds_read_b64_tr_b16 a[212:213], v10 offset:18432
    ds_read_b64_tr_b16 a[214:215], v10 offset:21504
    v_mfma_f32_16x16x32_bf16 v[116:119], a[228:231], a[128:131], v[116:119]
    buffer_load_dwordx4 v32, s[16:19], s50 offen offset:0 lds
    v_mfma_f32_16x16x32_bf16 v[72:75], a[232:235], a[56:59], v[72:75]
    ds_read_b64_tr_b16 a[216:217], v11 offset:0
    v_mfma_f32_16x16x32_bf16 v[76:79], a[232:235], a[128:131], v[76:79]
    ds_read_b64_tr_b16 a[218:219], v11 offset:3072
    v_mfma_f32_16x16x32_bf16 v[120:123], a[236:239], a[56:59], v[120:123]
    ds_read_b64_tr_b16 a[220:221], v11 offset:18432
    ds_read_b64_tr_b16 a[222:223], v11 offset:21504
    v_mfma_f32_16x16x32_bf16 v[124:127], a[236:239], a[128:131], v[124:127]
    buffer_load_dwordx4 v33, s[16:19], s50 offen offset:1024 lds
    s_waitcnt lgkmcnt(15)
    v_mfma_f32_16x16x32_bf16 v[80:83], a[240:243], a[56:59], v[80:83]
    ds_read_b64_tr_b16 a[224:225], v10 offset:64
    v_mfma_f32_16x16x32_bf16 v[84:87], a[240:243], a[128:131], v[84:87]
    ds_read_b64_tr_b16 a[226:227], v10 offset:3136
    v_mfma_f32_16x16x32_bf16 v[128:131], a[244:247], a[56:59], v[128:131]
    ds_read_b64_tr_b16 a[228:229], v10 offset:18496
    ds_read_b64_tr_b16 a[230:231], v10 offset:21568
    v_mfma_f32_16x16x32_bf16 v[132:135], a[244:247], a[128:131], v[132:135]
    buffer_load_dwordx4 v34, s[16:19], s50 offen offset:2048 lds
    s_add_u32 m0, s47, 113664
    v_mfma_f32_16x16x32_bf16 v[88:91], a[248:251], a[56:59], v[88:91]
    ds_read_b64_tr_b16 a[232:233], v11 offset:64
    v_mfma_f32_16x16x32_bf16 v[92:95], a[248:251], a[128:131], v[92:95]
    s_mov_b32 s50, 1032384
    ds_read_b64_tr_b16 a[234:235], v11 offset:3136
    v_mfma_f32_16x16x32_bf16 v[136:139], a[252:255], a[56:59], v[136:139]
    ds_read_b64_tr_b16 a[236:237], v11 offset:18496
    ds_read_b64_tr_b16 a[238:239], v11 offset:21568
    v_mfma_f32_16x16x32_bf16 v[140:143], a[252:255], a[128:131], v[140:143]
    buffer_load_dwordx4 v32, s[16:19], s50 offen offset:0 lds
    s_waitcnt lgkmcnt(15)
    v_mfma_f32_16x16x32_bf16 v[96:99], a[192:195], a[56:59], v[96:99]
    ds_read_b64_tr_b16 a[240:241], v10 offset:128
    v_mfma_f32_16x16x32_bf16 v[100:103], a[192:195], a[128:131], v[100:103]
    ds_read_b64_tr_b16 a[242:243], v10 offset:3200
    v_mfma_f32_16x16x32_bf16 v[144:147], a[196:199], a[56:59], v[144:147]
    ds_read_b64_tr_b16 a[244:245], v10 offset:18560
    ds_read_b64_tr_b16 a[246:247], v10 offset:21632
    v_mfma_f32_16x16x32_bf16 v[148:151], a[196:199], a[128:131], v[148:151]
    buffer_load_dwordx4 v33, s[16:19], s50 offen offset:1024 lds
    v_mfma_f32_16x16x32_bf16 v[104:107], a[200:203], a[56:59], v[104:107]
    ds_read_b64_tr_b16 a[248:249], v11 offset:128
    v_mfma_f32_16x16x32_bf16 v[108:111], a[200:203], a[128:131], v[108:111]
    ds_read_b64_tr_b16 a[250:251], v11 offset:3200
    v_mfma_f32_16x16x32_bf16 v[152:155], a[204:207], a[56:59], v[152:155]
    ds_read_b64_tr_b16 a[252:253], v11 offset:18560
    ds_read_b64_tr_b16 a[254:255], v11 offset:21632
    v_mfma_f32_16x16x32_bf16 v[156:159], a[204:207], a[128:131], v[156:159]
    buffer_load_dwordx4 v34, s[16:19], s50 offen offset:2048 lds
    s_add_u32 m0, s47, 116736
    s_waitcnt lgkmcnt(15)
    v_mfma_f32_16x16x32_bf16 v[64:67], a[208:211], a[60:63], v[64:67]
    ds_read_b64_tr_b16 a[192:193], v10 offset:6144
    v_mfma_f32_16x16x32_bf16 v[68:71], a[208:211], a[132:135], v[68:71]
    s_mov_b32 s50, 1179840
    ds_read_b64_tr_b16 a[194:195], v10 offset:9216
    v_mfma_f32_16x16x32_bf16 v[112:115], a[212:215], a[60:63], v[112:115]
    ds_read_b64_tr_b16 a[196:197], v10 offset:24576
    ds_read_b64_tr_b16 a[198:199], v10 offset:27648
    v_mfma_f32_16x16x32_bf16 v[116:119], a[212:215], a[132:135], v[116:119]
    buffer_load_dwordx4 v32, s[16:19], s50 offen offset:0 lds
    v_mfma_f32_16x16x32_bf16 v[72:75], a[216:219], a[60:63], v[72:75]
    ds_read_b64_tr_b16 a[200:201], v11 offset:6144
    v_mfma_f32_16x16x32_bf16 v[76:79], a[216:219], a[132:135], v[76:79]
    ds_read_b64_tr_b16 a[202:203], v11 offset:9216
    v_mfma_f32_16x16x32_bf16 v[120:123], a[220:223], a[60:63], v[120:123]
    ds_read_b64_tr_b16 a[204:205], v11 offset:24576
    ds_read_b64_tr_b16 a[206:207], v11 offset:27648
    v_mfma_f32_16x16x32_bf16 v[124:127], a[220:223], a[132:135], v[124:127]
    buffer_load_dwordx4 v33, s[16:19], s50 offen offset:1024 lds
    s_waitcnt lgkmcnt(15)
    v_mfma_f32_16x16x32_bf16 v[80:83], a[224:227], a[60:63], v[80:83]
    ds_read_b64_tr_b16 a[208:209], v10 offset:6208
    v_mfma_f32_16x16x32_bf16 v[84:87], a[224:227], a[132:135], v[84:87]
    ds_read_b64_tr_b16 a[210:211], v10 offset:9280
    v_mfma_f32_16x16x32_bf16 v[128:131], a[228:231], a[60:63], v[128:131]
    ds_read_b64_tr_b16 a[212:213], v10 offset:24640
    ds_read_b64_tr_b16 a[214:215], v10 offset:27712
    v_mfma_f32_16x16x32_bf16 v[132:135], a[228:231], a[132:135], v[132:135]
    buffer_load_dwordx4 v34, s[16:19], s50 offen offset:2048 lds
    v_mfma_f32_16x16x32_bf16 v[88:91], a[232:235], a[60:63], v[88:91]
    ds_read_b64_tr_b16 a[216:217], v11 offset:6208
    v_mfma_f32_16x16x32_bf16 v[92:95], a[232:235], a[132:135], v[92:95]
    ds_read_b64_tr_b16 a[218:219], v11 offset:9280
    v_mfma_f32_16x16x32_bf16 v[136:139], a[236:239], a[60:63], v[136:139]
    ds_read_b64_tr_b16 a[220:221], v11 offset:24640
    v_mfma_f32_16x16x32_bf16 v[140:143], a[236:239], a[132:135], v[140:143]
    ds_read_b64_tr_b16 a[222:223], v11 offset:27712
    s_waitcnt lgkmcnt(15)
    v_mfma_f32_16x16x32_bf16 v[96:99], a[240:243], a[60:63], v[96:99]
    ds_read_b64_tr_b16 a[224:225], v10 offset:6272
    v_mfma_f32_16x16x32_bf16 v[100:103], a[240:243], a[132:135], v[100:103]
    ds_read_b64_tr_b16 a[226:227], v10 offset:9344
    v_mfma_f32_16x16x32_bf16 v[144:147], a[244:247], a[60:63], v[144:147]
    ds_read_b64_tr_b16 a[228:229], v10 offset:24704
    v_mfma_f32_16x16x32_bf16 v[148:151], a[244:247], a[132:135], v[148:151]
    ds_read_b64_tr_b16 a[230:231], v10 offset:27776
    v_mfma_f32_16x16x32_bf16 v[104:107], a[248:251], a[60:63], v[104:107]
    ds_read_b64_tr_b16 a[232:233], v11 offset:6272
    v_mfma_f32_16x16x32_bf16 v[108:111], a[248:251], a[132:135], v[108:111]
    ds_read_b64_tr_b16 a[234:235], v11 offset:9344
    v_mfma_f32_16x16x32_bf16 v[152:155], a[252:255], a[60:63], v[152:155]
    ds_read_b64_tr_b16 a[236:237], v11 offset:24704
    v_mfma_f32_16x16x32_bf16 v[156:159], a[252:255], a[132:135], v[156:159]
    ds_read_b64_tr_b16 a[238:239], v11 offset:27776
    s_waitcnt lgkmcnt(15)
    v_mfma_f32_16x16x32_bf16 v[64:67], a[192:195], a[64:67], v[64:67]
    ds_read_b64_tr_b16 a[240:241], v10 offset:12288
    v_mfma_f32_16x16x32_bf16 v[68:71], a[192:195], a[136:139], v[68:71]
    ds_read_b64_tr_b16 a[242:243], v10 offset:15360
    v_mfma_f32_16x16x32_bf16 v[112:115], a[196:199], a[64:67], v[112:115]
    ds_read_b64_tr_b16 a[244:245], v10 offset:30720
    v_mfma_f32_16x16x32_bf16 v[116:119], a[196:199], a[136:139], v[116:119]
    ds_read_b64_tr_b16 a[246:247], v10 offset:33792
    v_mfma_f32_16x16x32_bf16 v[72:75], a[200:203], a[64:67], v[72:75]
    ds_read_b64_tr_b16 a[248:249], v11 offset:12288
    v_mfma_f32_16x16x32_bf16 v[76:79], a[200:203], a[136:139], v[76:79]
    ds_read_b64_tr_b16 a[250:251], v11 offset:15360
    v_mfma_f32_16x16x32_bf16 v[120:123], a[204:207], a[64:67], v[120:123]
    ds_read_b64_tr_b16 a[252:253], v11 offset:30720
    v_mfma_f32_16x16x32_bf16 v[124:127], a[204:207], a[136:139], v[124:127]
    ds_read_b64_tr_b16 a[254:255], v11 offset:33792
    s_waitcnt lgkmcnt(15)
    v_mfma_f32_16x16x32_bf16 v[80:83], a[208:211], a[64:67], v[80:83]
    ds_read_b64_tr_b16 a[192:193], v10 offset:12352
    v_mfma_f32_16x16x32_bf16 v[84:87], a[208:211], a[136:139], v[84:87]
    ds_read_b64_tr_b16 a[194:195], v10 offset:15424
    v_mfma_f32_16x16x32_bf16 v[128:131], a[212:215], a[64:67], v[128:131]
    ds_read_b64_tr_b16 a[196:197], v10 offset:30784
    v_mfma_f32_16x16x32_bf16 v[132:135], a[212:215], a[136:139], v[132:135]
    ds_read_b64_tr_b16 a[198:199], v10 offset:33856
    v_mfma_f32_16x16x32_bf16 v[88:91], a[216:219], a[64:67], v[88:91]
    ds_read_b64_tr_b16 a[200:201], v11 offset:12352
    v_mfma_f32_16x16x32_bf16 v[92:95], a[216:219], a[136:139], v[92:95]
    ds_read_b64_tr_b16 a[202:203], v11 offset:15424
    v_mfma_f32_16x16x32_bf16 v[136:139], a[220:223], a[64:67], v[136:139]
    ds_read_b64_tr_b16 a[204:205], v11 offset:30784
    v_mfma_f32_16x16x32_bf16 v[140:143], a[220:223], a[136:139], v[140:143]
    ds_read_b64_tr_b16 a[206:207], v11 offset:33856
    s_waitcnt lgkmcnt(15)
    v_mfma_f32_16x16x32_bf16 v[96:99], a[224:227], a[64:67], v[96:99]
    ds_read_b64_tr_b16 a[208:209], v10 offset:12416
    v_mfma_f32_16x16x32_bf16 v[100:103], a[224:227], a[136:139], v[100:103]
    ds_read_b64_tr_b16 a[210:211], v10 offset:15488
    v_mfma_f32_16x16x32_bf16 v[144:147], a[228:231], a[64:67], v[144:147]
    ds_read_b64_tr_b16 a[212:213], v10 offset:30848
    v_mfma_f32_16x16x32_bf16 v[148:151], a[228:231], a[136:139], v[148:151]
    ds_read_b64_tr_b16 a[214:215], v10 offset:33920
    v_mfma_f32_16x16x32_bf16 v[104:107], a[232:235], a[64:67], v[104:107]
    ds_read_b64_tr_b16 a[216:217], v11 offset:12416
    v_mfma_f32_16x16x32_bf16 v[108:111], a[232:235], a[136:139], v[108:111]
    ds_read_b64_tr_b16 a[218:219], v11 offset:15488
    v_mfma_f32_16x16x32_bf16 v[152:155], a[236:239], a[64:67], v[152:155]
    ds_read_b64_tr_b16 a[220:221], v11 offset:30848
    v_mfma_f32_16x16x32_bf16 v[156:159], a[236:239], a[136:139], v[156:159]
    s_add_u32 m0, s47, 0
    ds_read_b64_tr_b16 a[222:223], v11 offset:33920
    s_waitcnt vmcnt(9)
    s_barrier
    s_waitcnt lgkmcnt(15)
    v_mfma_f32_16x16x32_bf16 v[64:67], a[240:243], a[68:71], v[64:67]
    ds_read_b64_tr_b16 a[224:225], v12 offset:0
    v_mfma_f32_16x16x32_bf16 v[68:71], a[240:243], a[140:143], v[68:71]
    s_mov_b32 s50, 1769664
    ds_read_b64_tr_b16 a[226:227], v12 offset:3072
    v_mfma_f32_16x16x32_bf16 v[112:115], a[244:247], a[68:71], v[112:115]
    ds_read_b64_tr_b16 a[228:229], v12 offset:18432
    ds_read_b64_tr_b16 a[230:231], v12 offset:21504
    v_mfma_f32_16x16x32_bf16 v[116:119], a[244:247], a[140:143], v[116:119]
    buffer_load_dwordx4 v32, s[16:19], s50 offen offset:0 lds
    v_mfma_f32_16x16x32_bf16 v[72:75], a[248:251], a[68:71], v[72:75]
    ds_read_b64_tr_b16 a[232:233], v13 offset:0
    v_mfma_f32_16x16x32_bf16 v[76:79], a[248:251], a[140:143], v[76:79]
    ds_read_b64_tr_b16 a[234:235], v13 offset:3072
    v_mfma_f32_16x16x32_bf16 v[120:123], a[252:255], a[68:71], v[120:123]
    ds_read_b64_tr_b16 a[236:237], v13 offset:18432
    ds_read_b64_tr_b16 a[238:239], v13 offset:21504
    v_mfma_f32_16x16x32_bf16 v[124:127], a[252:255], a[140:143], v[124:127]
    buffer_load_dwordx4 v33, s[16:19], s50 offen offset:1024 lds
    s_waitcnt lgkmcnt(15)
    v_mfma_f32_16x16x32_bf16 v[80:83], a[192:195], a[68:71], v[80:83]
    ds_read_b64_tr_b16 a[240:241], v12 offset:64
    v_mfma_f32_16x16x32_bf16 v[84:87], a[192:195], a[140:143], v[84:87]
    ds_read_b64_tr_b16 a[242:243], v12 offset:3136
    v_mfma_f32_16x16x32_bf16 v[128:131], a[196:199], a[68:71], v[128:131]
    ds_read_b64_tr_b16 a[244:245], v12 offset:18496
    ds_read_b64_tr_b16 a[246:247], v12 offset:21568
    v_mfma_f32_16x16x32_bf16 v[132:135], a[196:199], a[140:143], v[132:135]
    buffer_load_dwordx4 v34, s[16:19], s50 offen offset:2048 lds
    s_add_u32 m0, s47, 3072
    v_mfma_f32_16x16x32_bf16 v[88:91], a[200:203], a[68:71], v[88:91]
    ds_read_b64_tr_b16 a[248:249], v13 offset:64
    v_mfma_f32_16x16x32_bf16 v[92:95], a[200:203], a[140:143], v[92:95]
    s_mov_b32 s50, 1917120
    ds_read_b64_tr_b16 a[250:251], v13 offset:3136
    v_mfma_f32_16x16x32_bf16 v[136:139], a[204:207], a[68:71], v[136:139]
    ds_read_b64_tr_b16 a[252:253], v13 offset:18496
    ds_read_b64_tr_b16 a[254:255], v13 offset:21568
    v_mfma_f32_16x16x32_bf16 v[140:143], a[204:207], a[140:143], v[140:143]
    buffer_load_dwordx4 v32, s[16:19], s50 offen offset:0 lds
    s_waitcnt lgkmcnt(15)
    v_mfma_f32_16x16x32_bf16 v[96:99], a[208:211], a[68:71], v[96:99]
    ds_read_b64_tr_b16 a[192:193], v12 offset:128
    v_mfma_f32_16x16x32_bf16 v[100:103], a[208:211], a[140:143], v[100:103]
    ds_read_b64_tr_b16 a[194:195], v12 offset:3200
    v_mfma_f32_16x16x32_bf16 v[144:147], a[212:215], a[68:71], v[144:147]
    ds_read_b64_tr_b16 a[196:197], v12 offset:18560
    ds_read_b64_tr_b16 a[198:199], v12 offset:21632
    v_mfma_f32_16x16x32_bf16 v[148:151], a[212:215], a[140:143], v[148:151]
    buffer_load_dwordx4 v33, s[16:19], s50 offen offset:1024 lds
    v_mfma_f32_16x16x32_bf16 v[104:107], a[216:219], a[68:71], v[104:107]
    ds_read_b64_tr_b16 a[200:201], v13 offset:128
    v_mfma_f32_16x16x32_bf16 v[108:111], a[216:219], a[140:143], v[108:111]
    ds_read_b64_tr_b16 a[202:203], v13 offset:3200
    v_mfma_f32_16x16x32_bf16 v[152:155], a[220:223], a[68:71], v[152:155]
    ds_read_b64_tr_b16 a[204:205], v13 offset:18560
    ds_read_b64_tr_b16 a[206:207], v13 offset:21632
    v_mfma_f32_16x16x32_bf16 v[156:159], a[220:223], a[140:143], v[156:159]
    buffer_load_dwordx4 v34, s[16:19], s50 offen offset:2048 lds
    s_add_u32 m0, s47, 6144
    s_waitcnt lgkmcnt(15)
    v_mfma_f32_16x16x32_bf16 v[160:163], a[224:227], a[0:3], 0
    ds_read_b64_tr_b16 a[208:209], v12 offset:6144
    v_mfma_f32_16x16x32_bf16 v[164:167], a[224:227], a[72:75], 0
    s_mov_b32 s50, 2064576
    ds_read_b64_tr_b16 a[210:211], v12 offset:9216
    v_mfma_f32_16x16x32_bf16 v[208:211], a[228:231], a[0:3], 0
    ds_read_b64_tr_b16 a[212:213], v12 offset:24576
    ds_read_b64_tr_b16 a[214:215], v12 offset:27648
    v_mfma_f32_16x16x32_bf16 v[212:215], a[228:231], a[72:75], 0
    buffer_load_dwordx4 v32, s[16:19], s50 offen offset:0 lds
    v_mfma_f32_16x16x32_bf16 v[168:171], a[232:235], a[0:3], 0
    ds_read_b64_tr_b16 a[216:217], v13 offset:6144
    ds_read_b64_tr_b16 a[218:219], v13 offset:9216
    v_mfma_f32_16x16x32_bf16 v[172:175], a[232:235], a[72:75], 0
    v_exp_f32 v40, v64
    v_mfma_f32_16x16x32_bf16 v[216:219], a[236:239], a[0:3], 0
    ds_read_b64_tr_b16 a[220:221], v13 offset:24576
    ds_read_b64_tr_b16 a[222:223], v13 offset:27648
    v_mfma_f32_16x16x32_bf16 v[220:223], a[236:239], a[72:75], 0
    buffer_load_dwordx4 v33, s[16:19], s50 offen offset:1024 lds
    s_waitcnt lgkmcnt(15)
    v_mfma_f32_16x16x32_bf16 v[176:179], a[240:243], a[0:3], 0
    ds_read_b64_tr_b16 a[224:225], v12 offset:6208
    v_mul_f32 v64, v64, v112
    v_mfma_f32_16x16x32_bf16 v[180:183], a[240:243], a[72:75], 0
    ds_read_b64_tr_b16 a[226:227], v12 offset:9280
    v_add_f32 v40, 1.0, v40
    v_mfma_f32_16x16x32_bf16 v[224:227], a[244:247], a[0:3], 0
    ds_read_b64_tr_b16 a[228:229], v12 offset:24640
    ds_read_b64_tr_b16 a[230:231], v12 offset:27712
    v_mfma_f32_16x16x32_bf16 v[228:231], a[244:247], a[72:75], 0
    buffer_load_dwordx4 v34, s[16:19], s50 offen offset:2048 lds
    v_mfma_f32_16x16x32_bf16 v[184:187], a[248:251], a[0:3], 0
    ds_read_b64_tr_b16 a[232:233], v13 offset:6208
    ds_read_b64_tr_b16 a[234:235], v13 offset:9280
    v_mfma_f32_16x16x32_bf16 v[188:191], a[248:251], a[72:75], 0
    v_exp_f32 v41, v65
    v_mfma_f32_16x16x32_bf16 v[232:235], a[252:255], a[0:3], 0
    ds_read_b64_tr_b16 a[236:237], v13 offset:24640
    v_mul_f32 v65, v65, v113
    v_mfma_f32_16x16x32_bf16 v[236:239], a[252:255], a[72:75], 0
    ds_read_b64_tr_b16 a[238:239], v13 offset:27712
    s_waitcnt lgkmcnt(15)
    v_mfma_f32_16x16x32_bf16 v[192:195], a[192:195], a[0:3], 0
    ds_read_b64_tr_b16 a[240:241], v12 offset:6272
    ds_read_b64_tr_b16 a[242:243], v12 offset:9344
    v_mfma_f32_16x16x32_bf16 v[196:199], a[192:195], a[72:75], 0
    v_exp_f32 v42, v66
    v_mfma_f32_16x16x32_bf16 v[240:243], a[196:199], a[0:3], 0
    ds_read_b64_tr_b16 a[244:245], v12 offset:24704
    v_mul_f32 v66, v66, v114
    v_mfma_f32_16x16x32_bf16 v[244:247], a[196:199], a[72:75], 0
    ds_read_b64_tr_b16 a[246:247], v12 offset:27776
    v_add_f32 v41, 1.0, v41
    v_mfma_f32_16x16x32_bf16 v[200:203], a[200:203], a[0:3], 0
    ds_read_b64_tr_b16 a[248:249], v13 offset:6272
    ds_read_b64_tr_b16 a[250:251], v13 offset:9344
    v_mfma_f32_16x16x32_bf16 v[204:207], a[200:203], a[72:75], 0
    v_exp_f32 v43, v67
    v_mfma_f32_16x16x32_bf16 v[248:251], a[204:207], a[0:3], 0
    ds_read_b64_tr_b16 a[252:253], v13 offset:24704
    v_mul_f32 v67, v67, v115
    v_mfma_f32_16x16x32_bf16 v[252:255], a[204:207], a[72:75], 0
    ds_read_b64_tr_b16 a[254:255], v13 offset:27776
    s_waitcnt lgkmcnt(15)
    v_mfma_f32_16x16x32_bf16 v[160:163], a[208:211], a[4:7], v[160:163]
    ds_read_b64_tr_b16 a[192:193], v12 offset:12288
    ds_read_b64_tr_b16 a[194:195], v12 offset:15360
    v_mfma_f32_16x16x32_bf16 v[164:167], a[208:211], a[76:79], v[164:167]
    v_exp_f32 v44, v72
    v_mfma_f32_16x16x32_bf16 v[208:211], a[212:215], a[4:7], v[208:211]
    ds_read_b64_tr_b16 a[196:197], v12 offset:30720
    v_mul_f32 v72, v72, v120
    v_mfma_f32_16x16x32_bf16 v[212:215], a[212:215], a[76:79], v[212:215]
    ds_read_b64_tr_b16 a[198:199], v12 offset:33792
    v_add_f32 v42, 1.0, v42
    v_mfma_f32_16x16x32_bf16 v[168:171], a[216:219], a[4:7], v[168:171]
    ds_read_b64_tr_b16 a[200:201], v13 offset:12288
    ds_read_b64_tr_b16 a[202:203], v13 offset:15360
    v_mfma_f32_16x16x32_bf16 v[172:175], a[216:219], a[76:79], v[172:175]
    v_exp_f32 v45, v73
    v_mfma_f32_16x16x32_bf16 v[216:219], a[220:223], a[4:7], v[216:219]
    ds_read_b64_tr_b16 a[204:205], v13 offset:30720
    v_mul_f32 v73, v73, v121
    v_mfma_f32_16x16x32_bf16 v[220:223], a[220:223], a[76:79], v[220:223]
    ds_read_b64_tr_b16 a[206:207], v13 offset:33792
    s_waitcnt lgkmcnt(15)
    v_mfma_f32_16x16x32_bf16 v[176:179], a[224:227], a[4:7], v[176:179]
    ds_read_b64_tr_b16 a[208:209], v12 offset:12352
    ds_read_b64_tr_b16 a[210:211], v12 offset:15424
    v_mfma_f32_16x16x32_bf16 v[180:183], a[224:227], a[76:79], v[180:183]
    v_exp_f32 v46, v74
    v_mfma_f32_16x16x32_bf16 v[224:227], a[228:231], a[4:7], v[224:227]
    ds_read_b64_tr_b16 a[212:213], v12 offset:30784
    v_mul_f32 v74, v74, v122
    v_mfma_f32_16x16x32_bf16 v[228:231], a[228:231], a[76:79], v[228:231]
    ds_read_b64_tr_b16 a[214:215], v12 offset:33856
    v_add_f32 v43, 1.0, v43
    v_mfma_f32_16x16x32_bf16 v[184:187], a[232:235], a[4:7], v[184:187]
    ds_read_b64_tr_b16 a[216:217], v13 offset:12352
    ds_read_b64_tr_b16 a[218:219], v13 offset:15424
    v_mfma_f32_16x16x32_bf16 v[188:191], a[232:235], a[76:79], v[188:191]
    v_exp_f32 v47, v75
    v_mfma_f32_16x16x32_bf16 v[232:235], a[236:239], a[4:7], v[232:235]
    ds_read_b64_tr_b16 a[220:221], v13 offset:30784
    v_mul_f32 v75, v75, v123
    v_mfma_f32_16x16x32_bf16 v[236:239], a[236:239], a[76:79], v[236:239]
    ds_read_b64_tr_b16 a[222:223], v13 offset:33856
    s_waitcnt lgkmcnt(15)
    v_mfma_f32_16x16x32_bf16 v[192:195], a[240:243], a[4:7], v[192:195]
    ds_read_b64_tr_b16 a[224:225], v12 offset:12416
    v_add_f32 v44, 1.0, v44
    v_mfma_f32_16x16x32_bf16 v[196:199], a[240:243], a[76:79], v[196:199]
    ds_read_b64_tr_b16 a[226:227], v12 offset:15488
    v_add_f32 v45, 1.0, v45
    v_mfma_f32_16x16x32_bf16 v[240:243], a[244:247], a[4:7], v[240:243]
    ds_read_b64_tr_b16 a[228:229], v12 offset:30848
    v_add_f32 v46, 1.0, v46
    v_mfma_f32_16x16x32_bf16 v[244:247], a[244:247], a[76:79], v[244:247]
    ds_read_b64_tr_b16 a[230:231], v12 offset:33920
    v_add_f32 v47, 1.0, v47
    v_mfma_f32_16x16x32_bf16 v[200:203], a[248:251], a[4:7], v[200:203]
    ds_read_b64_tr_b16 a[232:233], v13 offset:12416
    ds_read_b64_tr_b16 a[234:235], v13 offset:15488
    v_mfma_f32_16x16x32_bf16 v[204:207], a[248:251], a[76:79], v[204:207]
    v_rcp_f32 v40, v40
    v_mfma_f32_16x16x32_bf16 v[248:251], a[252:255], a[4:7], v[248:251]
    ds_read_b64_tr_b16 a[236:237], v13 offset:30848
    v_mul_f32 v64, v64, v40
    v_mfma_f32_16x16x32_bf16 v[252:255], a[252:255], a[76:79], v[252:255]
    s_add_u32 m0, s47, 36864
    ds_read_b64_tr_b16 a[238:239], v13 offset:33920
    s_waitcnt vmcnt(9)
    s_barrier
    s_waitcnt lgkmcnt(15)
    v_mfma_f32_16x16x32_bf16 v[160:163], a[192:195], a[8:11], v[160:163]
    ds_read_b64_tr_b16 a[240:241], v14 offset:0
    v_mfma_f32_16x16x32_bf16 v[164:167], a[192:195], a[80:83], v[164:167]
    s_mov_b32 s50, 2654400
    ds_read_b64_tr_b16 a[242:243], v14 offset:3072
    v_mfma_f32_16x16x32_bf16 v[208:211], a[196:199], a[8:11], v[208:211]
    ds_read_b64_tr_b16 a[244:245], v14 offset:18432
    ds_read_b64_tr_b16 a[246:247], v14 offset:21504
    v_mfma_f32_16x16x32_bf16 v[212:215], a[196:199], a[80:83], v[212:215]
    buffer_load_dwordx4 v32, s[16:19], s50 offen offset:0 lds
    v_mfma_f32_16x16x32_bf16 v[168:171], a[200:203], a[8:11], v[168:171]
    ds_read_b64_tr_b16 a[248:249], v15 offset:0
    ds_read_b64_tr_b16 a[250:251], v15 offset:3072
    v_mfma_f32_16x16x32_bf16 v[172:175], a[200:203], a[80:83], v[172:175]
    v_rcp_f32 v41, v41
    v_mfma_f32_16x16x32_bf16 v[216:219], a[204:207], a[8:11], v[216:219]
    ds_read_b64_tr_b16 a[252:253], v15 offset:18432
    ds_read_b64_tr_b16 a[254:255], v15 offset:21504
    v_mfma_f32_16x16x32_bf16 v[220:223], a[204:207], a[80:83], v[220:223]
    buffer_load_dwordx4 v33, s[16:19], s50 offen offset:1024 lds
    s_waitcnt lgkmcnt(15)
    v_mfma_f32_16x16x32_bf16 v[176:179], a[208:211], a[8:11], v[176:179]
    ds_read_b64_tr_b16 a[192:193], v14 offset:64
    ds_read_b64_tr_b16 a[194:195], v14 offset:3136
    v_mfma_f32_16x16x32_bf16 v[180:183], a[208:211], a[80:83], v[180:183]
    v_rcp_f32 v42, v42
    v_mfma_f32_16x16x32_bf16 v[224:227], a[212:215], a[8:11], v[224:227]
    ds_read_b64_tr_b16 a[196:197], v14 offset:18496
    ds_read_b64_tr_b16 a[198:199], v14 offset:21568
    v_mfma_f32_16x16x32_bf16 v[228:231], a[212:215], a[80:83], v[228:231]
    buffer_load_dwordx4 v34, s[16:19], s50 offen offset:2048 lds
    s_add_u32 m0, s47, 39936
    v_mfma_f32_16x16x32_bf16 v[184:187], a[216:219], a[8:11], v[184:187]
    ds_read_b64_tr_b16 a[200:201], v15 offset:64
    v_mul_f32 v65, v65, v41
    v_mfma_f32_16x16x32_bf16 v[188:191], a[216:219], a[80:83], v[188:191]
    s_mov_b32 s50, 2801856
    ds_read_b64_tr_b16 a[202:203], v15 offset:3136
    v_mfma_f32_16x16x32_bf16 v[232:235], a[220:223], a[8:11], v[232:235]
    ds_read_b64_tr_b16 a[204:205], v15 offset:18496
    ds_read_b64_tr_b16 a[206:207], v15 offset:21568
    v_mfma_f32_16x16x32_bf16 v[236:239], a[220:223], a[80:83], v[236:239]
    buffer_load_dwordx4 v32, s[16:19], s50 offen offset:0 lds
    s_waitcnt lgkmcnt(15)
    v_mfma_f32_16x16x32_bf16 v[192:195], a[224:227], a[8:11], v[192:195]
    ds_read_b64_tr_b16 a[208:209], v14 offset:128
    ds_read_b64_tr_b16 a[210:211], v14 offset:3200
    v_mfma_f32_16x16x32_bf16 v[196:199], a[224:227], a[80:83], v[196:199]
    v_rcp_f32 v43, v43
    v_mfma_f32_16x16x32_bf16 v[240:243], a[228:231], a[8:11], v[240:243]
    ds_read_b64_tr_b16 a[212:213], v14 offset:18560
    ds_read_b64_tr_b16 a[214:215], v14 offset:21632
    v_mfma_f32_16x16x32_bf16 v[244:247], a[228:231], a[80:83], v[244:247]
    buffer_load_dwordx4 v33, s[16:19], s50 offen offset:1024 lds
    v_mfma_f32_16x16x32_bf16 v[200:203], a[232:235], a[8:11], v[200:203]
    ds_read_b64_tr_b16 a[216:217], v15 offset:128
    ds_read_b64_tr_b16 a[218:219], v15 offset:3200
    v_mfma_f32_16x16x32_bf16 v[204:207], a[232:235], a[80:83], v[204:207]
    v_rcp_f32 v44, v44
    v_mfma_f32_16x16x32_bf16 v[248:251], a[236:239], a[8:11], v[248:251]
    ds_read_b64_tr_b16 a[220:221], v15 offset:18560
    ds_read_b64_tr_b16 a[222:223], v15 offset:21632
    v_mfma_f32_16x16x32_bf16 v[252:255], a[236:239], a[80:83], v[252:255]
    buffer_load_dwordx4 v34, s[16:19], s50 offen offset:2048 lds
    s_add_u32 m0, s47, 43008
    s_waitcnt lgkmcnt(15)
    v_mfma_f32_16x16x32_bf16 v[160:163], a[240:243], a[12:15], v[160:163]
    ds_read_b64_tr_b16 a[224:225], v14 offset:6144
    v_mul_f32 v66, v66, v42
    v_mfma_f32_16x16x32_bf16 v[164:167], a[240:243], a[84:87], v[164:167]
    s_mov_b32 s50, 2949312
    ds_read_b64_tr_b16 a[226:227], v14 offset:9216
    v_mfma_f32_16x16x32_bf16 v[208:211], a[244:247], a[12:15], v[208:211]
    ds_read_b64_tr_b16 a[228:229], v14 offset:24576
    ds_read_b64_tr_b16 a[230:231], v14 offset:27648
    v_mfma_f32_16x16x32_bf16 v[212:215], a[244:247], a[84:87], v[212:215]
    buffer_load_dwordx4 v32, s[16:19], s50 offen offset:0 lds
    v_mfma_f32_16x16x32_bf16 v[168:171], a[248:251], a[12:15], v[168:171]
    ds_read_b64_tr_b16 a[232:233], v15 offset:6144
    ds_read_b64_tr_b16 a[234:235], v15 offset:9216
    v_mfma_f32_16x16x32_bf16 v[172:175], a[248:251], a[84:87], v[172:175]
    v_rcp_f32 v45, v45
    v_mfma_f32_16x16x32_bf16 v[216:219], a[252:255], a[12:15], v[216:219]
    ds_read_b64_tr_b16 a[236:237], v15 offset:24576
    ds_read_b64_tr_b16 a[238:239], v15 offset:27648
    v_mfma_f32_16x16x32_bf16 v[220:223], a[252:255], a[84:87], v[220:223]
    buffer_load_dwordx4 v33, s[16:19], s50 offen offset:1024 lds
    s_waitcnt lgkmcnt(15)
    v_mfma_f32_16x16x32_bf16 v[176:179], a[192:195], a[12:15], v[176:179]
    ds_read_b64_tr_b16 a[240:241], v14 offset:6208
    ds_read_b64_tr_b16 a[242:243], v14 offset:9280
    v_mfma_f32_16x16x32_bf16 v[180:183], a[192:195], a[84:87], v[180:183]
    v_rcp_f32 v46, v46
    v_mfma_f32_16x16x32_bf16 v[224:227], a[196:199], a[12:15], v[224:227]
    ds_read_b64_tr_b16 a[244:245], v14 offset:24640
    ds_read_b64_tr_b16 a[246:247], v14 offset:27712
    v_mfma_f32_16x16x32_bf16 v[228:231], a[196:199], a[84:87], v[228:231]
    buffer_load_dwordx4 v34, s[16:19], s50 offen offset:2048 lds
    v_mfma_f32_16x16x32_bf16 v[184:187], a[200:203], a[12:15], v[184:187]
    ds_read_b64_tr_b16 a[248:249], v15 offset:6208
    ds_read_b64_tr_b16 a[250:251], v15 offset:9280
    v_mfma_f32_16x16x32_bf16 v[188:191], a[200:203], a[84:87], v[188:191]
    v_rcp_f32 v47, v47
    v_mfma_f32_16x16x32_bf16 v[232:235], a[204:207], a[12:15], v[232:235]
    ds_read_b64_tr_b16 a[252:253], v15 offset:24640
    v_mul_f32 v67, v67, v43
    v_mfma_f32_16x16x32_bf16 v[236:239], a[204:207], a[84:87], v[236:239]
    ds_read_b64_tr_b16 a[254:255], v15 offset:27712
    s_waitcnt lgkmcnt(15)
    v_mfma_f32_16x16x32_bf16 v[192:195], a[208:211], a[12:15], v[192:195]
    ds_read_b64_tr_b16 a[192:193], v14 offset:6272
    v_mul_f32 v72, v72, v44
    v_mfma_f32_16x16x32_bf16 v[196:199], a[208:211], a[84:87], v[196:199]
    ds_read_b64_tr_b16 a[194:195], v14 offset:9344
    v_mul_f32 v73, v73, v45
    v_mfma_f32_16x16x32_bf16 v[240:243], a[212:215], a[12:15], v[240:243]
    ds_read_b64_tr_b16 a[196:197], v14 offset:24704
    v_mul_f32 v74, v74, v46
    v_mfma_f32_16x16x32_bf16 v[244:247], a[212:215], a[84:87], v[244:247]
    ds_read_b64_tr_b16 a[198:199], v14 offset:27776
    v_mul_f32 v75, v75, v47
    v_mfma_f32_16x16x32_bf16 v[200:203], a[216:219], a[12:15], v[200:203]
    ds_read_b64_tr_b16 a[200:201], v15 offset:6272
    v_cvt_pk_bf16_f32 v56, v64, v65
    v_mfma_f32_16x16x32_bf16 v[204:207], a[216:219], a[84:87], v[204:207]
    ds_read_b64_tr_b16 a[202:203], v15 offset:9344
    v_cvt_pk_bf16_f32 v57, v66, v67
    v_mfma_f32_16x16x32_bf16 v[248:251], a[220:223], a[12:15], v[248:251]
    ds_read_b64_tr_b16 a[204:205], v15 offset:24704
    v_cvt_pk_bf16_f32 v58, v72, v73
    v_mfma_f32_16x16x32_bf16 v[252:255], a[220:223], a[84:87], v[252:255]
    ds_read_b64_tr_b16 a[206:207], v15 offset:27776
    s_waitcnt lgkmcnt(15)
    v_mfma_f32_16x16x32_bf16 v[160:163], a[224:227], a[16:19], v[160:163]
    ds_read_b64_tr_b16 a[208:209], v14 offset:12288
    v_cvt_pk_bf16_f32 v59, v74, v75
    v_mfma_f32_16x16x32_bf16 v[164:167], a[224:227], a[88:91], v[164:167]
    ds_read_b64_tr_b16 a[210:211], v14 offset:15360
    v_accvgpr_write_b32 a144, v56
    v_mfma_f32_16x16x32_bf16 v[208:211], a[228:231], a[16:19], v[208:211]
    ds_read_b64_tr_b16 a[212:213], v14 offset:30720
    v_accvgpr_write_b32 a145, v57
    v_mfma_f32_16x16x32_bf16 v[212:215], a[228:231], a[88:91], v[212:215]
    ds_read_b64_tr_b16 a[214:215], v14 offset:33792
    v_accvgpr_write_b32 a146, v58
    v_mfma_f32_16x16x32_bf16 v[168:171], a[232:235], a[16:19], v[168:171]
    ds_read_b64_tr_b16 a[216:217], v15 offset:12288
    v_accvgpr_write_b32 a147, v59
    v_mfma_f32_16x16x32_bf16 v[172:175], a[232:235], a[88:91], v[172:175]
    ds_read_b64_tr_b16 a[218:219], v15 offset:15360
    v_mfma_f32_16x16x32_bf16 v[216:219], a[236:239], a[16:19], v[216:219]
    ds_read_b64_tr_b16 a[220:221], v15 offset:30720
    ds_read_b64_tr_b16 a[222:223], v15 offset:33792
    v_mfma_f32_16x16x32_bf16 v[220:223], a[236:239], a[88:91], v[220:223]
    s_waitcnt lgkmcnt(15)
    v_mfma_f32_16x16x32_bf16 v[176:179], a[240:243], a[16:19], v[176:179]
    ds_read_b64_tr_b16 a[224:225], v14 offset:12352
    ds_read_b64_tr_b16 a[226:227], v14 offset:15424
    v_mfma_f32_16x16x32_bf16 v[180:183], a[240:243], a[88:91], v[180:183]
    v_exp_f32 v48, v68
    v_mfma_f32_16x16x32_bf16 v[224:227], a[244:247], a[16:19], v[224:227]
    ds_read_b64_tr_b16 a[228:229], v14 offset:30784
    v_mul_f32 v68, v68, v116
    v_mfma_f32_16x16x32_bf16 v[228:231], a[244:247], a[88:91], v[228:231]
    ds_read_b64_tr_b16 a[230:231], v14 offset:33856
    v_add_f32 v48, 1.0, v48
    v_mfma_f32_16x16x32_bf16 v[184:187], a[248:251], a[16:19], v[184:187]
    ds_read_b64_tr_b16 a[232:233], v15 offset:12352
    ds_read_b64_tr_b16 a[234:235], v15 offset:15424
    v_mfma_f32_16x16x32_bf16 v[188:191], a[248:251], a[88:91], v[188:191]
    v_exp_f32 v49, v69
    v_mfma_f32_16x16x32_bf16 v[232:235], a[252:255], a[16:19], v[232:235]
    ds_read_b64_tr_b16 a[236:237], v15 offset:30784
    v_mul_f32 v69, v69, v117
    v_mfma_f32_16x16x32_bf16 v[236:239], a[252:255], a[88:91], v[236:239]
    ds_read_b64_tr_b16 a[238:239], v15 offset:33856
    s_waitcnt lgkmcnt(15)
    v_mfma_f32_16x16x32_bf16 v[192:195], a[192:195], a[16:19], v[192:195]
    ds_read_b64_tr_b16 a[240:241], v14 offset:12416
    ds_read_b64_tr_b16 a[242:243], v14 offset:15488
    v_mfma_f32_16x16x32_bf16 v[196:199], a[192:195], a[88:91], v[196:199]
    v_exp_f32 v50, v70
    v_mfma_f32_16x16x32_bf16 v[240:243], a[196:199], a[16:19], v[240:243]
    ds_read_b64_tr_b16 a[244:245], v14 offset:30848
    v_mul_f32 v70, v70, v118
    v_mfma_f32_16x16x32_bf16 v[244:247], a[196:199], a[88:91], v[244:247]
    ds_read_b64_tr_b16 a[246:247], v14 offset:33920
    v_add_f32 v49, 1.0, v49
    v_mfma_f32_16x16x32_bf16 v[200:203], a[200:203], a[16:19], v[200:203]
    ds_read_b64_tr_b16 a[248:249], v15 offset:12416
    ds_read_b64_tr_b16 a[250:251], v15 offset:15488
    v_mfma_f32_16x16x32_bf16 v[204:207], a[200:203], a[88:91], v[204:207]
    v_exp_f32 v51, v71
    v_mfma_f32_16x16x32_bf16 v[248:251], a[204:207], a[16:19], v[248:251]
    ds_read_b64_tr_b16 a[252:253], v15 offset:30848
    v_mul_f32 v71, v71, v119
    v_mfma_f32_16x16x32_bf16 v[252:255], a[204:207], a[88:91], v[252:255]
    s_add_u32 m0, s47, 73728
    ds_read_b64_tr_b16 a[254:255], v15 offset:33920
    s_waitcnt vmcnt(9)
    s_barrier
    s_waitcnt lgkmcnt(15)
    v_mfma_f32_16x16x32_bf16 v[160:163], a[208:211], a[20:23], v[160:163]
    ds_read_b64_tr_b16 a[192:193], v8 offset:0
    v_add_f32 v50, 1.0, v50
    v_mfma_f32_16x16x32_bf16 v[164:167], a[208:211], a[92:95], v[164:167]
    s_mov_b32 s50, 3539136
    ds_read_b64_tr_b16 a[194:195], v8 offset:3072
    v_mfma_f32_16x16x32_bf16 v[208:211], a[212:215], a[20:23], v[208:211]
    ds_read_b64_tr_b16 a[196:197], v8 offset:18432
    ds_read_b64_tr_b16 a[198:199], v8 offset:21504
    v_mfma_f32_16x16x32_bf16 v[212:215], a[212:215], a[92:95], v[212:215]
    buffer_load_dwordx4 v32, s[16:19], s50 offen offset:0 lds
    v_mfma_f32_16x16x32_bf16 v[168:171], a[216:219], a[20:23], v[168:171]
    ds_read_b64_tr_b16 a[200:201], v9 offset:0
    ds_read_b64_tr_b16 a[202:203], v9 offset:3072
    v_mfma_f32_16x16x32_bf16 v[172:175], a[216:219], a[92:95], v[172:175]
    v_exp_f32 v52, v76
    v_mfma_f32_16x16x32_bf16 v[216:219], a[220:223], a[20:23], v[216:219]
    ds_read_b64_tr_b16 a[204:205], v9 offset:18432
    ds_read_b64_tr_b16 a[206:207], v9 offset:21504
    v_mfma_f32_16x16x32_bf16 v[220:223], a[220:223], a[92:95], v[220:223]
    buffer_load_dwordx4 v33, s[16:19], s50 offen offset:1024 lds
    s_waitcnt lgkmcnt(15)
    v_mfma_f32_16x16x32_bf16 v[176:179], a[224:227], a[20:23], v[176:179]
    ds_read_b64_tr_b16 a[208:209], v8 offset:64
    v_mul_f32 v76, v76, v124
    v_mfma_f32_16x16x32_bf16 v[180:183], a[224:227], a[92:95], v[180:183]
    ds_read_b64_tr_b16 a[210:211], v8 offset:3136
    v_add_f32 v51, 1.0, v51
    v_mfma_f32_16x16x32_bf16 v[224:227], a[228:231], a[20:23], v[224:227]
    ds_read_b64_tr_b16 a[212:213], v8 offset:18496
    ds_read_b64_tr_b16 a[214:215], v8 offset:21568
    v_mfma_f32_16x16x32_bf16 v[228:231], a[228:231], a[92:95], v[228:231]
    buffer_load_dwordx4 v34, s[16:19], s50 offen offset:2048 lds
    s_add_u32 m0, s47, 76800
    v_mfma_f32_16x16x32_bf16 v[184:187], a[232:235], a[20:23], v[184:187]
    ds_read_b64_tr_b16 a[216:217], v9 offset:64
    v_add_f32 v52, 1.0, v52
    v_mfma_f32_16x16x32_bf16 v[188:191], a[232:235], a[92:95], v[188:191]
    s_mov_b32 s50, 3686592
    ds_read_b64_tr_b16 a[218:219], v9 offset:3136
    v_mfma_f32_16x16x32_bf16 v[232:235], a[236:239], a[20:23], v[232:235]
    ds_read_b64_tr_b16 a[220:221], v9 offset:18496
    ds_read_b64_tr_b16 a[222:223], v9 offset:21568
    v_mfma_f32_16x16x32_bf16 v[236:239], a[236:239], a[92:95], v[236:239]
    buffer_load_dwordx4 v32, s[16:19], s50 offen offset:0 lds
    s_waitcnt lgkmcnt(15)
    v_mfma_f32_16x16x32_bf16 v[192:195], a[240:243], a[20:23], v[192:195]
    ds_read_b64_tr_b16 a[224:225], v8 offset:128
    ds_read_b64_tr_b16 a[226:227], v8 offset:3200
    v_mfma_f32_16x16x32_bf16 v[196:199], a[240:243], a[92:95], v[196:199]
    v_exp_f32 v53, v77
    v_mfma_f32_16x16x32_bf16 v[240:243], a[244:247], a[20:23], v[240:243]
    ds_read_b64_tr_b16 a[228:229], v8 offset:18560
    ds_read_b64_tr_b16 a[230:231], v8 offset:21632
    v_mfma_f32_16x16x32_bf16 v[244:247], a[244:247], a[92:95], v[244:247]
    buffer_load_dwordx4 v33, s[16:19], s50 offen offset:1024 lds
    v_mfma_f32_16x16x32_bf16 v[200:203], a[248:251], a[20:23], v[200:203]
    ds_read_b64_tr_b16 a[232:233], v9 offset:128
    v_mul_f32 v77, v77, v125
    v_mfma_f32_16x16x32_bf16 v[204:207], a[248:251], a[92:95], v[204:207]
    ds_read_b64_tr_b16 a[234:235], v9 offset:3200
    v_add_f32 v53, 1.0, v53
    v_mfma_f32_16x16x32_bf16 v[248:251], a[252:255], a[20:23], v[248:251]
    ds_read_b64_tr_b16 a[236:237], v9 offset:18560
    ds_read_b64_tr_b16 a[238:239], v9 offset:21632
    v_mfma_f32_16x16x32_bf16 v[252:255], a[252:255], a[92:95], v[252:255]
    buffer_load_dwordx4 v34, s[16:19], s50 offen offset:2048 lds
    s_add_u32 m0, s47, 79872
    s_waitcnt lgkmcnt(15)
    v_mfma_f32_16x16x32_bf16 v[160:163], a[192:195], a[24:27], v[160:163]
    ds_read_b64_tr_b16 a[240:241], v8 offset:6144
    v_mfma_f32_16x16x32_bf16 v[164:167], a[192:195], a[96:99], v[164:167]
    s_mov_b32 s50, 3834048
    ds_read_b64_tr_b16 a[242:243], v8 offset:9216
    v_mfma_f32_16x16x32_bf16 v[208:211], a[196:199], a[24:27], v[208:211]
    ds_read_b64_tr_b16 a[244:245], v8 offset:24576
    ds_read_b64_tr_b16 a[246:247], v8 offset:27648
    v_mfma_f32_16x16x32_bf16 v[212:215], a[196:199], a[96:99], v[212:215]
    buffer_load_dwordx4 v32, s[16:19], s50 offen offset:0 lds
    v_mfma_f32_16x16x32_bf16 v[168:171], a[200:203], a[24:27], v[168:171]
    ds_read_b64_tr_b16 a[248:249], v9 offset:6144
    ds_read_b64_tr_b16 a[250:251], v9 offset:9216
    v_mfma_f32_16x16x32_bf16 v[172:175], a[200:203], a[96:99], v[172:175]
    v_exp_f32 v54, v78
    v_mfma_f32_16x16x32_bf16 v[216:219], a[204:207], a[24:27], v[216:219]
    ds_read_b64_tr_b16 a[252:253], v9 offset:24576
    ds_read_b64_tr_b16 a[254:255], v9 offset:27648
    v_mfma_f32_16x16x32_bf16 v[220:223], a[204:207], a[96:99], v[220:223]
    buffer_load_dwordx4 v33, s[16:19], s50 offen offset:1024 lds
    s_waitcnt lgkmcnt(15)
    v_mfma_f32_16x16x32_bf16 v[176:179], a[208:211], a[24:27], v[176:179]
    ds_read_b64_tr_b16 a[192:193], v8 offset:6208
    v_mul_f32 v78, v78, v126
    v_mfma_f32_16x16x32_bf16 v[180:183], a[208:211], a[96:99], v[180:183]
    ds_read_b64_tr_b16 a[194:195], v8 offset:9280
    v_add_f32 v54, 1.0, v54
    v_mfma_f32_16x16x32_bf16 v[224:227], a[212:215], a[24:27], v[224:227]
    ds_read_b64_tr_b16 a[196:197], v8 offset:24640
    ds_read_b64_tr_b16 a[198:199], v8 offset:27712
    v_mfma_f32_16x16x32_bf16 v[228:231], a[212:215], a[96:99], v[228:231]
    buffer_load_dwordx4 v34, s[16:19], s50 offen offset:2048 lds
    v_mfma_f32_16x16x32_bf16 v[184:187], a[216:219], a[24:27], v[184:187]
    ds_read_b64_tr_b16 a[200:201], v9 offset:6208
    ds_read_b64_tr_b16 a[202:203], v9 offset:9280
    v_mfma_f32_16x16x32_bf16 v[188:191], a[216:219], a[96:99], v[188:191]
    v_exp_f32 v55, v79
    v_mfma_f32_16x16x32_bf16 v[232:235], a[220:223], a[24:27], v[232:235]
    ds_read_b64_tr_b16 a[204:205], v9 offset:24640
    v_mul_f32 v79, v79, v127
    v_mfma_f32_16x16x32_bf16 v[236:239], a[220:223], a[96:99], v[236:239]
    ds_read_b64_tr_b16 a[206:207], v9 offset:27712
    s_waitcnt lgkmcnt(15)
    v_mfma_f32_16x16x32_bf16 v[192:195], a[224:227], a[24:27], v[192:195]
    ds_read_b64_tr_b16 a[208:209], v8 offset:6272
    v_add_f32 v55, 1.0, v55
    v_mfma_f32_16x16x32_bf16 v[196:199], a[224:227], a[96:99], v[196:199]
    ds_read_b64_tr_b16 a[210:211], v8 offset:9344
    v_mfma_f32_16x16x32_bf16 v[240:243], a[228:231], a[24:27], v[240:243]
    ds_read_b64_tr_b16 a[212:213], v8 offset:24704
    ds_read_b64_tr_b16 a[214:215], v8 offset:27776
    v_mfma_f32_16x16x32_bf16 v[244:247], a[228:231], a[96:99], v[244:247]
    v_rcp_f32 v48, v48
    v_mfma_f32_16x16x32_bf16 v[200:203], a[232:235], a[24:27], v[200:203]
    ds_read_b64_tr_b16 a[216:217], v9 offset:6272
    ds_read_b64_tr_b16 a[218:219], v9 offset:9344
    v_mfma_f32_16x16x32_bf16 v[204:207], a[232:235], a[96:99], v[204:207]
    v_rcp_f32 v49, v49
    v_mfma_f32_16x16x32_bf16 v[248:251], a[236:239], a[24:27], v[248:251]
    ds_read_b64_tr_b16 a[220:221], v9 offset:24704
    ds_read_b64_tr_b16 a[222:223], v9 offset:27776
    v_mfma_f32_16x16x32_bf16 v[252:255], a[236:239], a[96:99], v[252:255]
    v_mul_f32 v68, v68, v48
    s_waitcnt lgkmcnt(15)
    v_mfma_f32_16x16x32_bf16 v[160:163], a[240:243], a[28:31], v[160:163]
    ds_read_b64_tr_b16 a[224:225], v8 offset:12288
    ds_read_b64_tr_b16 a[226:227], v8 offset:15360
    v_mfma_f32_16x16x32_bf16 v[164:167], a[240:243], a[100:103], v[164:167]
    v_rcp_f32 v50, v50
    v_mfma_f32_16x16x32_bf16 v[208:211], a[244:247], a[28:31], v[208:211]
    ds_read_b64_tr_b16 a[228:229], v8 offset:30720
    ds_read_b64_tr_b16 a[230:231], v8 offset:33792
    v_mfma_f32_16x16x32_bf16 v[212:215], a[244:247], a[100:103], v[212:215]
    v_rcp_f32 v51, v51
    v_mfma_f32_16x16x32_bf16 v[168:171], a[248:251], a[28:31], v[168:171]
    ds_read_b64_tr_b16 a[232:233], v9 offset:12288
    ds_read_b64_tr_b16 a[234:235], v9 offset:15360
    v_mfma_f32_16x16x32_bf16 v[172:175], a[248:251], a[100:103], v[172:175]
    v_rcp_f32 v52, v52
    v_mfma_f32_16x16x32_bf16 v[216:219], a[252:255], a[28:31], v[216:219]
    ds_read_b64_tr_b16 a[236:237], v9 offset:30720
    ds_read_b64_tr_b16 a[238:239], v9 offset:33792
    v_mfma_f32_16x16x32_bf16 v[220:223], a[252:255], a[100:103], v[220:223]
    v_mul_f32 v69, v69, v49
    s_waitcnt lgkmcnt(15)
    v_mfma_f32_16x16x32_bf16 v[176:179], a[192:195], a[28:31], v[176:179]
    ds_read_b64_tr_b16 a[240:241], v8 offset:12352
    ds_read_b64_tr_b16 a[242:243], v8 offset:15424
    v_mfma_f32_16x16x32_bf16 v[180:183], a[192:195], a[100:103], v[180:183]
    v_rcp_f32 v53, v53
    v_mfma_f32_16x16x32_bf16 v[224:227], a[196:199], a[28:31], v[224:227]
    ds_read_b64_tr_b16 a[244:245], v8 offset:30784
    ds_read_b64_tr_b16 a[246:247], v8 offset:33856
    v_mfma_f32_16x16x32_bf16 v[228:231], a[196:199], a[100:103], v[228:231]
    v_rcp_f32 v54, v54
    v_mfma_f32_16x16x32_bf16 v[184:187], a[200:203], a[28:31], v[184:187]
    ds_read_b64_tr_b16 a[248:249], v9 offset:12352
    ds_read_b64_tr_b16 a[250:251], v9 offset:15424
    v_mfma_f32_16x16x32_bf16 v[188:191], a[200:203], a[100:103], v[188:191]
    v_rcp_f32 v55, v55
    v_mfma_f32_16x16x32_bf16 v[232:235], a[204:207], a[28:31], v[232:235]
    ds_read_b64_tr_b16 a[252:253], v9 offset:30784
    v_mul_f32 v70, v70, v50
    v_mfma_f32_16x16x32_bf16 v[236:239], a[204:207], a[100:103], v[236:239]
    ds_read_b64_tr_b16 a[254:255], v9 offset:33856
    s_waitcnt lgkmcnt(15)
    v_mfma_f32_16x16x32_bf16 v[192:195], a[208:211], a[28:31], v[192:195]
    ds_read_b64_tr_b16 a[192:193], v8 offset:12416
    v_mul_f32 v71, v71, v51
    v_mfma_f32_16x16x32_bf16 v[196:199], a[208:211], a[100:103], v[196:199]
    ds_read_b64_tr_b16 a[194:195], v8 offset:15488
    v_mul_f32 v76, v76, v52
    v_mfma_f32_16x16x32_bf16 v[240:243], a[212:215], a[28:31], v[240:243]
    ds_read_b64_tr_b16 a[196:197], v8 offset:30848
    v_mul_f32 v77, v77, v53
    v_mfma_f32_16x16x32_bf16 v[244:247], a[212:215], a[100:103], v[244:247]
    ds_read_b64_tr_b16 a[198:199], v8 offset:33920
    v_mul_f32 v78, v78, v54
    v_mfma_f32_16x16x32_bf16 v[200:203], a[216:219], a[28:31], v[200:203]
    ds_read_b64_tr_b16 a[200:201], v9 offset:12416
    v_mul_f32 v79, v79, v55
    v_mfma_f32_16x16x32_bf16 v[204:207], a[216:219], a[100:103], v[204:207]
    ds_read_b64_tr_b16 a[202:203], v9 offset:15488
    v_cvt_pk_bf16_f32 v56, v68, v69
    v_mfma_f32_16x16x32_bf16 v[248:251], a[220:223], a[28:31], v[248:251]
    ds_read_b64_tr_b16 a[204:205], v9 offset:30848
    v_cvt_pk_bf16_f32 v57, v70, v71
    v_mfma_f32_16x16x32_bf16 v[252:255], a[220:223], a[100:103], v[252:255]
    s_add_u32 m0, s47, 110592
    ds_read_b64_tr_b16 a[206:207], v9 offset:33920
    s_waitcnt vmcnt(9)
    s_barrier
    s_waitcnt lgkmcnt(15)
    v_mfma_f32_16x16x32_bf16 v[160:163], a[224:227], a[32:35], v[160:163]
    ds_read_b64_tr_b16 a[208:209], v10 offset:0
    v_cvt_pk_bf16_f32 v58, v76, v77
    v_mfma_f32_16x16x32_bf16 v[164:167], a[224:227], a[104:107], v[164:167]
    s_mov_b32 s50, 4423872
    ds_read_b64_tr_b16 a[210:211], v10 offset:3072
    v_mfma_f32_16x16x32_bf16 v[208:211], a[228:231], a[32:35], v[208:211]
    ds_read_b64_tr_b16 a[212:213], v10 offset:18432
    ds_read_b64_tr_b16 a[214:215], v10 offset:21504
    v_mfma_f32_16x16x32_bf16 v[212:215], a[228:231], a[104:107], v[212:215]
    buffer_load_dwordx4 v32, s[16:19], s50 offen offset:0 lds
    v_mfma_f32_16x16x32_bf16 v[168:171], a[232:235], a[32:35], v[168:171]
    ds_read_b64_tr_b16 a[216:217], v11 offset:0
    v_cvt_pk_bf16_f32 v59, v78, v79
    v_mfma_f32_16x16x32_bf16 v[172:175], a[232:235], a[104:107], v[172:175]
    ds_read_b64_tr_b16 a[218:219], v11 offset:3072
    v_accvgpr_write_b32 a148, v56
    v_mfma_f32_16x16x32_bf16 v[216:219], a[236:239], a[32:35], v[216:219]
    ds_read_b64_tr_b16 a[220:221], v11 offset:18432
    ds_read_b64_tr_b16 a[222:223], v11 offset:21504
    v_mfma_f32_16x16x32_bf16 v[220:223], a[236:239], a[104:107], v[220:223]
    buffer_load_dwordx4 v33, s[16:19], s50 offen offset:1024 lds
    s_waitcnt lgkmcnt(15)
    v_mfma_f32_16x16x32_bf16 v[176:179], a[240:243], a[32:35], v[176:179]
    ds_read_b64_tr_b16 a[224:225], v10 offset:64
    v_accvgpr_write_b32 a149, v57
    v_mfma_f32_16x16x32_bf16 v[180:183], a[240:243], a[104:107], v[180:183]
    ds_read_b64_tr_b16 a[226:227], v10 offset:3136
    v_accvgpr_write_b32 a150, v58
    v_mfma_f32_16x16x32_bf16 v[224:227], a[244:247], a[32:35], v[224:227]
    ds_read_b64_tr_b16 a[228:229], v10 offset:18496
    ds_read_b64_tr_b16 a[230:231], v10 offset:21568
    v_mfma_f32_16x16x32_bf16 v[228:231], a[244:247], a[104:107], v[228:231]
    buffer_load_dwordx4 v34, s[16:19], s50 offen offset:2048 lds
    s_add_u32 m0, s47, 113664
    v_mfma_f32_16x16x32_bf16 v[184:187], a[248:251], a[32:35], v[184:187]
    ds_read_b64_tr_b16 a[232:233], v11 offset:64
    v_accvgpr_write_b32 a151, v59
    v_mfma_f32_16x16x32_bf16 v[188:191], a[248:251], a[104:107], v[188:191]
    s_mov_b32 s50, 4571328
    ds_read_b64_tr_b16 a[234:235], v11 offset:3136
    v_mfma_f32_16x16x32_bf16 v[232:235], a[252:255], a[32:35], v[232:235]
    ds_read_b64_tr_b16 a[236:237], v11 offset:18496
    ds_read_b64_tr_b16 a[238:239], v11 offset:21568
    v_mfma_f32_16x16x32_bf16 v[236:239], a[252:255], a[104:107], v[236:239]
    buffer_load_dwordx4 v32, s[16:19], s50 offen offset:0 lds
    s_waitcnt lgkmcnt(15)
    v_mfma_f32_16x16x32_bf16 v[192:195], a[192:195], a[32:35], v[192:195]
    ds_read_b64_tr_b16 a[240:241], v10 offset:128
    ds_read_b64_tr_b16 a[242:243], v10 offset:3200
    v_mfma_f32_16x16x32_bf16 v[196:199], a[192:195], a[104:107], v[196:199]
    v_exp_f32 v40, v80
    v_mfma_f32_16x16x32_bf16 v[240:243], a[196:199], a[32:35], v[240:243]
    ds_read_b64_tr_b16 a[244:245], v10 offset:18560
    ds_read_b64_tr_b16 a[246:247], v10 offset:21632
    v_mfma_f32_16x16x32_bf16 v[244:247], a[196:199], a[104:107], v[244:247]
    buffer_load_dwordx4 v33, s[16:19], s50 offen offset:1024 lds
    v_mfma_f32_16x16x32_bf16 v[200:203], a[200:203], a[32:35], v[200:203]
    ds_read_b64_tr_b16 a[248:249], v11 offset:128
    v_mul_f32 v80, v80, v128
    v_mfma_f32_16x16x32_bf16 v[204:207], a[200:203], a[104:107], v[204:207]
    ds_read_b64_tr_b16 a[250:251], v11 offset:3200
    v_add_f32 v40, 1.0, v40
    v_mfma_f32_16x16x32_bf16 v[248:251], a[204:207], a[32:35], v[248:251]
    ds_read_b64_tr_b16 a[252:253], v11 offset:18560
    ds_read_b64_tr_b16 a[254:255], v11 offset:21632
    v_mfma_f32_16x16x32_bf16 v[252:255], a[204:207], a[104:107], v[252:255]
    buffer_load_dwordx4 v34, s[16:19], s50 offen offset:2048 lds
    s_add_u32 m0, s47, 116736
    s_waitcnt lgkmcnt(15)
    v_mfma_f32_16x16x32_bf16 v[160:163], a[208:211], a[36:39], v[160:163]
    ds_read_b64_tr_b16 a[192:193], v10 offset:6144
    v_mfma_f32_16x16x32_bf16 v[164:167], a[208:211], a[108:111], v[164:167]
    s_mov_b32 s50, 4718784
    ds_read_b64_tr_b16 a[194:195], v10 offset:9216
    v_mfma_f32_16x16x32_bf16 v[208:211], a[212:215], a[36:39], v[208:211]
    ds_read_b64_tr_b16 a[196:197], v10 offset:24576
    ds_read_b64_tr_b16 a[198:199], v10 offset:27648
    v_mfma_f32_16x16x32_bf16 v[212:215], a[212:215], a[108:111], v[212:215]
    buffer_load_dwordx4 v32, s[16:19], s50 offen offset:0 lds
    v_mfma_f32_16x16x32_bf16 v[168:171], a[216:219], a[36:39], v[168:171]
    ds_read_b64_tr_b16 a[200:201], v11 offset:6144
    ds_read_b64_tr_b16 a[202:203], v11 offset:9216
    v_mfma_f32_16x16x32_bf16 v[172:175], a[216:219], a[108:111], v[172:175]
    v_exp_f32 v41, v81
    v_mfma_f32_16x16x32_bf16 v[216:219], a[220:223], a[36:39], v[216:219]
    ds_read_b64_tr_b16 a[204:205], v11 offset:24576
    ds_read_b64_tr_b16 a[206:207], v11 offset:27648
    v_mfma_f32_16x16x32_bf16 v[220:223], a[220:223], a[108:111], v[220:223]
    buffer_load_dwordx4 v33, s[16:19], s50 offen offset:1024 lds
    s_waitcnt lgkmcnt(15)
    v_mfma_f32_16x16x32_bf16 v[176:179], a[224:227], a[36:39], v[176:179]
    ds_read_b64_tr_b16 a[208:209], v10 offset:6208
    v_mul_f32 v81, v81, v129
    v_mfma_f32_16x16x32_bf16 v[180:183], a[224:227], a[108:111], v[180:183]
    ds_read_b64_tr_b16 a[210:211], v10 offset:9280
    v_add_f32 v41, 1.0, v41
    v_mfma_f32_16x16x32_bf16 v[224:227], a[228:231], a[36:39], v[224:227]
    ds_read_b64_tr_b16 a[212:213], v10 offset:24640
    ds_read_b64_tr_b16 a[214:215], v10 offset:27712
    v_mfma_f32_16x16x32_bf16 v[228:231], a[228:231], a[108:111], v[228:231]
    buffer_load_dwordx4 v34, s[16:19], s50 offen offset:2048 lds
    v_mfma_f32_16x16x32_bf16 v[184:187], a[232:235], a[36:39], v[184:187]
    ds_read_b64_tr_b16 a[216:217], v11 offset:6208
    ds_read_b64_tr_b16 a[218:219], v11 offset:9280
    v_mfma_f32_16x16x32_bf16 v[188:191], a[232:235], a[108:111], v[188:191]
    v_exp_f32 v42, v82
    v_mfma_f32_16x16x32_bf16 v[232:235], a[236:239], a[36:39], v[232:235]
    ds_read_b64_tr_b16 a[220:221], v11 offset:24640
    v_mul_f32 v82, v82, v130
    v_mfma_f32_16x16x32_bf16 v[236:239], a[236:239], a[108:111], v[236:239]
    ds_read_b64_tr_b16 a[222:223], v11 offset:27712
    s_waitcnt lgkmcnt(15)
    v_mfma_f32_16x16x32_bf16 v[192:195], a[240:243], a[36:39], v[192:195]
    ds_read_b64_tr_b16 a[224:225], v10 offset:6272
    ds_read_b64_tr_b16 a[226:227], v10 offset:9344
    v_mfma_f32_16x16x32_bf16 v[196:199], a[240:243], a[108:111], v[196:199]
    v_exp_f32 v43, v83
    v_mfma_f32_16x16x32_bf16 v[240:243], a[244:247], a[36:39], v[240:243]
    ds_read_b64_tr_b16 a[228:229], v10 offset:24704
    v_mul_f32 v83, v83, v131
    v_mfma_f32_16x16x32_bf16 v[244:247], a[244:247], a[108:111], v[244:247]
    ds_read_b64_tr_b16 a[230:231], v10 offset:27776
    v_add_f32 v42, 1.0, v42
    v_mfma_f32_16x16x32_bf16 v[200:203], a[248:251], a[36:39], v[200:203]
    ds_read_b64_tr_b16 a[232:233], v11 offset:6272
    ds_read_b64_tr_b16 a[234:235], v11 offset:9344
    v_mfma_f32_16x16x32_bf16 v[204:207], a[248:251], a[108:111], v[204:207]
    v_exp_f32 v44, v88
    v_mfma_f32_16x16x32_bf16 v[248:251], a[252:255], a[36:39], v[248:251]
    ds_read_b64_tr_b16 a[236:237], v11 offset:24704
    v_mul_f32 v88, v88, v136
    v_mfma_f32_16x16x32_bf16 v[252:255], a[252:255], a[108:111], v[252:255]
    ds_read_b64_tr_b16 a[238:239], v11 offset:27776
    s_waitcnt lgkmcnt(15)
    v_mfma_f32_16x16x32_bf16 v[160:163], a[192:195], a[40:43], v[160:163]
    ds_read_b64_tr_b16 a[240:241], v10 offset:12288
    ds_read_b64_tr_b16 a[242:243], v10 offset:15360
    v_mfma_f32_16x16x32_bf16 v[164:167], a[192:195], a[112:115], v[164:167]
    v_exp_f32 v45, v89
    v_mfma_f32_16x16x32_bf16 v[208:211], a[196:199], a[40:43], v[208:211]
    ds_read_b64_tr_b16 a[244:245], v10 offset:30720
    v_mul_f32 v89, v89, v137
    v_mfma_f32_16x16x32_bf16 v[212:215], a[196:199], a[112:115], v[212:215]
    ds_read_b64_tr_b16 a[246:247], v10 offset:33792
    v_add_f32 v43, 1.0, v43
    v_mfma_f32_16x16x32_bf16 v[168:171], a[200:203], a[40:43], v[168:171]
    ds_read_b64_tr_b16 a[248:249], v11 offset:12288
    ds_read_b64_tr_b16 a[250:251], v11 offset:15360
    v_mfma_f32_16x16x32_bf16 v[172:175], a[200:203], a[112:115], v[172:175]
    v_exp_f32 v46, v90
    v_mfma_f32_16x16x32_bf16 v[216:219], a[204:207], a[40:43], v[216:219]
    ds_read_b64_tr_b16 a[252:253], v11 offset:30720
    v_mul_f32 v90, v90, v138
    v_mfma_f32_16x16x32_bf16 v[220:223], a[204:207], a[112:115], v[220:223]
    ds_read_b64_tr_b16 a[254:255], v11 offset:33792
    s_waitcnt lgkmcnt(15)
    v_mfma_f32_16x16x32_bf16 v[176:179], a[208:211], a[40:43], v[176:179]
    ds_read_b64_tr_b16 a[192:193], v10 offset:12352
    ds_read_b64_tr_b16 a[194:195], v10 offset:15424
    v_mfma_f32_16x16x32_bf16 v[180:183], a[208:211], a[112:115], v[180:183]
    v_exp_f32 v47, v91
    v_mfma_f32_16x16x32_bf16 v[224:227], a[212:215], a[40:43], v[224:227]
    ds_read_b64_tr_b16 a[196:197], v10 offset:30784
    v_mul_f32 v91, v91, v139
    v_mfma_f32_16x16x32_bf16 v[228:231], a[212:215], a[112:115], v[228:231]
    ds_read_b64_tr_b16 a[198:199], v10 offset:33856
    v_add_f32 v44, 1.0, v44
    v_mfma_f32_16x16x32_bf16 v[184:187], a[216:219], a[40:43], v[184:187]
    ds_read_b64_tr_b16 a[200:201], v11 offset:12352
    v_add_f32 v45, 1.0, v45
    v_mfma_f32_16x16x32_bf16 v[188:191], a[216:219], a[112:115], v[188:191]
    ds_read_b64_tr_b16 a[202:203], v11 offset:15424
    v_add_f32 v46, 1.0, v46
    v_mfma_f32_16x16x32_bf16 v[232:235], a[220:223], a[40:43], v[232:235]
    ds_read_b64_tr_b16 a[204:205], v11 offset:30784
    v_add_f32 v47, 1.0, v47
    v_mfma_f32_16x16x32_bf16 v[236:239], a[220:223], a[112:115], v[236:239]
    ds_read_b64_tr_b16 a[206:207], v11 offset:33856
    s_waitcnt lgkmcnt(15)
    v_mfma_f32_16x16x32_bf16 v[192:195], a[224:227], a[40:43], v[192:195]
    ds_read_b64_tr_b16 a[208:209], v10 offset:12416
    ds_read_b64_tr_b16 a[210:211], v10 offset:15488
    v_mfma_f32_16x16x32_bf16 v[196:199], a[224:227], a[112:115], v[196:199]
    v_rcp_f32 v40, v40
    v_mfma_f32_16x16x32_bf16 v[240:243], a[228:231], a[40:43], v[240:243]
    ds_read_b64_tr_b16 a[212:213], v10 offset:30848
    ds_read_b64_tr_b16 a[214:215], v10 offset:33920
    v_mfma_f32_16x16x32_bf16 v[244:247], a[228:231], a[112:115], v[244:247]
    v_rcp_f32 v41, v41
    v_mfma_f32_16x16x32_bf16 v[200:203], a[232:235], a[40:43], v[200:203]
    ds_read_b64_tr_b16 a[216:217], v11 offset:12416
    ds_read_b64_tr_b16 a[218:219], v11 offset:15488
    v_mfma_f32_16x16x32_bf16 v[204:207], a[232:235], a[112:115], v[204:207]
    v_rcp_f32 v42, v42
    v_mfma_f32_16x16x32_bf16 v[248:251], a[236:239], a[40:43], v[248:251]
    ds_read_b64_tr_b16 a[220:221], v11 offset:30848
    v_mul_f32 v80, v80, v40
    v_mfma_f32_16x16x32_bf16 v[252:255], a[236:239], a[112:115], v[252:255]
    s_add_u32 m0, s47, 0
    ds_read_b64_tr_b16 a[222:223], v11 offset:33920
    s_waitcnt vmcnt(9)
    s_barrier
    s_waitcnt lgkmcnt(15)
    v_mfma_f32_16x16x32_bf16 v[160:163], a[240:243], a[44:47], v[160:163]
    ds_read_b64_tr_b16 a[224:225], v12 offset:0
    v_mul_f32 v81, v81, v41
    v_mfma_f32_16x16x32_bf16 v[164:167], a[240:243], a[116:119], v[164:167]
    s_mov_b32 s50, 384
    ds_read_b64_tr_b16 a[226:227], v12 offset:3072
    v_mfma_f32_16x16x32_bf16 v[208:211], a[244:247], a[44:47], v[208:211]
    ds_read_b64_tr_b16 a[228:229], v12 offset:18432
    ds_read_b64_tr_b16 a[230:231], v12 offset:21504
    v_mfma_f32_16x16x32_bf16 v[212:215], a[244:247], a[116:119], v[212:215]
    buffer_load_dwordx4 v32, s[16:19], s50 offen offset:0 lds
    v_mfma_f32_16x16x32_bf16 v[168:171], a[248:251], a[44:47], v[168:171]
    ds_read_b64_tr_b16 a[232:233], v13 offset:0
    ds_read_b64_tr_b16 a[234:235], v13 offset:3072
    v_mfma_f32_16x16x32_bf16 v[172:175], a[248:251], a[116:119], v[172:175]
    v_rcp_f32 v43, v43
    v_mfma_f32_16x16x32_bf16 v[216:219], a[252:255], a[44:47], v[216:219]
    ds_read_b64_tr_b16 a[236:237], v13 offset:18432
    ds_read_b64_tr_b16 a[238:239], v13 offset:21504
    v_mfma_f32_16x16x32_bf16 v[220:223], a[252:255], a[116:119], v[220:223]
    buffer_load_dwordx4 v33, s[16:19], s50 offen offset:1024 lds
    s_waitcnt lgkmcnt(15)
    v_mfma_f32_16x16x32_bf16 v[176:179], a[192:195], a[44:47], v[176:179]
    ds_read_b64_tr_b16 a[240:241], v12 offset:64
    ds_read_b64_tr_b16 a[242:243], v12 offset:3136
    v_mfma_f32_16x16x32_bf16 v[180:183], a[192:195], a[116:119], v[180:183]
    v_rcp_f32 v44, v44
    v_mfma_f32_16x16x32_bf16 v[224:227], a[196:199], a[44:47], v[224:227]
    ds_read_b64_tr_b16 a[244:245], v12 offset:18496
    ds_read_b64_tr_b16 a[246:247], v12 offset:21568
    v_mfma_f32_16x16x32_bf16 v[228:231], a[196:199], a[116:119], v[228:231]
    buffer_load_dwordx4 v34, s[16:19], s50 offen offset:2048 lds
    s_add_u32 m0, s47, 3072
    v_mfma_f32_16x16x32_bf16 v[184:187], a[200:203], a[44:47], v[184:187]
    ds_read_b64_tr_b16 a[248:249], v13 offset:64
    v_mul_f32 v82, v82, v42
    v_mfma_f32_16x16x32_bf16 v[188:191], a[200:203], a[116:119], v[188:191]
    s_mov_b32 s50, 147840
    ds_read_b64_tr_b16 a[250:251], v13 offset:3136
    v_mfma_f32_16x16x32_bf16 v[232:235], a[204:207], a[44:47], v[232:235]
    ds_read_b64_tr_b16 a[252:253], v13 offset:18496
    ds_read_b64_tr_b16 a[254:255], v13 offset:21568
    v_mfma_f32_16x16x32_bf16 v[236:239], a[204:207], a[116:119], v[236:239]
    buffer_load_dwordx4 v32, s[16:19], s50 offen offset:0 lds
    s_waitcnt lgkmcnt(15)
    v_mfma_f32_16x16x32_bf16 v[192:195], a[208:211], a[44:47], v[192:195]
    ds_read_b64_tr_b16 a[192:193], v12 offset:128
    ds_read_b64_tr_b16 a[194:195], v12 offset:3200
    v_mfma_f32_16x16x32_bf16 v[196:199], a[208:211], a[116:119], v[196:199]
    v_rcp_f32 v45, v45
    v_mfma_f32_16x16x32_bf16 v[240:243], a[212:215], a[44:47], v[240:243]
    ds_read_b64_tr_b16 a[196:197], v12 offset:18560
    ds_read_b64_tr_b16 a[198:199], v12 offset:21632
    v_mfma_f32_16x16x32_bf16 v[244:247], a[212:215], a[116:119], v[244:247]
    buffer_load_dwordx4 v33, s[16:19], s50 offen offset:1024 lds
    v_mfma_f32_16x16x32_bf16 v[200:203], a[216:219], a[44:47], v[200:203]
    ds_read_b64_tr_b16 a[200:201], v13 offset:128
    ds_read_b64_tr_b16 a[202:203], v13 offset:3200
    v_mfma_f32_16x16x32_bf16 v[204:207], a[216:219], a[116:119], v[204:207]
    v_rcp_f32 v46, v46
    v_mfma_f32_16x16x32_bf16 v[248:251], a[220:223], a[44:47], v[248:251]
    ds_read_b64_tr_b16 a[204:205], v13 offset:18560
    ds_read_b64_tr_b16 a[206:207], v13 offset:21632
    v_mfma_f32_16x16x32_bf16 v[252:255], a[220:223], a[116:119], v[252:255]
    buffer_load_dwordx4 v34, s[16:19], s50 offen offset:2048 lds
    s_add_u32 m0, s47, 6144
    s_waitcnt lgkmcnt(15)
    v_mfma_f32_16x16x32_bf16 v[160:163], a[224:227], a[48:51], v[160:163]
    ds_read_b64_tr_b16 a[208:209], v12 offset:6144
    v_mul_f32 v83, v83, v43
    v_mfma_f32_16x16x32_bf16 v[164:167], a[224:227], a[120:123], v[164:167]
    s_mov_b32 s50, 295296
    ds_read_b64_tr_b16 a[210:211], v12 offset:9216
    v_mfma_f32_16x16x32_bf16 v[208:211], a[228:231], a[48:51], v[208:211]
    ds_read_b64_tr_b16 a[212:213], v12 offset:24576
    ds_read_b64_tr_b16 a[214:215], v12 offset:27648
    v_mfma_f32_16x16x32_bf16 v[212:215], a[228:231], a[120:123], v[212:215]
    buffer_load_dwordx4 v32, s[16:19], s50 offen offset:0 lds
    v_mfma_f32_16x16x32_bf16 v[168:171], a[232:235], a[48:51], v[168:171]
    ds_read_b64_tr_b16 a[216:217], v13 offset:6144
    ds_read_b64_tr_b16 a[218:219], v13 offset:9216
    v_mfma_f32_16x16x32_bf16 v[172:175], a[232:235], a[120:123], v[172:175]
    v_rcp_f32 v47, v47
    v_mfma_f32_16x16x32_bf16 v[216:219], a[236:239], a[48:51], v[216:219]
    ds_read_b64_tr_b16 a[220:221], v13 offset:24576
    ds_read_b64_tr_b16 a[222:223], v13 offset:27648
    v_mfma_f32_16x16x32_bf16 v[220:223], a[236:239], a[120:123], v[220:223]
    buffer_load_dwordx4 v33, s[16:19], s50 offen offset:1024 lds
    s_waitcnt lgkmcnt(15)
    v_mfma_f32_16x16x32_bf16 v[176:179], a[240:243], a[48:51], v[176:179]
    ds_read_b64_tr_b16 a[224:225], v12 offset:6208
    v_mul_f32 v88, v88, v44
    v_mfma_f32_16x16x32_bf16 v[180:183], a[240:243], a[120:123], v[180:183]
    ds_read_b64_tr_b16 a[226:227], v12 offset:9280
    v_mul_f32 v89, v89, v45
    v_mfma_f32_16x16x32_bf16 v[224:227], a[244:247], a[48:51], v[224:227]
    ds_read_b64_tr_b16 a[228:229], v12 offset:24640
    ds_read_b64_tr_b16 a[230:231], v12 offset:27712
    v_mfma_f32_16x16x32_bf16 v[228:231], a[244:247], a[120:123], v[228:231]
    buffer_load_dwordx4 v34, s[16:19], s50 offen offset:2048 lds
    v_mfma_f32_16x16x32_bf16 v[184:187], a[248:251], a[48:51], v[184:187]
    ds_read_b64_tr_b16 a[232:233], v13 offset:6208
    v_mul_f32 v90, v90, v46
    v_mfma_f32_16x16x32_bf16 v[188:191], a[248:251], a[120:123], v[188:191]
    ds_read_b64_tr_b16 a[234:235], v13 offset:9280
    v_mul_f32 v91, v91, v47
    v_mfma_f32_16x16x32_bf16 v[232:235], a[252:255], a[48:51], v[232:235]
    ds_read_b64_tr_b16 a[236:237], v13 offset:24640
    v_cvt_pk_bf16_f32 v56, v80, v81
    v_mfma_f32_16x16x32_bf16 v[236:239], a[252:255], a[120:123], v[236:239]
    ds_read_b64_tr_b16 a[238:239], v13 offset:27712
    s_waitcnt lgkmcnt(15)
    v_mfma_f32_16x16x32_bf16 v[192:195], a[192:195], a[48:51], v[192:195]
    ds_read_b64_tr_b16 a[240:241], v12 offset:6272
    v_cvt_pk_bf16_f32 v57, v82, v83
    v_mfma_f32_16x16x32_bf16 v[196:199], a[192:195], a[120:123], v[196:199]
    ds_read_b64_tr_b16 a[242:243], v12 offset:9344
    v_cvt_pk_bf16_f32 v58, v88, v89
    v_mfma_f32_16x16x32_bf16 v[240:243], a[196:199], a[48:51], v[240:243]
    ds_read_b64_tr_b16 a[244:245], v12 offset:24704
    v_cvt_pk_bf16_f32 v59, v90, v91
    v_mfma_f32_16x16x32_bf16 v[244:247], a[196:199], a[120:123], v[244:247]
    ds_read_b64_tr_b16 a[246:247], v12 offset:27776
    v_accvgpr_write_b32 a152, v56
    v_mfma_f32_16x16x32_bf16 v[200:203], a[200:203], a[48:51], v[200:203]
    ds_read_b64_tr_b16 a[248:249], v13 offset:6272
    v_accvgpr_write_b32 a153, v57
    v_mfma_f32_16x16x32_bf16 v[204:207], a[200:203], a[120:123], v[204:207]
    ds_read_b64_tr_b16 a[250:251], v13 offset:9344
    v_accvgpr_write_b32 a154, v58
    v_mfma_f32_16x16x32_bf16 v[248:251], a[204:207], a[48:51], v[248:251]
    ds_read_b64_tr_b16 a[252:253], v13 offset:24704
    v_accvgpr_write_b32 a155, v59
    v_mfma_f32_16x16x32_bf16 v[252:255], a[204:207], a[120:123], v[252:255]
    ds_read_b64_tr_b16 a[254:255], v13 offset:27776
    s_waitcnt lgkmcnt(15)
    v_mfma_f32_16x16x32_bf16 v[160:163], a[208:211], a[52:55], v[160:163]
    ds_read_b64_tr_b16 a[192:193], v12 offset:12288
    ds_read_b64_tr_b16 a[194:195], v12 offset:15360
    v_mfma_f32_16x16x32_bf16 v[164:167], a[208:211], a[124:127], v[164:167]
    v_exp_f32 v48, v84
    v_mfma_f32_16x16x32_bf16 v[208:211], a[212:215], a[52:55], v[208:211]
    ds_read_b64_tr_b16 a[196:197], v12 offset:30720
    v_mul_f32 v84, v84, v132
    v_mfma_f32_16x16x32_bf16 v[212:215], a[212:215], a[124:127], v[212:215]
    ds_read_b64_tr_b16 a[198:199], v12 offset:33792
    v_add_f32 v48, 1.0, v48
    v_mfma_f32_16x16x32_bf16 v[168:171], a[216:219], a[52:55], v[168:171]
    ds_read_b64_tr_b16 a[200:201], v13 offset:12288
    ds_read_b64_tr_b16 a[202:203], v13 offset:15360
    v_mfma_f32_16x16x32_bf16 v[172:175], a[216:219], a[124:127], v[172:175]
    v_exp_f32 v49, v85
    v_mfma_f32_16x16x32_bf16 v[216:219], a[220:223], a[52:55], v[216:219]
    ds_read_b64_tr_b16 a[204:205], v13 offset:30720
    v_mul_f32 v85, v85, v133
    v_mfma_f32_16x16x32_bf16 v[220:223], a[220:223], a[124:127], v[220:223]
    ds_read_b64_tr_b16 a[206:207], v13 offset:33792
    s_waitcnt lgkmcnt(15)
    v_mfma_f32_16x16x32_bf16 v[176:179], a[224:227], a[52:55], v[176:179]
    ds_read_b64_tr_b16 a[208:209], v12 offset:12352
    ds_read_b64_tr_b16 a[210:211], v12 offset:15424
    v_mfma_f32_16x16x32_bf16 v[180:183], a[224:227], a[124:127], v[180:183]
    v_exp_f32 v50, v86
    v_mfma_f32_16x16x32_bf16 v[224:227], a[228:231], a[52:55], v[224:227]
    ds_read_b64_tr_b16 a[212:213], v12 offset:30784
    v_mul_f32 v86, v86, v134
    v_mfma_f32_16x16x32_bf16 v[228:231], a[228:231], a[124:127], v[228:231]
    ds_read_b64_tr_b16 a[214:215], v12 offset:33856
    v_add_f32 v49, 1.0, v49
    v_mfma_f32_16x16x32_bf16 v[184:187], a[232:235], a[52:55], v[184:187]
    ds_read_b64_tr_b16 a[216:217], v13 offset:12352
    ds_read_b64_tr_b16 a[218:219], v13 offset:15424
    v_mfma_f32_16x16x32_bf16 v[188:191], a[232:235], a[124:127], v[188:191]
    v_exp_f32 v51, v87
    v_mfma_f32_16x16x32_bf16 v[232:235], a[236:239], a[52:55], v[232:235]
    ds_read_b64_tr_b16 a[220:221], v13 offset:30784
    v_mul_f32 v87, v87, v135
    v_mfma_f32_16x16x32_bf16 v[236:239], a[236:239], a[124:127], v[236:239]
    ds_read_b64_tr_b16 a[222:223], v13 offset:33856
    s_waitcnt lgkmcnt(15)
    v_mfma_f32_16x16x32_bf16 v[192:195], a[240:243], a[52:55], v[192:195]
    ds_read_b64_tr_b16 a[224:225], v12 offset:12416
    ds_read_b64_tr_b16 a[226:227], v12 offset:15488
    v_mfma_f32_16x16x32_bf16 v[196:199], a[240:243], a[124:127], v[196:199]
    v_exp_f32 v52, v92
    v_mfma_f32_16x16x32_bf16 v[240:243], a[244:247], a[52:55], v[240:243]
    ds_read_b64_tr_b16 a[228:229], v12 offset:30848
    v_mul_f32 v92, v92, v140
    v_mfma_f32_16x16x32_bf16 v[244:247], a[244:247], a[124:127], v[244:247]
    ds_read_b64_tr_b16 a[230:231], v12 offset:33920
    v_add_f32 v50, 1.0, v50
    v_mfma_f32_16x16x32_bf16 v[200:203], a[248:251], a[52:55], v[200:203]
    ds_read_b64_tr_b16 a[232:233], v13 offset:12416
    ds_read_b64_tr_b16 a[234:235], v13 offset:15488
    v_mfma_f32_16x16x32_bf16 v[204:207], a[248:251], a[124:127], v[204:207]
    v_exp_f32 v53, v93
    v_mfma_f32_16x16x32_bf16 v[248:251], a[252:255], a[52:55], v[248:251]
    ds_read_b64_tr_b16 a[236:237], v13 offset:30848
    v_mul_f32 v93, v93, v141
    v_mfma_f32_16x16x32_bf16 v[252:255], a[252:255], a[124:127], v[252:255]
    s_add_u32 m0, s47, 36864
    ds_read_b64_tr_b16 a[238:239], v13 offset:33920
    s_waitcnt vmcnt(9)
    s_barrier
    s_waitcnt lgkmcnt(15)
    v_mfma_f32_16x16x32_bf16 v[160:163], a[192:195], a[56:59], v[160:163]
    ds_read_b64_tr_b16 a[240:241], v14 offset:0
    v_add_f32 v51, 1.0, v51
    v_mfma_f32_16x16x32_bf16 v[164:167], a[192:195], a[128:131], v[164:167]
    s_mov_b32 s50, 885120
    ds_read_b64_tr_b16 a[242:243], v14 offset:3072
    v_mfma_f32_16x16x32_bf16 v[208:211], a[196:199], a[56:59], v[208:211]
    ds_read_b64_tr_b16 a[244:245], v14 offset:18432
    ds_read_b64_tr_b16 a[246:247], v14 offset:21504
    v_mfma_f32_16x16x32_bf16 v[212:215], a[196:199], a[128:131], v[212:215]
    buffer_load_dwordx4 v32, s[16:19], s50 offen offset:0 lds
    v_mfma_f32_16x16x32_bf16 v[168:171], a[200:203], a[56:59], v[168:171]
    ds_read_b64_tr_b16 a[248:249], v15 offset:0
    ds_read_b64_tr_b16 a[250:251], v15 offset:3072
    v_mfma_f32_16x16x32_bf16 v[172:175], a[200:203], a[128:131], v[172:175]
    v_exp_f32 v54, v94
    v_mfma_f32_16x16x32_bf16 v[216:219], a[204:207], a[56:59], v[216:219]
    ds_read_b64_tr_b16 a[252:253], v15 offset:18432
    ds_read_b64_tr_b16 a[254:255], v15 offset:21504
    v_mfma_f32_16x16x32_bf16 v[220:223], a[204:207], a[128:131], v[220:223]
    buffer_load_dwordx4 v33, s[16:19], s50 offen offset:1024 lds
    s_waitcnt lgkmcnt(15)
    v_mfma_f32_16x16x32_bf16 v[176:179], a[208:211], a[56:59], v[176:179]
    ds_read_b64_tr_b16 a[192:193], v14 offset:64
    v_mul_f32 v94, v94, v142
    v_mfma_f32_16x16x32_bf16 v[180:183], a[208:211], a[128:131], v[180:183]
    ds_read_b64_tr_b16 a[194:195], v14 offset:3136
    v_add_f32 v52, 1.0, v52
    v_mfma_f32_16x16x32_bf16 v[224:227], a[212:215], a[56:59], v[224:227]
    ds_read_b64_tr_b16 a[196:197], v14 offset:18496
    ds_read_b64_tr_b16 a[198:199], v14 offset:21568
    v_mfma_f32_16x16x32_bf16 v[228:231], a[212:215], a[128:131], v[228:231]
    buffer_load_dwordx4 v34, s[16:19], s50 offen offset:2048 lds
    s_add_u32 m0, s47, 39936
    v_mfma_f32_16x16x32_bf16 v[184:187], a[216:219], a[56:59], v[184:187]
    ds_read_b64_tr_b16 a[200:201], v15 offset:64
    v_add_f32 v53, 1.0, v53
    v_mfma_f32_16x16x32_bf16 v[188:191], a[216:219], a[128:131], v[188:191]
    s_mov_b32 s50, 1032576
    ds_read_b64_tr_b16 a[202:203], v15 offset:3136
    v_mfma_f32_16x16x32_bf16 v[232:235], a[220:223], a[56:59], v[232:235]
    ds_read_b64_tr_b16 a[204:205], v15 offset:18496
    ds_read_b64_tr_b16 a[206:207], v15 offset:21568
    v_mfma_f32_16x16x32_bf16 v[236:239], a[220:223], a[128:131], v[236:239]
    buffer_load_dwordx4 v32, s[16:19], s50 offen offset:0 lds
    s_waitcnt lgkmcnt(15)
    v_mfma_f32_16x16x32_bf16 v[192:195], a[224:227], a[56:59], v[192:195]
    ds_read_b64_tr_b16 a[208:209], v14 offset:128
    ds_read_b64_tr_b16 a[210:211], v14 offset:3200
    v_mfma_f32_16x16x32_bf16 v[196:199], a[224:227], a[128:131], v[196:199]
    v_exp_f32 v55, v95
    v_mfma_f32_16x16x32_bf16 v[240:243], a[228:231], a[56:59], v[240:243]
    ds_read_b64_tr_b16 a[212:213], v14 offset:18560
    ds_read_b64_tr_b16 a[214:215], v14 offset:21632
    v_mfma_f32_16x16x32_bf16 v[244:247], a[228:231], a[128:131], v[244:247]
    buffer_load_dwordx4 v33, s[16:19], s50 offen offset:1024 lds
    v_mfma_f32_16x16x32_bf16 v[200:203], a[232:235], a[56:59], v[200:203]
    ds_read_b64_tr_b16 a[216:217], v15 offset:128
    v_mul_f32 v95, v95, v143
    v_mfma_f32_16x16x32_bf16 v[204:207], a[232:235], a[128:131], v[204:207]
    ds_read_b64_tr_b16 a[218:219], v15 offset:3200
    v_add_f32 v54, 1.0, v54
    v_mfma_f32_16x16x32_bf16 v[248:251], a[236:239], a[56:59], v[248:251]
    ds_read_b64_tr_b16 a[220:221], v15 offset:18560
    ds_read_b64_tr_b16 a[222:223], v15 offset:21632
    v_mfma_f32_16x16x32_bf16 v[252:255], a[236:239], a[128:131], v[252:255]
    buffer_load_dwordx4 v34, s[16:19], s50 offen offset:2048 lds
    s_add_u32 m0, s47, 43008
    s_waitcnt lgkmcnt(15)
    v_mfma_f32_16x16x32_bf16 v[160:163], a[240:243], a[60:63], v[160:163]
    ds_read_b64_tr_b16 a[224:225], v14 offset:6144
    v_add_f32 v55, 1.0, v55
    v_mfma_f32_16x16x32_bf16 v[164:167], a[240:243], a[132:135], v[164:167]
    s_mov_b32 s50, 1180032
    ds_read_b64_tr_b16 a[226:227], v14 offset:9216
    v_mfma_f32_16x16x32_bf16 v[208:211], a[244:247], a[60:63], v[208:211]
    ds_read_b64_tr_b16 a[228:229], v14 offset:24576
    ds_read_b64_tr_b16 a[230:231], v14 offset:27648
    v_mfma_f32_16x16x32_bf16 v[212:215], a[244:247], a[132:135], v[212:215]
    buffer_load_dwordx4 v32, s[16:19], s50 offen offset:0 lds
    v_mfma_f32_16x16x32_bf16 v[168:171], a[248:251], a[60:63], v[168:171]
    ds_read_b64_tr_b16 a[232:233], v15 offset:6144
    ds_read_b64_tr_b16 a[234:235], v15 offset:9216
    v_mfma_f32_16x16x32_bf16 v[172:175], a[248:251], a[132:135], v[172:175]
    v_rcp_f32 v48, v48
    v_mfma_f32_16x16x32_bf16 v[216:219], a[252:255], a[60:63], v[216:219]
    ds_read_b64_tr_b16 a[236:237], v15 offset:24576
    ds_read_b64_tr_b16 a[238:239], v15 offset:27648
    v_mfma_f32_16x16x32_bf16 v[220:223], a[252:255], a[132:135], v[220:223]
    buffer_load_dwordx4 v33, s[16:19], s50 offen offset:1024 lds
    s_waitcnt lgkmcnt(15)
    v_mfma_f32_16x16x32_bf16 v[176:179], a[192:195], a[60:63], v[176:179]
    ds_read_b64_tr_b16 a[240:241], v14 offset:6208
    ds_read_b64_tr_b16 a[242:243], v14 offset:9280
    v_mfma_f32_16x16x32_bf16 v[180:183], a[192:195], a[132:135], v[180:183]
    v_rcp_f32 v49, v49
    v_mfma_f32_16x16x32_bf16 v[224:227], a[196:199], a[60:63], v[224:227]
    ds_read_b64_tr_b16 a[244:245], v14 offset:24640
    ds_read_b64_tr_b16 a[246:247], v14 offset:27712
    v_mfma_f32_16x16x32_bf16 v[228:231], a[196:199], a[132:135], v[228:231]
    buffer_load_dwordx4 v34, s[16:19], s50 offen offset:2048 lds
    v_mfma_f32_16x16x32_bf16 v[184:187], a[200:203], a[60:63], v[184:187]
    ds_read_b64_tr_b16 a[248:249], v15 offset:6208
    ds_read_b64_tr_b16 a[250:251], v15 offset:9280
    v_mfma_f32_16x16x32_bf16 v[188:191], a[200:203], a[132:135], v[188:191]
    v_rcp_f32 v50, v50
    v_mfma_f32_16x16x32_bf16 v[232:235], a[204:207], a[60:63], v[232:235]
    ds_read_b64_tr_b16 a[252:253], v15 offset:24640
    ds_read_b64_tr_b16 a[254:255], v15 offset:27712
    v_mfma_f32_16x16x32_bf16 v[236:239], a[204:207], a[132:135], v[236:239]
    v_mul_f32 v84, v84, v48
    s_waitcnt lgkmcnt(15)
    v_mfma_f32_16x16x32_bf16 v[192:195], a[208:211], a[60:63], v[192:195]
    ds_read_b64_tr_b16 a[192:193], v14 offset:6272
    ds_read_b64_tr_b16 a[194:195], v14 offset:9344
    v_mfma_f32_16x16x32_bf16 v[196:199], a[208:211], a[132:135], v[196:199]
    v_rcp_f32 v51, v51
    v_mfma_f32_16x16x32_bf16 v[240:243], a[212:215], a[60:63], v[240:243]
    ds_read_b64_tr_b16 a[196:197], v14 offset:24704
    ds_read_b64_tr_b16 a[198:199], v14 offset:27776
    v_mfma_f32_16x16x32_bf16 v[244:247], a[212:215], a[132:135], v[244:247]
    v_rcp_f32 v52, v52
    v_mfma_f32_16x16x32_bf16 v[200:203], a[216:219], a[60:63], v[200:203]
    ds_read_b64_tr_b16 a[200:201], v15 offset:6272
    ds_read_b64_tr_b16 a[202:203], v15 offset:9344
    v_mfma_f32_16x16x32_bf16 v[204:207], a[216:219], a[132:135], v[204:207]
    v_rcp_f32 v53, v53
    v_mfma_f32_16x16x32_bf16 v[248:251], a[220:223], a[60:63], v[248:251]
    ds_read_b64_tr_b16 a[204:205], v15 offset:24704
    ds_read_b64_tr_b16 a[206:207], v15 offset:27776
    v_mfma_f32_16x16x32_bf16 v[252:255], a[220:223], a[132:135], v[252:255]
    v_mul_f32 v85, v85, v49
    s_waitcnt lgkmcnt(15)
    v_mfma_f32_16x16x32_bf16 v[160:163], a[224:227], a[64:67], v[160:163]
    ds_read_b64_tr_b16 a[208:209], v14 offset:12288
    ds_read_b64_tr_b16 a[210:211], v14 offset:15360
    v_mfma_f32_16x16x32_bf16 v[164:167], a[224:227], a[136:139], v[164:167]
    v_rcp_f32 v54, v54
    v_mfma_f32_16x16x32_bf16 v[208:211], a[228:231], a[64:67], v[208:211]
    ds_read_b64_tr_b16 a[212:213], v14 offset:30720
    ds_read_b64_tr_b16 a[214:215], v14 offset:33792
    v_mfma_f32_16x16x32_bf16 v[212:215], a[228:231], a[136:139], v[212:215]
    v_rcp_f32 v55, v55
    v_mfma_f32_16x16x32_bf16 v[168:171], a[232:235], a[64:67], v[168:171]
    ds_read_b64_tr_b16 a[216:217], v15 offset:12288
    v_mul_f32 v86, v86, v50
    v_mfma_f32_16x16x32_bf16 v[172:175], a[232:235], a[136:139], v[172:175]
    ds_read_b64_tr_b16 a[218:219], v15 offset:15360
    v_mul_f32 v87, v87, v51
    v_mfma_f32_16x16x32_bf16 v[216:219], a[236:239], a[64:67], v[216:219]
    ds_read_b64_tr_b16 a[220:221], v15 offset:30720
    v_mul_f32 v92, v92, v52
    v_mfma_f32_16x16x32_bf16 v[220:223], a[236:239], a[136:139], v[220:223]
    ds_read_b64_tr_b16 a[222:223], v15 offset:33792
    s_waitcnt lgkmcnt(15)
    v_mfma_f32_16x16x32_bf16 v[176:179], a[240:243], a[64:67], v[176:179]
    ds_read_b64_tr_b16 a[224:225], v14 offset:12352
    v_mul_f32 v93, v93, v53
    v_mfma_f32_16x16x32_bf16 v[180:183], a[240:243], a[136:139], v[180:183]
    ds_read_b64_tr_b16 a[226:227], v14 offset:15424
    v_mul_f32 v94, v94, v54
    v_mfma_f32_16x16x32_bf16 v[224:227], a[244:247], a[64:67], v[224:227]
    ds_read_b64_tr_b16 a[228:229], v14 offset:30784
    v_mul_f32 v95, v95, v55
    v_mfma_f32_16x16x32_bf16 v[228:231], a[244:247], a[136:139], v[228:231]
    ds_read_b64_tr_b16 a[230:231], v14 offset:33856
    v_cvt_pk_bf16_f32 v56, v84, v85
    v_mfma_f32_16x16x32_bf16 v[184:187], a[248:251], a[64:67], v[184:187]
    ds_read_b64_tr_b16 a[232:233], v15 offset:12352
    v_cvt_pk_bf16_f32 v57, v86, v87
    v_mfma_f32_16x16x32_bf16 v[188:191], a[248:251], a[136:139], v[188:191]
    ds_read_b64_tr_b16 a[234:235], v15 offset:15424
    v_cvt_pk_bf16_f32 v58, v92, v93
    v_mfma_f32_16x16x32_bf16 v[232:235], a[252:255], a[64:67], v[232:235]
    ds_read_b64_tr_b16 a[236:237], v15 offset:30784
    v_cvt_pk_bf16_f32 v59, v94, v95
    v_accvgpr_write_b32 a156, v56
    v_accvgpr_write_b32 a157, v57
    v_accvgpr_write_b32 a158, v58
    v_accvgpr_write_b32 a159, v59
    v_exp_f32 v40, v96
    v_mul_f32 v96, v96, v144
    v_exp_f32 v41, v97
    v_mul_f32 v97, v97, v145
    v_exp_f32 v42, v98
    v_mul_f32 v98, v98, v146
    v_exp_f32 v43, v99
    v_mul_f32 v99, v99, v147
    v_exp_f32 v44, v104
    v_mul_f32 v104, v104, v152
    v_exp_f32 v45, v105
    v_mul_f32 v105, v105, v153
    v_exp_f32 v46, v106
    v_mul_f32 v106, v106, v154
    v_exp_f32 v47, v107
    v_mul_f32 v107, v107, v155
    v_add_f32 v40, 1.0, v40
    v_add_f32 v41, 1.0, v41
    v_add_f32 v42, 1.0, v42
    v_add_f32 v43, 1.0, v43
    v_add_f32 v44, 1.0, v44
    v_add_f32 v45, 1.0, v45
    v_add_f32 v46, 1.0, v46
    v_add_f32 v47, 1.0, v47
    v_rcp_f32 v40, v40
    v_rcp_f32 v41, v41
    v_rcp_f32 v42, v42
    v_rcp_f32 v43, v43
    v_rcp_f32 v44, v44
    v_rcp_f32 v45, v45
    v_rcp_f32 v46, v46
    v_rcp_f32 v47, v47
    v_mul_f32 v96, v96, v40
    v_mul_f32 v97, v97, v41
    v_mul_f32 v98, v98, v42
    v_mul_f32 v99, v99, v43
    v_mul_f32 v104, v104, v44
    v_mul_f32 v105, v105, v45
    v_mul_f32 v106, v106, v46
    v_mul_f32 v107, v107, v47
    v_cvt_pk_bf16_f32 v56, v96, v97
    v_cvt_pk_bf16_f32 v57, v98, v99
    v_cvt_pk_bf16_f32 v58, v104, v105
    v_cvt_pk_bf16_f32 v59, v106, v107
    v_accvgpr_write_b32 a160, v56
    v_accvgpr_write_b32 a161, v57
    v_accvgpr_write_b32 a162, v58
    v_accvgpr_write_b32 a163, v59
    v_exp_f32 v48, v100
    v_mul_f32 v100, v100, v148
    v_exp_f32 v49, v101
    v_mul_f32 v101, v101, v149
    v_exp_f32 v50, v102
    v_mul_f32 v102, v102, v150
    v_exp_f32 v51, v103
    v_mul_f32 v103, v103, v151
    v_exp_f32 v52, v108
    v_mul_f32 v108, v108, v156
    v_exp_f32 v53, v109
    v_mul_f32 v109, v109, v157
    v_exp_f32 v54, v110
    v_mul_f32 v110, v110, v158
    v_exp_f32 v55, v111
    v_mul_f32 v111, v111, v159
    v_add_f32 v48, 1.0, v48
    v_add_f32 v49, 1.0, v49
    v_add_f32 v50, 1.0, v50
    v_add_f32 v51, 1.0, v51
    v_add_f32 v52, 1.0, v52
    v_add_f32 v53, 1.0, v53
    v_add_f32 v54, 1.0, v54
    v_add_f32 v55, 1.0, v55
    v_rcp_f32 v48, v48
    v_rcp_f32 v49, v49
    v_rcp_f32 v50, v50
    v_rcp_f32 v51, v51
    v_rcp_f32 v52, v52
    v_rcp_f32 v53, v53
    v_rcp_f32 v54, v54
    v_rcp_f32 v55, v55
    v_mul_f32 v100, v100, v48
    v_mul_f32 v101, v101, v49
    v_mul_f32 v102, v102, v50
    v_mul_f32 v103, v103, v51
    v_mul_f32 v108, v108, v52
    v_mul_f32 v109, v109, v53
    v_mul_f32 v110, v110, v54
    v_mul_f32 v111, v111, v55
    v_cvt_pk_bf16_f32 v56, v100, v101
    v_cvt_pk_bf16_f32 v57, v102, v103
    v_cvt_pk_bf16_f32 v58, v108, v109
    v_cvt_pk_bf16_f32 v59, v110, v111
    v_accvgpr_write_b32 a164, v56
    v_accvgpr_write_b32 a165, v57
    v_accvgpr_write_b32 a166, v58
    v_accvgpr_write_b32 a167, v59
    v_mfma_f32_16x16x32_bf16 v[236:239], a[252:255], a[136:139], v[236:239]
    ds_read_b64_tr_b16 a[238:239], v15 offset:33856
    s_waitcnt lgkmcnt(15)
    v_mfma_f32_16x16x32_bf16 v[192:195], a[192:195], a[64:67], v[192:195]
    ds_read_b64_tr_b16 a[240:241], v14 offset:12416
    v_mfma_f32_16x16x32_bf16 v[196:199], a[192:195], a[136:139], v[196:199]
    ds_read_b64_tr_b16 a[242:243], v14 offset:15488
    v_mfma_f32_16x16x32_bf16 v[240:243], a[196:199], a[64:67], v[240:243]
    ds_read_b64_tr_b16 a[244:245], v14 offset:30848
    v_mfma_f32_16x16x32_bf16 v[244:247], a[196:199], a[136:139], v[244:247]
    ds_read_b64_tr_b16 a[246:247], v14 offset:33920
    v_mfma_f32_16x16x32_bf16 v[200:203], a[200:203], a[64:67], v[200:203]
    ds_read_b64_tr_b16 a[248:249], v15 offset:12416
    v_mfma_f32_16x16x32_bf16 v[204:207], a[200:203], a[136:139], v[204:207]
    ds_read_b64_tr_b16 a[250:251], v15 offset:15488
    v_mfma_f32_16x16x32_bf16 v[248:251], a[204:207], a[64:67], v[248:251]
    ds_read_b64_tr_b16 a[252:253], v15 offset:30848
    v_mfma_f32_16x16x32_bf16 v[252:255], a[204:207], a[136:139], v[252:255]
    s_add_u32 m0, s47, 73728
    ds_read_b64_tr_b16 a[254:255], v15 offset:33920
    s_waitcnt vmcnt(9)
    s_barrier
    s_waitcnt lgkmcnt(15)
    v_mfma_f32_16x16x32_bf16 v[160:163], a[208:211], a[68:71], v[160:163]
    ds_read_b64_tr_b16 a[192:193], v8 offset:0
    v_mfma_f32_16x16x32_bf16 v[164:167], a[208:211], a[140:143], v[164:167]
    s_mov_b32 s50, 1769856
    ds_read_b64_tr_b16 a[194:195], v8 offset:3072
    v_mfma_f32_16x16x32_bf16 v[208:211], a[212:215], a[68:71], v[208:211]
    ds_read_b64_tr_b16 a[196:197], v8 offset:18432
    ds_read_b64_tr_b16 a[198:199], v8 offset:21504
    v_mfma_f32_16x16x32_bf16 v[212:215], a[212:215], a[140:143], v[212:215]
    buffer_load_dwordx4 v32, s[16:19], s50 offen offset:0 lds
    v_mfma_f32_16x16x32_bf16 v[168:171], a[216:219], a[68:71], v[168:171]
    ds_read_b64_tr_b16 a[200:201], v9 offset:0
    v_mfma_f32_16x16x32_bf16 v[172:175], a[216:219], a[140:143], v[172:175]
    ds_read_b64_tr_b16 a[202:203], v9 offset:3072
    v_mfma_f32_16x16x32_bf16 v[216:219], a[220:223], a[68:71], v[216:219]
    ds_read_b64_tr_b16 a[204:205], v9 offset:18432
    ds_read_b64_tr_b16 a[206:207], v9 offset:21504
    v_mfma_f32_16x16x32_bf16 v[220:223], a[220:223], a[140:143], v[220:223]
    buffer_load_dwordx4 v33, s[16:19], s50 offen offset:1024 lds
    s_waitcnt lgkmcnt(15)
    v_mfma_f32_16x16x32_bf16 v[176:179], a[224:227], a[68:71], v[176:179]
    ds_read_b64_tr_b16 a[208:209], v8 offset:64
    v_mfma_f32_16x16x32_bf16 v[180:183], a[224:227], a[140:143], v[180:183]
    ds_read_b64_tr_b16 a[210:211], v8 offset:3136
    v_mfma_f32_16x16x32_bf16 v[224:227], a[228:231], a[68:71], v[224:227]
    ds_read_b64_tr_b16 a[212:213], v8 offset:18496
    ds_read_b64_tr_b16 a[214:215], v8 offset:21568
    v_mfma_f32_16x16x32_bf16 v[228:231], a[228:231], a[140:143], v[228:231]
    buffer_load_dwordx4 v34, s[16:19], s50 offen offset:2048 lds
    s_add_u32 m0, s47, 76800
    v_mfma_f32_16x16x32_bf16 v[184:187], a[232:235], a[68:71], v[184:187]
    ds_read_b64_tr_b16 a[216:217], v9 offset:64
    v_mfma_f32_16x16x32_bf16 v[188:191], a[232:235], a[140:143], v[188:191]
    s_mov_b32 s50, 1917312
    ds_read_b64_tr_b16 a[218:219], v9 offset:3136
    v_mfma_f32_16x16x32_bf16 v[232:235], a[236:239], a[68:71], v[232:235]
    ds_read_b64_tr_b16 a[220:221], v9 offset:18496
    ds_read_b64_tr_b16 a[222:223], v9 offset:21568
    v_mfma_f32_16x16x32_bf16 v[236:239], a[236:239], a[140:143], v[236:239]
    buffer_load_dwordx4 v32, s[16:19], s50 offen offset:0 lds
    s_waitcnt lgkmcnt(15)
    v_mfma_f32_16x16x32_bf16 v[192:195], a[240:243], a[68:71], v[192:195]
    ds_read_b64_tr_b16 a[224:225], v8 offset:128
    v_mfma_f32_16x16x32_bf16 v[196:199], a[240:243], a[140:143], v[196:199]
    ds_read_b64_tr_b16 a[226:227], v8 offset:3200
    v_mfma_f32_16x16x32_bf16 v[240:243], a[244:247], a[68:71], v[240:243]
    ds_read_b64_tr_b16 a[228:229], v8 offset:18560
    ds_read_b64_tr_b16 a[230:231], v8 offset:21632
    v_mfma_f32_16x16x32_bf16 v[244:247], a[244:247], a[140:143], v[244:247]
    buffer_load_dwordx4 v33, s[16:19], s50 offen offset:1024 lds
    v_mfma_f32_16x16x32_bf16 v[200:203], a[248:251], a[68:71], v[200:203]
    ds_read_b64_tr_b16 a[232:233], v9 offset:128
    v_mfma_f32_16x16x32_bf16 v[204:207], a[248:251], a[140:143], v[204:207]
    ds_read_b64_tr_b16 a[234:235], v9 offset:3200
    v_mfma_f32_16x16x32_bf16 v[248:251], a[252:255], a[68:71], v[248:251]
    ds_read_b64_tr_b16 a[236:237], v9 offset:18560
    ds_read_b64_tr_b16 a[238:239], v9 offset:21632
    v_mfma_f32_16x16x32_bf16 v[252:255], a[252:255], a[140:143], v[252:255]
    buffer_load_dwordx4 v34, s[16:19], s50 offen offset:2048 lds
    s_add_u32 m0, s47, 79872
    s_waitcnt lgkmcnt(15)
    v_mfma_f32_16x16x32_bf16 v[64:67], a[192:195], a[0:3], 0
    ds_read_b64_tr_b16 a[240:241], v8 offset:6144
    v_mfma_f32_16x16x32_bf16 v[68:71], a[192:195], a[72:75], 0
    s_mov_b32 s50, 2064768
    ds_read_b64_tr_b16 a[242:243], v8 offset:9216
    v_mfma_f32_16x16x32_bf16 v[112:115], a[196:199], a[0:3], 0
    ds_read_b64_tr_b16 a[244:245], v8 offset:24576
    ds_read_b64_tr_b16 a[246:247], v8 offset:27648
    v_mfma_f32_16x16x32_bf16 v[116:119], a[196:199], a[72:75], 0
    buffer_load_dwordx4 v32, s[16:19], s50 offen offset:0 lds
    v_mfma_f32_16x16x32_bf16 v[72:75], a[200:203], a[0:3], 0
    ds_read_b64_tr_b16 a[248:249], v9 offset:6144
    ds_read_b64_tr_b16 a[250:251], v9 offset:9216
    v_mfma_f32_16x16x32_bf16 v[76:79], a[200:203], a[72:75], 0
    v_exp_f32 v40, v160
    v_mfma_f32_16x16x32_bf16 v[120:123], a[204:207], a[0:3], 0
    ds_read_b64_tr_b16 a[252:253], v9 offset:24576
    ds_read_b64_tr_b16 a[254:255], v9 offset:27648
    v_mfma_f32_16x16x32_bf16 v[124:127], a[204:207], a[72:75], 0
    buffer_load_dwordx4 v33, s[16:19], s50 offen offset:1024 lds
    s_waitcnt lgkmcnt(15)
    v_mfma_f32_16x16x32_bf16 v[80:83], a[208:211], a[0:3], 0
    ds_read_b64_tr_b16 a[192:193], v8 offset:6208
    v_mul_f32 v160, v160, v208
    v_mfma_f32_16x16x32_bf16 v[84:87], a[208:211], a[72:75], 0
    ds_read_b64_tr_b16 a[194:195], v8 offset:9280
    v_add_f32 v40, 1.0, v40
    v_mfma_f32_16x16x32_bf16 v[128:131], a[212:215], a[0:3], 0
    ds_read_b64_tr_b16 a[196:197], v8 offset:24640
    ds_read_b64_tr_b16 a[198:199], v8 offset:27712
    v_mfma_f32_16x16x32_bf16 v[132:135], a[212:215], a[72:75], 0
    buffer_load_dwordx4 v34, s[16:19], s50 offen offset:2048 lds
    v_mfma_f32_16x16x32_bf16 v[88:91], a[216:219], a[0:3], 0
    ds_read_b64_tr_b16 a[200:201], v9 offset:6208
    ds_read_b64_tr_b16 a[202:203], v9 offset:9280
    v_mfma_f32_16x16x32_bf16 v[92:95], a[216:219], a[72:75], 0
    v_exp_f32 v41, v161
    v_mfma_f32_16x16x32_bf16 v[136:139], a[220:223], a[0:3], 0
    ds_read_b64_tr_b16 a[204:205], v9 offset:24640
    v_mul_f32 v161, v161, v209
    v_mfma_f32_16x16x32_bf16 v[140:143], a[220:223], a[72:75], 0
    ds_read_b64_tr_b16 a[206:207], v9 offset:27712
    s_waitcnt lgkmcnt(15)
    v_mfma_f32_16x16x32_bf16 v[96:99], a[224:227], a[0:3], 0
    ds_read_b64_tr_b16 a[208:209], v8 offset:6272
    ds_read_b64_tr_b16 a[210:211], v8 offset:9344
    v_mfma_f32_16x16x32_bf16 v[100:103], a[224:227], a[72:75], 0
    v_exp_f32 v42, v162
    v_mfma_f32_16x16x32_bf16 v[144:147], a[228:231], a[0:3], 0
    ds_read_b64_tr_b16 a[212:213], v8 offset:24704
    v_mul_f32 v162, v162, v210
    v_mfma_f32_16x16x32_bf16 v[148:151], a[228:231], a[72:75], 0
    ds_read_b64_tr_b16 a[214:215], v8 offset:27776
    v_add_f32 v41, 1.0, v41
    v_mfma_f32_16x16x32_bf16 v[104:107], a[232:235], a[0:3], 0
    ds_read_b64_tr_b16 a[216:217], v9 offset:6272
    ds_read_b64_tr_b16 a[218:219], v9 offset:9344
    v_mfma_f32_16x16x32_bf16 v[108:111], a[232:235], a[72:75], 0
    v_exp_f32 v43, v163
    v_mfma_f32_16x16x32_bf16 v[152:155], a[236:239], a[0:3], 0
    ds_read_b64_tr_b16 a[220:221], v9 offset:24704
    v_mul_f32 v163, v163, v211
    v_mfma_f32_16x16x32_bf16 v[156:159], a[236:239], a[72:75], 0
    ds_read_b64_tr_b16 a[222:223], v9 offset:27776
    s_waitcnt lgkmcnt(15)
    v_mfma_f32_16x16x32_bf16 v[64:67], a[240:243], a[4:7], v[64:67]
    ds_read_b64_tr_b16 a[224:225], v8 offset:12288
    ds_read_b64_tr_b16 a[226:227], v8 offset:15360
    v_mfma_f32_16x16x32_bf16 v[68:71], a[240:243], a[76:79], v[68:71]
    v_exp_f32 v44, v168
    v_mfma_f32_16x16x32_bf16 v[112:115], a[244:247], a[4:7], v[112:115]
    ds_read_b64_tr_b16 a[228:229], v8 offset:30720
    v_mul_f32 v168, v168, v216
    v_mfma_f32_16x16x32_bf16 v[116:119], a[244:247], a[76:79], v[116:119]
    ds_read_b64_tr_b16 a[230:231], v8 offset:33792
    v_add_f32 v42, 1.0, v42
    v_mfma_f32_16x16x32_bf16 v[72:75], a[248:251], a[4:7], v[72:75]
    ds_read_b64_tr_b16 a[232:233], v9 offset:12288
    ds_read_b64_tr_b16 a[234:235], v9 offset:15360
    v_mfma_f32_16x16x32_bf16 v[76:79], a[248:251], a[76:79], v[76:79]
    v_exp_f32 v45, v169
    v_mfma_f32_16x16x32_bf16 v[120:123], a[252:255], a[4:7], v[120:123]
    ds_read_b64_tr_b16 a[236:237], v9 offset:30720
    v_mul_f32 v169, v169, v217
    v_mfma_f32_16x16x32_bf16 v[124:127], a[252:255], a[76:79], v[124:127]
    ds_read_b64_tr_b16 a[238:239], v9 offset:33792
    s_waitcnt lgkmcnt(15)
    v_mfma_f32_16x16x32_bf16 v[80:83], a[192:195], a[4:7], v[80:83]
    ds_read_b64_tr_b16 a[240:241], v8 offset:12352
    ds_read_b64_tr_b16 a[242:243], v8 offset:15424
    v_mfma_f32_16x16x32_bf16 v[84:87], a[192:195], a[76:79], v[84:87]
    v_exp_f32 v46, v170
    v_mfma_f32_16x16x32_bf16 v[128:131], a[196:199], a[4:7], v[128:131]
    ds_read_b64_tr_b16 a[244:245], v8 offset:30784
    v_mul_f32 v170, v170, v218
    v_mfma_f32_16x16x32_bf16 v[132:135], a[196:199], a[76:79], v[132:135]
    ds_read_b64_tr_b16 a[246:247], v8 offset:33856
    v_add_f32 v43, 1.0, v43
    v_mfma_f32_16x16x32_bf16 v[88:91], a[200:203], a[4:7], v[88:91]
    ds_read_b64_tr_b16 a[248:249], v9 offset:12352
    ds_read_b64_tr_b16 a[250:251], v9 offset:15424
    v_mfma_f32_16x16x32_bf16 v[92:95], a[200:203], a[76:79], v[92:95]
    v_exp_f32 v47, v171
    v_mfma_f32_16x16x32_bf16 v[136:139], a[204:207], a[4:7], v[136:139]
    ds_read_b64_tr_b16 a[252:253], v9 offset:30784
    v_mul_f32 v171, v171, v219
    v_mfma_f32_16x16x32_bf16 v[140:143], a[204:207], a[76:79], v[140:143]
    ds_read_b64_tr_b16 a[254:255], v9 offset:33856
    s_waitcnt lgkmcnt(15)
    v_mfma_f32_16x16x32_bf16 v[96:99], a[208:211], a[4:7], v[96:99]
    ds_read_b64_tr_b16 a[192:193], v8 offset:12416
    v_add_f32 v44, 1.0, v44
    v_mfma_f32_16x16x32_bf16 v[100:103], a[208:211], a[76:79], v[100:103]
    ds_read_b64_tr_b16 a[194:195], v8 offset:15488
    v_add_f32 v45, 1.0, v45
    v_mfma_f32_16x16x32_bf16 v[144:147], a[212:215], a[4:7], v[144:147]
    ds_read_b64_tr_b16 a[196:197], v8 offset:30848
    v_add_f32 v46, 1.0, v46
    v_mfma_f32_16x16x32_bf16 v[148:151], a[212:215], a[76:79], v[148:151]
    ds_read_b64_tr_b16 a[198:199], v8 offset:33920
    v_add_f32 v47, 1.0, v47
    v_mfma_f32_16x16x32_bf16 v[104:107], a[216:219], a[4:7], v[104:107]
    ds_read_b64_tr_b16 a[200:201], v9 offset:12416
    ds_read_b64_tr_b16 a[202:203], v9 offset:15488
    v_mfma_f32_16x16x32_bf16 v[108:111], a[216:219], a[76:79], v[108:111]
    v_rcp_f32 v40, v40
    v_mfma_f32_16x16x32_bf16 v[152:155], a[220:223], a[4:7], v[152:155]
    ds_read_b64_tr_b16 a[204:205], v9 offset:30848
    v_mul_f32 v160, v160, v40
    v_mfma_f32_16x16x32_bf16 v[156:159], a[220:223], a[76:79], v[156:159]
    s_add_u32 m0, s47, 110592
    ds_read_b64_tr_b16 a[206:207], v9 offset:33920
    s_waitcnt vmcnt(9)
    s_barrier
    s_waitcnt lgkmcnt(15)
    v_mfma_f32_16x16x32_bf16 v[64:67], a[224:227], a[8:11], v[64:67]
    ds_read_b64_tr_b16 a[208:209], v10 offset:0
    v_mfma_f32_16x16x32_bf16 v[68:71], a[224:227], a[80:83], v[68:71]
    s_mov_b32 s50, 2654592
    ds_read_b64_tr_b16 a[210:211], v10 offset:3072
    v_mfma_f32_16x16x32_bf16 v[112:115], a[228:231], a[8:11], v[112:115]
    ds_read_b64_tr_b16 a[212:213], v10 offset:18432
    ds_read_b64_tr_b16 a[214:215], v10 offset:21504
    v_mfma_f32_16x16x32_bf16 v[116:119], a[228:231], a[80:83], v[116:119]
    buffer_load_dwordx4 v32, s[16:19], s50 offen offset:0 lds
    v_mfma_f32_16x16x32_bf16 v[72:75], a[232:235], a[8:11], v[72:75]
    ds_read_b64_tr_b16 a[216:217], v11 offset:0
    ds_read_b64_tr_b16 a[218:219], v11 offset:3072
    v_mfma_f32_16x16x32_bf16 v[76:79], a[232:235], a[80:83], v[76:79]
    v_rcp_f32 v41, v41
    v_mfma_f32_16x16x32_bf16 v[120:123], a[236:239], a[8:11], v[120:123]
    ds_read_b64_tr_b16 a[220:221], v11 offset:18432
    ds_read_b64_tr_b16 a[222:223], v11 offset:21504
    v_mfma_f32_16x16x32_bf16 v[124:127], a[236:239], a[80:83], v[124:127]
    buffer_load_dwordx4 v33, s[16:19], s50 offen offset:1024 lds
    s_waitcnt lgkmcnt(15)
    v_mfma_f32_16x16x32_bf16 v[80:83], a[240:243], a[8:11], v[80:83]
    ds_read_b64_tr_b16 a[224:225], v10 offset:64
    ds_read_b64_tr_b16 a[226:227], v10 offset:3136
    v_mfma_f32_16x16x32_bf16 v[84:87], a[240:243], a[80:83], v[84:87]
    v_rcp_f32 v42, v42
    v_mfma_f32_16x16x32_bf16 v[128:131], a[244:247], a[8:11], v[128:131]
    ds_read_b64_tr_b16 a[228:229], v10 offset:18496
    ds_read_b64_tr_b16 a[230:231], v10 offset:21568
    v_mfma_f32_16x16x32_bf16 v[132:135], a[244:247], a[80:83], v[132:135]
    buffer_load_dwordx4 v34, s[16:19], s50 offen offset:2048 lds
    s_add_u32 m0, s47, 113664
    v_mfma_f32_16x16x32_bf16 v[88:91], a[248:251], a[8:11], v[88:91]
    ds_read_b64_tr_b16 a[232:233], v11 offset:64
    v_mul_f32 v161, v161, v41
    v_mfma_f32_16x16x32_bf16 v[92:95], a[248:251], a[80:83], v[92:95]
    s_mov_b32 s50, 2802048
    ds_read_b64_tr_b16 a[234:235], v11 offset:3136
    v_mfma_f32_16x16x32_bf16 v[136:139], a[252:255], a[8:11], v[136:139]
    ds_read_b64_tr_b16 a[236:237], v11 offset:18496
    ds_read_b64_tr_b16 a[238:239], v11 offset:21568
    v_mfma_f32_16x16x32_bf16 v[140:143], a[252:255], a[80:83], v[140:143]
    buffer_load_dwordx4 v32, s[16:19], s50 offen offset:0 lds
    s_waitcnt lgkmcnt(15)
    v_mfma_f32_16x16x32_bf16 v[96:99], a[192:195], a[8:11], v[96:99]
    ds_read_b64_tr_b16 a[240:241], v10 offset:128
    ds_read_b64_tr_b16 a[242:243], v10 offset:3200
    v_mfma_f32_16x16x32_bf16 v[100:103], a[192:195], a[80:83], v[100:103]
    v_rcp_f32 v43, v43
    v_mfma_f32_16x16x32_bf16 v[144:147], a[196:199], a[8:11], v[144:147]
    ds_read_b64_tr_b16 a[244:245], v10 offset:18560
    ds_read_b64_tr_b16 a[246:247], v10 offset:21632
    v_mfma_f32_16x16x32_bf16 v[148:151], a[196:199], a[80:83], v[148:151]
    buffer_load_dwordx4 v33, s[16:19], s50 offen offset:1024 lds
    v_mfma_f32_16x16x32_bf16 v[104:107], a[200:203], a[8:11], v[104:107]
    ds_read_b64_tr_b16 a[248:249], v11 offset:128
    ds_read_b64_tr_b16 a[250:251], v11 offset:3200
    v_mfma_f32_16x16x32_bf16 v[108:111], a[200:203], a[80:83], v[108:111]
    v_rcp_f32 v44, v44
    v_mfma_f32_16x16x32_bf16 v[152:155], a[204:207], a[8:11], v[152:155]
    ds_read_b64_tr_b16 a[252:253], v11 offset:18560
    ds_read_b64_tr_b16 a[254:255], v11 offset:21632
    v_mfma_f32_16x16x32_bf16 v[156:159], a[204:207], a[80:83], v[156:159]
    buffer_load_dwordx4 v34, s[16:19], s50 offen offset:2048 lds
    s_add_u32 m0, s47, 116736
    s_waitcnt lgkmcnt(15)
    v_mfma_f32_16x16x32_bf16 v[64:67], a[208:211], a[12:15], v[64:67]
    ds_read_b64_tr_b16 a[192:193], v10 offset:6144
    v_mul_f32 v162, v162, v42
    v_mfma_f32_16x16x32_bf16 v[68:71], a[208:211], a[84:87], v[68:71]
    s_mov_b32 s50, 2949504
    ds_read_b64_tr_b16 a[194:195], v10 offset:9216
    v_mfma_f32_16x16x32_bf16 v[112:115], a[212:215], a[12:15], v[112:115]
    ds_read_b64_tr_b16 a[196:197], v10 offset:24576
    ds_read_b64_tr_b16 a[198:199], v10 offset:27648
    v_mfma_f32_16x16x32_bf16 v[116:119], a[212:215], a[84:87], v[116:119]
    buffer_load_dwordx4 v32, s[16:19], s50 offen offset:0 lds
    v_mfma_f32_16x16x32_bf16 v[72:75], a[216:219], a[12:15], v[72:75]
    ds_read_b64_tr_b16 a[200:201], v11 offset:6144
    ds_read_b64_tr_b16 a[202:203], v11 offset:9216
    v_mfma_f32_16x16x32_bf16 v[76:79], a[216:219], a[84:87], v[76:79]
    v_rcp_f32 v45, v45
    v_mfma_f32_16x16x32_bf16 v[120:123], a[220:223], a[12:15], v[120:123]
    ds_read_b64_tr_b16 a[204:205], v11 offset:24576
    ds_read_b64_tr_b16 a[206:207], v11 offset:27648
    v_mfma_f32_16x16x32_bf16 v[124:127], a[220:223], a[84:87], v[124:127]
    buffer_load_dwordx4 v33, s[16:19], s50 offen offset:1024 lds
    s_waitcnt lgkmcnt(15)
    v_mfma_f32_16x16x32_bf16 v[80:83], a[224:227], a[12:15], v[80:83]
    ds_read_b64_tr_b16 a[208:209], v10 offset:6208
    ds_read_b64_tr_b16 a[210:211], v10 offset:9280
    v_mfma_f32_16x16x32_bf16 v[84:87], a[224:227], a[84:87], v[84:87]
    v_rcp_f32 v46, v46
    v_mfma_f32_16x16x32_bf16 v[128:131], a[228:231], a[12:15], v[128:131]
    ds_read_b64_tr_b16 a[212:213], v10 offset:24640
    ds_read_b64_tr_b16 a[214:215], v10 offset:27712
    v_mfma_f32_16x16x32_bf16 v[132:135], a[228:231], a[84:87], v[132:135]
    buffer_load_dwordx4 v34, s[16:19], s50 offen offset:2048 lds
    v_mfma_f32_16x16x32_bf16 v[88:91], a[232:235], a[12:15], v[88:91]
    ds_read_b64_tr_b16 a[216:217], v11 offset:6208
    ds_read_b64_tr_b16 a[218:219], v11 offset:9280
    v_mfma_f32_16x16x32_bf16 v[92:95], a[232:235], a[84:87], v[92:95]
    v_rcp_f32 v47, v47
    v_mfma_f32_16x16x32_bf16 v[136:139], a[236:239], a[12:15], v[136:139]
    ds_read_b64_tr_b16 a[220:221], v11 offset:24640
    v_mul_f32 v163, v163, v43
    v_mfma_f32_16x16x32_bf16 v[140:143], a[236:239], a[84:87], v[140:143]
    ds_read_b64_tr_b16 a[222:223], v11 offset:27712
    s_waitcnt lgkmcnt(15)
    v_mfma_f32_16x16x32_bf16 v[96:99], a[240:243], a[12:15], v[96:99]
    ds_read_b64_tr_b16 a[224:225], v10 offset:6272
    v_mul_f32 v168, v168, v44
    v_mfma_f32_16x16x32_bf16 v[100:103], a[240:243], a[84:87], v[100:103]
    ds_read_b64_tr_b16 a[226:227], v10 offset:9344
    v_mul_f32 v169, v169, v45
    v_mfma_f32_16x16x32_bf16 v[144:147], a[244:247], a[12:15], v[144:147]
    ds_read_b64_tr_b16 a[228:229], v10 offset:24704
    v_mul_f32 v170, v170, v46
    v_mfma_f32_16x16x32_bf16 v[148:151], a[244:247], a[84:87], v[148:151]
    ds_read_b64_tr_b16 a[230:231], v10 offset:27776
    v_mul_f32 v171, v171, v47
    v_mfma_f32_16x16x32_bf16 v[104:107], a[248:251], a[12:15], v[104:107]
    ds_read_b64_tr_b16 a[232:233], v11 offset:6272
    v_cvt_pk_bf16_f32 v56, v160, v161
    v_mfma_f32_16x16x32_bf16 v[108:111], a[248:251], a[84:87], v[108:111]
    ds_read_b64_tr_b16 a[234:235], v11 offset:9344
    v_cvt_pk_bf16_f32 v57, v162, v163
    v_mfma_f32_16x16x32_bf16 v[152:155], a[252:255], a[12:15], v[152:155]
    ds_read_b64_tr_b16 a[236:237], v11 offset:24704
    v_cvt_pk_bf16_f32 v58, v168, v169
    v_mfma_f32_16x16x32_bf16 v[156:159], a[252:255], a[84:87], v[156:159]
    ds_read_b64_tr_b16 a[238:239], v11 offset:27776
    s_waitcnt lgkmcnt(15)
    v_mfma_f32_16x16x32_bf16 v[64:67], a[192:195], a[16:19], v[64:67]
    ds_read_b64_tr_b16 a[240:241], v10 offset:12288
    v_cvt_pk_bf16_f32 v59, v170, v171
    v_mfma_f32_16x16x32_bf16 v[68:71], a[192:195], a[88:91], v[68:71]
    ds_read_b64_tr_b16 a[242:243], v10 offset:15360
    v_accvgpr_write_b32 a168, v56
    v_mfma_f32_16x16x32_bf16 v[112:115], a[196:199], a[16:19], v[112:115]
    ds_read_b64_tr_b16 a[244:245], v10 offset:30720
    v_accvgpr_write_b32 a169, v57
    v_mfma_f32_16x16x32_bf16 v[116:119], a[196:199], a[88:91], v[116:119]
    ds_read_b64_tr_b16 a[246:247], v10 offset:33792
    v_accvgpr_write_b32 a170, v58
    v_mfma_f32_16x16x32_bf16 v[72:75], a[200:203], a[16:19], v[72:75]
    ds_read_b64_tr_b16 a[248:249], v11 offset:12288
    v_accvgpr_write_b32 a171, v59
    v_mfma_f32_16x16x32_bf16 v[76:79], a[200:203], a[88:91], v[76:79]
    ds_read_b64_tr_b16 a[250:251], v11 offset:15360
    v_mfma_f32_16x16x32_bf16 v[120:123], a[204:207], a[16:19], v[120:123]
    ds_read_b64_tr_b16 a[252:253], v11 offset:30720
    ds_read_b64_tr_b16 a[254:255], v11 offset:33792
    v_mfma_f32_16x16x32_bf16 v[124:127], a[204:207], a[88:91], v[124:127]
    s_waitcnt lgkmcnt(15)
    v_mfma_f32_16x16x32_bf16 v[80:83], a[208:211], a[16:19], v[80:83]
    ds_read_b64_tr_b16 a[192:193], v10 offset:12352
    ds_read_b64_tr_b16 a[194:195], v10 offset:15424
    v_mfma_f32_16x16x32_bf16 v[84:87], a[208:211], a[88:91], v[84:87]
    v_exp_f32 v48, v164
    v_mfma_f32_16x16x32_bf16 v[128:131], a[212:215], a[16:19], v[128:131]
    ds_read_b64_tr_b16 a[196:197], v10 offset:30784
    v_mul_f32 v164, v164, v212
    v_mfma_f32_16x16x32_bf16 v[132:135], a[212:215], a[88:91], v[132:135]
    ds_read_b64_tr_b16 a[198:199], v10 offset:33856
    v_add_f32 v48, 1.0, v48
    v_mfma_f32_16x16x32_bf16 v[88:91], a[216:219], a[16:19], v[88:91]
    ds_read_b64_tr_b16 a[200:201], v11 offset:12352
    ds_read_b64_tr_b16 a[202:203], v11 offset:15424
    v_mfma_f32_16x16x32_bf16 v[92:95], a[216:219], a[88:91], v[92:95]
    v_exp_f32 v49, v165
    v_mfma_f32_16x16x32_bf16 v[136:139], a[220:223], a[16:19], v[136:139]
    ds_read_b64_tr_b16 a[204:205], v11 offset:30784
    v_mul_f32 v165, v165, v213
    v_mfma_f32_16x16x32_bf16 v[140:143], a[220:223], a[88:91], v[140:143]
    ds_read_b64_tr_b16 a[206:207], v11 offset:33856
    s_waitcnt lgkmcnt(15)
    v_mfma_f32_16x16x32_bf16 v[96:99], a[224:227], a[16:19], v[96:99]
    ds_read_b64_tr_b16 a[208:209], v10 offset:12416
    ds_read_b64_tr_b16 a[210:211], v10 offset:15488
    v_mfma_f32_16x16x32_bf16 v[100:103], a[224:227], a[88:91], v[100:103]
    v_exp_f32 v50, v166
    v_mfma_f32_16x16x32_bf16 v[144:147], a[228:231], a[16:19], v[144:147]
    ds_read_b64_tr_b16 a[212:213], v10 offset:30848
    v_mul_f32 v166, v166, v214
    v_mfma_f32_16x16x32_bf16 v[148:151], a[228:231], a[88:91], v[148:151]
    ds_read_b64_tr_b16 a[214:215], v10 offset:33920
    v_add_f32 v49, 1.0, v49
    v_mfma_f32_16x16x32_bf16 v[104:107], a[232:235], a[16:19], v[104:107]
    ds_read_b64_tr_b16 a[216:217], v11 offset:12416
    ds_read_b64_tr_b16 a[218:219], v11 offset:15488
    v_mfma_f32_16x16x32_bf16 v[108:111], a[232:235], a[88:91], v[108:111]
    v_exp_f32 v51, v167
    v_mfma_f32_16x16x32_bf16 v[152:155], a[236:239], a[16:19], v[152:155]
    ds_read_b64_tr_b16 a[220:221], v11 offset:30848
    v_mul_f32 v167, v167, v215
    v_mfma_f32_16x16x32_bf16 v[156:159], a[236:239], a[88:91], v[156:159]
    s_add_u32 m0, s47, 0
    ds_read_b64_tr_b16 a[222:223], v11 offset:33920
    s_waitcnt vmcnt(9)
    s_barrier
    s_waitcnt lgkmcnt(15)
    v_mfma_f32_16x16x32_bf16 v[64:67], a[240:243], a[20:23], v[64:67]
    ds_read_b64_tr_b16 a[224:225], v12 offset:0
    v_add_f32 v50, 1.0, v50
    v_mfma_f32_16x16x32_bf16 v[68:71], a[240:243], a[92:95], v[68:71]
    s_mov_b32 s50, 3539328
    ds_read_b64_tr_b16 a[226:227], v12 offset:3072
    v_mfma_f32_16x16x32_bf16 v[112:115], a[244:247], a[20:23], v[112:115]
    ds_read_b64_tr_b16 a[228:229], v12 offset:18432
    ds_read_b64_tr_b16 a[230:231], v12 offset:21504
    v_mfma_f32_16x16x32_bf16 v[116:119], a[244:247], a[92:95], v[116:119]
    buffer_load_dwordx4 v32, s[16:19], s50 offen offset:0 lds
    v_mfma_f32_16x16x32_bf16 v[72:75], a[248:251], a[20:23], v[72:75]
    ds_read_b64_tr_b16 a[232:233], v13 offset:0
    ds_read_b64_tr_b16 a[234:235], v13 offset:3072
    v_mfma_f32_16x16x32_bf16 v[76:79], a[248:251], a[92:95], v[76:79]
    v_exp_f32 v52, v172
    v_mfma_f32_16x16x32_bf16 v[120:123], a[252:255], a[20:23], v[120:123]
    ds_read_b64_tr_b16 a[236:237], v13 offset:18432
    ds_read_b64_tr_b16 a[238:239], v13 offset:21504
    v_mfma_f32_16x16x32_bf16 v[124:127], a[252:255], a[92:95], v[124:127]
    buffer_load_dwordx4 v33, s[16:19], s50 offen offset:1024 lds
    s_waitcnt lgkmcnt(15)
    v_mfma_f32_16x16x32_bf16 v[80:83], a[192:195], a[20:23], v[80:83]
    ds_read_b64_tr_b16 a[240:241], v12 offset:64
    v_mul_f32 v172, v172, v220
    v_mfma_f32_16x16x32_bf16 v[84:87], a[192:195], a[92:95], v[84:87]
    ds_read_b64_tr_b16 a[242:243], v12 offset:3136
    v_add_f32 v51, 1.0, v51
    v_mfma_f32_16x16x32_bf16 v[128:131], a[196:199], a[20:23], v[128:131]
    ds_read_b64_tr_b16 a[244:245], v12 offset:18496
    ds_read_b64_tr_b16 a[246:247], v12 offset:21568
    v_mfma_f32_16x16x32_bf16 v[132:135], a[196:199], a[92:95], v[132:135]
    buffer_load_dwordx4 v34, s[16:19], s50 offen offset:2048 lds
    s_add_u32 m0, s47, 3072
    v_mfma_f32_16x16x32_bf16 v[88:91], a[200:203], a[20:23], v[88:91]
    ds_read_b64_tr_b16 a[248:249], v13 offset:64
    v_add_f32 v52, 1.0, v52
    v_mfma_f32_16x16x32_bf16 v[92:95], a[200:203], a[92:95], v[92:95]
    s_mov_b32 s50, 3686784
    ds_read_b64_tr_b16 a[250:251], v13 offset:3136
    v_mfma_f32_16x16x32_bf16 v[136:139], a[204:207], a[20:23], v[136:139]
    ds_read_b64_tr_b16 a[252:253], v13 offset:18496
    ds_read_b64_tr_b16 a[254:255], v13 offset:21568
    v_mfma_f32_16x16x32_bf16 v[140:143], a[204:207], a[92:95], v[140:143]
    buffer_load_dwordx4 v32, s[16:19], s50 offen offset:0 lds
    s_waitcnt lgkmcnt(15)
    v_mfma_f32_16x16x32_bf16 v[96:99], a[208:211], a[20:23], v[96:99]
    ds_read_b64_tr_b16 a[192:193], v12 offset:128
    ds_read_b64_tr_b16 a[194:195], v12 offset:3200
    v_mfma_f32_16x16x32_bf16 v[100:103], a[208:211], a[92:95], v[100:103]
    v_exp_f32 v53, v173
    v_mfma_f32_16x16x32_bf16 v[144:147], a[212:215], a[20:23], v[144:147]
    ds_read_b64_tr_b16 a[196:197], v12 offset:18560
    ds_read_b64_tr_b16 a[198:199], v12 offset:21632
    v_mfma_f32_16x16x32_bf16 v[148:151], a[212:215], a[92:95], v[148:151]
    buffer_load_dwordx4 v33, s[16:19], s50 offen offset:1024 lds
    v_mfma_f32_16x16x32_bf16 v[104:107], a[216:219], a[20:23], v[104:107]
    ds_read_b64_tr_b16 a[200:201], v13 offset:128
    v_mul_f32 v173, v173, v221
    v_mfma_f32_16x16x32_bf16 v[108:111], a[216:219], a[92:95], v[108:111]
    ds_read_b64_tr_b16 a[202:203], v13 offset:3200
    v_add_f32 v53, 1.0, v53
    v_mfma_f32_16x16x32_bf16 v[152:155], a[220:223], a[20:23], v[152:155]
    ds_read_b64_tr_b16 a[204:205], v13 offset:18560
    ds_read_b64_tr_b16 a[206:207], v13 offset:21632
    v_mfma_f32_16x16x32_bf16 v[156:159], a[220:223], a[92:95], v[156:159]
    buffer_load_dwordx4 v34, s[16:19], s50 offen offset:2048 lds
    s_add_u32 m0, s47, 6144
    s_waitcnt lgkmcnt(15)
    v_mfma_f32_16x16x32_bf16 v[64:67], a[224:227], a[24:27], v[64:67]
    ds_read_b64_tr_b16 a[208:209], v12 offset:6144
    v_mfma_f32_16x16x32_bf16 v[68:71], a[224:227], a[96:99], v[68:71]
    s_mov_b32 s50, 3834240
    ds_read_b64_tr_b16 a[210:211], v12 offset:9216
    v_mfma_f32_16x16x32_bf16 v[112:115], a[228:231], a[24:27], v[112:115]
    ds_read_b64_tr_b16 a[212:213], v12 offset:24576
    ds_read_b64_tr_b16 a[214:215], v12 offset:27648
    v_mfma_f32_16x16x32_bf16 v[116:119], a[228:231], a[96:99], v[116:119]
    buffer_load_dwordx4 v32, s[16:19], s50 offen offset:0 lds
    v_mfma_f32_16x16x32_bf16 v[72:75], a[232:235], a[24:27], v[72:75]
    ds_read_b64_tr_b16 a[216:217], v13 offset:6144
    ds_read_b64_tr_b16 a[218:219], v13 offset:9216
    v_mfma_f32_16x16x32_bf16 v[76:79], a[232:235], a[96:99], v[76:79]
    v_exp_f32 v54, v174
    v_mfma_f32_16x16x32_bf16 v[120:123], a[236:239], a[24:27], v[120:123]
    ds_read_b64_tr_b16 a[220:221], v13 offset:24576
    ds_read_b64_tr_b16 a[222:223], v13 offset:27648
    v_mfma_f32_16x16x32_bf16 v[124:127], a[236:239], a[96:99], v[124:127]
    buffer_load_dwordx4 v33, s[16:19], s50 offen offset:1024 lds
    s_waitcnt lgkmcnt(15)
    v_mfma_f32_16x16x32_bf16 v[80:83], a[240:243], a[24:27], v[80:83]
    ds_read_b64_tr_b16 a[224:225], v12 offset:6208
    v_mul_f32 v174, v174, v222
    v_mfma_f32_16x16x32_bf16 v[84:87], a[240:243], a[96:99], v[84:87]
    ds_read_b64_tr_b16 a[226:227], v12 offset:9280
    v_add_f32 v54, 1.0, v54
    v_mfma_f32_16x16x32_bf16 v[128:131], a[244:247], a[24:27], v[128:131]
    ds_read_b64_tr_b16 a[228:229], v12 offset:24640
    ds_read_b64_tr_b16 a[230:231], v12 offset:27712
    v_mfma_f32_16x16x32_bf16 v[132:135], a[244:247], a[96:99], v[132:135]
    buffer_load_dwordx4 v34, s[16:19], s50 offen offset:2048 lds
    v_mfma_f32_16x16x32_bf16 v[88:91], a[248:251], a[24:27], v[88:91]
    ds_read_b64_tr_b16 a[232:233], v13 offset:6208
    ds_read_b64_tr_b16 a[234:235], v13 offset:9280
    v_mfma_f32_16x16x32_bf16 v[92:95], a[248:251], a[96:99], v[92:95]
    v_exp_f32 v55, v175
    v_mfma_f32_16x16x32_bf16 v[136:139], a[252:255], a[24:27], v[136:139]
    ds_read_b64_tr_b16 a[236:237], v13 offset:24640
    v_mul_f32 v175, v175, v223
    v_mfma_f32_16x16x32_bf16 v[140:143], a[252:255], a[96:99], v[140:143]
    ds_read_b64_tr_b16 a[238:239], v13 offset:27712
    s_waitcnt lgkmcnt(15)
    v_mfma_f32_16x16x32_bf16 v[96:99], a[192:195], a[24:27], v[96:99]
    ds_read_b64_tr_b16 a[240:241], v12 offset:6272
    v_add_f32 v55, 1.0, v55
    v_mfma_f32_16x16x32_bf16 v[100:103], a[192:195], a[96:99], v[100:103]
    ds_read_b64_tr_b16 a[242:243], v12 offset:9344
    v_mfma_f32_16x16x32_bf16 v[144:147], a[196:199], a[24:27], v[144:147]
    ds_read_b64_tr_b16 a[244:245], v12 offset:24704
    ds_read_b64_tr_b16 a[246:247], v12 offset:27776
    v_mfma_f32_16x16x32_bf16 v[148:151], a[196:199], a[96:99], v[148:151]
    v_rcp_f32 v48, v48
    v_mfma_f32_16x16x32_bf16 v[104:107], a[200:203], a[24:27], v[104:107]
    ds_read_b64_tr_b16 a[248:249], v13 offset:6272
    ds_read_b64_tr_b16 a[250:251], v13 offset:9344
    v_mfma_f32_16x16x32_bf16 v[108:111], a[200:203], a[96:99], v[108:111]
    v_rcp_f32 v49, v49
    v_mfma_f32_16x16x32_bf16 v[152:155], a[204:207], a[24:27], v[152:155]
    ds_read_b64_tr_b16 a[252:253], v13 offset:24704
    ds_read_b64_tr_b16 a[254:255], v13 offset:27776
    v_mfma_f32_16x16x32_bf16 v[156:159], a[204:207], a[96:99], v[156:159]
    v_mul_f32 v164, v164, v48
    s_waitcnt lgkmcnt(15)
    v_mfma_f32_16x16x32_bf16 v[64:67], a[208:211], a[28:31], v[64:67]
    ds_read_b64_tr_b16 a[192:193], v12 offset:12288
    ds_read_b64_tr_b16 a[194:195], v12 offset:15360
    v_mfma_f32_16x16x32_bf16 v[68:71], a[208:211], a[100:103], v[68:71]
    v_rcp_f32 v50, v50
    v_mfma_f32_16x16x32_bf16 v[112:115], a[212:215], a[28:31], v[112:115]
    ds_read_b64_tr_b16 a[196:197], v12 offset:30720
    ds_read_b64_tr_b16 a[198:199], v12 offset:33792
    v_mfma_f32_16x16x32_bf16 v[116:119], a[212:215], a[100:103], v[116:119]
    v_rcp_f32 v51, v51
    v_mfma_f32_16x16x32_bf16 v[72:75], a[216:219], a[28:31], v[72:75]
    ds_read_b64_tr_b16 a[200:201], v13 offset:12288
    ds_read_b64_tr_b16 a[202:203], v13 offset:15360
    v_mfma_f32_16x16x32_bf16 v[76:79], a[216:219], a[100:103], v[76:79]
    v_rcp_f32 v52, v52
    v_mfma_f32_16x16x32_bf16 v[120:123], a[220:223], a[28:31], v[120:123]
    ds_read_b64_tr_b16 a[204:205], v13 offset:30720
    ds_read_b64_tr_b16 a[206:207], v13 offset:33792
    v_mfma_f32_16x16x32_bf16 v[124:127], a[220:223], a[100:103], v[124:127]
    v_mul_f32 v165, v165, v49
    s_waitcnt lgkmcnt(15)
    v_mfma_f32_16x16x32_bf16 v[80:83], a[224:227], a[28:31], v[80:83]
    ds_read_b64_tr_b16 a[208:209], v12 offset:12352
    ds_read_b64_tr_b16 a[210:211], v12 offset:15424
    v_mfma_f32_16x16x32_bf16 v[84:87], a[224:227], a[100:103], v[84:87]
    v_rcp_f32 v53, v53
    v_mfma_f32_16x16x32_bf16 v[128:131], a[228:231], a[28:31], v[128:131]
    ds_read_b64_tr_b16 a[212:213], v12 offset:30784
    ds_read_b64_tr_b16 a[214:215], v12 offset:33856
    v_mfma_f32_16x16x32_bf16 v[132:135], a[228:231], a[100:103], v[132:135]
    v_rcp_f32 v54, v54
    v_mfma_f32_16x16x32_bf16 v[88:91], a[232:235], a[28:31], v[88:91]
    ds_read_b64_tr_b16 a[216:217], v13 offset:12352
    ds_read_b64_tr_b16 a[218:219], v13 offset:15424
    v_mfma_f32_16x16x32_bf16 v[92:95], a[232:235], a[100:103], v[92:95]
    v_rcp_f32 v55, v55
    v_mfma_f32_16x16x32_bf16 v[136:139], a[236:239], a[28:31], v[136:139]
    ds_read_b64_tr_b16 a[220:221], v13 offset:30784
    v_mul_f32 v166, v166, v50
    v_mfma_f32_16x16x32_bf16 v[140:143], a[236:239], a[100:103], v[140:143]
    ds_read_b64_tr_b16 a[222:223], v13 offset:33856
    s_waitcnt lgkmcnt(15)
    v_mfma_f32_16x16x32_bf16 v[96:99], a[240:243], a[28:31], v[96:99]
    ds_read_b64_tr_b16 a[224:225], v12 offset:12416
    v_mul_f32 v167, v167, v51
    v_mfma_f32_16x16x32_bf16 v[100:103], a[240:243], a[100:103], v[100:103]
    ds_read_b64_tr_b16 a[226:227], v12 offset:15488
    v_mul_f32 v172, v172, v52
    v_mfma_f32_16x16x32_bf16 v[144:147], a[244:247], a[28:31], v[144:147]
    ds_read_b64_tr_b16 a[228:229], v12 offset:30848
    v_mul_f32 v173, v173, v53
    v_mfma_f32_16x16x32_bf16 v[148:151], a[244:247], a[100:103], v[148:151]
    ds_read_b64_tr_b16 a[230:231], v12 offset:33920
    v_mul_f32 v174, v174, v54
    v_mfma_f32_16x16x32_bf16 v[104:107], a[248:251], a[28:31], v[104:107]
    ds_read_b64_tr_b16 a[232:233], v13 offset:12416
    v_mul_f32 v175, v175, v55
    v_mfma_f32_16x16x32_bf16 v[108:111], a[248:251], a[100:103], v[108:111]
    ds_read_b64_tr_b16 a[234:235], v13 offset:15488
    v_cvt_pk_bf16_f32 v56, v164, v165
    v_mfma_f32_16x16x32_bf16 v[152:155], a[252:255], a[28:31], v[152:155]
    ds_read_b64_tr_b16 a[236:237], v13 offset:30848
    v_cvt_pk_bf16_f32 v57, v166, v167
    v_mfma_f32_16x16x32_bf16 v[156:159], a[252:255], a[100:103], v[156:159]
    s_add_u32 m0, s47, 36864
    ds_read_b64_tr_b16 a[238:239], v13 offset:33920
    s_waitcnt vmcnt(9)
    s_barrier
    s_waitcnt lgkmcnt(15)
    v_mfma_f32_16x16x32_bf16 v[64:67], a[192:195], a[32:35], v[64:67]
    ds_read_b64_tr_b16 a[240:241], v14 offset:0
    v_cvt_pk_bf16_f32 v58, v172, v173
    v_mfma_f32_16x16x32_bf16 v[68:71], a[192:195], a[104:107], v[68:71]
    s_mov_b32 s50, 4424064
    ds_read_b64_tr_b16 a[242:243], v14 offset:3072
    v_mfma_f32_16x16x32_bf16 v[112:115], a[196:199], a[32:35], v[112:115]
    ds_read_b64_tr_b16 a[244:245], v14 offset:18432
    ds_read_b64_tr_b16 a[246:247], v14 offset:21504
    v_mfma_f32_16x16x32_bf16 v[116:119], a[196:199], a[104:107], v[116:119]
    buffer_load_dwordx4 v32, s[16:19], s50 offen offset:0 lds
    v_mfma_f32_16x16x32_bf16 v[72:75], a[200:203], a[32:35], v[72:75]
    ds_read_b64_tr_b16 a[248:249], v15 offset:0
    v_cvt_pk_bf16_f32 v59, v174, v175
    v_mfma_f32_16x16x32_bf16 v[76:79], a[200:203], a[104:107], v[76:79]
    ds_read_b64_tr_b16 a[250:251], v15 offset:3072
    v_accvgpr_write_b32 a172, v56
    v_mfma_f32_16x16x32_bf16 v[120:123], a[204:207], a[32:35], v[120:123]
    ds_read_b64_tr_b16 a[252:253], v15 offset:18432
    ds_read_b64_tr_b16 a[254:255], v15 offset:21504
    v_mfma_f32_16x16x32_bf16 v[124:127], a[204:207], a[104:107], v[124:127]
    buffer_load_dwordx4 v33, s[16:19], s50 offen offset:1024 lds
    s_waitcnt lgkmcnt(15)
    v_mfma_f32_16x16x32_bf16 v[80:83], a[208:211], a[32:35], v[80:83]
    ds_read_b64_tr_b16 a[192:193], v14 offset:64
    v_accvgpr_write_b32 a173, v57
    v_mfma_f32_16x16x32_bf16 v[84:87], a[208:211], a[104:107], v[84:87]
    ds_read_b64_tr_b16 a[194:195], v14 offset:3136
    v_accvgpr_write_b32 a174, v58
    v_mfma_f32_16x16x32_bf16 v[128:131], a[212:215], a[32:35], v[128:131]
    ds_read_b64_tr_b16 a[196:197], v14 offset:18496
    ds_read_b64_tr_b16 a[198:199], v14 offset:21568
    v_mfma_f32_16x16x32_bf16 v[132:135], a[212:215], a[104:107], v[132:135]
    buffer_load_dwordx4 v34, s[16:19], s50 offen offset:2048 lds
    s_add_u32 m0, s47, 39936
    v_mfma_f32_16x16x32_bf16 v[88:91], a[216:219], a[32:35], v[88:91]
    ds_read_b64_tr_b16 a[200:201], v15 offset:64
    v_accvgpr_write_b32 a175, v59
    v_mfma_f32_16x16x32_bf16 v[92:95], a[216:219], a[104:107], v[92:95]
    s_mov_b32 s50, 4571520
    ds_read_b64_tr_b16 a[202:203], v15 offset:3136
    v_mfma_f32_16x16x32_bf16 v[136:139], a[220:223], a[32:35], v[136:139]
    ds_read_b64_tr_b16 a[204:205], v15 offset:18496
    ds_read_b64_tr_b16 a[206:207], v15 offset:21568
    v_mfma_f32_16x16x32_bf16 v[140:143], a[220:223], a[104:107], v[140:143]
    buffer_load_dwordx4 v32, s[16:19], s50 offen offset:0 lds
    s_waitcnt lgkmcnt(15)
    v_mfma_f32_16x16x32_bf16 v[96:99], a[224:227], a[32:35], v[96:99]
    ds_read_b64_tr_b16 a[208:209], v14 offset:128
    ds_read_b64_tr_b16 a[210:211], v14 offset:3200
    v_mfma_f32_16x16x32_bf16 v[100:103], a[224:227], a[104:107], v[100:103]
    v_exp_f32 v40, v176
    v_mfma_f32_16x16x32_bf16 v[144:147], a[228:231], a[32:35], v[144:147]
    ds_read_b64_tr_b16 a[212:213], v14 offset:18560
    ds_read_b64_tr_b16 a[214:215], v14 offset:21632
    v_mfma_f32_16x16x32_bf16 v[148:151], a[228:231], a[104:107], v[148:151]
    buffer_load_dwordx4 v33, s[16:19], s50 offen offset:1024 lds
    v_mfma_f32_16x16x32_bf16 v[104:107], a[232:235], a[32:35], v[104:107]
    ds_read_b64_tr_b16 a[216:217], v15 offset:128
    v_mul_f32 v176, v176, v224
    v_mfma_f32_16x16x32_bf16 v[108:111], a[232:235], a[104:107], v[108:111]
    ds_read_b64_tr_b16 a[218:219], v15 offset:3200
    v_add_f32 v40, 1.0, v40
    v_mfma_f32_16x16x32_bf16 v[152:155], a[236:239], a[32:35], v[152:155]
    ds_read_b64_tr_b16 a[220:221], v15 offset:18560
    ds_read_b64_tr_b16 a[222:223], v15 offset:21632
    v_mfma_f32_16x16x32_bf16 v[156:159], a[236:239], a[104:107], v[156:159]
    buffer_load_dwordx4 v34, s[16:19], s50 offen offset:2048 lds
    s_add_u32 m0, s47, 43008
    s_waitcnt lgkmcnt(15)
    v_mfma_f32_16x16x32_bf16 v[64:67], a[240:243], a[36:39], v[64:67]
    ds_read_b64_tr_b16 a[224:225], v14 offset:6144
    v_mfma_f32_16x16x32_bf16 v[68:71], a[240:243], a[108:111], v[68:71]
    s_mov_b32 s50, 4718976
    ds_read_b64_tr_b16 a[226:227], v14 offset:9216
    v_mfma_f32_16x16x32_bf16 v[112:115], a[244:247], a[36:39], v[112:115]
    ds_read_b64_tr_b16 a[228:229], v14 offset:24576
    ds_read_b64_tr_b16 a[230:231], v14 offset:27648
    v_mfma_f32_16x16x32_bf16 v[116:119], a[244:247], a[108:111], v[116:119]
    buffer_load_dwordx4 v32, s[16:19], s50 offen offset:0 lds
    v_mfma_f32_16x16x32_bf16 v[72:75], a[248:251], a[36:39], v[72:75]
    ds_read_b64_tr_b16 a[232:233], v15 offset:6144
    ds_read_b64_tr_b16 a[234:235], v15 offset:9216
    v_mfma_f32_16x16x32_bf16 v[76:79], a[248:251], a[108:111], v[76:79]
    v_exp_f32 v41, v177
    v_mfma_f32_16x16x32_bf16 v[120:123], a[252:255], a[36:39], v[120:123]
    ds_read_b64_tr_b16 a[236:237], v15 offset:24576
    ds_read_b64_tr_b16 a[238:239], v15 offset:27648
    v_mfma_f32_16x16x32_bf16 v[124:127], a[252:255], a[108:111], v[124:127]
    buffer_load_dwordx4 v33, s[16:19], s50 offen offset:1024 lds
    s_waitcnt lgkmcnt(15)
    v_mfma_f32_16x16x32_bf16 v[80:83], a[192:195], a[36:39], v[80:83]
    ds_read_b64_tr_b16 a[240:241], v14 offset:6208
    v_mul_f32 v177, v177, v225
    v_mfma_f32_16x16x32_bf16 v[84:87], a[192:195], a[108:111], v[84:87]
    ds_read_b64_tr_b16 a[242:243], v14 offset:9280
    v_add_f32 v41, 1.0, v41
    v_mfma_f32_16x16x32_bf16 v[128:131], a[196:199], a[36:39], v[128:131]
    ds_read_b64_tr_b16 a[244:245], v14 offset:24640
    ds_read_b64_tr_b16 a[246:247], v14 offset:27712
    v_mfma_f32_16x16x32_bf16 v[132:135], a[196:199], a[108:111], v[132:135]
    buffer_load_dwordx4 v34, s[16:19], s50 offen offset:2048 lds
    v_mfma_f32_16x16x32_bf16 v[88:91], a[200:203], a[36:39], v[88:91]
    ds_read_b64_tr_b16 a[248:249], v15 offset:6208
    ds_read_b64_tr_b16 a[250:251], v15 offset:9280
    v_mfma_f32_16x16x32_bf16 v[92:95], a[200:203], a[108:111], v[92:95]
    v_exp_f32 v42, v178
    v_mfma_f32_16x16x32_bf16 v[136:139], a[204:207], a[36:39], v[136:139]
    ds_read_b64_tr_b16 a[252:253], v15 offset:24640
    v_mul_f32 v178, v178, v226
    v_mfma_f32_16x16x32_bf16 v[140:143], a[204:207], a[108:111], v[140:143]
    ds_read_b64_tr_b16 a[254:255], v15 offset:27712
    s_waitcnt lgkmcnt(15)
    v_mfma_f32_16x16x32_bf16 v[96:99], a[208:211], a[36:39], v[96:99]
    ds_read_b64_tr_b16 a[192:193], v14 offset:6272
    ds_read_b64_tr_b16 a[194:195], v14 offset:9344
    v_mfma_f32_16x16x32_bf16 v[100:103], a[208:211], a[108:111], v[100:103]
    v_exp_f32 v43, v179
    v_mfma_f32_16x16x32_bf16 v[144:147], a[212:215], a[36:39], v[144:147]
    ds_read_b64_tr_b16 a[196:197], v14 offset:24704
    v_mul_f32 v179, v179, v227
    v_mfma_f32_16x16x32_bf16 v[148:151], a[212:215], a[108:111], v[148:151]
    ds_read_b64_tr_b16 a[198:199], v14 offset:27776
    v_add_f32 v42, 1.0, v42
    v_mfma_f32_16x16x32_bf16 v[104:107], a[216:219], a[36:39], v[104:107]
    ds_read_b64_tr_b16 a[200:201], v15 offset:6272
    ds_read_b64_tr_b16 a[202:203], v15 offset:9344
    v_mfma_f32_16x16x32_bf16 v[108:111], a[216:219], a[108:111], v[108:111]
    v_exp_f32 v44, v184
    v_mfma_f32_16x16x32_bf16 v[152:155], a[220:223], a[36:39], v[152:155]
    ds_read_b64_tr_b16 a[204:205], v15 offset:24704
    v_mul_f32 v184, v184, v232
    v_mfma_f32_16x16x32_bf16 v[156:159], a[220:223], a[108:111], v[156:159]
    ds_read_b64_tr_b16 a[206:207], v15 offset:27776
    s_waitcnt lgkmcnt(15)
    v_mfma_f32_16x16x32_bf16 v[64:67], a[224:227], a[40:43], v[64:67]
    ds_read_b64_tr_b16 a[208:209], v14 offset:12288
    ds_read_b64_tr_b16 a[210:211], v14 offset:15360
    v_mfma_f32_16x16x32_bf16 v[68:71], a[224:227], a[112:115], v[68:71]
    v_exp_f32 v45, v185
    v_mfma_f32_16x16x32_bf16 v[112:115], a[228:231], a[40:43], v[112:115]
    ds_read_b64_tr_b16 a[212:213], v14 offset:30720
    v_mul_f32 v185, v185, v233
    v_mfma_f32_16x16x32_bf16 v[116:119], a[228:231], a[112:115], v[116:119]
    ds_read_b64_tr_b16 a[214:215], v14 offset:33792
    v_add_f32 v43, 1.0, v43
    v_mfma_f32_16x16x32_bf16 v[72:75], a[232:235], a[40:43], v[72:75]
    ds_read_b64_tr_b16 a[216:217], v15 offset:12288
    ds_read_b64_tr_b16 a[218:219], v15 offset:15360
    v_mfma_f32_16x16x32_bf16 v[76:79], a[232:235], a[112:115], v[76:79]
    v_exp_f32 v46, v186
    v_mfma_f32_16x16x32_bf16 v[120:123], a[236:239], a[40:43], v[120:123]
    ds_read_b64_tr_b16 a[220:221], v15 offset:30720
    v_mul_f32 v186, v186, v234
    v_mfma_f32_16x16x32_bf16 v[124:127], a[236:239], a[112:115], v[124:127]
    ds_read_b64_tr_b16 a[222:223], v15 offset:33792
    s_waitcnt lgkmcnt(15)
    v_mfma_f32_16x16x32_bf16 v[80:83], a[240:243], a[40:43], v[80:83]
    ds_read_b64_tr_b16 a[224:225], v14 offset:12352
    ds_read_b64_tr_b16 a[226:227], v14 offset:15424
    v_mfma_f32_16x16x32_bf16 v[84:87], a[240:243], a[112:115], v[84:87]
    v_exp_f32 v47, v187
    v_mfma_f32_16x16x32_bf16 v[128:131], a[244:247], a[40:43], v[128:131]
    ds_read_b64_tr_b16 a[228:229], v14 offset:30784
    v_mul_f32 v187, v187, v235
    v_mfma_f32_16x16x32_bf16 v[132:135], a[244:247], a[112:115], v[132:135]
    ds_read_b64_tr_b16 a[230:231], v14 offset:33856
    v_add_f32 v44, 1.0, v44
    v_mfma_f32_16x16x32_bf16 v[88:91], a[248:251], a[40:43], v[88:91]
    ds_read_b64_tr_b16 a[232:233], v15 offset:12352
    v_add_f32 v45, 1.0, v45
    v_mfma_f32_16x16x32_bf16 v[92:95], a[248:251], a[112:115], v[92:95]
    ds_read_b64_tr_b16 a[234:235], v15 offset:15424
    v_add_f32 v46, 1.0, v46
    v_mfma_f32_16x16x32_bf16 v[136:139], a[252:255], a[40:43], v[136:139]
    ds_read_b64_tr_b16 a[236:237], v15 offset:30784
    v_add_f32 v47, 1.0, v47
    v_mfma_f32_16x16x32_bf16 v[140:143], a[252:255], a[112:115], v[140:143]
    ds_read_b64_tr_b16 a[238:239], v15 offset:33856
    s_waitcnt lgkmcnt(15)
    v_mfma_f32_16x16x32_bf16 v[96:99], a[192:195], a[40:43], v[96:99]
    ds_read_b64_tr_b16 a[240:241], v14 offset:12416
    ds_read_b64_tr_b16 a[242:243], v14 offset:15488
    v_mfma_f32_16x16x32_bf16 v[100:103], a[192:195], a[112:115], v[100:103]
    v_rcp_f32 v40, v40
    v_mfma_f32_16x16x32_bf16 v[144:147], a[196:199], a[40:43], v[144:147]
    ds_read_b64_tr_b16 a[244:245], v14 offset:30848
    ds_read_b64_tr_b16 a[246:247], v14 offset:33920
    v_mfma_f32_16x16x32_bf16 v[148:151], a[196:199], a[112:115], v[148:151]
    v_rcp_f32 v41, v41
    v_mfma_f32_16x16x32_bf16 v[104:107], a[200:203], a[40:43], v[104:107]
    ds_read_b64_tr_b16 a[248:249], v15 offset:12416
    ds_read_b64_tr_b16 a[250:251], v15 offset:15488
    v_mfma_f32_16x16x32_bf16 v[108:111], a[200:203], a[112:115], v[108:111]
    v_rcp_f32 v42, v42
    v_mfma_f32_16x16x32_bf16 v[152:155], a[204:207], a[40:43], v[152:155]
    ds_read_b64_tr_b16 a[252:253], v15 offset:30848
    v_mul_f32 v176, v176, v40
    v_mfma_f32_16x16x32_bf16 v[156:159], a[204:207], a[112:115], v[156:159]
    s_add_u32 m0, s47, 73728
    ds_read_b64_tr_b16 a[254:255], v15 offset:33920
    s_waitcnt vmcnt(9)
    s_barrier
    s_waitcnt lgkmcnt(15)
    v_mfma_f32_16x16x32_bf16 v[64:67], a[208:211], a[44:47], v[64:67]
    ds_read_b64_tr_b16 a[192:193], v8 offset:0
    v_mul_f32 v177, v177, v41
    v_mfma_f32_16x16x32_bf16 v[68:71], a[208:211], a[116:119], v[68:71]
    s_mov_b32 s50, 0
    ds_read_b64_tr_b16 a[194:195], v8 offset:3072
    v_mfma_f32_16x16x32_bf16 v[112:115], a[212:215], a[44:47], v[112:115]
    ds_read_b64_tr_b16 a[196:197], v8 offset:18432
    ds_read_b64_tr_b16 a[198:199], v8 offset:21504
    v_mfma_f32_16x16x32_bf16 v[116:119], a[212:215], a[116:119], v[116:119]
    buffer_load_dwordx4 v35, s[20:23], s50 offen offset:0 lds
    v_mfma_f32_16x16x32_bf16 v[72:75], a[216:219], a[44:47], v[72:75]
    ds_read_b64_tr_b16 a[200:201], v9 offset:0
    ds_read_b64_tr_b16 a[202:203], v9 offset:3072
    v_mfma_f32_16x16x32_bf16 v[76:79], a[216:219], a[116:119], v[76:79]
    v_rcp_f32 v43, v43
    v_mfma_f32_16x16x32_bf16 v[120:123], a[220:223], a[44:47], v[120:123]
    ds_read_b64_tr_b16 a[204:205], v9 offset:18432
    ds_read_b64_tr_b16 a[206:207], v9 offset:21504
    v_mfma_f32_16x16x32_bf16 v[124:127], a[220:223], a[116:119], v[124:127]
    buffer_load_dwordx4 v36, s[20:23], s50 offen offset:1024 lds
    s_waitcnt lgkmcnt(15)
    v_mfma_f32_16x16x32_bf16 v[80:83], a[224:227], a[44:47], v[80:83]
    ds_read_b64_tr_b16 a[208:209], v8 offset:64
    ds_read_b64_tr_b16 a[210:211], v8 offset:3136
    v_mfma_f32_16x16x32_bf16 v[84:87], a[224:227], a[116:119], v[84:87]
    v_rcp_f32 v44, v44
    v_mfma_f32_16x16x32_bf16 v[128:131], a[228:231], a[44:47], v[128:131]
    ds_read_b64_tr_b16 a[212:213], v8 offset:18496
    ds_read_b64_tr_b16 a[214:215], v8 offset:21568
    v_mfma_f32_16x16x32_bf16 v[132:135], a[228:231], a[116:119], v[132:135]
    buffer_load_dwordx4 v37, s[20:23], s50 offen offset:2048 lds
    s_add_u32 m0, s47, 76800
    v_mfma_f32_16x16x32_bf16 v[88:91], a[232:235], a[44:47], v[88:91]
    ds_read_b64_tr_b16 a[216:217], v9 offset:64
    v_mul_f32 v178, v178, v42
    v_mfma_f32_16x16x32_bf16 v[92:95], a[232:235], a[116:119], v[92:95]
    s_mov_b32 s50, 27648
    ds_read_b64_tr_b16 a[218:219], v9 offset:3136
    v_mfma_f32_16x16x32_bf16 v[136:139], a[236:239], a[44:47], v[136:139]
    ds_read_b64_tr_b16 a[220:221], v9 offset:18496
    ds_read_b64_tr_b16 a[222:223], v9 offset:21568
    v_mfma_f32_16x16x32_bf16 v[140:143], a[236:239], a[116:119], v[140:143]
    buffer_load_dwordx4 v35, s[20:23], s50 offen offset:0 lds
    s_waitcnt lgkmcnt(15)
    v_mfma_f32_16x16x32_bf16 v[96:99], a[240:243], a[44:47], v[96:99]
    ds_read_b64_tr_b16 a[224:225], v8 offset:128
    ds_read_b64_tr_b16 a[226:227], v8 offset:3200
    v_mfma_f32_16x16x32_bf16 v[100:103], a[240:243], a[116:119], v[100:103]
    v_rcp_f32 v45, v45
    v_mfma_f32_16x16x32_bf16 v[144:147], a[244:247], a[44:47], v[144:147]
    ds_read_b64_tr_b16 a[228:229], v8 offset:18560
    ds_read_b64_tr_b16 a[230:231], v8 offset:21632
    v_mfma_f32_16x16x32_bf16 v[148:151], a[244:247], a[116:119], v[148:151]
    buffer_load_dwordx4 v36, s[20:23], s50 offen offset:1024 lds
    v_mfma_f32_16x16x32_bf16 v[104:107], a[248:251], a[44:47], v[104:107]
    ds_read_b64_tr_b16 a[232:233], v9 offset:128
    ds_read_b64_tr_b16 a[234:235], v9 offset:3200
    v_mfma_f32_16x16x32_bf16 v[108:111], a[248:251], a[116:119], v[108:111]
    v_rcp_f32 v46, v46
    v_mfma_f32_16x16x32_bf16 v[152:155], a[252:255], a[44:47], v[152:155]
    ds_read_b64_tr_b16 a[236:237], v9 offset:18560
    ds_read_b64_tr_b16 a[238:239], v9 offset:21632
    v_mfma_f32_16x16x32_bf16 v[156:159], a[252:255], a[116:119], v[156:159]
    buffer_load_dwordx4 v37, s[20:23], s50 offen offset:2048 lds
    s_add_u32 m0, s47, 79872
    s_waitcnt lgkmcnt(15)
    v_mfma_f32_16x16x32_bf16 v[64:67], a[192:195], a[48:51], v[64:67]
    ds_read_b64_tr_b16 a[240:241], v8 offset:6144
    v_mul_f32 v179, v179, v43
    v_mfma_f32_16x16x32_bf16 v[68:71], a[192:195], a[120:123], v[68:71]
    s_mov_b32 s50, 55296
    ds_read_b64_tr_b16 a[242:243], v8 offset:9216
    v_mfma_f32_16x16x32_bf16 v[112:115], a[196:199], a[48:51], v[112:115]
    ds_read_b64_tr_b16 a[244:245], v8 offset:24576
    ds_read_b64_tr_b16 a[246:247], v8 offset:27648
    v_mfma_f32_16x16x32_bf16 v[116:119], a[196:199], a[120:123], v[116:119]
    buffer_load_dwordx4 v35, s[20:23], s50 offen offset:0 lds
    v_mfma_f32_16x16x32_bf16 v[72:75], a[200:203], a[48:51], v[72:75]
    ds_read_b64_tr_b16 a[248:249], v9 offset:6144
    ds_read_b64_tr_b16 a[250:251], v9 offset:9216
    v_mfma_f32_16x16x32_bf16 v[76:79], a[200:203], a[120:123], v[76:79]
    v_rcp_f32 v47, v47
    v_mfma_f32_16x16x32_bf16 v[120:123], a[204:207], a[48:51], v[120:123]
    ds_read_b64_tr_b16 a[252:253], v9 offset:24576
    ds_read_b64_tr_b16 a[254:255], v9 offset:27648
    v_mfma_f32_16x16x32_bf16 v[124:127], a[204:207], a[120:123], v[124:127]
    buffer_load_dwordx4 v36, s[20:23], s50 offen offset:1024 lds
    s_waitcnt lgkmcnt(15)
    v_mfma_f32_16x16x32_bf16 v[80:83], a[208:211], a[48:51], v[80:83]
    ds_read_b64_tr_b16 a[192:193], v8 offset:6208
    v_mul_f32 v184, v184, v44
    v_mfma_f32_16x16x32_bf16 v[84:87], a[208:211], a[120:123], v[84:87]
    ds_read_b64_tr_b16 a[194:195], v8 offset:9280
    v_mul_f32 v185, v185, v45
    v_mfma_f32_16x16x32_bf16 v[128:131], a[212:215], a[48:51], v[128:131]
    ds_read_b64_tr_b16 a[196:197], v8 offset:24640
    ds_read_b64_tr_b16 a[198:199], v8 offset:27712
    v_mfma_f32_16x16x32_bf16 v[132:135], a[212:215], a[120:123], v[132:135]
    buffer_load_dwordx4 v37, s[20:23], s50 offen offset:2048 lds
    v_mfma_f32_16x16x32_bf16 v[88:91], a[216:219], a[48:51], v[88:91]
    ds_read_b64_tr_b16 a[200:201], v9 offset:6208
    v_mul_f32 v186, v186, v46
    v_mfma_f32_16x16x32_bf16 v[92:95], a[216:219], a[120:123], v[92:95]
    ds_read_b64_tr_b16 a[202:203], v9 offset:9280
    v_mul_f32 v187, v187, v47
    v_mfma_f32_16x16x32_bf16 v[136:139], a[220:223], a[48:51], v[136:139]
    ds_read_b64_tr_b16 a[204:205], v9 offset:24640
    v_cvt_pk_bf16_f32 v56, v176, v177
    v_mfma_f32_16x16x32_bf16 v[140:143], a[220:223], a[120:123], v[140:143]
    ds_read_b64_tr_b16 a[206:207], v9 offset:27712
    s_waitcnt lgkmcnt(15)
    v_mfma_f32_16x16x32_bf16 v[96:99], a[224:227], a[48:51], v[96:99]
    ds_read_b64_tr_b16 a[208:209], v8 offset:6272
    v_cvt_pk_bf16_f32 v57, v178, v179
    v_mfma_f32_16x16x32_bf16 v[100:103], a[224:227], a[120:123], v[100:103]
    ds_read_b64_tr_b16 a[210:211], v8 offset:9344
    v_cvt_pk_bf16_f32 v58, v184, v185
    v_mfma_f32_16x16x32_bf16 v[144:147], a[228:231], a[48:51], v[144:147]
    ds_read_b64_tr_b16 a[212:213], v8 offset:24704
    v_cvt_pk_bf16_f32 v59, v186, v187
    v_mfma_f32_16x16x32_bf16 v[148:151], a[228:231], a[120:123], v[148:151]
    ds_read_b64_tr_b16 a[214:215], v8 offset:27776
    v_accvgpr_write_b32 a176, v56
    v_mfma_f32_16x16x32_bf16 v[104:107], a[232:235], a[48:51], v[104:107]
    ds_read_b64_tr_b16 a[216:217], v9 offset:6272
    v_accvgpr_write_b32 a177, v57
    v_mfma_f32_16x16x32_bf16 v[108:111], a[232:235], a[120:123], v[108:111]
    ds_read_b64_tr_b16 a[218:219], v9 offset:9344
    v_accvgpr_write_b32 a178, v58
    v_mfma_f32_16x16x32_bf16 v[152:155], a[236:239], a[48:51], v[152:155]
    ds_read_b64_tr_b16 a[220:221], v9 offset:24704
    v_accvgpr_write_b32 a179, v59
    v_mfma_f32_16x16x32_bf16 v[156:159], a[236:239], a[120:123], v[156:159]
    ds_read_b64_tr_b16 a[222:223], v9 offset:27776
    s_waitcnt lgkmcnt(15)
    v_mfma_f32_16x16x32_bf16 v[64:67], a[240:243], a[52:55], v[64:67]
    ds_read_b64_tr_b16 a[224:225], v8 offset:12288
    ds_read_b64_tr_b16 a[226:227], v8 offset:15360
    v_mfma_f32_16x16x32_bf16 v[68:71], a[240:243], a[124:127], v[68:71]
    v_exp_f32 v48, v180
    v_mfma_f32_16x16x32_bf16 v[112:115], a[244:247], a[52:55], v[112:115]
    ds_read_b64_tr_b16 a[228:229], v8 offset:30720
    v_mul_f32 v180, v180, v228
    v_mfma_f32_16x16x32_bf16 v[116:119], a[244:247], a[124:127], v[116:119]
    ds_read_b64_tr_b16 a[230:231], v8 offset:33792
    v_add_f32 v48, 1.0, v48
    v_mfma_f32_16x16x32_bf16 v[72:75], a[248:251], a[52:55], v[72:75]
    ds_read_b64_tr_b16 a[232:233], v9 offset:12288
    ds_read_b64_tr_b16 a[234:235], v9 offset:15360
    v_mfma_f32_16x16x32_bf16 v[76:79], a[248:251], a[124:127], v[76:79]
    v_exp_f32 v49, v181
    v_mfma_f32_16x16x32_bf16 v[120:123], a[252:255], a[52:55], v[120:123]
    ds_read_b64_tr_b16 a[236:237], v9 offset:30720
    v_mul_f32 v181, v181, v229
    v_mfma_f32_16x16x32_bf16 v[124:127], a[252:255], a[124:127], v[124:127]
    ds_read_b64_tr_b16 a[238:239], v9 offset:33792
    s_waitcnt lgkmcnt(15)
    v_mfma_f32_16x16x32_bf16 v[80:83], a[192:195], a[52:55], v[80:83]
    ds_read_b64_tr_b16 a[240:241], v8 offset:12352
    ds_read_b64_tr_b16 a[242:243], v8 offset:15424
    v_mfma_f32_16x16x32_bf16 v[84:87], a[192:195], a[124:127], v[84:87]
    v_exp_f32 v50, v182
    v_mfma_f32_16x16x32_bf16 v[128:131], a[196:199], a[52:55], v[128:131]
    ds_read_b64_tr_b16 a[244:245], v8 offset:30784
    v_mul_f32 v182, v182, v230
    v_mfma_f32_16x16x32_bf16 v[132:135], a[196:199], a[124:127], v[132:135]
    ds_read_b64_tr_b16 a[246:247], v8 offset:33856
    v_add_f32 v49, 1.0, v49
    v_mfma_f32_16x16x32_bf16 v[88:91], a[200:203], a[52:55], v[88:91]
    ds_read_b64_tr_b16 a[248:249], v9 offset:12352
    ds_read_b64_tr_b16 a[250:251], v9 offset:15424
    v_mfma_f32_16x16x32_bf16 v[92:95], a[200:203], a[124:127], v[92:95]
    v_exp_f32 v51, v183
    v_mfma_f32_16x16x32_bf16 v[136:139], a[204:207], a[52:55], v[136:139]
    ds_read_b64_tr_b16 a[252:253], v9 offset:30784
    v_mul_f32 v183, v183, v231
    v_mfma_f32_16x16x32_bf16 v[140:143], a[204:207], a[124:127], v[140:143]
    ds_read_b64_tr_b16 a[254:255], v9 offset:33856
    s_waitcnt lgkmcnt(15)
    v_mfma_f32_16x16x32_bf16 v[96:99], a[208:211], a[52:55], v[96:99]
    ds_read_b64_tr_b16 a[192:193], v8 offset:12416
    ds_read_b64_tr_b16 a[194:195], v8 offset:15488
    v_mfma_f32_16x16x32_bf16 v[100:103], a[208:211], a[124:127], v[100:103]
    v_exp_f32 v52, v188
    v_mfma_f32_16x16x32_bf16 v[144:147], a[212:215], a[52:55], v[144:147]
    ds_read_b64_tr_b16 a[196:197], v8 offset:30848
    v_mul_f32 v188, v188, v236
    v_mfma_f32_16x16x32_bf16 v[148:151], a[212:215], a[124:127], v[148:151]
    ds_read_b64_tr_b16 a[198:199], v8 offset:33920
    v_add_f32 v50, 1.0, v50
    v_mfma_f32_16x16x32_bf16 v[104:107], a[216:219], a[52:55], v[104:107]
    ds_read_b64_tr_b16 a[200:201], v9 offset:12416
    ds_read_b64_tr_b16 a[202:203], v9 offset:15488
    v_mfma_f32_16x16x32_bf16 v[108:111], a[216:219], a[124:127], v[108:111]
    v_exp_f32 v53, v189
    v_mfma_f32_16x16x32_bf16 v[152:155], a[220:223], a[52:55], v[152:155]
    ds_read_b64_tr_b16 a[204:205], v9 offset:30848
    v_mul_f32 v189, v189, v237
    v_mfma_f32_16x16x32_bf16 v[156:159], a[220:223], a[124:127], v[156:159]
    s_add_u32 m0, s47, 110592
    ds_read_b64_tr_b16 a[206:207], v9 offset:33920
    s_waitcnt vmcnt(9)
    s_barrier
    s_waitcnt lgkmcnt(15)
    v_mfma_f32_16x16x32_bf16 v[64:67], a[224:227], a[56:59], v[64:67]
    ds_read_b64_tr_b16 a[208:209], v10 offset:0
    v_add_f32 v51, 1.0, v51
    v_mfma_f32_16x16x32_bf16 v[68:71], a[224:227], a[128:131], v[68:71]
    s_mov_b32 s50, 128
    ds_read_b64_tr_b16 a[210:211], v10 offset:3072
    v_mfma_f32_16x16x32_bf16 v[112:115], a[228:231], a[56:59], v[112:115]
    ds_read_b64_tr_b16 a[212:213], v10 offset:18432
    ds_read_b64_tr_b16 a[214:215], v10 offset:21504
    v_mfma_f32_16x16x32_bf16 v[116:119], a[228:231], a[128:131], v[116:119]
    buffer_load_dwordx4 v35, s[20:23], s50 offen offset:0 lds
    v_mfma_f32_16x16x32_bf16 v[72:75], a[232:235], a[56:59], v[72:75]
    ds_read_b64_tr_b16 a[216:217], v11 offset:0
    ds_read_b64_tr_b16 a[218:219], v11 offset:3072
    v_mfma_f32_16x16x32_bf16 v[76:79], a[232:235], a[128:131], v[76:79]
    v_exp_f32 v54, v190
    v_mfma_f32_16x16x32_bf16 v[120:123], a[236:239], a[56:59], v[120:123]
    ds_read_b64_tr_b16 a[220:221], v11 offset:18432
    ds_read_b64_tr_b16 a[222:223], v11 offset:21504
    v_mfma_f32_16x16x32_bf16 v[124:127], a[236:239], a[128:131], v[124:127]
    buffer_load_dwordx4 v36, s[20:23], s50 offen offset:1024 lds
    s_waitcnt lgkmcnt(15)
    v_mfma_f32_16x16x32_bf16 v[80:83], a[240:243], a[56:59], v[80:83]
    ds_read_b64_tr_b16 a[224:225], v10 offset:64
    v_mul_f32 v190, v190, v238
    v_mfma_f32_16x16x32_bf16 v[84:87], a[240:243], a[128:131], v[84:87]
    ds_read_b64_tr_b16 a[226:227], v10 offset:3136
    v_add_f32 v52, 1.0, v52
    v_mfma_f32_16x16x32_bf16 v[128:131], a[244:247], a[56:59], v[128:131]
    ds_read_b64_tr_b16 a[228:229], v10 offset:18496
    ds_read_b64_tr_b16 a[230:231], v10 offset:21568
    v_mfma_f32_16x16x32_bf16 v[132:135], a[244:247], a[128:131], v[132:135]
    buffer_load_dwordx4 v37, s[20:23], s50 offen offset:2048 lds
    s_add_u32 m0, s47, 113664
    v_mfma_f32_16x16x32_bf16 v[88:91], a[248:251], a[56:59], v[88:91]
    ds_read_b64_tr_b16 a[232:233], v11 offset:64
    v_add_f32 v53, 1.0, v53
    v_mfma_f32_16x16x32_bf16 v[92:95], a[248:251], a[128:131], v[92:95]
    s_mov_b32 s50, 27776
    ds_read_b64_tr_b16 a[234:235], v11 offset:3136
    v_mfma_f32_16x16x32_bf16 v[136:139], a[252:255], a[56:59], v[136:139]
    ds_read_b64_tr_b16 a[236:237], v11 offset:18496
    ds_read_b64_tr_b16 a[238:239], v11 offset:21568
    v_mfma_f32_16x16x32_bf16 v[140:143], a[252:255], a[128:131], v[140:143]
    buffer_load_dwordx4 v35, s[20:23], s50 offen offset:0 lds
    s_waitcnt lgkmcnt(15)
    v_mfma_f32_16x16x32_bf16 v[96:99], a[192:195], a[56:59], v[96:99]
    ds_read_b64_tr_b16 a[240:241], v10 offset:128
    ds_read_b64_tr_b16 a[242:243], v10 offset:3200
    v_mfma_f32_16x16x32_bf16 v[100:103], a[192:195], a[128:131], v[100:103]
    v_exp_f32 v55, v191
    v_mfma_f32_16x16x32_bf16 v[144:147], a[196:199], a[56:59], v[144:147]
    ds_read_b64_tr_b16 a[244:245], v10 offset:18560
    ds_read_b64_tr_b16 a[246:247], v10 offset:21632
    v_mfma_f32_16x16x32_bf16 v[148:151], a[196:199], a[128:131], v[148:151]
    buffer_load_dwordx4 v36, s[20:23], s50 offen offset:1024 lds
    v_mfma_f32_16x16x32_bf16 v[104:107], a[200:203], a[56:59], v[104:107]
    ds_read_b64_tr_b16 a[248:249], v11 offset:128
    v_mul_f32 v191, v191, v239
    v_mfma_f32_16x16x32_bf16 v[108:111], a[200:203], a[128:131], v[108:111]
    ds_read_b64_tr_b16 a[250:251], v11 offset:3200
    v_add_f32 v54, 1.0, v54
    v_mfma_f32_16x16x32_bf16 v[152:155], a[204:207], a[56:59], v[152:155]
    ds_read_b64_tr_b16 a[252:253], v11 offset:18560
    ds_read_b64_tr_b16 a[254:255], v11 offset:21632
    v_mfma_f32_16x16x32_bf16 v[156:159], a[204:207], a[128:131], v[156:159]
    buffer_load_dwordx4 v37, s[20:23], s50 offen offset:2048 lds
    s_add_u32 m0, s47, 116736
    s_waitcnt lgkmcnt(15)
    v_mfma_f32_16x16x32_bf16 v[64:67], a[208:211], a[60:63], v[64:67]
    ds_read_b64_tr_b16 a[192:193], v10 offset:6144
    v_add_f32 v55, 1.0, v55
    v_mfma_f32_16x16x32_bf16 v[68:71], a[208:211], a[132:135], v[68:71]
    s_mov_b32 s50, 55424
    ds_read_b64_tr_b16 a[194:195], v10 offset:9216
    v_mfma_f32_16x16x32_bf16 v[112:115], a[212:215], a[60:63], v[112:115]
    ds_read_b64_tr_b16 a[196:197], v10 offset:24576
    ds_read_b64_tr_b16 a[198:199], v10 offset:27648
    v_mfma_f32_16x16x32_bf16 v[116:119], a[212:215], a[132:135], v[116:119]
    buffer_load_dwordx4 v35, s[20:23], s50 offen offset:0 lds
    v_mfma_f32_16x16x32_bf16 v[72:75], a[216:219], a[60:63], v[72:75]
    ds_read_b64_tr_b16 a[200:201], v11 offset:6144
    ds_read_b64_tr_b16 a[202:203], v11 offset:9216
    v_mfma_f32_16x16x32_bf16 v[76:79], a[216:219], a[132:135], v[76:79]
    v_rcp_f32 v48, v48
    v_mfma_f32_16x16x32_bf16 v[120:123], a[220:223], a[60:63], v[120:123]
    ds_read_b64_tr_b16 a[204:205], v11 offset:24576
    ds_read_b64_tr_b16 a[206:207], v11 offset:27648
    v_mfma_f32_16x16x32_bf16 v[124:127], a[220:223], a[132:135], v[124:127]
    buffer_load_dwordx4 v36, s[20:23], s50 offen offset:1024 lds
    s_waitcnt lgkmcnt(15)
    v_mfma_f32_16x16x32_bf16 v[80:83], a[224:227], a[60:63], v[80:83]
    ds_read_b64_tr_b16 a[208:209], v10 offset:6208
    ds_read_b64_tr_b16 a[210:211], v10 offset:9280
    v_mfma_f32_16x16x32_bf16 v[84:87], a[224:227], a[132:135], v[84:87]
    v_rcp_f32 v49, v49
    v_mfma_f32_16x16x32_bf16 v[128:131], a[228:231], a[60:63], v[128:131]
    ds_read_b64_tr_b16 a[212:213], v10 offset:24640
    ds_read_b64_tr_b16 a[214:215], v10 offset:27712
    v_mfma_f32_16x16x32_bf16 v[132:135], a[228:231], a[132:135], v[132:135]
    buffer_load_dwordx4 v37, s[20:23], s50 offen offset:2048 lds
    v_mfma_f32_16x16x32_bf16 v[88:91], a[232:235], a[60:63], v[88:91]
    ds_read_b64_tr_b16 a[216:217], v11 offset:6208
    ds_read_b64_tr_b16 a[218:219], v11 offset:9280
    v_mfma_f32_16x16x32_bf16 v[92:95], a[232:235], a[132:135], v[92:95]
    v_rcp_f32 v50, v50
    v_mfma_f32_16x16x32_bf16 v[136:139], a[236:239], a[60:63], v[136:139]
    ds_read_b64_tr_b16 a[220:221], v11 offset:24640
    ds_read_b64_tr_b16 a[222:223], v11 offset:27712
    v_mfma_f32_16x16x32_bf16 v[140:143], a[236:239], a[132:135], v[140:143]
    v_mul_f32 v180, v180, v48
    s_waitcnt lgkmcnt(15)
    v_mfma_f32_16x16x32_bf16 v[96:99], a[240:243], a[60:63], v[96:99]
    ds_read_b64_tr_b16 a[224:225], v10 offset:6272
    ds_read_b64_tr_b16 a[226:227], v10 offset:9344
    v_mfma_f32_16x16x32_bf16 v[100:103], a[240:243], a[132:135], v[100:103]
    v_rcp_f32 v51, v51
    v_mfma_f32_16x16x32_bf16 v[144:147], a[244:247], a[60:63], v[144:147]
    ds_read_b64_tr_b16 a[228:229], v10 offset:24704
    ds_read_b64_tr_b16 a[230:231], v10 offset:27776
    v_mfma_f32_16x16x32_bf16 v[148:151], a[244:247], a[132:135], v[148:151]
    v_rcp_f32 v52, v52
    v_mfma_f32_16x16x32_bf16 v[104:107], a[248:251], a[60:63], v[104:107]
    ds_read_b64_tr_b16 a[232:233], v11 offset:6272
    ds_read_b64_tr_b16 a[234:235], v11 offset:9344
    v_mfma_f32_16x16x32_bf16 v[108:111], a[248:251], a[132:135], v[108:111]
    v_rcp_f32 v53, v53
    v_mfma_f32_16x16x32_bf16 v[152:155], a[252:255], a[60:63], v[152:155]
    ds_read_b64_tr_b16 a[236:237], v11 offset:24704
    ds_read_b64_tr_b16 a[238:239], v11 offset:27776
    v_mfma_f32_16x16x32_bf16 v[156:159], a[252:255], a[132:135], v[156:159]
    v_mul_f32 v181, v181, v49
    s_waitcnt lgkmcnt(15)
    v_mfma_f32_16x16x32_bf16 v[64:67], a[192:195], a[64:67], v[64:67]
    ds_read_b64_tr_b16 a[240:241], v10 offset:12288
    ds_read_b64_tr_b16 a[242:243], v10 offset:15360
    v_mfma_f32_16x16x32_bf16 v[68:71], a[192:195], a[136:139], v[68:71]
    v_rcp_f32 v54, v54
    v_mfma_f32_16x16x32_bf16 v[112:115], a[196:199], a[64:67], v[112:115]
    ds_read_b64_tr_b16 a[244:245], v10 offset:30720
    ds_read_b64_tr_b16 a[246:247], v10 offset:33792
    v_mfma_f32_16x16x32_bf16 v[116:119], a[196:199], a[136:139], v[116:119]
    v_rcp_f32 v55, v55
    v_mfma_f32_16x16x32_bf16 v[72:75], a[200:203], a[64:67], v[72:75]
    ds_read_b64_tr_b16 a[248:249], v11 offset:12288
    v_mul_f32 v182, v182, v50
    v_mfma_f32_16x16x32_bf16 v[76:79], a[200:203], a[136:139], v[76:79]
    ds_read_b64_tr_b16 a[250:251], v11 offset:15360
    v_mul_f32 v183, v183, v51
    v_mfma_f32_16x16x32_bf16 v[120:123], a[204:207], a[64:67], v[120:123]
    ds_read_b64_tr_b16 a[252:253], v11 offset:30720
    v_mul_f32 v188, v188, v52
    v_mfma_f32_16x16x32_bf16 v[124:127], a[204:207], a[136:139], v[124:127]
    ds_read_b64_tr_b16 a[254:255], v11 offset:33792
    s_waitcnt lgkmcnt(15)
    v_mfma_f32_16x16x32_bf16 v[80:83], a[208:211], a[64:67], v[80:83]
    ds_read_b64_tr_b16 a[192:193], v10 offset:12352
    v_mul_f32 v189, v189, v53
    v_mfma_f32_16x16x32_bf16 v[84:87], a[208:211], a[136:139], v[84:87]
    ds_read_b64_tr_b16 a[194:195], v10 offset:15424
    v_mul_f32 v190, v190, v54
    v_mfma_f32_16x16x32_bf16 v[128:131], a[212:215], a[64:67], v[128:131]
    ds_read_b64_tr_b16 a[196:197], v10 offset:30784
    v_mul_f32 v191, v191, v55
    v_mfma_f32_16x16x32_bf16 v[132:135], a[212:215], a[136:139], v[132:135]
    ds_read_b64_tr_b16 a[198:199], v10 offset:33856
    v_cvt_pk_bf16_f32 v56, v180, v181
    v_mfma_f32_16x16x32_bf16 v[88:91], a[216:219], a[64:67], v[88:91]
    ds_read_b64_tr_b16 a[200:201], v11 offset:12352
    v_cvt_pk_bf16_f32 v57, v182, v183
    v_mfma_f32_16x16x32_bf16 v[92:95], a[216:219], a[136:139], v[92:95]
    ds_read_b64_tr_b16 a[202:203], v11 offset:15424
    v_cvt_pk_bf16_f32 v58, v188, v189
    v_mfma_f32_16x16x32_bf16 v[136:139], a[220:223], a[64:67], v[136:139]
    ds_read_b64_tr_b16 a[204:205], v11 offset:30784
    v_cvt_pk_bf16_f32 v59, v190, v191
    v_accvgpr_write_b32 a180, v56
    v_accvgpr_write_b32 a181, v57
    v_accvgpr_write_b32 a182, v58
    v_accvgpr_write_b32 a183, v59
    v_exp_f32 v40, v192
    v_mul_f32 v192, v192, v240
    v_exp_f32 v41, v193
    v_mul_f32 v193, v193, v241
    v_exp_f32 v42, v194
    v_mul_f32 v194, v194, v242
    v_exp_f32 v43, v195
    v_mul_f32 v195, v195, v243
    v_exp_f32 v44, v200
    v_mul_f32 v200, v200, v248
    v_exp_f32 v45, v201
    v_mul_f32 v201, v201, v249
    v_exp_f32 v46, v202
    v_mul_f32 v202, v202, v250
    v_exp_f32 v47, v203
    v_mul_f32 v203, v203, v251
    v_add_f32 v40, 1.0, v40
    v_add_f32 v41, 1.0, v41
    v_add_f32 v42, 1.0, v42
    v_add_f32 v43, 1.0, v43
    v_add_f32 v44, 1.0, v44
    v_add_f32 v45, 1.0, v45
    v_add_f32 v46, 1.0, v46
    v_add_f32 v47, 1.0, v47
    v_rcp_f32 v40, v40
    v_rcp_f32 v41, v41
    v_rcp_f32 v42, v42
    v_rcp_f32 v43, v43
    v_rcp_f32 v44, v44
    v_rcp_f32 v45, v45
    v_rcp_f32 v46, v46
    v_rcp_f32 v47, v47
    v_mul_f32 v192, v192, v40
    v_mul_f32 v193, v193, v41
    v_mul_f32 v194, v194, v42
    v_mul_f32 v195, v195, v43
    v_mul_f32 v200, v200, v44
    v_mul_f32 v201, v201, v45
    v_mul_f32 v202, v202, v46
    v_mul_f32 v203, v203, v47
    v_cvt_pk_bf16_f32 v56, v192, v193
    v_cvt_pk_bf16_f32 v57, v194, v195
    v_cvt_pk_bf16_f32 v58, v200, v201
    v_cvt_pk_bf16_f32 v59, v202, v203
    v_accvgpr_write_b32 a184, v56
    v_accvgpr_write_b32 a185, v57
    v_accvgpr_write_b32 a186, v58
    v_accvgpr_write_b32 a187, v59
    v_exp_f32 v48, v196
    v_mul_f32 v196, v196, v244
    v_exp_f32 v49, v197
    v_mul_f32 v197, v197, v245
    v_exp_f32 v50, v198
    v_mul_f32 v198, v198, v246
    v_exp_f32 v51, v199
    v_mul_f32 v199, v199, v247
    v_exp_f32 v52, v204
    v_mul_f32 v204, v204, v252
    v_exp_f32 v53, v205
    v_mul_f32 v205, v205, v253
    v_exp_f32 v54, v206
    v_mul_f32 v206, v206, v254
    v_exp_f32 v55, v207
    v_mul_f32 v207, v207, v255
    v_add_f32 v48, 1.0, v48
    v_add_f32 v49, 1.0, v49
    v_add_f32 v50, 1.0, v50
    v_add_f32 v51, 1.0, v51
    v_add_f32 v52, 1.0, v52
    v_add_f32 v53, 1.0, v53
    v_add_f32 v54, 1.0, v54
    v_add_f32 v55, 1.0, v55
    v_rcp_f32 v48, v48
    v_rcp_f32 v49, v49
    v_rcp_f32 v50, v50
    v_rcp_f32 v51, v51
    v_rcp_f32 v52, v52
    v_rcp_f32 v53, v53
    v_rcp_f32 v54, v54
    v_rcp_f32 v55, v55
    v_mul_f32 v196, v196, v48
    v_mul_f32 v197, v197, v49
    v_mul_f32 v198, v198, v50
    v_mul_f32 v199, v199, v51
    v_mul_f32 v204, v204, v52
    v_mul_f32 v205, v205, v53
    v_mul_f32 v206, v206, v54
    v_mul_f32 v207, v207, v55
    v_cvt_pk_bf16_f32 v56, v196, v197
    v_cvt_pk_bf16_f32 v57, v198, v199
    v_cvt_pk_bf16_f32 v58, v204, v205
    v_cvt_pk_bf16_f32 v59, v206, v207
    v_accvgpr_write_b32 a188, v56
    v_accvgpr_write_b32 a189, v57
    v_accvgpr_write_b32 a190, v58
    v_accvgpr_write_b32 a191, v59
    v_mfma_f32_16x16x32_bf16 v[140:143], a[220:223], a[136:139], v[140:143]
    ds_read_b64_tr_b16 a[206:207], v11 offset:33856
    s_waitcnt lgkmcnt(15)
    v_mfma_f32_16x16x32_bf16 v[96:99], a[224:227], a[64:67], v[96:99]
    ds_read_b64_tr_b16 a[208:209], v10 offset:12416
    v_mfma_f32_16x16x32_bf16 v[100:103], a[224:227], a[136:139], v[100:103]
    ds_read_b64_tr_b16 a[210:211], v10 offset:15488
    v_mfma_f32_16x16x32_bf16 v[144:147], a[228:231], a[64:67], v[144:147]
    ds_read_b64_tr_b16 a[212:213], v10 offset:30848
    v_mfma_f32_16x16x32_bf16 v[148:151], a[228:231], a[136:139], v[148:151]
    ds_read_b64_tr_b16 a[214:215], v10 offset:33920
    v_mfma_f32_16x16x32_bf16 v[104:107], a[232:235], a[64:67], v[104:107]
    ds_read_b64_tr_b16 a[216:217], v11 offset:12416
    v_mfma_f32_16x16x32_bf16 v[108:111], a[232:235], a[136:139], v[108:111]
    ds_read_b64_tr_b16 a[218:219], v11 offset:15488
    v_mfma_f32_16x16x32_bf16 v[152:155], a[236:239], a[64:67], v[152:155]
    ds_read_b64_tr_b16 a[220:221], v11 offset:30848
    v_mfma_f32_16x16x32_bf16 v[156:159], a[236:239], a[136:139], v[156:159]
    s_add_u32 m0, s47, 0
    ds_read_b64_tr_b16 a[222:223], v11 offset:33920
    s_waitcnt vmcnt(9)
    s_barrier
    s_waitcnt lgkmcnt(15)
    v_mfma_f32_16x16x32_bf16 v[64:67], a[240:243], a[68:71], v[64:67]
    ds_read_b64_tr_b16 a[224:225], v24 offset:0
    v_mfma_f32_16x16x32_bf16 v[68:71], a[240:243], a[140:143], v[68:71]
    s_mov_b32 s50, 256
    ds_read_b64_tr_b16 a[226:227], v24 offset:2048
    v_mfma_f32_16x16x32_bf16 v[112:115], a[244:247], a[68:71], v[112:115]
    ds_read_b64_tr_b16 a[228:229], v25 offset:0
    ds_read_b64_tr_b16 a[230:231], v25 offset:2048
    v_mfma_f32_16x16x32_bf16 v[116:119], a[244:247], a[140:143], v[116:119]
    buffer_load_dwordx4 v35, s[20:23], s50 offen offset:0 lds
    v_mfma_f32_16x16x32_bf16 v[72:75], a[248:251], a[68:71], v[72:75]
    ds_read_b64_tr_b16 a[232:233], v26 offset:0
    v_mfma_f32_16x16x32_bf16 v[76:79], a[248:251], a[140:143], v[76:79]
    ds_read_b64_tr_b16 a[234:235], v26 offset:2048
    v_mfma_f32_16x16x32_bf16 v[120:123], a[252:255], a[68:71], v[120:123]
    ds_read_b64_tr_b16 a[236:237], v27 offset:0
    ds_read_b64_tr_b16 a[238:239], v27 offset:2048
    v_mfma_f32_16x16x32_bf16 v[124:127], a[252:255], a[140:143], v[124:127]
    buffer_load_dwordx4 v36, s[20:23], s50 offen offset:1024 lds
    s_waitcnt lgkmcnt(15)
    v_mfma_f32_16x16x32_bf16 v[80:83], a[192:195], a[68:71], v[80:83]
    ds_read_b64_tr_b16 a[240:241], v24 offset:4096
    v_mfma_f32_16x16x32_bf16 v[84:87], a[192:195], a[140:143], v[84:87]
    ds_read_b64_tr_b16 a[242:243], v24 offset:6144
    v_mfma_f32_16x16x32_bf16 v[128:131], a[196:199], a[68:71], v[128:131]
    ds_read_b64_tr_b16 a[244:245], v25 offset:4096
    ds_read_b64_tr_b16 a[246:247], v25 offset:6144
    v_mfma_f32_16x16x32_bf16 v[132:135], a[196:199], a[140:143], v[132:135]
    buffer_load_dwordx4 v37, s[20:23], s50 offen offset:2048 lds
    s_add_u32 m0, s47, 3072
    v_mfma_f32_16x16x32_bf16 v[88:91], a[200:203], a[68:71], v[88:91]
    ds_read_b64_tr_b16 a[248:249], v26 offset:4096
    v_mfma_f32_16x16x32_bf16 v[92:95], a[200:203], a[140:143], v[92:95]
    s_mov_b32 s50, 27904
    ds_read_b64_tr_b16 a[250:251], v26 offset:6144
    v_mfma_f32_16x16x32_bf16 v[136:139], a[204:207], a[68:71], v[136:139]
    ds_read_b64_tr_b16 a[252:253], v27 offset:4096
    ds_read_b64_tr_b16 a[254:255], v27 offset:6144
    v_mfma_f32_16x16x32_bf16 v[140:143], a[204:207], a[140:143], v[140:143]
    buffer_load_dwordx4 v35, s[20:23], s50 offen offset:0 lds
    s_waitcnt lgkmcnt(15)
    v_mfma_f32_16x16x32_bf16 v[96:99], a[208:211], a[68:71], v[96:99]
    ds_read_b64_tr_b16 a[192:193], v24 offset:8192
    v_mfma_f32_16x16x32_bf16 v[100:103], a[208:211], a[140:143], v[100:103]
    ds_read_b64_tr_b16 a[194:195], v24 offset:10240
    v_mfma_f32_16x16x32_bf16 v[144:147], a[212:215], a[68:71], v[144:147]
    ds_read_b64_tr_b16 a[196:197], v25 offset:8192
    ds_read_b64_tr_b16 a[198:199], v25 offset:10240
    v_mfma_f32_16x16x32_bf16 v[148:151], a[212:215], a[140:143], v[148:151]
    buffer_load_dwordx4 v36, s[20:23], s50 offen offset:1024 lds
    v_mfma_f32_16x16x32_bf16 v[104:107], a[216:219], a[68:71], v[104:107]
    ds_read_b64_tr_b16 a[200:201], v26 offset:8192
    v_mfma_f32_16x16x32_bf16 v[108:111], a[216:219], a[140:143], v[108:111]
    ds_read_b64_tr_b16 a[202:203], v26 offset:10240
    v_mfma_f32_16x16x32_bf16 v[152:155], a[220:223], a[68:71], v[152:155]
    ds_read_b64_tr_b16 a[204:205], v27 offset:8192
    ds_read_b64_tr_b16 a[206:207], v27 offset:10240
    v_mfma_f32_16x16x32_bf16 v[156:159], a[220:223], a[140:143], v[156:159]
    buffer_load_dwordx4 v37, s[20:23], s50 offen offset:2048 lds
    s_add_u32 m0, s47, 6144
    s_waitcnt lgkmcnt(15)
    v_mfma_f32_16x16x32_bf16 v[192:195], a[224:227], a[144:147], 0
    ds_read_b64_tr_b16 a[208:209], v24 offset:12288
    v_mfma_f32_16x16x32_bf16 v[208:211], a[224:227], a[148:151], 0
    s_mov_b32 s50, 55552
    ds_read_b64_tr_b16 a[210:211], v24 offset:14336
    v_mfma_f32_16x16x32_bf16 v[196:199], a[228:231], a[144:147], 0
    ds_read_b64_tr_b16 a[212:213], v25 offset:12288
    ds_read_b64_tr_b16 a[214:215], v25 offset:14336
    v_mfma_f32_16x16x32_bf16 v[212:215], a[228:231], a[148:151], 0
    buffer_load_dwordx4 v35, s[20:23], s50 offen offset:0 lds
    v_mfma_f32_16x16x32_bf16 v[200:203], a[232:235], a[144:147], 0
    ds_read_b64_tr_b16 a[216:217], v26 offset:12288
    ds_read_b64_tr_b16 a[218:219], v26 offset:14336
    v_mfma_f32_16x16x32_bf16 v[216:219], a[232:235], a[148:151], 0
    v_exp_f32 v40, v64
    v_mfma_f32_16x16x32_bf16 v[204:207], a[236:239], a[144:147], 0
    ds_read_b64_tr_b16 a[220:221], v27 offset:12288
    ds_read_b64_tr_b16 a[222:223], v27 offset:14336
    v_mfma_f32_16x16x32_bf16 v[220:223], a[236:239], a[148:151], 0
    buffer_load_dwordx4 v36, s[20:23], s50 offen offset:1024 lds
    s_waitcnt lgkmcnt(15)
    v_mfma_f32_16x16x32_bf16 v[192:195], a[240:243], a[152:155], v[192:195]
    ds_read_b64_tr_b16 a[224:225], v24 offset:16384
    v_mul_f32 v64, v64, v112
    v_mfma_f32_16x16x32_bf16 v[208:211], a[240:243], a[156:159], v[208:211]
    ds_read_b64_tr_b16 a[226:227], v24 offset:18432
    v_add_f32 v40, 1.0, v40
    v_mfma_f32_16x16x32_bf16 v[196:199], a[244:247], a[152:155], v[196:199]
    ds_read_b64_tr_b16 a[228:229], v25 offset:16384
    ds_read_b64_tr_b16 a[230:231], v25 offset:18432
    v_mfma_f32_16x16x32_bf16 v[212:215], a[244:247], a[156:159], v[212:215]
    buffer_load_dwordx4 v37, s[20:23], s50 offen offset:2048 lds
    v_mfma_f32_16x16x32_bf16 v[200:203], a[248:251], a[152:155], v[200:203]
    ds_read_b64_tr_b16 a[232:233], v26 offset:16384
    ds_read_b64_tr_b16 a[234:235], v26 offset:18432
    v_mfma_f32_16x16x32_bf16 v[216:219], a[248:251], a[156:159], v[216:219]
    v_exp_f32 v41, v65
    v_mfma_f32_16x16x32_bf16 v[204:207], a[252:255], a[152:155], v[204:207]
    ds_read_b64_tr_b16 a[236:237], v27 offset:16384
    v_mul_f32 v65, v65, v113
    v_mfma_f32_16x16x32_bf16 v[220:223], a[252:255], a[156:159], v[220:223]
    ds_read_b64_tr_b16 a[238:239], v27 offset:18432
    s_waitcnt lgkmcnt(15)
    v_mfma_f32_16x16x32_bf16 v[192:195], a[192:195], a[160:163], v[192:195]
    ds_read_b64_tr_b16 a[240:241], v24 offset:20480
    ds_read_b64_tr_b16 a[242:243], v24 offset:22528
    v_mfma_f32_16x16x32_bf16 v[208:211], a[192:195], a[164:167], v[208:211]
    v_exp_f32 v42, v66
    v_mfma_f32_16x16x32_bf16 v[196:199], a[196:199], a[160:163], v[196:199]
    ds_read_b64_tr_b16 a[244:245], v25 offset:20480
    v_mul_f32 v66, v66, v114
    v_mfma_f32_16x16x32_bf16 v[212:215], a[196:199], a[164:167], v[212:215]
    ds_read_b64_tr_b16 a[246:247], v25 offset:22528
    v_add_f32 v41, 1.0, v41
    v_mfma_f32_16x16x32_bf16 v[200:203], a[200:203], a[160:163], v[200:203]
    ds_read_b64_tr_b16 a[248:249], v26 offset:20480
    ds_read_b64_tr_b16 a[250:251], v26 offset:22528
    v_mfma_f32_16x16x32_bf16 v[216:219], a[200:203], a[164:167], v[216:219]
    v_exp_f32 v43, v67
    v_mfma_f32_16x16x32_bf16 v[204:207], a[204:207], a[160:163], v[204:207]
    ds_read_b64_tr_b16 a[252:253], v27 offset:20480
    v_mul_f32 v67, v67, v115
    v_mfma_f32_16x16x32_bf16 v[220:223], a[204:207], a[164:167], v[220:223]
    ds_read_b64_tr_b16 a[254:255], v27 offset:22528
    s_waitcnt lgkmcnt(15)
    v_mfma_f32_16x16x32_bf16 v[192:195], a[208:211], a[168:171], v[192:195]
    ds_read_b64_tr_b16 a[192:193], v24 offset:24576
    ds_read_b64_tr_b16 a[194:195], v24 offset:26624
    v_mfma_f32_16x16x32_bf16 v[208:211], a[208:211], a[172:175], v[208:211]
    v_exp_f32 v44, v72
    v_mfma_f32_16x16x32_bf16 v[196:199], a[212:215], a[168:171], v[196:199]
    ds_read_b64_tr_b16 a[196:197], v25 offset:24576
    v_mul_f32 v72, v72, v120
    v_mfma_f32_16x16x32_bf16 v[212:215], a[212:215], a[172:175], v[212:215]
    ds_read_b64_tr_b16 a[198:199], v25 offset:26624
    v_add_f32 v42, 1.0, v42
    v_mfma_f32_16x16x32_bf16 v[200:203], a[216:219], a[168:171], v[200:203]
    ds_read_b64_tr_b16 a[200:201], v26 offset:24576
    ds_read_b64_tr_b16 a[202:203], v26 offset:26624
    v_mfma_f32_16x16x32_bf16 v[216:219], a[216:219], a[172:175], v[216:219]
    v_exp_f32 v45, v73
    v_mfma_f32_16x16x32_bf16 v[204:207], a[220:223], a[168:171], v[204:207]
    ds_read_b64_tr_b16 a[204:205], v27 offset:24576
    v_mul_f32 v73, v73, v121
    v_mfma_f32_16x16x32_bf16 v[220:223], a[220:223], a[172:175], v[220:223]
    ds_read_b64_tr_b16 a[206:207], v27 offset:26624
    s_waitcnt lgkmcnt(15)
    v_mfma_f32_16x16x32_bf16 v[192:195], a[224:227], a[176:179], v[192:195]
    ds_read_b64_tr_b16 a[208:209], v24 offset:28672
    ds_read_b64_tr_b16 a[210:211], v24 offset:30720
    v_mfma_f32_16x16x32_bf16 v[208:211], a[224:227], a[180:183], v[208:211]
    v_exp_f32 v46, v74
    v_mfma_f32_16x16x32_bf16 v[196:199], a[228:231], a[176:179], v[196:199]
    ds_read_b64_tr_b16 a[212:213], v25 offset:28672
    v_mul_f32 v74, v74, v122
    v_mfma_f32_16x16x32_bf16 v[212:215], a[228:231], a[180:183], v[212:215]
    ds_read_b64_tr_b16 a[214:215], v25 offset:30720
    v_add_f32 v43, 1.0, v43
    v_mfma_f32_16x16x32_bf16 v[200:203], a[232:235], a[176:179], v[200:203]
    ds_read_b64_tr_b16 a[216:217], v26 offset:28672
    ds_read_b64_tr_b16 a[218:219], v26 offset:30720
    v_mfma_f32_16x16x32_bf16 v[216:219], a[232:235], a[180:183], v[216:219]
    v_exp_f32 v47, v75
    v_mfma_f32_16x16x32_bf16 v[204:207], a[236:239], a[176:179], v[204:207]
    ds_read_b64_tr_b16 a[220:221], v27 offset:28672
    v_mul_f32 v75, v75, v123
    v_mfma_f32_16x16x32_bf16 v[220:223], a[236:239], a[180:183], v[220:223]
    ds_read_b64_tr_b16 a[222:223], v27 offset:30720
    s_waitcnt lgkmcnt(15)
    v_mfma_f32_16x16x32_bf16 v[192:195], a[240:243], a[184:187], v[192:195]
    ds_read_b64_tr_b16 a[224:225], v24 offset:32768
    v_add_f32 v44, 1.0, v44
    v_mfma_f32_16x16x32_bf16 v[208:211], a[240:243], a[188:191], v[208:211]
    ds_read_b64_tr_b16 a[226:227], v24 offset:34816
    v_add_f32 v45, 1.0, v45
    v_mfma_f32_16x16x32_bf16 v[196:199], a[244:247], a[184:187], v[196:199]
    ds_read_b64_tr_b16 a[228:229], v25 offset:32768
    v_add_f32 v46, 1.0, v46
    v_mfma_f32_16x16x32_bf16 v[212:215], a[244:247], a[188:191], v[212:215]
    ds_read_b64_tr_b16 a[230:231], v25 offset:34816
    v_add_f32 v47, 1.0, v47
    v_mfma_f32_16x16x32_bf16 v[200:203], a[248:251], a[184:187], v[200:203]
    ds_read_b64_tr_b16 a[232:233], v26 offset:32768
    ds_read_b64_tr_b16 a[234:235], v26 offset:34816
    v_mfma_f32_16x16x32_bf16 v[216:219], a[248:251], a[188:191], v[216:219]
    v_rcp_f32 v40, v40
    v_mfma_f32_16x16x32_bf16 v[204:207], a[252:255], a[184:187], v[204:207]
    ds_read_b64_tr_b16 a[236:237], v27 offset:32768
    v_rcp_f32 v41, v41
    v_rcp_f32 v42, v42
    v_rcp_f32 v43, v43
    v_rcp_f32 v44, v44
    v_rcp_f32 v45, v45
    v_rcp_f32 v46, v46
    v_rcp_f32 v47, v47
    v_mul_f32 v64, v64, v40
    v_mul_f32 v65, v65, v41
    v_mul_f32 v66, v66, v42
    v_mul_f32 v67, v67, v43
    v_mul_f32 v72, v72, v44
    v_mul_f32 v73, v73, v45
    v_mul_f32 v74, v74, v46
    v_mul_f32 v75, v75, v47
    v_cvt_pk_bf16_f32 v160, v64, v65
    v_cvt_pk_bf16_f32 v161, v66, v67
    v_cvt_pk_bf16_f32 v162, v72, v73
    v_cvt_pk_bf16_f32 v163, v74, v75
    v_exp_f32 v48, v68
    v_mul_f32 v68, v68, v116
    v_exp_f32 v49, v69
    v_mul_f32 v69, v69, v117
    v_exp_f32 v50, v70
    v_mul_f32 v70, v70, v118
    v_exp_f32 v51, v71
    v_mul_f32 v71, v71, v119
    v_exp_f32 v52, v76
    v_mul_f32 v76, v76, v124
    v_exp_f32 v53, v77
    v_mul_f32 v77, v77, v125
    v_exp_f32 v54, v78
    v_mul_f32 v78, v78, v126
    v_exp_f32 v55, v79
    v_mul_f32 v79, v79, v127
    v_add_f32 v48, 1.0, v48
    v_add_f32 v49, 1.0, v49
    v_add_f32 v50, 1.0, v50
    v_add_f32 v51, 1.0, v51
    v_add_f32 v52, 1.0, v52
    v_add_f32 v53, 1.0, v53
    v_add_f32 v54, 1.0, v54
    v_add_f32 v55, 1.0, v55
    v_rcp_f32 v48, v48
    v_rcp_f32 v49, v49
    v_rcp_f32 v50, v50
    v_rcp_f32 v51, v51
    v_rcp_f32 v52, v52
    v_rcp_f32 v53, v53
    v_rcp_f32 v54, v54
    v_rcp_f32 v55, v55
    v_mul_f32 v68, v68, v48
    v_mul_f32 v69, v69, v49
    v_mul_f32 v70, v70, v50
    v_mul_f32 v71, v71, v51
    v_mul_f32 v76, v76, v52
    v_mul_f32 v77, v77, v53
    v_mul_f32 v78, v78, v54
    v_mul_f32 v79, v79, v55
    v_cvt_pk_bf16_f32 v164, v68, v69
    v_cvt_pk_bf16_f32 v165, v70, v71
    v_cvt_pk_bf16_f32 v166, v76, v77
    v_cvt_pk_bf16_f32 v167, v78, v79
    v_mfma_f32_16x16x32_bf16 v[220:223], a[252:255], a[188:191], v[220:223]
    s_add_u32 m0, s47, 36864
    ds_read_b64_tr_b16 a[238:239], v27 offset:34816
    s_waitcnt vmcnt(9)
    s_barrier
    s_waitcnt lgkmcnt(15)
    v_mfma_f32_16x16x32_bf16 v[192:195], a[192:195], v[160:163], v[192:195]
    ds_read_b64_tr_b16 a[240:241], v28 offset:0
    v_mfma_f32_16x16x32_bf16 v[208:211], a[192:195], v[164:167], v[208:211]
    s_mov_b32 s50, 384
    ds_read_b64_tr_b16 a[242:243], v28 offset:2048
    v_mfma_f32_16x16x32_bf16 v[196:199], a[196:199], v[160:163], v[196:199]
    ds_read_b64_tr_b16 a[244:245], v29 offset:0
    ds_read_b64_tr_b16 a[246:247], v29 offset:2048
    v_mfma_f32_16x16x32_bf16 v[212:215], a[196:199], v[164:167], v[212:215]
    buffer_load_dwordx4 v35, s[20:23], s50 offen offset:0 lds
    v_mfma_f32_16x16x32_bf16 v[200:203], a[200:203], v[160:163], v[200:203]
    ds_read_b64_tr_b16 a[248:249], v30 offset:0
    ds_read_b64_tr_b16 a[250:251], v30 offset:2048
    v_mfma_f32_16x16x32_bf16 v[216:219], a[200:203], v[164:167], v[216:219]
    v_exp_f32 v40, v80
    v_mfma_f32_16x16x32_bf16 v[204:207], a[204:207], v[160:163], v[204:207]
    ds_read_b64_tr_b16 a[252:253], v31 offset:0
    ds_read_b64_tr_b16 a[254:255], v31 offset:2048
    v_mul_f32 v80, v80, v128
    v_exp_f32 v41, v81
    v_mul_f32 v81, v81, v129
    v_exp_f32 v42, v82
    v_mul_f32 v82, v82, v130
    v_exp_f32 v43, v83
    v_mul_f32 v83, v83, v131
    v_exp_f32 v44, v88
    v_mul_f32 v88, v88, v136
    v_exp_f32 v45, v89
    v_mul_f32 v89, v89, v137
    v_exp_f32 v46, v90
    v_mul_f32 v90, v90, v138
    v_exp_f32 v47, v91
    v_mul_f32 v91, v91, v139
    v_add_f32 v40, 1.0, v40
    v_add_f32 v41, 1.0, v41
    v_add_f32 v42, 1.0, v42
    v_add_f32 v43, 1.0, v43
    v_add_f32 v44, 1.0, v44
    v_add_f32 v45, 1.0, v45
    v_add_f32 v46, 1.0, v46
    v_add_f32 v47, 1.0, v47
    v_rcp_f32 v40, v40
    v_rcp_f32 v41, v41
    v_rcp_f32 v42, v42
    v_rcp_f32 v43, v43
    v_rcp_f32 v44, v44
    v_rcp_f32 v45, v45
    v_rcp_f32 v46, v46
    v_rcp_f32 v47, v47
    v_mul_f32 v80, v80, v40
    v_mul_f32 v81, v81, v41
    v_mul_f32 v82, v82, v42
    v_mul_f32 v83, v83, v43
    v_mul_f32 v88, v88, v44
    v_mul_f32 v89, v89, v45
    v_mul_f32 v90, v90, v46
    v_mul_f32 v91, v91, v47
    v_cvt_pk_bf16_f32 v168, v80, v81
    v_cvt_pk_bf16_f32 v169, v82, v83
    v_cvt_pk_bf16_f32 v170, v88, v89
    v_cvt_pk_bf16_f32 v171, v90, v91
    v_exp_f32 v48, v84
    v_mul_f32 v84, v84, v132
    v_exp_f32 v49, v85
    v_mul_f32 v85, v85, v133
    v_exp_f32 v50, v86
    v_mul_f32 v86, v86, v134
    v_exp_f32 v51, v87
    v_mul_f32 v87, v87, v135
    v_exp_f32 v52, v92
    v_mul_f32 v92, v92, v140
    v_exp_f32 v53, v93
    v_mul_f32 v93, v93, v141
    v_exp_f32 v54, v94
    v_mul_f32 v94, v94, v142
    v_exp_f32 v55, v95
    v_mul_f32 v95, v95, v143
    v_add_f32 v48, 1.0, v48
    v_add_f32 v49, 1.0, v49
    v_add_f32 v50, 1.0, v50
    v_add_f32 v51, 1.0, v51
    v_add_f32 v52, 1.0, v52
    v_add_f32 v53, 1.0, v53
    v_add_f32 v54, 1.0, v54
    v_add_f32 v55, 1.0, v55
    v_rcp_f32 v48, v48
    v_rcp_f32 v49, v49
    v_rcp_f32 v50, v50
    v_rcp_f32 v51, v51
    v_rcp_f32 v52, v52
    v_rcp_f32 v53, v53
    v_rcp_f32 v54, v54
    v_rcp_f32 v55, v55
    v_mul_f32 v84, v84, v48
    v_mul_f32 v85, v85, v49
    v_mul_f32 v86, v86, v50
    v_mul_f32 v87, v87, v51
    v_mul_f32 v92, v92, v52
    v_mul_f32 v93, v93, v53
    v_mul_f32 v94, v94, v54
    v_mul_f32 v95, v95, v55
    v_cvt_pk_bf16_f32 v172, v84, v85
    v_cvt_pk_bf16_f32 v173, v86, v87
    v_cvt_pk_bf16_f32 v174, v92, v93
    v_cvt_pk_bf16_f32 v175, v94, v95
    v_mfma_f32_16x16x32_bf16 v[220:223], a[204:207], v[164:167], v[220:223]
    buffer_load_dwordx4 v36, s[20:23], s50 offen offset:1024 lds
    s_waitcnt lgkmcnt(15)
    v_mfma_f32_16x16x32_bf16 v[192:195], a[208:211], v[168:171], v[192:195]
    ds_read_b64_tr_b16 a[192:193], v28 offset:4096
    ds_read_b64_tr_b16 a[194:195], v28 offset:6144
    v_mfma_f32_16x16x32_bf16 v[208:211], a[208:211], v[172:175], v[208:211]
    v_exp_f32 v40, v96
    v_mfma_f32_16x16x32_bf16 v[196:199], a[212:215], v[168:171], v[196:199]
    ds_read_b64_tr_b16 a[196:197], v29 offset:4096
    ds_read_b64_tr_b16 a[198:199], v29 offset:6144
    v_mfma_f32_16x16x32_bf16 v[212:215], a[212:215], v[172:175], v[212:215]
    buffer_load_dwordx4 v37, s[20:23], s50 offen offset:2048 lds
    s_add_u32 m0, s47, 39936
    v_mfma_f32_16x16x32_bf16 v[200:203], a[216:219], v[168:171], v[200:203]
    ds_read_b64_tr_b16 a[200:201], v30 offset:4096
    v_mul_f32 v96, v96, v144
    v_mfma_f32_16x16x32_bf16 v[216:219], a[216:219], v[172:175], v[216:219]
    s_mov_b32 s50, 28032
    ds_read_b64_tr_b16 a[202:203], v30 offset:6144
    v_mfma_f32_16x16x32_bf16 v[204:207], a[220:223], v[168:171], v[204:207]
    ds_read_b64_tr_b16 a[204:205], v31 offset:4096
    ds_read_b64_tr_b16 a[206:207], v31 offset:6144
    v_exp_f32 v41, v97
    v_mul_f32 v97, v97, v145
    v_exp_f32 v42, v98
    v_mul_f32 v98, v98, v146
    v_exp_f32 v43, v99
    v_mul_f32 v99, v99, v147
    v_exp_f32 v44, v104
    v_mul_f32 v104, v104, v152
    v_exp_f32 v45, v105
    v_mul_f32 v105, v105, v153
    v_exp_f32 v46, v106
    v_mul_f32 v106, v106, v154
    v_exp_f32 v47, v107
    v_mul_f32 v107, v107, v155
    v_add_f32 v40, 1.0, v40
    v_add_f32 v41, 1.0, v41
    v_add_f32 v42, 1.0, v42
    v_add_f32 v43, 1.0, v43
    v_add_f32 v44, 1.0, v44
    v_add_f32 v45, 1.0, v45
    v_add_f32 v46, 1.0, v46
    v_add_f32 v47, 1.0, v47
    v_rcp_f32 v40, v40
    v_rcp_f32 v41, v41
    v_rcp_f32 v42, v42
    v_rcp_f32 v43, v43
    v_rcp_f32 v44, v44
    v_rcp_f32 v45, v45
    v_rcp_f32 v46, v46
    v_rcp_f32 v47, v47
    v_mul_f32 v96, v96, v40
    v_mul_f32 v97, v97, v41
    v_mul_f32 v98, v98, v42
    v_mul_f32 v99, v99, v43
    v_mul_f32 v104, v104, v44
    v_mul_f32 v105, v105, v45
    v_mul_f32 v106, v106, v46
    v_mul_f32 v107, v107, v47
    v_cvt_pk_bf16_f32 v176, v96, v97
    v_cvt_pk_bf16_f32 v177, v98, v99
    v_cvt_pk_bf16_f32 v178, v104, v105
    v_cvt_pk_bf16_f32 v179, v106, v107
    v_exp_f32 v48, v100
    v_mul_f32 v100, v100, v148
    v_exp_f32 v49, v101
    v_mul_f32 v101, v101, v149
    v_exp_f32 v50, v102
    v_mul_f32 v102, v102, v150
    v_exp_f32 v51, v103
    v_mul_f32 v103, v103, v151
    v_exp_f32 v52, v108
    v_mul_f32 v108, v108, v156
    v_exp_f32 v53, v109
    v_mul_f32 v109, v109, v157
    v_exp_f32 v54, v110
    v_mul_f32 v110, v110, v158
    v_exp_f32 v55, v111
    v_mul_f32 v111, v111, v159
    v_add_f32 v48, 1.0, v48
    v_add_f32 v49, 1.0, v49
    v_add_f32 v50, 1.0, v50
    v_add_f32 v51, 1.0, v51
    v_add_f32 v52, 1.0, v52
    v_add_f32 v53, 1.0, v53
    v_add_f32 v54, 1.0, v54
    v_add_f32 v55, 1.0, v55
    v_rcp_f32 v48, v48
    v_rcp_f32 v49, v49
    v_rcp_f32 v50, v50
    v_rcp_f32 v51, v51
    v_rcp_f32 v52, v52
    v_rcp_f32 v53, v53
    v_rcp_f32 v54, v54
    v_rcp_f32 v55, v55
    v_mul_f32 v100, v100, v48
    v_mul_f32 v101, v101, v49
    v_mul_f32 v102, v102, v50
    v_mul_f32 v103, v103, v51
    v_mul_f32 v108, v108, v52
    v_mul_f32 v109, v109, v53
    v_mul_f32 v110, v110, v54
    v_mul_f32 v111, v111, v55
    v_cvt_pk_bf16_f32 v180, v100, v101
    v_cvt_pk_bf16_f32 v181, v102, v103
    v_cvt_pk_bf16_f32 v182, v108, v109
    v_cvt_pk_bf16_f32 v183, v110, v111
    v_mfma_f32_16x16x32_bf16 v[220:223], a[220:223], v[172:175], v[220:223]
    buffer_load_dwordx4 v35, s[20:23], s50 offen offset:0 lds
    s_waitcnt lgkmcnt(15)
    v_mfma_f32_16x16x32_bf16 v[192:195], a[224:227], v[176:179], v[192:195]
    ds_read_b64_tr_b16 a[208:209], v28 offset:8192
    v_mfma_f32_16x16x32_bf16 v[208:211], a[224:227], v[180:183], v[208:211]
    ds_read_b64_tr_b16 a[210:211], v28 offset:10240
    v_mfma_f32_16x16x32_bf16 v[196:199], a[228:231], v[176:179], v[196:199]
    ds_read_b64_tr_b16 a[212:213], v29 offset:8192
    ds_read_b64_tr_b16 a[214:215], v29 offset:10240
    v_mfma_f32_16x16x32_bf16 v[212:215], a[228:231], v[180:183], v[212:215]
    buffer_load_dwordx4 v36, s[20:23], s50 offen offset:1024 lds
    v_mfma_f32_16x16x32_bf16 v[200:203], a[232:235], v[176:179], v[200:203]
    ds_read_b64_tr_b16 a[216:217], v30 offset:8192
    v_mfma_f32_16x16x32_bf16 v[216:219], a[232:235], v[180:183], v[216:219]
    ds_read_b64_tr_b16 a[218:219], v30 offset:10240
    v_mfma_f32_16x16x32_bf16 v[204:207], a[236:239], v[176:179], v[204:207]
    ds_read_b64_tr_b16 a[220:221], v31 offset:8192
    ds_read_b64_tr_b16 a[222:223], v31 offset:10240
    v_mfma_f32_16x16x32_bf16 v[220:223], a[236:239], v[180:183], v[220:223]
    buffer_load_dwordx4 v37, s[20:23], s50 offen offset:2048 lds
    s_add_u32 m0, s47, 43008
    s_waitcnt lgkmcnt(15)
    v_mfma_f32_16x16x32_bf16 v[224:227], a[240:243], a[144:147], 0
    ds_read_b64_tr_b16 a[224:225], v28 offset:12288
    v_mfma_f32_16x16x32_bf16 v[240:243], a[240:243], a[148:151], 0
    s_mov_b32 s50, 55680
    ds_read_b64_tr_b16 a[226:227], v28 offset:14336
    v_mfma_f32_16x16x32_bf16 v[228:231], a[244:247], a[144:147], 0
    ds_read_b64_tr_b16 a[228:229], v29 offset:12288
    ds_read_b64_tr_b16 a[230:231], v29 offset:14336
    v_mfma_f32_16x16x32_bf16 v[244:247], a[244:247], a[148:151], 0
    buffer_load_dwordx4 v35, s[20:23], s50 offen offset:0 lds
    v_mfma_f32_16x16x32_bf16 v[232:235], a[248:251], a[144:147], 0
    ds_read_b64_tr_b16 a[232:233], v30 offset:12288
    v_cvt_pk_bf16_f32 v64, v192, v193
    v_mfma_f32_16x16x32_bf16 v[248:251], a[248:251], a[148:151], 0
    ds_read_b64_tr_b16 a[234:235], v30 offset:14336
    v_cvt_pk_bf16_f32 v65, v194, v195
    v_mfma_f32_16x16x32_bf16 v[236:239], a[252:255], a[144:147], 0
    ds_read_b64_tr_b16 a[236:237], v31 offset:12288
    ds_read_b64_tr_b16 a[238:239], v31 offset:14336
    v_mfma_f32_16x16x32_bf16 v[252:255], a[252:255], a[148:151], 0
    buffer_load_dwordx4 v36, s[20:23], s50 offen offset:1024 lds
    s_waitcnt lgkmcnt(15)
    v_mfma_f32_16x16x32_bf16 v[224:227], a[192:195], a[152:155], v[224:227]
    ds_read_b64_tr_b16 a[240:241], v28 offset:16384
    v_cvt_pk_bf16_f32 v66, v196, v197
    v_mfma_f32_16x16x32_bf16 v[240:243], a[192:195], a[156:159], v[240:243]
    ds_read_b64_tr_b16 a[242:243], v28 offset:18432
    v_cvt_pk_bf16_f32 v67, v198, v199
    v_mfma_f32_16x16x32_bf16 v[228:231], a[196:199], a[152:155], v[228:231]
    ds_read_b64_tr_b16 a[244:245], v29 offset:16384
    ds_read_b64_tr_b16 a[246:247], v29 offset:18432
    v_mfma_f32_16x16x32_bf16 v[244:247], a[196:199], a[156:159], v[244:247]
    buffer_load_dwordx4 v37, s[20:23], s50 offen offset:2048 lds
    v_mfma_f32_16x16x32_bf16 v[232:235], a[200:203], a[152:155], v[232:235]
    ds_read_b64_tr_b16 a[248:249], v30 offset:16384
    v_cvt_pk_bf16_f32 v68, v200, v201
    v_mfma_f32_16x16x32_bf16 v[248:251], a[200:203], a[156:159], v[248:251]
    ds_read_b64_tr_b16 a[250:251], v30 offset:18432
    v_cvt_pk_bf16_f32 v69, v202, v203
    v_mfma_f32_16x16x32_bf16 v[236:239], a[204:207], a[152:155], v[236:239]
    ds_read_b64_tr_b16 a[252:253], v31 offset:16384
    v_cvt_pk_bf16_f32 v70, v204, v205
    v_mfma_f32_16x16x32_bf16 v[252:255], a[204:207], a[156:159], v[252:255]
    ds_read_b64_tr_b16 a[254:255], v31 offset:18432
    s_waitcnt lgkmcnt(15)
    v_mfma_f32_16x16x32_bf16 v[224:227], a[208:211], a[160:163], v[224:227]
    ds_read_b64_tr_b16 a[192:193], v28 offset:20480
    v_cvt_pk_bf16_f32 v71, v206, v207
    v_mfma_f32_16x16x32_bf16 v[240:243], a[208:211], a[164:167], v[240:243]
    ds_read_b64_tr_b16 a[194:195], v28 offset:22528
    v_cvt_pk_bf16_f32 v72, v208, v209
    v_mfma_f32_16x16x32_bf16 v[228:231], a[212:215], a[160:163], v[228:231]
    ds_read_b64_tr_b16 a[196:197], v29 offset:20480
    v_cvt_pk_bf16_f32 v73, v210, v211
    v_mfma_f32_16x16x32_bf16 v[244:247], a[212:215], a[164:167], v[244:247]
    ds_read_b64_tr_b16 a[198:199], v29 offset:22528
    v_cvt_pk_bf16_f32 v74, v212, v213
    v_mfma_f32_16x16x32_bf16 v[232:235], a[216:219], a[160:163], v[232:235]
    ds_read_b64_tr_b16 a[200:201], v30 offset:20480
    v_cvt_pk_bf16_f32 v75, v214, v215
    v_mfma_f32_16x16x32_bf16 v[248:251], a[216:219], a[164:167], v[248:251]
    ds_read_b64_tr_b16 a[202:203], v30 offset:22528
    v_cvt_pk_bf16_f32 v76, v216, v217
    v_mfma_f32_16x16x32_bf16 v[236:239], a[220:223], a[160:163], v[236:239]
    ds_read_b64_tr_b16 a[204:205], v31 offset:20480
    v_cvt_pk_bf16_f32 v77, v218, v219
    v_mfma_f32_16x16x32_bf16 v[252:255], a[220:223], a[164:167], v[252:255]
    s_mov_b32 s56, 0
    ds_read_b64_tr_b16 a[206:207], v31 offset:22528
    v_cvt_pk_bf16_f32 v78, v220, v221
    v_cvt_pk_bf16_f32 v79, v222, v223
    s_waitcnt lgkmcnt(15)
    v_mfma_f32_16x16x32_bf16 v[224:227], a[224:227], a[168:171], v[224:227]
    ds_read_b64_tr_b16 a[208:209], v28 offset:24576
    ds_read_b64_tr_b16 a[210:211], v28 offset:26624
    v_mfma_f32_16x16x32_bf16 v[240:243], a[224:227], a[172:175], v[240:243]
    buffer_store_dwordx4 v[64:67], v38, s[32:35], s56 offen offset:0 sc1
    v_mfma_f32_16x16x32_bf16 v[228:231], a[228:231], a[168:171], v[228:231]
    ds_read_b64_tr_b16 a[212:213], v29 offset:24576
    v_mfma_f32_16x16x32_bf16 v[244:247], a[228:231], a[172:175], v[244:247]
    ds_read_b64_tr_b16 a[214:215], v29 offset:26624
    v_mfma_f32_16x16x32_bf16 v[232:235], a[232:235], a[168:171], v[232:235]
    ds_read_b64_tr_b16 a[216:217], v30 offset:24576
    ds_read_b64_tr_b16 a[218:219], v30 offset:26624
    v_mfma_f32_16x16x32_bf16 v[248:251], a[232:235], a[172:175], v[248:251]
    buffer_store_dwordx4 v[68:71], v38, s[32:35], s56 offen offset:512 sc1
    v_mfma_f32_16x16x32_bf16 v[236:239], a[236:239], a[168:171], v[236:239]
    ds_read_b64_tr_b16 a[220:221], v31 offset:24576
    v_mfma_f32_16x16x32_bf16 v[252:255], a[236:239], a[172:175], v[252:255]
    s_mov_b32 s56, 18432
    ds_read_b64_tr_b16 a[222:223], v31 offset:26624
    s_waitcnt lgkmcnt(15)
    v_mfma_f32_16x16x32_bf16 v[224:227], a[240:243], a[176:179], v[224:227]
    ds_read_b64_tr_b16 a[224:225], v28 offset:28672
    ds_read_b64_tr_b16 a[226:227], v28 offset:30720
    v_mfma_f32_16x16x32_bf16 v[240:243], a[240:243], a[180:183], v[240:243]
    buffer_store_dwordx4 v[72:75], v38, s[32:35], s56 offen offset:0 sc1
    v_mfma_f32_16x16x32_bf16 v[228:231], a[244:247], a[176:179], v[228:231]
    ds_read_b64_tr_b16 a[228:229], v29 offset:28672
    v_mfma_f32_16x16x32_bf16 v[244:247], a[244:247], a[180:183], v[244:247]
    ds_read_b64_tr_b16 a[230:231], v29 offset:30720
    v_mfma_f32_16x16x32_bf16 v[232:235], a[248:251], a[176:179], v[232:235]
    ds_read_b64_tr_b16 a[232:233], v30 offset:28672
    ds_read_b64_tr_b16 a[234:235], v30 offset:30720
    v_mfma_f32_16x16x32_bf16 v[248:251], a[248:251], a[180:183], v[248:251]
    buffer_store_dwordx4 v[76:79], v38, s[32:35], s56 offen offset:512 sc1
    v_mfma_f32_16x16x32_bf16 v[236:239], a[252:255], a[176:179], v[236:239]
    ds_read_b64_tr_b16 a[236:237], v31 offset:28672
    v_mfma_f32_16x16x32_bf16 v[252:255], a[252:255], a[180:183], v[252:255]
    ds_read_b64_tr_b16 a[238:239], v31 offset:30720
    s_waitcnt lgkmcnt(15)
    v_mfma_f32_16x16x32_bf16 v[224:227], a[192:195], a[184:187], v[224:227]
    ds_read_b64_tr_b16 a[240:241], v28 offset:32768
    v_mfma_f32_16x16x32_bf16 v[240:243], a[192:195], a[188:191], v[240:243]
    ds_read_b64_tr_b16 a[242:243], v28 offset:34816
    v_mfma_f32_16x16x32_bf16 v[228:231], a[196:199], a[184:187], v[228:231]
    ds_read_b64_tr_b16 a[244:245], v29 offset:32768
    v_mfma_f32_16x16x32_bf16 v[244:247], a[196:199], a[188:191], v[244:247]
    ds_read_b64_tr_b16 a[246:247], v29 offset:34816
    v_mfma_f32_16x16x32_bf16 v[232:235], a[200:203], a[184:187], v[232:235]
    ds_read_b64_tr_b16 a[248:249], v30 offset:32768
    v_mfma_f32_16x16x32_bf16 v[248:251], a[200:203], a[188:191], v[248:251]
    ds_read_b64_tr_b16 a[250:251], v30 offset:34816
    v_mfma_f32_16x16x32_bf16 v[236:239], a[204:207], a[184:187], v[236:239]
    ds_read_b64_tr_b16 a[252:253], v31 offset:32768
    v_mfma_f32_16x16x32_bf16 v[252:255], a[204:207], a[188:191], v[252:255]
    s_add_u32 m0, s47, 73728
    ds_read_b64_tr_b16 a[254:255], v31 offset:34816
    s_waitcnt vmcnt(13)
    s_barrier
    s_waitcnt lgkmcnt(15)
    v_mfma_f32_16x16x32_bf16 v[224:227], a[208:211], v[160:163], v[224:227]
    ds_read_b64_tr_b16 a[192:193], v16 offset:0
    v_mfma_f32_16x16x32_bf16 v[240:243], a[208:211], v[164:167], v[240:243]
    s_mov_b32 s50, 512
    ds_read_b64_tr_b16 a[194:195], v16 offset:2048
    v_mfma_f32_16x16x32_bf16 v[228:231], a[212:215], v[160:163], v[228:231]
    ds_read_b64_tr_b16 a[196:197], v17 offset:0
    ds_read_b64_tr_b16 a[198:199], v17 offset:2048
    v_mfma_f32_16x16x32_bf16 v[244:247], a[212:215], v[164:167], v[244:247]
    buffer_load_dwordx4 v35, s[20:23], s50 offen offset:0 lds
    v_mfma_f32_16x16x32_bf16 v[232:235], a[216:219], v[160:163], v[232:235]
    ds_read_b64_tr_b16 a[200:201], v18 offset:0
    v_mfma_f32_16x16x32_bf16 v[248:251], a[216:219], v[164:167], v[248:251]
    ds_read_b64_tr_b16 a[202:203], v18 offset:2048
    v_mfma_f32_16x16x32_bf16 v[236:239], a[220:223], v[160:163], v[236:239]
    ds_read_b64_tr_b16 a[204:205], v19 offset:0
    ds_read_b64_tr_b16 a[206:207], v19 offset:2048
    v_mfma_f32_16x16x32_bf16 v[252:255], a[220:223], v[164:167], v[252:255]
    buffer_load_dwordx4 v36, s[20:23], s50 offen offset:1024 lds
    s_waitcnt lgkmcnt(15)
    v_mfma_f32_16x16x32_bf16 v[224:227], a[224:227], v[168:171], v[224:227]
    ds_read_b64_tr_b16 a[208:209], v16 offset:4096
    v_mfma_f32_16x16x32_bf16 v[240:243], a[224:227], v[172:175], v[240:243]
    ds_read_b64_tr_b16 a[210:211], v16 offset:6144
    v_mfma_f32_16x16x32_bf16 v[228:231], a[228:231], v[168:171], v[228:231]
    ds_read_b64_tr_b16 a[212:213], v17 offset:4096
    ds_read_b64_tr_b16 a[214:215], v17 offset:6144
    v_mfma_f32_16x16x32_bf16 v[244:247], a[228:231], v[172:175], v[244:247]
    buffer_load_dwordx4 v37, s[20:23], s50 offen offset:2048 lds
    s_add_u32 m0, s47, 76800
    v_mfma_f32_16x16x32_bf16 v[232:235], a[232:235], v[168:171], v[232:235]
    ds_read_b64_tr_b16 a[216:217], v18 offset:4096
    v_mfma_f32_16x16x32_bf16 v[248:251], a[232:235], v[172:175], v[248:251]
    s_mov_b32 s50, 28160
    ds_read_b64_tr_b16 a[218:219], v18 offset:6144
    v_mfma_f32_16x16x32_bf16 v[236:239], a[236:239], v[168:171], v[236:239]
    ds_read_b64_tr_b16 a[220:221], v19 offset:4096
    ds_read_b64_tr_b16 a[222:223], v19 offset:6144
    v_mfma_f32_16x16x32_bf16 v[252:255], a[236:239], v[172:175], v[252:255]
    buffer_load_dwordx4 v35, s[20:23], s50 offen offset:0 lds
    s_waitcnt lgkmcnt(15)
    v_mfma_f32_16x16x32_bf16 v[224:227], a[240:243], v[176:179], v[224:227]
    ds_read_b64_tr_b16 a[224:225], v16 offset:8192
    v_mfma_f32_16x16x32_bf16 v[240:243], a[240:243], v[180:183], v[240:243]
    ds_read_b64_tr_b16 a[226:227], v16 offset:10240
    v_mfma_f32_16x16x32_bf16 v[228:231], a[244:247], v[176:179], v[228:231]
    ds_read_b64_tr_b16 a[228:229], v17 offset:8192
    ds_read_b64_tr_b16 a[230:231], v17 offset:10240
    v_mfma_f32_16x16x32_bf16 v[244:247], a[244:247], v[180:183], v[244:247]
    buffer_load_dwordx4 v36, s[20:23], s50 offen offset:1024 lds
    v_mfma_f32_16x16x32_bf16 v[232:235], a[248:251], v[176:179], v[232:235]
    ds_read_b64_tr_b16 a[232:233], v18 offset:8192
    v_mfma_f32_16x16x32_bf16 v[248:251], a[248:251], v[180:183], v[248:251]
    ds_read_b64_tr_b16 a[234:235], v18 offset:10240
    v_mfma_f32_16x16x32_bf16 v[236:239], a[252:255], v[176:179], v[236:239]
    ds_read_b64_tr_b16 a[236:237], v19 offset:8192
    ds_read_b64_tr_b16 a[238:239], v19 offset:10240
    v_mfma_f32_16x16x32_bf16 v[252:255], a[252:255], v[180:183], v[252:255]
    buffer_load_dwordx4 v37, s[20:23], s50 offen offset:2048 lds
    s_add_u32 m0, s47, 79872
    s_waitcnt lgkmcnt(15)
    v_mfma_f32_16x16x32_bf16 v[192:195], a[192:195], a[144:147], 0
    ds_read_b64_tr_b16 a[240:241], v16 offset:12288
    v_mfma_f32_16x16x32_bf16 v[208:211], a[192:195], a[148:151], 0
    s_mov_b32 s50, 55808
    ds_read_b64_tr_b16 a[242:243], v16 offset:14336
    v_mfma_f32_16x16x32_bf16 v[196:199], a[196:199], a[144:147], 0
    ds_read_b64_tr_b16 a[244:245], v17 offset:12288
    ds_read_b64_tr_b16 a[246:247], v17 offset:14336
    v_mfma_f32_16x16x32_bf16 v[212:215], a[196:199], a[148:151], 0
    buffer_load_dwordx4 v35, s[20:23], s50 offen offset:0 lds
    v_mfma_f32_16x16x32_bf16 v[200:203], a[200:203], a[144:147], 0
    ds_read_b64_tr_b16 a[248:249], v18 offset:12288
    v_cvt_pk_bf16_f32 v80, v224, v225
    v_mfma_f32_16x16x32_bf16 v[216:219], a[200:203], a[148:151], 0
    ds_read_b64_tr_b16 a[250:251], v18 offset:14336
    v_cvt_pk_bf16_f32 v81, v226, v227
    v_mfma_f32_16x16x32_bf16 v[204:207], a[204:207], a[144:147], 0
    ds_read_b64_tr_b16 a[252:253], v19 offset:12288
    ds_read_b64_tr_b16 a[254:255], v19 offset:14336
    v_mfma_f32_16x16x32_bf16 v[220:223], a[204:207], a[148:151], 0
    buffer_load_dwordx4 v36, s[20:23], s50 offen offset:1024 lds
    s_waitcnt lgkmcnt(15)
    v_mfma_f32_16x16x32_bf16 v[192:195], a[208:211], a[152:155], v[192:195]
    ds_read_b64_tr_b16 a[192:193], v16 offset:16384
    v_cvt_pk_bf16_f32 v82, v228, v229
    v_mfma_f32_16x16x32_bf16 v[208:211], a[208:211], a[156:159], v[208:211]
    ds_read_b64_tr_b16 a[194:195], v16 offset:18432
    v_cvt_pk_bf16_f32 v83, v230, v231
    v_mfma_f32_16x16x32_bf16 v[196:199], a[212:215], a[152:155], v[196:199]
    ds_read_b64_tr_b16 a[196:197], v17 offset:16384
    ds_read_b64_tr_b16 a[198:199], v17 offset:18432
    v_mfma_f32_16x16x32_bf16 v[212:215], a[212:215], a[156:159], v[212:215]
    buffer_load_dwordx4 v37, s[20:23], s50 offen offset:2048 lds
    v_mfma_f32_16x16x32_bf16 v[200:203], a[216:219], a[152:155], v[200:203]
    ds_read_b64_tr_b16 a[200:201], v18 offset:16384
    v_cvt_pk_bf16_f32 v84, v232, v233
    v_mfma_f32_16x16x32_bf16 v[216:219], a[216:219], a[156:159], v[216:219]
    ds_read_b64_tr_b16 a[202:203], v18 offset:18432
    v_cvt_pk_bf16_f32 v85, v234, v235
    v_mfma_f32_16x16x32_bf16 v[204:207], a[220:223], a[152:155], v[204:207]
    ds_read_b64_tr_b16 a[204:205], v19 offset:16384
    v_cvt_pk_bf16_f32 v86, v236, v237
    v_mfma_f32_16x16x32_bf16 v[220:223], a[220:223], a[156:159], v[220:223]
    ds_read_b64_tr_b16 a[206:207], v19 offset:18432
    s_waitcnt lgkmcnt(15)
    v_mfma_f32_16x16x32_bf16 v[192:195], a[224:227], a[160:163], v[192:195]
    ds_read_b64_tr_b16 a[208:209], v16 offset:20480
    v_cvt_pk_bf16_f32 v87, v238, v239
    v_mfma_f32_16x16x32_bf16 v[208:211], a[224:227], a[164:167], v[208:211]
    ds_read_b64_tr_b16 a[210:211], v16 offset:22528
    v_cvt_pk_bf16_f32 v88, v240, v241
    v_mfma_f32_16x16x32_bf16 v[196:199], a[228:231], a[160:163], v[196:199]
    ds_read_b64_tr_b16 a[212:213], v17 offset:20480
    v_cvt_pk_bf16_f32 v89, v242, v243
    v_mfma_f32_16x16x32_bf16 v[212:215], a[228:231], a[164:167], v[212:215]
    ds_read_b64_tr_b16 a[214:215], v17 offset:22528
    v_cvt_pk_bf16_f32 v90, v244, v245
    v_mfma_f32_16x16x32_bf16 v[200:203], a[232:235], a[160:163], v[200:203]
    ds_read_b64_tr_b16 a[216:217], v18 offset:20480
    v_cvt_pk_bf16_f32 v91, v246, v247
    v_mfma_f32_16x16x32_bf16 v[216:219], a[232:235], a[164:167], v[216:219]
    ds_read_b64_tr_b16 a[218:219], v18 offset:22528
    v_cvt_pk_bf16_f32 v92, v248, v249
    v_mfma_f32_16x16x32_bf16 v[204:207], a[236:239], a[160:163], v[204:207]
    ds_read_b64_tr_b16 a[220:221], v19 offset:20480
    v_cvt_pk_bf16_f32 v93, v250, v251
    v_mfma_f32_16x16x32_bf16 v[220:223], a[236:239], a[164:167], v[220:223]
    s_mov_b32 s56, 1024
    ds_read_b64_tr_b16 a[222:223], v19 offset:22528
    v_cvt_pk_bf16_f32 v94, v252, v253
    v_cvt_pk_bf16_f32 v95, v254, v255
    s_waitcnt lgkmcnt(15)
    v_mfma_f32_16x16x32_bf16 v[192:195], a[240:243], a[168:171], v[192:195]
    ds_read_b64_tr_b16 a[224:225], v16 offset:24576
    ds_read_b64_tr_b16 a[226:227], v16 offset:26624
    v_mfma_f32_16x16x32_bf16 v[208:211], a[240:243], a[172:175], v[208:211]
    buffer_store_dwordx4 v[80:83], v38, s[32:35], s56 offen offset:0 sc1
    v_mfma_f32_16x16x32_bf16 v[196:199], a[244:247], a[168:171], v[196:199]
    ds_read_b64_tr_b16 a[228:229], v17 offset:24576
    v_mfma_f32_16x16x32_bf16 v[212:215], a[244:247], a[172:175], v[212:215]
    ds_read_b64_tr_b16 a[230:231], v17 offset:26624
    v_mfma_f32_16x16x32_bf16 v[200:203], a[248:251], a[168:171], v[200:203]
    ds_read_b64_tr_b16 a[232:233], v18 offset:24576
    ds_read_b64_tr_b16 a[234:235], v18 offset:26624
    v_mfma_f32_16x16x32_bf16 v[216:219], a[248:251], a[172:175], v[216:219]
    buffer_store_dwordx4 v[84:87], v38, s[32:35], s56 offen offset:512 sc1
    v_mfma_f32_16x16x32_bf16 v[204:207], a[252:255], a[168:171], v[204:207]
    ds_read_b64_tr_b16 a[236:237], v19 offset:24576
    v_mfma_f32_16x16x32_bf16 v[220:223], a[252:255], a[172:175], v[220:223]
    s_mov_b32 s56, 19456
    ds_read_b64_tr_b16 a[238:239], v19 offset:26624
    s_waitcnt lgkmcnt(15)
    v_mfma_f32_16x16x32_bf16 v[192:195], a[192:195], a[176:179], v[192:195]
    ds_read_b64_tr_b16 a[240:241], v16 offset:28672
    ds_read_b64_tr_b16 a[242:243], v16 offset:30720
    v_mfma_f32_16x16x32_bf16 v[208:211], a[192:195], a[180:183], v[208:211]
    buffer_store_dwordx4 v[88:91], v38, s[32:35], s56 offen offset:0 sc1
    v_mfma_f32_16x16x32_bf16 v[196:199], a[196:199], a[176:179], v[196:199]
    ds_read_b64_tr_b16 a[244:245], v17 offset:28672
    v_mfma_f32_16x16x32_bf16 v[212:215], a[196:199], a[180:183], v[212:215]
    ds_read_b64_tr_b16 a[246:247], v17 offset:30720
    v_mfma_f32_16x16x32_bf16 v[200:203], a[200:203], a[176:179], v[200:203]
    ds_read_b64_tr_b16 a[248:249], v18 offset:28672
    ds_read_b64_tr_b16 a[250:251], v18 offset:30720
    v_mfma_f32_16x16x32_bf16 v[216:219], a[200:203], a[180:183], v[216:219]
    buffer_store_dwordx4 v[92:95], v38, s[32:35], s56 offen offset:512 sc1
    v_mfma_f32_16x16x32_bf16 v[204:207], a[204:207], a[176:179], v[204:207]
    ds_read_b64_tr_b16 a[252:253], v19 offset:28672
    v_mfma_f32_16x16x32_bf16 v[220:223], a[204:207], a[180:183], v[220:223]
    ds_read_b64_tr_b16 a[254:255], v19 offset:30720
    s_waitcnt lgkmcnt(15)
    v_mfma_f32_16x16x32_bf16 v[192:195], a[208:211], a[184:187], v[192:195]
    ds_read_b64_tr_b16 a[192:193], v16 offset:32768
    v_mfma_f32_16x16x32_bf16 v[208:211], a[208:211], a[188:191], v[208:211]
    ds_read_b64_tr_b16 a[194:195], v16 offset:34816
    v_mfma_f32_16x16x32_bf16 v[196:199], a[212:215], a[184:187], v[196:199]
    ds_read_b64_tr_b16 a[196:197], v17 offset:32768
    v_mfma_f32_16x16x32_bf16 v[212:215], a[212:215], a[188:191], v[212:215]
    ds_read_b64_tr_b16 a[198:199], v17 offset:34816
    v_mfma_f32_16x16x32_bf16 v[200:203], a[216:219], a[184:187], v[200:203]
    ds_read_b64_tr_b16 a[200:201], v18 offset:32768
    v_mfma_f32_16x16x32_bf16 v[216:219], a[216:219], a[188:191], v[216:219]
    ds_read_b64_tr_b16 a[202:203], v18 offset:34816
    v_mfma_f32_16x16x32_bf16 v[204:207], a[220:223], a[184:187], v[204:207]
    ds_read_b64_tr_b16 a[204:205], v19 offset:32768
    v_mfma_f32_16x16x32_bf16 v[220:223], a[220:223], a[188:191], v[220:223]
    s_add_u32 m0, s47, 110592
    ds_read_b64_tr_b16 a[206:207], v19 offset:34816
    s_waitcnt vmcnt(17)
    s_barrier
    s_waitcnt lgkmcnt(15)
    v_mfma_f32_16x16x32_bf16 v[192:195], a[224:227], v[160:163], v[192:195]
    ds_read_b64_tr_b16 a[208:209], v20 offset:0
    v_mfma_f32_16x16x32_bf16 v[208:211], a[224:227], v[164:167], v[208:211]
    s_mov_b32 s50, 640
    ds_read_b64_tr_b16 a[210:211], v20 offset:2048
    v_mfma_f32_16x16x32_bf16 v[196:199], a[228:231], v[160:163], v[196:199]
    ds_read_b64_tr_b16 a[212:213], v21 offset:0
    ds_read_b64_tr_b16 a[214:215], v21 offset:2048
    v_mfma_f32_16x16x32_bf16 v[212:215], a[228:231], v[164:167], v[212:215]
    buffer_load_dwordx4 v35, s[20:23], s50 offen offset:0 lds
    v_mfma_f32_16x16x32_bf16 v[200:203], a[232:235], v[160:163], v[200:203]
    ds_read_b64_tr_b16 a[216:217], v22 offset:0
    v_mfma_f32_16x16x32_bf16 v[216:219], a[232:235], v[164:167], v[216:219]
    ds_read_b64_tr_b16 a[218:219], v22 offset:2048
    v_mfma_f32_16x16x32_bf16 v[204:207], a[236:239], v[160:163], v[204:207]
    ds_read_b64_tr_b16 a[220:221], v23 offset:0
    ds_read_b64_tr_b16 a[222:223], v23 offset:2048
    v_mfma_f32_16x16x32_bf16 v[220:223], a[236:239], v[164:167], v[220:223]
    buffer_load_dwordx4 v36, s[20:23], s50 offen offset:1024 lds
    s_waitcnt lgkmcnt(15)
    v_mfma_f32_16x16x32_bf16 v[192:195], a[240:243], v[168:171], v[192:195]
    ds_read_b64_tr_b16 a[224:225], v20 offset:4096
    v_mfma_f32_16x16x32_bf16 v[208:211], a[240:243], v[172:175], v[208:211]
    ds_read_b64_tr_b16 a[226:227], v20 offset:6144
    v_mfma_f32_16x16x32_bf16 v[196:199], a[244:247], v[168:171], v[196:199]
    ds_read_b64_tr_b16 a[228:229], v21 offset:4096
    ds_read_b64_tr_b16 a[230:231], v21 offset:6144
    v_mfma_f32_16x16x32_bf16 v[212:215], a[244:247], v[172:175], v[212:215]
    buffer_load_dwordx4 v37, s[20:23], s50 offen offset:2048 lds
    s_add_u32 m0, s47, 113664
    v_mfma_f32_16x16x32_bf16 v[200:203], a[248:251], v[168:171], v[200:203]
    ds_read_b64_tr_b16 a[232:233], v22 offset:4096
    v_mfma_f32_16x16x32_bf16 v[216:219], a[248:251], v[172:175], v[216:219]
    s_mov_b32 s50, 28288
    ds_read_b64_tr_b16 a[234:235], v22 offset:6144
    v_mfma_f32_16x16x32_bf16 v[204:207], a[252:255], v[168:171], v[204:207]
    ds_read_b64_tr_b16 a[236:237], v23 offset:4096
    ds_read_b64_tr_b16 a[238:239], v23 offset:6144
    v_mfma_f32_16x16x32_bf16 v[220:223], a[252:255], v[172:175], v[220:223]
    buffer_load_dwordx4 v35, s[20:23], s50 offen offset:0 lds
    s_waitcnt lgkmcnt(15)
    v_mfma_f32_16x16x32_bf16 v[192:195], a[192:195], v[176:179], v[192:195]
    ds_read_b64_tr_b16 a[240:241], v20 offset:8192
    v_mfma_f32_16x16x32_bf16 v[208:211], a[192:195], v[180:183], v[208:211]
    ds_read_b64_tr_b16 a[242:243], v20 offset:10240
    v_mfma_f32_16x16x32_bf16 v[196:199], a[196:199], v[176:179], v[196:199]
    ds_read_b64_tr_b16 a[244:245], v21 offset:8192
    ds_read_b64_tr_b16 a[246:247], v21 offset:10240
    v_mfma_f32_16x16x32_bf16 v[212:215], a[196:199], v[180:183], v[212:215]
    buffer_load_dwordx4 v36, s[20:23], s50 offen offset:1024 lds
    v_mfma_f32_16x16x32_bf16 v[200:203], a[200:203], v[176:179], v[200:203]
    ds_read_b64_tr_b16 a[248:249], v22 offset:8192
    v_mfma_f32_16x16x32_bf16 v[216:219], a[200:203], v[180:183], v[216:219]
    ds_read_b64_tr_b16 a[250:251], v22 offset:10240
    v_mfma_f32_16x16x32_bf16 v[204:207], a[204:207], v[176:179], v[204:207]
    ds_read_b64_tr_b16 a[252:253], v23 offset:8192
    ds_read_b64_tr_b16 a[254:255], v23 offset:10240
    v_mfma_f32_16x16x32_bf16 v[220:223], a[204:207], v[180:183], v[220:223]
    buffer_load_dwordx4 v37, s[20:23], s50 offen offset:2048 lds
    s_add_u32 m0, s47, 116736
    s_waitcnt lgkmcnt(15)
    v_mfma_f32_16x16x32_bf16 v[224:227], a[208:211], a[144:147], 0
    ds_read_b64_tr_b16 a[192:193], v20 offset:12288
    v_mfma_f32_16x16x32_bf16 v[240:243], a[208:211], a[148:151], 0
    s_mov_b32 s50, 55936
    ds_read_b64_tr_b16 a[194:195], v20 offset:14336
    v_mfma_f32_16x16x32_bf16 v[228:231], a[212:215], a[144:147], 0
    ds_read_b64_tr_b16 a[196:197], v21 offset:12288
    ds_read_b64_tr_b16 a[198:199], v21 offset:14336
    v_mfma_f32_16x16x32_bf16 v[244:247], a[212:215], a[148:151], 0
    buffer_load_dwordx4 v35, s[20:23], s50 offen offset:0 lds
    v_mfma_f32_16x16x32_bf16 v[232:235], a[216:219], a[144:147], 0
    ds_read_b64_tr_b16 a[200:201], v22 offset:12288
    v_cvt_pk_bf16_f32 v64, v192, v193
    v_mfma_f32_16x16x32_bf16 v[248:251], a[216:219], a[148:151], 0
    ds_read_b64_tr_b16 a[202:203], v22 offset:14336
    v_cvt_pk_bf16_f32 v65, v194, v195
    v_mfma_f32_16x16x32_bf16 v[236:239], a[220:223], a[144:147], 0
    ds_read_b64_tr_b16 a[204:205], v23 offset:12288
    ds_read_b64_tr_b16 a[206:207], v23 offset:14336
    v_mfma_f32_16x16x32_bf16 v[252:255], a[220:223], a[148:151], 0
    buffer_load_dwordx4 v36, s[20:23], s50 offen offset:1024 lds
    s_waitcnt lgkmcnt(15)
    v_mfma_f32_16x16x32_bf16 v[224:227], a[224:227], a[152:155], v[224:227]
    ds_read_b64_tr_b16 a[208:209], v20 offset:16384
    v_cvt_pk_bf16_f32 v66, v196, v197
    v_mfma_f32_16x16x32_bf16 v[240:243], a[224:227], a[156:159], v[240:243]
    ds_read_b64_tr_b16 a[210:211], v20 offset:18432
    v_cvt_pk_bf16_f32 v67, v198, v199
    v_mfma_f32_16x16x32_bf16 v[228:231], a[228:231], a[152:155], v[228:231]
    ds_read_b64_tr_b16 a[212:213], v21 offset:16384
    ds_read_b64_tr_b16 a[214:215], v21 offset:18432
    v_mfma_f32_16x16x32_bf16 v[244:247], a[228:231], a[156:159], v[244:247]
    buffer_load_dwordx4 v37, s[20:23], s50 offen offset:2048 lds
    v_mfma_f32_16x16x32_bf16 v[232:235], a[232:235], a[152:155], v[232:235]
    ds_read_b64_tr_b16 a[216:217], v22 offset:16384
    v_cvt_pk_bf16_f32 v68, v200, v201
    v_mfma_f32_16x16x32_bf16 v[248:251], a[232:235], a[156:159], v[248:251]
    ds_read_b64_tr_b16 a[218:219], v22 offset:18432
    v_cvt_pk_bf16_f32 v69, v202, v203
    v_mfma_f32_16x16x32_bf16 v[236:239], a[236:239], a[152:155], v[236:239]
    ds_read_b64_tr_b16 a[220:221], v23 offset:16384
    v_cvt_pk_bf16_f32 v70, v204, v205
    v_mfma_f32_16x16x32_bf16 v[252:255], a[236:239], a[156:159], v[252:255]
    ds_read_b64_tr_b16 a[222:223], v23 offset:18432
    s_waitcnt lgkmcnt(15)
    v_mfma_f32_16x16x32_bf16 v[224:227], a[240:243], a[160:163], v[224:227]
    ds_read_b64_tr_b16 a[224:225], v20 offset:20480
    v_cvt_pk_bf16_f32 v71, v206, v207
    v_mfma_f32_16x16x32_bf16 v[240:243], a[240:243], a[164:167], v[240:243]
    ds_read_b64_tr_b16 a[226:227], v20 offset:22528
    v_cvt_pk_bf16_f32 v72, v208, v209
    v_mfma_f32_16x16x32_bf16 v[228:231], a[244:247], a[160:163], v[228:231]
    ds_read_b64_tr_b16 a[228:229], v21 offset:20480
    v_cvt_pk_bf16_f32 v73, v210, v211
    v_mfma_f32_16x16x32_bf16 v[244:247], a[244:247], a[164:167], v[244:247]
    ds_read_b64_tr_b16 a[230:231], v21 offset:22528
    v_cvt_pk_bf16_f32 v74, v212, v213
    v_mfma_f32_16x16x32_bf16 v[232:235], a[248:251], a[160:163], v[232:235]
    ds_read_b64_tr_b16 a[232:233], v22 offset:20480
    v_cvt_pk_bf16_f32 v75, v214, v215
    v_mfma_f32_16x16x32_bf16 v[248:251], a[248:251], a[164:167], v[248:251]
    ds_read_b64_tr_b16 a[234:235], v22 offset:22528
    v_cvt_pk_bf16_f32 v76, v216, v217
    v_mfma_f32_16x16x32_bf16 v[236:239], a[252:255], a[160:163], v[236:239]
    ds_read_b64_tr_b16 a[236:237], v23 offset:20480
    v_cvt_pk_bf16_f32 v77, v218, v219
    v_mfma_f32_16x16x32_bf16 v[252:255], a[252:255], a[164:167], v[252:255]
    s_mov_b32 s56, 2048
    ds_read_b64_tr_b16 a[238:239], v23 offset:22528
    v_cvt_pk_bf16_f32 v78, v220, v221
    v_cvt_pk_bf16_f32 v79, v222, v223
    s_waitcnt lgkmcnt(15)
    v_mfma_f32_16x16x32_bf16 v[224:227], a[192:195], a[168:171], v[224:227]
    ds_read_b64_tr_b16 a[240:241], v20 offset:24576
    ds_read_b64_tr_b16 a[242:243], v20 offset:26624
    v_mfma_f32_16x16x32_bf16 v[240:243], a[192:195], a[172:175], v[240:243]
    buffer_store_dwordx4 v[64:67], v38, s[32:35], s56 offen offset:0 sc1
    v_mfma_f32_16x16x32_bf16 v[228:231], a[196:199], a[168:171], v[228:231]
    ds_read_b64_tr_b16 a[244:245], v21 offset:24576
    v_mfma_f32_16x16x32_bf16 v[244:247], a[196:199], a[172:175], v[244:247]
    ds_read_b64_tr_b16 a[246:247], v21 offset:26624
    v_mfma_f32_16x16x32_bf16 v[232:235], a[200:203], a[168:171], v[232:235]
    ds_read_b64_tr_b16 a[248:249], v22 offset:24576
    ds_read_b64_tr_b16 a[250:251], v22 offset:26624
    v_mfma_f32_16x16x32_bf16 v[248:251], a[200:203], a[172:175], v[248:251]
    buffer_store_dwordx4 v[68:71], v38, s[32:35], s56 offen offset:512 sc1
    v_mfma_f32_16x16x32_bf16 v[236:239], a[204:207], a[168:171], v[236:239]
    ds_read_b64_tr_b16 a[252:253], v23 offset:24576
    v_mfma_f32_16x16x32_bf16 v[252:255], a[204:207], a[172:175], v[252:255]
    s_mov_b32 s56, 20480
    ds_read_b64_tr_b16 a[254:255], v23 offset:26624
    s_waitcnt lgkmcnt(15)
    v_mfma_f32_16x16x32_bf16 v[224:227], a[208:211], a[176:179], v[224:227]
    ds_read_b64_tr_b16 a[192:193], v20 offset:28672
    ds_read_b64_tr_b16 a[194:195], v20 offset:30720
    v_mfma_f32_16x16x32_bf16 v[240:243], a[208:211], a[180:183], v[240:243]
    buffer_store_dwordx4 v[72:75], v38, s[32:35], s56 offen offset:0 sc1
    v_mfma_f32_16x16x32_bf16 v[228:231], a[212:215], a[176:179], v[228:231]
    ds_read_b64_tr_b16 a[196:197], v21 offset:28672
    v_mfma_f32_16x16x32_bf16 v[244:247], a[212:215], a[180:183], v[244:247]
    ds_read_b64_tr_b16 a[198:199], v21 offset:30720
    v_mfma_f32_16x16x32_bf16 v[232:235], a[216:219], a[176:179], v[232:235]
    ds_read_b64_tr_b16 a[200:201], v22 offset:28672
    ds_read_b64_tr_b16 a[202:203], v22 offset:30720
    v_mfma_f32_16x16x32_bf16 v[248:251], a[216:219], a[180:183], v[248:251]
    buffer_store_dwordx4 v[76:79], v38, s[32:35], s56 offen offset:512 sc1
    v_mfma_f32_16x16x32_bf16 v[236:239], a[220:223], a[176:179], v[236:239]
    ds_read_b64_tr_b16 a[204:205], v23 offset:28672
    v_mfma_f32_16x16x32_bf16 v[252:255], a[220:223], a[180:183], v[252:255]
    ds_read_b64_tr_b16 a[206:207], v23 offset:30720
    s_waitcnt lgkmcnt(15)
    v_mfma_f32_16x16x32_bf16 v[224:227], a[224:227], a[184:187], v[224:227]
    ds_read_b64_tr_b16 a[208:209], v20 offset:32768
    v_mfma_f32_16x16x32_bf16 v[240:243], a[224:227], a[188:191], v[240:243]
    ds_read_b64_tr_b16 a[210:211], v20 offset:34816
    v_mfma_f32_16x16x32_bf16 v[228:231], a[228:231], a[184:187], v[228:231]
    ds_read_b64_tr_b16 a[212:213], v21 offset:32768
    v_mfma_f32_16x16x32_bf16 v[244:247], a[228:231], a[188:191], v[244:247]
    ds_read_b64_tr_b16 a[214:215], v21 offset:34816
    v_mfma_f32_16x16x32_bf16 v[232:235], a[232:235], a[184:187], v[232:235]
    ds_read_b64_tr_b16 a[216:217], v22 offset:32768
    v_mfma_f32_16x16x32_bf16 v[248:251], a[232:235], a[188:191], v[248:251]
    ds_read_b64_tr_b16 a[218:219], v22 offset:34816
    v_mfma_f32_16x16x32_bf16 v[236:239], a[236:239], a[184:187], v[236:239]
    ds_read_b64_tr_b16 a[220:221], v23 offset:32768
    v_mfma_f32_16x16x32_bf16 v[252:255], a[236:239], a[188:191], v[252:255]
    s_add_u32 m0, s47, 0
    ds_read_b64_tr_b16 a[222:223], v23 offset:34816
    s_waitcnt vmcnt(17)
    s_barrier
    s_waitcnt lgkmcnt(15)
    v_mfma_f32_16x16x32_bf16 v[224:227], a[240:243], v[160:163], v[224:227]
    ds_read_b64_tr_b16 a[224:225], v24 offset:0
    v_mfma_f32_16x16x32_bf16 v[240:243], a[240:243], v[164:167], v[240:243]
    s_mov_b32 s50, 768
    ds_read_b64_tr_b16 a[226:227], v24 offset:2048
    v_mfma_f32_16x16x32_bf16 v[228:231], a[244:247], v[160:163], v[228:231]
    ds_read_b64_tr_b16 a[228:229], v25 offset:0
    ds_read_b64_tr_b16 a[230:231], v25 offset:2048
    v_mfma_f32_16x16x32_bf16 v[244:247], a[244:247], v[164:167], v[244:247]
    buffer_load_dwordx4 v35, s[20:23], s50 offen offset:0 lds
    v_mfma_f32_16x16x32_bf16 v[232:235], a[248:251], v[160:163], v[232:235]
    ds_read_b64_tr_b16 a[232:233], v26 offset:0
    v_mfma_f32_16x16x32_bf16 v[248:251], a[248:251], v[164:167], v[248:251]
    ds_read_b64_tr_b16 a[234:235], v26 offset:2048
    v_mfma_f32_16x16x32_bf16 v[236:239], a[252:255], v[160:163], v[236:239]
    ds_read_b64_tr_b16 a[236:237], v27 offset:0
    ds_read_b64_tr_b16 a[238:239], v27 offset:2048
    v_mfma_f32_16x16x32_bf16 v[252:255], a[252:255], v[164:167], v[252:255]
    buffer_load_dwordx4 v36, s[20:23], s50 offen offset:1024 lds
    s_waitcnt lgkmcnt(15)
    v_mfma_f32_16x16x32_bf16 v[224:227], a[192:195], v[168:171], v[224:227]
    ds_read_b64_tr_b16 a[240:241], v24 offset:4096
    v_mfma_f32_16x16x32_bf16 v[240:243], a[192:195], v[172:175], v[240:243]
    ds_read_b64_tr_b16 a[242:243], v24 offset:6144
    v_mfma_f32_16x16x32_bf16 v[228:231], a[196:199], v[168:171], v[228:231]
    ds_read_b64_tr_b16 a[244:245], v25 offset:4096
    ds_read_b64_tr_b16 a[246:247], v25 offset:6144
    v_mfma_f32_16x16x32_bf16 v[244:247], a[196:199], v[172:175], v[244:247]
    buffer_load_dwordx4 v37, s[20:23], s50 offen offset:2048 lds
    s_add_u32 m0, s47, 3072
    v_mfma_f32_16x16x32_bf16 v[232:235], a[200:203], v[168:171], v[232:235]
    ds_read_b64_tr_b16 a[248:249], v26 offset:4096
    v_mfma_f32_16x16x32_bf16 v[248:251], a[200:203], v[172:175], v[248:251]
    s_mov_b32 s50, 28416
    ds_read_b64_tr_b16 a[250:251], v26 offset:6144
    v_mfma_f32_16x16x32_bf16 v[236:239], a[204:207], v[168:171], v[236:239]
    ds_read_b64_tr_b16 a[252:253], v27 offset:4096
    ds_read_b64_tr_b16 a[254:255], v27 offset:6144
    v_mfma_f32_16x16x32_bf16 v[252:255], a[204:207], v[172:175], v[252:255]
    buffer_load_dwordx4 v35, s[20:23], s50 offen offset:0 lds
    s_waitcnt lgkmcnt(15)
    v_mfma_f32_16x16x32_bf16 v[224:227], a[208:211], v[176:179], v[224:227]
    ds_read_b64_tr_b16 a[192:193], v24 offset:8192
    v_mfma_f32_16x16x32_bf16 v[240:243], a[208:211], v[180:183], v[240:243]
    ds_read_b64_tr_b16 a[194:195], v24 offset:10240
    v_mfma_f32_16x16x32_bf16 v[228:231], a[212:215], v[176:179], v[228:231]
    ds_read_b64_tr_b16 a[196:197], v25 offset:8192
    ds_read_b64_tr_b16 a[198:199], v25 offset:10240
    v_mfma_f32_16x16x32_bf16 v[244:247], a[212:215], v[180:183], v[244:247]
    buffer_load_dwordx4 v36, s[20:23], s50 offen offset:1024 lds
    v_mfma_f32_16x16x32_bf16 v[232:235], a[216:219], v[176:179], v[232:235]
    ds_read_b64_tr_b16 a[200:201], v26 offset:8192
    v_mfma_f32_16x16x32_bf16 v[248:251], a[216:219], v[180:183], v[248:251]
    ds_read_b64_tr_b16 a[202:203], v26 offset:10240
    v_mfma_f32_16x16x32_bf16 v[236:239], a[220:223], v[176:179], v[236:239]
    ds_read_b64_tr_b16 a[204:205], v27 offset:8192
    ds_read_b64_tr_b16 a[206:207], v27 offset:10240
    v_mfma_f32_16x16x32_bf16 v[252:255], a[220:223], v[180:183], v[252:255]
    buffer_load_dwordx4 v37, s[20:23], s50 offen offset:2048 lds
    s_add_u32 m0, s47, 6144
    s_waitcnt lgkmcnt(15)
    v_mfma_f32_16x16x32_bf16 v[192:195], a[224:227], a[144:147], 0
    ds_read_b64_tr_b16 a[208:209], v24 offset:12288
    v_mfma_f32_16x16x32_bf16 v[208:211], a[224:227], a[148:151], 0
    s_mov_b32 s50, 56064
    ds_read_b64_tr_b16 a[210:211], v24 offset:14336
    v_mfma_f32_16x16x32_bf16 v[196:199], a[228:231], a[144:147], 0
    ds_read_b64_tr_b16 a[212:213], v25 offset:12288
    ds_read_b64_tr_b16 a[214:215], v25 offset:14336
    v_mfma_f32_16x16x32_bf16 v[212:215], a[228:231], a[148:151], 0
    buffer_load_dwordx4 v35, s[20:23], s50 offen offset:0 lds
    v_mfma_f32_16x16x32_bf16 v[200:203], a[232:235], a[144:147], 0
    ds_read_b64_tr_b16 a[216:217], v26 offset:12288
    v_cvt_pk_bf16_f32 v80, v224, v225
    v_mfma_f32_16x16x32_bf16 v[216:219], a[232:235], a[148:151], 0
    ds_read_b64_tr_b16 a[218:219], v26 offset:14336
    v_cvt_pk_bf16_f32 v81, v226, v227
    v_mfma_f32_16x16x32_bf16 v[204:207], a[236:239], a[144:147], 0
    ds_read_b64_tr_b16 a[220:221], v27 offset:12288
    ds_read_b64_tr_b16 a[222:223], v27 offset:14336
    v_mfma_f32_16x16x32_bf16 v[220:223], a[236:239], a[148:151], 0
    buffer_load_dwordx4 v36, s[20:23], s50 offen offset:1024 lds
    s_waitcnt lgkmcnt(15)
    v_mfma_f32_16x16x32_bf16 v[192:195], a[240:243], a[152:155], v[192:195]
    ds_read_b64_tr_b16 a[224:225], v24 offset:16384
    v_cvt_pk_bf16_f32 v82, v228, v229
    v_mfma_f32_16x16x32_bf16 v[208:211], a[240:243], a[156:159], v[208:211]
    ds_read_b64_tr_b16 a[226:227], v24 offset:18432
    v_cvt_pk_bf16_f32 v83, v230, v231
    v_mfma_f32_16x16x32_bf16 v[196:199], a[244:247], a[152:155], v[196:199]
    ds_read_b64_tr_b16 a[228:229], v25 offset:16384
    ds_read_b64_tr_b16 a[230:231], v25 offset:18432
    v_mfma_f32_16x16x32_bf16 v[212:215], a[244:247], a[156:159], v[212:215]
    buffer_load_dwordx4 v37, s[20:23], s50 offen offset:2048 lds
    v_mfma_f32_16x16x32_bf16 v[200:203], a[248:251], a[152:155], v[200:203]
    ds_read_b64_tr_b16 a[232:233], v26 offset:16384
    v_cvt_pk_bf16_f32 v84, v232, v233
    v_mfma_f32_16x16x32_bf16 v[216:219], a[248:251], a[156:159], v[216:219]
    ds_read_b64_tr_b16 a[234:235], v26 offset:18432
    v_cvt_pk_bf16_f32 v85, v234, v235
    v_mfma_f32_16x16x32_bf16 v[204:207], a[252:255], a[152:155], v[204:207]
    ds_read_b64_tr_b16 a[236:237], v27 offset:16384
    v_cvt_pk_bf16_f32 v86, v236, v237
    v_mfma_f32_16x16x32_bf16 v[220:223], a[252:255], a[156:159], v[220:223]
    ds_read_b64_tr_b16 a[238:239], v27 offset:18432
    s_waitcnt lgkmcnt(15)
    v_mfma_f32_16x16x32_bf16 v[192:195], a[192:195], a[160:163], v[192:195]
    ds_read_b64_tr_b16 a[240:241], v24 offset:20480
    v_cvt_pk_bf16_f32 v87, v238, v239
    v_mfma_f32_16x16x32_bf16 v[208:211], a[192:195], a[164:167], v[208:211]
    ds_read_b64_tr_b16 a[242:243], v24 offset:22528
    v_cvt_pk_bf16_f32 v88, v240, v241
    v_mfma_f32_16x16x32_bf16 v[196:199], a[196:199], a[160:163], v[196:199]
    ds_read_b64_tr_b16 a[244:245], v25 offset:20480
    v_cvt_pk_bf16_f32 v89, v242, v243
    v_mfma_f32_16x16x32_bf16 v[212:215], a[196:199], a[164:167], v[212:215]
    ds_read_b64_tr_b16 a[246:247], v25 offset:22528
    v_cvt_pk_bf16_f32 v90, v244, v245
    v_mfma_f32_16x16x32_bf16 v[200:203], a[200:203], a[160:163], v[200:203]
    ds_read_b64_tr_b16 a[248:249], v26 offset:20480
    v_cvt_pk_bf16_f32 v91, v246, v247
    v_mfma_f32_16x16x32_bf16 v[216:219], a[200:203], a[164:167], v[216:219]
    ds_read_b64_tr_b16 a[250:251], v26 offset:22528
    v_cvt_pk_bf16_f32 v92, v248, v249
    v_mfma_f32_16x16x32_bf16 v[204:207], a[204:207], a[160:163], v[204:207]
    ds_read_b64_tr_b16 a[252:253], v27 offset:20480
    v_cvt_pk_bf16_f32 v93, v250, v251
    v_mfma_f32_16x16x32_bf16 v[220:223], a[204:207], a[164:167], v[220:223]
    s_mov_b32 s56, 3072
    ds_read_b64_tr_b16 a[254:255], v27 offset:22528
    v_cvt_pk_bf16_f32 v94, v252, v253
    v_cvt_pk_bf16_f32 v95, v254, v255
    s_waitcnt lgkmcnt(15)
    v_mfma_f32_16x16x32_bf16 v[192:195], a[208:211], a[168:171], v[192:195]
    ds_read_b64_tr_b16 a[192:193], v24 offset:24576
    ds_read_b64_tr_b16 a[194:195], v24 offset:26624
    v_mfma_f32_16x16x32_bf16 v[208:211], a[208:211], a[172:175], v[208:211]
    buffer_store_dwordx4 v[80:83], v38, s[32:35], s56 offen offset:0 sc1
    v_mfma_f32_16x16x32_bf16 v[196:199], a[212:215], a[168:171], v[196:199]
    ds_read_b64_tr_b16 a[196:197], v25 offset:24576
    v_mfma_f32_16x16x32_bf16 v[212:215], a[212:215], a[172:175], v[212:215]
    ds_read_b64_tr_b16 a[198:199], v25 offset:26624
    v_mfma_f32_16x16x32_bf16 v[200:203], a[216:219], a[168:171], v[200:203]
    ds_read_b64_tr_b16 a[200:201], v26 offset:24576
    ds_read_b64_tr_b16 a[202:203], v26 offset:26624
    v_mfma_f32_16x16x32_bf16 v[216:219], a[216:219], a[172:175], v[216:219]
    buffer_store_dwordx4 v[84:87], v38, s[32:35], s56 offen offset:512 sc1
    v_mfma_f32_16x16x32_bf16 v[204:207], a[220:223], a[168:171], v[204:207]
    ds_read_b64_tr_b16 a[204:205], v27 offset:24576
    v_mfma_f32_16x16x32_bf16 v[220:223], a[220:223], a[172:175], v[220:223]
    s_mov_b32 s56, 21504
    ds_read_b64_tr_b16 a[206:207], v27 offset:26624
    s_waitcnt lgkmcnt(15)
    v_mfma_f32_16x16x32_bf16 v[192:195], a[224:227], a[176:179], v[192:195]
    ds_read_b64_tr_b16 a[208:209], v24 offset:28672
    ds_read_b64_tr_b16 a[210:211], v24 offset:30720
    v_mfma_f32_16x16x32_bf16 v[208:211], a[224:227], a[180:183], v[208:211]
    buffer_store_dwordx4 v[88:91], v38, s[32:35], s56 offen offset:0 sc1
    v_mfma_f32_16x16x32_bf16 v[196:199], a[228:231], a[176:179], v[196:199]
    ds_read_b64_tr_b16 a[212:213], v25 offset:28672
    v_mfma_f32_16x16x32_bf16 v[212:215], a[228:231], a[180:183], v[212:215]
    ds_read_b64_tr_b16 a[214:215], v25 offset:30720
    v_mfma_f32_16x16x32_bf16 v[200:203], a[232:235], a[176:179], v[200:203]
    ds_read_b64_tr_b16 a[216:217], v26 offset:28672
    ds_read_b64_tr_b16 a[218:219], v26 offset:30720
    v_mfma_f32_16x16x32_bf16 v[216:219], a[232:235], a[180:183], v[216:219]
    buffer_store_dwordx4 v[92:95], v38, s[32:35], s56 offen offset:512 sc1
    v_mfma_f32_16x16x32_bf16 v[204:207], a[236:239], a[176:179], v[204:207]
    ds_read_b64_tr_b16 a[220:221], v27 offset:28672
    v_mfma_f32_16x16x32_bf16 v[220:223], a[236:239], a[180:183], v[220:223]
    ds_read_b64_tr_b16 a[222:223], v27 offset:30720
    s_waitcnt lgkmcnt(15)
    v_mfma_f32_16x16x32_bf16 v[192:195], a[240:243], a[184:187], v[192:195]
    ds_read_b64_tr_b16 a[224:225], v24 offset:32768
    v_mfma_f32_16x16x32_bf16 v[208:211], a[240:243], a[188:191], v[208:211]
    ds_read_b64_tr_b16 a[226:227], v24 offset:34816
    v_mfma_f32_16x16x32_bf16 v[196:199], a[244:247], a[184:187], v[196:199]
    ds_read_b64_tr_b16 a[228:229], v25 offset:32768
    v_mfma_f32_16x16x32_bf16 v[212:215], a[244:247], a[188:191], v[212:215]
    ds_read_b64_tr_b16 a[230:231], v25 offset:34816
    v_mfma_f32_16x16x32_bf16 v[200:203], a[248:251], a[184:187], v[200:203]
    ds_read_b64_tr_b16 a[232:233], v26 offset:32768
    v_mfma_f32_16x16x32_bf16 v[216:219], a[248:251], a[188:191], v[216:219]
    ds_read_b64_tr_b16 a[234:235], v26 offset:34816
    v_mfma_f32_16x16x32_bf16 v[204:207], a[252:255], a[184:187], v[204:207]
    ds_read_b64_tr_b16 a[236:237], v27 offset:32768
    v_mfma_f32_16x16x32_bf16 v[220:223], a[252:255], a[188:191], v[220:223]
    s_add_u32 m0, s47, 36864
    ds_read_b64_tr_b16 a[238:239], v27 offset:34816
    s_waitcnt vmcnt(17)
    s_barrier
    s_waitcnt lgkmcnt(15)
    v_mfma_f32_16x16x32_bf16 v[192:195], a[192:195], v[160:163], v[192:195]
    ds_read_b64_tr_b16 a[240:241], v28 offset:0
    v_mfma_f32_16x16x32_bf16 v[208:211], a[192:195], v[164:167], v[208:211]
    s_mov_b32 s50, 896
    ds_read_b64_tr_b16 a[242:243], v28 offset:2048
    v_mfma_f32_16x16x32_bf16 v[196:199], a[196:199], v[160:163], v[196:199]
    ds_read_b64_tr_b16 a[244:245], v29 offset:0
    ds_read_b64_tr_b16 a[246:247], v29 offset:2048
    v_mfma_f32_16x16x32_bf16 v[212:215], a[196:199], v[164:167], v[212:215]
    buffer_load_dwordx4 v35, s[20:23], s50 offen offset:0 lds
    v_mfma_f32_16x16x32_bf16 v[200:203], a[200:203], v[160:163], v[200:203]
    ds_read_b64_tr_b16 a[248:249], v30 offset:0
    v_mfma_f32_16x16x32_bf16 v[216:219], a[200:203], v[164:167], v[216:219]
    ds_read_b64_tr_b16 a[250:251], v30 offset:2048
    v_mfma_f32_16x16x32_bf16 v[204:207], a[204:207], v[160:163], v[204:207]
    ds_read_b64_tr_b16 a[252:253], v31 offset:0
    ds_read_b64_tr_b16 a[254:255], v31 offset:2048
    v_mfma_f32_16x16x32_bf16 v[220:223], a[204:207], v[164:167], v[220:223]
    buffer_load_dwordx4 v36, s[20:23], s50 offen offset:1024 lds
    s_waitcnt lgkmcnt(15)
    v_mfma_f32_16x16x32_bf16 v[192:195], a[208:211], v[168:171], v[192:195]
    ds_read_b64_tr_b16 a[192:193], v28 offset:4096
    v_mfma_f32_16x16x32_bf16 v[208:211], a[208:211], v[172:175], v[208:211]
    ds_read_b64_tr_b16 a[194:195], v28 offset:6144
    v_mfma_f32_16x16x32_bf16 v[196:199], a[212:215], v[168:171], v[196:199]
    ds_read_b64_tr_b16 a[196:197], v29 offset:4096
    ds_read_b64_tr_b16 a[198:199], v29 offset:6144
    v_mfma_f32_16x16x32_bf16 v[212:215], a[212:215], v[172:175], v[212:215]
    buffer_load_dwordx4 v37, s[20:23], s50 offen offset:2048 lds
    s_add_u32 m0, s47, 39936
    v_mfma_f32_16x16x32_bf16 v[200:203], a[216:219], v[168:171], v[200:203]
    ds_read_b64_tr_b16 a[200:201], v30 offset:4096
    v_mfma_f32_16x16x32_bf16 v[216:219], a[216:219], v[172:175], v[216:219]
    s_mov_b32 s50, 28544
    ds_read_b64_tr_b16 a[202:203], v30 offset:6144
    v_mfma_f32_16x16x32_bf16 v[204:207], a[220:223], v[168:171], v[204:207]
    ds_read_b64_tr_b16 a[204:205], v31 offset:4096
    ds_read_b64_tr_b16 a[206:207], v31 offset:6144
    v_mfma_f32_16x16x32_bf16 v[220:223], a[220:223], v[172:175], v[220:223]
    buffer_load_dwordx4 v35, s[20:23], s50 offen offset:0 lds
    s_waitcnt lgkmcnt(15)
    v_mfma_f32_16x16x32_bf16 v[192:195], a[224:227], v[176:179], v[192:195]
    ds_read_b64_tr_b16 a[208:209], v28 offset:8192
    v_mfma_f32_16x16x32_bf16 v[208:211], a[224:227], v[180:183], v[208:211]
    ds_read_b64_tr_b16 a[210:211], v28 offset:10240
    v_mfma_f32_16x16x32_bf16 v[196:199], a[228:231], v[176:179], v[196:199]
    ds_read_b64_tr_b16 a[212:213], v29 offset:8192
    ds_read_b64_tr_b16 a[214:215], v29 offset:10240
    v_mfma_f32_16x16x32_bf16 v[212:215], a[228:231], v[180:183], v[212:215]
    buffer_load_dwordx4 v36, s[20:23], s50 offen offset:1024 lds
    v_mfma_f32_16x16x32_bf16 v[200:203], a[232:235], v[176:179], v[200:203]
    ds_read_b64_tr_b16 a[216:217], v30 offset:8192
    v_mfma_f32_16x16x32_bf16 v[216:219], a[232:235], v[180:183], v[216:219]
    ds_read_b64_tr_b16 a[218:219], v30 offset:10240
    v_mfma_f32_16x16x32_bf16 v[204:207], a[236:239], v[176:179], v[204:207]
    ds_read_b64_tr_b16 a[220:221], v31 offset:8192
    ds_read_b64_tr_b16 a[222:223], v31 offset:10240
    v_mfma_f32_16x16x32_bf16 v[220:223], a[236:239], v[180:183], v[220:223]
    buffer_load_dwordx4 v37, s[20:23], s50 offen offset:2048 lds
    s_add_u32 m0, s47, 43008
    s_waitcnt lgkmcnt(15)
    v_mfma_f32_16x16x32_bf16 v[224:227], a[240:243], a[144:147], 0
    ds_read_b64_tr_b16 a[224:225], v28 offset:12288
    v_mfma_f32_16x16x32_bf16 v[240:243], a[240:243], a[148:151], 0
    s_mov_b32 s50, 56192
    ds_read_b64_tr_b16 a[226:227], v28 offset:14336
    v_mfma_f32_16x16x32_bf16 v[228:231], a[244:247], a[144:147], 0
    ds_read_b64_tr_b16 a[228:229], v29 offset:12288
    ds_read_b64_tr_b16 a[230:231], v29 offset:14336
    v_mfma_f32_16x16x32_bf16 v[244:247], a[244:247], a[148:151], 0
    buffer_load_dwordx4 v35, s[20:23], s50 offen offset:0 lds
    v_mfma_f32_16x16x32_bf16 v[232:235], a[248:251], a[144:147], 0
    ds_read_b64_tr_b16 a[232:233], v30 offset:12288
    v_cvt_pk_bf16_f32 v64, v192, v193
    v_mfma_f32_16x16x32_bf16 v[248:251], a[248:251], a[148:151], 0
    ds_read_b64_tr_b16 a[234:235], v30 offset:14336
    v_cvt_pk_bf16_f32 v65, v194, v195
    v_mfma_f32_16x16x32_bf16 v[236:239], a[252:255], a[144:147], 0
    ds_read_b64_tr_b16 a[236:237], v31 offset:12288
    ds_read_b64_tr_b16 a[238:239], v31 offset:14336
    v_mfma_f32_16x16x32_bf16 v[252:255], a[252:255], a[148:151], 0
    buffer_load_dwordx4 v36, s[20:23], s50 offen offset:1024 lds
    s_waitcnt lgkmcnt(15)
    v_mfma_f32_16x16x32_bf16 v[224:227], a[192:195], a[152:155], v[224:227]
    ds_read_b64_tr_b16 a[240:241], v28 offset:16384
    v_cvt_pk_bf16_f32 v66, v196, v197
    v_mfma_f32_16x16x32_bf16 v[240:243], a[192:195], a[156:159], v[240:243]
    ds_read_b64_tr_b16 a[242:243], v28 offset:18432
    v_cvt_pk_bf16_f32 v67, v198, v199
    v_mfma_f32_16x16x32_bf16 v[228:231], a[196:199], a[152:155], v[228:231]
    ds_read_b64_tr_b16 a[244:245], v29 offset:16384
    ds_read_b64_tr_b16 a[246:247], v29 offset:18432
    v_mfma_f32_16x16x32_bf16 v[244:247], a[196:199], a[156:159], v[244:247]
    buffer_load_dwordx4 v37, s[20:23], s50 offen offset:2048 lds
    v_mfma_f32_16x16x32_bf16 v[232:235], a[200:203], a[152:155], v[232:235]
    ds_read_b64_tr_b16 a[248:249], v30 offset:16384
    v_cvt_pk_bf16_f32 v68, v200, v201
    v_mfma_f32_16x16x32_bf16 v[248:251], a[200:203], a[156:159], v[248:251]
    ds_read_b64_tr_b16 a[250:251], v30 offset:18432
    v_cvt_pk_bf16_f32 v69, v202, v203
    v_mfma_f32_16x16x32_bf16 v[236:239], a[204:207], a[152:155], v[236:239]
    ds_read_b64_tr_b16 a[252:253], v31 offset:16384
    v_cvt_pk_bf16_f32 v70, v204, v205
    v_mfma_f32_16x16x32_bf16 v[252:255], a[204:207], a[156:159], v[252:255]
    ds_read_b64_tr_b16 a[254:255], v31 offset:18432
    s_waitcnt lgkmcnt(15)
    v_mfma_f32_16x16x32_bf16 v[224:227], a[208:211], a[160:163], v[224:227]
    ds_read_b64_tr_b16 a[192:193], v28 offset:20480
    v_cvt_pk_bf16_f32 v71, v206, v207
    v_mfma_f32_16x16x32_bf16 v[240:243], a[208:211], a[164:167], v[240:243]
    ds_read_b64_tr_b16 a[194:195], v28 offset:22528
    v_cvt_pk_bf16_f32 v72, v208, v209
    v_mfma_f32_16x16x32_bf16 v[228:231], a[212:215], a[160:163], v[228:231]
    ds_read_b64_tr_b16 a[196:197], v29 offset:20480
    v_cvt_pk_bf16_f32 v73, v210, v211
    v_mfma_f32_16x16x32_bf16 v[244:247], a[212:215], a[164:167], v[244:247]
    ds_read_b64_tr_b16 a[198:199], v29 offset:22528
    v_cvt_pk_bf16_f32 v74, v212, v213
    v_mfma_f32_16x16x32_bf16 v[232:235], a[216:219], a[160:163], v[232:235]
    ds_read_b64_tr_b16 a[200:201], v30 offset:20480
    v_cvt_pk_bf16_f32 v75, v214, v215
    v_mfma_f32_16x16x32_bf16 v[248:251], a[216:219], a[164:167], v[248:251]
    ds_read_b64_tr_b16 a[202:203], v30 offset:22528
    v_cvt_pk_bf16_f32 v76, v216, v217
    v_mfma_f32_16x16x32_bf16 v[236:239], a[220:223], a[160:163], v[236:239]
    ds_read_b64_tr_b16 a[204:205], v31 offset:20480
    v_cvt_pk_bf16_f32 v77, v218, v219
    v_mfma_f32_16x16x32_bf16 v[252:255], a[220:223], a[164:167], v[252:255]
    s_mov_b32 s56, 4096
    ds_read_b64_tr_b16 a[206:207], v31 offset:22528
    v_cvt_pk_bf16_f32 v78, v220, v221
    v_cvt_pk_bf16_f32 v79, v222, v223
    s_waitcnt lgkmcnt(15)
    v_mfma_f32_16x16x32_bf16 v[224:227], a[224:227], a[168:171], v[224:227]
    ds_read_b64_tr_b16 a[208:209], v28 offset:24576
    ds_read_b64_tr_b16 a[210:211], v28 offset:26624
    v_mfma_f32_16x16x32_bf16 v[240:243], a[224:227], a[172:175], v[240:243]
    buffer_store_dwordx4 v[64:67], v38, s[32:35], s56 offen offset:0 sc1
    v_mfma_f32_16x16x32_bf16 v[228:231], a[228:231], a[168:171], v[228:231]
    ds_read_b64_tr_b16 a[212:213], v29 offset:24576
    v_mfma_f32_16x16x32_bf16 v[244:247], a[228:231], a[172:175], v[244:247]
    ds_read_b64_tr_b16 a[214:215], v29 offset:26624
    v_mfma_f32_16x16x32_bf16 v[232:235], a[232:235], a[168:171], v[232:235]
    ds_read_b64_tr_b16 a[216:217], v30 offset:24576
    ds_read_b64_tr_b16 a[218:219], v30 offset:26624
    v_mfma_f32_16x16x32_bf16 v[248:251], a[232:235], a[172:175], v[248:251]
    buffer_store_dwordx4 v[68:71], v38, s[32:35], s56 offen offset:512 sc1
    v_mfma_f32_16x16x32_bf16 v[236:239], a[236:239], a[168:171], v[236:239]
    ds_read_b64_tr_b16 a[220:221], v31 offset:24576
    v_mfma_f32_16x16x32_bf16 v[252:255], a[236:239], a[172:175], v[252:255]
    s_mov_b32 s56, 22528
    ds_read_b64_tr_b16 a[222:223], v31 offset:26624
    s_waitcnt lgkmcnt(15)
    v_mfma_f32_16x16x32_bf16 v[224:227], a[240:243], a[176:179], v[224:227]
    ds_read_b64_tr_b16 a[224:225], v28 offset:28672
    ds_read_b64_tr_b16 a[226:227], v28 offset:30720
    v_mfma_f32_16x16x32_bf16 v[240:243], a[240:243], a[180:183], v[240:243]
    buffer_store_dwordx4 v[72:75], v38, s[32:35], s56 offen offset:0 sc1
    v_mfma_f32_16x16x32_bf16 v[228:231], a[244:247], a[176:179], v[228:231]
    ds_read_b64_tr_b16 a[228:229], v29 offset:28672
    v_mfma_f32_16x16x32_bf16 v[244:247], a[244:247], a[180:183], v[244:247]
    ds_read_b64_tr_b16 a[230:231], v29 offset:30720
    v_mfma_f32_16x16x32_bf16 v[232:235], a[248:251], a[176:179], v[232:235]
    ds_read_b64_tr_b16 a[232:233], v30 offset:28672
    ds_read_b64_tr_b16 a[234:235], v30 offset:30720
    v_mfma_f32_16x16x32_bf16 v[248:251], a[248:251], a[180:183], v[248:251]
    buffer_store_dwordx4 v[76:79], v38, s[32:35], s56 offen offset:512 sc1
    v_mfma_f32_16x16x32_bf16 v[236:239], a[252:255], a[176:179], v[236:239]
    ds_read_b64_tr_b16 a[236:237], v31 offset:28672
    v_mfma_f32_16x16x32_bf16 v[252:255], a[252:255], a[180:183], v[252:255]
    ds_read_b64_tr_b16 a[238:239], v31 offset:30720
    s_waitcnt lgkmcnt(15)
    v_mfma_f32_16x16x32_bf16 v[224:227], a[192:195], a[184:187], v[224:227]
    ds_read_b64_tr_b16 a[240:241], v28 offset:32768
    v_mfma_f32_16x16x32_bf16 v[240:243], a[192:195], a[188:191], v[240:243]
    ds_read_b64_tr_b16 a[242:243], v28 offset:34816
    v_mfma_f32_16x16x32_bf16 v[228:231], a[196:199], a[184:187], v[228:231]
    ds_read_b64_tr_b16 a[244:245], v29 offset:32768
    v_mfma_f32_16x16x32_bf16 v[244:247], a[196:199], a[188:191], v[244:247]
    ds_read_b64_tr_b16 a[246:247], v29 offset:34816
    v_mfma_f32_16x16x32_bf16 v[232:235], a[200:203], a[184:187], v[232:235]
    ds_read_b64_tr_b16 a[248:249], v30 offset:32768
    v_mfma_f32_16x16x32_bf16 v[248:251], a[200:203], a[188:191], v[248:251]
    ds_read_b64_tr_b16 a[250:251], v30 offset:34816
    v_mfma_f32_16x16x32_bf16 v[236:239], a[204:207], a[184:187], v[236:239]
    ds_read_b64_tr_b16 a[252:253], v31 offset:32768
    v_mfma_f32_16x16x32_bf16 v[252:255], a[204:207], a[188:191], v[252:255]
    s_add_u32 m0, s47, 73728
    ds_read_b64_tr_b16 a[254:255], v31 offset:34816
    s_waitcnt vmcnt(17)
    s_barrier
    s_waitcnt lgkmcnt(15)
    v_mfma_f32_16x16x32_bf16 v[224:227], a[208:211], v[160:163], v[224:227]
    ds_read_b64_tr_b16 a[192:193], v16 offset:0
    v_mfma_f32_16x16x32_bf16 v[240:243], a[208:211], v[164:167], v[240:243]
    s_mov_b32 s50, 1024
    ds_read_b64_tr_b16 a[194:195], v16 offset:2048
    v_mfma_f32_16x16x32_bf16 v[228:231], a[212:215], v[160:163], v[228:231]
    ds_read_b64_tr_b16 a[196:197], v17 offset:0
    ds_read_b64_tr_b16 a[198:199], v17 offset:2048
    v_mfma_f32_16x16x32_bf16 v[244:247], a[212:215], v[164:167], v[244:247]
    buffer_load_dwordx4 v35, s[20:23], s50 offen offset:0 lds
    v_mfma_f32_16x16x32_bf16 v[232:235], a[216:219], v[160:163], v[232:235]
    ds_read_b64_tr_b16 a[200:201], v18 offset:0
    v_mfma_f32_16x16x32_bf16 v[248:251], a[216:219], v[164:167], v[248:251]
    ds_read_b64_tr_b16 a[202:203], v18 offset:2048
    v_mfma_f32_16x16x32_bf16 v[236:239], a[220:223], v[160:163], v[236:239]
    ds_read_b64_tr_b16 a[204:205], v19 offset:0
    ds_read_b64_tr_b16 a[206:207], v19 offset:2048
    v_mfma_f32_16x16x32_bf16 v[252:255], a[220:223], v[164:167], v[252:255]
    buffer_load_dwordx4 v36, s[20:23], s50 offen offset:1024 lds
    s_waitcnt lgkmcnt(15)
    v_mfma_f32_16x16x32_bf16 v[224:227], a[224:227], v[168:171], v[224:227]
    ds_read_b64_tr_b16 a[208:209], v16 offset:4096
    v_mfma_f32_16x16x32_bf16 v[240:243], a[224:227], v[172:175], v[240:243]
    ds_read_b64_tr_b16 a[210:211], v16 offset:6144
    v_mfma_f32_16x16x32_bf16 v[228:231], a[228:231], v[168:171], v[228:231]
    ds_read_b64_tr_b16 a[212:213], v17 offset:4096
    ds_read_b64_tr_b16 a[214:215], v17 offset:6144
    v_mfma_f32_16x16x32_bf16 v[244:247], a[228:231], v[172:175], v[244:247]
    buffer_load_dwordx4 v37, s[20:23], s50 offen offset:2048 lds
    s_add_u32 m0, s47, 76800
    v_mfma_f32_16x16x32_bf16 v[232:235], a[232:235], v[168:171], v[232:235]
    ds_read_b64_tr_b16 a[216:217], v18 offset:4096
    v_mfma_f32_16x16x32_bf16 v[248:251], a[232:235], v[172:175], v[248:251]
    s_mov_b32 s50, 28672
    ds_read_b64_tr_b16 a[218:219], v18 offset:6144
    v_mfma_f32_16x16x32_bf16 v[236:239], a[236:239], v[168:171], v[236:239]
    ds_read_b64_tr_b16 a[220:221], v19 offset:4096
    ds_read_b64_tr_b16 a[222:223], v19 offset:6144
    v_mfma_f32_16x16x32_bf16 v[252:255], a[236:239], v[172:175], v[252:255]
    buffer_load_dwordx4 v35, s[20:23], s50 offen offset:0 lds
    s_waitcnt lgkmcnt(15)
    v_mfma_f32_16x16x32_bf16 v[224:227], a[240:243], v[176:179], v[224:227]
    ds_read_b64_tr_b16 a[224:225], v16 offset:8192
    v_mfma_f32_16x16x32_bf16 v[240:243], a[240:243], v[180:183], v[240:243]
    ds_read_b64_tr_b16 a[226:227], v16 offset:10240
    v_mfma_f32_16x16x32_bf16 v[228:231], a[244:247], v[176:179], v[228:231]
    ds_read_b64_tr_b16 a[228:229], v17 offset:8192
    ds_read_b64_tr_b16 a[230:231], v17 offset:10240
    v_mfma_f32_16x16x32_bf16 v[244:247], a[244:247], v[180:183], v[244:247]
    buffer_load_dwordx4 v36, s[20:23], s50 offen offset:1024 lds
    v_mfma_f32_16x16x32_bf16 v[232:235], a[248:251], v[176:179], v[232:235]
    ds_read_b64_tr_b16 a[232:233], v18 offset:8192
    v_mfma_f32_16x16x32_bf16 v[248:251], a[248:251], v[180:183], v[248:251]
    ds_read_b64_tr_b16 a[234:235], v18 offset:10240
    v_mfma_f32_16x16x32_bf16 v[236:239], a[252:255], v[176:179], v[236:239]
    ds_read_b64_tr_b16 a[236:237], v19 offset:8192
    ds_read_b64_tr_b16 a[238:239], v19 offset:10240
    v_mfma_f32_16x16x32_bf16 v[252:255], a[252:255], v[180:183], v[252:255]
    buffer_load_dwordx4 v37, s[20:23], s50 offen offset:2048 lds
    s_add_u32 m0, s47, 79872
    s_waitcnt lgkmcnt(15)
    v_mfma_f32_16x16x32_bf16 v[192:195], a[192:195], a[144:147], 0
    ds_read_b64_tr_b16 a[240:241], v16 offset:12288
    v_mfma_f32_16x16x32_bf16 v[208:211], a[192:195], a[148:151], 0
    s_mov_b32 s50, 56320
    ds_read_b64_tr_b16 a[242:243], v16 offset:14336
    v_mfma_f32_16x16x32_bf16 v[196:199], a[196:199], a[144:147], 0
    ds_read_b64_tr_b16 a[244:245], v17 offset:12288
    ds_read_b64_tr_b16 a[246:247], v17 offset:14336
    v_mfma_f32_16x16x32_bf16 v[212:215], a[196:199], a[148:151], 0
    buffer_load_dwordx4 v35, s[20:23], s50 offen offset:0 lds
    v_mfma_f32_16x16x32_bf16 v[200:203], a[200:203], a[144:147], 0
    ds_read_b64_tr_b16 a[248:249], v18 offset:12288
    v_cvt_pk_bf16_f32 v80, v224, v225
    v_mfma_f32_16x16x32_bf16 v[216:219], a[200:203], a[148:151], 0
    ds_read_b64_tr_b16 a[250:251], v18 offset:14336
    v_cvt_pk_bf16_f32 v81, v226, v227
    v_mfma_f32_16x16x32_bf16 v[204:207], a[204:207], a[144:147], 0
    ds_read_b64_tr_b16 a[252:253], v19 offset:12288
    ds_read_b64_tr_b16 a[254:255], v19 offset:14336
    v_mfma_f32_16x16x32_bf16 v[220:223], a[204:207], a[148:151], 0
    buffer_load_dwordx4 v36, s[20:23], s50 offen offset:1024 lds
    s_waitcnt lgkmcnt(15)
    v_mfma_f32_16x16x32_bf16 v[192:195], a[208:211], a[152:155], v[192:195]
    ds_read_b64_tr_b16 a[192:193], v16 offset:16384
    v_cvt_pk_bf16_f32 v82, v228, v229
    v_mfma_f32_16x16x32_bf16 v[208:211], a[208:211], a[156:159], v[208:211]
    ds_read_b64_tr_b16 a[194:195], v16 offset:18432
    v_cvt_pk_bf16_f32 v83, v230, v231
    v_mfma_f32_16x16x32_bf16 v[196:199], a[212:215], a[152:155], v[196:199]
    ds_read_b64_tr_b16 a[196:197], v17 offset:16384
    ds_read_b64_tr_b16 a[198:199], v17 offset:18432
    v_mfma_f32_16x16x32_bf16 v[212:215], a[212:215], a[156:159], v[212:215]
    buffer_load_dwordx4 v37, s[20:23], s50 offen offset:2048 lds
    v_mfma_f32_16x16x32_bf16 v[200:203], a[216:219], a[152:155], v[200:203]
    ds_read_b64_tr_b16 a[200:201], v18 offset:16384
    v_cvt_pk_bf16_f32 v84, v232, v233
    v_mfma_f32_16x16x32_bf16 v[216:219], a[216:219], a[156:159], v[216:219]
    ds_read_b64_tr_b16 a[202:203], v18 offset:18432
    v_cvt_pk_bf16_f32 v85, v234, v235
    v_mfma_f32_16x16x32_bf16 v[204:207], a[220:223], a[152:155], v[204:207]
    ds_read_b64_tr_b16 a[204:205], v19 offset:16384
    v_cvt_pk_bf16_f32 v86, v236, v237
    v_mfma_f32_16x16x32_bf16 v[220:223], a[220:223], a[156:159], v[220:223]
    ds_read_b64_tr_b16 a[206:207], v19 offset:18432
    s_waitcnt lgkmcnt(15)
    v_mfma_f32_16x16x32_bf16 v[192:195], a[224:227], a[160:163], v[192:195]
    ds_read_b64_tr_b16 a[208:209], v16 offset:20480
    v_cvt_pk_bf16_f32 v87, v238, v239
    v_mfma_f32_16x16x32_bf16 v[208:211], a[224:227], a[164:167], v[208:211]
    ds_read_b64_tr_b16 a[210:211], v16 offset:22528
    v_cvt_pk_bf16_f32 v88, v240, v241
    v_mfma_f32_16x16x32_bf16 v[196:199], a[228:231], a[160:163], v[196:199]
    ds_read_b64_tr_b16 a[212:213], v17 offset:20480
    v_cvt_pk_bf16_f32 v89, v242, v243
    v_mfma_f32_16x16x32_bf16 v[212:215], a[228:231], a[164:167], v[212:215]
    ds_read_b64_tr_b16 a[214:215], v17 offset:22528
    v_cvt_pk_bf16_f32 v90, v244, v245
    v_mfma_f32_16x16x32_bf16 v[200:203], a[232:235], a[160:163], v[200:203]
    ds_read_b64_tr_b16 a[216:217], v18 offset:20480
    v_cvt_pk_bf16_f32 v91, v246, v247
    v_mfma_f32_16x16x32_bf16 v[216:219], a[232:235], a[164:167], v[216:219]
    ds_read_b64_tr_b16 a[218:219], v18 offset:22528
    v_cvt_pk_bf16_f32 v92, v248, v249
    v_mfma_f32_16x16x32_bf16 v[204:207], a[236:239], a[160:163], v[204:207]
    ds_read_b64_tr_b16 a[220:221], v19 offset:20480
    v_cvt_pk_bf16_f32 v93, v250, v251
    v_mfma_f32_16x16x32_bf16 v[220:223], a[236:239], a[164:167], v[220:223]
    s_mov_b32 s56, 5120
    ds_read_b64_tr_b16 a[222:223], v19 offset:22528
    v_cvt_pk_bf16_f32 v94, v252, v253
    v_cvt_pk_bf16_f32 v95, v254, v255
    s_waitcnt lgkmcnt(15)
    v_mfma_f32_16x16x32_bf16 v[192:195], a[240:243], a[168:171], v[192:195]
    ds_read_b64_tr_b16 a[224:225], v16 offset:24576
    ds_read_b64_tr_b16 a[226:227], v16 offset:26624
    v_mfma_f32_16x16x32_bf16 v[208:211], a[240:243], a[172:175], v[208:211]
    buffer_store_dwordx4 v[80:83], v38, s[32:35], s56 offen offset:0 sc1
    v_mfma_f32_16x16x32_bf16 v[196:199], a[244:247], a[168:171], v[196:199]
    ds_read_b64_tr_b16 a[228:229], v17 offset:24576
    v_mfma_f32_16x16x32_bf16 v[212:215], a[244:247], a[172:175], v[212:215]
    ds_read_b64_tr_b16 a[230:231], v17 offset:26624
    v_mfma_f32_16x16x32_bf16 v[200:203], a[248:251], a[168:171], v[200:203]
    ds_read_b64_tr_b16 a[232:233], v18 offset:24576
    ds_read_b64_tr_b16 a[234:235], v18 offset:26624
    v_mfma_f32_16x16x32_bf16 v[216:219], a[248:251], a[172:175], v[216:219]
    buffer_store_dwordx4 v[84:87], v38, s[32:35], s56 offen offset:512 sc1
    v_mfma_f32_16x16x32_bf16 v[204:207], a[252:255], a[168:171], v[204:207]
    ds_read_b64_tr_b16 a[236:237], v19 offset:24576
    v_mfma_f32_16x16x32_bf16 v[220:223], a[252:255], a[172:175], v[220:223]
    s_mov_b32 s56, 23552
    ds_read_b64_tr_b16 a[238:239], v19 offset:26624
    s_waitcnt lgkmcnt(15)
    v_mfma_f32_16x16x32_bf16 v[192:195], a[192:195], a[176:179], v[192:195]
    ds_read_b64_tr_b16 a[240:241], v16 offset:28672
    ds_read_b64_tr_b16 a[242:243], v16 offset:30720
    v_mfma_f32_16x16x32_bf16 v[208:211], a[192:195], a[180:183], v[208:211]
    buffer_store_dwordx4 v[88:91], v38, s[32:35], s56 offen offset:0 sc1
    v_mfma_f32_16x16x32_bf16 v[196:199], a[196:199], a[176:179], v[196:199]
    ds_read_b64_tr_b16 a[244:245], v17 offset:28672
    v_mfma_f32_16x16x32_bf16 v[212:215], a[196:199], a[180:183], v[212:215]
    ds_read_b64_tr_b16 a[246:247], v17 offset:30720
    v_mfma_f32_16x16x32_bf16 v[200:203], a[200:203], a[176:179], v[200:203]
    ds_read_b64_tr_b16 a[248:249], v18 offset:28672
    ds_read_b64_tr_b16 a[250:251], v18 offset:30720
    v_mfma_f32_16x16x32_bf16 v[216:219], a[200:203], a[180:183], v[216:219]
    buffer_store_dwordx4 v[92:95], v38, s[32:35], s56 offen offset:512 sc1
    v_mfma_f32_16x16x32_bf16 v[204:207], a[204:207], a[176:179], v[204:207]
    ds_read_b64_tr_b16 a[252:253], v19 offset:28672
    v_mfma_f32_16x16x32_bf16 v[220:223], a[204:207], a[180:183], v[220:223]
    ds_read_b64_tr_b16 a[254:255], v19 offset:30720
    s_waitcnt lgkmcnt(15)
    v_mfma_f32_16x16x32_bf16 v[192:195], a[208:211], a[184:187], v[192:195]
    ds_read_b64_tr_b16 a[192:193], v16 offset:32768
    v_mfma_f32_16x16x32_bf16 v[208:211], a[208:211], a[188:191], v[208:211]
    ds_read_b64_tr_b16 a[194:195], v16 offset:34816
    v_mfma_f32_16x16x32_bf16 v[196:199], a[212:215], a[184:187], v[196:199]
    ds_read_b64_tr_b16 a[196:197], v17 offset:32768
    v_mfma_f32_16x16x32_bf16 v[212:215], a[212:215], a[188:191], v[212:215]
    ds_read_b64_tr_b16 a[198:199], v17 offset:34816
    v_mfma_f32_16x16x32_bf16 v[200:203], a[216:219], a[184:187], v[200:203]
    ds_read_b64_tr_b16 a[200:201], v18 offset:32768
    v_mfma_f32_16x16x32_bf16 v[216:219], a[216:219], a[188:191], v[216:219]
    ds_read_b64_tr_b16 a[202:203], v18 offset:34816
    v_mfma_f32_16x16x32_bf16 v[204:207], a[220:223], a[184:187], v[204:207]
    ds_read_b64_tr_b16 a[204:205], v19 offset:32768
    v_mfma_f32_16x16x32_bf16 v[220:223], a[220:223], a[188:191], v[220:223]
    ds_read_b64_tr_b16 a[206:207], v19 offset:34816
    s_waitcnt vmcnt(17)
    s_barrier
    s_waitcnt lgkmcnt(15)
    v_mfma_f32_16x16x32_bf16 v[192:195], a[224:227], v[160:163], v[192:195]
    ds_read_b64_tr_b16 a[208:209], v20 offset:0
    v_mfma_f32_16x16x32_bf16 v[208:211], a[224:227], v[164:167], v[208:211]
    ds_read_b64_tr_b16 a[210:211], v20 offset:2048
    v_mfma_f32_16x16x32_bf16 v[196:199], a[228:231], v[160:163], v[196:199]
    ds_read_b64_tr_b16 a[212:213], v21 offset:0
    v_mfma_f32_16x16x32_bf16 v[212:215], a[228:231], v[164:167], v[212:215]
    ds_read_b64_tr_b16 a[214:215], v21 offset:2048
    v_mfma_f32_16x16x32_bf16 v[200:203], a[232:235], v[160:163], v[200:203]
    ds_read_b64_tr_b16 a[216:217], v22 offset:0
    v_mfma_f32_16x16x32_bf16 v[216:219], a[232:235], v[164:167], v[216:219]
    ds_read_b64_tr_b16 a[218:219], v22 offset:2048
    v_mfma_f32_16x16x32_bf16 v[204:207], a[236:239], v[160:163], v[204:207]
    ds_read_b64_tr_b16 a[220:221], v23 offset:0
    v_mfma_f32_16x16x32_bf16 v[220:223], a[236:239], v[164:167], v[220:223]
    ds_read_b64_tr_b16 a[222:223], v23 offset:2048
    s_waitcnt lgkmcnt(15)
    v_mfma_f32_16x16x32_bf16 v[192:195], a[240:243], v[168:171], v[192:195]
    ds_read_b64_tr_b16 a[224:225], v20 offset:4096
    v_mfma_f32_16x16x32_bf16 v[208:211], a[240:243], v[172:175], v[208:211]
    ds_read_b64_tr_b16 a[226:227], v20 offset:6144
    v_mfma_f32_16x16x32_bf16 v[196:199], a[244:247], v[168:171], v[196:199]
    ds_read_b64_tr_b16 a[228:229], v21 offset:4096
    v_mfma_f32_16x16x32_bf16 v[212:215], a[244:247], v[172:175], v[212:215]
    ds_read_b64_tr_b16 a[230:231], v21 offset:6144
    v_mfma_f32_16x16x32_bf16 v[200:203], a[248:251], v[168:171], v[200:203]
    ds_read_b64_tr_b16 a[232:233], v22 offset:4096
    v_mfma_f32_16x16x32_bf16 v[216:219], a[248:251], v[172:175], v[216:219]
    ds_read_b64_tr_b16 a[234:235], v22 offset:6144
    v_mfma_f32_16x16x32_bf16 v[204:207], a[252:255], v[168:171], v[204:207]
    ds_read_b64_tr_b16 a[236:237], v23 offset:4096
    v_mfma_f32_16x16x32_bf16 v[220:223], a[252:255], v[172:175], v[220:223]
    ds_read_b64_tr_b16 a[238:239], v23 offset:6144
    s_waitcnt lgkmcnt(15)
    v_mfma_f32_16x16x32_bf16 v[192:195], a[192:195], v[176:179], v[192:195]
    ds_read_b64_tr_b16 a[240:241], v20 offset:8192
    v_mfma_f32_16x16x32_bf16 v[208:211], a[192:195], v[180:183], v[208:211]
    ds_read_b64_tr_b16 a[242:243], v20 offset:10240
    v_mfma_f32_16x16x32_bf16 v[196:199], a[196:199], v[176:179], v[196:199]
    ds_read_b64_tr_b16 a[244:245], v21 offset:8192
    v_mfma_f32_16x16x32_bf16 v[212:215], a[196:199], v[180:183], v[212:215]
    ds_read_b64_tr_b16 a[246:247], v21 offset:10240
    v_mfma_f32_16x16x32_bf16 v[200:203], a[200:203], v[176:179], v[200:203]
    ds_read_b64_tr_b16 a[248:249], v22 offset:8192
    v_mfma_f32_16x16x32_bf16 v[216:219], a[200:203], v[180:183], v[216:219]
    ds_read_b64_tr_b16 a[250:251], v22 offset:10240
    v_mfma_f32_16x16x32_bf16 v[204:207], a[204:207], v[176:179], v[204:207]
    ds_read_b64_tr_b16 a[252:253], v23 offset:8192
    v_mfma_f32_16x16x32_bf16 v[220:223], a[204:207], v[180:183], v[220:223]
    ds_read_b64_tr_b16 a[254:255], v23 offset:10240
    s_waitcnt lgkmcnt(15)
    v_mfma_f32_16x16x32_bf16 v[224:227], a[208:211], a[144:147], 0
    ds_read_b64_tr_b16 a[192:193], v20 offset:12288
    v_mfma_f32_16x16x32_bf16 v[240:243], a[208:211], a[148:151], 0
    ds_read_b64_tr_b16 a[194:195], v20 offset:14336
    v_mfma_f32_16x16x32_bf16 v[228:231], a[212:215], a[144:147], 0
    ds_read_b64_tr_b16 a[196:197], v21 offset:12288
    v_mfma_f32_16x16x32_bf16 v[244:247], a[212:215], a[148:151], 0
    ds_read_b64_tr_b16 a[198:199], v21 offset:14336
    v_cvt_pk_bf16_f32 v64, v192, v193
    v_mfma_f32_16x16x32_bf16 v[232:235], a[216:219], a[144:147], 0
    ds_read_b64_tr_b16 a[200:201], v22 offset:12288
    v_cvt_pk_bf16_f32 v65, v194, v195
    v_mfma_f32_16x16x32_bf16 v[248:251], a[216:219], a[148:151], 0
    ds_read_b64_tr_b16 a[202:203], v22 offset:14336
    v_cvt_pk_bf16_f32 v66, v196, v197
    v_mfma_f32_16x16x32_bf16 v[236:239], a[220:223], a[144:147], 0
    ds_read_b64_tr_b16 a[204:205], v23 offset:12288
    v_cvt_pk_bf16_f32 v67, v198, v199
    v_mfma_f32_16x16x32_bf16 v[252:255], a[220:223], a[148:151], 0
    ds_read_b64_tr_b16 a[206:207], v23 offset:14336
    s_waitcnt lgkmcnt(15)
    v_mfma_f32_16x16x32_bf16 v[224:227], a[224:227], a[152:155], v[224:227]
    ds_read_b64_tr_b16 a[208:209], v20 offset:16384
    v_cvt_pk_bf16_f32 v68, v200, v201
    v_mfma_f32_16x16x32_bf16 v[240:243], a[224:227], a[156:159], v[240:243]
    ds_read_b64_tr_b16 a[210:211], v20 offset:18432
    v_cvt_pk_bf16_f32 v69, v202, v203
    v_mfma_f32_16x16x32_bf16 v[228:231], a[228:231], a[152:155], v[228:231]
    ds_read_b64_tr_b16 a[212:213], v21 offset:16384
    v_cvt_pk_bf16_f32 v70, v204, v205
    v_mfma_f32_16x16x32_bf16 v[244:247], a[228:231], a[156:159], v[244:247]
    ds_read_b64_tr_b16 a[214:215], v21 offset:18432
    v_cvt_pk_bf16_f32 v71, v206, v207
    v_mfma_f32_16x16x32_bf16 v[232:235], a[232:235], a[152:155], v[232:235]
    ds_read_b64_tr_b16 a[216:217], v22 offset:16384
    v_cvt_pk_bf16_f32 v72, v208, v209
    v_mfma_f32_16x16x32_bf16 v[248:251], a[232:235], a[156:159], v[248:251]
    ds_read_b64_tr_b16 a[218:219], v22 offset:18432
    v_cvt_pk_bf16_f32 v73, v210, v211
    v_mfma_f32_16x16x32_bf16 v[236:239], a[236:239], a[152:155], v[236:239]
    ds_read_b64_tr_b16 a[220:221], v23 offset:16384
    v_cvt_pk_bf16_f32 v74, v212, v213
    v_mfma_f32_16x16x32_bf16 v[252:255], a[236:239], a[156:159], v[252:255]
    ds_read_b64_tr_b16 a[222:223], v23 offset:18432
    s_waitcnt lgkmcnt(15)
    v_mfma_f32_16x16x32_bf16 v[224:227], a[240:243], a[160:163], v[224:227]
    ds_read_b64_tr_b16 a[224:225], v20 offset:20480
    v_cvt_pk_bf16_f32 v75, v214, v215
    v_mfma_f32_16x16x32_bf16 v[240:243], a[240:243], a[164:167], v[240:243]
    ds_read_b64_tr_b16 a[226:227], v20 offset:22528
    v_cvt_pk_bf16_f32 v76, v216, v217
    v_mfma_f32_16x16x32_bf16 v[228:231], a[244:247], a[160:163], v[228:231]
    ds_read_b64_tr_b16 a[228:229], v21 offset:20480
    v_cvt_pk_bf16_f32 v77, v218, v219
    v_mfma_f32_16x16x32_bf16 v[244:247], a[244:247], a[164:167], v[244:247]
    ds_read_b64_tr_b16 a[230:231], v21 offset:22528
    v_cvt_pk_bf16_f32 v78, v220, v221
    v_mfma_f32_16x16x32_bf16 v[232:235], a[248:251], a[160:163], v[232:235]
    ds_read_b64_tr_b16 a[232:233], v22 offset:20480
    v_cvt_pk_bf16_f32 v79, v222, v223
    v_mfma_f32_16x16x32_bf16 v[248:251], a[248:251], a[164:167], v[248:251]
    ds_read_b64_tr_b16 a[234:235], v22 offset:22528
    v_mfma_f32_16x16x32_bf16 v[236:239], a[252:255], a[160:163], v[236:239]
    ds_read_b64_tr_b16 a[236:237], v23 offset:20480
    v_mfma_f32_16x16x32_bf16 v[252:255], a[252:255], a[164:167], v[252:255]
    s_mov_b32 s56, 6144
    ds_read_b64_tr_b16 a[238:239], v23 offset:22528
    s_waitcnt lgkmcnt(15)
    v_mfma_f32_16x16x32_bf16 v[224:227], a[192:195], a[168:171], v[224:227]
    ds_read_b64_tr_b16 a[240:241], v20 offset:24576
    ds_read_b64_tr_b16 a[242:243], v20 offset:26624
    v_mfma_f32_16x16x32_bf16 v[240:243], a[192:195], a[172:175], v[240:243]
    buffer_store_dwordx4 v[64:67], v38, s[32:35], s56 offen offset:0 sc1
    v_mfma_f32_16x16x32_bf16 v[228:231], a[196:199], a[168:171], v[228:231]
    ds_read_b64_tr_b16 a[244:245], v21 offset:24576
    v_mfma_f32_16x16x32_bf16 v[244:247], a[196:199], a[172:175], v[244:247]
    ds_read_b64_tr_b16 a[246:247], v21 offset:26624
    v_mfma_f32_16x16x32_bf16 v[232:235], a[200:203], a[168:171], v[232:235]
    ds_read_b64_tr_b16 a[248:249], v22 offset:24576
    ds_read_b64_tr_b16 a[250:251], v22 offset:26624
    v_mfma_f32_16x16x32_bf16 v[248:251], a[200:203], a[172:175], v[248:251]
    buffer_store_dwordx4 v[68:71], v38, s[32:35], s56 offen offset:512 sc1
    v_mfma_f32_16x16x32_bf16 v[236:239], a[204:207], a[168:171], v[236:239]
    ds_read_b64_tr_b16 a[252:253], v23 offset:24576
    v_mfma_f32_16x16x32_bf16 v[252:255], a[204:207], a[172:175], v[252:255]
    s_mov_b32 s56, 24576
    ds_read_b64_tr_b16 a[254:255], v23 offset:26624
    s_waitcnt lgkmcnt(15)
    v_mfma_f32_16x16x32_bf16 v[224:227], a[208:211], a[176:179], v[224:227]
    ds_read_b64_tr_b16 a[192:193], v20 offset:28672
    ds_read_b64_tr_b16 a[194:195], v20 offset:30720
    v_mfma_f32_16x16x32_bf16 v[240:243], a[208:211], a[180:183], v[240:243]
    buffer_store_dwordx4 v[72:75], v38, s[32:35], s56 offen offset:0 sc1
    v_mfma_f32_16x16x32_bf16 v[228:231], a[212:215], a[176:179], v[228:231]
    ds_read_b64_tr_b16 a[196:197], v21 offset:28672
    v_mfma_f32_16x16x32_bf16 v[244:247], a[212:215], a[180:183], v[244:247]
    ds_read_b64_tr_b16 a[198:199], v21 offset:30720
    v_mfma_f32_16x16x32_bf16 v[232:235], a[216:219], a[176:179], v[232:235]
    ds_read_b64_tr_b16 a[200:201], v22 offset:28672
    ds_read_b64_tr_b16 a[202:203], v22 offset:30720
    v_mfma_f32_16x16x32_bf16 v[248:251], a[216:219], a[180:183], v[248:251]
    buffer_store_dwordx4 v[76:79], v38, s[32:35], s56 offen offset:512 sc1
    v_mfma_f32_16x16x32_bf16 v[236:239], a[220:223], a[176:179], v[236:239]
    ds_read_b64_tr_b16 a[204:205], v23 offset:28672
    v_mfma_f32_16x16x32_bf16 v[252:255], a[220:223], a[180:183], v[252:255]
    ds_read_b64_tr_b16 a[206:207], v23 offset:30720
    s_waitcnt lgkmcnt(15)
    v_mfma_f32_16x16x32_bf16 v[224:227], a[224:227], a[184:187], v[224:227]
    ds_read_b64_tr_b16 a[208:209], v20 offset:32768
    v_mfma_f32_16x16x32_bf16 v[240:243], a[224:227], a[188:191], v[240:243]
    ds_read_b64_tr_b16 a[210:211], v20 offset:34816
    v_mfma_f32_16x16x32_bf16 v[228:231], a[228:231], a[184:187], v[228:231]
    ds_read_b64_tr_b16 a[212:213], v21 offset:32768
    v_mfma_f32_16x16x32_bf16 v[244:247], a[228:231], a[188:191], v[244:247]
    ds_read_b64_tr_b16 a[214:215], v21 offset:34816
    v_mfma_f32_16x16x32_bf16 v[232:235], a[232:235], a[184:187], v[232:235]
    ds_read_b64_tr_b16 a[216:217], v22 offset:32768
    v_mfma_f32_16x16x32_bf16 v[248:251], a[232:235], a[188:191], v[248:251]
    ds_read_b64_tr_b16 a[218:219], v22 offset:34816
    v_mfma_f32_16x16x32_bf16 v[236:239], a[236:239], a[184:187], v[236:239]
    ds_read_b64_tr_b16 a[220:221], v23 offset:32768
    v_mfma_f32_16x16x32_bf16 v[252:255], a[236:239], a[188:191], v[252:255]
    ds_read_b64_tr_b16 a[222:223], v23 offset:34816
    s_waitcnt vmcnt(8)
    s_barrier
    s_waitcnt lgkmcnt(15)
    v_mfma_f32_16x16x32_bf16 v[224:227], a[240:243], v[160:163], v[224:227]
    ds_read_b64_tr_b16 a[224:225], v24 offset:0
    v_mfma_f32_16x16x32_bf16 v[240:243], a[240:243], v[164:167], v[240:243]
    ds_read_b64_tr_b16 a[226:227], v24 offset:2048
    v_mfma_f32_16x16x32_bf16 v[228:231], a[244:247], v[160:163], v[228:231]
    ds_read_b64_tr_b16 a[228:229], v25 offset:0
    v_mfma_f32_16x16x32_bf16 v[244:247], a[244:247], v[164:167], v[244:247]
    ds_read_b64_tr_b16 a[230:231], v25 offset:2048
    v_mfma_f32_16x16x32_bf16 v[232:235], a[248:251], v[160:163], v[232:235]
    ds_read_b64_tr_b16 a[232:233], v26 offset:0
    v_mfma_f32_16x16x32_bf16 v[248:251], a[248:251], v[164:167], v[248:251]
    ds_read_b64_tr_b16 a[234:235], v26 offset:2048
    v_mfma_f32_16x16x32_bf16 v[236:239], a[252:255], v[160:163], v[236:239]
    ds_read_b64_tr_b16 a[236:237], v27 offset:0
    v_mfma_f32_16x16x32_bf16 v[252:255], a[252:255], v[164:167], v[252:255]
    ds_read_b64_tr_b16 a[238:239], v27 offset:2048
    s_waitcnt lgkmcnt(15)
    v_mfma_f32_16x16x32_bf16 v[224:227], a[192:195], v[168:171], v[224:227]
    ds_read_b64_tr_b16 a[240:241], v24 offset:4096
    v_mfma_f32_16x16x32_bf16 v[240:243], a[192:195], v[172:175], v[240:243]
    ds_read_b64_tr_b16 a[242:243], v24 offset:6144
    v_mfma_f32_16x16x32_bf16 v[228:231], a[196:199], v[168:171], v[228:231]
    ds_read_b64_tr_b16 a[244:245], v25 offset:4096
    v_mfma_f32_16x16x32_bf16 v[244:247], a[196:199], v[172:175], v[244:247]
    ds_read_b64_tr_b16 a[246:247], v25 offset:6144
    v_mfma_f32_16x16x32_bf16 v[232:235], a[200:203], v[168:171], v[232:235]
    ds_read_b64_tr_b16 a[248:249], v26 offset:4096
    v_mfma_f32_16x16x32_bf16 v[248:251], a[200:203], v[172:175], v[248:251]
    ds_read_b64_tr_b16 a[250:251], v26 offset:6144
    v_mfma_f32_16x16x32_bf16 v[236:239], a[204:207], v[168:171], v[236:239]
    ds_read_b64_tr_b16 a[252:253], v27 offset:4096
    v_mfma_f32_16x16x32_bf16 v[252:255], a[204:207], v[172:175], v[252:255]
    ds_read_b64_tr_b16 a[254:255], v27 offset:6144
    s_waitcnt lgkmcnt(15)
    v_mfma_f32_16x16x32_bf16 v[224:227], a[208:211], v[176:179], v[224:227]
    ds_read_b64_tr_b16 a[192:193], v24 offset:8192
    v_mfma_f32_16x16x32_bf16 v[240:243], a[208:211], v[180:183], v[240:243]
    ds_read_b64_tr_b16 a[194:195], v24 offset:10240
    v_mfma_f32_16x16x32_bf16 v[228:231], a[212:215], v[176:179], v[228:231]
    ds_read_b64_tr_b16 a[196:197], v25 offset:8192
    v_mfma_f32_16x16x32_bf16 v[244:247], a[212:215], v[180:183], v[244:247]
    ds_read_b64_tr_b16 a[198:199], v25 offset:10240
    v_mfma_f32_16x16x32_bf16 v[232:235], a[216:219], v[176:179], v[232:235]
    ds_read_b64_tr_b16 a[200:201], v26 offset:8192
    v_mfma_f32_16x16x32_bf16 v[248:251], a[216:219], v[180:183], v[248:251]
    ds_read_b64_tr_b16 a[202:203], v26 offset:10240
    v_mfma_f32_16x16x32_bf16 v[236:239], a[220:223], v[176:179], v[236:239]
    ds_read_b64_tr_b16 a[204:205], v27 offset:8192
    v_mfma_f32_16x16x32_bf16 v[252:255], a[220:223], v[180:183], v[252:255]
    ds_read_b64_tr_b16 a[206:207], v27 offset:10240
    s_waitcnt lgkmcnt(15)
    v_mfma_f32_16x16x32_bf16 v[192:195], a[224:227], a[144:147], 0
    ds_read_b64_tr_b16 a[208:209], v24 offset:12288
    v_mfma_f32_16x16x32_bf16 v[208:211], a[224:227], a[148:151], 0
    ds_read_b64_tr_b16 a[210:211], v24 offset:14336
    v_mfma_f32_16x16x32_bf16 v[196:199], a[228:231], a[144:147], 0
    ds_read_b64_tr_b16 a[212:213], v25 offset:12288
    v_mfma_f32_16x16x32_bf16 v[212:215], a[228:231], a[148:151], 0
    ds_read_b64_tr_b16 a[214:215], v25 offset:14336
    v_cvt_pk_bf16_f32 v80, v224, v225
    v_mfma_f32_16x16x32_bf16 v[200:203], a[232:235], a[144:147], 0
    ds_read_b64_tr_b16 a[216:217], v26 offset:12288
    v_cvt_pk_bf16_f32 v81, v226, v227
    v_mfma_f32_16x16x32_bf16 v[216:219], a[232:235], a[148:151], 0
    ds_read_b64_tr_b16 a[218:219], v26 offset:14336
    v_cvt_pk_bf16_f32 v82, v228, v229
    v_mfma_f32_16x16x32_bf16 v[204:207], a[236:239], a[144:147], 0
    ds_read_b64_tr_b16 a[220:221], v27 offset:12288
    v_cvt_pk_bf16_f32 v83, v230, v231
    v_mfma_f32_16x16x32_bf16 v[220:223], a[236:239], a[148:151], 0
    ds_read_b64_tr_b16 a[222:223], v27 offset:14336
    s_waitcnt lgkmcnt(15)
    v_mfma_f32_16x16x32_bf16 v[192:195], a[240:243], a[152:155], v[192:195]
    ds_read_b64_tr_b16 a[224:225], v24 offset:16384
    v_cvt_pk_bf16_f32 v84, v232, v233
    v_mfma_f32_16x16x32_bf16 v[208:211], a[240:243], a[156:159], v[208:211]
    ds_read_b64_tr_b16 a[226:227], v24 offset:18432
    v_cvt_pk_bf16_f32 v85, v234, v235
    v_mfma_f32_16x16x32_bf16 v[196:199], a[244:247], a[152:155], v[196:199]
    ds_read_b64_tr_b16 a[228:229], v25 offset:16384
    v_cvt_pk_bf16_f32 v86, v236, v237
    v_mfma_f32_16x16x32_bf16 v[212:215], a[244:247], a[156:159], v[212:215]
    ds_read_b64_tr_b16 a[230:231], v25 offset:18432
    v_cvt_pk_bf16_f32 v87, v238, v239
    v_mfma_f32_16x16x32_bf16 v[200:203], a[248:251], a[152:155], v[200:203]
    ds_read_b64_tr_b16 a[232:233], v26 offset:16384
    v_cvt_pk_bf16_f32 v88, v240, v241
    v_mfma_f32_16x16x32_bf16 v[216:219], a[248:251], a[156:159], v[216:219]
    ds_read_b64_tr_b16 a[234:235], v26 offset:18432
    v_cvt_pk_bf16_f32 v89, v242, v243
    v_mfma_f32_16x16x32_bf16 v[204:207], a[252:255], a[152:155], v[204:207]
    ds_read_b64_tr_b16 a[236:237], v27 offset:16384
    v_cvt_pk_bf16_f32 v90, v244, v245
    v_mfma_f32_16x16x32_bf16 v[220:223], a[252:255], a[156:159], v[220:223]
    ds_read_b64_tr_b16 a[238:239], v27 offset:18432
    s_waitcnt lgkmcnt(15)
    v_mfma_f32_16x16x32_bf16 v[192:195], a[192:195], a[160:163], v[192:195]
    ds_read_b64_tr_b16 a[240:241], v24 offset:20480
    v_cvt_pk_bf16_f32 v91, v246, v247
    v_mfma_f32_16x16x32_bf16 v[208:211], a[192:195], a[164:167], v[208:211]
    ds_read_b64_tr_b16 a[242:243], v24 offset:22528
    v_cvt_pk_bf16_f32 v92, v248, v249
    v_mfma_f32_16x16x32_bf16 v[196:199], a[196:199], a[160:163], v[196:199]
    ds_read_b64_tr_b16 a[244:245], v25 offset:20480
    v_cvt_pk_bf16_f32 v93, v250, v251
    v_mfma_f32_16x16x32_bf16 v[212:215], a[196:199], a[164:167], v[212:215]
    ds_read_b64_tr_b16 a[246:247], v25 offset:22528
    v_cvt_pk_bf16_f32 v94, v252, v253
    v_mfma_f32_16x16x32_bf16 v[200:203], a[200:203], a[160:163], v[200:203]
    ds_read_b64_tr_b16 a[248:249], v26 offset:20480
    v_cvt_pk_bf16_f32 v95, v254, v255
    v_mfma_f32_16x16x32_bf16 v[216:219], a[200:203], a[164:167], v[216:219]
    ds_read_b64_tr_b16 a[250:251], v26 offset:22528
    v_mfma_f32_16x16x32_bf16 v[204:207], a[204:207], a[160:163], v[204:207]
    ds_read_b64_tr_b16 a[252:253], v27 offset:20480
    v_mfma_f32_16x16x32_bf16 v[220:223], a[204:207], a[164:167], v[220:223]
    s_mov_b32 s56, 7168
    ds_read_b64_tr_b16 a[254:255], v27 offset:22528
    s_waitcnt lgkmcnt(15)
    v_mfma_f32_16x16x32_bf16 v[192:195], a[208:211], a[168:171], v[192:195]
    ds_read_b64_tr_b16 a[192:193], v24 offset:24576
    ds_read_b64_tr_b16 a[194:195], v24 offset:26624
    v_mfma_f32_16x16x32_bf16 v[208:211], a[208:211], a[172:175], v[208:211]
    buffer_store_dwordx4 v[80:83], v38, s[32:35], s56 offen offset:0 sc1
    v_mfma_f32_16x16x32_bf16 v[196:199], a[212:215], a[168:171], v[196:199]
    ds_read_b64_tr_b16 a[196:197], v25 offset:24576
    v_mfma_f32_16x16x32_bf16 v[212:215], a[212:215], a[172:175], v[212:215]
    ds_read_b64_tr_b16 a[198:199], v25 offset:26624
    v_mfma_f32_16x16x32_bf16 v[200:203], a[216:219], a[168:171], v[200:203]
    ds_read_b64_tr_b16 a[200:201], v26 offset:24576
    ds_read_b64_tr_b16 a[202:203], v26 offset:26624
    v_mfma_f32_16x16x32_bf16 v[216:219], a[216:219], a[172:175], v[216:219]
    buffer_store_dwordx4 v[84:87], v38, s[32:35], s56 offen offset:512 sc1
    v_mfma_f32_16x16x32_bf16 v[204:207], a[220:223], a[168:171], v[204:207]
    ds_read_b64_tr_b16 a[204:205], v27 offset:24576
    v_mfma_f32_16x16x32_bf16 v[220:223], a[220:223], a[172:175], v[220:223]
    s_mov_b32 s56, 25600
    ds_read_b64_tr_b16 a[206:207], v27 offset:26624
    s_waitcnt lgkmcnt(15)
    v_mfma_f32_16x16x32_bf16 v[192:195], a[224:227], a[176:179], v[192:195]
    ds_read_b64_tr_b16 a[208:209], v24 offset:28672
    ds_read_b64_tr_b16 a[210:211], v24 offset:30720
    v_mfma_f32_16x16x32_bf16 v[208:211], a[224:227], a[180:183], v[208:211]
    buffer_store_dwordx4 v[88:91], v38, s[32:35], s56 offen offset:0 sc1
    v_mfma_f32_16x16x32_bf16 v[196:199], a[228:231], a[176:179], v[196:199]
    ds_read_b64_tr_b16 a[212:213], v25 offset:28672
    v_mfma_f32_16x16x32_bf16 v[212:215], a[228:231], a[180:183], v[212:215]
    ds_read_b64_tr_b16 a[214:215], v25 offset:30720
    v_mfma_f32_16x16x32_bf16 v[200:203], a[232:235], a[176:179], v[200:203]
    ds_read_b64_tr_b16 a[216:217], v26 offset:28672
    ds_read_b64_tr_b16 a[218:219], v26 offset:30720
    v_mfma_f32_16x16x32_bf16 v[216:219], a[232:235], a[180:183], v[216:219]
    buffer_store_dwordx4 v[92:95], v38, s[32:35], s56 offen offset:512 sc1
    v_mfma_f32_16x16x32_bf16 v[204:207], a[236:239], a[176:179], v[204:207]
    ds_read_b64_tr_b16 a[220:221], v27 offset:28672
    v_mfma_f32_16x16x32_bf16 v[220:223], a[236:239], a[180:183], v[220:223]
    ds_read_b64_tr_b16 a[222:223], v27 offset:30720
    s_waitcnt lgkmcnt(15)
    v_mfma_f32_16x16x32_bf16 v[192:195], a[240:243], a[184:187], v[192:195]
    ds_read_b64_tr_b16 a[224:225], v24 offset:32768
    v_mfma_f32_16x16x32_bf16 v[208:211], a[240:243], a[188:191], v[208:211]
    ds_read_b64_tr_b16 a[226:227], v24 offset:34816
    v_mfma_f32_16x16x32_bf16 v[196:199], a[244:247], a[184:187], v[196:199]
    ds_read_b64_tr_b16 a[228:229], v25 offset:32768
    v_mfma_f32_16x16x32_bf16 v[212:215], a[244:247], a[188:191], v[212:215]
    ds_read_b64_tr_b16 a[230:231], v25 offset:34816
    v_mfma_f32_16x16x32_bf16 v[200:203], a[248:251], a[184:187], v[200:203]
    ds_read_b64_tr_b16 a[232:233], v26 offset:32768
    v_mfma_f32_16x16x32_bf16 v[216:219], a[248:251], a[188:191], v[216:219]
    ds_read_b64_tr_b16 a[234:235], v26 offset:34816
    v_mfma_f32_16x16x32_bf16 v[204:207], a[252:255], a[184:187], v[204:207]
    ds_read_b64_tr_b16 a[236:237], v27 offset:32768
    v_mfma_f32_16x16x32_bf16 v[220:223], a[252:255], a[188:191], v[220:223]
    ds_read_b64_tr_b16 a[238:239], v27 offset:34816
    s_waitcnt lgkmcnt(15)
    v_mfma_f32_16x16x32_bf16 v[192:195], a[192:195], v[160:163], v[192:195]
    v_mfma_f32_16x16x32_bf16 v[208:211], a[192:195], v[164:167], v[208:211]
    v_mfma_f32_16x16x32_bf16 v[196:199], a[196:199], v[160:163], v[196:199]
    v_mfma_f32_16x16x32_bf16 v[212:215], a[196:199], v[164:167], v[212:215]
    v_mfma_f32_16x16x32_bf16 v[200:203], a[200:203], v[160:163], v[200:203]
    v_mfma_f32_16x16x32_bf16 v[216:219], a[200:203], v[164:167], v[216:219]
    v_mfma_f32_16x16x32_bf16 v[204:207], a[204:207], v[160:163], v[204:207]
    v_mfma_f32_16x16x32_bf16 v[220:223], a[204:207], v[164:167], v[220:223]
    s_waitcnt lgkmcnt(8)
    v_mfma_f32_16x16x32_bf16 v[192:195], a[208:211], v[168:171], v[192:195]
    v_mfma_f32_16x16x32_bf16 v[208:211], a[208:211], v[172:175], v[208:211]
    v_mfma_f32_16x16x32_bf16 v[196:199], a[212:215], v[168:171], v[196:199]
    v_mfma_f32_16x16x32_bf16 v[212:215], a[212:215], v[172:175], v[212:215]
    v_mfma_f32_16x16x32_bf16 v[200:203], a[216:219], v[168:171], v[200:203]
    v_mfma_f32_16x16x32_bf16 v[216:219], a[216:219], v[172:175], v[216:219]
    v_mfma_f32_16x16x32_bf16 v[204:207], a[220:223], v[168:171], v[204:207]
    v_mfma_f32_16x16x32_bf16 v[220:223], a[220:223], v[172:175], v[220:223]
    s_waitcnt lgkmcnt(0)
    v_mfma_f32_16x16x32_bf16 v[192:195], a[224:227], v[176:179], v[192:195]
    v_mfma_f32_16x16x32_bf16 v[208:211], a[224:227], v[180:183], v[208:211]
    v_mfma_f32_16x16x32_bf16 v[196:199], a[228:231], v[176:179], v[196:199]
    v_mfma_f32_16x16x32_bf16 v[212:215], a[228:231], v[180:183], v[212:215]
    v_mfma_f32_16x16x32_bf16 v[200:203], a[232:235], v[176:179], v[200:203]
    v_mfma_f32_16x16x32_bf16 v[216:219], a[232:235], v[180:183], v[216:219]
    v_mfma_f32_16x16x32_bf16 v[204:207], a[236:239], v[176:179], v[204:207]
    v_mfma_f32_16x16x32_bf16 v[220:223], a[236:239], v[180:183], v[220:223]
    s_nop 7
    v_cvt_pk_bf16_f32 v64, v192, v193
    v_cvt_pk_bf16_f32 v65, v194, v195
    v_cvt_pk_bf16_f32 v66, v196, v197
    v_cvt_pk_bf16_f32 v67, v198, v199
    s_mov_b32 s56, 8192
    buffer_store_dwordx4 v[64:67], v38, s[32:35], s56 offen offset:0 sc1
    v_cvt_pk_bf16_f32 v68, v200, v201
    v_cvt_pk_bf16_f32 v69, v202, v203
    v_cvt_pk_bf16_f32 v70, v204, v205
    v_cvt_pk_bf16_f32 v71, v206, v207
    s_mov_b32 s56, 8192
    buffer_store_dwordx4 v[68:71], v38, s[32:35], s56 offen offset:512 sc1
    v_cvt_pk_bf16_f32 v72, v208, v209
    v_cvt_pk_bf16_f32 v73, v210, v211
    v_cvt_pk_bf16_f32 v74, v212, v213
    v_cvt_pk_bf16_f32 v75, v214, v215
    s_mov_b32 s56, 26624
    buffer_store_dwordx4 v[72:75], v38, s[32:35], s56 offen offset:0 sc1
    v_cvt_pk_bf16_f32 v76, v216, v217
    v_cvt_pk_bf16_f32 v77, v218, v219
    v_cvt_pk_bf16_f32 v78, v220, v221
    v_cvt_pk_bf16_f32 v79, v222, v223
    s_mov_b32 s56, 26624
    buffer_store_dwordx4 v[76:79], v38, s[32:35], s56 offen offset:512 sc1
    s_load_dwordx2 s[8:9], s[0:1], 88
    s_lshl_b32 s56, s45, 4
    s_add_u32 s56, s56, s44
    s_mul_i32 s57, s56, 9216
    s_lshl_b32 s58, s45, 7
    s_add_u32 s58, s58, 7106560
    s_add_u32 s60, s40, s58
    s_addc_u32 s61, s41, 0
    s_mov_b32 s62, 0x40
    s_mov_b32 s63, 0x20000
    s_add_u32 s12, s40, 0x2b00000
    s_addc_u32 s13, s41, 0
    s_mov_b32 s14, 0x2400000
    s_mov_b32 s15, 0x20000
    s_add_u32 s16, s40, 0x480000
    s_addc_u32 s17, s41, 0
    s_mov_b32 s18, 0x240000
    s_mov_b32 s19, 0x20000
    s_add_u32 s28, s40, 0x6c2000
    s_addc_u32 s29, s41, 0
    s_mov_b32 s30, 0x2400
    s_mov_b32 s31, 0x20000
    v_lshlrev_b32 v16, 4, v0
    v_add_u32 v16, s57, v16
    v_add_u32 v17, 6144, v16
    v_and_b32 v18, 7, v0
    v_bfe_u32 v19, v0, 3, 2
    v_lshrrev_b32 v20, 5, v0
    v_lshlrev_b32 v21, 6, v20
    v_lshl_add_u32 v21, v19, 3, v21
    v_mul_u32_u24 v22, 1152, v18
    v_add3_u32 v22, v22, v21, s57
    v_lshlrev_b32 v23, 1, v21
    v_and_b32 v48, 15, v2
    v_lshlrev_b32 v48, 2, v48
    s_lshl_b32 s58, s44, 2
    v_mov_b32 v49, s58
    v_mov_b32 v50, 1
    s_mov_b32 s59, 0x80000
    s_waitcnt vmcnt(0) lgkmcnt(0)
    s_mov_b32 s10, 2359296
    s_mov_b32 s11, 0x20000
    s_barrier
    s_cmp_lg_u32 s46, 3
    s_cbranch_scc1 k4_kernel_fin
    s_mov_b64 exec, 1
    buffer_store_dword v50, v49, s[60:63], 0 offen sc1
    s_mov_b64 exec, -1
k4_kernel_poll3:
    buffer_load_dword v51, v48, s[60:63], 0 offen sc1
    s_waitcnt vmcnt(0)
    v_cmp_ne_u32 vcc, 1, v51
    s_sub_u32 s59, s59, 1
    s_cbranch_scc1 k4_kernel_got3
    s_cbranch_vccz k4_kernel_got3
    s_sleep 2
    s_branch k4_kernel_poll3
k4_kernel_got3:
    s_barrier
    s_endpgm
k4_kernel_fin:
    buffer_load_dwordx2 v[244:245], v22, s[16:19], 0 offen offset:0
    buffer_load_dwordx2 v[246:247], v22, s[16:19], 0 offen offset:32
    buffer_load_dwordx2 v[248:249], v22, s[16:19], 0 offen offset:384
    buffer_load_dwordx2 v[250:251], v22, s[16:19], 0 offen offset:416
    buffer_load_dwordx2 v[252:253], v22, s[16:19], 0 offen offset:768
    buffer_load_dwordx2 v[254:255], v22, s[16:19], 0 offen offset:800
    s_movk_i32 s59, 6912
    buffer_load_dwordx4 v[220:223], v23, s[28:31], s59 offen offset:0
    buffer_load_dwordx4 v[224:227], v23, s[28:31], s59 offen offset:64
    buffer_load_dwordx4 v[228:231], v23, s[28:31], s59 offen offset:768
    buffer_load_dwordx4 v[232:235], v23, s[28:31], s59 offen offset:832
    buffer_load_dwordx4 v[236:239], v23, s[28:31], s59 offen offset:1536
    buffer_load_dwordx4 v[240:243], v23, s[28:31], s59 offen offset:1600
    s_barrier
    s_mov_b32 s59, 0
    buffer_load_dwordx4 v[64:67], v16, s[12:15], s59 offen offset:0 sc1
    buffer_load_dwordx4 v[68:71], v16, s[12:15], s59 offen offset:3072 sc1
    buffer_load_dwordx4 v[72:75], v17, s[12:15], s59 offen offset:0 sc1
    s_mov_b32 s59, 2359296
    buffer_load_dwordx4 v[76:79], v16, s[12:15], s59 offen offset:0 sc1
    buffer_load_dwordx4 v[80:83], v16, s[12:15], s59 offen offset:3072 sc1
    buffer_load_dwordx4 v[84:87], v17, s[12:15], s59 offen offset:0 sc1
    s_mov_b32 s59, 4718592
    buffer_load_dwordx4 v[88:91], v16, s[12:15], s59 offen offset:0 sc1
    buffer_load_dwordx4 v[92:95], v16, s[12:15], s59 offen offset:3072 sc1
    buffer_load_dwordx4 v[96:99], v17, s[12:15], s59 offen offset:0 sc1
    s_mov_b32 s59, 7077888
    buffer_load_dwordx4 v[100:103], v16, s[12:15], s59 offen offset:0 sc1
    buffer_load_dwordx4 v[104:107], v16, s[12:15], s59 offen offset:3072 sc1
    buffer_load_dwordx4 v[108:111], v17, s[12:15], s59 offen offset:0 sc1
    s_mov_b32 s59, 9437184
    buffer_load_dwordx4 v[112:115], v16, s[12:15], s59 offen offset:0 sc1
    buffer_load_dwordx4 v[116:119], v16, s[12:15], s59 offen offset:3072 sc1
    buffer_load_dwordx4 v[120:123], v17, s[12:15], s59 offen offset:0 sc1
    s_mov_b32 s59, 11796480
    buffer_load_dwordx4 v[124:127], v16, s[12:15], s59 offen offset:0 sc1
    buffer_load_dwordx4 v[128:131], v16, s[12:15], s59 offen offset:3072 sc1
    buffer_load_dwordx4 v[132:135], v17, s[12:15], s59 offen offset:0 sc1
    s_mov_b32 s59, 14155776
    buffer_load_dwordx4 v[136:139], v16, s[12:15], s59 offen offset:0 sc1
    buffer_load_dwordx4 v[140:143], v16, s[12:15], s59 offen offset:3072 sc1
    buffer_load_dwordx4 v[144:147], v17, s[12:15], s59 offen offset:0 sc1
    s_mov_b32 s59, 16515072
    buffer_load_dwordx4 v[148:151], v16, s[12:15], s59 offen offset:0 sc1
    buffer_load_dwordx4 v[152:155], v16, s[12:15], s59 offen offset:3072 sc1
    buffer_load_dwordx4 v[156:159], v17, s[12:15], s59 offen offset:0 sc1
    s_mov_b32 s59, 18874368
    buffer_load_dwordx4 v[160:163], v16, s[12:15], s59 offen offset:0 sc1
    buffer_load_dwordx4 v[164:167], v16, s[12:15], s59 offen offset:3072 sc1
    buffer_load_dwordx4 v[168:171], v17, s[12:15], s59 offen offset:0 sc1
    s_mov_b32 s59, 21233664
    buffer_load_dwordx4 v[172:175], v16, s[12:15], s59 offen offset:0 sc1
    buffer_load_dwordx4 v[176:179], v16, s[12:15], s59 offen offset:3072 sc1
    buffer_load_dwordx4 v[180:183], v17, s[12:15], s59 offen offset:0 sc1
    s_mov_b32 s59, 23592960
    buffer_load_dwordx4 v[184:187], v16, s[12:15], s59 offen offset:0 sc1
    buffer_load_dwordx4 v[188:191], v16, s[12:15], s59 offen offset:3072 sc1
    buffer_load_dwordx4 v[192:195], v17, s[12:15], s59 offen offset:0 sc1
    s_mov_b32 s59, 25952256
    buffer_load_dwordx4 v[196:199], v16, s[12:15], s59 offen offset:0 sc1
    buffer_load_dwordx4 v[200:203], v16, s[12:15], s59 offen offset:3072 sc1
    buffer_load_dwordx4 v[204:207], v17, s[12:15], s59 offen offset:0 sc1
    s_mov_b32 s59, 28311552
    buffer_load_dwordx4 v[208:211], v16, s[12:15], s59 offen offset:0 sc1
    buffer_load_dwordx4 v[212:215], v16, s[12:15], s59 offen offset:3072 sc1
    buffer_load_dwordx4 v[216:219], v17, s[12:15], s59 offen offset:0 sc1
    s_mov_b32 s54, 0x3ef5fdf0
    s_mov_b32 s55, 0x3ef5fdf0
    s_waitcnt vmcnt(36)
    v_lshlrev_b32 v40, 16, v64
    v_and_b32 v41, s53, v64
    v_lshlrev_b32 v42, 16, v65
    v_and_b32 v43, s53, v65
    v_lshlrev_b32 v44, 16, v66
    v_and_b32 v45, s53, v66
    v_lshlrev_b32 v46, 16, v67
    v_and_b32 v47, s53, v67
    v_lshlrev_b32 v48, 16, v68
    v_and_b32 v49, s53, v68
    v_lshlrev_b32 v50, 16, v69
    v_and_b32 v51, s53, v69
    v_lshlrev_b32 v52, 16, v70
    v_and_b32 v53, s53, v70
    v_lshlrev_b32 v54, 16, v71
    v_and_b32 v55, s53, v71
    v_lshlrev_b32 v56, 16, v72
    v_and_b32 v57, s53, v72
    v_lshlrev_b32 v58, 16, v73
    v_and_b32 v59, s53, v73
    v_lshlrev_b32 v60, 16, v74
    v_and_b32 v61, s53, v74
    v_lshlrev_b32 v62, 16, v75
    v_and_b32 v63, s53, v75
    s_mov_b32 s59, 30670848
    buffer_load_dwordx4 v[64:67], v16, s[12:15], s59 offen offset:0 sc1
    buffer_load_dwordx4 v[68:71], v16, s[12:15], s59 offen offset:3072 sc1
    buffer_load_dwordx4 v[72:75], v17, s[12:15], s59 offen offset:0 sc1
    s_waitcnt vmcnt(36)
    v_lshlrev_b32 v8, 16, v76
    v_and_b32 v9, s53, v76
    v_lshlrev_b32 v10, 16, v77
    v_and_b32 v11, s53, v77
    v_lshlrev_b32 v12, 16, v78
    v_and_b32 v13, s53, v78
    v_lshlrev_b32 v14, 16, v79
    v_and_b32 v15, s53, v79
    v_pk_add_f32 v[40:41], v[40:41], v[8:9]
    v_pk_add_f32 v[42:43], v[42:43], v[10:11]
    v_pk_add_f32 v[44:45], v[44:45], v[12:13]
    v_pk_add_f32 v[46:47], v[46:47], v[14:15]
    v_lshlrev_b32 v8, 16, v80
    v_and_b32 v9, s53, v80
    v_lshlrev_b32 v10, 16, v81
    v_and_b32 v11, s53, v81
    v_lshlrev_b32 v12, 16, v82
    v_and_b32 v13, s53, v82
    v_lshlrev_b32 v14, 16, v83
    v_and_b32 v15, s53, v83
    v_pk_add_f32 v[48:49], v[48:49], v[8:9]
    v_pk_add_f32 v[50:51], v[50:51], v[10:11]
    v_pk_add_f32 v[52:53], v[52:53], v[12:13]
    v_pk_add_f32 v[54:55], v[54:55], v[14:15]
    v_lshlrev_b32 v8, 16, v84
    v_and_b32 v9, s53, v84
    v_lshlrev_b32 v10, 16, v85
    v_and_b32 v11, s53, v85
    v_lshlrev_b32 v12, 16, v86
    v_and_b32 v13, s53, v86
    v_lshlrev_b32 v14, 16, v87
    v_and_b32 v15, s53, v87
    v_pk_add_f32 v[56:57], v[56:57], v[8:9]
    v_pk_add_f32 v[58:59], v[58:59], v[10:11]
    v_pk_add_f32 v[60:61], v[60:61], v[12:13]
    v_pk_add_f32 v[62:63], v[62:63], v[14:15]
    s_mov_b32 s59, 33030144
    buffer_load_dwordx4 v[76:79], v16, s[12:15], s59 offen offset:0 sc1
    buffer_load_dwordx4 v[80:83], v16, s[12:15], s59 offen offset:3072 sc1
    buffer_load_dwordx4 v[84:87], v17, s[12:15], s59 offen offset:0 sc1
    s_waitcnt vmcnt(36)
    v_lshlrev_b32 v8, 16, v88
    v_and_b32 v9, s53, v88
    v_lshlrev_b32 v10, 16, v89
    v_and_b32 v11, s53, v89
    v_lshlrev_b32 v12, 16, v90
    v_and_b32 v13, s53, v90
    v_lshlrev_b32 v14, 16, v91
    v_and_b32 v15, s53, v91
    v_pk_add_f32 v[40:41], v[40:41], v[8:9]
    v_pk_add_f32 v[42:43], v[42:43], v[10:11]
    v_pk_add_f32 v[44:45], v[44:45], v[12:13]
    v_pk_add_f32 v[46:47], v[46:47], v[14:15]
    v_lshlrev_b32 v8, 16, v92
    v_and_b32 v9, s53, v92
    v_lshlrev_b32 v10, 16, v93
    v_and_b32 v11, s53, v93
    v_lshlrev_b32 v12, 16, v94
    v_and_b32 v13, s53, v94
    v_lshlrev_b32 v14, 16, v95
    v_and_b32 v15, s53, v95
    v_pk_add_f32 v[48:49], v[48:49], v[8:9]
    v_pk_add_f32 v[50:51], v[50:51], v[10:11]
    v_pk_add_f32 v[52:53], v[52:53], v[12:13]
    v_pk_add_f32 v[54:55], v[54:55], v[14:15]
    v_lshlrev_b32 v8, 16, v96
    v_and_b32 v9, s53, v96
    v_lshlrev_b32 v10, 16, v97
    v_and_b32 v11, s53, v97
    v_lshlrev_b32 v12, 16, v98
    v_and_b32 v13, s53, v98
    v_lshlrev_b32 v14, 16, v99
    v_and_b32 v15, s53, v99
    v_pk_add_f32 v[56:57], v[56:57], v[8:9]
    v_pk_add_f32 v[58:59], v[58:59], v[10:11]
    v_pk_add_f32 v[60:61], v[60:61], v[12:13]
    v_pk_add_f32 v[62:63], v[62:63], v[14:15]
    s_mov_b32 s59, 35389440
    buffer_load_dwordx4 v[88:91], v16, s[12:15], s59 offen offset:0 sc1
    buffer_load_dwordx4 v[92:95], v16, s[12:15], s59 offen offset:3072 sc1
    buffer_load_dwordx4 v[96:99], v17, s[12:15], s59 offen offset:0 sc1
    s_waitcnt vmcnt(36)
    v_lshlrev_b32 v8, 16, v100
    v_and_b32 v9, s53, v100
    v_lshlrev_b32 v10, 16, v101
    v_and_b32 v11, s53, v101
    v_lshlrev_b32 v12, 16, v102
    v_and_b32 v13, s53, v102
    v_lshlrev_b32 v14, 16, v103
    v_and_b32 v15, s53, v103
    v_pk_add_f32 v[40:41], v[40:41], v[8:9]
    v_pk_add_f32 v[42:43], v[42:43], v[10:11]
    v_pk_add_f32 v[44:45], v[44:45], v[12:13]
    v_pk_add_f32 v[46:47], v[46:47], v[14:15]
    v_lshlrev_b32 v8, 16, v104
    v_and_b32 v9, s53, v104
    v_lshlrev_b32 v10, 16, v105
    v_and_b32 v11, s53, v105
    v_lshlrev_b32 v12, 16, v106
    v_and_b32 v13, s53, v106
    v_lshlrev_b32 v14, 16, v107
    v_and_b32 v15, s53, v107
    v_pk_add_f32 v[48:49], v[48:49], v[8:9]
    v_pk_add_f32 v[50:51], v[50:51], v[10:11]
    v_pk_add_f32 v[52:53], v[52:53], v[12:13]
    v_pk_add_f32 v[54:55], v[54:55], v[14:15]
    v_lshlrev_b32 v8, 16, v108
    v_and_b32 v9, s53, v108
    v_lshlrev_b32 v10, 16, v109
    v_and_b32 v11, s53, v109
    v_lshlrev_b32 v12, 16, v110
    v_and_b32 v13, s53, v110
    v_lshlrev_b32 v14, 16, v111
    v_and_b32 v15, s53, v111
    v_pk_add_f32 v[56:57], v[56:57], v[8:9]
    v_pk_add_f32 v[58:59], v[58:59], v[10:11]
    v_pk_add_f32 v[60:61], v[60:61], v[12:13]
    v_pk_add_f32 v[62:63], v[62:63], v[14:15]
    s_waitcnt vmcnt(33)
    v_lshlrev_b32 v8, 16, v112
    v_and_b32 v9, s53, v112
    v_lshlrev_b32 v10, 16, v113
    v_and_b32 v11, s53, v113
    v_lshlrev_b32 v12, 16, v114
    v_and_b32 v13, s53, v114
    v_lshlrev_b32 v14, 16, v115
    v_and_b32 v15, s53, v115
    v_pk_add_f32 v[40:41], v[40:41], v[8:9]
    v_pk_add_f32 v[42:43], v[42:43], v[10:11]
    v_pk_add_f32 v[44:45], v[44:45], v[12:13]
    v_pk_add_f32 v[46:47], v[46:47], v[14:15]
    v_lshlrev_b32 v8, 16, v116
    v_and_b32 v9, s53, v116
    v_lshlrev_b32 v10, 16, v117
    v_and_b32 v11, s53, v117
    v_lshlrev_b32 v12, 16, v118
    v_and_b32 v13, s53, v118
    v_lshlrev_b32 v14, 16, v119
    v_and_b32 v15, s53, v119
    v_pk_add_f32 v[48:49], v[48:49], v[8:9]
    v_pk_add_f32 v[50:51], v[50:51], v[10:11]
    v_pk_add_f32 v[52:53], v[52:53], v[12:13]
    v_pk_add_f32 v[54:55], v[54:55], v[14:15]
    v_lshlrev_b32 v8, 16, v120
    v_and_b32 v9, s53, v120
    v_lshlrev_b32 v10, 16, v121
    v_and_b32 v11, s53, v121
    v_lshlrev_b32 v12, 16, v122
    v_and_b32 v13, s53, v122
    v_lshlrev_b32 v14, 16, v123
    v_and_b32 v15, s53, v123
    v_pk_add_f32 v[56:57], v[56:57], v[8:9]
    v_pk_add_f32 v[58:59], v[58:59], v[10:11]
    v_pk_add_f32 v[60:61], v[60:61], v[12:13]
    v_pk_add_f32 v[62:63], v[62:63], v[14:15]
    s_waitcnt vmcnt(30)
    v_lshlrev_b32 v8, 16, v124
    v_and_b32 v9, s53, v124
    v_lshlrev_b32 v10, 16, v125
    v_and_b32 v11, s53, v125
    v_lshlrev_b32 v12, 16, v126
    v_and_b32 v13, s53, v126
    v_lshlrev_b32 v14, 16, v127
    v_and_b32 v15, s53, v127
    v_pk_add_f32 v[40:41], v[40:41], v[8:9]
    v_pk_add_f32 v[42:43], v[42:43], v[10:11]
    v_pk_add_f32 v[44:45], v[44:45], v[12:13]
    v_pk_add_f32 v[46:47], v[46:47], v[14:15]
    v_lshlrev_b32 v8, 16, v128
    v_and_b32 v9, s53, v128
    v_lshlrev_b32 v10, 16, v129
    v_and_b32 v11, s53, v129
    v_lshlrev_b32 v12, 16, v130
    v_and_b32 v13, s53, v130
    v_lshlrev_b32 v14, 16, v131
    v_and_b32 v15, s53, v131
    v_pk_add_f32 v[48:49], v[48:49], v[8:9]
    v_pk_add_f32 v[50:51], v[50:51], v[10:11]
    v_pk_add_f32 v[52:53], v[52:53], v[12:13]
    v_pk_add_f32 v[54:55], v[54:55], v[14:15]
    v_lshlrev_b32 v8, 16, v132
    v_and_b32 v9, s53, v132
    v_lshlrev_b32 v10, 16, v133
    v_and_b32 v11, s53, v133
    v_lshlrev_b32 v12, 16, v134
    v_and_b32 v13, s53, v134
    v_lshlrev_b32 v14, 16, v135
    v_and_b32 v15, s53, v135
    v_pk_add_f32 v[56:57], v[56:57], v[8:9]
    v_pk_add_f32 v[58:59], v[58:59], v[10:11]
    v_pk_add_f32 v[60:61], v[60:61], v[12:13]
    v_pk_add_f32 v[62:63], v[62:63], v[14:15]
    s_waitcnt vmcnt(27)
    v_lshlrev_b32 v8, 16, v136
    v_and_b32 v9, s53, v136
    v_lshlrev_b32 v10, 16, v137
    v_and_b32 v11, s53, v137
    v_lshlrev_b32 v12, 16, v138
    v_and_b32 v13, s53, v138
    v_lshlrev_b32 v14, 16, v139
    v_and_b32 v15, s53, v139
    v_pk_add_f32 v[40:41], v[40:41], v[8:9]
    v_pk_add_f32 v[42:43], v[42:43], v[10:11]
    v_pk_add_f32 v[44:45], v[44:45], v[12:13]
    v_pk_add_f32 v[46:47], v[46:47], v[14:15]
    v_lshlrev_b32 v8, 16, v140
    v_and_b32 v9, s53, v140
    v_lshlrev_b32 v10, 16, v141
    v_and_b32 v11, s53, v141
    v_lshlrev_b32 v12, 16, v142
    v_and_b32 v13, s53, v142
    v_lshlrev_b32 v14, 16, v143
    v_and_b32 v15, s53, v143
    v_pk_add_f32 v[48:49], v[48:49], v[8:9]
    v_pk_add_f32 v[50:51], v[50:51], v[10:11]
    v_pk_add_f32 v[52:53], v[52:53], v[12:13]
    v_pk_add_f32 v[54:55], v[54:55], v[14:15]
    v_lshlrev_b32 v8, 16, v144
    v_and_b32 v9, s53, v144
    v_lshlrev_b32 v10, 16, v145
    v_and_b32 v11, s53, v145
    v_lshlrev_b32 v12, 16, v146
    v_and_b32 v13, s53, v146
    v_lshlrev_b32 v14, 16, v147
    v_and_b32 v15, s53, v147
    v_pk_add_f32 v[56:57], v[56:57], v[8:9]
    v_pk_add_f32 v[58:59], v[58:59], v[10:11]
    v_pk_add_f32 v[60:61], v[60:61], v[12:13]
    v_pk_add_f32 v[62:63], v[62:63], v[14:15]
    s_waitcnt vmcnt(24)
    v_lshlrev_b32 v8, 16, v148
    v_and_b32 v9, s53, v148
    v_lshlrev_b32 v10, 16, v149
    v_and_b32 v11, s53, v149
    v_lshlrev_b32 v12, 16, v150
    v_and_b32 v13, s53, v150
    v_lshlrev_b32 v14, 16, v151
    v_and_b32 v15, s53, v151
    v_pk_add_f32 v[40:41], v[40:41], v[8:9]
    v_pk_add_f32 v[42:43], v[42:43], v[10:11]
    v_pk_add_f32 v[44:45], v[44:45], v[12:13]
    v_pk_add_f32 v[46:47], v[46:47], v[14:15]
    v_lshlrev_b32 v8, 16, v152
    v_and_b32 v9, s53, v152
    v_lshlrev_b32 v10, 16, v153
    v_and_b32 v11, s53, v153
    v_lshlrev_b32 v12, 16, v154
    v_and_b32 v13, s53, v154
    v_lshlrev_b32 v14, 16, v155
    v_and_b32 v15, s53, v155
    v_pk_add_f32 v[48:49], v[48:49], v[8:9]
    v_pk_add_f32 v[50:51], v[50:51], v[10:11]
    v_pk_add_f32 v[52:53], v[52:53], v[12:13]
    v_pk_add_f32 v[54:55], v[54:55], v[14:15]
    v_lshlrev_b32 v8, 16, v156
    v_and_b32 v9, s53, v156
    v_lshlrev_b32 v10, 16, v157
    v_and_b32 v11, s53, v157
    v_lshlrev_b32 v12, 16, v158
    v_and_b32 v13, s53, v158
    v_lshlrev_b32 v14, 16, v159
    v_and_b32 v15, s53, v159
    v_pk_add_f32 v[56:57], v[56:57], v[8:9]
    v_pk_add_f32 v[58:59], v[58:59], v[10:11]
    v_pk_add_f32 v[60:61], v[60:61], v[12:13]
    v_pk_add_f32 v[62:63], v[62:63], v[14:15]
    s_waitcnt vmcnt(21)
    v_lshlrev_b32 v8, 16, v160
    v_and_b32 v9, s53, v160
    v_lshlrev_b32 v10, 16, v161
    v_and_b32 v11, s53, v161
    v_lshlrev_b32 v12, 16, v162
    v_and_b32 v13, s53, v162
    v_lshlrev_b32 v14, 16, v163
    v_and_b32 v15, s53, v163
    v_pk_add_f32 v[40:41], v[40:41], v[8:9]
    v_pk_add_f32 v[42:43], v[42:43], v[10:11]
    v_pk_add_f32 v[44:45], v[44:45], v[12:13]
    v_pk_add_f32 v[46:47], v[46:47], v[14:15]
    v_lshlrev_b32 v8, 16, v164
    v_and_b32 v9, s53, v164
    v_lshlrev_b32 v10, 16, v165
    v_and_b32 v11, s53, v165
    v_lshlrev_b32 v12, 16, v166
    v_and_b32 v13, s53, v166
    v_lshlrev_b32 v14, 16, v167
    v_and_b32 v15, s53, v167
    v_pk_add_f32 v[48:49], v[48:49], v[8:9]
    v_pk_add_f32 v[50:51], v[50:51], v[10:11]
    v_pk_add_f32 v[52:53], v[52:53], v[12:13]
    v_pk_add_f32 v[54:55], v[54:55], v[14:15]
    v_lshlrev_b32 v8, 16, v168
    v_and_b32 v9, s53, v168
    v_lshlrev_b32 v10, 16, v169
    v_and_b32 v11, s53, v169
    v_lshlrev_b32 v12, 16, v170
    v_and_b32 v13, s53, v170
    v_lshlrev_b32 v14, 16, v171
    v_and_b32 v15, s53, v171
    v_pk_add_f32 v[56:57], v[56:57], v[8:9]
    v_pk_add_f32 v[58:59], v[58:59], v[10:11]
    v_pk_add_f32 v[60:61], v[60:61], v[12:13]
    v_pk_add_f32 v[62:63], v[62:63], v[14:15]
    s_waitcnt vmcnt(18)
    v_lshlrev_b32 v8, 16, v172
    v_and_b32 v9, s53, v172
    v_lshlrev_b32 v10, 16, v173
    v_and_b32 v11, s53, v173
    v_lshlrev_b32 v12, 16, v174
    v_and_b32 v13, s53, v174
    v_lshlrev_b32 v14, 16, v175
    v_and_b32 v15, s53, v175
    v_pk_add_f32 v[40:41], v[40:41], v[8:9]
    v_pk_add_f32 v[42:43], v[42:43], v[10:11]
    v_pk_add_f32 v[44:45], v[44:45], v[12:13]
    v_pk_add_f32 v[46:47], v[46:47], v[14:15]
    v_lshlrev_b32 v8, 16, v176
    v_and_b32 v9, s53, v176
    v_lshlrev_b32 v10, 16, v177
    v_and_b32 v11, s53, v177
    v_lshlrev_b32 v12, 16, v178
    v_and_b32 v13, s53, v178
    v_lshlrev_b32 v14, 16, v179
    v_and_b32 v15, s53, v179
    v_pk_add_f32 v[48:49], v[48:49], v[8:9]
    v_pk_add_f32 v[50:51], v[50:51], v[10:11]
    v_pk_add_f32 v[52:53], v[52:53], v[12:13]
    v_pk_add_f32 v[54:55], v[54:55], v[14:15]
    v_lshlrev_b32 v8, 16, v180
    v_and_b32 v9, s53, v180
    v_lshlrev_b32 v10, 16, v181
    v_and_b32 v11, s53, v181
    v_lshlrev_b32 v12, 16, v182
    v_and_b32 v13, s53, v182
    v_lshlrev_b32 v14, 16, v183
    v_and_b32 v15, s53, v183
    v_pk_add_f32 v[56:57], v[56:57], v[8:9]
    v_pk_add_f32 v[58:59], v[58:59], v[10:11]
    v_pk_add_f32 v[60:61], v[60:61], v[12:13]
    v_pk_add_f32 v[62:63], v[62:63], v[14:15]
    s_waitcnt vmcnt(15)
    v_lshlrev_b32 v8, 16, v184
    v_and_b32 v9, s53, v184
    v_lshlrev_b32 v10, 16, v185
    v_and_b32 v11, s53, v185
    v_lshlrev_b32 v12, 16, v186
    v_and_b32 v13, s53, v186
    v_lshlrev_b32 v14, 16, v187
    v_and_b32 v15, s53, v187
    v_pk_add_f32 v[40:41], v[40:41], v[8:9]
    v_pk_add_f32 v[42:43], v[42:43], v[10:11]
    v_pk_add_f32 v[44:45], v[44:45], v[12:13]
    v_pk_add_f32 v[46:47], v[46:47], v[14:15]
    v_lshlrev_b32 v8, 16, v188
    v_and_b32 v9, s53, v188
    v_lshlrev_b32 v10, 16, v189
    v_and_b32 v11, s53, v189
    v_lshlrev_b32 v12, 16, v190
    v_and_b32 v13, s53, v190
    v_lshlrev_b32 v14, 16, v191
    v_and_b32 v15, s53, v191
    v_pk_add_f32 v[48:49], v[48:49], v[8:9]
    v_pk_add_f32 v[50:51], v[50:51], v[10:11]
    v_pk_add_f32 v[52:53], v[52:53], v[12:13]
    v_pk_add_f32 v[54:55], v[54:55], v[14:15]
    v_lshlrev_b32 v8, 16, v192
    v_and_b32 v9, s53, v192
    v_lshlrev_b32 v10, 16, v193
    v_and_b32 v11, s53, v193
    v_lshlrev_b32 v12, 16, v194
    v_and_b32 v13, s53, v194
    v_lshlrev_b32 v14, 16, v195
    v_and_b32 v15, s53, v195
    v_pk_add_f32 v[56:57], v[56:57], v[8:9]
    v_pk_add_f32 v[58:59], v[58:59], v[10:11]
    v_pk_add_f32 v[60:61], v[60:61], v[12:13]
    v_pk_add_f32 v[62:63], v[62:63], v[14:15]
    s_waitcnt vmcnt(12)
    v_lshlrev_b32 v8, 16, v196
    v_and_b32 v9, s53, v196
    v_lshlrev_b32 v10, 16, v197
    v_and_b32 v11, s53, v197
    v_lshlrev_b32 v12, 16, v198
    v_and_b32 v13, s53, v198
    v_lshlrev_b32 v14, 16, v199
    v_and_b32 v15, s53, v199
    v_pk_add_f32 v[40:41], v[40:41], v[8:9]
    v_pk_add_f32 v[42:43], v[42:43], v[10:11]
    v_pk_add_f32 v[44:45], v[44:45], v[12:13]
    v_pk_add_f32 v[46:47], v[46:47], v[14:15]
    v_lshlrev_b32 v8, 16, v200
    v_and_b32 v9, s53, v200
    v_lshlrev_b32 v10, 16, v201
    v_and_b32 v11, s53, v201
    v_lshlrev_b32 v12, 16, v202
    v_and_b32 v13, s53, v202
    v_lshlrev_b32 v14, 16, v203
    v_and_b32 v15, s53, v203
    v_pk_add_f32 v[48:49], v[48:49], v[8:9]
    v_pk_add_f32 v[50:51], v[50:51], v[10:11]
    v_pk_add_f32 v[52:53], v[52:53], v[12:13]
    v_pk_add_f32 v[54:55], v[54:55], v[14:15]
    v_lshlrev_b32 v8, 16, v204
    v_and_b32 v9, s53, v204
    v_lshlrev_b32 v10, 16, v205
    v_and_b32 v11, s53, v205
    v_lshlrev_b32 v12, 16, v206
    v_and_b32 v13, s53, v206
    v_lshlrev_b32 v14, 16, v207
    v_and_b32 v15, s53, v207
    v_pk_add_f32 v[56:57], v[56:57], v[8:9]
    v_pk_add_f32 v[58:59], v[58:59], v[10:11]
    v_pk_add_f32 v[60:61], v[60:61], v[12:13]
    v_pk_add_f32 v[62:63], v[62:63], v[14:15]
    s_waitcnt vmcnt(9)
    v_lshlrev_b32 v8, 16, v208
    v_and_b32 v9, s53, v208
    v_lshlrev_b32 v10, 16, v209
    v_and_b32 v11, s53, v209
    v_lshlrev_b32 v12, 16, v210
    v_and_b32 v13, s53, v210
    v_lshlrev_b32 v14, 16, v211
    v_and_b32 v15, s53, v211
    v_pk_add_f32 v[40:41], v[40:41], v[8:9]
    v_pk_add_f32 v[42:43], v[42:43], v[10:11]
    v_pk_add_f32 v[44:45], v[44:45], v[12:13]
    v_pk_add_f32 v[46:47], v[46:47], v[14:15]
    v_lshlrev_b32 v8, 16, v212
    v_and_b32 v9, s53, v212
    v_lshlrev_b32 v10, 16, v213
    v_and_b32 v11, s53, v213
    v_lshlrev_b32 v12, 16, v214
    v_and_b32 v13, s53, v214
    v_lshlrev_b32 v14, 16, v215
    v_and_b32 v15, s53, v215
    v_pk_add_f32 v[48:49], v[48:49], v[8:9]
    v_pk_add_f32 v[50:51], v[50:51], v[10:11]
    v_pk_add_f32 v[52:53], v[52:53], v[12:13]
    v_pk_add_f32 v[54:55], v[54:55], v[14:15]
    v_lshlrev_b32 v8, 16, v216
    v_and_b32 v9, s53, v216
    v_lshlrev_b32 v10, 16, v217
    v_and_b32 v11, s53, v217
    v_lshlrev_b32 v12, 16, v218
    v_and_b32 v13, s53, v218
    v_lshlrev_b32 v14, 16, v219
    v_and_b32 v15, s53, v219
    v_pk_add_f32 v[56:57], v[56:57], v[8:9]
    v_pk_add_f32 v[58:59], v[58:59], v[10:11]
    v_pk_add_f32 v[60:61], v[60:61], v[12:13]
    v_pk_add_f32 v[62:63], v[62:63], v[14:15]
    s_waitcnt vmcnt(6)
    v_lshlrev_b32 v8, 16, v64
    v_and_b32 v9, s53, v64
    v_lshlrev_b32 v10, 16, v65
    v_and_b32 v11, s53, v65
    v_lshlrev_b32 v12, 16, v66
    v_and_b32 v13, s53, v66
    v_lshlrev_b32 v14, 16, v67
    v_and_b32 v15, s53, v67
    v_pk_add_f32 v[40:41], v[40:41], v[8:9]
    v_pk_add_f32 v[42:43], v[42:43], v[10:11]
    v_pk_add_f32 v[44:45], v[44:45], v[12:13]
    v_pk_add_f32 v[46:47], v[46:47], v[14:15]
    v_lshlrev_b32 v8, 16, v68
    v_and_b32 v9, s53, v68
    v_lshlrev_b32 v10, 16, v69
    v_and_b32 v11, s53, v69
    v_lshlrev_b32 v12, 16, v70
    v_and_b32 v13, s53, v70
    v_lshlrev_b32 v14, 16, v71
    v_and_b32 v15, s53, v71
    v_pk_add_f32 v[48:49], v[48:49], v[8:9]
    v_pk_add_f32 v[50:51], v[50:51], v[10:11]
    v_pk_add_f32 v[52:53], v[52:53], v[12:13]
    v_pk_add_f32 v[54:55], v[54:55], v[14:15]
    v_lshlrev_b32 v8, 16, v72
    v_and_b32 v9, s53, v72
    v_lshlrev_b32 v10, 16, v73
    v_and_b32 v11, s53, v73
    v_lshlrev_b32 v12, 16, v74
    v_and_b32 v13, s53, v74
    v_lshlrev_b32 v14, 16, v75
    v_and_b32 v15, s53, v75
    v_pk_add_f32 v[56:57], v[56:57], v[8:9]
    v_pk_add_f32 v[58:59], v[58:59], v[10:11]
    v_pk_add_f32 v[60:61], v[60:61], v[12:13]
    v_pk_add_f32 v[62:63], v[62:63], v[14:15]
    s_waitcnt vmcnt(3)
    v_lshlrev_b32 v8, 16, v76
    v_and_b32 v9, s53, v76
    v_lshlrev_b32 v10, 16, v77
    v_and_b32 v11, s53, v77
    v_lshlrev_b32 v12, 16, v78
    v_and_b32 v13, s53, v78
    v_lshlrev_b32 v14, 16, v79
    v_and_b32 v15, s53, v79
    v_pk_add_f32 v[40:41], v[40:41], v[8:9]
    v_pk_add_f32 v[42:43], v[42:43], v[10:11]
    v_pk_add_f32 v[44:45], v[44:45], v[12:13]
    v_pk_add_f32 v[46:47], v[46:47], v[14:15]
    v_lshlrev_b32 v8, 16, v80
    v_and_b32 v9, s53, v80
    v_lshlrev_b32 v10, 16, v81
    v_and_b32 v11, s53, v81
    v_lshlrev_b32 v12, 16, v82
    v_and_b32 v13, s53, v82
    v_lshlrev_b32 v14, 16, v83
    v_and_b32 v15, s53, v83
    v_pk_add_f32 v[48:49], v[48:49], v[8:9]
    v_pk_add_f32 v[50:51], v[50:51], v[10:11]
    v_pk_add_f32 v[52:53], v[52:53], v[12:13]
    v_pk_add_f32 v[54:55], v[54:55], v[14:15]
    v_lshlrev_b32 v8, 16, v84
    v_and_b32 v9, s53, v84
    v_lshlrev_b32 v10, 16, v85
    v_and_b32 v11, s53, v85
    v_lshlrev_b32 v12, 16, v86
    v_and_b32 v13, s53, v86
    v_lshlrev_b32 v14, 16, v87
    v_and_b32 v15, s53, v87
    v_pk_add_f32 v[56:57], v[56:57], v[8:9]
    v_pk_add_f32 v[58:59], v[58:59], v[10:11]
    v_pk_add_f32 v[60:61], v[60:61], v[12:13]
    v_pk_add_f32 v[62:63], v[62:63], v[14:15]
    s_waitcnt vmcnt(0)
    v_lshlrev_b32 v8, 16, v88
    v_and_b32 v9, s53, v88
    v_lshlrev_b32 v10, 16, v89
    v_and_b32 v11, s53, v89
    v_lshlrev_b32 v12, 16, v90
    v_and_b32 v13, s53, v90
    v_lshlrev_b32 v14, 16, v91
    v_and_b32 v15, s53, v91
    v_pk_add_f32 v[40:41], v[40:41], v[8:9]
    v_pk_add_f32 v[42:43], v[42:43], v[10:11]
    v_pk_add_f32 v[44:45], v[44:45], v[12:13]
    v_pk_add_f32 v[46:47], v[46:47], v[14:15]
    v_lshlrev_b32 v8, 16, v92
    v_and_b32 v9, s53, v92
    v_lshlrev_b32 v10, 16, v93
    v_and_b32 v11, s53, v93
    v_lshlrev_b32 v12, 16, v94
    v_and_b32 v13, s53, v94
    v_lshlrev_b32 v14, 16, v95
    v_and_b32 v15, s53, v95
    v_pk_add_f32 v[48:49], v[48:49], v[8:9]
    v_pk_add_f32 v[50:51], v[50:51], v[10:11]
    v_pk_add_f32 v[52:53], v[52:53], v[12:13]
    v_pk_add_f32 v[54:55], v[54:55], v[14:15]
    v_lshlrev_b32 v8, 16, v96
    v_and_b32 v9, s53, v96
    v_lshlrev_b32 v10, 16, v97
    v_and_b32 v11, s53, v97
    v_lshlrev_b32 v12, 16, v98
    v_and_b32 v13, s53, v98
    v_lshlrev_b32 v14, 16, v99
    v_and_b32 v15, s53, v99
    v_pk_add_f32 v[56:57], v[56:57], v[8:9]
    v_pk_add_f32 v[58:59], v[58:59], v[10:11]
    v_pk_add_f32 v[60:61], v[60:61], v[12:13]
    v_pk_add_f32 v[62:63], v[62:63], v[14:15]
    v_pk_mul_f32 v[40:41], v[40:41], s[54:55]
    v_pk_mul_f32 v[42:43], v[42:43], s[54:55]
    v_pk_mul_f32 v[44:45], v[44:45], s[54:55]
    v_pk_mul_f32 v[46:47], v[46:47], s[54:55]
    v_cvt_pk_bf16_f32 v8, v40, v41
    v_cvt_pk_bf16_f32 v9, v42, v43
    v_cvt_pk_bf16_f32 v10, v44, v45
    v_cvt_pk_bf16_f32 v11, v46, v47
    v_lshlrev_b32 v40, 16, v8
    v_and_b32 v41, s53, v8
    v_lshlrev_b32 v42, 16, v9
    v_and_b32 v43, s53, v9
    v_lshlrev_b32 v44, 16, v10
    v_and_b32 v45, s53, v10
    v_lshlrev_b32 v46, 16, v11
    v_and_b32 v47, s53, v11
    v_pk_mul_f32 v[40:41], v[40:41], v[220:221]
    v_pk_mul_f32 v[42:43], v[42:43], v[222:223]
    v_pk_mul_f32 v[44:45], v[44:45], v[224:225]
    v_pk_mul_f32 v[46:47], v[46:47], v[226:227]
    v_cvt_pk_bf16_f32 v8, v40, v41
    v_cvt_pk_bf16_f32 v9, v42, v43
    v_cvt_pk_bf16_f32 v10, v44, v45
    v_cvt_pk_bf16_f32 v11, v46, v47
    v_lshlrev_b32 v40, 16, v8
    v_and_b32 v41, s53, v8
    v_lshlrev_b32 v42, 16, v9
    v_and_b32 v43, s53, v9
    v_lshlrev_b32 v44, 16, v10
    v_and_b32 v45, s53, v10
    v_lshlrev_b32 v46, 16, v11
    v_and_b32 v47, s53, v11
    v_lshlrev_b32 v8, 16, v244
    v_and_b32 v9, s53, v244
    v_lshlrev_b32 v10, 16, v245
    v_and_b32 v11, s53, v245
    v_lshlrev_b32 v12, 16, v246
    v_and_b32 v13, s53, v246
    v_lshlrev_b32 v14, 16, v247
    v_and_b32 v15, s53, v247
    v_pk_add_f32 v[40:41], v[40:41], v[8:9]
    v_pk_add_f32 v[42:43], v[42:43], v[10:11]
    v_pk_add_f32 v[44:45], v[44:45], v[12:13]
    v_pk_add_f32 v[46:47], v[46:47], v[14:15]
    v_cvt_pk_bf16_f32 v244, v40, v41
    v_cvt_pk_bf16_f32 v245, v42, v43
    v_cvt_pk_bf16_f32 v246, v44, v45
    v_cvt_pk_bf16_f32 v247, v46, v47
    buffer_store_dwordx2 v[244:245], v22, s[8:11], 0 offen offset:0
    buffer_store_dwordx2 v[246:247], v22, s[8:11], 0 offen offset:32
    v_pk_mul_f32 v[48:49], v[48:49], s[54:55]
    v_pk_mul_f32 v[50:51], v[50:51], s[54:55]
    v_pk_mul_f32 v[52:53], v[52:53], s[54:55]
    v_pk_mul_f32 v[54:55], v[54:55], s[54:55]
    v_cvt_pk_bf16_f32 v8, v48, v49
    v_cvt_pk_bf16_f32 v9, v50, v51
    v_cvt_pk_bf16_f32 v10, v52, v53
    v_cvt_pk_bf16_f32 v11, v54, v55
    v_lshlrev_b32 v48, 16, v8
    v_and_b32 v49, s53, v8
    v_lshlrev_b32 v50, 16, v9
    v_and_b32 v51, s53, v9
    v_lshlrev_b32 v52, 16, v10
    v_and_b32 v53, s53, v10
    v_lshlrev_b32 v54, 16, v11
    v_and_b32 v55, s53, v11
    v_pk_mul_f32 v[48:49], v[48:49], v[228:229]
    v_pk_mul_f32 v[50:51], v[50:51], v[230:231]
    v_pk_mul_f32 v[52:53], v[52:53], v[232:233]
    v_pk_mul_f32 v[54:55], v[54:55], v[234:235]
    v_cvt_pk_bf16_f32 v8, v48, v49
    v_cvt_pk_bf16_f32 v9, v50, v51
    v_cvt_pk_bf16_f32 v10, v52, v53
    v_cvt_pk_bf16_f32 v11, v54, v55
    v_lshlrev_b32 v48, 16, v8
    v_and_b32 v49, s53, v8
    v_lshlrev_b32 v50, 16, v9
    v_and_b32 v51, s53, v9
    v_lshlrev_b32 v52, 16, v10
    v_and_b32 v53, s53, v10
    v_lshlrev_b32 v54, 16, v11
    v_and_b32 v55, s53, v11
    v_lshlrev_b32 v8, 16, v248
    v_and_b32 v9, s53, v248
    v_lshlrev_b32 v10, 16, v249
    v_and_b32 v11, s53, v249
    v_lshlrev_b32 v12, 16, v250
    v_and_b32 v13, s53, v250
    v_lshlrev_b32 v14, 16, v251
    v_and_b32 v15, s53, v251
    v_pk_add_f32 v[48:49], v[48:49], v[8:9]
    v_pk_add_f32 v[50:51], v[50:51], v[10:11]
    v_pk_add_f32 v[52:53], v[52:53], v[12:13]
    v_pk_add_f32 v[54:55], v[54:55], v[14:15]
    v_cvt_pk_bf16_f32 v248, v48, v49
    v_cvt_pk_bf16_f32 v249, v50, v51
    v_cvt_pk_bf16_f32 v250, v52, v53
    v_cvt_pk_bf16_f32 v251, v54, v55
    buffer_store_dwordx2 v[248:249], v22, s[8:11], 0 offen offset:384
    buffer_store_dwordx2 v[250:251], v22, s[8:11], 0 offen offset:416
    v_pk_mul_f32 v[56:57], v[56:57], s[54:55]
    v_pk_mul_f32 v[58:59], v[58:59], s[54:55]
    v_pk_mul_f32 v[60:61], v[60:61], s[54:55]
    v_pk_mul_f32 v[62:63], v[62:63], s[54:55]
    v_cvt_pk_bf16_f32 v8, v56, v57
    v_cvt_pk_bf16_f32 v9, v58, v59
    v_cvt_pk_bf16_f32 v10, v60, v61
    v_cvt_pk_bf16_f32 v11, v62, v63
    v_lshlrev_b32 v56, 16, v8
    v_and_b32 v57, s53, v8
    v_lshlrev_b32 v58, 16, v9
    v_and_b32 v59, s53, v9
    v_lshlrev_b32 v60, 16, v10
    v_and_b32 v61, s53, v10
    v_lshlrev_b32 v62, 16, v11
    v_and_b32 v63, s53, v11
    v_pk_mul_f32 v[56:57], v[56:57], v[236:237]
    v_pk_mul_f32 v[58:59], v[58:59], v[238:239]
    v_pk_mul_f32 v[60:61], v[60:61], v[240:241]
    v_pk_mul_f32 v[62:63], v[62:63], v[242:243]
    v_cvt_pk_bf16_f32 v8, v56, v57
    v_cvt_pk_bf16_f32 v9, v58, v59
    v_cvt_pk_bf16_f32 v10, v60, v61
    v_cvt_pk_bf16_f32 v11, v62, v63
    v_lshlrev_b32 v56, 16, v8
    v_and_b32 v57, s53, v8
    v_lshlrev_b32 v58, 16, v9
    v_and_b32 v59, s53, v9
    v_lshlrev_b32 v60, 16, v10
    v_and_b32 v61, s53, v10
    v_lshlrev_b32 v62, 16, v11
    v_and_b32 v63, s53, v11
    v_lshlrev_b32 v8, 16, v252
    v_and_b32 v9, s53, v252
    v_lshlrev_b32 v10, 16, v253
    v_and_b32 v11, s53, v253
    v_lshlrev_b32 v12, 16, v254
    v_and_b32 v13, s53, v254
    v_lshlrev_b32 v14, 16, v255
    v_and_b32 v15, s53, v255
    v_pk_add_f32 v[56:57], v[56:57], v[8:9]
    v_pk_add_f32 v[58:59], v[58:59], v[10:11]
    v_pk_add_f32 v[60:61], v[60:61], v[12:13]
    v_pk_add_f32 v[62:63], v[62:63], v[14:15]
    v_cvt_pk_bf16_f32 v252, v56, v57
    v_cvt_pk_bf16_f32 v253, v58, v59
    v_cvt_pk_bf16_f32 v254, v60, v61
    v_cvt_pk_bf16_f32 v255, v62, v63
    buffer_store_dwordx2 v[252:253], v22, s[8:11], 0 offen offset:768
    buffer_store_dwordx2 v[254:255], v22, s[8:11], 0 offen offset:800
k4_kernel_end:
    s_endpgm
k4_kernel_stub100:
    s_movk_i32 s52, 100
    s_branch k4_kernel_rare0
k4_kernel_stub102:
    s_movk_i32 s52, 102
    s_branch k4_kernel_rare0
k4_kernel_stub1:
    s_movk_i32 s52, 1
    s_branch k4_kernel_rare0
k4_kernel_stub3:
    s_movk_i32 s52, 3
    s_branch k4_kernel_rare0
k4_kernel_stub5:
    s_movk_i32 s52, 5
    s_branch k4_kernel_rare0
k4_kernel_stub7:
    s_movk_i32 s52, 7
    s_branch k4_kernel_rare0
k4_kernel_stub160:
    s_movk_i32 s52, 160
    s_branch k4_kernel_rare0
k4_kernel_stub162:
    s_movk_i32 s52, 162
    s_branch k4_kernel_rare0
k4_kernel_rare0:
    s_nop 15
    v_max3_f32 v168, v48, v49, v50
    v_max3_f32 v168, v168, v51, v52
    v_max3_f32 v168, v168, v53, v54
    v_max_f32 v168, v168, v55
    v_mov_b32 v169, v168
    s_nop 1
    v_permlane16_swap_b32 v168, v169
    v_max_f32 v168, v168, v169
    v_mov_b32 v169, v168
    s_nop 1
    v_permlane32_swap_b32 v168, v169
    v_max_f32 v168, v168, v169
    v_add_f32 v168, 0x42b40000, v168
    v_max_f32 v168, 0, v168
    v_ceil_f32 v168, v168
    v_cvt_i32_f32 v169, v168
    v_sub_u32 v169, 0, v169
    v_sub_f32 v144, v144, v168
    v_sub_f32 v145, v145, v168
    v_sub_f32 v146, v146, v168
    v_sub_f32 v147, v147, v168
    v_sub_f32 v80, v80, v168
    v_sub_f32 v48, v48, v168
    v_sub_f32 v81, v81, v168
    v_sub_f32 v49, v49, v168
    v_sub_f32 v82, v82, v168
    v_sub_f32 v50, v50, v168
    v_sub_f32 v83, v83, v168
    v_sub_f32 v51, v51, v168
    v_sub_f32 v84, v84, v168
    v_sub_f32 v52, v52, v168
    v_sub_f32 v85, v85, v168
    v_sub_f32 v53, v53, v168
    v_sub_f32 v86, v86, v168
    v_sub_f32 v54, v54, v168
    v_sub_f32 v87, v87, v168
    v_sub_f32 v55, v55, v168
    v_exp_f32 v48, v48
    v_exp_f32 v49, v49
    v_exp_f32 v50, v50
    v_exp_f32 v51, v51
    v_exp_f32 v52, v52
    v_exp_f32 v53, v53
    v_exp_f32 v54, v54
    v_exp_f32 v55, v55
    v_cvt_pk_bf16_f32 v112, v48, v49
    v_cvt_pk_bf16_f32 v113, v50, v51
    v_cvt_pk_bf16_f32 v114, v52, v53
    v_cvt_pk_bf16_f32 v115, v54, v55
    v_ldexp_f32 v40, v248, v169
    v_ldexp_f32 v41, v248, v169
    v_ldexp_f32 v42, v248, v169
    v_ldexp_f32 v43, v248, v169
    s_nop 1
    v_mfma_f32_16x16x32_bf16 v[40:43], v[172:175], v[112:115], v[40:43]
    v_accvgpr_read_b32 v160, a0
    v_accvgpr_read_b32 v161, a1
    v_accvgpr_read_b32 v162, a2
    v_accvgpr_read_b32 v163, a3
    v_accvgpr_read_b32 v164, a4
    v_accvgpr_read_b32 v165, a5
    v_accvgpr_read_b32 v166, a6
    v_accvgpr_read_b32 v167, a7
    v_ldexp_f32 v160, v160, v169
    v_ldexp_f32 v161, v161, v169
    v_ldexp_f32 v162, v162, v169
    v_ldexp_f32 v163, v163, v169
    v_ldexp_f32 v164, v164, v169
    v_ldexp_f32 v165, v165, v169
    v_ldexp_f32 v166, v166, v169
    v_ldexp_f32 v167, v167, v169
    v_accvgpr_write_b32 a0, v160
    v_accvgpr_write_b32 a1, v161
    v_accvgpr_write_b32 a2, v162
    v_accvgpr_write_b32 a3, v163
    v_accvgpr_write_b32 a4, v164
    v_accvgpr_write_b32 a5, v165
    v_accvgpr_write_b32 a6, v166
    v_accvgpr_write_b32 a7, v167
    v_accvgpr_read_b32 v160, a8
    v_accvgpr_read_b32 v161, a9
    v_accvgpr_read_b32 v162, a10
    v_accvgpr_read_b32 v163, a11
    v_accvgpr_read_b32 v164, a12
    v_accvgpr_read_b32 v165, a13
    v_accvgpr_read_b32 v166, a14
    v_accvgpr_read_b32 v167, a15
    v_ldexp_f32 v160, v160, v169
    v_ldexp_f32 v161, v161, v169
    v_ldexp_f32 v162, v162, v169
    v_ldexp_f32 v163, v163, v169
    v_ldexp_f32 v164, v164, v169
    v_ldexp_f32 v165, v165, v169
    v_ldexp_f32 v166, v166, v169
    v_ldexp_f32 v167, v167, v169
    v_accvgpr_write_b32 a8, v160
    v_accvgpr_write_b32 a9, v161
    v_accvgpr_write_b32 a10, v162
    v_accvgpr_write_b32 a11, v163
    v_accvgpr_write_b32 a12, v164
    v_accvgpr_write_b32 a13, v165
    v_accvgpr_write_b32 a14, v166
    v_accvgpr_write_b32 a15, v167
    v_accvgpr_read_b32 v160, a16
    v_accvgpr_read_b32 v161, a17
    v_accvgpr_read_b32 v162, a18
    v_accvgpr_read_b32 v163, a19
    v_accvgpr_read_b32 v164, a20
    v_accvgpr_read_b32 v165, a21
    v_accvgpr_read_b32 v166, a22
    v_accvgpr_read_b32 v167, a23
    v_ldexp_f32 v160, v160, v169
    v_ldexp_f32 v161, v161, v169
    v_ldexp_f32 v162, v162, v169
    v_ldexp_f32 v163, v163, v169
    v_ldexp_f32 v164, v164, v169
    v_ldexp_f32 v165, v165, v169
    v_ldexp_f32 v166, v166, v169
    v_ldexp_f32 v167, v167, v169
    v_accvgpr_write_b32 a16, v160
    v_accvgpr_write_b32 a17, v161
    v_accvgpr_write_b32 a18, v162
    v_accvgpr_write_b32 a19, v163
    v_accvgpr_write_b32 a20, v164
    v_accvgpr_write_b32 a21, v165
    v_accvgpr_write_b32 a22, v166
    v_accvgpr_write_b32 a23, v167
    v_accvgpr_read_b32 v160, a24
    v_accvgpr_read_b32 v161, a25
    v_accvgpr_read_b32 v162, a26
    v_accvgpr_read_b32 v163, a27
    v_accvgpr_read_b32 v164, a28
    v_accvgpr_read_b32 v165, a29
    v_accvgpr_read_b32 v166, a30
    v_accvgpr_read_b32 v167, a31
    v_ldexp_f32 v160, v160, v169
    v_ldexp_f32 v161, v161, v169
    v_ldexp_f32 v162, v162, v169
    v_ldexp_f32 v163, v163, v169
    v_ldexp_f32 v164, v164, v169
    v_ldexp_f32 v165, v165, v169
    v_ldexp_f32 v166, v166, v169
    v_ldexp_f32 v167, v167, v169
    v_accvgpr_write_b32 a24, v160
    v_accvgpr_write_b32 a25, v161
    v_accvgpr_write_b32 a26, v162
    v_accvgpr_write_b32 a27, v163
    v_accvgpr_write_b32 a28, v164
    v_accvgpr_write_b32 a29, v165
    v_accvgpr_write_b32 a30, v166
    v_accvgpr_write_b32 a31, v167
    v_max3_f32 v168, v56, v57, v58
    v_max3_f32 v168, v168, v59, v60
    v_max3_f32 v168, v168, v61, v62
    v_max_f32 v168, v168, v63
    v_mov_b32 v169, v168
    s_nop 1
    v_permlane16_swap_b32 v168, v169
    v_max_f32 v168, v168, v169
    v_mov_b32 v169, v168
    s_nop 1
    v_permlane32_swap_b32 v168, v169
    v_max_f32 v168, v168, v169
    v_add_f32 v168, 0x42b40000, v168
    v_max_f32 v168, 0, v168
    v_ceil_f32 v168, v168
    v_cvt_i32_f32 v169, v168
    v_sub_u32 v169, 0, v169
    v_sub_f32 v148, v148, v168
    v_sub_f32 v149, v149, v168
    v_sub_f32 v150, v150, v168
    v_sub_f32 v151, v151, v168
    v_sub_f32 v88, v88, v168
    v_sub_f32 v56, v56, v168
    v_sub_f32 v89, v89, v168
    v_sub_f32 v57, v57, v168
    v_sub_f32 v90, v90, v168
    v_sub_f32 v58, v58, v168
    v_sub_f32 v91, v91, v168
    v_sub_f32 v59, v59, v168
    v_sub_f32 v92, v92, v168
    v_sub_f32 v60, v60, v168
    v_sub_f32 v93, v93, v168
    v_sub_f32 v61, v61, v168
    v_sub_f32 v94, v94, v168
    v_sub_f32 v62, v62, v168
    v_sub_f32 v95, v95, v168
    v_sub_f32 v63, v63, v168
    v_exp_f32 v56, v56
    v_exp_f32 v57, v57
    v_exp_f32 v58, v58
    v_exp_f32 v59, v59
    v_exp_f32 v60, v60
    v_exp_f32 v61, v61
    v_exp_f32 v62, v62
    v_exp_f32 v63, v63
    v_cvt_pk_bf16_f32 v116, v56, v57
    v_cvt_pk_bf16_f32 v117, v58, v59
    v_cvt_pk_bf16_f32 v118, v60, v61
    v_cvt_pk_bf16_f32 v119, v62, v63
    v_ldexp_f32 v44, v249, v169
    v_ldexp_f32 v45, v249, v169
    v_ldexp_f32 v46, v249, v169
    v_ldexp_f32 v47, v249, v169
    s_nop 1
    v_mfma_f32_16x16x32_bf16 v[44:47], v[172:175], v[116:119], v[44:47]
    v_accvgpr_read_b32 v160, a32
    v_accvgpr_read_b32 v161, a33
    v_accvgpr_read_b32 v162, a34
    v_accvgpr_read_b32 v163, a35
    v_accvgpr_read_b32 v164, a36
    v_accvgpr_read_b32 v165, a37
    v_accvgpr_read_b32 v166, a38
    v_accvgpr_read_b32 v167, a39
    v_ldexp_f32 v160, v160, v169
    v_ldexp_f32 v161, v161, v169
    v_ldexp_f32 v162, v162, v169
    v_ldexp_f32 v163, v163, v169
    v_ldexp_f32 v164, v164, v169
    v_ldexp_f32 v165, v165, v169
    v_ldexp_f32 v166, v166, v169
    v_ldexp_f32 v167, v167, v169
    v_accvgpr_write_b32 a32, v160
    v_accvgpr_write_b32 a33, v161
    v_accvgpr_write_b32 a34, v162
    v_accvgpr_write_b32 a35, v163
    v_accvgpr_write_b32 a36, v164
    v_accvgpr_write_b32 a37, v165
    v_accvgpr_write_b32 a38, v166
    v_accvgpr_write_b32 a39, v167
    v_accvgpr_read_b32 v160, a40
    v_accvgpr_read_b32 v161, a41
    v_accvgpr_read_b32 v162, a42
    v_accvgpr_read_b32 v163, a43
    v_accvgpr_read_b32 v164, a44
    v_accvgpr_read_b32 v165, a45
    v_accvgpr_read_b32 v166, a46
    v_accvgpr_read_b32 v167, a47
    v_ldexp_f32 v160, v160, v169
    v_ldexp_f32 v161, v161, v169
    v_ldexp_f32 v162, v162, v169
    v_ldexp_f32 v163, v163, v169
    v_ldexp_f32 v164, v164, v169
    v_ldexp_f32 v165, v165, v169
    v_ldexp_f32 v166, v166, v169
    v_ldexp_f32 v167, v167, v169
    v_accvgpr_write_b32 a40, v160
    v_accvgpr_write_b32 a41, v161
    v_accvgpr_write_b32 a42, v162
    v_accvgpr_write_b32 a43, v163
    v_accvgpr_write_b32 a44, v164
    v_accvgpr_write_b32 a45, v165
    v_accvgpr_write_b32 a46, v166
    v_accvgpr_write_b32 a47, v167
    v_accvgpr_read_b32 v160, a48
    v_accvgpr_read_b32 v161, a49
    v_accvgpr_read_b32 v162, a50
    v_accvgpr_read_b32 v163, a51
    v_accvgpr_read_b32 v164, a52
    v_accvgpr_read_b32 v165, a53
    v_accvgpr_read_b32 v166, a54
    v_accvgpr_read_b32 v167, a55
    v_ldexp_f32 v160, v160, v169
    v_ldexp_f32 v161, v161, v169
    v_ldexp_f32 v162, v162, v169
    v_ldexp_f32 v163, v163, v169
    v_ldexp_f32 v164, v164, v169
    v_ldexp_f32 v165, v165, v169
    v_ldexp_f32 v166, v166, v169
    v_ldexp_f32 v167, v167, v169
    v_accvgpr_write_b32 a48, v160
    v_accvgpr_write_b32 a49, v161
    v_accvgpr_write_b32 a50, v162
    v_accvgpr_write_b32 a51, v163
    v_accvgpr_write_b32 a52, v164
    v_accvgpr_write_b32 a53, v165
    v_accvgpr_write_b32 a54, v166
    v_accvgpr_write_b32 a55, v167
    v_accvgpr_read_b32 v160, a56
    v_accvgpr_read_b32 v161, a57
    v_accvgpr_read_b32 v162, a58
    v_accvgpr_read_b32 v163, a59
    v_accvgpr_read_b32 v164, a60
    v_accvgpr_read_b32 v165, a61
    v_accvgpr_read_b32 v166, a62
    v_accvgpr_read_b32 v167, a63
    v_ldexp_f32 v160, v160, v169
    v_ldexp_f32 v161, v161, v169
    v_ldexp_f32 v162, v162, v169
    v_ldexp_f32 v163, v163, v169
    v_ldexp_f32 v164, v164, v169
    v_ldexp_f32 v165, v165, v169
    v_ldexp_f32 v166, v166, v169
    v_ldexp_f32 v167, v167, v169
    v_accvgpr_write_b32 a56, v160
    v_accvgpr_write_b32 a57, v161
    v_accvgpr_write_b32 a58, v162
    v_accvgpr_write_b32 a59, v163
    v_accvgpr_write_b32 a60, v164
    v_accvgpr_write_b32 a61, v165
    v_accvgpr_write_b32 a62, v166
    v_accvgpr_write_b32 a63, v167
    v_max3_f32 v168, v64, v65, v66
    v_max3_f32 v168, v168, v67, v68
    v_max3_f32 v168, v168, v69, v70
    v_max_f32 v168, v168, v71
    v_mov_b32 v169, v168
    s_nop 1
    v_permlane16_swap_b32 v168, v169
    v_max_f32 v168, v168, v169
    v_mov_b32 v169, v168
    s_nop 1
    v_permlane32_swap_b32 v168, v169
    v_max_f32 v168, v168, v169
    v_add_f32 v168, 0x42b40000, v168
    v_max_f32 v168, 0, v168
    v_ceil_f32 v168, v168
    v_cvt_i32_f32 v169, v168
    v_sub_u32 v169, 0, v169
    v_sub_f32 v152, v152, v168
    v_sub_f32 v153, v153, v168
    v_sub_f32 v154, v154, v168
    v_sub_f32 v155, v155, v168
    v_sub_f32 v96, v96, v168
    v_sub_f32 v64, v64, v168
    v_sub_f32 v97, v97, v168
    v_sub_f32 v65, v65, v168
    v_sub_f32 v98, v98, v168
    v_sub_f32 v66, v66, v168
    v_sub_f32 v99, v99, v168
    v_sub_f32 v67, v67, v168
    v_sub_f32 v100, v100, v168
    v_sub_f32 v68, v68, v168
    v_sub_f32 v101, v101, v168
    v_sub_f32 v69, v69, v168
    v_sub_f32 v102, v102, v168
    v_sub_f32 v70, v70, v168
    v_sub_f32 v103, v103, v168
    v_sub_f32 v71, v71, v168
    v_exp_f32 v64, v64
    v_exp_f32 v65, v65
    v_exp_f32 v66, v66
    v_exp_f32 v67, v67
    v_exp_f32 v68, v68
    v_exp_f32 v69, v69
    v_exp_f32 v70, v70
    v_exp_f32 v71, v71
    v_cvt_pk_bf16_f32 v120, v64, v65
    v_cvt_pk_bf16_f32 v121, v66, v67
    v_cvt_pk_bf16_f32 v122, v68, v69
    v_cvt_pk_bf16_f32 v123, v70, v71
    v_ldexp_f32 v240, v250, v169
    v_ldexp_f32 v241, v250, v169
    v_ldexp_f32 v242, v250, v169
    v_ldexp_f32 v243, v250, v169
    s_nop 1
    v_mfma_f32_16x16x32_bf16 v[240:243], v[172:175], v[120:123], v[240:243]
    v_accvgpr_read_b32 v160, a64
    v_accvgpr_read_b32 v161, a65
    v_accvgpr_read_b32 v162, a66
    v_accvgpr_read_b32 v163, a67
    v_accvgpr_read_b32 v164, a68
    v_accvgpr_read_b32 v165, a69
    v_accvgpr_read_b32 v166, a70
    v_accvgpr_read_b32 v167, a71
    v_ldexp_f32 v160, v160, v169
    v_ldexp_f32 v161, v161, v169
    v_ldexp_f32 v162, v162, v169
    v_ldexp_f32 v163, v163, v169
    v_ldexp_f32 v164, v164, v169
    v_ldexp_f32 v165, v165, v169
    v_ldexp_f32 v166, v166, v169
    v_ldexp_f32 v167, v167, v169
    v_accvgpr_write_b32 a64, v160
    v_accvgpr_write_b32 a65, v161
    v_accvgpr_write_b32 a66, v162
    v_accvgpr_write_b32 a67, v163
    v_accvgpr_write_b32 a68, v164
    v_accvgpr_write_b32 a69, v165
    v_accvgpr_write_b32 a70, v166
    v_accvgpr_write_b32 a71, v167
    v_accvgpr_read_b32 v160, a72
    v_accvgpr_read_b32 v161, a73
    v_accvgpr_read_b32 v162, a74
    v_accvgpr_read_b32 v163, a75
    v_accvgpr_read_b32 v164, a76
    v_accvgpr_read_b32 v165, a77
    v_accvgpr_read_b32 v166, a78
    v_accvgpr_read_b32 v167, a79
    v_ldexp_f32 v160, v160, v169
    v_ldexp_f32 v161, v161, v169
    v_ldexp_f32 v162, v162, v169
    v_ldexp_f32 v163, v163, v169
    v_ldexp_f32 v164, v164, v169
    v_ldexp_f32 v165, v165, v169
    v_ldexp_f32 v166, v166, v169
    v_ldexp_f32 v167, v167, v169
    v_accvgpr_write_b32 a72, v160
    v_accvgpr_write_b32 a73, v161
    v_accvgpr_write_b32 a74, v162
    v_accvgpr_write_b32 a75, v163
    v_accvgpr_write_b32 a76, v164
    v_accvgpr_write_b32 a77, v165
    v_accvgpr_write_b32 a78, v166
    v_accvgpr_write_b32 a79, v167
    v_accvgpr_read_b32 v160, a80
    v_accvgpr_read_b32 v161, a81
    v_accvgpr_read_b32 v162, a82
    v_accvgpr_read_b32 v163, a83
    v_accvgpr_read_b32 v164, a84
    v_accvgpr_read_b32 v165, a85
    v_accvgpr_read_b32 v166, a86
    v_accvgpr_read_b32 v167, a87
    v_ldexp_f32 v160, v160, v169
    v_ldexp_f32 v161, v161, v169
    v_ldexp_f32 v162, v162, v169
    v_ldexp_f32 v163, v163, v169
    v_ldexp_f32 v164, v164, v169
    v_ldexp_f32 v165, v165, v169
    v_ldexp_f32 v166, v166, v169
    v_ldexp_f32 v167, v167, v169
    v_accvgpr_write_b32 a80, v160
    v_accvgpr_write_b32 a81, v161
    v_accvgpr_write_b32 a82, v162
    v_accvgpr_write_b32 a83, v163
    v_accvgpr_write_b32 a84, v164
    v_accvgpr_write_b32 a85, v165
    v_accvgpr_write_b32 a86, v166
    v_accvgpr_write_b32 a87, v167
    v_accvgpr_read_b32 v160, a88
    v_accvgpr_read_b32 v161, a89
    v_accvgpr_read_b32 v162, a90
    v_accvgpr_read_b32 v163, a91
    v_accvgpr_read_b32 v164, a92
    v_accvgpr_read_b32 v165, a93
    v_accvgpr_read_b32 v166, a94
    v_accvgpr_read_b32 v167, a95
    v_ldexp_f32 v160, v160, v169
    v_ldexp_f32 v161, v161, v169
    v_ldexp_f32 v162, v162, v169
    v_ldexp_f32 v163, v163, v169
    v_ldexp_f32 v164, v164, v169
    v_ldexp_f32 v165, v165, v169
    v_ldexp_f32 v166, v166, v169
    v_ldexp_f32 v167, v167, v169
    v_accvgpr_write_b32 a88, v160
    v_accvgpr_write_b32 a89, v161
    v_accvgpr_write_b32 a90, v162
    v_accvgpr_write_b32 a91, v163
    v_accvgpr_write_b32 a92, v164
    v_accvgpr_write_b32 a93, v165
    v_accvgpr_write_b32 a94, v166
    v_accvgpr_write_b32 a95, v167
    v_max3_f32 v168, v72, v73, v74
    v_max3_f32 v168, v168, v75, v76
    v_max3_f32 v168, v168, v77, v78
    v_max_f32 v168, v168, v79
    v_mov_b32 v169, v168
    s_nop 1
    v_permlane16_swap_b32 v168, v169
    v_max_f32 v168, v168, v169
    v_mov_b32 v169, v168
    s_nop 1
    v_permlane32_swap_b32 v168, v169
    v_max_f32 v168, v168, v169
    v_add_f32 v168, 0x42b40000, v168
    v_max_f32 v168, 0, v168
    v_ceil_f32 v168, v168
    v_cvt_i32_f32 v169, v168
    v_sub_u32 v169, 0, v169
    v_sub_f32 v156, v156, v168
    v_sub_f32 v157, v157, v168
    v_sub_f32 v158, v158, v168
    v_sub_f32 v159, v159, v168
    v_sub_f32 v104, v104, v168
    v_sub_f32 v72, v72, v168
    v_sub_f32 v105, v105, v168
    v_sub_f32 v73, v73, v168
    v_sub_f32 v106, v106, v168
    v_sub_f32 v74, v74, v168
    v_sub_f32 v107, v107, v168
    v_sub_f32 v75, v75, v168
    v_sub_f32 v108, v108, v168
    v_sub_f32 v76, v76, v168
    v_sub_f32 v109, v109, v168
    v_sub_f32 v77, v77, v168
    v_sub_f32 v110, v110, v168
    v_sub_f32 v78, v78, v168
    v_sub_f32 v111, v111, v168
    v_sub_f32 v79, v79, v168
    v_exp_f32 v72, v72
    v_exp_f32 v73, v73
    v_exp_f32 v74, v74
    v_exp_f32 v75, v75
    v_exp_f32 v76, v76
    v_exp_f32 v77, v77
    v_exp_f32 v78, v78
    v_exp_f32 v79, v79
    v_cvt_pk_bf16_f32 v124, v72, v73
    v_cvt_pk_bf16_f32 v125, v74, v75
    v_cvt_pk_bf16_f32 v126, v76, v77
    v_cvt_pk_bf16_f32 v127, v78, v79
    v_ldexp_f32 v244, v251, v169
    v_ldexp_f32 v245, v251, v169
    v_ldexp_f32 v246, v251, v169
    v_ldexp_f32 v247, v251, v169
    s_nop 1
    v_mfma_f32_16x16x32_bf16 v[244:247], v[172:175], v[124:127], v[244:247]
    v_accvgpr_read_b32 v160, a96
    v_accvgpr_read_b32 v161, a97
    v_accvgpr_read_b32 v162, a98
    v_accvgpr_read_b32 v163, a99
    v_accvgpr_read_b32 v164, a100
    v_accvgpr_read_b32 v165, a101
    v_accvgpr_read_b32 v166, a102
    v_accvgpr_read_b32 v167, a103
    v_ldexp_f32 v160, v160, v169
    v_ldexp_f32 v161, v161, v169
    v_ldexp_f32 v162, v162, v169
    v_ldexp_f32 v163, v163, v169
    v_ldexp_f32 v164, v164, v169
    v_ldexp_f32 v165, v165, v169
    v_ldexp_f32 v166, v166, v169
    v_ldexp_f32 v167, v167, v169
    v_accvgpr_write_b32 a96, v160
    v_accvgpr_write_b32 a97, v161
    v_accvgpr_write_b32 a98, v162
    v_accvgpr_write_b32 a99, v163
    v_accvgpr_write_b32 a100, v164
    v_accvgpr_write_b32 a101, v165
    v_accvgpr_write_b32 a102, v166
    v_accvgpr_write_b32 a103, v167
    v_accvgpr_read_b32 v160, a104
    v_accvgpr_read_b32 v161, a105
    v_accvgpr_read_b32 v162, a106
    v_accvgpr_read_b32 v163, a107
    v_accvgpr_read_b32 v164, a108
    v_accvgpr_read_b32 v165, a109
    v_accvgpr_read_b32 v166, a110
    v_accvgpr_read_b32 v167, a111
    v_ldexp_f32 v160, v160, v169
    v_ldexp_f32 v161, v161, v169
    v_ldexp_f32 v162, v162, v169
    v_ldexp_f32 v163, v163, v169
    v_ldexp_f32 v164, v164, v169
    v_ldexp_f32 v165, v165, v169
    v_ldexp_f32 v166, v166, v169
    v_ldexp_f32 v167, v167, v169
    v_accvgpr_write_b32 a104, v160
    v_accvgpr_write_b32 a105, v161
    v_accvgpr_write_b32 a106, v162
    v_accvgpr_write_b32 a107, v163
    v_accvgpr_write_b32 a108, v164
    v_accvgpr_write_b32 a109, v165
    v_accvgpr_write_b32 a110, v166
    v_accvgpr_write_b32 a111, v167
    v_accvgpr_read_b32 v160, a112
    v_accvgpr_read_b32 v161, a113
    v_accvgpr_read_b32 v162, a114
    v_accvgpr_read_b32 v163, a115
    v_accvgpr_read_b32 v164, a116
    v_accvgpr_read_b32 v165, a117
    v_accvgpr_read_b32 v166, a118
    v_accvgpr_read_b32 v167, a119
    v_ldexp_f32 v160, v160, v169
    v_ldexp_f32 v161, v161, v169
    v_ldexp_f32 v162, v162, v169
    v_ldexp_f32 v163, v163, v169
    v_ldexp_f32 v164, v164, v169
    v_ldexp_f32 v165, v165, v169
    v_ldexp_f32 v166, v166, v169
    v_ldexp_f32 v167, v167, v169
    v_accvgpr_write_b32 a112, v160
    v_accvgpr_write_b32 a113, v161
    v_accvgpr_write_b32 a114, v162
    v_accvgpr_write_b32 a115, v163
    v_accvgpr_write_b32 a116, v164
    v_accvgpr_write_b32 a117, v165
    v_accvgpr_write_b32 a118, v166
    v_accvgpr_write_b32 a119, v167
    v_accvgpr_read_b32 v160, a120
    v_accvgpr_read_b32 v161, a121
    v_accvgpr_read_b32 v162, a122
    v_accvgpr_read_b32 v163, a123
    v_accvgpr_read_b32 v164, a124
    v_accvgpr_read_b32 v165, a125
    v_accvgpr_read_b32 v166, a126
    v_accvgpr_read_b32 v167, a127
    v_ldexp_f32 v160, v160, v169
    v_ldexp_f32 v161, v161, v169
    v_ldexp_f32 v162, v162, v169
    v_ldexp_f32 v163, v163, v169
    v_ldexp_f32 v164, v164, v169
    v_ldexp_f32 v165, v165, v169
    v_ldexp_f32 v166, v166, v169
    v_ldexp_f32 v167, v167, v169
    v_accvgpr_write_b32 a120, v160
    v_accvgpr_write_b32 a121, v161
    v_accvgpr_write_b32 a122, v162
    v_accvgpr_write_b32 a123, v163
    v_accvgpr_write_b32 a124, v164
    v_accvgpr_write_b32 a125, v165
    v_accvgpr_write_b32 a126, v166
    v_accvgpr_write_b32 a127, v167
    s_nop 1
    s_cmp_eq_u32 s52, 100
    s_cbranch_scc1 k4_kernel_ret100
    s_cmp_eq_u32 s52, 102
    s_cbranch_scc1 k4_kernel_ret102
    s_cmp_eq_u32 s52, 1
    s_cbranch_scc1 k4_kernel_ret1
    s_cmp_eq_u32 s52, 3
    s_cbranch_scc1 k4_kernel_ret3
    s_cmp_eq_u32 s52, 5
    s_cbranch_scc1 k4_kernel_ret5
    s_cmp_eq_u32 s52, 7
    s_cbranch_scc1 k4_kernel_ret7
    s_cmp_eq_u32 s52, 160
    s_cbranch_scc1 k4_kernel_ret160
    s_branch k4_kernel_ret162
k4_kernel_stub101:
    s_movk_i32 s52, 101
    s_branch k4_kernel_rare1
k4_kernel_stub0:
    s_movk_i32 s52, 0
    s_branch k4_kernel_rare1
k4_kernel_stub2:
    s_movk_i32 s52, 2
    s_branch k4_kernel_rare1
k4_kernel_stub4:
    s_movk_i32 s52, 4
    s_branch k4_kernel_rare1
k4_kernel_stub6:
    s_movk_i32 s52, 6
    s_branch k4_kernel_rare1
k4_kernel_stub159:
    s_movk_i32 s52, 159
    s_branch k4_kernel_rare1
k4_kernel_stub161:
    s_movk_i32 s52, 161
    s_branch k4_kernel_rare1
k4_kernel_stub163:
    s_movk_i32 s52, 163
    s_branch k4_kernel_rare1
k4_kernel_rare1:
    s_nop 15
    v_max3_f32 v168, v80, v81, v82
    v_max3_f32 v168, v168, v83, v84
    v_max3_f32 v168, v168, v85, v86
    v_max_f32 v168, v168, v87
    v_mov_b32 v169, v168
    s_nop 1
    v_permlane16_swap_b32 v168, v169
    v_max_f32 v168, v168, v169
    v_mov_b32 v169, v168
    s_nop 1
    v_permlane32_swap_b32 v168, v169
    v_max_f32 v168, v168, v169
    v_add_f32 v168, 0x42b40000, v168
    v_max_f32 v168, 0, v168
    v_ceil_f32 v168, v168
    v_cvt_i32_f32 v169, v168
    v_sub_u32 v169, 0, v169
    v_sub_f32 v144, v144, v168
    v_sub_f32 v145, v145, v168
    v_sub_f32 v146, v146, v168
    v_sub_f32 v147, v147, v168
    v_sub_f32 v48, v48, v168
    v_sub_f32 v80, v80, v168
    v_sub_f32 v49, v49, v168
    v_sub_f32 v81, v81, v168
    v_sub_f32 v50, v50, v168
    v_sub_f32 v82, v82, v168
    v_sub_f32 v51, v51, v168
    v_sub_f32 v83, v83, v168
    v_sub_f32 v52, v52, v168
    v_sub_f32 v84, v84, v168
    v_sub_f32 v53, v53, v168
    v_sub_f32 v85, v85, v168
    v_sub_f32 v54, v54, v168
    v_sub_f32 v86, v86, v168
    v_sub_f32 v55, v55, v168
    v_sub_f32 v87, v87, v168
    v_exp_f32 v80, v80
    v_exp_f32 v81, v81
    v_exp_f32 v82, v82
    v_exp_f32 v83, v83
    v_exp_f32 v84, v84
    v_exp_f32 v85, v85
    v_exp_f32 v86, v86
    v_exp_f32 v87, v87
    v_cvt_pk_bf16_f32 v128, v80, v81
    v_cvt_pk_bf16_f32 v129, v82, v83
    v_cvt_pk_bf16_f32 v130, v84, v85
    v_cvt_pk_bf16_f32 v131, v86, v87
    v_ldexp_f32 v40, v248, v169
    v_ldexp_f32 v41, v248, v169
    v_ldexp_f32 v42, v248, v169
    v_ldexp_f32 v43, v248, v169
    s_nop 1
    v_mfma_f32_16x16x32_bf16 v[40:43], v[172:175], v[128:131], v[40:43]
    v_accvgpr_read_b32 v160, a0
    v_accvgpr_read_b32 v161, a1
    v_accvgpr_read_b32 v162, a2
    v_accvgpr_read_b32 v163, a3
    v_accvgpr_read_b32 v164, a4
    v_accvgpr_read_b32 v165, a5
    v_accvgpr_read_b32 v166, a6
    v_accvgpr_read_b32 v167, a7
    v_ldexp_f32 v160, v160, v169
    v_ldexp_f32 v161, v161, v169
    v_ldexp_f32 v162, v162, v169
    v_ldexp_f32 v163, v163, v169
    v_ldexp_f32 v164, v164, v169
    v_ldexp_f32 v165, v165, v169
    v_ldexp_f32 v166, v166, v169
    v_ldexp_f32 v167, v167, v169
    v_accvgpr_write_b32 a0, v160
    v_accvgpr_write_b32 a1, v161
    v_accvgpr_write_b32 a2, v162
    v_accvgpr_write_b32 a3, v163
    v_accvgpr_write_b32 a4, v164
    v_accvgpr_write_b32 a5, v165
    v_accvgpr_write_b32 a6, v166
    v_accvgpr_write_b32 a7, v167
    v_accvgpr_read_b32 v160, a8
    v_accvgpr_read_b32 v161, a9
    v_accvgpr_read_b32 v162, a10
    v_accvgpr_read_b32 v163, a11
    v_accvgpr_read_b32 v164, a12
    v_accvgpr_read_b32 v165, a13
    v_accvgpr_read_b32 v166, a14
    v_accvgpr_read_b32 v167, a15
    v_ldexp_f32 v160, v160, v169
    v_ldexp_f32 v161, v161, v169
    v_ldexp_f32 v162, v162, v169
    v_ldexp_f32 v163, v163, v169
    v_ldexp_f32 v164, v164, v169
    v_ldexp_f32 v165, v165, v169
    v_ldexp_f32 v166, v166, v169
    v_ldexp_f32 v167, v167, v169
    v_accvgpr_write_b32 a8, v160
    v_accvgpr_write_b32 a9, v161
    v_accvgpr_write_b32 a10, v162
    v_accvgpr_write_b32 a11, v163
    v_accvgpr_write_b32 a12, v164
    v_accvgpr_write_b32 a13, v165
    v_accvgpr_write_b32 a14, v166
    v_accvgpr_write_b32 a15, v167
    v_accvgpr_read_b32 v160, a16
    v_accvgpr_read_b32 v161, a17
    v_accvgpr_read_b32 v162, a18
    v_accvgpr_read_b32 v163, a19
    v_accvgpr_read_b32 v164, a20
    v_accvgpr_read_b32 v165, a21
    v_accvgpr_read_b32 v166, a22
    v_accvgpr_read_b32 v167, a23
    v_ldexp_f32 v160, v160, v169
    v_ldexp_f32 v161, v161, v169
    v_ldexp_f32 v162, v162, v169
    v_ldexp_f32 v163, v163, v169
    v_ldexp_f32 v164, v164, v169
    v_ldexp_f32 v165, v165, v169
    v_ldexp_f32 v166, v166, v169
    v_ldexp_f32 v167, v167, v169
    v_accvgpr_write_b32 a16, v160
    v_accvgpr_write_b32 a17, v161
    v_accvgpr_write_b32 a18, v162
    v_accvgpr_write_b32 a19, v163
    v_accvgpr_write_b32 a20, v164
    v_accvgpr_write_b32 a21, v165
    v_accvgpr_write_b32 a22, v166
    v_accvgpr_write_b32 a23, v167
    v_accvgpr_read_b32 v160, a24
    v_accvgpr_read_b32 v161, a25
    v_accvgpr_read_b32 v162, a26
    v_accvgpr_read_b32 v163, a27
    v_accvgpr_read_b32 v164, a28
    v_accvgpr_read_b32 v165, a29
    v_accvgpr_read_b32 v166, a30
    v_accvgpr_read_b32 v167, a31
    v_ldexp_f32 v160, v160, v169
    v_ldexp_f32 v161, v161, v169
    v_ldexp_f32 v162, v162, v169
    v_ldexp_f32 v163, v163, v169
    v_ldexp_f32 v164, v164, v169
    v_ldexp_f32 v165, v165, v169
    v_ldexp_f32 v166, v166, v169
    v_ldexp_f32 v167, v167, v169
    v_accvgpr_write_b32 a24, v160
    v_accvgpr_write_b32 a25, v161
    v_accvgpr_write_b32 a26, v162
    v_accvgpr_write_b32 a27, v163
    v_accvgpr_write_b32 a28, v164
    v_accvgpr_write_b32 a29, v165
    v_accvgpr_write_b32 a30, v166
    v_accvgpr_write_b32 a31, v167
    v_max3_f32 v168, v88, v89, v90
    v_max3_f32 v168, v168, v91, v92
    v_max3_f32 v168, v168, v93, v94
    v_max_f32 v168, v168, v95
    v_mov_b32 v169, v168
    s_nop 1
    v_permlane16_swap_b32 v168, v169
    v_max_f32 v168, v168, v169
    v_mov_b32 v169, v168
    s_nop 1
    v_permlane32_swap_b32 v168, v169
    v_max_f32 v168, v168, v169
    v_add_f32 v168, 0x42b40000, v168
    v_max_f32 v168, 0, v168
    v_ceil_f32 v168, v168
    v_cvt_i32_f32 v169, v168
    v_sub_u32 v169, 0, v169
    v_sub_f32 v148, v148, v168
    v_sub_f32 v149, v149, v168
    v_sub_f32 v150, v150, v168
    v_sub_f32 v151, v151, v168
    v_sub_f32 v56, v56, v168
    v_sub_f32 v88, v88, v168
    v_sub_f32 v57, v57, v168
    v_sub_f32 v89, v89, v168
    v_sub_f32 v58, v58, v168
    v_sub_f32 v90, v90, v168
    v_sub_f32 v59, v59, v168
    v_sub_f32 v91, v91, v168
    v_sub_f32 v60, v60, v168
    v_sub_f32 v92, v92, v168
    v_sub_f32 v61, v61, v168
    v_sub_f32 v93, v93, v168
    v_sub_f32 v62, v62, v168
    v_sub_f32 v94, v94, v168
    v_sub_f32 v63, v63, v168
    v_sub_f32 v95, v95, v168
    v_exp_f32 v88, v88
    v_exp_f32 v89, v89
    v_exp_f32 v90, v90
    v_exp_f32 v91, v91
    v_exp_f32 v92, v92
    v_exp_f32 v93, v93
    v_exp_f32 v94, v94
    v_exp_f32 v95, v95
    v_cvt_pk_bf16_f32 v132, v88, v89
    v_cvt_pk_bf16_f32 v133, v90, v91
    v_cvt_pk_bf16_f32 v134, v92, v93
    v_cvt_pk_bf16_f32 v135, v94, v95
    v_ldexp_f32 v44, v249, v169
    v_ldexp_f32 v45, v249, v169
    v_ldexp_f32 v46, v249, v169
    v_ldexp_f32 v47, v249, v169
    s_nop 1
    v_mfma_f32_16x16x32_bf16 v[44:47], v[172:175], v[132:135], v[44:47]
    v_accvgpr_read_b32 v160, a32
    v_accvgpr_read_b32 v161, a33
    v_accvgpr_read_b32 v162, a34
    v_accvgpr_read_b32 v163, a35
    v_accvgpr_read_b32 v164, a36
    v_accvgpr_read_b32 v165, a37
    v_accvgpr_read_b32 v166, a38
    v_accvgpr_read_b32 v167, a39
    v_ldexp_f32 v160, v160, v169
    v_ldexp_f32 v161, v161, v169
    v_ldexp_f32 v162, v162, v169
    v_ldexp_f32 v163, v163, v169
    v_ldexp_f32 v164, v164, v169
    v_ldexp_f32 v165, v165, v169
    v_ldexp_f32 v166, v166, v169
    v_ldexp_f32 v167, v167, v169
    v_accvgpr_write_b32 a32, v160
    v_accvgpr_write_b32 a33, v161
    v_accvgpr_write_b32 a34, v162
    v_accvgpr_write_b32 a35, v163
    v_accvgpr_write_b32 a36, v164
    v_accvgpr_write_b32 a37, v165
    v_accvgpr_write_b32 a38, v166
    v_accvgpr_write_b32 a39, v167
    v_accvgpr_read_b32 v160, a40
    v_accvgpr_read_b32 v161, a41
    v_accvgpr_read_b32 v162, a42
    v_accvgpr_read_b32 v163, a43
    v_accvgpr_read_b32 v164, a44
    v_accvgpr_read_b32 v165, a45
    v_accvgpr_read_b32 v166, a46
    v_accvgpr_read_b32 v167, a47
    v_ldexp_f32 v160, v160, v169
    v_ldexp_f32 v161, v161, v169
    v_ldexp_f32 v162, v162, v169
    v_ldexp_f32 v163, v163, v169
    v_ldexp_f32 v164, v164, v169
    v_ldexp_f32 v165, v165, v169
    v_ldexp_f32 v166, v166, v169
    v_ldexp_f32 v167, v167, v169
    v_accvgpr_write_b32 a40, v160
    v_accvgpr_write_b32 a41, v161
    v_accvgpr_write_b32 a42, v162
    v_accvgpr_write_b32 a43, v163
    v_accvgpr_write_b32 a44, v164
    v_accvgpr_write_b32 a45, v165
    v_accvgpr_write_b32 a46, v166
    v_accvgpr_write_b32 a47, v167
    v_accvgpr_read_b32 v160, a48
    v_accvgpr_read_b32 v161, a49
    v_accvgpr_read_b32 v162, a50
    v_accvgpr_read_b32 v163, a51
    v_accvgpr_read_b32 v164, a52
    v_accvgpr_read_b32 v165, a53
    v_accvgpr_read_b32 v166, a54
    v_accvgpr_read_b32 v167, a55
    v_ldexp_f32 v160, v160, v169
    v_ldexp_f32 v161, v161, v169
    v_ldexp_f32 v162, v162, v169
    v_ldexp_f32 v163, v163, v169
    v_ldexp_f32 v164, v164, v169
    v_ldexp_f32 v165, v165, v169
    v_ldexp_f32 v166, v166, v169
    v_ldexp_f32 v167, v167, v169
    v_accvgpr_write_b32 a48, v160
    v_accvgpr_write_b32 a49, v161
    v_accvgpr_write_b32 a50, v162
    v_accvgpr_write_b32 a51, v163
    v_accvgpr_write_b32 a52, v164
    v_accvgpr_write_b32 a53, v165
    v_accvgpr_write_b32 a54, v166
    v_accvgpr_write_b32 a55, v167
    v_accvgpr_read_b32 v160, a56
    v_accvgpr_read_b32 v161, a57
    v_accvgpr_read_b32 v162, a58
    v_accvgpr_read_b32 v163, a59
    v_accvgpr_read_b32 v164, a60
    v_accvgpr_read_b32 v165, a61
    v_accvgpr_read_b32 v166, a62
    v_accvgpr_read_b32 v167, a63
    v_ldexp_f32 v160, v160, v169
    v_ldexp_f32 v161, v161, v169
    v_ldexp_f32 v162, v162, v169
    v_ldexp_f32 v163, v163, v169
    v_ldexp_f32 v164, v164, v169
    v_ldexp_f32 v165, v165, v169
    v_ldexp_f32 v166, v166, v169
    v_ldexp_f32 v167, v167, v169
    v_accvgpr_write_b32 a56, v160
    v_accvgpr_write_b32 a57, v161
    v_accvgpr_write_b32 a58, v162
    v_accvgpr_write_b32 a59, v163
    v_accvgpr_write_b32 a60, v164
    v_accvgpr_write_b32 a61, v165
    v_accvgpr_write_b32 a62, v166
    v_accvgpr_write_b32 a63, v167
    v_max3_f32 v168, v96, v97, v98
    v_max3_f32 v168, v168, v99, v100
    v_max3_f32 v168, v168, v101, v102
    v_max_f32 v168, v168, v103
    v_mov_b32 v169, v168
    s_nop 1
    v_permlane16_swap_b32 v168, v169
    v_max_f32 v168, v168, v169
    v_mov_b32 v169, v168
    s_nop 1
    v_permlane32_swap_b32 v168, v169
    v_max_f32 v168, v168, v169
    v_add_f32 v168, 0x42b40000, v168
    v_max_f32 v168, 0, v168
    v_ceil_f32 v168, v168
    v_cvt_i32_f32 v169, v168
    v_sub_u32 v169, 0, v169
    v_sub_f32 v152, v152, v168
    v_sub_f32 v153, v153, v168
    v_sub_f32 v154, v154, v168
    v_sub_f32 v155, v155, v168
    v_sub_f32 v64, v64, v168
    v_sub_f32 v96, v96, v168
    v_sub_f32 v65, v65, v168
    v_sub_f32 v97, v97, v168
    v_sub_f32 v66, v66, v168
    v_sub_f32 v98, v98, v168
    v_sub_f32 v67, v67, v168
    v_sub_f32 v99, v99, v168
    v_sub_f32 v68, v68, v168
    v_sub_f32 v100, v100, v168
    v_sub_f32 v69, v69, v168
    v_sub_f32 v101, v101, v168
    v_sub_f32 v70, v70, v168
    v_sub_f32 v102, v102, v168
    v_sub_f32 v71, v71, v168
    v_sub_f32 v103, v103, v168
    v_exp_f32 v96, v96
    v_exp_f32 v97, v97
    v_exp_f32 v98, v98
    v_exp_f32 v99, v99
    v_exp_f32 v100, v100
    v_exp_f32 v101, v101
    v_exp_f32 v102, v102
    v_exp_f32 v103, v103
    v_cvt_pk_bf16_f32 v136, v96, v97
    v_cvt_pk_bf16_f32 v137, v98, v99
    v_cvt_pk_bf16_f32 v138, v100, v101
    v_cvt_pk_bf16_f32 v139, v102, v103
    v_ldexp_f32 v240, v250, v169
    v_ldexp_f32 v241, v250, v169
    v_ldexp_f32 v242, v250, v169
    v_ldexp_f32 v243, v250, v169
    s_nop 1
    v_mfma_f32_16x16x32_bf16 v[240:243], v[172:175], v[136:139], v[240:243]
    v_accvgpr_read_b32 v160, a64
    v_accvgpr_read_b32 v161, a65
    v_accvgpr_read_b32 v162, a66
    v_accvgpr_read_b32 v163, a67
    v_accvgpr_read_b32 v164, a68
    v_accvgpr_read_b32 v165, a69
    v_accvgpr_read_b32 v166, a70
    v_accvgpr_read_b32 v167, a71
    v_ldexp_f32 v160, v160, v169
    v_ldexp_f32 v161, v161, v169
    v_ldexp_f32 v162, v162, v169
    v_ldexp_f32 v163, v163, v169
    v_ldexp_f32 v164, v164, v169
    v_ldexp_f32 v165, v165, v169
    v_ldexp_f32 v166, v166, v169
    v_ldexp_f32 v167, v167, v169
    v_accvgpr_write_b32 a64, v160
    v_accvgpr_write_b32 a65, v161
    v_accvgpr_write_b32 a66, v162
    v_accvgpr_write_b32 a67, v163
    v_accvgpr_write_b32 a68, v164
    v_accvgpr_write_b32 a69, v165
    v_accvgpr_write_b32 a70, v166
    v_accvgpr_write_b32 a71, v167
    v_accvgpr_read_b32 v160, a72
    v_accvgpr_read_b32 v161, a73
    v_accvgpr_read_b32 v162, a74
    v_accvgpr_read_b32 v163, a75
    v_accvgpr_read_b32 v164, a76
    v_accvgpr_read_b32 v165, a77
    v_accvgpr_read_b32 v166, a78
    v_accvgpr_read_b32 v167, a79
    v_ldexp_f32 v160, v160, v169
    v_ldexp_f32 v161, v161, v169
    v_ldexp_f32 v162, v162, v169
    v_ldexp_f32 v163, v163, v169
    v_ldexp_f32 v164, v164, v169
    v_ldexp_f32 v165, v165, v169
    v_ldexp_f32 v166, v166, v169
    v_ldexp_f32 v167, v167, v169
    v_accvgpr_write_b32 a72, v160
    v_accvgpr_write_b32 a73, v161
    v_accvgpr_write_b32 a74, v162
    v_accvgpr_write_b32 a75, v163
    v_accvgpr_write_b32 a76, v164
    v_accvgpr_write_b32 a77, v165
    v_accvgpr_write_b32 a78, v166
    v_accvgpr_write_b32 a79, v167
    v_accvgpr_read_b32 v160, a80
    v_accvgpr_read_b32 v161, a81
    v_accvgpr_read_b32 v162, a82
    v_accvgpr_read_b32 v163, a83
    v_accvgpr_read_b32 v164, a84
    v_accvgpr_read_b32 v165, a85
    v_accvgpr_read_b32 v166, a86
    v_accvgpr_read_b32 v167, a87
    v_ldexp_f32 v160, v160, v169
    v_ldexp_f32 v161, v161, v169
    v_ldexp_f32 v162, v162, v169
    v_ldexp_f32 v163, v163, v169
    v_ldexp_f32 v164, v164, v169
    v_ldexp_f32 v165, v165, v169
    v_ldexp_f32 v166, v166, v169
    v_ldexp_f32 v167, v167, v169
    v_accvgpr_write_b32 a80, v160
    v_accvgpr_write_b32 a81, v161
    v_accvgpr_write_b32 a82, v162
    v_accvgpr_write_b32 a83, v163
    v_accvgpr_write_b32 a84, v164
    v_accvgpr_write_b32 a85, v165
    v_accvgpr_write_b32 a86, v166
    v_accvgpr_write_b32 a87, v167
    v_accvgpr_read_b32 v160, a88
    v_accvgpr_read_b32 v161, a89
    v_accvgpr_read_b32 v162, a90
    v_accvgpr_read_b32 v163, a91
    v_accvgpr_read_b32 v164, a92
    v_accvgpr_read_b32 v165, a93
    v_accvgpr_read_b32 v166, a94
    v_accvgpr_read_b32 v167, a95
    v_ldexp_f32 v160, v160, v169
    v_ldexp_f32 v161, v161, v169
    v_ldexp_f32 v162, v162, v169
    v_ldexp_f32 v163, v163, v169
    v_ldexp_f32 v164, v164, v169
    v_ldexp_f32 v165, v165, v169
    v_ldexp_f32 v166, v166, v169
    v_ldexp_f32 v167, v167, v169
    v_accvgpr_write_b32 a88, v160
    v_accvgpr_write_b32 a89, v161
    v_accvgpr_write_b32 a90, v162
    v_accvgpr_write_b32 a91, v163
    v_accvgpr_write_b32 a92, v164
    v_accvgpr_write_b32 a93, v165
    v_accvgpr_write_b32 a94, v166
    v_accvgpr_write_b32 a95, v167
    v_max3_f32 v168, v104, v105, v106
    v_max3_f32 v168, v168, v107, v108
    v_max3_f32 v168, v168, v109, v110
    v_max_f32 v168, v168, v111
    v_mov_b32 v169, v168
    s_nop 1
    v_permlane16_swap_b32 v168, v169
    v_max_f32 v168, v168, v169
    v_mov_b32 v169, v168
    s_nop 1
    v_permlane32_swap_b32 v168, v169
    v_max_f32 v168, v168, v169
    v_add_f32 v168, 0x42b40000, v168
    v_max_f32 v168, 0, v168
    v_ceil_f32 v168, v168
    v_cvt_i32_f32 v169, v168
    v_sub_u32 v169, 0, v169
    v_sub_f32 v156, v156, v168
    v_sub_f32 v157, v157, v168
    v_sub_f32 v158, v158, v168
    v_sub_f32 v159, v159, v168
    v_sub_f32 v72, v72, v168
    v_sub_f32 v104, v104, v168
    v_sub_f32 v73, v73, v168
    v_sub_f32 v105, v105, v168
    v_sub_f32 v74, v74, v168
    v_sub_f32 v106, v106, v168
    v_sub_f32 v75, v75, v168
    v_sub_f32 v107, v107, v168
    v_sub_f32 v76, v76, v168
    v_sub_f32 v108, v108, v168
    v_sub_f32 v77, v77, v168
    v_sub_f32 v109, v109, v168
    v_sub_f32 v78, v78, v168
    v_sub_f32 v110, v110, v168
    v_sub_f32 v79, v79, v168
    v_sub_f32 v111, v111, v168
    v_exp_f32 v104, v104
    v_exp_f32 v105, v105
    v_exp_f32 v106, v106
    v_exp_f32 v107, v107
    v_exp_f32 v108, v108
    v_exp_f32 v109, v109
    v_exp_f32 v110, v110
    v_exp_f32 v111, v111
    v_cvt_pk_bf16_f32 v140, v104, v105
    v_cvt_pk_bf16_f32 v141, v106, v107
    v_cvt_pk_bf16_f32 v142, v108, v109
    v_cvt_pk_bf16_f32 v143, v110, v111
    v_ldexp_f32 v244, v251, v169
    v_ldexp_f32 v245, v251, v169
    v_ldexp_f32 v246, v251, v169
    v_ldexp_f32 v247, v251, v169
    s_nop 1
    v_mfma_f32_16x16x32_bf16 v[244:247], v[172:175], v[140:143], v[244:247]
    v_accvgpr_read_b32 v160, a96
    v_accvgpr_read_b32 v161, a97
    v_accvgpr_read_b32 v162, a98
    v_accvgpr_read_b32 v163, a99
    v_accvgpr_read_b32 v164, a100
    v_accvgpr_read_b32 v165, a101
    v_accvgpr_read_b32 v166, a102
    v_accvgpr_read_b32 v167, a103
    v_ldexp_f32 v160, v160, v169
    v_ldexp_f32 v161, v161, v169
    v_ldexp_f32 v162, v162, v169
    v_ldexp_f32 v163, v163, v169
    v_ldexp_f32 v164, v164, v169
    v_ldexp_f32 v165, v165, v169
    v_ldexp_f32 v166, v166, v169
    v_ldexp_f32 v167, v167, v169
    v_accvgpr_write_b32 a96, v160
    v_accvgpr_write_b32 a97, v161
    v_accvgpr_write_b32 a98, v162
    v_accvgpr_write_b32 a99, v163
    v_accvgpr_write_b32 a100, v164
    v_accvgpr_write_b32 a101, v165
    v_accvgpr_write_b32 a102, v166
    v_accvgpr_write_b32 a103, v167
    v_accvgpr_read_b32 v160, a104
    v_accvgpr_read_b32 v161, a105
    v_accvgpr_read_b32 v162, a106
    v_accvgpr_read_b32 v163, a107
    v_accvgpr_read_b32 v164, a108
    v_accvgpr_read_b32 v165, a109
    v_accvgpr_read_b32 v166, a110
    v_accvgpr_read_b32 v167, a111
    v_ldexp_f32 v160, v160, v169
    v_ldexp_f32 v161, v161, v169
    v_ldexp_f32 v162, v162, v169
    v_ldexp_f32 v163, v163, v169
    v_ldexp_f32 v164, v164, v169
    v_ldexp_f32 v165, v165, v169
    v_ldexp_f32 v166, v166, v169
    v_ldexp_f32 v167, v167, v169
    v_accvgpr_write_b32 a104, v160
    v_accvgpr_write_b32 a105, v161
    v_accvgpr_write_b32 a106, v162
    v_accvgpr_write_b32 a107, v163
    v_accvgpr_write_b32 a108, v164
    v_accvgpr_write_b32 a109, v165
    v_accvgpr_write_b32 a110, v166
    v_accvgpr_write_b32 a111, v167
    v_accvgpr_read_b32 v160, a112
    v_accvgpr_read_b32 v161, a113
    v_accvgpr_read_b32 v162, a114
    v_accvgpr_read_b32 v163, a115
    v_accvgpr_read_b32 v164, a116
    v_accvgpr_read_b32 v165, a117
    v_accvgpr_read_b32 v166, a118
    v_accvgpr_read_b32 v167, a119
    v_ldexp_f32 v160, v160, v169
    v_ldexp_f32 v161, v161, v169
    v_ldexp_f32 v162, v162, v169
    v_ldexp_f32 v163, v163, v169
    v_ldexp_f32 v164, v164, v169
    v_ldexp_f32 v165, v165, v169
    v_ldexp_f32 v166, v166, v169
    v_ldexp_f32 v167, v167, v169
    v_accvgpr_write_b32 a112, v160
    v_accvgpr_write_b32 a113, v161
    v_accvgpr_write_b32 a114, v162
    v_accvgpr_write_b32 a115, v163
    v_accvgpr_write_b32 a116, v164
    v_accvgpr_write_b32 a117, v165
    v_accvgpr_write_b32 a118, v166
    v_accvgpr_write_b32 a119, v167
    v_accvgpr_read_b32 v160, a120
    v_accvgpr_read_b32 v161, a121
    v_accvgpr_read_b32 v162, a122
    v_accvgpr_read_b32 v163, a123
    v_accvgpr_read_b32 v164, a124
    v_accvgpr_read_b32 v165, a125
    v_accvgpr_read_b32 v166, a126
    v_accvgpr_read_b32 v167, a127
    v_ldexp_f32 v160, v160, v169
    v_ldexp_f32 v161, v161, v169
    v_ldexp_f32 v162, v162, v169
    v_ldexp_f32 v163, v163, v169
    v_ldexp_f32 v164, v164, v169
    v_ldexp_f32 v165, v165, v169
    v_ldexp_f32 v166, v166, v169
    v_ldexp_f32 v167, v167, v169
    v_accvgpr_write_b32 a120, v160
    v_accvgpr_write_b32 a121, v161
    v_accvgpr_write_b32 a122, v162
    v_accvgpr_write_b32 a123, v163
    v_accvgpr_write_b32 a124, v164
    v_accvgpr_write_b32 a125, v165
    v_accvgpr_write_b32 a126, v166
    v_accvgpr_write_b32 a127, v167
    s_nop 1
    s_cmp_eq_u32 s52, 101
    s_cbranch_scc1 k4_kernel_ret101
    s_cmp_eq_u32 s52, 0
    s_cbranch_scc1 k4_kernel_ret0
    s_cmp_eq_u32 s52, 2
    s_cbranch_scc1 k4_kernel_ret2
    s_cmp_eq_u32 s52, 4
    s_cbranch_scc1 k4_kernel_ret4
    s_cmp_eq_u32 s52, 6
    s_cbranch_scc1 k4_kernel_ret6
    s_cmp_eq_u32 s52, 159
    s_cbranch_scc1 k4_kernel_ret159
    s_cmp_eq_u32 s52, 161
    s_cbranch_scc1 k4_kernel_ret161
    s_branch k4_kernel_ret163

.section .rodata,"a"
.p2align 6
.amdhsa_kernel k1_kernel
  .amdhsa_next_free_vgpr 64
  .amdhsa_next_free_sgpr 72
  .amdhsa_accum_offset 64
  .amdhsa_group_segment_fixed_size 0
  .amdhsa_kernarg_size 112
  .amdhsa_user_sgpr_count 2
  .amdhsa_user_sgpr_kernarg_segment_ptr 1
  .amdhsa_system_sgpr_workgroup_id_x 1
.end_amdhsa_kernel
.text

.section .rodata,"a"
.p2align 6
.amdhsa_kernel k4_kernel
  .amdhsa_next_free_vgpr 512
  .amdhsa_next_free_sgpr 102
  .amdhsa_accum_offset 256
  .amdhsa_group_segment_fixed_size 0
  .amdhsa_kernarg_size 112
  .amdhsa_user_sgpr_count 2
  .amdhsa_user_sgpr_kernarg_segment_ptr 1
  .amdhsa_system_sgpr_workgroup_id_x 1
.end_amdhsa_kernel
.text
```
